```python
import torch

def _softmax(x, axis=-1):
    return torch.softmax(x, dim=axis)
def _gelu(x):
    return torch.nn.functional.gelu(x, approximate="tanh")
def _silu(x):
    return torch.nn.functional.silu(x)
def _sigmoid(x):
    return torch.sigmoid(x)
def _layernorm(x, axis=-1, eps=1e-5):
    m = x.mean(dim=axis, keepdim=True)
    v = x.var(dim=axis, keepdim=True, unbiased=False)
    return (x - m) / torch.sqrt(v + eps)
def _scatter_add(tgt, idx, src, axis=0):
    return tgt.clone().index_add_(axis, idx, src)
def _segment_sum(src, seg, n):
    out = torch.zeros((n,) + src.shape[1:], dtype=src.dtype)
    return out.index_add_(0, seg, src)
def _pad(x, pw):
    flat = tuple(v for pair in reversed(pw) for v in pair)
    return torch.nn.functional.pad(x, flat)

kernel_name = 'sequential_preLN__mha_block_cached__moe_arch_mod__decode'

def setup_inputs():

    _w = (lambda a: (lambda t: t.to(torch.bfloat16) if t.is_floating_point() else t)(torch.as_tensor(a)))
    def _A_setup():
        B, Sq, D = 4, 1, 640
        H, Sk, Dh = 32, 8192, 192
        return {
            "x": _w((lambda *s: torch.randn(*s, dtype=torch.bfloat16) * 0.05)(B, Sq, D)),
            "k_cache": _w((lambda *s: torch.randn(*s, dtype=torch.bfloat16) * 3.2)(B, H, Sk, Dh)),
            "v_cache": _w((lambda *s: torch.randn(*s, dtype=torch.bfloat16) * 0.4)(B, H, Sk, Dh)),
            "wq": _w((lambda *s: torch.randn(*s, dtype=torch.bfloat16) * 3.2)(D, H * Dh) * (D ** -0.5)),
            "wo": _w((lambda *s: torch.randn(*s, dtype=torch.bfloat16) * 0.4)(H * Dh, D) * ((H * Dh) ** -0.5)),
        }
    _A_in = _A_setup()

    def _B_setup():
        B, S, D, F, C = 4, 1, 640, 1536, 1
        return {
            "x": _w((lambda *s: torch.randn(*s, dtype=torch.bfloat16) * 0.05)(B, S, D)),
            "w_r": _w((lambda *s: torch.randn(*s, dtype=torch.bfloat16) * 0.05)(D)),
            "w_gate": _w((lambda *s: torch.randn(*s, dtype=torch.bfloat16) * 0.05)(D, F)),
            "w_up": _w((lambda *s: torch.randn(*s, dtype=torch.bfloat16) * 0.05)(D, F)),
            "w_down": _w((lambda *s: torch.randn(*s, dtype=torch.bfloat16) * 0.05)(F, D)),
        }
    _B_in = _B_setup()

    return {
        "A_x": _A_in["x"],
        "A_k_cache": _A_in["k_cache"],
        "A_v_cache": _A_in["v_cache"],
        "A_wq": _A_in["wq"],
        "A_wo": _A_in["wo"],
        "B_x": _B_in["x"],
        "B_w_r": _B_in["w_r"],
        "B_w_gate": _B_in["w_gate"],
        "B_w_up": _B_in["w_up"],
        "B_w_down": _B_in["w_down"],
    }

def reference(A_x, A_k_cache, A_v_cache, A_wq, A_wo, B_x, B_w_r, B_w_gate, B_w_up, B_w_down):
    def _A_ref(x, k_cache, v_cache, wq, wo):
        B, Sq, D = x.shape
        H, Dh = 32, 192
        q = (lambda x, *d: x.permute(*d))((x @ wq).reshape(B, Sq, H, Dh), 0, 2, 1, 3)
        scores = torch.einsum("bhqd,bhkd->bhqk", q, k_cache) * (Dh ** -0.5)
        p = _softmax(scores, axis=-1)
        o = torch.einsum("bhqk,bhkd->bhqd", p, v_cache)
        return (lambda x, *d: x.permute(*d))(o, 0, 2, 1, 3).reshape(B, Sq, H * Dh) @ wo

    def _B_ref(x, w_r, w_gate, w_up, w_down):
        B, S, D = x.shape
        C = 1
        r = x @ w_r
        idx = torch.argsort(-r, axis=-1)[:, :C]
        idx_e = (lambda x, n, axis: torch.repeat_interleave(x, n, dim=axis))(idx.reshape(B, C, 1), D, axis=2)
        x_sel = (lambda x, i, axis: torch.take_along_dim(x, i, dim=axis))(x, idx_e, axis=1)
        g = _silu(x_sel @ w_gate)
        u = x_sel @ w_up
        y = (g * u) @ w_down
        r_sel = _sigmoid((lambda x, i, axis: torch.take_along_dim(x, i, dim=axis))(r, idx, axis=1))
        y = y * r_sel.reshape(B, C, 1)
        b_off = (torch.arange(B) * S).reshape(B, 1)
        flat_idx = (idx + b_off).reshape(B * C)
        zero = (x * 0.0).reshape(B * S, D)
        upd = _scatter_add(zero, flat_idx, y.reshape(B * C, D), axis=0)
        return x + upd.reshape(B, S, D)

    x = A_x
    h = x + _A_ref(_layernorm(x, axis=-1), A_k_cache, A_v_cache, A_wq, A_wo)
    h2 = h + _B_ref(_layernorm(h, axis=-1), B_w_r, B_w_gate, B_w_up, B_w_down)
    return h2
```

```asm
; @launch kernel=attn_kernel grid=(256,1,1) block=(1024,1,1) lds=16384
; @launch kernel=wo_kernel grid=(10,32,1) block=(256,1,1) lds=8192
; @launch kernel=gateup_kernel grid=(96,1,1) block=(512,1,1) lds=24576
; @launch kernel=down_kernel grid=(80,1,1) block=(512,1,1) lds=24576
.amdgcn_target "amdgcn-amd-amdhsa--gfx950"
.text
.globl attn_kernel
.p2align 8
.type attn_kernel,@function
attn_kernel:
    s_cmp_ge_u32 s2, 256
    s_cbranch_scc1 L_attn_done
    s_load_dwordx2 s[4:5], s[0:1], 0
    s_load_dwordx4 s[8:11], s[0:1], 8
    s_load_dwordx2 s[12:13], s[0:1], 24
    s_load_dwordx2 s[14:15], s[0:1], 96
    s_and_b32 s36, s2, 7
    s_lshr_b32 s37, s2, 3
    s_and_b32 s38, s37, 3
    s_lshl_b32 s36, s36, 2
    s_add_u32 s36, s36, s38
    s_lshr_b32 s37, s37, 2
    s_lshr_b32 s38, s37, 1
    s_and_b32 s39, s37, 1
    s_lshl_b32 s40, s38, 5
    s_add_u32 s40, s40, s36
    s_lshl_b32 s40, s40, 1
    s_add_u32 s40, s40, s39
    s_mul_i32 s41, s40, 1572864
    v_and_b32 v6, 63, v0
    v_lshrrev_b32 v2, 6, v0
    v_lshrrev_b32 v3, 3, v6
    v_and_b32 v4, 7, v6
    v_lshlrev_b32 v4, 4, v4
    v_mul_u32_u24 v1, 98304, v2
    v_mul_u32_u24 v5, 384, v3
    v_add3_u32 v1, v1, v5, v4
    v_mul_u32_u24 v5, 40, v2
    v_add_u32 v5, v5, v3
    v_mul_u32_u24 v7, 12288, v5
    v_add_u32 v7, v7, v4
    v_lshlrev_b32 v8, 1, v5
    v_lshlrev_b32 v5, 2, v6
    s_waitcnt lgkmcnt(0)
    s_mul_i32 s42, s38, 1280
    s_add_u32 s4, s4, s42
    s_addc_u32 s5, s5, 0
    s_mov_b32 s28, s4
    s_and_b32 s29, s5, 0xffff
    s_mov_b32 s30, 0x500
    s_mov_b32 s31, 0x00020000
    s_mul_i32 s42, s36, 384
    s_add_u32 s12, s12, s42
    s_addc_u32 s13, s13, 0
    s_sub_u32 s43, 7864320, s42
    s_mov_b32 s24, s12
    s_and_b32 s25, s13, 0xffff
    s_mov_b32 s26, s43
    s_mov_b32 s27, 0x00020000
    s_add_u32 s8, s8, s41
    s_addc_u32 s9, s9, 0
    s_mov_b32 s16, s8
    s_and_b32 s17, s9, 0xffff
    s_mov_b32 s18, 0x180000
    s_mov_b32 s19, 0x00020000
    s_add_u32 s10, s10, s41
    s_addc_u32 s11, s11, 0
    s_mov_b32 s20, s10
    s_and_b32 s21, s11, 0xffff
    s_mov_b32 s22, 0x180000
    s_mov_b32 s23, 0x00020000
    s_mov_b32 s32, s14
    s_and_b32 s33, s15, 0xffff
    s_mov_b32 s34, 0x60000
    s_mov_b32 s35, 0x00020000
    buffer_load_dword v46, v5, s[28:31], 0 offen offset:0
    buffer_load_dword v47, v5, s[28:31], 0 offen offset:256
    buffer_load_dword v48, v5, s[28:31], 0 offen offset:512
    buffer_load_dword v49, v5, s[28:31], 0 offen offset:768
    buffer_load_dword v50, v5, s[28:31], 0 offen offset:1024
    buffer_load_ushort v51, v8, s[28:31], 0 offen offset:0
    buffer_load_ushort v52, v8, s[28:31], 0 offen offset:16
    buffer_load_ushort v53, v8, s[28:31], 0 offen offset:32
    buffer_load_ushort v126, v8, s[28:31], 0 offen offset:48
    buffer_load_ushort v127, v8, s[28:31], 0 offen offset:64
    s_mov_b32 s44, 0
    buffer_load_dwordx4 v[102:105], v7, s[24:27], s44 offen offset:0
    buffer_load_dwordx4 v[106:109], v7, s[24:27], s44 offen offset:128
    buffer_load_dwordx4 v[110:113], v7, s[24:27], s44 offen offset:256
    s_mov_b32 s44, 98304
    buffer_load_dwordx4 v[114:117], v7, s[24:27], s44 offen offset:0
    buffer_load_dwordx4 v[118:121], v7, s[24:27], s44 offen offset:128
    buffer_load_dwordx4 v[122:125], v7, s[24:27], s44 offen offset:256
    s_mov_b32 s44, 196608
    buffer_load_dwordx4 v[10:13], v7, s[24:27], s44 offen offset:0
    buffer_load_dwordx4 v[14:17], v7, s[24:27], s44 offen offset:128
    buffer_load_dwordx4 v[18:21], v7, s[24:27], s44 offen offset:256
    s_mov_b32 s44, 294912
    buffer_load_dwordx4 v[22:25], v7, s[24:27], s44 offen offset:0
    buffer_load_dwordx4 v[26:29], v7, s[24:27], s44 offen offset:128
    buffer_load_dwordx4 v[30:33], v7, s[24:27], s44 offen offset:256
    s_mov_b32 s44, 393216
    buffer_load_dwordx4 v[34:37], v7, s[24:27], s44 offen offset:0
    buffer_load_dwordx4 v[38:41], v7, s[24:27], s44 offen offset:128
    buffer_load_dwordx4 v[42:45], v7, s[24:27], s44 offen offset:256
    s_mov_b32 s45, 0
    buffer_load_dwordx4 v[78:81], v1, s[16:19], s45 offen offset:0 nt
    buffer_load_dwordx4 v[82:85], v1, s[16:19], s45 offen offset:128 nt
    buffer_load_dwordx4 v[86:89], v1, s[16:19], s45 offen offset:256 nt
    s_mov_b32 s45, 3072
    buffer_load_dwordx4 v[90:93], v1, s[16:19], s45 offen offset:0 nt
    buffer_load_dwordx4 v[94:97], v1, s[16:19], s45 offen offset:128 nt
    buffer_load_dwordx4 v[98:101], v1, s[16:19], s45 offen offset:256 nt
    s_waitcnt vmcnt(26)
    v_lshlrev_b32 v54, 16, v46
    v_and_b32 v55, 0xffff0000, v46
    v_lshlrev_b32 v56, 16, v47
    v_and_b32 v57, 0xffff0000, v47
    v_lshlrev_b32 v58, 16, v48
    v_and_b32 v59, 0xffff0000, v48
    v_lshlrev_b32 v60, 16, v49
    v_and_b32 v61, 0xffff0000, v49
    v_lshlrev_b32 v62, 16, v50
    v_and_b32 v63, 0xffff0000, v50
    v_add_f32 v2, v54, v55
    v_add_f32 v2, v2, v56
    v_add_f32 v2, v2, v57
    v_add_f32 v2, v2, v58
    v_add_f32 v2, v2, v59
    v_add_f32 v2, v2, v60
    v_add_f32 v2, v2, v61
    v_add_f32 v2, v2, v62
    v_add_f32 v2, v2, v63
    s_nop 1
    v_add_f32_dpp v2, v2, v2 quad_perm:[1,0,3,2] row_mask:0xf bank_mask:0xf
    s_nop 1
    v_add_f32_dpp v2, v2, v2 quad_perm:[2,3,0,1] row_mask:0xf bank_mask:0xf
    s_nop 1
    v_add_f32_dpp v2, v2, v2 row_half_mirror row_mask:0xf bank_mask:0xf
    s_nop 1
    v_add_f32_dpp v2, v2, v2 row_mirror row_mask:0xf bank_mask:0xf
    s_nop 1
    v_readlane_b32 s48, v2, 0
    v_readlane_b32 s49, v2, 16
    v_readlane_b32 s50, v2, 32
    v_readlane_b32 s51, v2, 48
    s_nop 1
    v_mov_b32 v2, s48
    v_add_f32 v2, s49, v2
    v_add_f32 v2, s50, v2
    v_add_f32 v2, s51, v2
    v_mul_f32 v2, 0x3acccccd, v2
    v_sub_f32 v4, v54, v2
    v_mul_f32 v3, v4, v4
    v_sub_f32 v4, v55, v2
    v_fmac_f32 v3, v4, v4
    v_sub_f32 v4, v56, v2
    v_fmac_f32 v3, v4, v4
    v_sub_f32 v4, v57, v2
    v_fmac_f32 v3, v4, v4
    v_sub_f32 v4, v58, v2
    v_fmac_f32 v3, v4, v4
    v_sub_f32 v4, v59, v2
    v_fmac_f32 v3, v4, v4
    v_sub_f32 v4, v60, v2
    v_fmac_f32 v3, v4, v4
    v_sub_f32 v4, v61, v2
    v_fmac_f32 v3, v4, v4
    v_sub_f32 v4, v62, v2
    v_fmac_f32 v3, v4, v4
    v_sub_f32 v4, v63, v2
    v_fmac_f32 v3, v4, v4
    s_nop 1
    v_add_f32_dpp v3, v3, v3 quad_perm:[1,0,3,2] row_mask:0xf bank_mask:0xf
    s_nop 1
    v_add_f32_dpp v3, v3, v3 quad_perm:[2,3,0,1] row_mask:0xf bank_mask:0xf
    s_nop 1
    v_add_f32_dpp v3, v3, v3 row_half_mirror row_mask:0xf bank_mask:0xf
    s_nop 1
    v_add_f32_dpp v3, v3, v3 row_mirror row_mask:0xf bank_mask:0xf
    s_nop 1
    v_readlane_b32 s48, v3, 0
    v_readlane_b32 s49, v3, 16
    v_readlane_b32 s50, v3, 32
    v_readlane_b32 s51, v3, 48
    s_nop 1
    v_mov_b32 v3, s48
    v_add_f32 v3, s49, v3
    v_add_f32 v3, s50, v3
    v_add_f32 v3, s51, v3
    v_mul_f32 v3, 0x3acccccd, v3
    v_cvt_pk_bf16_f32 v2, v2, v2
    v_lshlrev_b32 v2, 16, v2
    v_cvt_pk_bf16_f32 v3, v3, v3
    v_lshlrev_b32 v3, 16, v3
    v_add_f32 v3, 0x3727c5ac, v3
    v_cvt_pk_bf16_f32 v3, v3, v3
    v_lshlrev_b32 v3, 16, v3
    v_sqrt_f32 v3, v3
    s_nop 0
    v_cvt_pk_bf16_f32 v3, v3, v3
    v_lshlrev_b32 v3, 16, v3
    v_rcp_f32 v3, v3
    s_waitcnt vmcnt(21)
    v_lshlrev_b32 v51, 16, v51
    v_sub_f32 v51, v51, v2
    v_cvt_pk_bf16_f32 v51, v51, v51
    v_lshlrev_b32 v51, 16, v51
    v_mul_f32 v51, v51, v3
    v_cvt_pk_bf16_f32 v51, v51, v51
    v_lshlrev_b32 v51, 16, v51
    v_lshlrev_b32 v52, 16, v52
    v_sub_f32 v52, v52, v2
    v_cvt_pk_bf16_f32 v52, v52, v52
    v_lshlrev_b32 v52, 16, v52
    v_mul_f32 v52, v52, v3
    v_cvt_pk_bf16_f32 v52, v52, v52
    v_lshlrev_b32 v52, 16, v52
    v_lshlrev_b32 v53, 16, v53
    v_sub_f32 v53, v53, v2
    v_cvt_pk_bf16_f32 v53, v53, v53
    v_lshlrev_b32 v53, 16, v53
    v_mul_f32 v53, v53, v3
    v_cvt_pk_bf16_f32 v53, v53, v53
    v_lshlrev_b32 v53, 16, v53
    v_lshlrev_b32 v126, 16, v126
    v_sub_f32 v126, v126, v2
    v_cvt_pk_bf16_f32 v126, v126, v126
    v_lshlrev_b32 v126, 16, v126
    v_mul_f32 v126, v126, v3
    v_cvt_pk_bf16_f32 v126, v126, v126
    v_lshlrev_b32 v126, 16, v126
    v_lshlrev_b32 v127, 16, v127
    v_sub_f32 v127, v127, v2
    v_cvt_pk_bf16_f32 v127, v127, v127
    v_lshlrev_b32 v127, 16, v127
    v_mul_f32 v127, v127, v3
    v_cvt_pk_bf16_f32 v127, v127, v127
    v_lshlrev_b32 v127, 16, v127
    s_waitcnt vmcnt(18)
    v_lshlrev_b32 v2, 16, v102
    v_and_b32 v3, 0xffff0000, v102
    v_mul_f32 v54, v51, v2
    v_mul_f32 v55, v51, v3
    v_lshlrev_b32 v2, 16, v103
    v_and_b32 v3, 0xffff0000, v103
    v_mul_f32 v56, v51, v2
    v_mul_f32 v57, v51, v3
    v_lshlrev_b32 v2, 16, v104
    v_and_b32 v3, 0xffff0000, v104
    v_mul_f32 v58, v51, v2
    v_mul_f32 v59, v51, v3
    v_lshlrev_b32 v2, 16, v105
    v_and_b32 v3, 0xffff0000, v105
    v_mul_f32 v60, v51, v2
    v_mul_f32 v61, v51, v3
    v_lshlrev_b32 v2, 16, v106
    v_and_b32 v3, 0xffff0000, v106
    v_mul_f32 v62, v51, v2
    v_mul_f32 v63, v51, v3
    v_lshlrev_b32 v2, 16, v107
    v_and_b32 v3, 0xffff0000, v107
    v_mul_f32 v64, v51, v2
    v_mul_f32 v65, v51, v3
    v_lshlrev_b32 v2, 16, v108
    v_and_b32 v3, 0xffff0000, v108
    v_mul_f32 v66, v51, v2
    v_mul_f32 v67, v51, v3
    v_lshlrev_b32 v2, 16, v109
    v_and_b32 v3, 0xffff0000, v109
    v_mul_f32 v68, v51, v2
    v_mul_f32 v69, v51, v3
    v_lshlrev_b32 v2, 16, v110
    v_and_b32 v3, 0xffff0000, v110
    v_mul_f32 v70, v51, v2
    v_mul_f32 v71, v51, v3
    v_lshlrev_b32 v2, 16, v111
    v_and_b32 v3, 0xffff0000, v111
    v_mul_f32 v72, v51, v2
    v_mul_f32 v73, v51, v3
    v_lshlrev_b32 v2, 16, v112
    v_and_b32 v3, 0xffff0000, v112
    v_mul_f32 v74, v51, v2
    v_mul_f32 v75, v51, v3
    v_lshlrev_b32 v2, 16, v113
    v_and_b32 v3, 0xffff0000, v113
    v_mul_f32 v76, v51, v2
    v_mul_f32 v77, v51, v3
    s_mov_b32 s45, 6144
    buffer_load_dwordx4 v[102:105], v1, s[16:19], s45 offen offset:0 nt
    buffer_load_dwordx4 v[106:109], v1, s[16:19], s45 offen offset:128 nt
    buffer_load_dwordx4 v[110:113], v1, s[16:19], s45 offen offset:256 nt
    s_waitcnt vmcnt(18)
    v_lshlrev_b32 v2, 16, v114
    v_and_b32 v3, 0xffff0000, v114
    v_fmac_f32 v54, v52, v2
    v_fmac_f32 v55, v52, v3
    v_lshlrev_b32 v2, 16, v115
    v_and_b32 v3, 0xffff0000, v115
    v_fmac_f32 v56, v52, v2
    v_fmac_f32 v57, v52, v3
    v_lshlrev_b32 v2, 16, v116
    v_and_b32 v3, 0xffff0000, v116
    v_fmac_f32 v58, v52, v2
    v_fmac_f32 v59, v52, v3
    v_lshlrev_b32 v2, 16, v117
    v_and_b32 v3, 0xffff0000, v117
    v_fmac_f32 v60, v52, v2
    v_fmac_f32 v61, v52, v3
    v_lshlrev_b32 v2, 16, v118
    v_and_b32 v3, 0xffff0000, v118
    v_fmac_f32 v62, v52, v2
    v_fmac_f32 v63, v52, v3
    v_lshlrev_b32 v2, 16, v119
    v_and_b32 v3, 0xffff0000, v119
    v_fmac_f32 v64, v52, v2
    v_fmac_f32 v65, v52, v3
    v_lshlrev_b32 v2, 16, v120
    v_and_b32 v3, 0xffff0000, v120
    v_fmac_f32 v66, v52, v2
    v_fmac_f32 v67, v52, v3
    v_lshlrev_b32 v2, 16, v121
    v_and_b32 v3, 0xffff0000, v121
    v_fmac_f32 v68, v52, v2
    v_fmac_f32 v69, v52, v3
    v_lshlrev_b32 v2, 16, v122
    v_and_b32 v3, 0xffff0000, v122
    v_fmac_f32 v70, v52, v2
    v_fmac_f32 v71, v52, v3
    v_lshlrev_b32 v2, 16, v123
    v_and_b32 v3, 0xffff0000, v123
    v_fmac_f32 v72, v52, v2
    v_fmac_f32 v73, v52, v3
    v_lshlrev_b32 v2, 16, v124
    v_and_b32 v3, 0xffff0000, v124
    v_fmac_f32 v74, v52, v2
    v_fmac_f32 v75, v52, v3
    v_lshlrev_b32 v2, 16, v125
    v_and_b32 v3, 0xffff0000, v125
    v_fmac_f32 v76, v52, v2
    v_fmac_f32 v77, v52, v3
    s_mov_b32 s45, 9216
    buffer_load_dwordx4 v[114:117], v1, s[16:19], s45 offen offset:0 nt
    buffer_load_dwordx4 v[118:121], v1, s[16:19], s45 offen offset:128 nt
    buffer_load_dwordx4 v[122:125], v1, s[16:19], s45 offen offset:256 nt
    s_waitcnt vmcnt(18)
    v_lshlrev_b32 v2, 16, v10
    v_and_b32 v3, 0xffff0000, v10
    v_fmac_f32 v54, v53, v2
    v_fmac_f32 v55, v53, v3
    v_lshlrev_b32 v2, 16, v11
    v_and_b32 v3, 0xffff0000, v11
    v_fmac_f32 v56, v53, v2
    v_fmac_f32 v57, v53, v3
    v_lshlrev_b32 v2, 16, v12
    v_and_b32 v3, 0xffff0000, v12
    v_fmac_f32 v58, v53, v2
    v_fmac_f32 v59, v53, v3
    v_lshlrev_b32 v2, 16, v13
    v_and_b32 v3, 0xffff0000, v13
    v_fmac_f32 v60, v53, v2
    v_fmac_f32 v61, v53, v3
    v_lshlrev_b32 v2, 16, v14
    v_and_b32 v3, 0xffff0000, v14
    v_fmac_f32 v62, v53, v2
    v_fmac_f32 v63, v53, v3
    v_lshlrev_b32 v2, 16, v15
    v_and_b32 v3, 0xffff0000, v15
    v_fmac_f32 v64, v53, v2
    v_fmac_f32 v65, v53, v3
    v_lshlrev_b32 v2, 16, v16
    v_and_b32 v3, 0xffff0000, v16
    v_fmac_f32 v66, v53, v2
    v_fmac_f32 v67, v53, v3
    v_lshlrev_b32 v2, 16, v17
    v_and_b32 v3, 0xffff0000, v17
    v_fmac_f32 v68, v53, v2
    v_fmac_f32 v69, v53, v3
    v_lshlrev_b32 v2, 16, v18
    v_and_b32 v3, 0xffff0000, v18
    v_fmac_f32 v70, v53, v2
    v_fmac_f32 v71, v53, v3
    v_lshlrev_b32 v2, 16, v19
    v_and_b32 v3, 0xffff0000, v19
    v_fmac_f32 v72, v53, v2
    v_fmac_f32 v73, v53, v3
    v_lshlrev_b32 v2, 16, v20
    v_and_b32 v3, 0xffff0000, v20
    v_fmac_f32 v74, v53, v2
    v_fmac_f32 v75, v53, v3
    v_lshlrev_b32 v2, 16, v21
    v_and_b32 v3, 0xffff0000, v21
    v_fmac_f32 v76, v53, v2
    v_fmac_f32 v77, v53, v3
    s_waitcnt vmcnt(15)
    v_lshlrev_b32 v2, 16, v22
    v_and_b32 v3, 0xffff0000, v22
    v_fmac_f32 v54, v126, v2
    v_fmac_f32 v55, v126, v3
    v_lshlrev_b32 v2, 16, v23
    v_and_b32 v3, 0xffff0000, v23
    v_fmac_f32 v56, v126, v2
    v_fmac_f32 v57, v126, v3
    v_lshlrev_b32 v2, 16, v24
    v_and_b32 v3, 0xffff0000, v24
    v_fmac_f32 v58, v126, v2
    v_fmac_f32 v59, v126, v3
    v_lshlrev_b32 v2, 16, v25
    v_and_b32 v3, 0xffff0000, v25
    v_fmac_f32 v60, v126, v2
    v_fmac_f32 v61, v126, v3
    v_lshlrev_b32 v2, 16, v26
    v_and_b32 v3, 0xffff0000, v26
    v_fmac_f32 v62, v126, v2
    v_fmac_f32 v63, v126, v3
    v_lshlrev_b32 v2, 16, v27
    v_and_b32 v3, 0xffff0000, v27
    v_fmac_f32 v64, v126, v2
    v_fmac_f32 v65, v126, v3
    v_lshlrev_b32 v2, 16, v28
    v_and_b32 v3, 0xffff0000, v28
    v_fmac_f32 v66, v126, v2
    v_fmac_f32 v67, v126, v3
    v_lshlrev_b32 v2, 16, v29
    v_and_b32 v3, 0xffff0000, v29
    v_fmac_f32 v68, v126, v2
    v_fmac_f32 v69, v126, v3
    v_lshlrev_b32 v2, 16, v30
    v_and_b32 v3, 0xffff0000, v30
    v_fmac_f32 v70, v126, v2
    v_fmac_f32 v71, v126, v3
    v_lshlrev_b32 v2, 16, v31
    v_and_b32 v3, 0xffff0000, v31
    v_fmac_f32 v72, v126, v2
    v_fmac_f32 v73, v126, v3
    v_lshlrev_b32 v2, 16, v32
    v_and_b32 v3, 0xffff0000, v32
    v_fmac_f32 v74, v126, v2
    v_fmac_f32 v75, v126, v3
    v_lshlrev_b32 v2, 16, v33
    v_and_b32 v3, 0xffff0000, v33
    v_fmac_f32 v76, v126, v2
    v_fmac_f32 v77, v126, v3
    s_waitcnt vmcnt(12)
    v_lshlrev_b32 v2, 16, v34
    v_and_b32 v3, 0xffff0000, v34
    v_fmac_f32 v54, v127, v2
    v_fmac_f32 v55, v127, v3
    v_lshlrev_b32 v2, 16, v35
    v_and_b32 v3, 0xffff0000, v35
    v_fmac_f32 v56, v127, v2
    v_fmac_f32 v57, v127, v3
    v_lshlrev_b32 v2, 16, v36
    v_and_b32 v3, 0xffff0000, v36
    v_fmac_f32 v58, v127, v2
    v_fmac_f32 v59, v127, v3
    v_lshlrev_b32 v2, 16, v37
    v_and_b32 v3, 0xffff0000, v37
    v_fmac_f32 v60, v127, v2
    v_fmac_f32 v61, v127, v3
    v_lshlrev_b32 v2, 16, v38
    v_and_b32 v3, 0xffff0000, v38
    v_fmac_f32 v62, v127, v2
    v_fmac_f32 v63, v127, v3
    v_lshlrev_b32 v2, 16, v39
    v_and_b32 v3, 0xffff0000, v39
    v_fmac_f32 v64, v127, v2
    v_fmac_f32 v65, v127, v3
    v_lshlrev_b32 v2, 16, v40
    v_and_b32 v3, 0xffff0000, v40
    v_fmac_f32 v66, v127, v2
    v_fmac_f32 v67, v127, v3
    v_lshlrev_b32 v2, 16, v41
    v_and_b32 v3, 0xffff0000, v41
    v_fmac_f32 v68, v127, v2
    v_fmac_f32 v69, v127, v3
    v_lshlrev_b32 v2, 16, v42
    v_and_b32 v3, 0xffff0000, v42
    v_fmac_f32 v70, v127, v2
    v_fmac_f32 v71, v127, v3
    v_lshlrev_b32 v2, 16, v43
    v_and_b32 v3, 0xffff0000, v43
    v_fmac_f32 v72, v127, v2
    v_fmac_f32 v73, v127, v3
    v_lshlrev_b32 v2, 16, v44
    v_and_b32 v3, 0xffff0000, v44
    v_fmac_f32 v74, v127, v2
    v_fmac_f32 v75, v127, v3
    v_lshlrev_b32 v2, 16, v45
    v_and_b32 v3, 0xffff0000, v45
    v_fmac_f32 v76, v127, v2
    v_fmac_f32 v77, v127, v3
    s_nop 1
    v_permlane32_swap_b32 v54, v58
    v_permlane32_swap_b32 v55, v59
    v_permlane32_swap_b32 v56, v60
    v_permlane32_swap_b32 v57, v61
    v_permlane32_swap_b32 v62, v66
    v_permlane32_swap_b32 v63, v67
    v_permlane32_swap_b32 v64, v68
    v_permlane32_swap_b32 v65, v69
    v_permlane32_swap_b32 v70, v74
    v_permlane32_swap_b32 v71, v75
    v_permlane32_swap_b32 v72, v76
    v_permlane32_swap_b32 v73, v77
    v_add_f32 v54, v54, v58
    v_add_f32 v55, v55, v59
    v_add_f32 v56, v56, v60
    v_add_f32 v57, v57, v61
    v_add_f32 v62, v62, v66
    v_add_f32 v63, v63, v67
    v_add_f32 v64, v64, v68
    v_add_f32 v65, v65, v69
    v_add_f32 v70, v70, v74
    v_add_f32 v71, v71, v75
    v_add_f32 v72, v72, v76
    v_add_f32 v73, v73, v77
    s_nop 1
    v_permlane16_swap_b32 v54, v56
    v_permlane16_swap_b32 v55, v57
    v_permlane16_swap_b32 v62, v64
    v_permlane16_swap_b32 v63, v65
    v_permlane16_swap_b32 v70, v72
    v_permlane16_swap_b32 v71, v73
    v_add_f32 v54, v54, v56
    v_add_f32 v55, v55, v57
    v_add_f32 v62, v62, v64
    v_add_f32 v63, v63, v65
    v_add_f32 v70, v70, v72
    v_add_f32 v71, v71, v73
    s_nop 1
    v_add_f32_dpp v54, v54, v54 row_ror:8 row_mask:0xf bank_mask:0xf
    v_add_f32_dpp v55, v55, v55 row_ror:8 row_mask:0xf bank_mask:0xf
    v_add_f32_dpp v62, v62, v62 row_ror:8 row_mask:0xf bank_mask:0xf
    v_add_f32_dpp v63, v63, v63 row_ror:8 row_mask:0xf bank_mask:0xf
    v_add_f32_dpp v70, v70, v70 row_ror:8 row_mask:0xf bank_mask:0xf
    v_add_f32_dpp v71, v71, v71 row_ror:8 row_mask:0xf bank_mask:0xf
    v_lshrrev_b32 v2, 6, v0
    v_mul_u32_u24 v9, 768, v2
    v_and_b32 v2, 7, v6
    v_lshlrev_b32 v2, 5, v2
    v_add_u32 v9, v9, v2
    v_lshrrev_b32 v2, 5, v6
    v_lshlrev_b32 v2, 4, v2
    v_add_u32 v9, v9, v2
    v_bfe_u32 v2, v6, 4, 1
    v_lshlrev_b32 v2, 3, v2
    v_add_u32 v9, v9, v2
    ds_write_b64 v9, v[54:55] offset:0
    ds_write_b64 v9, v[62:63] offset:256
    ds_write_b64 v9, v[70:71] offset:512
    s_waitcnt lgkmcnt(0)
    s_barrier
    v_cmp_gt_u32 vcc, 192, v0
    s_and_saveexec_b64 s[46:47], vcc
    s_cbranch_execz L_attn_q1
    v_lshlrev_b32 v2, 2, v0
    ds_read_b32 v54, v2 offset:0
    ds_read_b32 v55, v2 offset:768
    ds_read_b32 v56, v2 offset:1536
    ds_read_b32 v57, v2 offset:2304
    ds_read_b32 v58, v2 offset:3072
    ds_read_b32 v59, v2 offset:3840
    ds_read_b32 v60, v2 offset:4608
    ds_read_b32 v61, v2 offset:5376
    ds_read_b32 v62, v2 offset:6144
    ds_read_b32 v63, v2 offset:6912
    ds_read_b32 v64, v2 offset:7680
    ds_read_b32 v65, v2 offset:8448
    ds_read_b32 v66, v2 offset:9216
    ds_read_b32 v67, v2 offset:9984
    ds_read_b32 v68, v2 offset:10752
    ds_read_b32 v69, v2 offset:11520
    s_waitcnt lgkmcnt(0)
    v_add_f32 v54, v54, v55
    v_add_f32 v54, v54, v56
    v_add_f32 v54, v54, v57
    v_add_f32 v54, v54, v58
    v_add_f32 v54, v54, v59
    v_add_f32 v54, v54, v60
    v_add_f32 v54, v54, v61
    v_add_f32 v54, v54, v62
    v_add_f32 v54, v54, v63
    v_add_f32 v54, v54, v64
    v_add_f32 v54, v54, v65
    v_add_f32 v54, v54, v66
    v_add_f32 v54, v54, v67
    v_add_f32 v54, v54, v68
    v_add_f32 v54, v54, v69
    v_cvt_pk_bf16_f32 v54, v54, v54
    v_lshlrev_b32 v2, 1, v0
    ds_write_b16 v2, v54 offset:12288
    s_waitcnt lgkmcnt(0)
L_attn_q1:
    s_or_b64 exec, exec, s[46:47]
    s_barrier
    v_and_b32 v2, 7, v6
    v_lshlrev_b32 v2, 4, v2
    ds_read_b128 v[10:13], v2 offset:12288
    ds_read_b128 v[14:17], v2 offset:12416
    ds_read_b128 v[18:21], v2 offset:12544
    s_waitcnt lgkmcnt(0)
    s_waitcnt vmcnt(9)
    v_dot2_f32_bf16 v2, v78, v10, 0
    v_dot2_f32_bf16 v3, v82, v14, 0
    v_dot2_f32_bf16 v4, v86, v18, 0
    v_dot2_f32_bf16 v2, v79, v11, v2
    v_dot2_f32_bf16 v3, v83, v15, v3
    v_dot2_f32_bf16 v4, v87, v19, v4
    v_dot2_f32_bf16 v2, v80, v12, v2
    v_dot2_f32_bf16 v3, v84, v16, v3
    v_dot2_f32_bf16 v4, v88, v20, v4
    v_dot2_f32_bf16 v2, v81, v13, v2
    v_dot2_f32_bf16 v3, v85, v17, v3
    v_dot2_f32_bf16 v4, v89, v21, v4
    s_mov_b32 s45, 12288
    buffer_load_dwordx4 v[78:81], v1, s[16:19], s45 offen offset:0 nt
    buffer_load_dwordx4 v[82:85], v1, s[16:19], s45 offen offset:128 nt
    buffer_load_dwordx4 v[86:89], v1, s[16:19], s45 offen offset:256 nt
    v_add_f32 v2, v2, v3
    v_add_f32 v2, v2, v4
    s_nop 1
    v_add_f32_dpp v2, v2, v2 quad_perm:[1,0,3,2] row_mask:0xf bank_mask:0xf
    s_nop 1
    v_add_f32_dpp v2, v2, v2 quad_perm:[2,3,0,1] row_mask:0xf bank_mask:0xf
    s_nop 1
    v_add_f32_dpp v2, v2, v2 row_half_mirror row_mask:0xf bank_mask:0xf
    v_cvt_pk_bf16_f32 v2, v2, v2
    v_lshlrev_b32 v2, 16, v2
    v_mul_f32 v2, 0x3d93cd3a, v2
    v_cvt_pk_bf16_f32 v2, v2, v2
    v_lshlrev_b32 v22, 16, v2
    s_waitcnt vmcnt(9)
    v_dot2_f32_bf16 v2, v90, v10, 0
    v_dot2_f32_bf16 v3, v94, v14, 0
    v_dot2_f32_bf16 v4, v98, v18, 0
    v_dot2_f32_bf16 v2, v91, v11, v2
    v_dot2_f32_bf16 v3, v95, v15, v3
    v_dot2_f32_bf16 v4, v99, v19, v4
    v_dot2_f32_bf16 v2, v92, v12, v2
    v_dot2_f32_bf16 v3, v96, v16, v3
    v_dot2_f32_bf16 v4, v100, v20, v4
    v_dot2_f32_bf16 v2, v93, v13, v2
    v_dot2_f32_bf16 v3, v97, v17, v3
    v_dot2_f32_bf16 v4, v101, v21, v4
    s_mov_b32 s45, 15360
    buffer_load_dwordx4 v[90:93], v1, s[16:19], s45 offen offset:0 nt
    buffer_load_dwordx4 v[94:97], v1, s[16:19], s45 offen offset:128 nt
    buffer_load_dwordx4 v[98:101], v1, s[16:19], s45 offen offset:256 nt
    v_add_f32 v2, v2, v3
    v_add_f32 v2, v2, v4
    s_nop 1
    v_add_f32_dpp v2, v2, v2 quad_perm:[1,0,3,2] row_mask:0xf bank_mask:0xf
    s_nop 1
    v_add_f32_dpp v2, v2, v2 quad_perm:[2,3,0,1] row_mask:0xf bank_mask:0xf
    s_nop 1
    v_add_f32_dpp v2, v2, v2 row_half_mirror row_mask:0xf bank_mask:0xf
    v_cvt_pk_bf16_f32 v2, v2, v2
    v_lshlrev_b32 v2, 16, v2
    v_mul_f32 v2, 0x3d93cd3a, v2
    v_cvt_pk_bf16_f32 v2, v2, v2
    v_lshlrev_b32 v23, 16, v2
    s_waitcnt vmcnt(9)
    v_dot2_f32_bf16 v2, v102, v10, 0
    v_dot2_f32_bf16 v3, v106, v14, 0
    v_dot2_f32_bf16 v4, v110, v18, 0
    v_dot2_f32_bf16 v2, v103, v11, v2
    v_dot2_f32_bf16 v3, v107, v15, v3
    v_dot2_f32_bf16 v4, v111, v19, v4
    v_dot2_f32_bf16 v2, v104, v12, v2
    v_dot2_f32_bf16 v3, v108, v16, v3
    v_dot2_f32_bf16 v4, v112, v20, v4
    v_dot2_f32_bf16 v2, v105, v13, v2
    v_dot2_f32_bf16 v3, v109, v17, v3
    v_dot2_f32_bf16 v4, v113, v21, v4
    s_mov_b32 s45, 18432
    buffer_load_dwordx4 v[102:105], v1, s[16:19], s45 offen offset:0 nt
    buffer_load_dwordx4 v[106:109], v1, s[16:19], s45 offen offset:128 nt
    buffer_load_dwordx4 v[110:113], v1, s[16:19], s45 offen offset:256 nt
    v_add_f32 v2, v2, v3
    v_add_f32 v2, v2, v4
    s_nop 1
    v_add_f32_dpp v2, v2, v2 quad_perm:[1,0,3,2] row_mask:0xf bank_mask:0xf
    s_nop 1
    v_add_f32_dpp v2, v2, v2 quad_perm:[2,3,0,1] row_mask:0xf bank_mask:0xf
    s_nop 1
    v_add_f32_dpp v2, v2, v2 row_half_mirror row_mask:0xf bank_mask:0xf
    v_cvt_pk_bf16_f32 v2, v2, v2
    v_lshlrev_b32 v2, 16, v2
    v_mul_f32 v2, 0x3d93cd3a, v2
    v_cvt_pk_bf16_f32 v2, v2, v2
    v_lshlrev_b32 v24, 16, v2
    s_waitcnt vmcnt(9)
    v_dot2_f32_bf16 v2, v114, v10, 0
    v_dot2_f32_bf16 v3, v118, v14, 0
    v_dot2_f32_bf16 v4, v122, v18, 0
    v_dot2_f32_bf16 v2, v115, v11, v2
    v_dot2_f32_bf16 v3, v119, v15, v3
    v_dot2_f32_bf16 v4, v123, v19, v4
    v_dot2_f32_bf16 v2, v116, v12, v2
    v_dot2_f32_bf16 v3, v120, v16, v3
    v_dot2_f32_bf16 v4, v124, v20, v4
    v_dot2_f32_bf16 v2, v117, v13, v2
    v_dot2_f32_bf16 v3, v121, v17, v3
    v_dot2_f32_bf16 v4, v125, v21, v4
    s_mov_b32 s45, 21504
    buffer_load_dwordx4 v[114:117], v1, s[16:19], s45 offen offset:0 nt
    buffer_load_dwordx4 v[118:121], v1, s[16:19], s45 offen offset:128 nt
    buffer_load_dwordx4 v[122:125], v1, s[16:19], s45 offen offset:256 nt
    v_add_f32 v2, v2, v3
    v_add_f32 v2, v2, v4
    s_nop 1
    v_add_f32_dpp v2, v2, v2 quad_perm:[1,0,3,2] row_mask:0xf bank_mask:0xf
    s_nop 1
    v_add_f32_dpp v2, v2, v2 quad_perm:[2,3,0,1] row_mask:0xf bank_mask:0xf
    s_nop 1
    v_add_f32_dpp v2, v2, v2 row_half_mirror row_mask:0xf bank_mask:0xf
    v_cvt_pk_bf16_f32 v2, v2, v2
    v_lshlrev_b32 v2, 16, v2
    v_mul_f32 v2, 0x3d93cd3a, v2
    v_cvt_pk_bf16_f32 v2, v2, v2
    v_lshlrev_b32 v25, 16, v2
    s_waitcnt vmcnt(9)
    v_dot2_f32_bf16 v2, v78, v10, 0
    v_dot2_f32_bf16 v3, v82, v14, 0
    v_dot2_f32_bf16 v4, v86, v18, 0
    v_dot2_f32_bf16 v2, v79, v11, v2
    v_dot2_f32_bf16 v3, v83, v15, v3
    v_dot2_f32_bf16 v4, v87, v19, v4
    v_dot2_f32_bf16 v2, v80, v12, v2
    v_dot2_f32_bf16 v3, v84, v16, v3
    v_dot2_f32_bf16 v4, v88, v20, v4
    v_dot2_f32_bf16 v2, v81, v13, v2
    v_dot2_f32_bf16 v3, v85, v17, v3
    v_dot2_f32_bf16 v4, v89, v21, v4
    s_mov_b32 s45, 24576
    buffer_load_dwordx4 v[78:81], v1, s[16:19], s45 offen offset:0 nt
    buffer_load_dwordx4 v[82:85], v1, s[16:19], s45 offen offset:128 nt
    buffer_load_dwordx4 v[86:89], v1, s[16:19], s45 offen offset:256 nt
    v_add_f32 v2, v2, v3
    v_add_f32 v2, v2, v4
    s_nop 1
    v_add_f32_dpp v2, v2, v2 quad_perm:[1,0,3,2] row_mask:0xf bank_mask:0xf
    s_nop 1
    v_add_f32_dpp v2, v2, v2 quad_perm:[2,3,0,1] row_mask:0xf bank_mask:0xf
    s_nop 1
    v_add_f32_dpp v2, v2, v2 row_half_mirror row_mask:0xf bank_mask:0xf
    v_cvt_pk_bf16_f32 v2, v2, v2
    v_lshlrev_b32 v2, 16, v2
    v_mul_f32 v2, 0x3d93cd3a, v2
    v_cvt_pk_bf16_f32 v2, v2, v2
    v_lshlrev_b32 v26, 16, v2
    s_waitcnt vmcnt(9)
    v_dot2_f32_bf16 v2, v90, v10, 0
    v_dot2_f32_bf16 v3, v94, v14, 0
    v_dot2_f32_bf16 v4, v98, v18, 0
    v_dot2_f32_bf16 v2, v91, v11, v2
    v_dot2_f32_bf16 v3, v95, v15, v3
    v_dot2_f32_bf16 v4, v99, v19, v4
    v_dot2_f32_bf16 v2, v92, v12, v2
    v_dot2_f32_bf16 v3, v96, v16, v3
    v_dot2_f32_bf16 v4, v100, v20, v4
    v_dot2_f32_bf16 v2, v93, v13, v2
    v_dot2_f32_bf16 v3, v97, v17, v3
    v_dot2_f32_bf16 v4, v101, v21, v4
    s_mov_b32 s45, 27648
    buffer_load_dwordx4 v[90:93], v1, s[16:19], s45 offen offset:0 nt
    buffer_load_dwordx4 v[94:97], v1, s[16:19], s45 offen offset:128 nt
    buffer_load_dwordx4 v[98:101], v1, s[16:19], s45 offen offset:256 nt
    v_add_f32 v2, v2, v3
    v_add_f32 v2, v2, v4
    s_nop 1
    v_add_f32_dpp v2, v2, v2 quad_perm:[1,0,3,2] row_mask:0xf bank_mask:0xf
    s_nop 1
    v_add_f32_dpp v2, v2, v2 quad_perm:[2,3,0,1] row_mask:0xf bank_mask:0xf
    s_nop 1
    v_add_f32_dpp v2, v2, v2 row_half_mirror row_mask:0xf bank_mask:0xf
    v_cvt_pk_bf16_f32 v2, v2, v2
    v_lshlrev_b32 v2, 16, v2
    v_mul_f32 v2, 0x3d93cd3a, v2
    v_cvt_pk_bf16_f32 v2, v2, v2
    v_lshlrev_b32 v27, 16, v2
    s_waitcnt vmcnt(9)
    v_dot2_f32_bf16 v2, v102, v10, 0
    v_dot2_f32_bf16 v3, v106, v14, 0
    v_dot2_f32_bf16 v4, v110, v18, 0
    v_dot2_f32_bf16 v2, v103, v11, v2
    v_dot2_f32_bf16 v3, v107, v15, v3
    v_dot2_f32_bf16 v4, v111, v19, v4
    v_dot2_f32_bf16 v2, v104, v12, v2
    v_dot2_f32_bf16 v3, v108, v16, v3
    v_dot2_f32_bf16 v4, v112, v20, v4
    v_dot2_f32_bf16 v2, v105, v13, v2
    v_dot2_f32_bf16 v3, v109, v17, v3
    v_dot2_f32_bf16 v4, v113, v21, v4
    s_mov_b32 s45, 30720
    buffer_load_dwordx4 v[102:105], v1, s[16:19], s45 offen offset:0 nt
    buffer_load_dwordx4 v[106:109], v1, s[16:19], s45 offen offset:128 nt
    buffer_load_dwordx4 v[110:113], v1, s[16:19], s45 offen offset:256 nt
    v_add_f32 v2, v2, v3
    v_add_f32 v2, v2, v4
    s_nop 1
    v_add_f32_dpp v2, v2, v2 quad_perm:[1,0,3,2] row_mask:0xf bank_mask:0xf
    s_nop 1
    v_add_f32_dpp v2, v2, v2 quad_perm:[2,3,0,1] row_mask:0xf bank_mask:0xf
    s_nop 1
    v_add_f32_dpp v2, v2, v2 row_half_mirror row_mask:0xf bank_mask:0xf
    v_cvt_pk_bf16_f32 v2, v2, v2
    v_lshlrev_b32 v2, 16, v2
    v_mul_f32 v2, 0x3d93cd3a, v2
    v_cvt_pk_bf16_f32 v2, v2, v2
    v_lshlrev_b32 v28, 16, v2
    s_waitcnt vmcnt(9)
    v_dot2_f32_bf16 v2, v114, v10, 0
    v_dot2_f32_bf16 v3, v118, v14, 0
    v_dot2_f32_bf16 v4, v122, v18, 0
    v_dot2_f32_bf16 v2, v115, v11, v2
    v_dot2_f32_bf16 v3, v119, v15, v3
    v_dot2_f32_bf16 v4, v123, v19, v4
    v_dot2_f32_bf16 v2, v116, v12, v2
    v_dot2_f32_bf16 v3, v120, v16, v3
    v_dot2_f32_bf16 v4, v124, v20, v4
    v_dot2_f32_bf16 v2, v117, v13, v2
    v_dot2_f32_bf16 v3, v121, v17, v3
    v_dot2_f32_bf16 v4, v125, v21, v4
    s_mov_b32 s45, 33792
    buffer_load_dwordx4 v[114:117], v1, s[16:19], s45 offen offset:0 nt
    buffer_load_dwordx4 v[118:121], v1, s[16:19], s45 offen offset:128 nt
    buffer_load_dwordx4 v[122:125], v1, s[16:19], s45 offen offset:256 nt
    v_add_f32 v2, v2, v3
    v_add_f32 v2, v2, v4
    s_nop 1
    v_add_f32_dpp v2, v2, v2 quad_perm:[1,0,3,2] row_mask:0xf bank_mask:0xf
    s_nop 1
    v_add_f32_dpp v2, v2, v2 quad_perm:[2,3,0,1] row_mask:0xf bank_mask:0xf
    s_nop 1
    v_add_f32_dpp v2, v2, v2 row_half_mirror row_mask:0xf bank_mask:0xf
    v_cvt_pk_bf16_f32 v2, v2, v2
    v_lshlrev_b32 v2, 16, v2
    v_mul_f32 v2, 0x3d93cd3a, v2
    v_cvt_pk_bf16_f32 v2, v2, v2
    v_lshlrev_b32 v29, 16, v2
    s_waitcnt vmcnt(9)
    v_dot2_f32_bf16 v2, v78, v10, 0
    v_dot2_f32_bf16 v3, v82, v14, 0
    v_dot2_f32_bf16 v4, v86, v18, 0
    v_dot2_f32_bf16 v2, v79, v11, v2
    v_dot2_f32_bf16 v3, v83, v15, v3
    v_dot2_f32_bf16 v4, v87, v19, v4
    v_dot2_f32_bf16 v2, v80, v12, v2
    v_dot2_f32_bf16 v3, v84, v16, v3
    v_dot2_f32_bf16 v4, v88, v20, v4
    v_dot2_f32_bf16 v2, v81, v13, v2
    v_dot2_f32_bf16 v3, v85, v17, v3
    v_dot2_f32_bf16 v4, v89, v21, v4
    s_mov_b32 s45, 36864
    buffer_load_dwordx4 v[78:81], v1, s[16:19], s45 offen offset:0 nt
    buffer_load_dwordx4 v[82:85], v1, s[16:19], s45 offen offset:128 nt
    buffer_load_dwordx4 v[86:89], v1, s[16:19], s45 offen offset:256 nt
    v_add_f32 v2, v2, v3
    v_add_f32 v2, v2, v4
    s_nop 1
    v_add_f32_dpp v2, v2, v2 quad_perm:[1,0,3,2] row_mask:0xf bank_mask:0xf
    s_nop 1
    v_add_f32_dpp v2, v2, v2 quad_perm:[2,3,0,1] row_mask:0xf bank_mask:0xf
    s_nop 1
    v_add_f32_dpp v2, v2, v2 row_half_mirror row_mask:0xf bank_mask:0xf
    v_cvt_pk_bf16_f32 v2, v2, v2
    v_lshlrev_b32 v2, 16, v2
    v_mul_f32 v2, 0x3d93cd3a, v2
    v_cvt_pk_bf16_f32 v2, v2, v2
    v_lshlrev_b32 v30, 16, v2
    s_waitcnt vmcnt(9)
    v_dot2_f32_bf16 v2, v90, v10, 0
    v_dot2_f32_bf16 v3, v94, v14, 0
    v_dot2_f32_bf16 v4, v98, v18, 0
    v_dot2_f32_bf16 v2, v91, v11, v2
    v_dot2_f32_bf16 v3, v95, v15, v3
    v_dot2_f32_bf16 v4, v99, v19, v4
    v_dot2_f32_bf16 v2, v92, v12, v2
    v_dot2_f32_bf16 v3, v96, v16, v3
    v_dot2_f32_bf16 v4, v100, v20, v4
    v_dot2_f32_bf16 v2, v93, v13, v2
    v_dot2_f32_bf16 v3, v97, v17, v3
    v_dot2_f32_bf16 v4, v101, v21, v4
    s_mov_b32 s45, 39936
    buffer_load_dwordx4 v[90:93], v1, s[16:19], s45 offen offset:0 nt
    buffer_load_dwordx4 v[94:97], v1, s[16:19], s45 offen offset:128 nt
    buffer_load_dwordx4 v[98:101], v1, s[16:19], s45 offen offset:256 nt
    v_add_f32 v2, v2, v3
    v_add_f32 v2, v2, v4
    s_nop 1
    v_add_f32_dpp v2, v2, v2 quad_perm:[1,0,3,2] row_mask:0xf bank_mask:0xf
    s_nop 1
    v_add_f32_dpp v2, v2, v2 quad_perm:[2,3,0,1] row_mask:0xf bank_mask:0xf
    s_nop 1
    v_add_f32_dpp v2, v2, v2 row_half_mirror row_mask:0xf bank_mask:0xf
    v_cvt_pk_bf16_f32 v2, v2, v2
    v_lshlrev_b32 v2, 16, v2
    v_mul_f32 v2, 0x3d93cd3a, v2
    v_cvt_pk_bf16_f32 v2, v2, v2
    v_lshlrev_b32 v31, 16, v2
    s_waitcnt vmcnt(9)
    v_dot2_f32_bf16 v2, v102, v10, 0
    v_dot2_f32_bf16 v3, v106, v14, 0
    v_dot2_f32_bf16 v4, v110, v18, 0
    v_dot2_f32_bf16 v2, v103, v11, v2
    v_dot2_f32_bf16 v3, v107, v15, v3
    v_dot2_f32_bf16 v4, v111, v19, v4
    v_dot2_f32_bf16 v2, v104, v12, v2
    v_dot2_f32_bf16 v3, v108, v16, v3
    v_dot2_f32_bf16 v4, v112, v20, v4
    v_dot2_f32_bf16 v2, v105, v13, v2
    v_dot2_f32_bf16 v3, v109, v17, v3
    v_dot2_f32_bf16 v4, v113, v21, v4
    s_mov_b32 s45, 43008
    buffer_load_dwordx4 v[102:105], v1, s[16:19], s45 offen offset:0 nt
    buffer_load_dwordx4 v[106:109], v1, s[16:19], s45 offen offset:128 nt
    buffer_load_dwordx4 v[110:113], v1, s[16:19], s45 offen offset:256 nt
    v_add_f32 v2, v2, v3
    v_add_f32 v2, v2, v4
    s_nop 1
    v_add_f32_dpp v2, v2, v2 quad_perm:[1,0,3,2] row_mask:0xf bank_mask:0xf
    s_nop 1
    v_add_f32_dpp v2, v2, v2 quad_perm:[2,3,0,1] row_mask:0xf bank_mask:0xf
    s_nop 1
    v_add_f32_dpp v2, v2, v2 row_half_mirror row_mask:0xf bank_mask:0xf
    v_cvt_pk_bf16_f32 v2, v2, v2
    v_lshlrev_b32 v2, 16, v2
    v_mul_f32 v2, 0x3d93cd3a, v2
    v_cvt_pk_bf16_f32 v2, v2, v2
    v_lshlrev_b32 v32, 16, v2
    s_waitcnt vmcnt(9)
    v_dot2_f32_bf16 v2, v114, v10, 0
    v_dot2_f32_bf16 v3, v118, v14, 0
    v_dot2_f32_bf16 v4, v122, v18, 0
    v_dot2_f32_bf16 v2, v115, v11, v2
    v_dot2_f32_bf16 v3, v119, v15, v3
    v_dot2_f32_bf16 v4, v123, v19, v4
    v_dot2_f32_bf16 v2, v116, v12, v2
    v_dot2_f32_bf16 v3, v120, v16, v3
    v_dot2_f32_bf16 v4, v124, v20, v4
    v_dot2_f32_bf16 v2, v117, v13, v2
    v_dot2_f32_bf16 v3, v121, v17, v3
    v_dot2_f32_bf16 v4, v125, v21, v4
    s_mov_b32 s45, 46080
    buffer_load_dwordx4 v[114:117], v1, s[16:19], s45 offen offset:0 nt
    buffer_load_dwordx4 v[118:121], v1, s[16:19], s45 offen offset:128 nt
    buffer_load_dwordx4 v[122:125], v1, s[16:19], s45 offen offset:256 nt
    v_add_f32 v2, v2, v3
    v_add_f32 v2, v2, v4
    s_nop 1
    v_add_f32_dpp v2, v2, v2 quad_perm:[1,0,3,2] row_mask:0xf bank_mask:0xf
    s_nop 1
    v_add_f32_dpp v2, v2, v2 quad_perm:[2,3,0,1] row_mask:0xf bank_mask:0xf
    s_nop 1
    v_add_f32_dpp v2, v2, v2 row_half_mirror row_mask:0xf bank_mask:0xf
    v_cvt_pk_bf16_f32 v2, v2, v2
    v_lshlrev_b32 v2, 16, v2
    v_mul_f32 v2, 0x3d93cd3a, v2
    v_cvt_pk_bf16_f32 v2, v2, v2
    v_lshlrev_b32 v33, 16, v2
    s_waitcnt vmcnt(9)
    v_dot2_f32_bf16 v2, v78, v10, 0
    v_dot2_f32_bf16 v3, v82, v14, 0
    v_dot2_f32_bf16 v4, v86, v18, 0
    v_dot2_f32_bf16 v2, v79, v11, v2
    v_dot2_f32_bf16 v3, v83, v15, v3
    v_dot2_f32_bf16 v4, v87, v19, v4
    v_dot2_f32_bf16 v2, v80, v12, v2
    v_dot2_f32_bf16 v3, v84, v16, v3
    v_dot2_f32_bf16 v4, v88, v20, v4
    v_dot2_f32_bf16 v2, v81, v13, v2
    v_dot2_f32_bf16 v3, v85, v17, v3
    v_dot2_f32_bf16 v4, v89, v21, v4
    s_mov_b32 s45, 49152
    buffer_load_dwordx4 v[78:81], v1, s[16:19], s45 offen offset:0 nt
    buffer_load_dwordx4 v[82:85], v1, s[16:19], s45 offen offset:128 nt
    buffer_load_dwordx4 v[86:89], v1, s[16:19], s45 offen offset:256 nt
    v_add_f32 v2, v2, v3
    v_add_f32 v2, v2, v4
    s_nop 1
    v_add_f32_dpp v2, v2, v2 quad_perm:[1,0,3,2] row_mask:0xf bank_mask:0xf
    s_nop 1
    v_add_f32_dpp v2, v2, v2 quad_perm:[2,3,0,1] row_mask:0xf bank_mask:0xf
    s_nop 1
    v_add_f32_dpp v2, v2, v2 row_half_mirror row_mask:0xf bank_mask:0xf
    v_cvt_pk_bf16_f32 v2, v2, v2
    v_lshlrev_b32 v2, 16, v2
    v_mul_f32 v2, 0x3d93cd3a, v2
    v_cvt_pk_bf16_f32 v2, v2, v2
    v_lshlrev_b32 v34, 16, v2
    s_waitcnt vmcnt(9)
    v_dot2_f32_bf16 v2, v90, v10, 0
    v_dot2_f32_bf16 v3, v94, v14, 0
    v_dot2_f32_bf16 v4, v98, v18, 0
    v_dot2_f32_bf16 v2, v91, v11, v2
    v_dot2_f32_bf16 v3, v95, v15, v3
    v_dot2_f32_bf16 v4, v99, v19, v4
    v_dot2_f32_bf16 v2, v92, v12, v2
    v_dot2_f32_bf16 v3, v96, v16, v3
    v_dot2_f32_bf16 v4, v100, v20, v4
    v_dot2_f32_bf16 v2, v93, v13, v2
    v_dot2_f32_bf16 v3, v97, v17, v3
    v_dot2_f32_bf16 v4, v101, v21, v4
    s_mov_b32 s45, 52224
    buffer_load_dwordx4 v[90:93], v1, s[16:19], s45 offen offset:0 nt
    buffer_load_dwordx4 v[94:97], v1, s[16:19], s45 offen offset:128 nt
    buffer_load_dwordx4 v[98:101], v1, s[16:19], s45 offen offset:256 nt
    v_add_f32 v2, v2, v3
    v_add_f32 v2, v2, v4
    s_nop 1
    v_add_f32_dpp v2, v2, v2 quad_perm:[1,0,3,2] row_mask:0xf bank_mask:0xf
    s_nop 1
    v_add_f32_dpp v2, v2, v2 quad_perm:[2,3,0,1] row_mask:0xf bank_mask:0xf
    s_nop 1
    v_add_f32_dpp v2, v2, v2 row_half_mirror row_mask:0xf bank_mask:0xf
    v_cvt_pk_bf16_f32 v2, v2, v2
    v_lshlrev_b32 v2, 16, v2
    v_mul_f32 v2, 0x3d93cd3a, v2
    v_cvt_pk_bf16_f32 v2, v2, v2
    v_lshlrev_b32 v35, 16, v2
    s_waitcnt vmcnt(9)
    v_dot2_f32_bf16 v2, v102, v10, 0
    v_dot2_f32_bf16 v3, v106, v14, 0
    v_dot2_f32_bf16 v4, v110, v18, 0
    v_dot2_f32_bf16 v2, v103, v11, v2
    v_dot2_f32_bf16 v3, v107, v15, v3
    v_dot2_f32_bf16 v4, v111, v19, v4
    v_dot2_f32_bf16 v2, v104, v12, v2
    v_dot2_f32_bf16 v3, v108, v16, v3
    v_dot2_f32_bf16 v4, v112, v20, v4
    v_dot2_f32_bf16 v2, v105, v13, v2
    v_dot2_f32_bf16 v3, v109, v17, v3
    v_dot2_f32_bf16 v4, v113, v21, v4
    s_mov_b32 s45, 55296
    buffer_load_dwordx4 v[102:105], v1, s[16:19], s45 offen offset:0 nt
    buffer_load_dwordx4 v[106:109], v1, s[16:19], s45 offen offset:128 nt
    buffer_load_dwordx4 v[110:113], v1, s[16:19], s45 offen offset:256 nt
    v_add_f32 v2, v2, v3
    v_add_f32 v2, v2, v4
    s_nop 1
    v_add_f32_dpp v2, v2, v2 quad_perm:[1,0,3,2] row_mask:0xf bank_mask:0xf
    s_nop 1
    v_add_f32_dpp v2, v2, v2 quad_perm:[2,3,0,1] row_mask:0xf bank_mask:0xf
    s_nop 1
    v_add_f32_dpp v2, v2, v2 row_half_mirror row_mask:0xf bank_mask:0xf
    v_cvt_pk_bf16_f32 v2, v2, v2
    v_lshlrev_b32 v2, 16, v2
    v_mul_f32 v2, 0x3d93cd3a, v2
    v_cvt_pk_bf16_f32 v2, v2, v2
    v_lshlrev_b32 v36, 16, v2
    s_waitcnt vmcnt(9)
    v_dot2_f32_bf16 v2, v114, v10, 0
    v_dot2_f32_bf16 v3, v118, v14, 0
    v_dot2_f32_bf16 v4, v122, v18, 0
    v_dot2_f32_bf16 v2, v115, v11, v2
    v_dot2_f32_bf16 v3, v119, v15, v3
    v_dot2_f32_bf16 v4, v123, v19, v4
    v_dot2_f32_bf16 v2, v116, v12, v2
    v_dot2_f32_bf16 v3, v120, v16, v3
    v_dot2_f32_bf16 v4, v124, v20, v4
    v_dot2_f32_bf16 v2, v117, v13, v2
    v_dot2_f32_bf16 v3, v121, v17, v3
    v_dot2_f32_bf16 v4, v125, v21, v4
    s_mov_b32 s45, 58368
    buffer_load_dwordx4 v[114:117], v1, s[16:19], s45 offen offset:0 nt
    buffer_load_dwordx4 v[118:121], v1, s[16:19], s45 offen offset:128 nt
    buffer_load_dwordx4 v[122:125], v1, s[16:19], s45 offen offset:256 nt
    v_add_f32 v2, v2, v3
    v_add_f32 v2, v2, v4
    s_nop 1
    v_add_f32_dpp v2, v2, v2 quad_perm:[1,0,3,2] row_mask:0xf bank_mask:0xf
    s_nop 1
    v_add_f32_dpp v2, v2, v2 quad_perm:[2,3,0,1] row_mask:0xf bank_mask:0xf
    s_nop 1
    v_add_f32_dpp v2, v2, v2 row_half_mirror row_mask:0xf bank_mask:0xf
    v_cvt_pk_bf16_f32 v2, v2, v2
    v_lshlrev_b32 v2, 16, v2
    v_mul_f32 v2, 0x3d93cd3a, v2
    v_cvt_pk_bf16_f32 v2, v2, v2
    v_lshlrev_b32 v37, 16, v2
    s_waitcnt vmcnt(9)
    v_dot2_f32_bf16 v2, v78, v10, 0
    v_dot2_f32_bf16 v3, v82, v14, 0
    v_dot2_f32_bf16 v4, v86, v18, 0
    v_dot2_f32_bf16 v2, v79, v11, v2
    v_dot2_f32_bf16 v3, v83, v15, v3
    v_dot2_f32_bf16 v4, v87, v19, v4
    v_dot2_f32_bf16 v2, v80, v12, v2
    v_dot2_f32_bf16 v3, v84, v16, v3
    v_dot2_f32_bf16 v4, v88, v20, v4
    v_dot2_f32_bf16 v2, v81, v13, v2
    v_dot2_f32_bf16 v3, v85, v17, v3
    v_dot2_f32_bf16 v4, v89, v21, v4
    s_mov_b32 s45, 61440
    buffer_load_dwordx4 v[78:81], v1, s[16:19], s45 offen offset:0 nt
    buffer_load_dwordx4 v[82:85], v1, s[16:19], s45 offen offset:128 nt
    buffer_load_dwordx4 v[86:89], v1, s[16:19], s45 offen offset:256 nt
    v_add_f32 v2, v2, v3
    v_add_f32 v2, v2, v4
    s_nop 1
    v_add_f32_dpp v2, v2, v2 quad_perm:[1,0,3,2] row_mask:0xf bank_mask:0xf
    s_nop 1
    v_add_f32_dpp v2, v2, v2 quad_perm:[2,3,0,1] row_mask:0xf bank_mask:0xf
    s_nop 1
    v_add_f32_dpp v2, v2, v2 row_half_mirror row_mask:0xf bank_mask:0xf
    v_cvt_pk_bf16_f32 v2, v2, v2
    v_lshlrev_b32 v2, 16, v2
    v_mul_f32 v2, 0x3d93cd3a, v2
    v_cvt_pk_bf16_f32 v2, v2, v2
    v_lshlrev_b32 v38, 16, v2
    s_waitcnt vmcnt(9)
    v_dot2_f32_bf16 v2, v90, v10, 0
    v_dot2_f32_bf16 v3, v94, v14, 0
    v_dot2_f32_bf16 v4, v98, v18, 0
    v_dot2_f32_bf16 v2, v91, v11, v2
    v_dot2_f32_bf16 v3, v95, v15, v3
    v_dot2_f32_bf16 v4, v99, v19, v4
    v_dot2_f32_bf16 v2, v92, v12, v2
    v_dot2_f32_bf16 v3, v96, v16, v3
    v_dot2_f32_bf16 v4, v100, v20, v4
    v_dot2_f32_bf16 v2, v93, v13, v2
    v_dot2_f32_bf16 v3, v97, v17, v3
    v_dot2_f32_bf16 v4, v101, v21, v4
    s_mov_b32 s45, 64512
    buffer_load_dwordx4 v[90:93], v1, s[16:19], s45 offen offset:0 nt
    buffer_load_dwordx4 v[94:97], v1, s[16:19], s45 offen offset:128 nt
    buffer_load_dwordx4 v[98:101], v1, s[16:19], s45 offen offset:256 nt
    v_add_f32 v2, v2, v3
    v_add_f32 v2, v2, v4
    s_nop 1
    v_add_f32_dpp v2, v2, v2 quad_perm:[1,0,3,2] row_mask:0xf bank_mask:0xf
    s_nop 1
    v_add_f32_dpp v2, v2, v2 quad_perm:[2,3,0,1] row_mask:0xf bank_mask:0xf
    s_nop 1
    v_add_f32_dpp v2, v2, v2 row_half_mirror row_mask:0xf bank_mask:0xf
    v_cvt_pk_bf16_f32 v2, v2, v2
    v_lshlrev_b32 v2, 16, v2
    v_mul_f32 v2, 0x3d93cd3a, v2
    v_cvt_pk_bf16_f32 v2, v2, v2
    v_lshlrev_b32 v39, 16, v2
    s_waitcnt vmcnt(9)
    v_dot2_f32_bf16 v2, v102, v10, 0
    v_dot2_f32_bf16 v3, v106, v14, 0
    v_dot2_f32_bf16 v4, v110, v18, 0
    v_dot2_f32_bf16 v2, v103, v11, v2
    v_dot2_f32_bf16 v3, v107, v15, v3
    v_dot2_f32_bf16 v4, v111, v19, v4
    v_dot2_f32_bf16 v2, v104, v12, v2
    v_dot2_f32_bf16 v3, v108, v16, v3
    v_dot2_f32_bf16 v4, v112, v20, v4
    v_dot2_f32_bf16 v2, v105, v13, v2
    v_dot2_f32_bf16 v3, v109, v17, v3
    v_dot2_f32_bf16 v4, v113, v21, v4
    s_mov_b32 s45, 67584
    buffer_load_dwordx4 v[102:105], v1, s[16:19], s45 offen offset:0 nt
    buffer_load_dwordx4 v[106:109], v1, s[16:19], s45 offen offset:128 nt
    buffer_load_dwordx4 v[110:113], v1, s[16:19], s45 offen offset:256 nt
    v_add_f32 v2, v2, v3
    v_add_f32 v2, v2, v4
    s_nop 1
    v_add_f32_dpp v2, v2, v2 quad_perm:[1,0,3,2] row_mask:0xf bank_mask:0xf
    s_nop 1
    v_add_f32_dpp v2, v2, v2 quad_perm:[2,3,0,1] row_mask:0xf bank_mask:0xf
    s_nop 1
    v_add_f32_dpp v2, v2, v2 row_half_mirror row_mask:0xf bank_mask:0xf
    v_cvt_pk_bf16_f32 v2, v2, v2
    v_lshlrev_b32 v2, 16, v2
    v_mul_f32 v2, 0x3d93cd3a, v2
    v_cvt_pk_bf16_f32 v2, v2, v2
    v_lshlrev_b32 v40, 16, v2
    s_waitcnt vmcnt(9)
    v_dot2_f32_bf16 v2, v114, v10, 0
    v_dot2_f32_bf16 v3, v118, v14, 0
    v_dot2_f32_bf16 v4, v122, v18, 0
    v_dot2_f32_bf16 v2, v115, v11, v2
    v_dot2_f32_bf16 v3, v119, v15, v3
    v_dot2_f32_bf16 v4, v123, v19, v4
    v_dot2_f32_bf16 v2, v116, v12, v2
    v_dot2_f32_bf16 v3, v120, v16, v3
    v_dot2_f32_bf16 v4, v124, v20, v4
    v_dot2_f32_bf16 v2, v117, v13, v2
    v_dot2_f32_bf16 v3, v121, v17, v3
    v_dot2_f32_bf16 v4, v125, v21, v4
    s_mov_b32 s45, 70656
    buffer_load_dwordx4 v[114:117], v1, s[16:19], s45 offen offset:0 nt
    buffer_load_dwordx4 v[118:121], v1, s[16:19], s45 offen offset:128 nt
    buffer_load_dwordx4 v[122:125], v1, s[16:19], s45 offen offset:256 nt
    v_add_f32 v2, v2, v3
    v_add_f32 v2, v2, v4
    s_nop 1
    v_add_f32_dpp v2, v2, v2 quad_perm:[1,0,3,2] row_mask:0xf bank_mask:0xf
    s_nop 1
    v_add_f32_dpp v2, v2, v2 quad_perm:[2,3,0,1] row_mask:0xf bank_mask:0xf
    s_nop 1
    v_add_f32_dpp v2, v2, v2 row_half_mirror row_mask:0xf bank_mask:0xf
    v_cvt_pk_bf16_f32 v2, v2, v2
    v_lshlrev_b32 v2, 16, v2
    v_mul_f32 v2, 0x3d93cd3a, v2
    v_cvt_pk_bf16_f32 v2, v2, v2
    v_lshlrev_b32 v41, 16, v2
    s_waitcnt vmcnt(9)
    v_dot2_f32_bf16 v2, v78, v10, 0
    v_dot2_f32_bf16 v3, v82, v14, 0
    v_dot2_f32_bf16 v4, v86, v18, 0
    v_dot2_f32_bf16 v2, v79, v11, v2
    v_dot2_f32_bf16 v3, v83, v15, v3
    v_dot2_f32_bf16 v4, v87, v19, v4
    v_dot2_f32_bf16 v2, v80, v12, v2
    v_dot2_f32_bf16 v3, v84, v16, v3
    v_dot2_f32_bf16 v4, v88, v20, v4
    v_dot2_f32_bf16 v2, v81, v13, v2
    v_dot2_f32_bf16 v3, v85, v17, v3
    v_dot2_f32_bf16 v4, v89, v21, v4
    s_mov_b32 s45, 73728
    buffer_load_dwordx4 v[78:81], v1, s[16:19], s45 offen offset:0 nt
    buffer_load_dwordx4 v[82:85], v1, s[16:19], s45 offen offset:128 nt
    buffer_load_dwordx4 v[86:89], v1, s[16:19], s45 offen offset:256 nt
    v_add_f32 v2, v2, v3
    v_add_f32 v2, v2, v4
    s_nop 1
    v_add_f32_dpp v2, v2, v2 quad_perm:[1,0,3,2] row_mask:0xf bank_mask:0xf
    s_nop 1
    v_add_f32_dpp v2, v2, v2 quad_perm:[2,3,0,1] row_mask:0xf bank_mask:0xf
    s_nop 1
    v_add_f32_dpp v2, v2, v2 row_half_mirror row_mask:0xf bank_mask:0xf
    v_cvt_pk_bf16_f32 v2, v2, v2
    v_lshlrev_b32 v2, 16, v2
    v_mul_f32 v2, 0x3d93cd3a, v2
    v_cvt_pk_bf16_f32 v2, v2, v2
    v_lshlrev_b32 v42, 16, v2
    s_waitcnt vmcnt(9)
    v_dot2_f32_bf16 v2, v90, v10, 0
    v_dot2_f32_bf16 v3, v94, v14, 0
    v_dot2_f32_bf16 v4, v98, v18, 0
    v_dot2_f32_bf16 v2, v91, v11, v2
    v_dot2_f32_bf16 v3, v95, v15, v3
    v_dot2_f32_bf16 v4, v99, v19, v4
    v_dot2_f32_bf16 v2, v92, v12, v2
    v_dot2_f32_bf16 v3, v96, v16, v3
    v_dot2_f32_bf16 v4, v100, v20, v4
    v_dot2_f32_bf16 v2, v93, v13, v2
    v_dot2_f32_bf16 v3, v97, v17, v3
    v_dot2_f32_bf16 v4, v101, v21, v4
    s_mov_b32 s45, 76800
    buffer_load_dwordx4 v[90:93], v1, s[16:19], s45 offen offset:0 nt
    buffer_load_dwordx4 v[94:97], v1, s[16:19], s45 offen offset:128 nt
    buffer_load_dwordx4 v[98:101], v1, s[16:19], s45 offen offset:256 nt
    v_add_f32 v2, v2, v3
    v_add_f32 v2, v2, v4
    s_nop 1
    v_add_f32_dpp v2, v2, v2 quad_perm:[1,0,3,2] row_mask:0xf bank_mask:0xf
    s_nop 1
    v_add_f32_dpp v2, v2, v2 quad_perm:[2,3,0,1] row_mask:0xf bank_mask:0xf
    s_nop 1
    v_add_f32_dpp v2, v2, v2 row_half_mirror row_mask:0xf bank_mask:0xf
    v_cvt_pk_bf16_f32 v2, v2, v2
    v_lshlrev_b32 v2, 16, v2
    v_mul_f32 v2, 0x3d93cd3a, v2
    v_cvt_pk_bf16_f32 v2, v2, v2
    v_lshlrev_b32 v43, 16, v2
    s_waitcnt vmcnt(9)
    v_dot2_f32_bf16 v2, v102, v10, 0
    v_dot2_f32_bf16 v3, v106, v14, 0
    v_dot2_f32_bf16 v4, v110, v18, 0
    v_dot2_f32_bf16 v2, v103, v11, v2
    v_dot2_f32_bf16 v3, v107, v15, v3
    v_dot2_f32_bf16 v4, v111, v19, v4
    v_dot2_f32_bf16 v2, v104, v12, v2
    v_dot2_f32_bf16 v3, v108, v16, v3
    v_dot2_f32_bf16 v4, v112, v20, v4
    v_dot2_f32_bf16 v2, v105, v13, v2
    v_dot2_f32_bf16 v3, v109, v17, v3
    v_dot2_f32_bf16 v4, v113, v21, v4
    s_mov_b32 s45, 79872
    buffer_load_dwordx4 v[102:105], v1, s[16:19], s45 offen offset:0 nt
    buffer_load_dwordx4 v[106:109], v1, s[16:19], s45 offen offset:128 nt
    buffer_load_dwordx4 v[110:113], v1, s[16:19], s45 offen offset:256 nt
    v_add_f32 v2, v2, v3
    v_add_f32 v2, v2, v4
    s_nop 1
    v_add_f32_dpp v2, v2, v2 quad_perm:[1,0,3,2] row_mask:0xf bank_mask:0xf
    s_nop 1
    v_add_f32_dpp v2, v2, v2 quad_perm:[2,3,0,1] row_mask:0xf bank_mask:0xf
    s_nop 1
    v_add_f32_dpp v2, v2, v2 row_half_mirror row_mask:0xf bank_mask:0xf
    v_cvt_pk_bf16_f32 v2, v2, v2
    v_lshlrev_b32 v2, 16, v2
    v_mul_f32 v2, 0x3d93cd3a, v2
    v_cvt_pk_bf16_f32 v2, v2, v2
    v_lshlrev_b32 v44, 16, v2
    s_waitcnt vmcnt(9)
    v_dot2_f32_bf16 v2, v114, v10, 0
    v_dot2_f32_bf16 v3, v118, v14, 0
    v_dot2_f32_bf16 v4, v122, v18, 0
    v_dot2_f32_bf16 v2, v115, v11, v2
    v_dot2_f32_bf16 v3, v119, v15, v3
    v_dot2_f32_bf16 v4, v123, v19, v4
    v_dot2_f32_bf16 v2, v116, v12, v2
    v_dot2_f32_bf16 v3, v120, v16, v3
    v_dot2_f32_bf16 v4, v124, v20, v4
    v_dot2_f32_bf16 v2, v117, v13, v2
    v_dot2_f32_bf16 v3, v121, v17, v3
    v_dot2_f32_bf16 v4, v125, v21, v4
    s_mov_b32 s45, 82944
    buffer_load_dwordx4 v[114:117], v1, s[16:19], s45 offen offset:0 nt
    buffer_load_dwordx4 v[118:121], v1, s[16:19], s45 offen offset:128 nt
    buffer_load_dwordx4 v[122:125], v1, s[16:19], s45 offen offset:256 nt
    v_add_f32 v2, v2, v3
    v_add_f32 v2, v2, v4
    s_nop 1
    v_add_f32_dpp v2, v2, v2 quad_perm:[1,0,3,2] row_mask:0xf bank_mask:0xf
    s_nop 1
    v_add_f32_dpp v2, v2, v2 quad_perm:[2,3,0,1] row_mask:0xf bank_mask:0xf
    s_nop 1
    v_add_f32_dpp v2, v2, v2 row_half_mirror row_mask:0xf bank_mask:0xf
    v_cvt_pk_bf16_f32 v2, v2, v2
    v_lshlrev_b32 v2, 16, v2
    v_mul_f32 v2, 0x3d93cd3a, v2
    v_cvt_pk_bf16_f32 v2, v2, v2
    v_lshlrev_b32 v45, 16, v2
    s_waitcnt vmcnt(9)
    v_dot2_f32_bf16 v2, v78, v10, 0
    v_dot2_f32_bf16 v3, v82, v14, 0
    v_dot2_f32_bf16 v4, v86, v18, 0
    v_dot2_f32_bf16 v2, v79, v11, v2
    v_dot2_f32_bf16 v3, v83, v15, v3
    v_dot2_f32_bf16 v4, v87, v19, v4
    v_dot2_f32_bf16 v2, v80, v12, v2
    v_dot2_f32_bf16 v3, v84, v16, v3
    v_dot2_f32_bf16 v4, v88, v20, v4
    v_dot2_f32_bf16 v2, v81, v13, v2
    v_dot2_f32_bf16 v3, v85, v17, v3
    v_dot2_f32_bf16 v4, v89, v21, v4
    s_mov_b32 s45, 86016
    buffer_load_dwordx4 v[78:81], v1, s[16:19], s45 offen offset:0 nt
    buffer_load_dwordx4 v[82:85], v1, s[16:19], s45 offen offset:128 nt
    buffer_load_dwordx4 v[86:89], v1, s[16:19], s45 offen offset:256 nt
    v_add_f32 v2, v2, v3
    v_add_f32 v2, v2, v4
    s_nop 1
    v_add_f32_dpp v2, v2, v2 quad_perm:[1,0,3,2] row_mask:0xf bank_mask:0xf
    s_nop 1
    v_add_f32_dpp v2, v2, v2 quad_perm:[2,3,0,1] row_mask:0xf bank_mask:0xf
    s_nop 1
    v_add_f32_dpp v2, v2, v2 row_half_mirror row_mask:0xf bank_mask:0xf
    v_cvt_pk_bf16_f32 v2, v2, v2
    v_lshlrev_b32 v2, 16, v2
    v_mul_f32 v2, 0x3d93cd3a, v2
    v_cvt_pk_bf16_f32 v2, v2, v2
    v_lshlrev_b32 v46, 16, v2
    s_waitcnt vmcnt(9)
    v_dot2_f32_bf16 v2, v90, v10, 0
    v_dot2_f32_bf16 v3, v94, v14, 0
    v_dot2_f32_bf16 v4, v98, v18, 0
    v_dot2_f32_bf16 v2, v91, v11, v2
    v_dot2_f32_bf16 v3, v95, v15, v3
    v_dot2_f32_bf16 v4, v99, v19, v4
    v_dot2_f32_bf16 v2, v92, v12, v2
    v_dot2_f32_bf16 v3, v96, v16, v3
    v_dot2_f32_bf16 v4, v100, v20, v4
    v_dot2_f32_bf16 v2, v93, v13, v2
    v_dot2_f32_bf16 v3, v97, v17, v3
    v_dot2_f32_bf16 v4, v101, v21, v4
    s_mov_b32 s45, 89088
    buffer_load_dwordx4 v[90:93], v1, s[16:19], s45 offen offset:0 nt
    buffer_load_dwordx4 v[94:97], v1, s[16:19], s45 offen offset:128 nt
    buffer_load_dwordx4 v[98:101], v1, s[16:19], s45 offen offset:256 nt
    v_add_f32 v2, v2, v3
    v_add_f32 v2, v2, v4
    s_nop 1
    v_add_f32_dpp v2, v2, v2 quad_perm:[1,0,3,2] row_mask:0xf bank_mask:0xf
    s_nop 1
    v_add_f32_dpp v2, v2, v2 quad_perm:[2,3,0,1] row_mask:0xf bank_mask:0xf
    s_nop 1
    v_add_f32_dpp v2, v2, v2 row_half_mirror row_mask:0xf bank_mask:0xf
    v_cvt_pk_bf16_f32 v2, v2, v2
    v_lshlrev_b32 v2, 16, v2
    v_mul_f32 v2, 0x3d93cd3a, v2
    v_cvt_pk_bf16_f32 v2, v2, v2
    v_lshlrev_b32 v47, 16, v2
    s_waitcnt vmcnt(9)
    v_dot2_f32_bf16 v2, v102, v10, 0
    v_dot2_f32_bf16 v3, v106, v14, 0
    v_dot2_f32_bf16 v4, v110, v18, 0
    v_dot2_f32_bf16 v2, v103, v11, v2
    v_dot2_f32_bf16 v3, v107, v15, v3
    v_dot2_f32_bf16 v4, v111, v19, v4
    v_dot2_f32_bf16 v2, v104, v12, v2
    v_dot2_f32_bf16 v3, v108, v16, v3
    v_dot2_f32_bf16 v4, v112, v20, v4
    v_dot2_f32_bf16 v2, v105, v13, v2
    v_dot2_f32_bf16 v3, v109, v17, v3
    v_dot2_f32_bf16 v4, v113, v21, v4
    s_mov_b32 s45, 92160
    buffer_load_dwordx4 v[102:105], v1, s[16:19], s45 offen offset:0 nt
    buffer_load_dwordx4 v[106:109], v1, s[16:19], s45 offen offset:128 nt
    buffer_load_dwordx4 v[110:113], v1, s[16:19], s45 offen offset:256 nt
    v_add_f32 v2, v2, v3
    v_add_f32 v2, v2, v4
    s_nop 1
    v_add_f32_dpp v2, v2, v2 quad_perm:[1,0,3,2] row_mask:0xf bank_mask:0xf
    s_nop 1
    v_add_f32_dpp v2, v2, v2 quad_perm:[2,3,0,1] row_mask:0xf bank_mask:0xf
    s_nop 1
    v_add_f32_dpp v2, v2, v2 row_half_mirror row_mask:0xf bank_mask:0xf
    v_cvt_pk_bf16_f32 v2, v2, v2
    v_lshlrev_b32 v2, 16, v2
    v_mul_f32 v2, 0x3d93cd3a, v2
    v_cvt_pk_bf16_f32 v2, v2, v2
    v_lshlrev_b32 v48, 16, v2
    s_waitcnt vmcnt(9)
    v_dot2_f32_bf16 v2, v114, v10, 0
    v_dot2_f32_bf16 v3, v118, v14, 0
    v_dot2_f32_bf16 v4, v122, v18, 0
    v_dot2_f32_bf16 v2, v115, v11, v2
    v_dot2_f32_bf16 v3, v119, v15, v3
    v_dot2_f32_bf16 v4, v123, v19, v4
    v_dot2_f32_bf16 v2, v116, v12, v2
    v_dot2_f32_bf16 v3, v120, v16, v3
    v_dot2_f32_bf16 v4, v124, v20, v4
    v_dot2_f32_bf16 v2, v117, v13, v2
    v_dot2_f32_bf16 v3, v121, v17, v3
    v_dot2_f32_bf16 v4, v125, v21, v4
    s_mov_b32 s45, 95232
    buffer_load_dwordx4 v[114:117], v1, s[16:19], s45 offen offset:0 nt
    buffer_load_dwordx4 v[118:121], v1, s[16:19], s45 offen offset:128 nt
    buffer_load_dwordx4 v[122:125], v1, s[16:19], s45 offen offset:256 nt
    v_add_f32 v2, v2, v3
    v_add_f32 v2, v2, v4
    s_nop 1
    v_add_f32_dpp v2, v2, v2 quad_perm:[1,0,3,2] row_mask:0xf bank_mask:0xf
    s_nop 1
    v_add_f32_dpp v2, v2, v2 quad_perm:[2,3,0,1] row_mask:0xf bank_mask:0xf
    s_nop 1
    v_add_f32_dpp v2, v2, v2 row_half_mirror row_mask:0xf bank_mask:0xf
    v_cvt_pk_bf16_f32 v2, v2, v2
    v_lshlrev_b32 v2, 16, v2
    v_mul_f32 v2, 0x3d93cd3a, v2
    v_cvt_pk_bf16_f32 v2, v2, v2
    v_lshlrev_b32 v49, 16, v2
    s_waitcnt vmcnt(9)
    v_dot2_f32_bf16 v2, v78, v10, 0
    v_dot2_f32_bf16 v3, v82, v14, 0
    v_dot2_f32_bf16 v4, v86, v18, 0
    v_dot2_f32_bf16 v2, v79, v11, v2
    v_dot2_f32_bf16 v3, v83, v15, v3
    v_dot2_f32_bf16 v4, v87, v19, v4
    v_dot2_f32_bf16 v2, v80, v12, v2
    v_dot2_f32_bf16 v3, v84, v16, v3
    v_dot2_f32_bf16 v4, v88, v20, v4
    v_dot2_f32_bf16 v2, v81, v13, v2
    v_dot2_f32_bf16 v3, v85, v17, v3
    v_dot2_f32_bf16 v4, v89, v21, v4
    s_mov_b32 s45, 0
    buffer_load_dwordx4 v[78:81], v1, s[20:23], s45 offen offset:0 nt
    buffer_load_dwordx4 v[82:85], v1, s[20:23], s45 offen offset:128 nt
    buffer_load_dwordx4 v[86:89], v1, s[20:23], s45 offen offset:256 nt
    v_add_f32 v2, v2, v3
    v_add_f32 v2, v2, v4
    s_nop 1
    v_add_f32_dpp v2, v2, v2 quad_perm:[1,0,3,2] row_mask:0xf bank_mask:0xf
    s_nop 1
    v_add_f32_dpp v2, v2, v2 quad_perm:[2,3,0,1] row_mask:0xf bank_mask:0xf
    s_nop 1
    v_add_f32_dpp v2, v2, v2 row_half_mirror row_mask:0xf bank_mask:0xf
    v_cvt_pk_bf16_f32 v2, v2, v2
    v_lshlrev_b32 v2, 16, v2
    v_mul_f32 v2, 0x3d93cd3a, v2
    v_cvt_pk_bf16_f32 v2, v2, v2
    v_lshlrev_b32 v50, 16, v2
    s_waitcnt vmcnt(9)
    v_dot2_f32_bf16 v2, v90, v10, 0
    v_dot2_f32_bf16 v3, v94, v14, 0
    v_dot2_f32_bf16 v4, v98, v18, 0
    v_dot2_f32_bf16 v2, v91, v11, v2
    v_dot2_f32_bf16 v3, v95, v15, v3
    v_dot2_f32_bf16 v4, v99, v19, v4
    v_dot2_f32_bf16 v2, v92, v12, v2
    v_dot2_f32_bf16 v3, v96, v16, v3
    v_dot2_f32_bf16 v4, v100, v20, v4
    v_dot2_f32_bf16 v2, v93, v13, v2
    v_dot2_f32_bf16 v3, v97, v17, v3
    v_dot2_f32_bf16 v4, v101, v21, v4
    s_mov_b32 s45, 3072
    buffer_load_dwordx4 v[90:93], v1, s[20:23], s45 offen offset:0 nt
    buffer_load_dwordx4 v[94:97], v1, s[20:23], s45 offen offset:128 nt
    buffer_load_dwordx4 v[98:101], v1, s[20:23], s45 offen offset:256 nt
    v_add_f32 v2, v2, v3
    v_add_f32 v2, v2, v4
    s_nop 1
    v_add_f32_dpp v2, v2, v2 quad_perm:[1,0,3,2] row_mask:0xf bank_mask:0xf
    s_nop 1
    v_add_f32_dpp v2, v2, v2 quad_perm:[2,3,0,1] row_mask:0xf bank_mask:0xf
    s_nop 1
    v_add_f32_dpp v2, v2, v2 row_half_mirror row_mask:0xf bank_mask:0xf
    v_cvt_pk_bf16_f32 v2, v2, v2
    v_lshlrev_b32 v2, 16, v2
    v_mul_f32 v2, 0x3d93cd3a, v2
    v_cvt_pk_bf16_f32 v2, v2, v2
    v_lshlrev_b32 v51, 16, v2
    s_waitcnt vmcnt(9)
    v_dot2_f32_bf16 v2, v102, v10, 0
    v_dot2_f32_bf16 v3, v106, v14, 0
    v_dot2_f32_bf16 v4, v110, v18, 0
    v_dot2_f32_bf16 v2, v103, v11, v2
    v_dot2_f32_bf16 v3, v107, v15, v3
    v_dot2_f32_bf16 v4, v111, v19, v4
    v_dot2_f32_bf16 v2, v104, v12, v2
    v_dot2_f32_bf16 v3, v108, v16, v3
    v_dot2_f32_bf16 v4, v112, v20, v4
    v_dot2_f32_bf16 v2, v105, v13, v2
    v_dot2_f32_bf16 v3, v109, v17, v3
    v_dot2_f32_bf16 v4, v113, v21, v4
    s_mov_b32 s45, 6144
    buffer_load_dwordx4 v[102:105], v1, s[20:23], s45 offen offset:0 nt
    buffer_load_dwordx4 v[106:109], v1, s[20:23], s45 offen offset:128 nt
    buffer_load_dwordx4 v[110:113], v1, s[20:23], s45 offen offset:256 nt
    v_add_f32 v2, v2, v3
    v_add_f32 v2, v2, v4
    s_nop 1
    v_add_f32_dpp v2, v2, v2 quad_perm:[1,0,3,2] row_mask:0xf bank_mask:0xf
    s_nop 1
    v_add_f32_dpp v2, v2, v2 quad_perm:[2,3,0,1] row_mask:0xf bank_mask:0xf
    s_nop 1
    v_add_f32_dpp v2, v2, v2 row_half_mirror row_mask:0xf bank_mask:0xf
    v_cvt_pk_bf16_f32 v2, v2, v2
    v_lshlrev_b32 v2, 16, v2
    v_mul_f32 v2, 0x3d93cd3a, v2
    v_cvt_pk_bf16_f32 v2, v2, v2
    v_lshlrev_b32 v52, 16, v2
    s_waitcnt vmcnt(9)
    v_dot2_f32_bf16 v2, v114, v10, 0
    v_dot2_f32_bf16 v3, v118, v14, 0
    v_dot2_f32_bf16 v4, v122, v18, 0
    v_dot2_f32_bf16 v2, v115, v11, v2
    v_dot2_f32_bf16 v3, v119, v15, v3
    v_dot2_f32_bf16 v4, v123, v19, v4
    v_dot2_f32_bf16 v2, v116, v12, v2
    v_dot2_f32_bf16 v3, v120, v16, v3
    v_dot2_f32_bf16 v4, v124, v20, v4
    v_dot2_f32_bf16 v2, v117, v13, v2
    v_dot2_f32_bf16 v3, v121, v17, v3
    v_dot2_f32_bf16 v4, v125, v21, v4
    s_mov_b32 s45, 9216
    buffer_load_dwordx4 v[114:117], v1, s[20:23], s45 offen offset:0 nt
    buffer_load_dwordx4 v[118:121], v1, s[20:23], s45 offen offset:128 nt
    buffer_load_dwordx4 v[122:125], v1, s[20:23], s45 offen offset:256 nt
    v_add_f32 v2, v2, v3
    v_add_f32 v2, v2, v4
    s_nop 1
    v_add_f32_dpp v2, v2, v2 quad_perm:[1,0,3,2] row_mask:0xf bank_mask:0xf
    s_nop 1
    v_add_f32_dpp v2, v2, v2 quad_perm:[2,3,0,1] row_mask:0xf bank_mask:0xf
    s_nop 1
    v_add_f32_dpp v2, v2, v2 row_half_mirror row_mask:0xf bank_mask:0xf
    v_cvt_pk_bf16_f32 v2, v2, v2
    v_lshlrev_b32 v2, 16, v2
    v_mul_f32 v2, 0x3d93cd3a, v2
    v_cvt_pk_bf16_f32 v2, v2, v2
    v_lshlrev_b32 v53, 16, v2
    v_max3_f32 v2, v22, v23, v24
    v_max3_f32 v2, v2, v25, v26
    v_max3_f32 v2, v2, v27, v28
    v_max3_f32 v2, v2, v29, v30
    v_max3_f32 v2, v2, v31, v32
    v_max3_f32 v2, v2, v33, v34
    v_max3_f32 v2, v2, v35, v36
    v_max3_f32 v2, v2, v37, v38
    v_max3_f32 v2, v2, v39, v40
    v_max3_f32 v2, v2, v41, v42
    v_max3_f32 v2, v2, v43, v44
    v_max3_f32 v2, v2, v45, v46
    v_max3_f32 v2, v2, v47, v48
    v_max3_f32 v2, v2, v49, v50
    v_max3_f32 v2, v2, v51, v52
    v_max_f32 v2, v2, v53
    s_nop 1
    v_max_f32_dpp v2, v2, v2 quad_perm:[1,0,3,2] row_mask:0xf bank_mask:0xf
    s_nop 1
    v_max_f32_dpp v2, v2, v2 quad_perm:[2,3,0,1] row_mask:0xf bank_mask:0xf
    s_nop 1
    v_max_f32_dpp v2, v2, v2 row_half_mirror row_mask:0xf bank_mask:0xf
    s_nop 1
    v_max_f32_dpp v2, v2, v2 row_mirror row_mask:0xf bank_mask:0xf
    s_nop 1
    v_readlane_b32 s48, v2, 0
    v_readlane_b32 s49, v2, 16
    v_readlane_b32 s50, v2, 32
    v_readlane_b32 s51, v2, 48
    s_nop 1
    v_mov_b32 v2, s48
    v_max_f32 v2, s49, v2
    v_max_f32 v2, s50, v2
    v_max_f32 v2, s51, v2
    v_mul_f32 v3, 0x3fb8aa3b, v2
    s_mov_b32 s52, 0x3fb8aa3b
    v_fma_f32 v22, v22, s52, -v3
    v_exp_f32 v22, v22
    v_fma_f32 v23, v23, s52, -v3
    v_exp_f32 v23, v23
    v_fma_f32 v24, v24, s52, -v3
    v_exp_f32 v24, v24
    v_fma_f32 v25, v25, s52, -v3
    v_exp_f32 v25, v25
    v_fma_f32 v26, v26, s52, -v3
    v_exp_f32 v26, v26
    v_fma_f32 v27, v27, s52, -v3
    v_exp_f32 v27, v27
    v_fma_f32 v28, v28, s52, -v3
    v_exp_f32 v28, v28
    v_fma_f32 v29, v29, s52, -v3
    v_exp_f32 v29, v29
    v_fma_f32 v30, v30, s52, -v3
    v_exp_f32 v30, v30
    v_fma_f32 v31, v31, s52, -v3
    v_exp_f32 v31, v31
    v_fma_f32 v32, v32, s52, -v3
    v_exp_f32 v32, v32
    v_fma_f32 v33, v33, s52, -v3
    v_exp_f32 v33, v33
    v_fma_f32 v34, v34, s52, -v3
    v_exp_f32 v34, v34
    v_fma_f32 v35, v35, s52, -v3
    v_exp_f32 v35, v35
    v_fma_f32 v36, v36, s52, -v3
    v_exp_f32 v36, v36
    v_fma_f32 v37, v37, s52, -v3
    v_exp_f32 v37, v37
    v_fma_f32 v38, v38, s52, -v3
    v_exp_f32 v38, v38
    v_fma_f32 v39, v39, s52, -v3
    v_exp_f32 v39, v39
    v_fma_f32 v40, v40, s52, -v3
    v_exp_f32 v40, v40
    v_fma_f32 v41, v41, s52, -v3
    v_exp_f32 v41, v41
    v_fma_f32 v42, v42, s52, -v3
    v_exp_f32 v42, v42
    v_fma_f32 v43, v43, s52, -v3
    v_exp_f32 v43, v43
    v_fma_f32 v44, v44, s52, -v3
    v_exp_f32 v44, v44
    v_fma_f32 v45, v45, s52, -v3
    v_exp_f32 v45, v45
    v_fma_f32 v46, v46, s52, -v3
    v_exp_f32 v46, v46
    v_fma_f32 v47, v47, s52, -v3
    v_exp_f32 v47, v47
    v_fma_f32 v48, v48, s52, -v3
    v_exp_f32 v48, v48
    v_fma_f32 v49, v49, s52, -v3
    v_exp_f32 v49, v49
    v_fma_f32 v50, v50, s52, -v3
    v_exp_f32 v50, v50
    v_fma_f32 v51, v51, s52, -v3
    v_exp_f32 v51, v51
    v_fma_f32 v52, v52, s52, -v3
    v_exp_f32 v52, v52
    v_fma_f32 v53, v53, s52, -v3
    v_exp_f32 v53, v53
    s_nop 0
    v_add_f32 v3, v22, v23
    v_add_f32 v3, v3, v24
    v_add_f32 v3, v3, v25
    v_add_f32 v3, v3, v26
    v_add_f32 v3, v3, v27
    v_add_f32 v3, v3, v28
    v_add_f32 v3, v3, v29
    v_add_f32 v3, v3, v30
    v_add_f32 v3, v3, v31
    v_add_f32 v3, v3, v32
    v_add_f32 v3, v3, v33
    v_add_f32 v3, v3, v34
    v_add_f32 v3, v3, v35
    v_add_f32 v3, v3, v36
    v_add_f32 v3, v3, v37
    v_add_f32 v3, v3, v38
    v_add_f32 v3, v3, v39
    v_add_f32 v3, v3, v40
    v_add_f32 v3, v3, v41
    v_add_f32 v3, v3, v42
    v_add_f32 v3, v3, v43
    v_add_f32 v3, v3, v44
    v_add_f32 v3, v3, v45
    v_add_f32 v3, v3, v46
    v_add_f32 v3, v3, v47
    v_add_f32 v3, v3, v48
    v_add_f32 v3, v3, v49
    v_add_f32 v3, v3, v50
    v_add_f32 v3, v3, v51
    v_add_f32 v3, v3, v52
    v_add_f32 v3, v3, v53
    s_nop 1
    v_add_f32_dpp v3, v3, v3 quad_perm:[1,0,3,2] row_mask:0xf bank_mask:0xf
    s_nop 1
    v_add_f32_dpp v3, v3, v3 quad_perm:[2,3,0,1] row_mask:0xf bank_mask:0xf
    s_nop 1
    v_add_f32_dpp v3, v3, v3 row_half_mirror row_mask:0xf bank_mask:0xf
    s_nop 1
    v_add_f32_dpp v3, v3, v3 row_mirror row_mask:0xf bank_mask:0xf
    s_nop 1
    v_readlane_b32 s48, v3, 0
    v_readlane_b32 s49, v3, 16
    v_readlane_b32 s50, v3, 32
    v_readlane_b32 s51, v3, 48
    s_nop 1
    v_mov_b32 v3, s48
    v_add_f32 v3, s49, v3
    v_add_f32 v3, s50, v3
    v_add_f32 v3, s51, v3
    v_mul_f32 v3, 0.125, v3
    s_waitcnt vmcnt(9)
    v_lshlrev_b32 v4, 16, v78
    v_and_b32 v5, 0xffff0000, v78
    v_mul_f32 v54, v22, v4
    v_mul_f32 v55, v22, v5
    v_lshlrev_b32 v4, 16, v79
    v_and_b32 v5, 0xffff0000, v79
    v_mul_f32 v56, v22, v4
    v_mul_f32 v57, v22, v5
    v_lshlrev_b32 v4, 16, v80
    v_and_b32 v5, 0xffff0000, v80
    v_mul_f32 v58, v22, v4
    v_mul_f32 v59, v22, v5
    v_lshlrev_b32 v4, 16, v81
    v_and_b32 v5, 0xffff0000, v81
    v_mul_f32 v60, v22, v4
    v_mul_f32 v61, v22, v5
    v_lshlrev_b32 v4, 16, v82
    v_and_b32 v5, 0xffff0000, v82
    v_mul_f32 v62, v22, v4
    v_mul_f32 v63, v22, v5
    v_lshlrev_b32 v4, 16, v83
    v_and_b32 v5, 0xffff0000, v83
    v_mul_f32 v64, v22, v4
    v_mul_f32 v65, v22, v5
    v_lshlrev_b32 v4, 16, v84
    v_and_b32 v5, 0xffff0000, v84
    v_mul_f32 v66, v22, v4
    v_mul_f32 v67, v22, v5
    v_lshlrev_b32 v4, 16, v85
    v_and_b32 v5, 0xffff0000, v85
    v_mul_f32 v68, v22, v4
    v_mul_f32 v69, v22, v5
    v_lshlrev_b32 v4, 16, v86
    v_and_b32 v5, 0xffff0000, v86
    v_mul_f32 v70, v22, v4
    v_mul_f32 v71, v22, v5
    v_lshlrev_b32 v4, 16, v87
    v_and_b32 v5, 0xffff0000, v87
    v_mul_f32 v72, v22, v4
    v_mul_f32 v73, v22, v5
    v_lshlrev_b32 v4, 16, v88
    v_and_b32 v5, 0xffff0000, v88
    v_mul_f32 v74, v22, v4
    v_mul_f32 v75, v22, v5
    v_lshlrev_b32 v4, 16, v89
    v_and_b32 v5, 0xffff0000, v89
    v_mul_f32 v76, v22, v4
    v_mul_f32 v77, v22, v5
    s_mov_b32 s45, 12288
    buffer_load_dwordx4 v[78:81], v1, s[20:23], s45 offen offset:0 nt
    buffer_load_dwordx4 v[82:85], v1, s[20:23], s45 offen offset:128 nt
    buffer_load_dwordx4 v[86:89], v1, s[20:23], s45 offen offset:256 nt
    s_waitcnt vmcnt(9)
    v_lshlrev_b32 v4, 16, v90
    v_and_b32 v5, 0xffff0000, v90
    v_fmac_f32 v54, v23, v4
    v_fmac_f32 v55, v23, v5
    v_lshlrev_b32 v4, 16, v91
    v_and_b32 v5, 0xffff0000, v91
    v_fmac_f32 v56, v23, v4
    v_fmac_f32 v57, v23, v5
    v_lshlrev_b32 v4, 16, v92
    v_and_b32 v5, 0xffff0000, v92
    v_fmac_f32 v58, v23, v4
    v_fmac_f32 v59, v23, v5
    v_lshlrev_b32 v4, 16, v93
    v_and_b32 v5, 0xffff0000, v93
    v_fmac_f32 v60, v23, v4
    v_fmac_f32 v61, v23, v5
    v_lshlrev_b32 v4, 16, v94
    v_and_b32 v5, 0xffff0000, v94
    v_fmac_f32 v62, v23, v4
    v_fmac_f32 v63, v23, v5
    v_lshlrev_b32 v4, 16, v95
    v_and_b32 v5, 0xffff0000, v95
    v_fmac_f32 v64, v23, v4
    v_fmac_f32 v65, v23, v5
    v_lshlrev_b32 v4, 16, v96
    v_and_b32 v5, 0xffff0000, v96
    v_fmac_f32 v66, v23, v4
    v_fmac_f32 v67, v23, v5
    v_lshlrev_b32 v4, 16, v97
    v_and_b32 v5, 0xffff0000, v97
    v_fmac_f32 v68, v23, v4
    v_fmac_f32 v69, v23, v5
    v_lshlrev_b32 v4, 16, v98
    v_and_b32 v5, 0xffff0000, v98
    v_fmac_f32 v70, v23, v4
    v_fmac_f32 v71, v23, v5
    v_lshlrev_b32 v4, 16, v99
    v_and_b32 v5, 0xffff0000, v99
    v_fmac_f32 v72, v23, v4
    v_fmac_f32 v73, v23, v5
    v_lshlrev_b32 v4, 16, v100
    v_and_b32 v5, 0xffff0000, v100
    v_fmac_f32 v74, v23, v4
    v_fmac_f32 v75, v23, v5
    v_lshlrev_b32 v4, 16, v101
    v_and_b32 v5, 0xffff0000, v101
    v_fmac_f32 v76, v23, v4
    v_fmac_f32 v77, v23, v5
    s_mov_b32 s45, 15360
    buffer_load_dwordx4 v[90:93], v1, s[20:23], s45 offen offset:0 nt
    buffer_load_dwordx4 v[94:97], v1, s[20:23], s45 offen offset:128 nt
    buffer_load_dwordx4 v[98:101], v1, s[20:23], s45 offen offset:256 nt
    s_waitcnt vmcnt(9)
    v_lshlrev_b32 v4, 16, v102
    v_and_b32 v5, 0xffff0000, v102
    v_fmac_f32 v54, v24, v4
    v_fmac_f32 v55, v24, v5
    v_lshlrev_b32 v4, 16, v103
    v_and_b32 v5, 0xffff0000, v103
    v_fmac_f32 v56, v24, v4
    v_fmac_f32 v57, v24, v5
    v_lshlrev_b32 v4, 16, v104
    v_and_b32 v5, 0xffff0000, v104
    v_fmac_f32 v58, v24, v4
    v_fmac_f32 v59, v24, v5
    v_lshlrev_b32 v4, 16, v105
    v_and_b32 v5, 0xffff0000, v105
    v_fmac_f32 v60, v24, v4
    v_fmac_f32 v61, v24, v5
    v_lshlrev_b32 v4, 16, v106
    v_and_b32 v5, 0xffff0000, v106
    v_fmac_f32 v62, v24, v4
    v_fmac_f32 v63, v24, v5
    v_lshlrev_b32 v4, 16, v107
    v_and_b32 v5, 0xffff0000, v107
    v_fmac_f32 v64, v24, v4
    v_fmac_f32 v65, v24, v5
    v_lshlrev_b32 v4, 16, v108
    v_and_b32 v5, 0xffff0000, v108
    v_fmac_f32 v66, v24, v4
    v_fmac_f32 v67, v24, v5
    v_lshlrev_b32 v4, 16, v109
    v_and_b32 v5, 0xffff0000, v109
    v_fmac_f32 v68, v24, v4
    v_fmac_f32 v69, v24, v5
    v_lshlrev_b32 v4, 16, v110
    v_and_b32 v5, 0xffff0000, v110
    v_fmac_f32 v70, v24, v4
    v_fmac_f32 v71, v24, v5
    v_lshlrev_b32 v4, 16, v111
    v_and_b32 v5, 0xffff0000, v111
    v_fmac_f32 v72, v24, v4
    v_fmac_f32 v73, v24, v5
    v_lshlrev_b32 v4, 16, v112
    v_and_b32 v5, 0xffff0000, v112
    v_fmac_f32 v74, v24, v4
    v_fmac_f32 v75, v24, v5
    v_lshlrev_b32 v4, 16, v113
    v_and_b32 v5, 0xffff0000, v113
    v_fmac_f32 v76, v24, v4
    v_fmac_f32 v77, v24, v5
    s_mov_b32 s45, 18432
    buffer_load_dwordx4 v[102:105], v1, s[20:23], s45 offen offset:0 nt
    buffer_load_dwordx4 v[106:109], v1, s[20:23], s45 offen offset:128 nt
    buffer_load_dwordx4 v[110:113], v1, s[20:23], s45 offen offset:256 nt
    s_waitcnt vmcnt(9)
    v_lshlrev_b32 v4, 16, v114
    v_and_b32 v5, 0xffff0000, v114
    v_fmac_f32 v54, v25, v4
    v_fmac_f32 v55, v25, v5
    v_lshlrev_b32 v4, 16, v115
    v_and_b32 v5, 0xffff0000, v115
    v_fmac_f32 v56, v25, v4
    v_fmac_f32 v57, v25, v5
    v_lshlrev_b32 v4, 16, v116
    v_and_b32 v5, 0xffff0000, v116
    v_fmac_f32 v58, v25, v4
    v_fmac_f32 v59, v25, v5
    v_lshlrev_b32 v4, 16, v117
    v_and_b32 v5, 0xffff0000, v117
    v_fmac_f32 v60, v25, v4
    v_fmac_f32 v61, v25, v5
    v_lshlrev_b32 v4, 16, v118
    v_and_b32 v5, 0xffff0000, v118
    v_fmac_f32 v62, v25, v4
    v_fmac_f32 v63, v25, v5
    v_lshlrev_b32 v4, 16, v119
    v_and_b32 v5, 0xffff0000, v119
    v_fmac_f32 v64, v25, v4
    v_fmac_f32 v65, v25, v5
    v_lshlrev_b32 v4, 16, v120
    v_and_b32 v5, 0xffff0000, v120
    v_fmac_f32 v66, v25, v4
    v_fmac_f32 v67, v25, v5
    v_lshlrev_b32 v4, 16, v121
    v_and_b32 v5, 0xffff0000, v121
    v_fmac_f32 v68, v25, v4
    v_fmac_f32 v69, v25, v5
    v_lshlrev_b32 v4, 16, v122
    v_and_b32 v5, 0xffff0000, v122
    v_fmac_f32 v70, v25, v4
    v_fmac_f32 v71, v25, v5
    v_lshlrev_b32 v4, 16, v123
    v_and_b32 v5, 0xffff0000, v123
    v_fmac_f32 v72, v25, v4
    v_fmac_f32 v73, v25, v5
    v_lshlrev_b32 v4, 16, v124
    v_and_b32 v5, 0xffff0000, v124
    v_fmac_f32 v74, v25, v4
    v_fmac_f32 v75, v25, v5
    v_lshlrev_b32 v4, 16, v125
    v_and_b32 v5, 0xffff0000, v125
    v_fmac_f32 v76, v25, v4
    v_fmac_f32 v77, v25, v5
    s_mov_b32 s45, 21504
    buffer_load_dwordx4 v[114:117], v1, s[20:23], s45 offen offset:0 nt
    buffer_load_dwordx4 v[118:121], v1, s[20:23], s45 offen offset:128 nt
    buffer_load_dwordx4 v[122:125], v1, s[20:23], s45 offen offset:256 nt
    s_waitcnt vmcnt(9)
    v_lshlrev_b32 v4, 16, v78
    v_and_b32 v5, 0xffff0000, v78
    v_fmac_f32 v54, v26, v4
    v_fmac_f32 v55, v26, v5
    v_lshlrev_b32 v4, 16, v79
    v_and_b32 v5, 0xffff0000, v79
    v_fmac_f32 v56, v26, v4
    v_fmac_f32 v57, v26, v5
    v_lshlrev_b32 v4, 16, v80
    v_and_b32 v5, 0xffff0000, v80
    v_fmac_f32 v58, v26, v4
    v_fmac_f32 v59, v26, v5
    v_lshlrev_b32 v4, 16, v81
    v_and_b32 v5, 0xffff0000, v81
    v_fmac_f32 v60, v26, v4
    v_fmac_f32 v61, v26, v5
    v_lshlrev_b32 v4, 16, v82
    v_and_b32 v5, 0xffff0000, v82
    v_fmac_f32 v62, v26, v4
    v_fmac_f32 v63, v26, v5
    v_lshlrev_b32 v4, 16, v83
    v_and_b32 v5, 0xffff0000, v83
    v_fmac_f32 v64, v26, v4
    v_fmac_f32 v65, v26, v5
    v_lshlrev_b32 v4, 16, v84
    v_and_b32 v5, 0xffff0000, v84
    v_fmac_f32 v66, v26, v4
    v_fmac_f32 v67, v26, v5
    v_lshlrev_b32 v4, 16, v85
    v_and_b32 v5, 0xffff0000, v85
    v_fmac_f32 v68, v26, v4
    v_fmac_f32 v69, v26, v5
    v_lshlrev_b32 v4, 16, v86
    v_and_b32 v5, 0xffff0000, v86
    v_fmac_f32 v70, v26, v4
    v_fmac_f32 v71, v26, v5
    v_lshlrev_b32 v4, 16, v87
    v_and_b32 v5, 0xffff0000, v87
    v_fmac_f32 v72, v26, v4
    v_fmac_f32 v73, v26, v5
    v_lshlrev_b32 v4, 16, v88
    v_and_b32 v5, 0xffff0000, v88
    v_fmac_f32 v74, v26, v4
    v_fmac_f32 v75, v26, v5
    v_lshlrev_b32 v4, 16, v89
    v_and_b32 v5, 0xffff0000, v89
    v_fmac_f32 v76, v26, v4
    v_fmac_f32 v77, v26, v5
    s_mov_b32 s45, 24576
    buffer_load_dwordx4 v[78:81], v1, s[20:23], s45 offen offset:0 nt
    buffer_load_dwordx4 v[82:85], v1, s[20:23], s45 offen offset:128 nt
    buffer_load_dwordx4 v[86:89], v1, s[20:23], s45 offen offset:256 nt
    s_waitcnt vmcnt(9)
    v_lshlrev_b32 v4, 16, v90
    v_and_b32 v5, 0xffff0000, v90
    v_fmac_f32 v54, v27, v4
    v_fmac_f32 v55, v27, v5
    v_lshlrev_b32 v4, 16, v91
    v_and_b32 v5, 0xffff0000, v91
    v_fmac_f32 v56, v27, v4
    v_fmac_f32 v57, v27, v5
    v_lshlrev_b32 v4, 16, v92
    v_and_b32 v5, 0xffff0000, v92
    v_fmac_f32 v58, v27, v4
    v_fmac_f32 v59, v27, v5
    v_lshlrev_b32 v4, 16, v93
    v_and_b32 v5, 0xffff0000, v93
    v_fmac_f32 v60, v27, v4
    v_fmac_f32 v61, v27, v5
    v_lshlrev_b32 v4, 16, v94
    v_and_b32 v5, 0xffff0000, v94
    v_fmac_f32 v62, v27, v4
    v_fmac_f32 v63, v27, v5
    v_lshlrev_b32 v4, 16, v95
    v_and_b32 v5, 0xffff0000, v95
    v_fmac_f32 v64, v27, v4
    v_fmac_f32 v65, v27, v5
    v_lshlrev_b32 v4, 16, v96
    v_and_b32 v5, 0xffff0000, v96
    v_fmac_f32 v66, v27, v4
    v_fmac_f32 v67, v27, v5
    v_lshlrev_b32 v4, 16, v97
    v_and_b32 v5, 0xffff0000, v97
    v_fmac_f32 v68, v27, v4
    v_fmac_f32 v69, v27, v5
    v_lshlrev_b32 v4, 16, v98
    v_and_b32 v5, 0xffff0000, v98
    v_fmac_f32 v70, v27, v4
    v_fmac_f32 v71, v27, v5
    v_lshlrev_b32 v4, 16, v99
    v_and_b32 v5, 0xffff0000, v99
    v_fmac_f32 v72, v27, v4
    v_fmac_f32 v73, v27, v5
    v_lshlrev_b32 v4, 16, v100
    v_and_b32 v5, 0xffff0000, v100
    v_fmac_f32 v74, v27, v4
    v_fmac_f32 v75, v27, v5
    v_lshlrev_b32 v4, 16, v101
    v_and_b32 v5, 0xffff0000, v101
    v_fmac_f32 v76, v27, v4
    v_fmac_f32 v77, v27, v5
    s_mov_b32 s45, 27648
    buffer_load_dwordx4 v[90:93], v1, s[20:23], s45 offen offset:0 nt
    buffer_load_dwordx4 v[94:97], v1, s[20:23], s45 offen offset:128 nt
    buffer_load_dwordx4 v[98:101], v1, s[20:23], s45 offen offset:256 nt
    s_waitcnt vmcnt(9)
    v_lshlrev_b32 v4, 16, v102
    v_and_b32 v5, 0xffff0000, v102
    v_fmac_f32 v54, v28, v4
    v_fmac_f32 v55, v28, v5
    v_lshlrev_b32 v4, 16, v103
    v_and_b32 v5, 0xffff0000, v103
    v_fmac_f32 v56, v28, v4
    v_fmac_f32 v57, v28, v5
    v_lshlrev_b32 v4, 16, v104
    v_and_b32 v5, 0xffff0000, v104
    v_fmac_f32 v58, v28, v4
    v_fmac_f32 v59, v28, v5
    v_lshlrev_b32 v4, 16, v105
    v_and_b32 v5, 0xffff0000, v105
    v_fmac_f32 v60, v28, v4
    v_fmac_f32 v61, v28, v5
    v_lshlrev_b32 v4, 16, v106
    v_and_b32 v5, 0xffff0000, v106
    v_fmac_f32 v62, v28, v4
    v_fmac_f32 v63, v28, v5
    v_lshlrev_b32 v4, 16, v107
    v_and_b32 v5, 0xffff0000, v107
    v_fmac_f32 v64, v28, v4
    v_fmac_f32 v65, v28, v5
    v_lshlrev_b32 v4, 16, v108
    v_and_b32 v5, 0xffff0000, v108
    v_fmac_f32 v66, v28, v4
    v_fmac_f32 v67, v28, v5
    v_lshlrev_b32 v4, 16, v109
    v_and_b32 v5, 0xffff0000, v109
    v_fmac_f32 v68, v28, v4
    v_fmac_f32 v69, v28, v5
    v_lshlrev_b32 v4, 16, v110
    v_and_b32 v5, 0xffff0000, v110
    v_fmac_f32 v70, v28, v4
    v_fmac_f32 v71, v28, v5
    v_lshlrev_b32 v4, 16, v111
    v_and_b32 v5, 0xffff0000, v111
    v_fmac_f32 v72, v28, v4
    v_fmac_f32 v73, v28, v5
    v_lshlrev_b32 v4, 16, v112
    v_and_b32 v5, 0xffff0000, v112
    v_fmac_f32 v74, v28, v4
    v_fmac_f32 v75, v28, v5
    v_lshlrev_b32 v4, 16, v113
    v_and_b32 v5, 0xffff0000, v113
    v_fmac_f32 v76, v28, v4
    v_fmac_f32 v77, v28, v5
    s_mov_b32 s45, 30720
    buffer_load_dwordx4 v[102:105], v1, s[20:23], s45 offen offset:0 nt
    buffer_load_dwordx4 v[106:109], v1, s[20:23], s45 offen offset:128 nt
    buffer_load_dwordx4 v[110:113], v1, s[20:23], s45 offen offset:256 nt
    s_waitcnt vmcnt(9)
    v_lshlrev_b32 v4, 16, v114
    v_and_b32 v5, 0xffff0000, v114
    v_fmac_f32 v54, v29, v4
    v_fmac_f32 v55, v29, v5
    v_lshlrev_b32 v4, 16, v115
    v_and_b32 v5, 0xffff0000, v115
    v_fmac_f32 v56, v29, v4
    v_fmac_f32 v57, v29, v5
    v_lshlrev_b32 v4, 16, v116
    v_and_b32 v5, 0xffff0000, v116
    v_fmac_f32 v58, v29, v4
    v_fmac_f32 v59, v29, v5
    v_lshlrev_b32 v4, 16, v117
    v_and_b32 v5, 0xffff0000, v117
    v_fmac_f32 v60, v29, v4
    v_fmac_f32 v61, v29, v5
    v_lshlrev_b32 v4, 16, v118
    v_and_b32 v5, 0xffff0000, v118
    v_fmac_f32 v62, v29, v4
    v_fmac_f32 v63, v29, v5
    v_lshlrev_b32 v4, 16, v119
    v_and_b32 v5, 0xffff0000, v119
    v_fmac_f32 v64, v29, v4
    v_fmac_f32 v65, v29, v5
    v_lshlrev_b32 v4, 16, v120
    v_and_b32 v5, 0xffff0000, v120
    v_fmac_f32 v66, v29, v4
    v_fmac_f32 v67, v29, v5
    v_lshlrev_b32 v4, 16, v121
    v_and_b32 v5, 0xffff0000, v121
    v_fmac_f32 v68, v29, v4
    v_fmac_f32 v69, v29, v5
    v_lshlrev_b32 v4, 16, v122
    v_and_b32 v5, 0xffff0000, v122
    v_fmac_f32 v70, v29, v4
    v_fmac_f32 v71, v29, v5
    v_lshlrev_b32 v4, 16, v123
    v_and_b32 v5, 0xffff0000, v123
    v_fmac_f32 v72, v29, v4
    v_fmac_f32 v73, v29, v5
    v_lshlrev_b32 v4, 16, v124
    v_and_b32 v5, 0xffff0000, v124
    v_fmac_f32 v74, v29, v4
    v_fmac_f32 v75, v29, v5
    v_lshlrev_b32 v4, 16, v125
    v_and_b32 v5, 0xffff0000, v125
    v_fmac_f32 v76, v29, v4
    v_fmac_f32 v77, v29, v5
    s_mov_b32 s45, 33792
    buffer_load_dwordx4 v[114:117], v1, s[20:23], s45 offen offset:0 nt
    buffer_load_dwordx4 v[118:121], v1, s[20:23], s45 offen offset:128 nt
    buffer_load_dwordx4 v[122:125], v1, s[20:23], s45 offen offset:256 nt
    s_waitcnt vmcnt(9)
    v_lshlrev_b32 v4, 16, v78
    v_and_b32 v5, 0xffff0000, v78
    v_fmac_f32 v54, v30, v4
    v_fmac_f32 v55, v30, v5
    v_lshlrev_b32 v4, 16, v79
    v_and_b32 v5, 0xffff0000, v79
    v_fmac_f32 v56, v30, v4
    v_fmac_f32 v57, v30, v5
    v_lshlrev_b32 v4, 16, v80
    v_and_b32 v5, 0xffff0000, v80
    v_fmac_f32 v58, v30, v4
    v_fmac_f32 v59, v30, v5
    v_lshlrev_b32 v4, 16, v81
    v_and_b32 v5, 0xffff0000, v81
    v_fmac_f32 v60, v30, v4
    v_fmac_f32 v61, v30, v5
    v_lshlrev_b32 v4, 16, v82
    v_and_b32 v5, 0xffff0000, v82
    v_fmac_f32 v62, v30, v4
    v_fmac_f32 v63, v30, v5
    v_lshlrev_b32 v4, 16, v83
    v_and_b32 v5, 0xffff0000, v83
    v_fmac_f32 v64, v30, v4
    v_fmac_f32 v65, v30, v5
    v_lshlrev_b32 v4, 16, v84
    v_and_b32 v5, 0xffff0000, v84
    v_fmac_f32 v66, v30, v4
    v_fmac_f32 v67, v30, v5
    v_lshlrev_b32 v4, 16, v85
    v_and_b32 v5, 0xffff0000, v85
    v_fmac_f32 v68, v30, v4
    v_fmac_f32 v69, v30, v5
    v_lshlrev_b32 v4, 16, v86
    v_and_b32 v5, 0xffff0000, v86
    v_fmac_f32 v70, v30, v4
    v_fmac_f32 v71, v30, v5
    v_lshlrev_b32 v4, 16, v87
    v_and_b32 v5, 0xffff0000, v87
    v_fmac_f32 v72, v30, v4
    v_fmac_f32 v73, v30, v5
    v_lshlrev_b32 v4, 16, v88
    v_and_b32 v5, 0xffff0000, v88
    v_fmac_f32 v74, v30, v4
    v_fmac_f32 v75, v30, v5
    v_lshlrev_b32 v4, 16, v89
    v_and_b32 v5, 0xffff0000, v89
    v_fmac_f32 v76, v30, v4
    v_fmac_f32 v77, v30, v5
    s_mov_b32 s45, 36864
    buffer_load_dwordx4 v[78:81], v1, s[20:23], s45 offen offset:0 nt
    buffer_load_dwordx4 v[82:85], v1, s[20:23], s45 offen offset:128 nt
    buffer_load_dwordx4 v[86:89], v1, s[20:23], s45 offen offset:256 nt
    s_waitcnt vmcnt(9)
    v_lshlrev_b32 v4, 16, v90
    v_and_b32 v5, 0xffff0000, v90
    v_fmac_f32 v54, v31, v4
    v_fmac_f32 v55, v31, v5
    v_lshlrev_b32 v4, 16, v91
    v_and_b32 v5, 0xffff0000, v91
    v_fmac_f32 v56, v31, v4
    v_fmac_f32 v57, v31, v5
    v_lshlrev_b32 v4, 16, v92
    v_and_b32 v5, 0xffff0000, v92
    v_fmac_f32 v58, v31, v4
    v_fmac_f32 v59, v31, v5
    v_lshlrev_b32 v4, 16, v93
    v_and_b32 v5, 0xffff0000, v93
    v_fmac_f32 v60, v31, v4
    v_fmac_f32 v61, v31, v5
    v_lshlrev_b32 v4, 16, v94
    v_and_b32 v5, 0xffff0000, v94
    v_fmac_f32 v62, v31, v4
    v_fmac_f32 v63, v31, v5
    v_lshlrev_b32 v4, 16, v95
    v_and_b32 v5, 0xffff0000, v95
    v_fmac_f32 v64, v31, v4
    v_fmac_f32 v65, v31, v5
    v_lshlrev_b32 v4, 16, v96
    v_and_b32 v5, 0xffff0000, v96
    v_fmac_f32 v66, v31, v4
    v_fmac_f32 v67, v31, v5
    v_lshlrev_b32 v4, 16, v97
    v_and_b32 v5, 0xffff0000, v97
    v_fmac_f32 v68, v31, v4
    v_fmac_f32 v69, v31, v5
    v_lshlrev_b32 v4, 16, v98
    v_and_b32 v5, 0xffff0000, v98
    v_fmac_f32 v70, v31, v4
    v_fmac_f32 v71, v31, v5
    v_lshlrev_b32 v4, 16, v99
    v_and_b32 v5, 0xffff0000, v99
    v_fmac_f32 v72, v31, v4
    v_fmac_f32 v73, v31, v5
    v_lshlrev_b32 v4, 16, v100
    v_and_b32 v5, 0xffff0000, v100
    v_fmac_f32 v74, v31, v4
    v_fmac_f32 v75, v31, v5
    v_lshlrev_b32 v4, 16, v101
    v_and_b32 v5, 0xffff0000, v101
    v_fmac_f32 v76, v31, v4
    v_fmac_f32 v77, v31, v5
    s_mov_b32 s45, 39936
    buffer_load_dwordx4 v[90:93], v1, s[20:23], s45 offen offset:0 nt
    buffer_load_dwordx4 v[94:97], v1, s[20:23], s45 offen offset:128 nt
    buffer_load_dwordx4 v[98:101], v1, s[20:23], s45 offen offset:256 nt
    s_waitcnt vmcnt(9)
    v_lshlrev_b32 v4, 16, v102
    v_and_b32 v5, 0xffff0000, v102
    v_fmac_f32 v54, v32, v4
    v_fmac_f32 v55, v32, v5
    v_lshlrev_b32 v4, 16, v103
    v_and_b32 v5, 0xffff0000, v103
    v_fmac_f32 v56, v32, v4
    v_fmac_f32 v57, v32, v5
    v_lshlrev_b32 v4, 16, v104
    v_and_b32 v5, 0xffff0000, v104
    v_fmac_f32 v58, v32, v4
    v_fmac_f32 v59, v32, v5
    v_lshlrev_b32 v4, 16, v105
    v_and_b32 v5, 0xffff0000, v105
    v_fmac_f32 v60, v32, v4
    v_fmac_f32 v61, v32, v5
    v_lshlrev_b32 v4, 16, v106
    v_and_b32 v5, 0xffff0000, v106
    v_fmac_f32 v62, v32, v4
    v_fmac_f32 v63, v32, v5
    v_lshlrev_b32 v4, 16, v107
    v_and_b32 v5, 0xffff0000, v107
    v_fmac_f32 v64, v32, v4
    v_fmac_f32 v65, v32, v5
    v_lshlrev_b32 v4, 16, v108
    v_and_b32 v5, 0xffff0000, v108
    v_fmac_f32 v66, v32, v4
    v_fmac_f32 v67, v32, v5
    v_lshlrev_b32 v4, 16, v109
    v_and_b32 v5, 0xffff0000, v109
    v_fmac_f32 v68, v32, v4
    v_fmac_f32 v69, v32, v5
    v_lshlrev_b32 v4, 16, v110
    v_and_b32 v5, 0xffff0000, v110
    v_fmac_f32 v70, v32, v4
    v_fmac_f32 v71, v32, v5
    v_lshlrev_b32 v4, 16, v111
    v_and_b32 v5, 0xffff0000, v111
    v_fmac_f32 v72, v32, v4
    v_fmac_f32 v73, v32, v5
    v_lshlrev_b32 v4, 16, v112
    v_and_b32 v5, 0xffff0000, v112
    v_fmac_f32 v74, v32, v4
    v_fmac_f32 v75, v32, v5
    v_lshlrev_b32 v4, 16, v113
    v_and_b32 v5, 0xffff0000, v113
    v_fmac_f32 v76, v32, v4
    v_fmac_f32 v77, v32, v5
    s_mov_b32 s45, 43008
    buffer_load_dwordx4 v[102:105], v1, s[20:23], s45 offen offset:0 nt
    buffer_load_dwordx4 v[106:109], v1, s[20:23], s45 offen offset:128 nt
    buffer_load_dwordx4 v[110:113], v1, s[20:23], s45 offen offset:256 nt
    s_waitcnt vmcnt(9)
    v_lshlrev_b32 v4, 16, v114
    v_and_b32 v5, 0xffff0000, v114
    v_fmac_f32 v54, v33, v4
    v_fmac_f32 v55, v33, v5
    v_lshlrev_b32 v4, 16, v115
    v_and_b32 v5, 0xffff0000, v115
    v_fmac_f32 v56, v33, v4
    v_fmac_f32 v57, v33, v5
    v_lshlrev_b32 v4, 16, v116
    v_and_b32 v5, 0xffff0000, v116
    v_fmac_f32 v58, v33, v4
    v_fmac_f32 v59, v33, v5
    v_lshlrev_b32 v4, 16, v117
    v_and_b32 v5, 0xffff0000, v117
    v_fmac_f32 v60, v33, v4
    v_fmac_f32 v61, v33, v5
    v_lshlrev_b32 v4, 16, v118
    v_and_b32 v5, 0xffff0000, v118
    v_fmac_f32 v62, v33, v4
    v_fmac_f32 v63, v33, v5
    v_lshlrev_b32 v4, 16, v119
    v_and_b32 v5, 0xffff0000, v119
    v_fmac_f32 v64, v33, v4
    v_fmac_f32 v65, v33, v5
    v_lshlrev_b32 v4, 16, v120
    v_and_b32 v5, 0xffff0000, v120
    v_fmac_f32 v66, v33, v4
    v_fmac_f32 v67, v33, v5
    v_lshlrev_b32 v4, 16, v121
    v_and_b32 v5, 0xffff0000, v121
    v_fmac_f32 v68, v33, v4
    v_fmac_f32 v69, v33, v5
    v_lshlrev_b32 v4, 16, v122
    v_and_b32 v5, 0xffff0000, v122
    v_fmac_f32 v70, v33, v4
    v_fmac_f32 v71, v33, v5
    v_lshlrev_b32 v4, 16, v123
    v_and_b32 v5, 0xffff0000, v123
    v_fmac_f32 v72, v33, v4
    v_fmac_f32 v73, v33, v5
    v_lshlrev_b32 v4, 16, v124
    v_and_b32 v5, 0xffff0000, v124
    v_fmac_f32 v74, v33, v4
    v_fmac_f32 v75, v33, v5
    v_lshlrev_b32 v4, 16, v125
    v_and_b32 v5, 0xffff0000, v125
    v_fmac_f32 v76, v33, v4
    v_fmac_f32 v77, v33, v5
    s_mov_b32 s45, 46080
    buffer_load_dwordx4 v[114:117], v1, s[20:23], s45 offen offset:0 nt
    buffer_load_dwordx4 v[118:121], v1, s[20:23], s45 offen offset:128 nt
    buffer_load_dwordx4 v[122:125], v1, s[20:23], s45 offen offset:256 nt
    s_waitcnt vmcnt(9)
    v_lshlrev_b32 v4, 16, v78
    v_and_b32 v5, 0xffff0000, v78
    v_fmac_f32 v54, v34, v4
    v_fmac_f32 v55, v34, v5
    v_lshlrev_b32 v4, 16, v79
    v_and_b32 v5, 0xffff0000, v79
    v_fmac_f32 v56, v34, v4
    v_fmac_f32 v57, v34, v5
    v_lshlrev_b32 v4, 16, v80
    v_and_b32 v5, 0xffff0000, v80
    v_fmac_f32 v58, v34, v4
    v_fmac_f32 v59, v34, v5
    v_lshlrev_b32 v4, 16, v81
    v_and_b32 v5, 0xffff0000, v81
    v_fmac_f32 v60, v34, v4
    v_fmac_f32 v61, v34, v5
    v_lshlrev_b32 v4, 16, v82
    v_and_b32 v5, 0xffff0000, v82
    v_fmac_f32 v62, v34, v4
    v_fmac_f32 v63, v34, v5
    v_lshlrev_b32 v4, 16, v83
    v_and_b32 v5, 0xffff0000, v83
    v_fmac_f32 v64, v34, v4
    v_fmac_f32 v65, v34, v5
    v_lshlrev_b32 v4, 16, v84
    v_and_b32 v5, 0xffff0000, v84
    v_fmac_f32 v66, v34, v4
    v_fmac_f32 v67, v34, v5
    v_lshlrev_b32 v4, 16, v85
    v_and_b32 v5, 0xffff0000, v85
    v_fmac_f32 v68, v34, v4
    v_fmac_f32 v69, v34, v5
    v_lshlrev_b32 v4, 16, v86
    v_and_b32 v5, 0xffff0000, v86
    v_fmac_f32 v70, v34, v4
    v_fmac_f32 v71, v34, v5
    v_lshlrev_b32 v4, 16, v87
    v_and_b32 v5, 0xffff0000, v87
    v_fmac_f32 v72, v34, v4
    v_fmac_f32 v73, v34, v5
    v_lshlrev_b32 v4, 16, v88
    v_and_b32 v5, 0xffff0000, v88
    v_fmac_f32 v74, v34, v4
    v_fmac_f32 v75, v34, v5
    v_lshlrev_b32 v4, 16, v89
    v_and_b32 v5, 0xffff0000, v89
    v_fmac_f32 v76, v34, v4
    v_fmac_f32 v77, v34, v5
    s_mov_b32 s45, 49152
    buffer_load_dwordx4 v[78:81], v1, s[20:23], s45 offen offset:0 nt
    buffer_load_dwordx4 v[82:85], v1, s[20:23], s45 offen offset:128 nt
    buffer_load_dwordx4 v[86:89], v1, s[20:23], s45 offen offset:256 nt
    s_waitcnt vmcnt(9)
    v_lshlrev_b32 v4, 16, v90
    v_and_b32 v5, 0xffff0000, v90
    v_fmac_f32 v54, v35, v4
    v_fmac_f32 v55, v35, v5
    v_lshlrev_b32 v4, 16, v91
    v_and_b32 v5, 0xffff0000, v91
    v_fmac_f32 v56, v35, v4
    v_fmac_f32 v57, v35, v5
    v_lshlrev_b32 v4, 16, v92
    v_and_b32 v5, 0xffff0000, v92
    v_fmac_f32 v58, v35, v4
    v_fmac_f32 v59, v35, v5
    v_lshlrev_b32 v4, 16, v93
    v_and_b32 v5, 0xffff0000, v93
    v_fmac_f32 v60, v35, v4
    v_fmac_f32 v61, v35, v5
    v_lshlrev_b32 v4, 16, v94
    v_and_b32 v5, 0xffff0000, v94
    v_fmac_f32 v62, v35, v4
    v_fmac_f32 v63, v35, v5
    v_lshlrev_b32 v4, 16, v95
    v_and_b32 v5, 0xffff0000, v95
    v_fmac_f32 v64, v35, v4
    v_fmac_f32 v65, v35, v5
    v_lshlrev_b32 v4, 16, v96
    v_and_b32 v5, 0xffff0000, v96
    v_fmac_f32 v66, v35, v4
    v_fmac_f32 v67, v35, v5
    v_lshlrev_b32 v4, 16, v97
    v_and_b32 v5, 0xffff0000, v97
    v_fmac_f32 v68, v35, v4
    v_fmac_f32 v69, v35, v5
    v_lshlrev_b32 v4, 16, v98
    v_and_b32 v5, 0xffff0000, v98
    v_fmac_f32 v70, v35, v4
    v_fmac_f32 v71, v35, v5
    v_lshlrev_b32 v4, 16, v99
    v_and_b32 v5, 0xffff0000, v99
    v_fmac_f32 v72, v35, v4
    v_fmac_f32 v73, v35, v5
    v_lshlrev_b32 v4, 16, v100
    v_and_b32 v5, 0xffff0000, v100
    v_fmac_f32 v74, v35, v4
    v_fmac_f32 v75, v35, v5
    v_lshlrev_b32 v4, 16, v101
    v_and_b32 v5, 0xffff0000, v101
    v_fmac_f32 v76, v35, v4
    v_fmac_f32 v77, v35, v5
    s_mov_b32 s45, 52224
    buffer_load_dwordx4 v[90:93], v1, s[20:23], s45 offen offset:0 nt
    buffer_load_dwordx4 v[94:97], v1, s[20:23], s45 offen offset:128 nt
    buffer_load_dwordx4 v[98:101], v1, s[20:23], s45 offen offset:256 nt
    s_waitcnt vmcnt(9)
    v_lshlrev_b32 v4, 16, v102
    v_and_b32 v5, 0xffff0000, v102
    v_fmac_f32 v54, v36, v4
    v_fmac_f32 v55, v36, v5
    v_lshlrev_b32 v4, 16, v103
    v_and_b32 v5, 0xffff0000, v103
    v_fmac_f32 v56, v36, v4
    v_fmac_f32 v57, v36, v5
    v_lshlrev_b32 v4, 16, v104
    v_and_b32 v5, 0xffff0000, v104
    v_fmac_f32 v58, v36, v4
    v_fmac_f32 v59, v36, v5
    v_lshlrev_b32 v4, 16, v105
    v_and_b32 v5, 0xffff0000, v105
    v_fmac_f32 v60, v36, v4
    v_fmac_f32 v61, v36, v5
    v_lshlrev_b32 v4, 16, v106
    v_and_b32 v5, 0xffff0000, v106
    v_fmac_f32 v62, v36, v4
    v_fmac_f32 v63, v36, v5
    v_lshlrev_b32 v4, 16, v107
    v_and_b32 v5, 0xffff0000, v107
    v_fmac_f32 v64, v36, v4
    v_fmac_f32 v65, v36, v5
    v_lshlrev_b32 v4, 16, v108
    v_and_b32 v5, 0xffff0000, v108
    v_fmac_f32 v66, v36, v4
    v_fmac_f32 v67, v36, v5
    v_lshlrev_b32 v4, 16, v109
    v_and_b32 v5, 0xffff0000, v109
    v_fmac_f32 v68, v36, v4
    v_fmac_f32 v69, v36, v5
    v_lshlrev_b32 v4, 16, v110
    v_and_b32 v5, 0xffff0000, v110
    v_fmac_f32 v70, v36, v4
    v_fmac_f32 v71, v36, v5
    v_lshlrev_b32 v4, 16, v111
    v_and_b32 v5, 0xffff0000, v111
    v_fmac_f32 v72, v36, v4
    v_fmac_f32 v73, v36, v5
    v_lshlrev_b32 v4, 16, v112
    v_and_b32 v5, 0xffff0000, v112
    v_fmac_f32 v74, v36, v4
    v_fmac_f32 v75, v36, v5
    v_lshlrev_b32 v4, 16, v113
    v_and_b32 v5, 0xffff0000, v113
    v_fmac_f32 v76, v36, v4
    v_fmac_f32 v77, v36, v5
    s_mov_b32 s45, 55296
    buffer_load_dwordx4 v[102:105], v1, s[20:23], s45 offen offset:0 nt
    buffer_load_dwordx4 v[106:109], v1, s[20:23], s45 offen offset:128 nt
    buffer_load_dwordx4 v[110:113], v1, s[20:23], s45 offen offset:256 nt
    s_waitcnt vmcnt(9)
    v_lshlrev_b32 v4, 16, v114
    v_and_b32 v5, 0xffff0000, v114
    v_fmac_f32 v54, v37, v4
    v_fmac_f32 v55, v37, v5
    v_lshlrev_b32 v4, 16, v115
    v_and_b32 v5, 0xffff0000, v115
    v_fmac_f32 v56, v37, v4
    v_fmac_f32 v57, v37, v5
    v_lshlrev_b32 v4, 16, v116
    v_and_b32 v5, 0xffff0000, v116
    v_fmac_f32 v58, v37, v4
    v_fmac_f32 v59, v37, v5
    v_lshlrev_b32 v4, 16, v117
    v_and_b32 v5, 0xffff0000, v117
    v_fmac_f32 v60, v37, v4
    v_fmac_f32 v61, v37, v5
    v_lshlrev_b32 v4, 16, v118
    v_and_b32 v5, 0xffff0000, v118
    v_fmac_f32 v62, v37, v4
    v_fmac_f32 v63, v37, v5
    v_lshlrev_b32 v4, 16, v119
    v_and_b32 v5, 0xffff0000, v119
    v_fmac_f32 v64, v37, v4
    v_fmac_f32 v65, v37, v5
    v_lshlrev_b32 v4, 16, v120
    v_and_b32 v5, 0xffff0000, v120
    v_fmac_f32 v66, v37, v4
    v_fmac_f32 v67, v37, v5
    v_lshlrev_b32 v4, 16, v121
    v_and_b32 v5, 0xffff0000, v121
    v_fmac_f32 v68, v37, v4
    v_fmac_f32 v69, v37, v5
    v_lshlrev_b32 v4, 16, v122
    v_and_b32 v5, 0xffff0000, v122
    v_fmac_f32 v70, v37, v4
    v_fmac_f32 v71, v37, v5
    v_lshlrev_b32 v4, 16, v123
    v_and_b32 v5, 0xffff0000, v123
    v_fmac_f32 v72, v37, v4
    v_fmac_f32 v73, v37, v5
    v_lshlrev_b32 v4, 16, v124
    v_and_b32 v5, 0xffff0000, v124
    v_fmac_f32 v74, v37, v4
    v_fmac_f32 v75, v37, v5
    v_lshlrev_b32 v4, 16, v125
    v_and_b32 v5, 0xffff0000, v125
    v_fmac_f32 v76, v37, v4
    v_fmac_f32 v77, v37, v5
    s_mov_b32 s45, 58368
    buffer_load_dwordx4 v[114:117], v1, s[20:23], s45 offen offset:0 nt
    buffer_load_dwordx4 v[118:121], v1, s[20:23], s45 offen offset:128 nt
    buffer_load_dwordx4 v[122:125], v1, s[20:23], s45 offen offset:256 nt
    s_waitcnt vmcnt(9)
    v_lshlrev_b32 v4, 16, v78
    v_and_b32 v5, 0xffff0000, v78
    v_fmac_f32 v54, v38, v4
    v_fmac_f32 v55, v38, v5
    v_lshlrev_b32 v4, 16, v79
    v_and_b32 v5, 0xffff0000, v79
    v_fmac_f32 v56, v38, v4
    v_fmac_f32 v57, v38, v5
    v_lshlrev_b32 v4, 16, v80
    v_and_b32 v5, 0xffff0000, v80
    v_fmac_f32 v58, v38, v4
    v_fmac_f32 v59, v38, v5
    v_lshlrev_b32 v4, 16, v81
    v_and_b32 v5, 0xffff0000, v81
    v_fmac_f32 v60, v38, v4
    v_fmac_f32 v61, v38, v5
    v_lshlrev_b32 v4, 16, v82
    v_and_b32 v5, 0xffff0000, v82
    v_fmac_f32 v62, v38, v4
    v_fmac_f32 v63, v38, v5
    v_lshlrev_b32 v4, 16, v83
    v_and_b32 v5, 0xffff0000, v83
    v_fmac_f32 v64, v38, v4
    v_fmac_f32 v65, v38, v5
    v_lshlrev_b32 v4, 16, v84
    v_and_b32 v5, 0xffff0000, v84
    v_fmac_f32 v66, v38, v4
    v_fmac_f32 v67, v38, v5
    v_lshlrev_b32 v4, 16, v85
    v_and_b32 v5, 0xffff0000, v85
    v_fmac_f32 v68, v38, v4
    v_fmac_f32 v69, v38, v5
    v_lshlrev_b32 v4, 16, v86
    v_and_b32 v5, 0xffff0000, v86
    v_fmac_f32 v70, v38, v4
    v_fmac_f32 v71, v38, v5
    v_lshlrev_b32 v4, 16, v87
    v_and_b32 v5, 0xffff0000, v87
    v_fmac_f32 v72, v38, v4
    v_fmac_f32 v73, v38, v5
    v_lshlrev_b32 v4, 16, v88
    v_and_b32 v5, 0xffff0000, v88
    v_fmac_f32 v74, v38, v4
    v_fmac_f32 v75, v38, v5
    v_lshlrev_b32 v4, 16, v89
    v_and_b32 v5, 0xffff0000, v89
    v_fmac_f32 v76, v38, v4
    v_fmac_f32 v77, v38, v5
    s_mov_b32 s45, 61440
    buffer_load_dwordx4 v[78:81], v1, s[20:23], s45 offen offset:0 nt
    buffer_load_dwordx4 v[82:85], v1, s[20:23], s45 offen offset:128 nt
    buffer_load_dwordx4 v[86:89], v1, s[20:23], s45 offen offset:256 nt
    s_waitcnt vmcnt(9)
    v_lshlrev_b32 v4, 16, v90
    v_and_b32 v5, 0xffff0000, v90
    v_fmac_f32 v54, v39, v4
    v_fmac_f32 v55, v39, v5
    v_lshlrev_b32 v4, 16, v91
    v_and_b32 v5, 0xffff0000, v91
    v_fmac_f32 v56, v39, v4
    v_fmac_f32 v57, v39, v5
    v_lshlrev_b32 v4, 16, v92
    v_and_b32 v5, 0xffff0000, v92
    v_fmac_f32 v58, v39, v4
    v_fmac_f32 v59, v39, v5
    v_lshlrev_b32 v4, 16, v93
    v_and_b32 v5, 0xffff0000, v93
    v_fmac_f32 v60, v39, v4
    v_fmac_f32 v61, v39, v5
    v_lshlrev_b32 v4, 16, v94
    v_and_b32 v5, 0xffff0000, v94
    v_fmac_f32 v62, v39, v4
    v_fmac_f32 v63, v39, v5
    v_lshlrev_b32 v4, 16, v95
    v_and_b32 v5, 0xffff0000, v95
    v_fmac_f32 v64, v39, v4
    v_fmac_f32 v65, v39, v5
    v_lshlrev_b32 v4, 16, v96
    v_and_b32 v5, 0xffff0000, v96
    v_fmac_f32 v66, v39, v4
    v_fmac_f32 v67, v39, v5
    v_lshlrev_b32 v4, 16, v97
    v_and_b32 v5, 0xffff0000, v97
    v_fmac_f32 v68, v39, v4
    v_fmac_f32 v69, v39, v5
    v_lshlrev_b32 v4, 16, v98
    v_and_b32 v5, 0xffff0000, v98
    v_fmac_f32 v70, v39, v4
    v_fmac_f32 v71, v39, v5
    v_lshlrev_b32 v4, 16, v99
    v_and_b32 v5, 0xffff0000, v99
    v_fmac_f32 v72, v39, v4
    v_fmac_f32 v73, v39, v5
    v_lshlrev_b32 v4, 16, v100
    v_and_b32 v5, 0xffff0000, v100
    v_fmac_f32 v74, v39, v4
    v_fmac_f32 v75, v39, v5
    v_lshlrev_b32 v4, 16, v101
    v_and_b32 v5, 0xffff0000, v101
    v_fmac_f32 v76, v39, v4
    v_fmac_f32 v77, v39, v5
    s_mov_b32 s45, 64512
    buffer_load_dwordx4 v[90:93], v1, s[20:23], s45 offen offset:0 nt
    buffer_load_dwordx4 v[94:97], v1, s[20:23], s45 offen offset:128 nt
    buffer_load_dwordx4 v[98:101], v1, s[20:23], s45 offen offset:256 nt
    s_waitcnt vmcnt(9)
    v_lshlrev_b32 v4, 16, v102
    v_and_b32 v5, 0xffff0000, v102
    v_fmac_f32 v54, v40, v4
    v_fmac_f32 v55, v40, v5
    v_lshlrev_b32 v4, 16, v103
    v_and_b32 v5, 0xffff0000, v103
    v_fmac_f32 v56, v40, v4
    v_fmac_f32 v57, v40, v5
    v_lshlrev_b32 v4, 16, v104
    v_and_b32 v5, 0xffff0000, v104
    v_fmac_f32 v58, v40, v4
    v_fmac_f32 v59, v40, v5
    v_lshlrev_b32 v4, 16, v105
    v_and_b32 v5, 0xffff0000, v105
    v_fmac_f32 v60, v40, v4
    v_fmac_f32 v61, v40, v5
    v_lshlrev_b32 v4, 16, v106
    v_and_b32 v5, 0xffff0000, v106
    v_fmac_f32 v62, v40, v4
    v_fmac_f32 v63, v40, v5
    v_lshlrev_b32 v4, 16, v107
    v_and_b32 v5, 0xffff0000, v107
    v_fmac_f32 v64, v40, v4
    v_fmac_f32 v65, v40, v5
    v_lshlrev_b32 v4, 16, v108
    v_and_b32 v5, 0xffff0000, v108
    v_fmac_f32 v66, v40, v4
    v_fmac_f32 v67, v40, v5
    v_lshlrev_b32 v4, 16, v109
    v_and_b32 v5, 0xffff0000, v109
    v_fmac_f32 v68, v40, v4
    v_fmac_f32 v69, v40, v5
    v_lshlrev_b32 v4, 16, v110
    v_and_b32 v5, 0xffff0000, v110
    v_fmac_f32 v70, v40, v4
    v_fmac_f32 v71, v40, v5
    v_lshlrev_b32 v4, 16, v111
    v_and_b32 v5, 0xffff0000, v111
    v_fmac_f32 v72, v40, v4
    v_fmac_f32 v73, v40, v5
    v_lshlrev_b32 v4, 16, v112
    v_and_b32 v5, 0xffff0000, v112
    v_fmac_f32 v74, v40, v4
    v_fmac_f32 v75, v40, v5
    v_lshlrev_b32 v4, 16, v113
    v_and_b32 v5, 0xffff0000, v113
    v_fmac_f32 v76, v40, v4
    v_fmac_f32 v77, v40, v5
    s_mov_b32 s45, 67584
    buffer_load_dwordx4 v[102:105], v1, s[20:23], s45 offen offset:0 nt
    buffer_load_dwordx4 v[106:109], v1, s[20:23], s45 offen offset:128 nt
    buffer_load_dwordx4 v[110:113], v1, s[20:23], s45 offen offset:256 nt
    s_waitcnt vmcnt(9)
    v_lshlrev_b32 v4, 16, v114
    v_and_b32 v5, 0xffff0000, v114
    v_fmac_f32 v54, v41, v4
    v_fmac_f32 v55, v41, v5
    v_lshlrev_b32 v4, 16, v115
    v_and_b32 v5, 0xffff0000, v115
    v_fmac_f32 v56, v41, v4
    v_fmac_f32 v57, v41, v5
    v_lshlrev_b32 v4, 16, v116
    v_and_b32 v5, 0xffff0000, v116
    v_fmac_f32 v58, v41, v4
    v_fmac_f32 v59, v41, v5
    v_lshlrev_b32 v4, 16, v117
    v_and_b32 v5, 0xffff0000, v117
    v_fmac_f32 v60, v41, v4
    v_fmac_f32 v61, v41, v5
    v_lshlrev_b32 v4, 16, v118
    v_and_b32 v5, 0xffff0000, v118
    v_fmac_f32 v62, v41, v4
    v_fmac_f32 v63, v41, v5
    v_lshlrev_b32 v4, 16, v119
    v_and_b32 v5, 0xffff0000, v119
    v_fmac_f32 v64, v41, v4
    v_fmac_f32 v65, v41, v5
    v_lshlrev_b32 v4, 16, v120
    v_and_b32 v5, 0xffff0000, v120
    v_fmac_f32 v66, v41, v4
    v_fmac_f32 v67, v41, v5
    v_lshlrev_b32 v4, 16, v121
    v_and_b32 v5, 0xffff0000, v121
    v_fmac_f32 v68, v41, v4
    v_fmac_f32 v69, v41, v5
    v_lshlrev_b32 v4, 16, v122
    v_and_b32 v5, 0xffff0000, v122
    v_fmac_f32 v70, v41, v4
    v_fmac_f32 v71, v41, v5
    v_lshlrev_b32 v4, 16, v123
    v_and_b32 v5, 0xffff0000, v123
    v_fmac_f32 v72, v41, v4
    v_fmac_f32 v73, v41, v5
    v_lshlrev_b32 v4, 16, v124
    v_and_b32 v5, 0xffff0000, v124
    v_fmac_f32 v74, v41, v4
    v_fmac_f32 v75, v41, v5
    v_lshlrev_b32 v4, 16, v125
    v_and_b32 v5, 0xffff0000, v125
    v_fmac_f32 v76, v41, v4
    v_fmac_f32 v77, v41, v5
    s_mov_b32 s45, 70656
    buffer_load_dwordx4 v[114:117], v1, s[20:23], s45 offen offset:0 nt
    buffer_load_dwordx4 v[118:121], v1, s[20:23], s45 offen offset:128 nt
    buffer_load_dwordx4 v[122:125], v1, s[20:23], s45 offen offset:256 nt
    s_waitcnt vmcnt(9)
    v_lshlrev_b32 v4, 16, v78
    v_and_b32 v5, 0xffff0000, v78
    v_fmac_f32 v54, v42, v4
    v_fmac_f32 v55, v42, v5
    v_lshlrev_b32 v4, 16, v79
    v_and_b32 v5, 0xffff0000, v79
    v_fmac_f32 v56, v42, v4
    v_fmac_f32 v57, v42, v5
    v_lshlrev_b32 v4, 16, v80
    v_and_b32 v5, 0xffff0000, v80
    v_fmac_f32 v58, v42, v4
    v_fmac_f32 v59, v42, v5
    v_lshlrev_b32 v4, 16, v81
    v_and_b32 v5, 0xffff0000, v81
    v_fmac_f32 v60, v42, v4
    v_fmac_f32 v61, v42, v5
    v_lshlrev_b32 v4, 16, v82
    v_and_b32 v5, 0xffff0000, v82
    v_fmac_f32 v62, v42, v4
    v_fmac_f32 v63, v42, v5
    v_lshlrev_b32 v4, 16, v83
    v_and_b32 v5, 0xffff0000, v83
    v_fmac_f32 v64, v42, v4
    v_fmac_f32 v65, v42, v5
    v_lshlrev_b32 v4, 16, v84
    v_and_b32 v5, 0xffff0000, v84
    v_fmac_f32 v66, v42, v4
    v_fmac_f32 v67, v42, v5
    v_lshlrev_b32 v4, 16, v85
    v_and_b32 v5, 0xffff0000, v85
    v_fmac_f32 v68, v42, v4
    v_fmac_f32 v69, v42, v5
    v_lshlrev_b32 v4, 16, v86
    v_and_b32 v5, 0xffff0000, v86
    v_fmac_f32 v70, v42, v4
    v_fmac_f32 v71, v42, v5
    v_lshlrev_b32 v4, 16, v87
    v_and_b32 v5, 0xffff0000, v87
    v_fmac_f32 v72, v42, v4
    v_fmac_f32 v73, v42, v5
    v_lshlrev_b32 v4, 16, v88
    v_and_b32 v5, 0xffff0000, v88
    v_fmac_f32 v74, v42, v4
    v_fmac_f32 v75, v42, v5
    v_lshlrev_b32 v4, 16, v89
    v_and_b32 v5, 0xffff0000, v89
    v_fmac_f32 v76, v42, v4
    v_fmac_f32 v77, v42, v5
    s_mov_b32 s45, 73728
    buffer_load_dwordx4 v[78:81], v1, s[20:23], s45 offen offset:0 nt
    buffer_load_dwordx4 v[82:85], v1, s[20:23], s45 offen offset:128 nt
    buffer_load_dwordx4 v[86:89], v1, s[20:23], s45 offen offset:256 nt
    s_waitcnt vmcnt(9)
    v_lshlrev_b32 v4, 16, v90
    v_and_b32 v5, 0xffff0000, v90
    v_fmac_f32 v54, v43, v4
    v_fmac_f32 v55, v43, v5
    v_lshlrev_b32 v4, 16, v91
    v_and_b32 v5, 0xffff0000, v91
    v_fmac_f32 v56, v43, v4
    v_fmac_f32 v57, v43, v5
    v_lshlrev_b32 v4, 16, v92
    v_and_b32 v5, 0xffff0000, v92
    v_fmac_f32 v58, v43, v4
    v_fmac_f32 v59, v43, v5
    v_lshlrev_b32 v4, 16, v93
    v_and_b32 v5, 0xffff0000, v93
    v_fmac_f32 v60, v43, v4
    v_fmac_f32 v61, v43, v5
    v_lshlrev_b32 v4, 16, v94
    v_and_b32 v5, 0xffff0000, v94
    v_fmac_f32 v62, v43, v4
    v_fmac_f32 v63, v43, v5
    v_lshlrev_b32 v4, 16, v95
    v_and_b32 v5, 0xffff0000, v95
    v_fmac_f32 v64, v43, v4
    v_fmac_f32 v65, v43, v5
    v_lshlrev_b32 v4, 16, v96
    v_and_b32 v5, 0xffff0000, v96
    v_fmac_f32 v66, v43, v4
    v_fmac_f32 v67, v43, v5
    v_lshlrev_b32 v4, 16, v97
    v_and_b32 v5, 0xffff0000, v97
    v_fmac_f32 v68, v43, v4
    v_fmac_f32 v69, v43, v5
    v_lshlrev_b32 v4, 16, v98
    v_and_b32 v5, 0xffff0000, v98
    v_fmac_f32 v70, v43, v4
    v_fmac_f32 v71, v43, v5
    v_lshlrev_b32 v4, 16, v99
    v_and_b32 v5, 0xffff0000, v99
    v_fmac_f32 v72, v43, v4
    v_fmac_f32 v73, v43, v5
    v_lshlrev_b32 v4, 16, v100
    v_and_b32 v5, 0xffff0000, v100
    v_fmac_f32 v74, v43, v4
    v_fmac_f32 v75, v43, v5
    v_lshlrev_b32 v4, 16, v101
    v_and_b32 v5, 0xffff0000, v101
    v_fmac_f32 v76, v43, v4
    v_fmac_f32 v77, v43, v5
    s_mov_b32 s45, 76800
    buffer_load_dwordx4 v[90:93], v1, s[20:23], s45 offen offset:0 nt
    buffer_load_dwordx4 v[94:97], v1, s[20:23], s45 offen offset:128 nt
    buffer_load_dwordx4 v[98:101], v1, s[20:23], s45 offen offset:256 nt
    s_waitcnt vmcnt(9)
    v_lshlrev_b32 v4, 16, v102
    v_and_b32 v5, 0xffff0000, v102
    v_fmac_f32 v54, v44, v4
    v_fmac_f32 v55, v44, v5
    v_lshlrev_b32 v4, 16, v103
    v_and_b32 v5, 0xffff0000, v103
    v_fmac_f32 v56, v44, v4
    v_fmac_f32 v57, v44, v5
    v_lshlrev_b32 v4, 16, v104
    v_and_b32 v5, 0xffff0000, v104
    v_fmac_f32 v58, v44, v4
    v_fmac_f32 v59, v44, v5
    v_lshlrev_b32 v4, 16, v105
    v_and_b32 v5, 0xffff0000, v105
    v_fmac_f32 v60, v44, v4
    v_fmac_f32 v61, v44, v5
    v_lshlrev_b32 v4, 16, v106
    v_and_b32 v5, 0xffff0000, v106
    v_fmac_f32 v62, v44, v4
    v_fmac_f32 v63, v44, v5
    v_lshlrev_b32 v4, 16, v107
    v_and_b32 v5, 0xffff0000, v107
    v_fmac_f32 v64, v44, v4
    v_fmac_f32 v65, v44, v5
    v_lshlrev_b32 v4, 16, v108
    v_and_b32 v5, 0xffff0000, v108
    v_fmac_f32 v66, v44, v4
    v_fmac_f32 v67, v44, v5
    v_lshlrev_b32 v4, 16, v109
    v_and_b32 v5, 0xffff0000, v109
    v_fmac_f32 v68, v44, v4
    v_fmac_f32 v69, v44, v5
    v_lshlrev_b32 v4, 16, v110
    v_and_b32 v5, 0xffff0000, v110
    v_fmac_f32 v70, v44, v4
    v_fmac_f32 v71, v44, v5
    v_lshlrev_b32 v4, 16, v111
    v_and_b32 v5, 0xffff0000, v111
    v_fmac_f32 v72, v44, v4
    v_fmac_f32 v73, v44, v5
    v_lshlrev_b32 v4, 16, v112
    v_and_b32 v5, 0xffff0000, v112
    v_fmac_f32 v74, v44, v4
    v_fmac_f32 v75, v44, v5
    v_lshlrev_b32 v4, 16, v113
    v_and_b32 v5, 0xffff0000, v113
    v_fmac_f32 v76, v44, v4
    v_fmac_f32 v77, v44, v5
    s_mov_b32 s45, 79872
    buffer_load_dwordx4 v[102:105], v1, s[20:23], s45 offen offset:0 nt
    buffer_load_dwordx4 v[106:109], v1, s[20:23], s45 offen offset:128 nt
    buffer_load_dwordx4 v[110:113], v1, s[20:23], s45 offen offset:256 nt
    s_waitcnt vmcnt(9)
    v_lshlrev_b32 v4, 16, v114
    v_and_b32 v5, 0xffff0000, v114
    v_fmac_f32 v54, v45, v4
    v_fmac_f32 v55, v45, v5
    v_lshlrev_b32 v4, 16, v115
    v_and_b32 v5, 0xffff0000, v115
    v_fmac_f32 v56, v45, v4
    v_fmac_f32 v57, v45, v5
    v_lshlrev_b32 v4, 16, v116
    v_and_b32 v5, 0xffff0000, v116
    v_fmac_f32 v58, v45, v4
    v_fmac_f32 v59, v45, v5
    v_lshlrev_b32 v4, 16, v117
    v_and_b32 v5, 0xffff0000, v117
    v_fmac_f32 v60, v45, v4
    v_fmac_f32 v61, v45, v5
    v_lshlrev_b32 v4, 16, v118
    v_and_b32 v5, 0xffff0000, v118
    v_fmac_f32 v62, v45, v4
    v_fmac_f32 v63, v45, v5
    v_lshlrev_b32 v4, 16, v119
    v_and_b32 v5, 0xffff0000, v119
    v_fmac_f32 v64, v45, v4
    v_fmac_f32 v65, v45, v5
    v_lshlrev_b32 v4, 16, v120
    v_and_b32 v5, 0xffff0000, v120
    v_fmac_f32 v66, v45, v4
    v_fmac_f32 v67, v45, v5
    v_lshlrev_b32 v4, 16, v121
    v_and_b32 v5, 0xffff0000, v121
    v_fmac_f32 v68, v45, v4
    v_fmac_f32 v69, v45, v5
    v_lshlrev_b32 v4, 16, v122
    v_and_b32 v5, 0xffff0000, v122
    v_fmac_f32 v70, v45, v4
    v_fmac_f32 v71, v45, v5
    v_lshlrev_b32 v4, 16, v123
    v_and_b32 v5, 0xffff0000, v123
    v_fmac_f32 v72, v45, v4
    v_fmac_f32 v73, v45, v5
    v_lshlrev_b32 v4, 16, v124
    v_and_b32 v5, 0xffff0000, v124
    v_fmac_f32 v74, v45, v4
    v_fmac_f32 v75, v45, v5
    v_lshlrev_b32 v4, 16, v125
    v_and_b32 v5, 0xffff0000, v125
    v_fmac_f32 v76, v45, v4
    v_fmac_f32 v77, v45, v5
    s_mov_b32 s45, 82944
    buffer_load_dwordx4 v[114:117], v1, s[20:23], s45 offen offset:0 nt
    buffer_load_dwordx4 v[118:121], v1, s[20:23], s45 offen offset:128 nt
    buffer_load_dwordx4 v[122:125], v1, s[20:23], s45 offen offset:256 nt
    s_waitcnt vmcnt(9)
    v_lshlrev_b32 v4, 16, v78
    v_and_b32 v5, 0xffff0000, v78
    v_fmac_f32 v54, v46, v4
    v_fmac_f32 v55, v46, v5
    v_lshlrev_b32 v4, 16, v79
    v_and_b32 v5, 0xffff0000, v79
    v_fmac_f32 v56, v46, v4
    v_fmac_f32 v57, v46, v5
    v_lshlrev_b32 v4, 16, v80
    v_and_b32 v5, 0xffff0000, v80
    v_fmac_f32 v58, v46, v4
    v_fmac_f32 v59, v46, v5
    v_lshlrev_b32 v4, 16, v81
    v_and_b32 v5, 0xffff0000, v81
    v_fmac_f32 v60, v46, v4
    v_fmac_f32 v61, v46, v5
    v_lshlrev_b32 v4, 16, v82
    v_and_b32 v5, 0xffff0000, v82
    v_fmac_f32 v62, v46, v4
    v_fmac_f32 v63, v46, v5
    v_lshlrev_b32 v4, 16, v83
    v_and_b32 v5, 0xffff0000, v83
    v_fmac_f32 v64, v46, v4
    v_fmac_f32 v65, v46, v5
    v_lshlrev_b32 v4, 16, v84
    v_and_b32 v5, 0xffff0000, v84
    v_fmac_f32 v66, v46, v4
    v_fmac_f32 v67, v46, v5
    v_lshlrev_b32 v4, 16, v85
    v_and_b32 v5, 0xffff0000, v85
    v_fmac_f32 v68, v46, v4
    v_fmac_f32 v69, v46, v5
    v_lshlrev_b32 v4, 16, v86
    v_and_b32 v5, 0xffff0000, v86
    v_fmac_f32 v70, v46, v4
    v_fmac_f32 v71, v46, v5
    v_lshlrev_b32 v4, 16, v87
    v_and_b32 v5, 0xffff0000, v87
    v_fmac_f32 v72, v46, v4
    v_fmac_f32 v73, v46, v5
    v_lshlrev_b32 v4, 16, v88
    v_and_b32 v5, 0xffff0000, v88
    v_fmac_f32 v74, v46, v4
    v_fmac_f32 v75, v46, v5
    v_lshlrev_b32 v4, 16, v89
    v_and_b32 v5, 0xffff0000, v89
    v_fmac_f32 v76, v46, v4
    v_fmac_f32 v77, v46, v5
    s_mov_b32 s45, 86016
    buffer_load_dwordx4 v[78:81], v1, s[20:23], s45 offen offset:0 nt
    buffer_load_dwordx4 v[82:85], v1, s[20:23], s45 offen offset:128 nt
    buffer_load_dwordx4 v[86:89], v1, s[20:23], s45 offen offset:256 nt
    s_waitcnt vmcnt(9)
    v_lshlrev_b32 v4, 16, v90
    v_and_b32 v5, 0xffff0000, v90
    v_fmac_f32 v54, v47, v4
    v_fmac_f32 v55, v47, v5
    v_lshlrev_b32 v4, 16, v91
    v_and_b32 v5, 0xffff0000, v91
    v_fmac_f32 v56, v47, v4
    v_fmac_f32 v57, v47, v5
    v_lshlrev_b32 v4, 16, v92
    v_and_b32 v5, 0xffff0000, v92
    v_fmac_f32 v58, v47, v4
    v_fmac_f32 v59, v47, v5
    v_lshlrev_b32 v4, 16, v93
    v_and_b32 v5, 0xffff0000, v93
    v_fmac_f32 v60, v47, v4
    v_fmac_f32 v61, v47, v5
    v_lshlrev_b32 v4, 16, v94
    v_and_b32 v5, 0xffff0000, v94
    v_fmac_f32 v62, v47, v4
    v_fmac_f32 v63, v47, v5
    v_lshlrev_b32 v4, 16, v95
    v_and_b32 v5, 0xffff0000, v95
    v_fmac_f32 v64, v47, v4
    v_fmac_f32 v65, v47, v5
    v_lshlrev_b32 v4, 16, v96
    v_and_b32 v5, 0xffff0000, v96
    v_fmac_f32 v66, v47, v4
    v_fmac_f32 v67, v47, v5
    v_lshlrev_b32 v4, 16, v97
    v_and_b32 v5, 0xffff0000, v97
    v_fmac_f32 v68, v47, v4
    v_fmac_f32 v69, v47, v5
    v_lshlrev_b32 v4, 16, v98
    v_and_b32 v5, 0xffff0000, v98
    v_fmac_f32 v70, v47, v4
    v_fmac_f32 v71, v47, v5
    v_lshlrev_b32 v4, 16, v99
    v_and_b32 v5, 0xffff0000, v99
    v_fmac_f32 v72, v47, v4
    v_fmac_f32 v73, v47, v5
    v_lshlrev_b32 v4, 16, v100
    v_and_b32 v5, 0xffff0000, v100
    v_fmac_f32 v74, v47, v4
    v_fmac_f32 v75, v47, v5
    v_lshlrev_b32 v4, 16, v101
    v_and_b32 v5, 0xffff0000, v101
    v_fmac_f32 v76, v47, v4
    v_fmac_f32 v77, v47, v5
    s_mov_b32 s45, 89088
    buffer_load_dwordx4 v[90:93], v1, s[20:23], s45 offen offset:0 nt
    buffer_load_dwordx4 v[94:97], v1, s[20:23], s45 offen offset:128 nt
    buffer_load_dwordx4 v[98:101], v1, s[20:23], s45 offen offset:256 nt
    s_waitcnt vmcnt(9)
    v_lshlrev_b32 v4, 16, v102
    v_and_b32 v5, 0xffff0000, v102
    v_fmac_f32 v54, v48, v4
    v_fmac_f32 v55, v48, v5
    v_lshlrev_b32 v4, 16, v103
    v_and_b32 v5, 0xffff0000, v103
    v_fmac_f32 v56, v48, v4
    v_fmac_f32 v57, v48, v5
    v_lshlrev_b32 v4, 16, v104
    v_and_b32 v5, 0xffff0000, v104
    v_fmac_f32 v58, v48, v4
    v_fmac_f32 v59, v48, v5
    v_lshlrev_b32 v4, 16, v105
    v_and_b32 v5, 0xffff0000, v105
    v_fmac_f32 v60, v48, v4
    v_fmac_f32 v61, v48, v5
    v_lshlrev_b32 v4, 16, v106
    v_and_b32 v5, 0xffff0000, v106
    v_fmac_f32 v62, v48, v4
    v_fmac_f32 v63, v48, v5
    v_lshlrev_b32 v4, 16, v107
    v_and_b32 v5, 0xffff0000, v107
    v_fmac_f32 v64, v48, v4
    v_fmac_f32 v65, v48, v5
    v_lshlrev_b32 v4, 16, v108
    v_and_b32 v5, 0xffff0000, v108
    v_fmac_f32 v66, v48, v4
    v_fmac_f32 v67, v48, v5
    v_lshlrev_b32 v4, 16, v109
    v_and_b32 v5, 0xffff0000, v109
    v_fmac_f32 v68, v48, v4
    v_fmac_f32 v69, v48, v5
    v_lshlrev_b32 v4, 16, v110
    v_and_b32 v5, 0xffff0000, v110
    v_fmac_f32 v70, v48, v4
    v_fmac_f32 v71, v48, v5
    v_lshlrev_b32 v4, 16, v111
    v_and_b32 v5, 0xffff0000, v111
    v_fmac_f32 v72, v48, v4
    v_fmac_f32 v73, v48, v5
    v_lshlrev_b32 v4, 16, v112
    v_and_b32 v5, 0xffff0000, v112
    v_fmac_f32 v74, v48, v4
    v_fmac_f32 v75, v48, v5
    v_lshlrev_b32 v4, 16, v113
    v_and_b32 v5, 0xffff0000, v113
    v_fmac_f32 v76, v48, v4
    v_fmac_f32 v77, v48, v5
    s_mov_b32 s45, 92160
    buffer_load_dwordx4 v[102:105], v1, s[20:23], s45 offen offset:0 nt
    buffer_load_dwordx4 v[106:109], v1, s[20:23], s45 offen offset:128 nt
    buffer_load_dwordx4 v[110:113], v1, s[20:23], s45 offen offset:256 nt
    s_waitcnt vmcnt(9)
    v_lshlrev_b32 v4, 16, v114
    v_and_b32 v5, 0xffff0000, v114
    v_fmac_f32 v54, v49, v4
    v_fmac_f32 v55, v49, v5
    v_lshlrev_b32 v4, 16, v115
    v_and_b32 v5, 0xffff0000, v115
    v_fmac_f32 v56, v49, v4
    v_fmac_f32 v57, v49, v5
    v_lshlrev_b32 v4, 16, v116
    v_and_b32 v5, 0xffff0000, v116
    v_fmac_f32 v58, v49, v4
    v_fmac_f32 v59, v49, v5
    v_lshlrev_b32 v4, 16, v117
    v_and_b32 v5, 0xffff0000, v117
    v_fmac_f32 v60, v49, v4
    v_fmac_f32 v61, v49, v5
    v_lshlrev_b32 v4, 16, v118
    v_and_b32 v5, 0xffff0000, v118
    v_fmac_f32 v62, v49, v4
    v_fmac_f32 v63, v49, v5
    v_lshlrev_b32 v4, 16, v119
    v_and_b32 v5, 0xffff0000, v119
    v_fmac_f32 v64, v49, v4
    v_fmac_f32 v65, v49, v5
    v_lshlrev_b32 v4, 16, v120
    v_and_b32 v5, 0xffff0000, v120
    v_fmac_f32 v66, v49, v4
    v_fmac_f32 v67, v49, v5
    v_lshlrev_b32 v4, 16, v121
    v_and_b32 v5, 0xffff0000, v121
    v_fmac_f32 v68, v49, v4
    v_fmac_f32 v69, v49, v5
    v_lshlrev_b32 v4, 16, v122
    v_and_b32 v5, 0xffff0000, v122
    v_fmac_f32 v70, v49, v4
    v_fmac_f32 v71, v49, v5
    v_lshlrev_b32 v4, 16, v123
    v_and_b32 v5, 0xffff0000, v123
    v_fmac_f32 v72, v49, v4
    v_fmac_f32 v73, v49, v5
    v_lshlrev_b32 v4, 16, v124
    v_and_b32 v5, 0xffff0000, v124
    v_fmac_f32 v74, v49, v4
    v_fmac_f32 v75, v49, v5
    v_lshlrev_b32 v4, 16, v125
    v_and_b32 v5, 0xffff0000, v125
    v_fmac_f32 v76, v49, v4
    v_fmac_f32 v77, v49, v5
    s_mov_b32 s45, 95232
    buffer_load_dwordx4 v[114:117], v1, s[20:23], s45 offen offset:0 nt
    buffer_load_dwordx4 v[118:121], v1, s[20:23], s45 offen offset:128 nt
    buffer_load_dwordx4 v[122:125], v1, s[20:23], s45 offen offset:256 nt
    s_waitcnt vmcnt(9)
    v_lshlrev_b32 v4, 16, v78
    v_and_b32 v5, 0xffff0000, v78
    v_fmac_f32 v54, v50, v4
    v_fmac_f32 v55, v50, v5
    v_lshlrev_b32 v4, 16, v79
    v_and_b32 v5, 0xffff0000, v79
    v_fmac_f32 v56, v50, v4
    v_fmac_f32 v57, v50, v5
    v_lshlrev_b32 v4, 16, v80
    v_and_b32 v5, 0xffff0000, v80
    v_fmac_f32 v58, v50, v4
    v_fmac_f32 v59, v50, v5
    v_lshlrev_b32 v4, 16, v81
    v_and_b32 v5, 0xffff0000, v81
    v_fmac_f32 v60, v50, v4
    v_fmac_f32 v61, v50, v5
    v_lshlrev_b32 v4, 16, v82
    v_and_b32 v5, 0xffff0000, v82
    v_fmac_f32 v62, v50, v4
    v_fmac_f32 v63, v50, v5
    v_lshlrev_b32 v4, 16, v83
    v_and_b32 v5, 0xffff0000, v83
    v_fmac_f32 v64, v50, v4
    v_fmac_f32 v65, v50, v5
    v_lshlrev_b32 v4, 16, v84
    v_and_b32 v5, 0xffff0000, v84
    v_fmac_f32 v66, v50, v4
    v_fmac_f32 v67, v50, v5
    v_lshlrev_b32 v4, 16, v85
    v_and_b32 v5, 0xffff0000, v85
    v_fmac_f32 v68, v50, v4
    v_fmac_f32 v69, v50, v5
    v_lshlrev_b32 v4, 16, v86
    v_and_b32 v5, 0xffff0000, v86
    v_fmac_f32 v70, v50, v4
    v_fmac_f32 v71, v50, v5
    v_lshlrev_b32 v4, 16, v87
    v_and_b32 v5, 0xffff0000, v87
    v_fmac_f32 v72, v50, v4
    v_fmac_f32 v73, v50, v5
    v_lshlrev_b32 v4, 16, v88
    v_and_b32 v5, 0xffff0000, v88
    v_fmac_f32 v74, v50, v4
    v_fmac_f32 v75, v50, v5
    v_lshlrev_b32 v4, 16, v89
    v_and_b32 v5, 0xffff0000, v89
    v_fmac_f32 v76, v50, v4
    v_fmac_f32 v77, v50, v5
    s_waitcnt vmcnt(6)
    v_lshlrev_b32 v4, 16, v90
    v_and_b32 v5, 0xffff0000, v90
    v_fmac_f32 v54, v51, v4
    v_fmac_f32 v55, v51, v5
    v_lshlrev_b32 v4, 16, v91
    v_and_b32 v5, 0xffff0000, v91
    v_fmac_f32 v56, v51, v4
    v_fmac_f32 v57, v51, v5
    v_lshlrev_b32 v4, 16, v92
    v_and_b32 v5, 0xffff0000, v92
    v_fmac_f32 v58, v51, v4
    v_fmac_f32 v59, v51, v5
    v_lshlrev_b32 v4, 16, v93
    v_and_b32 v5, 0xffff0000, v93
    v_fmac_f32 v60, v51, v4
    v_fmac_f32 v61, v51, v5
    v_lshlrev_b32 v4, 16, v94
    v_and_b32 v5, 0xffff0000, v94
    v_fmac_f32 v62, v51, v4
    v_fmac_f32 v63, v51, v5
    v_lshlrev_b32 v4, 16, v95
    v_and_b32 v5, 0xffff0000, v95
    v_fmac_f32 v64, v51, v4
    v_fmac_f32 v65, v51, v5
    v_lshlrev_b32 v4, 16, v96
    v_and_b32 v5, 0xffff0000, v96
    v_fmac_f32 v66, v51, v4
    v_fmac_f32 v67, v51, v5
    v_lshlrev_b32 v4, 16, v97
    v_and_b32 v5, 0xffff0000, v97
    v_fmac_f32 v68, v51, v4
    v_fmac_f32 v69, v51, v5
    v_lshlrev_b32 v4, 16, v98
    v_and_b32 v5, 0xffff0000, v98
    v_fmac_f32 v70, v51, v4
    v_fmac_f32 v71, v51, v5
    v_lshlrev_b32 v4, 16, v99
    v_and_b32 v5, 0xffff0000, v99
    v_fmac_f32 v72, v51, v4
    v_fmac_f32 v73, v51, v5
    v_lshlrev_b32 v4, 16, v100
    v_and_b32 v5, 0xffff0000, v100
    v_fmac_f32 v74, v51, v4
    v_fmac_f32 v75, v51, v5
    v_lshlrev_b32 v4, 16, v101
    v_and_b32 v5, 0xffff0000, v101
    v_fmac_f32 v76, v51, v4
    v_fmac_f32 v77, v51, v5
    s_waitcnt vmcnt(3)
    v_lshlrev_b32 v4, 16, v102
    v_and_b32 v5, 0xffff0000, v102
    v_fmac_f32 v54, v52, v4
    v_fmac_f32 v55, v52, v5
    v_lshlrev_b32 v4, 16, v103
    v_and_b32 v5, 0xffff0000, v103
    v_fmac_f32 v56, v52, v4
    v_fmac_f32 v57, v52, v5
    v_lshlrev_b32 v4, 16, v104
    v_and_b32 v5, 0xffff0000, v104
    v_fmac_f32 v58, v52, v4
    v_fmac_f32 v59, v52, v5
    v_lshlrev_b32 v4, 16, v105
    v_and_b32 v5, 0xffff0000, v105
    v_fmac_f32 v60, v52, v4
    v_fmac_f32 v61, v52, v5
    v_lshlrev_b32 v4, 16, v106
    v_and_b32 v5, 0xffff0000, v106
    v_fmac_f32 v62, v52, v4
    v_fmac_f32 v63, v52, v5
    v_lshlrev_b32 v4, 16, v107
    v_and_b32 v5, 0xffff0000, v107
    v_fmac_f32 v64, v52, v4
    v_fmac_f32 v65, v52, v5
    v_lshlrev_b32 v4, 16, v108
    v_and_b32 v5, 0xffff0000, v108
    v_fmac_f32 v66, v52, v4
    v_fmac_f32 v67, v52, v5
    v_lshlrev_b32 v4, 16, v109
    v_and_b32 v5, 0xffff0000, v109
    v_fmac_f32 v68, v52, v4
    v_fmac_f32 v69, v52, v5
    v_lshlrev_b32 v4, 16, v110
    v_and_b32 v5, 0xffff0000, v110
    v_fmac_f32 v70, v52, v4
    v_fmac_f32 v71, v52, v5
    v_lshlrev_b32 v4, 16, v111
    v_and_b32 v5, 0xffff0000, v111
    v_fmac_f32 v72, v52, v4
    v_fmac_f32 v73, v52, v5
    v_lshlrev_b32 v4, 16, v112
    v_and_b32 v5, 0xffff0000, v112
    v_fmac_f32 v74, v52, v4
    v_fmac_f32 v75, v52, v5
    v_lshlrev_b32 v4, 16, v113
    v_and_b32 v5, 0xffff0000, v113
    v_fmac_f32 v76, v52, v4
    v_fmac_f32 v77, v52, v5
    s_waitcnt vmcnt(0)
    v_lshlrev_b32 v4, 16, v114
    v_and_b32 v5, 0xffff0000, v114
    v_fmac_f32 v54, v53, v4
    v_fmac_f32 v55, v53, v5
    v_lshlrev_b32 v4, 16, v115
    v_and_b32 v5, 0xffff0000, v115
    v_fmac_f32 v56, v53, v4
    v_fmac_f32 v57, v53, v5
    v_lshlrev_b32 v4, 16, v116
    v_and_b32 v5, 0xffff0000, v116
    v_fmac_f32 v58, v53, v4
    v_fmac_f32 v59, v53, v5
    v_lshlrev_b32 v4, 16, v117
    v_and_b32 v5, 0xffff0000, v117
    v_fmac_f32 v60, v53, v4
    v_fmac_f32 v61, v53, v5
    v_lshlrev_b32 v4, 16, v118
    v_and_b32 v5, 0xffff0000, v118
    v_fmac_f32 v62, v53, v4
    v_fmac_f32 v63, v53, v5
    v_lshlrev_b32 v4, 16, v119
    v_and_b32 v5, 0xffff0000, v119
    v_fmac_f32 v64, v53, v4
    v_fmac_f32 v65, v53, v5
    v_lshlrev_b32 v4, 16, v120
    v_and_b32 v5, 0xffff0000, v120
    v_fmac_f32 v66, v53, v4
    v_fmac_f32 v67, v53, v5
    v_lshlrev_b32 v4, 16, v121
    v_and_b32 v5, 0xffff0000, v121
    v_fmac_f32 v68, v53, v4
    v_fmac_f32 v69, v53, v5
    v_lshlrev_b32 v4, 16, v122
    v_and_b32 v5, 0xffff0000, v122
    v_fmac_f32 v70, v53, v4
    v_fmac_f32 v71, v53, v5
    v_lshlrev_b32 v4, 16, v123
    v_and_b32 v5, 0xffff0000, v123
    v_fmac_f32 v72, v53, v4
    v_fmac_f32 v73, v53, v5
    v_lshlrev_b32 v4, 16, v124
    v_and_b32 v5, 0xffff0000, v124
    v_fmac_f32 v74, v53, v4
    v_fmac_f32 v75, v53, v5
    v_lshlrev_b32 v4, 16, v125
    v_and_b32 v5, 0xffff0000, v125
    v_fmac_f32 v76, v53, v4
    v_fmac_f32 v77, v53, v5
    s_nop 1
    v_permlane32_swap_b32 v54, v58
    v_permlane32_swap_b32 v55, v59
    v_permlane32_swap_b32 v56, v60
    v_permlane32_swap_b32 v57, v61
    v_permlane32_swap_b32 v62, v66
    v_permlane32_swap_b32 v63, v67
    v_permlane32_swap_b32 v64, v68
    v_permlane32_swap_b32 v65, v69
    v_permlane32_swap_b32 v70, v74
    v_permlane32_swap_b32 v71, v75
    v_permlane32_swap_b32 v72, v76
    v_permlane32_swap_b32 v73, v77
    v_add_f32 v54, v54, v58
    v_add_f32 v55, v55, v59
    v_add_f32 v56, v56, v60
    v_add_f32 v57, v57, v61
    v_add_f32 v62, v62, v66
    v_add_f32 v63, v63, v67
    v_add_f32 v64, v64, v68
    v_add_f32 v65, v65, v69
    v_add_f32 v70, v70, v74
    v_add_f32 v71, v71, v75
    v_add_f32 v72, v72, v76
    v_add_f32 v73, v73, v77
    s_nop 1
    v_permlane16_swap_b32 v54, v56
    v_permlane16_swap_b32 v55, v57
    v_permlane16_swap_b32 v62, v64
    v_permlane16_swap_b32 v63, v65
    v_permlane16_swap_b32 v70, v72
    v_permlane16_swap_b32 v71, v73
    v_add_f32 v54, v54, v56
    v_add_f32 v55, v55, v57
    v_add_f32 v62, v62, v64
    v_add_f32 v63, v63, v65
    v_add_f32 v70, v70, v72
    v_add_f32 v71, v71, v73
    s_nop 1
    v_add_f32_dpp v54, v54, v54 row_ror:8 row_mask:0xf bank_mask:0xf
    v_add_f32_dpp v55, v55, v55 row_ror:8 row_mask:0xf bank_mask:0xf
    v_add_f32_dpp v62, v62, v62 row_ror:8 row_mask:0xf bank_mask:0xf
    v_add_f32_dpp v63, v63, v63 row_ror:8 row_mask:0xf bank_mask:0xf
    v_add_f32_dpp v70, v70, v70 row_ror:8 row_mask:0xf bank_mask:0xf
    v_add_f32_dpp v71, v71, v71 row_ror:8 row_mask:0xf bank_mask:0xf
    ds_write_b64 v9, v[54:55] offset:0
    ds_write_b64 v9, v[62:63] offset:256
    ds_write_b64 v9, v[70:71] offset:512
    v_lshrrev_b32 v4, 6, v0
    v_lshlrev_b32 v4, 3, v4
    ds_write_b64 v4, v[2:3] offset:12800
    s_waitcnt lgkmcnt(0)
    s_barrier
    v_cmp_gt_u32 vcc, 192, v0
    s_and_saveexec_b64 s[46:47], vcc
    s_cbranch_execz L_attn_e1
    v_lshlrev_b32 v2, 2, v0
    v_mov_b32 v4, 0
    ds_read_b32 v54, v2 offset:0
    ds_read_b32 v55, v2 offset:768
    ds_read_b32 v56, v2 offset:1536
    ds_read_b32 v57, v2 offset:2304
    ds_read_b32 v58, v2 offset:3072
    ds_read_b32 v59, v2 offset:3840
    ds_read_b32 v60, v2 offset:4608
    ds_read_b32 v61, v2 offset:5376
    ds_read_b32 v62, v2 offset:6144
    ds_read_b32 v63, v2 offset:6912
    ds_read_b32 v64, v2 offset:7680
    ds_read_b32 v65, v2 offset:8448
    ds_read_b32 v66, v2 offset:9216
    ds_read_b32 v67, v2 offset:9984
    ds_read_b32 v68, v2 offset:10752
    ds_read_b32 v69, v2 offset:11520
    ds_read_b128 v[22:25], v4 offset:12800
    ds_read_b128 v[26:29], v4 offset:12816
    ds_read_b128 v[30:33], v4 offset:12832
    ds_read_b128 v[34:37], v4 offset:12848
    ds_read_b128 v[38:41], v4 offset:12864
    ds_read_b128 v[42:45], v4 offset:12880
    ds_read_b128 v[46:49], v4 offset:12896
    ds_read_b128 v[50:53], v4 offset:12912
    s_waitcnt lgkmcnt(0)
    v_max_f32 v3, v22, v24
    v_max_f32 v3, v3, v26
    v_max_f32 v3, v3, v28
    v_max_f32 v3, v3, v30
    v_max_f32 v3, v3, v32
    v_max_f32 v3, v3, v34
    v_max_f32 v3, v3, v36
    v_max_f32 v3, v3, v38
    v_max_f32 v3, v3, v40
    v_max_f32 v3, v3, v42
    v_max_f32 v3, v3, v44
    v_max_f32 v3, v3, v46
    v_max_f32 v3, v3, v48
    v_max_f32 v3, v3, v50
    v_max_f32 v3, v3, v52
    v_sub_f32 v22, v22, v3
    v_mul_f32 v22, 0x3fb8aa3b, v22
    v_exp_f32 v22, v22
    v_sub_f32 v24, v24, v3
    v_mul_f32 v24, 0x3fb8aa3b, v24
    v_exp_f32 v24, v24
    v_sub_f32 v26, v26, v3
    v_mul_f32 v26, 0x3fb8aa3b, v26
    v_exp_f32 v26, v26
    v_sub_f32 v28, v28, v3
    v_mul_f32 v28, 0x3fb8aa3b, v28
    v_exp_f32 v28, v28
    v_sub_f32 v30, v30, v3
    v_mul_f32 v30, 0x3fb8aa3b, v30
    v_exp_f32 v30, v30
    v_sub_f32 v32, v32, v3
    v_mul_f32 v32, 0x3fb8aa3b, v32
    v_exp_f32 v32, v32
    v_sub_f32 v34, v34, v3
    v_mul_f32 v34, 0x3fb8aa3b, v34
    v_exp_f32 v34, v34
    v_sub_f32 v36, v36, v3
    v_mul_f32 v36, 0x3fb8aa3b, v36
    v_exp_f32 v36, v36
    v_sub_f32 v38, v38, v3
    v_mul_f32 v38, 0x3fb8aa3b, v38
    v_exp_f32 v38, v38
    v_sub_f32 v40, v40, v3
    v_mul_f32 v40, 0x3fb8aa3b, v40
    v_exp_f32 v40, v40
    v_sub_f32 v42, v42, v3
    v_mul_f32 v42, 0x3fb8aa3b, v42
    v_exp_f32 v42, v42
    v_sub_f32 v44, v44, v3
    v_mul_f32 v44, 0x3fb8aa3b, v44
    v_exp_f32 v44, v44
    v_sub_f32 v46, v46, v3
    v_mul_f32 v46, 0x3fb8aa3b, v46
    v_exp_f32 v46, v46
    v_sub_f32 v48, v48, v3
    v_mul_f32 v48, 0x3fb8aa3b, v48
    v_exp_f32 v48, v48
    v_sub_f32 v50, v50, v3
    v_mul_f32 v50, 0x3fb8aa3b, v50
    v_exp_f32 v50, v50
    v_sub_f32 v52, v52, v3
    v_mul_f32 v52, 0x3fb8aa3b, v52
    v_exp_f32 v52, v52
    s_nop 0
    v_mul_f32 v4, v22, v54
    v_mul_f32 v5, v22, v23
    v_fmac_f32 v4, v24, v55
    v_fmac_f32 v5, v24, v25
    v_fmac_f32 v4, v26, v56
    v_fmac_f32 v5, v26, v27
    v_fmac_f32 v4, v28, v57
    v_fmac_f32 v5, v28, v29
    v_fmac_f32 v4, v30, v58
    v_fmac_f32 v5, v30, v31
    v_fmac_f32 v4, v32, v59
    v_fmac_f32 v5, v32, v33
    v_fmac_f32 v4, v34, v60
    v_fmac_f32 v5, v34, v35
    v_fmac_f32 v4, v36, v61
    v_fmac_f32 v5, v36, v37
    v_fmac_f32 v4, v38, v62
    v_fmac_f32 v5, v38, v39
    v_fmac_f32 v4, v40, v63
    v_fmac_f32 v5, v40, v41
    v_fmac_f32 v4, v42, v64
    v_fmac_f32 v5, v42, v43
    v_fmac_f32 v4, v44, v65
    v_fmac_f32 v5, v44, v45
    v_fmac_f32 v4, v46, v66
    v_fmac_f32 v5, v46, v47
    v_fmac_f32 v4, v48, v67
    v_fmac_f32 v5, v48, v49
    v_fmac_f32 v4, v50, v68
    v_fmac_f32 v5, v50, v51
    v_fmac_f32 v4, v52, v69
    v_fmac_f32 v5, v52, v53
    s_mul_i32 s44, s40, 800
    buffer_store_dword v4, v2, s[32:35], s44 offen offset:0
    v_mov_b32 v2, v3
    v_mov_b32 v3, v5
    v_cmp_eq_u32 vcc, 0, v0
    s_and_b64 exec, exec, vcc
    v_mov_b32 v4, 768
    buffer_store_dwordx2 v[2:3], v4, s[32:35], s44 offen offset:0
L_attn_e1:
    s_mov_b64 exec, s[46:47]
    s_cmp_ge_u32 s2, 10
    s_cbranch_scc1 L_attn_done
    v_cmp_gt_u32 vcc, 256, v0
    s_and_saveexec_b64 s[46:47], vcc
    s_cbranch_execz L_attn_done
    s_lshl_b32 s44, s2, 10
    v_lshlrev_b32 v2, 2, v0
    v_mov_b32 v3, 0
    s_add_u32 s44, s44, 262144
    buffer_store_dword v3, v2, s[32:35], s44 offen
L_attn_done:
    s_endpgm
.globl wo_kernel
.p2align 8
.type wo_kernel,@function
wo_kernel:
    s_cmp_ge_u32 s2, 10
    s_cbranch_scc1 L_wo_done
    s_load_dwordx2 s[4:5], s[0:1], 32
    s_load_dwordx2 s[6:7], s[0:1], 96
    v_and_b32 v1, 63, v0
    v_lshrrev_b32 v2, 6, v0
    v_lshrrev_b32 v3, 3, v1
    v_and_b32 v4, 7, v1
    v_lshlrev_b32 v5, 3, v2
    v_add_u32 v5, v5, v3
    v_mul_u32_u24 v6, 1280, v5
    v_lshlrev_b32 v7, 4, v4
    v_add_u32 v6, v6, v7
    s_mul_i32 s8, s3, 245760
    s_lshl_b32 s9, s2, 7
    s_add_u32 s8, s8, s9
    s_waitcnt lgkmcnt(0)
    s_mov_b32 s12, s4
    s_and_b32 s13, s5, 0xffff
    s_mov_b32 s14, 0x780000
    s_mov_b32 s15, 0x00020000
    s_mov_b32 s16, s6
    s_and_b32 s17, s7, 0xffff
    s_mov_b32 s18, 0x60000
    s_mov_b32 s19, 0x00020000
    s_add_u32 s10, s8, 0
    buffer_load_dwordx4 v[16:19], v6, s[12:15], s10 offen
    s_add_u32 s10, s8, 40960
    buffer_load_dwordx4 v[20:23], v6, s[12:15], s10 offen
    s_add_u32 s10, s8, 81920
    buffer_load_dwordx4 v[24:27], v6, s[12:15], s10 offen
    s_add_u32 s10, s8, 122880
    buffer_load_dwordx4 v[28:31], v6, s[12:15], s10 offen
    s_add_u32 s10, s8, 163840
    buffer_load_dwordx4 v[32:35], v6, s[12:15], s10 offen
    s_add_u32 s10, s8, 204800
    buffer_load_dwordx4 v[36:39], v6, s[12:15], s10 offen
    v_lshlrev_b32 v8, 2, v0
    v_mov_b32 v9, 768
    s_mul_i32 s10, s3, 1600
    s_add_u32 s10, s10, 0
    buffer_load_dword v40, v8, s[16:19], s10 offen
    buffer_load_dwordx2 v[48:49], v9, s[16:19], s10 offen
    s_mul_i32 s10, s3, 1600
    s_add_u32 s10, s10, 800
    buffer_load_dword v41, v8, s[16:19], s10 offen
    buffer_load_dwordx2 v[50:51], v9, s[16:19], s10 offen
    s_mul_i32 s10, s3, 1600
    s_add_u32 s10, s10, 51200
    buffer_load_dword v42, v8, s[16:19], s10 offen
    buffer_load_dwordx2 v[52:53], v9, s[16:19], s10 offen
    s_mul_i32 s10, s3, 1600
    s_add_u32 s10, s10, 52000
    buffer_load_dword v43, v8, s[16:19], s10 offen
    buffer_load_dwordx2 v[54:55], v9, s[16:19], s10 offen
    s_mul_i32 s10, s3, 1600
    s_add_u32 s10, s10, 102400
    buffer_load_dword v44, v8, s[16:19], s10 offen
    buffer_load_dwordx2 v[56:57], v9, s[16:19], s10 offen
    s_mul_i32 s10, s3, 1600
    s_add_u32 s10, s10, 103200
    buffer_load_dword v45, v8, s[16:19], s10 offen
    buffer_load_dwordx2 v[58:59], v9, s[16:19], s10 offen
    s_mul_i32 s10, s3, 1600
    s_add_u32 s10, s10, 153600
    buffer_load_dword v46, v8, s[16:19], s10 offen
    buffer_load_dwordx2 v[60:61], v9, s[16:19], s10 offen
    s_mul_i32 s10, s3, 1600
    s_add_u32 s10, s10, 154400
    buffer_load_dword v47, v8, s[16:19], s10 offen
    buffer_load_dwordx2 v[62:63], v9, s[16:19], s10 offen
    s_waitcnt vmcnt(0)
    v_max_f32 v10, v48, v50
    v_sub_f32 v48, v48, v10
    v_sub_f32 v50, v50, v10
    v_mul_f32 v48, 0x3fb8aa3b, v48
    v_mul_f32 v50, 0x3fb8aa3b, v50
    v_exp_f32 v48, v48
    v_exp_f32 v50, v50
    s_nop 0
    v_mul_f32 v49, v48, v49
    v_fmac_f32 v49, v50, v51
    v_mul_f32 v40, v48, v40
    v_fmac_f32 v40, v50, v41
    v_rcp_f32 v49, v49
    s_nop 0
    v_mul_f32 v12, v40, v49
    v_cvt_pk_bf16_f32 v12, v12, v12
    v_lshlrev_b32 v12, 16, v12
    v_max_f32 v10, v52, v54
    v_sub_f32 v52, v52, v10
    v_sub_f32 v54, v54, v10
    v_mul_f32 v52, 0x3fb8aa3b, v52
    v_mul_f32 v54, 0x3fb8aa3b, v54
    v_exp_f32 v52, v52
    v_exp_f32 v54, v54
    s_nop 0
    v_mul_f32 v53, v52, v53
    v_fmac_f32 v53, v54, v55
    v_mul_f32 v42, v52, v42
    v_fmac_f32 v42, v54, v43
    v_rcp_f32 v53, v53
    s_nop 0
    v_mul_f32 v13, v42, v53
    v_cvt_pk_bf16_f32 v13, v13, v13
    v_lshlrev_b32 v13, 16, v13
    v_max_f32 v10, v56, v58
    v_sub_f32 v56, v56, v10
    v_sub_f32 v58, v58, v10
    v_mul_f32 v56, 0x3fb8aa3b, v56
    v_mul_f32 v58, 0x3fb8aa3b, v58
    v_exp_f32 v56, v56
    v_exp_f32 v58, v58
    s_nop 0
    v_mul_f32 v57, v56, v57
    v_fmac_f32 v57, v58, v59
    v_mul_f32 v44, v56, v44
    v_fmac_f32 v44, v58, v45
    v_rcp_f32 v57, v57
    s_nop 0
    v_mul_f32 v14, v44, v57
    v_cvt_pk_bf16_f32 v14, v14, v14
    v_lshlrev_b32 v14, 16, v14
    v_max_f32 v10, v60, v62
    v_sub_f32 v60, v60, v10
    v_sub_f32 v62, v62, v10
    v_mul_f32 v60, 0x3fb8aa3b, v60
    v_mul_f32 v62, 0x3fb8aa3b, v62
    v_exp_f32 v60, v60
    v_exp_f32 v62, v62
    s_nop 0
    v_mul_f32 v61, v60, v61
    v_fmac_f32 v61, v62, v63
    v_mul_f32 v46, v60, v46
    v_fmac_f32 v46, v62, v47
    v_rcp_f32 v61, v61
    s_nop 0
    v_mul_f32 v15, v46, v61
    v_cvt_pk_bf16_f32 v15, v15, v15
    v_lshlrev_b32 v15, 16, v15
    v_cmp_gt_u32 vcc, 192, v0
    s_and_saveexec_b64 s[20:21], vcc
    v_lshlrev_b32 v8, 4, v0
    ds_write_b128 v8, v[12:15]
    s_mov_b64 exec, s[20:21]
    s_waitcnt lgkmcnt(0)
    s_barrier
    v_lshlrev_b32 v8, 4, v5
    ds_read_b128 v[40:43], v8 offset:0
    ds_read_b128 v[44:47], v8 offset:512
    ds_read_b128 v[48:51], v8 offset:1024
    ds_read_b128 v[52:55], v8 offset:1536
    ds_read_b128 v[56:59], v8 offset:2048
    ds_read_b128 v[60:63], v8 offset:2560
    s_waitcnt lgkmcnt(0)
    v_lshlrev_b32 v10, 16, v16
    v_and_b32 v11, 0xffff0000, v16
    v_mul_f32 v64, v40, v10
    v_mul_f32 v65, v40, v11
    v_mul_f32 v72, v41, v10
    v_mul_f32 v73, v41, v11
    v_mul_f32 v80, v42, v10
    v_mul_f32 v81, v42, v11
    v_mul_f32 v88, v43, v10
    v_mul_f32 v89, v43, v11
    v_lshlrev_b32 v10, 16, v17
    v_and_b32 v11, 0xffff0000, v17
    v_mul_f32 v66, v40, v10
    v_mul_f32 v67, v40, v11
    v_mul_f32 v74, v41, v10
    v_mul_f32 v75, v41, v11
    v_mul_f32 v82, v42, v10
    v_mul_f32 v83, v42, v11
    v_mul_f32 v90, v43, v10
    v_mul_f32 v91, v43, v11
    v_lshlrev_b32 v10, 16, v18
    v_and_b32 v11, 0xffff0000, v18
    v_mul_f32 v68, v40, v10
    v_mul_f32 v69, v40, v11
    v_mul_f32 v76, v41, v10
    v_mul_f32 v77, v41, v11
    v_mul_f32 v84, v42, v10
    v_mul_f32 v85, v42, v11
    v_mul_f32 v92, v43, v10
    v_mul_f32 v93, v43, v11
    v_lshlrev_b32 v10, 16, v19
    v_and_b32 v11, 0xffff0000, v19
    v_mul_f32 v70, v40, v10
    v_mul_f32 v71, v40, v11
    v_mul_f32 v78, v41, v10
    v_mul_f32 v79, v41, v11
    v_mul_f32 v86, v42, v10
    v_mul_f32 v87, v42, v11
    v_mul_f32 v94, v43, v10
    v_mul_f32 v95, v43, v11
    v_lshlrev_b32 v10, 16, v20
    v_and_b32 v11, 0xffff0000, v20
    v_fmac_f32 v64, v44, v10
    v_fmac_f32 v65, v44, v11
    v_fmac_f32 v72, v45, v10
    v_fmac_f32 v73, v45, v11
    v_fmac_f32 v80, v46, v10
    v_fmac_f32 v81, v46, v11
    v_fmac_f32 v88, v47, v10
    v_fmac_f32 v89, v47, v11
    v_lshlrev_b32 v10, 16, v21
    v_and_b32 v11, 0xffff0000, v21
    v_fmac_f32 v66, v44, v10
    v_fmac_f32 v67, v44, v11
    v_fmac_f32 v74, v45, v10
    v_fmac_f32 v75, v45, v11
    v_fmac_f32 v82, v46, v10
    v_fmac_f32 v83, v46, v11
    v_fmac_f32 v90, v47, v10
    v_fmac_f32 v91, v47, v11
    v_lshlrev_b32 v10, 16, v22
    v_and_b32 v11, 0xffff0000, v22
    v_fmac_f32 v68, v44, v10
    v_fmac_f32 v69, v44, v11
    v_fmac_f32 v76, v45, v10
    v_fmac_f32 v77, v45, v11
    v_fmac_f32 v84, v46, v10
    v_fmac_f32 v85, v46, v11
    v_fmac_f32 v92, v47, v10
    v_fmac_f32 v93, v47, v11
    v_lshlrev_b32 v10, 16, v23
    v_and_b32 v11, 0xffff0000, v23
    v_fmac_f32 v70, v44, v10
    v_fmac_f32 v71, v44, v11
    v_fmac_f32 v78, v45, v10
    v_fmac_f32 v79, v45, v11
    v_fmac_f32 v86, v46, v10
    v_fmac_f32 v87, v46, v11
    v_fmac_f32 v94, v47, v10
    v_fmac_f32 v95, v47, v11
    v_lshlrev_b32 v10, 16, v24
    v_and_b32 v11, 0xffff0000, v24
    v_fmac_f32 v64, v48, v10
    v_fmac_f32 v65, v48, v11
    v_fmac_f32 v72, v49, v10
    v_fmac_f32 v73, v49, v11
    v_fmac_f32 v80, v50, v10
    v_fmac_f32 v81, v50, v11
    v_fmac_f32 v88, v51, v10
    v_fmac_f32 v89, v51, v11
    v_lshlrev_b32 v10, 16, v25
    v_and_b32 v11, 0xffff0000, v25
    v_fmac_f32 v66, v48, v10
    v_fmac_f32 v67, v48, v11
    v_fmac_f32 v74, v49, v10
    v_fmac_f32 v75, v49, v11
    v_fmac_f32 v82, v50, v10
    v_fmac_f32 v83, v50, v11
    v_fmac_f32 v90, v51, v10
    v_fmac_f32 v91, v51, v11
    v_lshlrev_b32 v10, 16, v26
    v_and_b32 v11, 0xffff0000, v26
    v_fmac_f32 v68, v48, v10
    v_fmac_f32 v69, v48, v11
    v_fmac_f32 v76, v49, v10
    v_fmac_f32 v77, v49, v11
    v_fmac_f32 v84, v50, v10
    v_fmac_f32 v85, v50, v11
    v_fmac_f32 v92, v51, v10
    v_fmac_f32 v93, v51, v11
    v_lshlrev_b32 v10, 16, v27
    v_and_b32 v11, 0xffff0000, v27
    v_fmac_f32 v70, v48, v10
    v_fmac_f32 v71, v48, v11
    v_fmac_f32 v78, v49, v10
    v_fmac_f32 v79, v49, v11
    v_fmac_f32 v86, v50, v10
    v_fmac_f32 v87, v50, v11
    v_fmac_f32 v94, v51, v10
    v_fmac_f32 v95, v51, v11
    v_lshlrev_b32 v10, 16, v28
    v_and_b32 v11, 0xffff0000, v28
    v_fmac_f32 v64, v52, v10
    v_fmac_f32 v65, v52, v11
    v_fmac_f32 v72, v53, v10
    v_fmac_f32 v73, v53, v11
    v_fmac_f32 v80, v54, v10
    v_fmac_f32 v81, v54, v11
    v_fmac_f32 v88, v55, v10
    v_fmac_f32 v89, v55, v11
    v_lshlrev_b32 v10, 16, v29
    v_and_b32 v11, 0xffff0000, v29
    v_fmac_f32 v66, v52, v10
    v_fmac_f32 v67, v52, v11
    v_fmac_f32 v74, v53, v10
    v_fmac_f32 v75, v53, v11
    v_fmac_f32 v82, v54, v10
    v_fmac_f32 v83, v54, v11
    v_fmac_f32 v90, v55, v10
    v_fmac_f32 v91, v55, v11
    v_lshlrev_b32 v10, 16, v30
    v_and_b32 v11, 0xffff0000, v30
    v_fmac_f32 v68, v52, v10
    v_fmac_f32 v69, v52, v11
    v_fmac_f32 v76, v53, v10
    v_fmac_f32 v77, v53, v11
    v_fmac_f32 v84, v54, v10
    v_fmac_f32 v85, v54, v11
    v_fmac_f32 v92, v55, v10
    v_fmac_f32 v93, v55, v11
    v_lshlrev_b32 v10, 16, v31
    v_and_b32 v11, 0xffff0000, v31
    v_fmac_f32 v70, v52, v10
    v_fmac_f32 v71, v52, v11
    v_fmac_f32 v78, v53, v10
    v_fmac_f32 v79, v53, v11
    v_fmac_f32 v86, v54, v10
    v_fmac_f32 v87, v54, v11
    v_fmac_f32 v94, v55, v10
    v_fmac_f32 v95, v55, v11
    v_lshlrev_b32 v10, 16, v32
    v_and_b32 v11, 0xffff0000, v32
    v_fmac_f32 v64, v56, v10
    v_fmac_f32 v65, v56, v11
    v_fmac_f32 v72, v57, v10
    v_fmac_f32 v73, v57, v11
    v_fmac_f32 v80, v58, v10
    v_fmac_f32 v81, v58, v11
    v_fmac_f32 v88, v59, v10
    v_fmac_f32 v89, v59, v11
    v_lshlrev_b32 v10, 16, v33
    v_and_b32 v11, 0xffff0000, v33
    v_fmac_f32 v66, v56, v10
    v_fmac_f32 v67, v56, v11
    v_fmac_f32 v74, v57, v10
    v_fmac_f32 v75, v57, v11
    v_fmac_f32 v82, v58, v10
    v_fmac_f32 v83, v58, v11
    v_fmac_f32 v90, v59, v10
    v_fmac_f32 v91, v59, v11
    v_lshlrev_b32 v10, 16, v34
    v_and_b32 v11, 0xffff0000, v34
    v_fmac_f32 v68, v56, v10
    v_fmac_f32 v69, v56, v11
    v_fmac_f32 v76, v57, v10
    v_fmac_f32 v77, v57, v11
    v_fmac_f32 v84, v58, v10
    v_fmac_f32 v85, v58, v11
    v_fmac_f32 v92, v59, v10
    v_fmac_f32 v93, v59, v11
    v_lshlrev_b32 v10, 16, v35
    v_and_b32 v11, 0xffff0000, v35
    v_fmac_f32 v70, v56, v10
    v_fmac_f32 v71, v56, v11
    v_fmac_f32 v78, v57, v10
    v_fmac_f32 v79, v57, v11
    v_fmac_f32 v86, v58, v10
    v_fmac_f32 v87, v58, v11
    v_fmac_f32 v94, v59, v10
    v_fmac_f32 v95, v59, v11
    v_lshlrev_b32 v10, 16, v36
    v_and_b32 v11, 0xffff0000, v36
    v_fmac_f32 v64, v60, v10
    v_fmac_f32 v65, v60, v11
    v_fmac_f32 v72, v61, v10
    v_fmac_f32 v73, v61, v11
    v_fmac_f32 v80, v62, v10
    v_fmac_f32 v81, v62, v11
    v_fmac_f32 v88, v63, v10
    v_fmac_f32 v89, v63, v11
    v_lshlrev_b32 v10, 16, v37
    v_and_b32 v11, 0xffff0000, v37
    v_fmac_f32 v66, v60, v10
    v_fmac_f32 v67, v60, v11
    v_fmac_f32 v74, v61, v10
    v_fmac_f32 v75, v61, v11
    v_fmac_f32 v82, v62, v10
    v_fmac_f32 v83, v62, v11
    v_fmac_f32 v90, v63, v10
    v_fmac_f32 v91, v63, v11
    v_lshlrev_b32 v10, 16, v38
    v_and_b32 v11, 0xffff0000, v38
    v_fmac_f32 v68, v60, v10
    v_fmac_f32 v69, v60, v11
    v_fmac_f32 v76, v61, v10
    v_fmac_f32 v77, v61, v11
    v_fmac_f32 v84, v62, v10
    v_fmac_f32 v85, v62, v11
    v_fmac_f32 v92, v63, v10
    v_fmac_f32 v93, v63, v11
    v_lshlrev_b32 v10, 16, v39
    v_and_b32 v11, 0xffff0000, v39
    v_fmac_f32 v70, v60, v10
    v_fmac_f32 v71, v60, v11
    v_fmac_f32 v78, v61, v10
    v_fmac_f32 v79, v61, v11
    v_fmac_f32 v86, v62, v10
    v_fmac_f32 v87, v62, v11
    v_fmac_f32 v94, v63, v10
    v_fmac_f32 v95, v63, v11
    s_nop 1
    v_permlane32_swap_b32 v64, v68
    v_permlane32_swap_b32 v65, v69
    v_permlane32_swap_b32 v66, v70
    v_permlane32_swap_b32 v67, v71
    v_permlane32_swap_b32 v72, v76
    v_permlane32_swap_b32 v73, v77
    v_permlane32_swap_b32 v74, v78
    v_permlane32_swap_b32 v75, v79
    v_permlane32_swap_b32 v80, v84
    v_permlane32_swap_b32 v81, v85
    v_permlane32_swap_b32 v82, v86
    v_permlane32_swap_b32 v83, v87
    v_permlane32_swap_b32 v88, v92
    v_permlane32_swap_b32 v89, v93
    v_permlane32_swap_b32 v90, v94
    v_permlane32_swap_b32 v91, v95
    v_add_f32 v64, v64, v68
    v_add_f32 v65, v65, v69
    v_add_f32 v66, v66, v70
    v_add_f32 v67, v67, v71
    v_add_f32 v72, v72, v76
    v_add_f32 v73, v73, v77
    v_add_f32 v74, v74, v78
    v_add_f32 v75, v75, v79
    v_add_f32 v80, v80, v84
    v_add_f32 v81, v81, v85
    v_add_f32 v82, v82, v86
    v_add_f32 v83, v83, v87
    v_add_f32 v88, v88, v92
    v_add_f32 v89, v89, v93
    v_add_f32 v90, v90, v94
    v_add_f32 v91, v91, v95
    s_nop 1
    v_permlane16_swap_b32 v64, v66
    v_permlane16_swap_b32 v65, v67
    v_permlane16_swap_b32 v72, v74
    v_permlane16_swap_b32 v73, v75
    v_permlane16_swap_b32 v80, v82
    v_permlane16_swap_b32 v81, v83
    v_permlane16_swap_b32 v88, v90
    v_permlane16_swap_b32 v89, v91
    v_add_f32 v64, v64, v66
    v_add_f32 v65, v65, v67
    v_add_f32 v72, v72, v74
    v_add_f32 v73, v73, v75
    v_add_f32 v80, v80, v82
    v_add_f32 v81, v81, v83
    v_add_f32 v88, v88, v90
    v_add_f32 v89, v89, v91
    s_nop 1
    v_add_f32_dpp v64, v64, v64 row_ror:8 row_mask:0xf bank_mask:0xf
    v_add_f32_dpp v65, v65, v65 row_ror:8 row_mask:0xf bank_mask:0xf
    v_add_f32_dpp v72, v72, v72 row_ror:8 row_mask:0xf bank_mask:0xf
    v_add_f32_dpp v73, v73, v73 row_ror:8 row_mask:0xf bank_mask:0xf
    v_add_f32_dpp v80, v80, v80 row_ror:8 row_mask:0xf bank_mask:0xf
    v_add_f32_dpp v81, v81, v81 row_ror:8 row_mask:0xf bank_mask:0xf
    v_add_f32_dpp v88, v88, v88 row_ror:8 row_mask:0xf bank_mask:0xf
    v_add_f32_dpp v89, v89, v89 row_ror:8 row_mask:0xf bank_mask:0xf
    v_lshlrev_b32 v8, 10, v2
    v_lshlrev_b32 v9, 5, v4
    v_add_u32 v8, v8, v9
    v_lshrrev_b32 v9, 5, v1
    v_lshlrev_b32 v9, 4, v9
    v_add_u32 v8, v8, v9
    v_bfe_u32 v9, v1, 4, 1
    v_lshlrev_b32 v9, 3, v9
    v_add_u32 v8, v8, v9
    ds_write_b64 v8, v[64:65] offset:4096
    ds_write_b64 v8, v[72:73] offset:4352
    ds_write_b64 v8, v[80:81] offset:4608
    ds_write_b64 v8, v[88:89] offset:4864
    s_waitcnt lgkmcnt(0)
    s_barrier
    v_lshlrev_b32 v8, 2, v0
    ds_read_b32 v12, v8 offset:4096
    ds_read_b32 v13, v8 offset:5120
    ds_read_b32 v14, v8 offset:6144
    ds_read_b32 v15, v8 offset:7168
    s_waitcnt lgkmcnt(0)
    v_add_f32 v12, v12, v13
    v_add_f32 v14, v14, v15
    v_add_f32 v12, v12, v14
    v_mul_u32_u24 v8, 2560, v2
    v_lshlrev_b32 v9, 2, v1
    v_add_u32 v8, v8, v9
    s_lshl_b32 s10, s2, 8
    s_add_u32 s10, s10, 262144
    buffer_atomic_add_f32 v12, v8, s[16:19], s10 offen
L_wo_done:
    s_endpgm
.globl gateup_kernel
.p2align 8
.type gateup_kernel,@function
gateup_kernel:
    s_cmp_ge_u32 s2, 96
    s_cbranch_scc1 L_gu_done
    s_load_dwordx2 s[4:5], s[0:1], 0
    s_load_dwordx4 s[8:11], s[0:1], 56
    s_load_dwordx2 s[6:7], s[0:1], 96
    v_and_b32 v1, 63, v0
    v_lshrrev_b32 v2, 6, v0
    s_nop 1
    v_readfirstlane_b32 s30, v2
    v_and_b32 v3, 3, v2
    v_mul_u32_u24 v3, 160, v3
    v_lshrrev_b32 v4, 1, v1
    v_add_u32 v3, v3, v4
    v_mul_u32_u24 v5, 3072, v3
    v_and_b32 v4, 1, v1
    v_lshlrev_b32 v4, 4, v4
    v_add_u32 v5, v5, v4
    s_waitcnt lgkmcnt(0)
    s_mov_b32 s12, s4
    s_and_b32 s13, s5, 0xffff
    s_mov_b32 s14, 0x1400
    s_mov_b32 s15, 0x00020000
    s_mov_b32 s16, s6
    s_and_b32 s17, s7, 0xffff
    s_mov_b32 s18, 0x60000
    s_mov_b32 s19, 0x00020000
    s_cmp_lt_u32 s30, 4
    s_cselect_b32 s20, s8, s10
    s_cselect_b32 s21, s9, s11
    s_and_b32 s21, s21, 0xffff
    s_mov_b32 s22, 1966080
    s_mov_b32 s23, 0x00020000
    s_lshl_b32 s24, s2, 5
    s_add_u32 s25, s24, 0
    buffer_load_dwordx4 v[16:19], v5, s[20:23], s25 offen
    s_add_u32 s25, s24, 98304
    buffer_load_dwordx4 v[20:23], v5, s[20:23], s25 offen
    s_add_u32 s25, s24, 196608
    buffer_load_dwordx4 v[24:27], v5, s[20:23], s25 offen
    s_add_u32 s25, s24, 294912
    buffer_load_dwordx4 v[28:31], v5, s[20:23], s25 offen
    s_add_u32 s25, s24, 393216
    buffer_load_dwordx4 v[32:35], v5, s[20:23], s25 offen
    s_cmp_ge_u32 s30, 4
    s_cbranch_scc1 L_gu_skipln
    s_mov_b32 s46, 262144
    v_mul_u32_u24 v63, 640, v2
    v_add_u32 v63, v63, v1
    v_lshlrev_b32 v60, 2, v63
    v_lshlrev_b32 v61, 1, v63
    buffer_load_dword v40, v60, s[16:19], s46 offen offset:0
    buffer_load_dword v41, v60, s[16:19], s46 offen offset:256
    buffer_load_dword v42, v60, s[16:19], s46 offen offset:512
    buffer_load_dword v43, v60, s[16:19], s46 offen offset:768
    buffer_load_dword v44, v60, s[16:19], s46 offen offset:1024
    buffer_load_dword v45, v60, s[16:19], s46 offen offset:1280
    buffer_load_dword v46, v60, s[16:19], s46 offen offset:1536
    buffer_load_dword v47, v60, s[16:19], s46 offen offset:1792
    buffer_load_dword v48, v60, s[16:19], s46 offen offset:2048
    buffer_load_dword v49, v60, s[16:19], s46 offen offset:2304
    buffer_load_ushort v50, v61, s[12:15], 0 offen offset:0
    buffer_load_ushort v51, v61, s[12:15], 0 offen offset:128
    buffer_load_ushort v52, v61, s[12:15], 0 offen offset:256
    buffer_load_ushort v53, v61, s[12:15], 0 offen offset:384
    buffer_load_ushort v54, v61, s[12:15], 0 offen offset:512
    buffer_load_ushort v55, v61, s[12:15], 0 offen offset:640
    buffer_load_ushort v56, v61, s[12:15], 0 offen offset:768
    buffer_load_ushort v57, v61, s[12:15], 0 offen offset:896
    buffer_load_ushort v58, v61, s[12:15], 0 offen offset:1024
    buffer_load_ushort v59, v61, s[12:15], 0 offen offset:1152
    s_waitcnt vmcnt(0)
    v_cvt_pk_bf16_f32 v40, v40, v40
    v_lshlrev_b32 v40, 16, v40
    v_lshlrev_b32 v50, 16, v50
    v_add_f32 v40, v40, v50
    v_cvt_pk_bf16_f32 v40, v40, v40
    v_lshlrev_b32 v40, 16, v40
    v_cvt_pk_bf16_f32 v41, v41, v41
    v_lshlrev_b32 v41, 16, v41
    v_lshlrev_b32 v51, 16, v51
    v_add_f32 v41, v41, v51
    v_cvt_pk_bf16_f32 v41, v41, v41
    v_lshlrev_b32 v41, 16, v41
    v_cvt_pk_bf16_f32 v42, v42, v42
    v_lshlrev_b32 v42, 16, v42
    v_lshlrev_b32 v52, 16, v52
    v_add_f32 v42, v42, v52
    v_cvt_pk_bf16_f32 v42, v42, v42
    v_lshlrev_b32 v42, 16, v42
    v_cvt_pk_bf16_f32 v43, v43, v43
    v_lshlrev_b32 v43, 16, v43
    v_lshlrev_b32 v53, 16, v53
    v_add_f32 v43, v43, v53
    v_cvt_pk_bf16_f32 v43, v43, v43
    v_lshlrev_b32 v43, 16, v43
    v_cvt_pk_bf16_f32 v44, v44, v44
    v_lshlrev_b32 v44, 16, v44
    v_lshlrev_b32 v54, 16, v54
    v_add_f32 v44, v44, v54
    v_cvt_pk_bf16_f32 v44, v44, v44
    v_lshlrev_b32 v44, 16, v44
    v_cvt_pk_bf16_f32 v45, v45, v45
    v_lshlrev_b32 v45, 16, v45
    v_lshlrev_b32 v55, 16, v55
    v_add_f32 v45, v45, v55
    v_cvt_pk_bf16_f32 v45, v45, v45
    v_lshlrev_b32 v45, 16, v45
    v_cvt_pk_bf16_f32 v46, v46, v46
    v_lshlrev_b32 v46, 16, v46
    v_lshlrev_b32 v56, 16, v56
    v_add_f32 v46, v46, v56
    v_cvt_pk_bf16_f32 v46, v46, v46
    v_lshlrev_b32 v46, 16, v46
    v_cvt_pk_bf16_f32 v47, v47, v47
    v_lshlrev_b32 v47, 16, v47
    v_lshlrev_b32 v57, 16, v57
    v_add_f32 v47, v47, v57
    v_cvt_pk_bf16_f32 v47, v47, v47
    v_lshlrev_b32 v47, 16, v47
    v_cvt_pk_bf16_f32 v48, v48, v48
    v_lshlrev_b32 v48, 16, v48
    v_lshlrev_b32 v58, 16, v58
    v_add_f32 v48, v48, v58
    v_cvt_pk_bf16_f32 v48, v48, v48
    v_lshlrev_b32 v48, 16, v48
    v_cvt_pk_bf16_f32 v49, v49, v49
    v_lshlrev_b32 v49, 16, v49
    v_lshlrev_b32 v59, 16, v59
    v_add_f32 v49, v49, v59
    v_cvt_pk_bf16_f32 v49, v49, v49
    v_lshlrev_b32 v49, 16, v49
    v_add_f32 v60, v40, v41
    v_add_f32 v60, v60, v42
    v_add_f32 v60, v60, v43
    v_add_f32 v60, v60, v44
    v_add_f32 v60, v60, v45
    v_add_f32 v60, v60, v46
    v_add_f32 v60, v60, v47
    v_add_f32 v60, v60, v48
    v_add_f32 v60, v60, v49
    s_nop 1
    v_add_f32_dpp v60, v60, v60 quad_perm:[1,0,3,2] row_mask:0xf bank_mask:0xf
    s_nop 1
    v_add_f32_dpp v60, v60, v60 quad_perm:[2,3,0,1] row_mask:0xf bank_mask:0xf
    s_nop 1
    v_add_f32_dpp v60, v60, v60 row_half_mirror row_mask:0xf bank_mask:0xf
    s_nop 1
    v_add_f32_dpp v60, v60, v60 row_mirror row_mask:0xf bank_mask:0xf
    s_nop 1
    v_readlane_b32 s47, v60, 0
    v_readlane_b32 s48, v60, 16
    v_readlane_b32 s49, v60, 32
    v_readlane_b32 s50, v60, 48
    s_nop 1
    v_mov_b32 v60, s47
    v_add_f32 v60, s48, v60
    v_add_f32 v60, s49, v60
    v_add_f32 v60, s50, v60
    v_mul_f32 v60, 0x3acccccd, v60
    v_sub_f32 v62, v40, v60
    v_mul_f32 v61, v62, v62
    v_sub_f32 v62, v41, v60
    v_fmac_f32 v61, v62, v62
    v_sub_f32 v62, v42, v60
    v_fmac_f32 v61, v62, v62
    v_sub_f32 v62, v43, v60
    v_fmac_f32 v61, v62, v62
    v_sub_f32 v62, v44, v60
    v_fmac_f32 v61, v62, v62
    v_sub_f32 v62, v45, v60
    v_fmac_f32 v61, v62, v62
    v_sub_f32 v62, v46, v60
    v_fmac_f32 v61, v62, v62
    v_sub_f32 v62, v47, v60
    v_fmac_f32 v61, v62, v62
    v_sub_f32 v62, v48, v60
    v_fmac_f32 v61, v62, v62
    v_sub_f32 v62, v49, v60
    v_fmac_f32 v61, v62, v62
    s_nop 1
    v_add_f32_dpp v61, v61, v61 quad_perm:[1,0,3,2] row_mask:0xf bank_mask:0xf
    s_nop 1
    v_add_f32_dpp v61, v61, v61 quad_perm:[2,3,0,1] row_mask:0xf bank_mask:0xf
    s_nop 1
    v_add_f32_dpp v61, v61, v61 row_half_mirror row_mask:0xf bank_mask:0xf
    s_nop 1
    v_add_f32_dpp v61, v61, v61 row_mirror row_mask:0xf bank_mask:0xf
    s_nop 1
    v_readlane_b32 s47, v61, 0
    v_readlane_b32 s48, v61, 16
    v_readlane_b32 s49, v61, 32
    v_readlane_b32 s50, v61, 48
    s_nop 1
    v_mov_b32 v61, s47
    v_add_f32 v61, s48, v61
    v_add_f32 v61, s49, v61
    v_add_f32 v61, s50, v61
    v_mul_f32 v61, 0x3acccccd, v61
    v_cvt_pk_bf16_f32 v60, v60, v60
    v_lshlrev_b32 v60, 16, v60
    v_cvt_pk_bf16_f32 v61, v61, v61
    v_lshlrev_b32 v61, 16, v61
    v_add_f32 v61, 0x3727c5ac, v61
    v_cvt_pk_bf16_f32 v61, v61, v61
    v_lshlrev_b32 v61, 16, v61
    v_sqrt_f32 v61, v61
    s_nop 0
    v_cvt_pk_bf16_f32 v61, v61, v61
    v_lshlrev_b32 v61, 16, v61
    v_rcp_f32 v61, v61
    s_nop 0
    v_sub_f32 v50, v40, v60
    v_cvt_pk_bf16_f32 v50, v50, v50
    v_lshlrev_b32 v50, 16, v50
    v_mul_f32 v50, v50, v61
    v_cvt_pk_bf16_f32 v50, v50, v50
    v_lshlrev_b32 v50, 16, v50
    v_sub_f32 v51, v41, v60
    v_cvt_pk_bf16_f32 v51, v51, v51
    v_lshlrev_b32 v51, 16, v51
    v_mul_f32 v51, v51, v61
    v_cvt_pk_bf16_f32 v51, v51, v51
    v_lshlrev_b32 v51, 16, v51
    v_sub_f32 v52, v42, v60
    v_cvt_pk_bf16_f32 v52, v52, v52
    v_lshlrev_b32 v52, 16, v52
    v_mul_f32 v52, v52, v61
    v_cvt_pk_bf16_f32 v52, v52, v52
    v_lshlrev_b32 v52, 16, v52
    v_sub_f32 v53, v43, v60
    v_cvt_pk_bf16_f32 v53, v53, v53
    v_lshlrev_b32 v53, 16, v53
    v_mul_f32 v53, v53, v61
    v_cvt_pk_bf16_f32 v53, v53, v53
    v_lshlrev_b32 v53, 16, v53
    v_sub_f32 v54, v44, v60
    v_cvt_pk_bf16_f32 v54, v54, v54
    v_lshlrev_b32 v54, 16, v54
    v_mul_f32 v54, v54, v61
    v_cvt_pk_bf16_f32 v54, v54, v54
    v_lshlrev_b32 v54, 16, v54
    v_sub_f32 v55, v45, v60
    v_cvt_pk_bf16_f32 v55, v55, v55
    v_lshlrev_b32 v55, 16, v55
    v_mul_f32 v55, v55, v61
    v_cvt_pk_bf16_f32 v55, v55, v55
    v_lshlrev_b32 v55, 16, v55
    v_sub_f32 v56, v46, v60
    v_cvt_pk_bf16_f32 v56, v56, v56
    v_lshlrev_b32 v56, 16, v56
    v_mul_f32 v56, v56, v61
    v_cvt_pk_bf16_f32 v56, v56, v56
    v_lshlrev_b32 v56, 16, v56
    v_sub_f32 v57, v47, v60
    v_cvt_pk_bf16_f32 v57, v57, v57
    v_lshlrev_b32 v57, 16, v57
    v_mul_f32 v57, v57, v61
    v_cvt_pk_bf16_f32 v57, v57, v57
    v_lshlrev_b32 v57, 16, v57
    v_sub_f32 v58, v48, v60
    v_cvt_pk_bf16_f32 v58, v58, v58
    v_lshlrev_b32 v58, 16, v58
    v_mul_f32 v58, v58, v61
    v_cvt_pk_bf16_f32 v58, v58, v58
    v_lshlrev_b32 v58, 16, v58
    v_sub_f32 v59, v49, v60
    v_cvt_pk_bf16_f32 v59, v59, v59
    v_lshlrev_b32 v59, 16, v59
    v_mul_f32 v59, v59, v61
    v_cvt_pk_bf16_f32 v59, v59, v59
    v_lshlrev_b32 v59, 16, v59
    v_lshlrev_b32 v60, 4, v1
    v_lshlrev_b32 v61, 2, v2
    v_add_u32 v60, v60, v61
    ds_write_b32 v60, v50 offset:0
    ds_write_b32 v60, v51 offset:1024
    ds_write_b32 v60, v52 offset:2048
    ds_write_b32 v60, v53 offset:3072
    ds_write_b32 v60, v54 offset:4096
    ds_write_b32 v60, v55 offset:5120
    ds_write_b32 v60, v56 offset:6144
    ds_write_b32 v60, v57 offset:7168
    ds_write_b32 v60, v58 offset:8192
    ds_write_b32 v60, v59 offset:9216
L_gu_skipln:
    s_waitcnt lgkmcnt(0)
    s_barrier
    v_lshlrev_b32 v8, 4, v3
    ds_read_b128 v[40:43], v8 offset:0
    ds_read_b128 v[44:47], v8 offset:512
    ds_read_b128 v[48:51], v8 offset:1024
    ds_read_b128 v[52:55], v8 offset:1536
    ds_read_b128 v[56:59], v8 offset:2048
    s_waitcnt vmcnt(0) lgkmcnt(0)
    v_lshlrev_b32 v10, 16, v16
    v_and_b32 v11, 0xffff0000, v16
    v_mul_f32 v64, v40, v10
    v_mul_f32 v65, v40, v11
    v_mul_f32 v72, v41, v10
    v_mul_f32 v73, v41, v11
    v_mul_f32 v80, v42, v10
    v_mul_f32 v81, v42, v11
    v_mul_f32 v88, v43, v10
    v_mul_f32 v89, v43, v11
    v_lshlrev_b32 v10, 16, v17
    v_and_b32 v11, 0xffff0000, v17
    v_mul_f32 v66, v40, v10
    v_mul_f32 v67, v40, v11
    v_mul_f32 v74, v41, v10
    v_mul_f32 v75, v41, v11
    v_mul_f32 v82, v42, v10
    v_mul_f32 v83, v42, v11
    v_mul_f32 v90, v43, v10
    v_mul_f32 v91, v43, v11
    v_lshlrev_b32 v10, 16, v18
    v_and_b32 v11, 0xffff0000, v18
    v_mul_f32 v68, v40, v10
    v_mul_f32 v69, v40, v11
    v_mul_f32 v76, v41, v10
    v_mul_f32 v77, v41, v11
    v_mul_f32 v84, v42, v10
    v_mul_f32 v85, v42, v11
    v_mul_f32 v92, v43, v10
    v_mul_f32 v93, v43, v11
    v_lshlrev_b32 v10, 16, v19
    v_and_b32 v11, 0xffff0000, v19
    v_mul_f32 v70, v40, v10
    v_mul_f32 v71, v40, v11
    v_mul_f32 v78, v41, v10
    v_mul_f32 v79, v41, v11
    v_mul_f32 v86, v42, v10
    v_mul_f32 v87, v42, v11
    v_mul_f32 v94, v43, v10
    v_mul_f32 v95, v43, v11
    v_lshlrev_b32 v10, 16, v20
    v_and_b32 v11, 0xffff0000, v20
    v_fmac_f32 v64, v44, v10
    v_fmac_f32 v65, v44, v11
    v_fmac_f32 v72, v45, v10
    v_fmac_f32 v73, v45, v11
    v_fmac_f32 v80, v46, v10
    v_fmac_f32 v81, v46, v11
    v_fmac_f32 v88, v47, v10
    v_fmac_f32 v89, v47, v11
    v_lshlrev_b32 v10, 16, v21
    v_and_b32 v11, 0xffff0000, v21
    v_fmac_f32 v66, v44, v10
    v_fmac_f32 v67, v44, v11
    v_fmac_f32 v74, v45, v10
    v_fmac_f32 v75, v45, v11
    v_fmac_f32 v82, v46, v10
    v_fmac_f32 v83, v46, v11
    v_fmac_f32 v90, v47, v10
    v_fmac_f32 v91, v47, v11
    v_lshlrev_b32 v10, 16, v22
    v_and_b32 v11, 0xffff0000, v22
    v_fmac_f32 v68, v44, v10
    v_fmac_f32 v69, v44, v11
    v_fmac_f32 v76, v45, v10
    v_fmac_f32 v77, v45, v11
    v_fmac_f32 v84, v46, v10
    v_fmac_f32 v85, v46, v11
    v_fmac_f32 v92, v47, v10
    v_fmac_f32 v93, v47, v11
    v_lshlrev_b32 v10, 16, v23
    v_and_b32 v11, 0xffff0000, v23
    v_fmac_f32 v70, v44, v10
    v_fmac_f32 v71, v44, v11
    v_fmac_f32 v78, v45, v10
    v_fmac_f32 v79, v45, v11
    v_fmac_f32 v86, v46, v10
    v_fmac_f32 v87, v46, v11
    v_fmac_f32 v94, v47, v10
    v_fmac_f32 v95, v47, v11
    v_lshlrev_b32 v10, 16, v24
    v_and_b32 v11, 0xffff0000, v24
    v_fmac_f32 v64, v48, v10
    v_fmac_f32 v65, v48, v11
    v_fmac_f32 v72, v49, v10
    v_fmac_f32 v73, v49, v11
    v_fmac_f32 v80, v50, v10
    v_fmac_f32 v81, v50, v11
    v_fmac_f32 v88, v51, v10
    v_fmac_f32 v89, v51, v11
    v_lshlrev_b32 v10, 16, v25
    v_and_b32 v11, 0xffff0000, v25
    v_fmac_f32 v66, v48, v10
    v_fmac_f32 v67, v48, v11
    v_fmac_f32 v74, v49, v10
    v_fmac_f32 v75, v49, v11
    v_fmac_f32 v82, v50, v10
    v_fmac_f32 v83, v50, v11
    v_fmac_f32 v90, v51, v10
    v_fmac_f32 v91, v51, v11
    v_lshlrev_b32 v10, 16, v26
    v_and_b32 v11, 0xffff0000, v26
    v_fmac_f32 v68, v48, v10
    v_fmac_f32 v69, v48, v11
    v_fmac_f32 v76, v49, v10
    v_fmac_f32 v77, v49, v11
    v_fmac_f32 v84, v50, v10
    v_fmac_f32 v85, v50, v11
    v_fmac_f32 v92, v51, v10
    v_fmac_f32 v93, v51, v11
    v_lshlrev_b32 v10, 16, v27
    v_and_b32 v11, 0xffff0000, v27
    v_fmac_f32 v70, v48, v10
    v_fmac_f32 v71, v48, v11
    v_fmac_f32 v78, v49, v10
    v_fmac_f32 v79, v49, v11
    v_fmac_f32 v86, v50, v10
    v_fmac_f32 v87, v50, v11
    v_fmac_f32 v94, v51, v10
    v_fmac_f32 v95, v51, v11
    v_lshlrev_b32 v10, 16, v28
    v_and_b32 v11, 0xffff0000, v28
    v_fmac_f32 v64, v52, v10
    v_fmac_f32 v65, v52, v11
    v_fmac_f32 v72, v53, v10
    v_fmac_f32 v73, v53, v11
    v_fmac_f32 v80, v54, v10
    v_fmac_f32 v81, v54, v11
    v_fmac_f32 v88, v55, v10
    v_fmac_f32 v89, v55, v11
    v_lshlrev_b32 v10, 16, v29
    v_and_b32 v11, 0xffff0000, v29
    v_fmac_f32 v66, v52, v10
    v_fmac_f32 v67, v52, v11
    v_fmac_f32 v74, v53, v10
    v_fmac_f32 v75, v53, v11
    v_fmac_f32 v82, v54, v10
    v_fmac_f32 v83, v54, v11
    v_fmac_f32 v90, v55, v10
    v_fmac_f32 v91, v55, v11
    v_lshlrev_b32 v10, 16, v30
    v_and_b32 v11, 0xffff0000, v30
    v_fmac_f32 v68, v52, v10
    v_fmac_f32 v69, v52, v11
    v_fmac_f32 v76, v53, v10
    v_fmac_f32 v77, v53, v11
    v_fmac_f32 v84, v54, v10
    v_fmac_f32 v85, v54, v11
    v_fmac_f32 v92, v55, v10
    v_fmac_f32 v93, v55, v11
    v_lshlrev_b32 v10, 16, v31
    v_and_b32 v11, 0xffff0000, v31
    v_fmac_f32 v70, v52, v10
    v_fmac_f32 v71, v52, v11
    v_fmac_f32 v78, v53, v10
    v_fmac_f32 v79, v53, v11
    v_fmac_f32 v86, v54, v10
    v_fmac_f32 v87, v54, v11
    v_fmac_f32 v94, v55, v10
    v_fmac_f32 v95, v55, v11
    v_lshlrev_b32 v10, 16, v32
    v_and_b32 v11, 0xffff0000, v32
    v_fmac_f32 v64, v56, v10
    v_fmac_f32 v65, v56, v11
    v_fmac_f32 v72, v57, v10
    v_fmac_f32 v73, v57, v11
    v_fmac_f32 v80, v58, v10
    v_fmac_f32 v81, v58, v11
    v_fmac_f32 v88, v59, v10
    v_fmac_f32 v89, v59, v11
    v_lshlrev_b32 v10, 16, v33
    v_and_b32 v11, 0xffff0000, v33
    v_fmac_f32 v66, v56, v10
    v_fmac_f32 v67, v56, v11
    v_fmac_f32 v74, v57, v10
    v_fmac_f32 v75, v57, v11
    v_fmac_f32 v82, v58, v10
    v_fmac_f32 v83, v58, v11
    v_fmac_f32 v90, v59, v10
    v_fmac_f32 v91, v59, v11
    v_lshlrev_b32 v10, 16, v34
    v_and_b32 v11, 0xffff0000, v34
    v_fmac_f32 v68, v56, v10
    v_fmac_f32 v69, v56, v11
    v_fmac_f32 v76, v57, v10
    v_fmac_f32 v77, v57, v11
    v_fmac_f32 v84, v58, v10
    v_fmac_f32 v85, v58, v11
    v_fmac_f32 v92, v59, v10
    v_fmac_f32 v93, v59, v11
    v_lshlrev_b32 v10, 16, v35
    v_and_b32 v11, 0xffff0000, v35
    v_fmac_f32 v70, v56, v10
    v_fmac_f32 v71, v56, v11
    v_fmac_f32 v78, v57, v10
    v_fmac_f32 v79, v57, v11
    v_fmac_f32 v86, v58, v10
    v_fmac_f32 v87, v58, v11
    v_fmac_f32 v94, v59, v10
    v_fmac_f32 v95, v59, v11
    s_nop 1
    v_permlane32_swap_b32 v64, v68
    v_permlane32_swap_b32 v65, v69
    v_permlane32_swap_b32 v66, v70
    v_permlane32_swap_b32 v67, v71
    v_permlane32_swap_b32 v72, v76
    v_permlane32_swap_b32 v73, v77
    v_permlane32_swap_b32 v74, v78
    v_permlane32_swap_b32 v75, v79
    v_permlane32_swap_b32 v80, v84
    v_permlane32_swap_b32 v81, v85
    v_permlane32_swap_b32 v82, v86
    v_permlane32_swap_b32 v83, v87
    v_permlane32_swap_b32 v88, v92
    v_permlane32_swap_b32 v89, v93
    v_permlane32_swap_b32 v90, v94
    v_permlane32_swap_b32 v91, v95
    v_add_f32 v64, v64, v68
    v_add_f32 v65, v65, v69
    v_add_f32 v66, v66, v70
    v_add_f32 v67, v67, v71
    v_add_f32 v72, v72, v76
    v_add_f32 v73, v73, v77
    v_add_f32 v74, v74, v78
    v_add_f32 v75, v75, v79
    v_add_f32 v80, v80, v84
    v_add_f32 v81, v81, v85
    v_add_f32 v82, v82, v86
    v_add_f32 v83, v83, v87
    v_add_f32 v88, v88, v92
    v_add_f32 v89, v89, v93
    v_add_f32 v90, v90, v94
    v_add_f32 v91, v91, v95
    s_nop 1
    v_permlane16_swap_b32 v64, v66
    v_permlane16_swap_b32 v65, v67
    v_permlane16_swap_b32 v72, v74
    v_permlane16_swap_b32 v73, v75
    v_permlane16_swap_b32 v80, v82
    v_permlane16_swap_b32 v81, v83
    v_permlane16_swap_b32 v88, v90
    v_permlane16_swap_b32 v89, v91
    v_add_f32 v64, v64, v66
    v_add_f32 v65, v65, v67
    v_add_f32 v72, v72, v74
    v_add_f32 v73, v73, v75
    v_add_f32 v80, v80, v82
    v_add_f32 v81, v81, v83
    v_add_f32 v88, v88, v90
    v_add_f32 v89, v89, v91
    s_nop 1
    v_add_f32_dpp v64, v64, v64 row_ror:8 row_mask:0xf bank_mask:0xf
    v_add_f32_dpp v65, v65, v65 row_ror:8 row_mask:0xf bank_mask:0xf
    v_add_f32_dpp v72, v72, v72 row_ror:8 row_mask:0xf bank_mask:0xf
    v_add_f32_dpp v73, v73, v73 row_ror:8 row_mask:0xf bank_mask:0xf
    v_add_f32_dpp v80, v80, v80 row_ror:8 row_mask:0xf bank_mask:0xf
    v_add_f32_dpp v81, v81, v81 row_ror:8 row_mask:0xf bank_mask:0xf
    v_add_f32_dpp v88, v88, v88 row_ror:8 row_mask:0xf bank_mask:0xf
    v_add_f32_dpp v89, v89, v89 row_ror:8 row_mask:0xf bank_mask:0xf
    s_nop 1
    v_add_f32_dpp v64, v64, v64 row_ror:4 row_mask:0xf bank_mask:0xf
    v_add_f32_dpp v65, v65, v65 row_ror:4 row_mask:0xf bank_mask:0xf
    v_add_f32_dpp v72, v72, v72 row_ror:4 row_mask:0xf bank_mask:0xf
    v_add_f32_dpp v73, v73, v73 row_ror:4 row_mask:0xf bank_mask:0xf
    v_add_f32_dpp v80, v80, v80 row_ror:4 row_mask:0xf bank_mask:0xf
    v_add_f32_dpp v81, v81, v81 row_ror:4 row_mask:0xf bank_mask:0xf
    v_add_f32_dpp v88, v88, v88 row_ror:4 row_mask:0xf bank_mask:0xf
    v_add_f32_dpp v89, v89, v89 row_ror:4 row_mask:0xf bank_mask:0xf
    s_nop 1
    v_add_f32_dpp v64, v64, v64 quad_perm:[2,3,0,1] row_mask:0xf bank_mask:0xf
    v_add_f32_dpp v65, v65, v65 quad_perm:[2,3,0,1] row_mask:0xf bank_mask:0xf
    v_add_f32_dpp v72, v72, v72 quad_perm:[2,3,0,1] row_mask:0xf bank_mask:0xf
    v_add_f32_dpp v73, v73, v73 quad_perm:[2,3,0,1] row_mask:0xf bank_mask:0xf
    v_add_f32_dpp v80, v80, v80 quad_perm:[2,3,0,1] row_mask:0xf bank_mask:0xf
    v_add_f32_dpp v81, v81, v81 quad_perm:[2,3,0,1] row_mask:0xf bank_mask:0xf
    v_add_f32_dpp v88, v88, v88 quad_perm:[2,3,0,1] row_mask:0xf bank_mask:0xf
    v_add_f32_dpp v89, v89, v89 quad_perm:[2,3,0,1] row_mask:0xf bank_mask:0xf
    v_lshlrev_b32 v8, 8, v2
    v_and_b32 v9, 1, v1
    v_lshlrev_b32 v9, 5, v9
    v_add_u32 v8, v8, v9
    v_lshrrev_b32 v9, 5, v1
    v_lshlrev_b32 v9, 4, v9
    v_add_u32 v8, v8, v9
    v_bfe_u32 v9, v1, 4, 1
    v_lshlrev_b32 v9, 3, v9
    v_add_u32 v8, v8, v9
    ds_write_b64 v8, v[64:65] offset:20480
    ds_write_b64 v8, v[72:73] offset:20544
    ds_write_b64 v8, v[80:81] offset:20608
    ds_write_b64 v8, v[88:89] offset:20672
    s_waitcnt lgkmcnt(0)
    s_barrier
    s_cmp_ge_u32 s30, 1
    s_cbranch_scc1 L_gu_done
    v_lshlrev_b32 v8, 2, v1
    ds_read_b32 v16, v8 offset:20480
    ds_read_b32 v17, v8 offset:20736
    ds_read_b32 v18, v8 offset:20992
    ds_read_b32 v19, v8 offset:21248
    ds_read_b32 v20, v8 offset:21504
    ds_read_b32 v21, v8 offset:21760
    ds_read_b32 v22, v8 offset:22016
    ds_read_b32 v23, v8 offset:22272
    s_waitcnt lgkmcnt(0)
    v_add_f32 v16, v16, v17
    v_add_f32 v18, v18, v19
    v_add_f32 v16, v16, v18
    v_add_f32 v20, v20, v21
    v_add_f32 v22, v22, v23
    v_add_f32 v20, v20, v22
    v_cvt_pk_bf16_f32 v16, v16, v16
    v_lshlrev_b32 v16, 16, v16
    v_cvt_pk_bf16_f32 v20, v20, v20
    v_lshlrev_b32 v20, 16, v20
    v_mul_f32 v17, 0xbfb8aa3b, v16
    v_exp_f32 v17, v17
    s_nop 0
    v_add_f32 v17, 1.0, v17
    v_rcp_f32 v17, v17
    s_nop 0
    v_mul_f32 v16, v16, v17
    v_cvt_pk_bf16_f32 v16, v16, v16
    v_lshlrev_b32 v16, 16, v16
    v_mul_f32 v16, v16, v20
    v_cvt_pk_bf16_f32 v16, v16, v16
    v_lshlrev_b32 v16, 16, v16
    v_lshrrev_b32 v8, 4, v1
    v_mul_u32_u24 v8, 6144, v8
    v_and_b32 v9, 15, v1
    v_lshlrev_b32 v9, 2, v9
    v_add_u32 v8, v8, v9
    s_lshl_b32 s25, s2, 6
    s_add_u32 s25, s25, 327680
    buffer_store_dword v16, v8, s[16:19], s25 offen
L_gu_done:
    s_endpgm
.globl down_kernel
.p2align 8
.type down_kernel,@function
down_kernel:
    s_cmp_ge_u32 s2, 80
    s_cbranch_scc1 L_dn_done
    s_load_dwordx2 s[4:5], s[0:1], 0
    s_load_dwordx2 s[8:9], s[0:1], 72
    s_load_dwordx2 s[10:11], s[0:1], 48
    s_load_dwordx2 s[6:7], s[0:1], 96
    s_load_dwordx2 s[26:27], s[0:1], 80
    v_and_b32 v1, 63, v0
    v_lshrrev_b32 v2, 6, v0
    s_nop 1
    v_readfirstlane_b32 s30, v2
    v_mul_u32_u24 v3, 192, v2
    v_add_u32 v3, v3, v1
    v_mul_u32_u24 v5, 1280, v3
    s_waitcnt lgkmcnt(0)
    s_mov_b32 s12, s4
    s_and_b32 s13, s5, 0xffff
    s_mov_b32 s14, 0x1400
    s_mov_b32 s15, 0x00020000
    s_mov_b32 s16, s6
    s_and_b32 s17, s7, 0xffff
    s_mov_b32 s18, 0x60000
    s_mov_b32 s19, 0x00020000
    s_mov_b32 s20, s8
    s_and_b32 s21, s9, 0xffff
    s_mov_b32 s22, 0x1e0000
    s_mov_b32 s23, 0x00020000
    s_mov_b32 s36, s10
    s_and_b32 s37, s11, 0xffff
    s_mov_b32 s38, 0x500
    s_mov_b32 s39, 0x00020000
    s_mov_b32 s40, s26
    s_and_b32 s41, s27, 0xffff
    s_mov_b32 s42, 0x1400
    s_mov_b32 s43, 0x00020000
    s_lshl_b32 s24, s2, 4
    s_add_u32 s25, s24, 0
    buffer_load_dwordx4 v[16:19], v5, s[20:23], s25 offen
    s_add_u32 s25, s24, 81920
    buffer_load_dwordx4 v[20:23], v5, s[20:23], s25 offen
    s_add_u32 s25, s24, 163840
    buffer_load_dwordx4 v[24:27], v5, s[20:23], s25 offen
    v_lshlrev_b32 v6, 2, v3
    s_mov_b32 s25, 327680
    buffer_load_dword v28, v6, s[16:19], s25 offen
    s_mov_b32 s25, 333824
    buffer_load_dword v29, v6, s[16:19], s25 offen
    s_mov_b32 s25, 339968
    buffer_load_dword v30, v6, s[16:19], s25 offen
    s_mov_b32 s25, 346112
    buffer_load_dword v31, v6, s[16:19], s25 offen
    s_mov_b32 s25, 327936
    buffer_load_dword v32, v6, s[16:19], s25 offen
    s_mov_b32 s25, 334080
    buffer_load_dword v33, v6, s[16:19], s25 offen
    s_mov_b32 s25, 340224
    buffer_load_dword v34, v6, s[16:19], s25 offen
    s_mov_b32 s25, 346368
    buffer_load_dword v35, v6, s[16:19], s25 offen
    s_mov_b32 s25, 328192
    buffer_load_dword v36, v6, s[16:19], s25 offen
    s_mov_b32 s25, 334336
    buffer_load_dword v37, v6, s[16:19], s25 offen
    s_mov_b32 s25, 340480
    buffer_load_dword v38, v6, s[16:19], s25 offen
    s_mov_b32 s25, 346624
    buffer_load_dword v39, v6, s[16:19], s25 offen
    s_cmp_ge_u32 s30, 4
    s_cbranch_scc1 L_dn_skipln
    s_mov_b32 s46, 262144
    v_lshlrev_b32 v7, 1, v1
    buffer_load_ushort v100, v7, s[36:39], 0 offen offset:0
    buffer_load_ushort v101, v7, s[36:39], 0 offen offset:128
    buffer_load_ushort v102, v7, s[36:39], 0 offen offset:256
    buffer_load_ushort v103, v7, s[36:39], 0 offen offset:384
    buffer_load_ushort v104, v7, s[36:39], 0 offen offset:512
    buffer_load_ushort v105, v7, s[36:39], 0 offen offset:640
    buffer_load_ushort v106, v7, s[36:39], 0 offen offset:768
    buffer_load_ushort v107, v7, s[36:39], 0 offen offset:896
    buffer_load_ushort v108, v7, s[36:39], 0 offen offset:1024
    buffer_load_ushort v109, v7, s[36:39], 0 offen offset:1152
    v_mul_u32_u24 v63, 640, v2
    v_add_u32 v63, v63, v1
    v_lshlrev_b32 v60, 2, v63
    v_lshlrev_b32 v61, 1, v63
    buffer_load_dword v40, v60, s[16:19], s46 offen offset:0
    buffer_load_dword v41, v60, s[16:19], s46 offen offset:256
    buffer_load_dword v42, v60, s[16:19], s46 offen offset:512
    buffer_load_dword v43, v60, s[16:19], s46 offen offset:768
    buffer_load_dword v44, v60, s[16:19], s46 offen offset:1024
    buffer_load_dword v45, v60, s[16:19], s46 offen offset:1280
    buffer_load_dword v46, v60, s[16:19], s46 offen offset:1536
    buffer_load_dword v47, v60, s[16:19], s46 offen offset:1792
    buffer_load_dword v48, v60, s[16:19], s46 offen offset:2048
    buffer_load_dword v49, v60, s[16:19], s46 offen offset:2304
    buffer_load_ushort v50, v61, s[12:15], 0 offen offset:0
    buffer_load_ushort v51, v61, s[12:15], 0 offen offset:128
    buffer_load_ushort v52, v61, s[12:15], 0 offen offset:256
    buffer_load_ushort v53, v61, s[12:15], 0 offen offset:384
    buffer_load_ushort v54, v61, s[12:15], 0 offen offset:512
    buffer_load_ushort v55, v61, s[12:15], 0 offen offset:640
    buffer_load_ushort v56, v61, s[12:15], 0 offen offset:768
    buffer_load_ushort v57, v61, s[12:15], 0 offen offset:896
    buffer_load_ushort v58, v61, s[12:15], 0 offen offset:1024
    buffer_load_ushort v59, v61, s[12:15], 0 offen offset:1152
    s_waitcnt vmcnt(0)
    v_cvt_pk_bf16_f32 v40, v40, v40
    v_lshlrev_b32 v40, 16, v40
    v_lshlrev_b32 v50, 16, v50
    v_add_f32 v40, v40, v50
    v_cvt_pk_bf16_f32 v40, v40, v40
    v_lshlrev_b32 v40, 16, v40
    v_cvt_pk_bf16_f32 v41, v41, v41
    v_lshlrev_b32 v41, 16, v41
    v_lshlrev_b32 v51, 16, v51
    v_add_f32 v41, v41, v51
    v_cvt_pk_bf16_f32 v41, v41, v41
    v_lshlrev_b32 v41, 16, v41
    v_cvt_pk_bf16_f32 v42, v42, v42
    v_lshlrev_b32 v42, 16, v42
    v_lshlrev_b32 v52, 16, v52
    v_add_f32 v42, v42, v52
    v_cvt_pk_bf16_f32 v42, v42, v42
    v_lshlrev_b32 v42, 16, v42
    v_cvt_pk_bf16_f32 v43, v43, v43
    v_lshlrev_b32 v43, 16, v43
    v_lshlrev_b32 v53, 16, v53
    v_add_f32 v43, v43, v53
    v_cvt_pk_bf16_f32 v43, v43, v43
    v_lshlrev_b32 v43, 16, v43
    v_cvt_pk_bf16_f32 v44, v44, v44
    v_lshlrev_b32 v44, 16, v44
    v_lshlrev_b32 v54, 16, v54
    v_add_f32 v44, v44, v54
    v_cvt_pk_bf16_f32 v44, v44, v44
    v_lshlrev_b32 v44, 16, v44
    v_cvt_pk_bf16_f32 v45, v45, v45
    v_lshlrev_b32 v45, 16, v45
    v_lshlrev_b32 v55, 16, v55
    v_add_f32 v45, v45, v55
    v_cvt_pk_bf16_f32 v45, v45, v45
    v_lshlrev_b32 v45, 16, v45
    v_cvt_pk_bf16_f32 v46, v46, v46
    v_lshlrev_b32 v46, 16, v46
    v_lshlrev_b32 v56, 16, v56
    v_add_f32 v46, v46, v56
    v_cvt_pk_bf16_f32 v46, v46, v46
    v_lshlrev_b32 v46, 16, v46
    v_cvt_pk_bf16_f32 v47, v47, v47
    v_lshlrev_b32 v47, 16, v47
    v_lshlrev_b32 v57, 16, v57
    v_add_f32 v47, v47, v57
    v_cvt_pk_bf16_f32 v47, v47, v47
    v_lshlrev_b32 v47, 16, v47
    v_cvt_pk_bf16_f32 v48, v48, v48
    v_lshlrev_b32 v48, 16, v48
    v_lshlrev_b32 v58, 16, v58
    v_add_f32 v48, v48, v58
    v_cvt_pk_bf16_f32 v48, v48, v48
    v_lshlrev_b32 v48, 16, v48
    v_cvt_pk_bf16_f32 v49, v49, v49
    v_lshlrev_b32 v49, 16, v49
    v_lshlrev_b32 v59, 16, v59
    v_add_f32 v49, v49, v59
    v_cvt_pk_bf16_f32 v49, v49, v49
    v_lshlrev_b32 v49, 16, v49
    v_add_f32 v60, v40, v41
    v_add_f32 v60, v60, v42
    v_add_f32 v60, v60, v43
    v_add_f32 v60, v60, v44
    v_add_f32 v60, v60, v45
    v_add_f32 v60, v60, v46
    v_add_f32 v60, v60, v47
    v_add_f32 v60, v60, v48
    v_add_f32 v60, v60, v49
    s_nop 1
    v_add_f32_dpp v60, v60, v60 quad_perm:[1,0,3,2] row_mask:0xf bank_mask:0xf
    s_nop 1
    v_add_f32_dpp v60, v60, v60 quad_perm:[2,3,0,1] row_mask:0xf bank_mask:0xf
    s_nop 1
    v_add_f32_dpp v60, v60, v60 row_half_mirror row_mask:0xf bank_mask:0xf
    s_nop 1
    v_add_f32_dpp v60, v60, v60 row_mirror row_mask:0xf bank_mask:0xf
    s_nop 1
    v_readlane_b32 s47, v60, 0
    v_readlane_b32 s48, v60, 16
    v_readlane_b32 s49, v60, 32
    v_readlane_b32 s50, v60, 48
    s_nop 1
    v_mov_b32 v60, s47
    v_add_f32 v60, s48, v60
    v_add_f32 v60, s49, v60
    v_add_f32 v60, s50, v60
    v_mul_f32 v60, 0x3acccccd, v60
    v_sub_f32 v62, v40, v60
    v_mul_f32 v61, v62, v62
    v_sub_f32 v62, v41, v60
    v_fmac_f32 v61, v62, v62
    v_sub_f32 v62, v42, v60
    v_fmac_f32 v61, v62, v62
    v_sub_f32 v62, v43, v60
    v_fmac_f32 v61, v62, v62
    v_sub_f32 v62, v44, v60
    v_fmac_f32 v61, v62, v62
    v_sub_f32 v62, v45, v60
    v_fmac_f32 v61, v62, v62
    v_sub_f32 v62, v46, v60
    v_fmac_f32 v61, v62, v62
    v_sub_f32 v62, v47, v60
    v_fmac_f32 v61, v62, v62
    v_sub_f32 v62, v48, v60
    v_fmac_f32 v61, v62, v62
    v_sub_f32 v62, v49, v60
    v_fmac_f32 v61, v62, v62
    s_nop 1
    v_add_f32_dpp v61, v61, v61 quad_perm:[1,0,3,2] row_mask:0xf bank_mask:0xf
    s_nop 1
    v_add_f32_dpp v61, v61, v61 quad_perm:[2,3,0,1] row_mask:0xf bank_mask:0xf
    s_nop 1
    v_add_f32_dpp v61, v61, v61 row_half_mirror row_mask:0xf bank_mask:0xf
    s_nop 1
    v_add_f32_dpp v61, v61, v61 row_mirror row_mask:0xf bank_mask:0xf
    s_nop 1
    v_readlane_b32 s47, v61, 0
    v_readlane_b32 s48, v61, 16
    v_readlane_b32 s49, v61, 32
    v_readlane_b32 s50, v61, 48
    s_nop 1
    v_mov_b32 v61, s47
    v_add_f32 v61, s48, v61
    v_add_f32 v61, s49, v61
    v_add_f32 v61, s50, v61
    v_mul_f32 v61, 0x3acccccd, v61
    v_cvt_pk_bf16_f32 v60, v60, v60
    v_lshlrev_b32 v60, 16, v60
    v_cvt_pk_bf16_f32 v61, v61, v61
    v_lshlrev_b32 v61, 16, v61
    v_add_f32 v61, 0x3727c5ac, v61
    v_cvt_pk_bf16_f32 v61, v61, v61
    v_lshlrev_b32 v61, 16, v61
    v_sqrt_f32 v61, v61
    s_nop 0
    v_cvt_pk_bf16_f32 v61, v61, v61
    v_lshlrev_b32 v61, 16, v61
    v_rcp_f32 v61, v61
    s_nop 0
    v_sub_f32 v50, v40, v60
    v_cvt_pk_bf16_f32 v50, v50, v50
    v_lshlrev_b32 v50, 16, v50
    v_mul_f32 v50, v50, v61
    v_cvt_pk_bf16_f32 v50, v50, v50
    v_lshlrev_b32 v50, 16, v50
    v_sub_f32 v51, v41, v60
    v_cvt_pk_bf16_f32 v51, v51, v51
    v_lshlrev_b32 v51, 16, v51
    v_mul_f32 v51, v51, v61
    v_cvt_pk_bf16_f32 v51, v51, v51
    v_lshlrev_b32 v51, 16, v51
    v_sub_f32 v52, v42, v60
    v_cvt_pk_bf16_f32 v52, v52, v52
    v_lshlrev_b32 v52, 16, v52
    v_mul_f32 v52, v52, v61
    v_cvt_pk_bf16_f32 v52, v52, v52
    v_lshlrev_b32 v52, 16, v52
    v_sub_f32 v53, v43, v60
    v_cvt_pk_bf16_f32 v53, v53, v53
    v_lshlrev_b32 v53, 16, v53
    v_mul_f32 v53, v53, v61
    v_cvt_pk_bf16_f32 v53, v53, v53
    v_lshlrev_b32 v53, 16, v53
    v_sub_f32 v54, v44, v60
    v_cvt_pk_bf16_f32 v54, v54, v54
    v_lshlrev_b32 v54, 16, v54
    v_mul_f32 v54, v54, v61
    v_cvt_pk_bf16_f32 v54, v54, v54
    v_lshlrev_b32 v54, 16, v54
    v_sub_f32 v55, v45, v60
    v_cvt_pk_bf16_f32 v55, v55, v55
    v_lshlrev_b32 v55, 16, v55
    v_mul_f32 v55, v55, v61
    v_cvt_pk_bf16_f32 v55, v55, v55
    v_lshlrev_b32 v55, 16, v55
    v_sub_f32 v56, v46, v60
    v_cvt_pk_bf16_f32 v56, v56, v56
    v_lshlrev_b32 v56, 16, v56
    v_mul_f32 v56, v56, v61
    v_cvt_pk_bf16_f32 v56, v56, v56
    v_lshlrev_b32 v56, 16, v56
    v_sub_f32 v57, v47, v60
    v_cvt_pk_bf16_f32 v57, v57, v57
    v_lshlrev_b32 v57, 16, v57
    v_mul_f32 v57, v57, v61
    v_cvt_pk_bf16_f32 v57, v57, v57
    v_lshlrev_b32 v57, 16, v57
    v_sub_f32 v58, v48, v60
    v_cvt_pk_bf16_f32 v58, v58, v58
    v_lshlrev_b32 v58, 16, v58
    v_mul_f32 v58, v58, v61
    v_cvt_pk_bf16_f32 v58, v58, v58
    v_lshlrev_b32 v58, 16, v58
    v_sub_f32 v59, v49, v60
    v_cvt_pk_bf16_f32 v59, v59, v59
    v_lshlrev_b32 v59, 16, v59
    v_mul_f32 v59, v59, v61
    v_cvt_pk_bf16_f32 v59, v59, v59
    v_lshlrev_b32 v59, 16, v59
    v_lshlrev_b32 v60, 4, v1
    v_lshlrev_b32 v61, 2, v2
    v_add_u32 v60, v60, v61
    ds_write_b32 v60, v50 offset:0
    ds_write_b32 v60, v51 offset:1024
    ds_write_b32 v60, v52 offset:2048
    ds_write_b32 v60, v53 offset:3072
    ds_write_b32 v60, v54 offset:4096
    ds_write_b32 v60, v55 offset:5120
    ds_write_b32 v60, v56 offset:6144
    ds_write_b32 v60, v57 offset:7168
    ds_write_b32 v60, v58 offset:8192
    ds_write_b32 v60, v59 offset:9216
    ds_write_b32 v60, v40 offset:10240
    ds_write_b32 v60, v41 offset:11264
    ds_write_b32 v60, v42 offset:12288
    ds_write_b32 v60, v43 offset:13312
    ds_write_b32 v60, v44 offset:14336
    ds_write_b32 v60, v45 offset:15360
    ds_write_b32 v60, v46 offset:16384
    ds_write_b32 v60, v47 offset:17408
    ds_write_b32 v60, v48 offset:18432
    ds_write_b32 v60, v49 offset:19456
    v_lshlrev_b32 v100, 16, v100
    v_lshlrev_b32 v101, 16, v101
    v_lshlrev_b32 v102, 16, v102
    v_lshlrev_b32 v103, 16, v103
    v_lshlrev_b32 v104, 16, v104
    v_lshlrev_b32 v105, 16, v105
    v_lshlrev_b32 v106, 16, v106
    v_lshlrev_b32 v107, 16, v107
    v_lshlrev_b32 v108, 16, v108
    v_lshlrev_b32 v109, 16, v109
    v_mul_f32 v7, v50, v100
    v_fmac_f32 v7, v51, v101
    v_fmac_f32 v7, v52, v102
    v_fmac_f32 v7, v53, v103
    v_fmac_f32 v7, v54, v104
    v_fmac_f32 v7, v55, v105
    v_fmac_f32 v7, v56, v106
    v_fmac_f32 v7, v57, v107
    v_fmac_f32 v7, v58, v108
    v_fmac_f32 v7, v59, v109
    s_nop 1
    v_add_f32_dpp v7, v7, v7 quad_perm:[1,0,3,2] row_mask:0xf bank_mask:0xf
    s_nop 1
    v_add_f32_dpp v7, v7, v7 quad_perm:[2,3,0,1] row_mask:0xf bank_mask:0xf
    s_nop 1
    v_add_f32_dpp v7, v7, v7 row_half_mirror row_mask:0xf bank_mask:0xf
    s_nop 1
    v_add_f32_dpp v7, v7, v7 row_mirror row_mask:0xf bank_mask:0xf
    s_nop 1
    v_readlane_b32 s47, v7, 0
    v_readlane_b32 s48, v7, 16
    v_readlane_b32 s49, v7, 32
    v_readlane_b32 s50, v7, 48
    s_nop 1
    v_mov_b32 v7, s47
    v_add_f32 v7, s48, v7
    v_add_f32 v7, s49, v7
    v_add_f32 v7, s50, v7
    v_cvt_pk_bf16_f32 v7, v7, v7
    v_lshlrev_b32 v7, 16, v7
    v_mul_f32 v7, 0xbfb8aa3b, v7
    v_exp_f32 v7, v7
    s_nop 0
    v_add_f32 v7, 1.0, v7
    v_rcp_f32 v7, v7
    s_nop 0
    v_cvt_pk_bf16_f32 v7, v7, v7
    v_lshlrev_b32 v7, 16, v7
    v_lshlrev_b32 v8, 2, v2
    ds_write_b32 v8, v7 offset:20480
L_dn_skipln:
    s_waitcnt vmcnt(0)
    v_lshlrev_b32 v10, 16, v16
    v_and_b32 v11, 0xffff0000, v16
    v_mul_f32 v64, v28, v10
    v_mul_f32 v65, v28, v11
    v_mul_f32 v72, v29, v10
    v_mul_f32 v73, v29, v11
    v_mul_f32 v80, v30, v10
    v_mul_f32 v81, v30, v11
    v_mul_f32 v88, v31, v10
    v_mul_f32 v89, v31, v11
    v_lshlrev_b32 v10, 16, v17
    v_and_b32 v11, 0xffff0000, v17
    v_mul_f32 v66, v28, v10
    v_mul_f32 v67, v28, v11
    v_mul_f32 v74, v29, v10
    v_mul_f32 v75, v29, v11
    v_mul_f32 v82, v30, v10
    v_mul_f32 v83, v30, v11
    v_mul_f32 v90, v31, v10
    v_mul_f32 v91, v31, v11
    v_lshlrev_b32 v10, 16, v18
    v_and_b32 v11, 0xffff0000, v18
    v_mul_f32 v68, v28, v10
    v_mul_f32 v69, v28, v11
    v_mul_f32 v76, v29, v10
    v_mul_f32 v77, v29, v11
    v_mul_f32 v84, v30, v10
    v_mul_f32 v85, v30, v11
    v_mul_f32 v92, v31, v10
    v_mul_f32 v93, v31, v11
    v_lshlrev_b32 v10, 16, v19
    v_and_b32 v11, 0xffff0000, v19
    v_mul_f32 v70, v28, v10
    v_mul_f32 v71, v28, v11
    v_mul_f32 v78, v29, v10
    v_mul_f32 v79, v29, v11
    v_mul_f32 v86, v30, v10
    v_mul_f32 v87, v30, v11
    v_mul_f32 v94, v31, v10
    v_mul_f32 v95, v31, v11
    v_lshlrev_b32 v10, 16, v20
    v_and_b32 v11, 0xffff0000, v20
    v_fmac_f32 v64, v32, v10
    v_fmac_f32 v65, v32, v11
    v_fmac_f32 v72, v33, v10
    v_fmac_f32 v73, v33, v11
    v_fmac_f32 v80, v34, v10
    v_fmac_f32 v81, v34, v11
    v_fmac_f32 v88, v35, v10
    v_fmac_f32 v89, v35, v11
    v_lshlrev_b32 v10, 16, v21
    v_and_b32 v11, 0xffff0000, v21
    v_fmac_f32 v66, v32, v10
    v_fmac_f32 v67, v32, v11
    v_fmac_f32 v74, v33, v10
    v_fmac_f32 v75, v33, v11
    v_fmac_f32 v82, v34, v10
    v_fmac_f32 v83, v34, v11
    v_fmac_f32 v90, v35, v10
    v_fmac_f32 v91, v35, v11
    v_lshlrev_b32 v10, 16, v22
    v_and_b32 v11, 0xffff0000, v22
    v_fmac_f32 v68, v32, v10
    v_fmac_f32 v69, v32, v11
    v_fmac_f32 v76, v33, v10
    v_fmac_f32 v77, v33, v11
    v_fmac_f32 v84, v34, v10
    v_fmac_f32 v85, v34, v11
    v_fmac_f32 v92, v35, v10
    v_fmac_f32 v93, v35, v11
    v_lshlrev_b32 v10, 16, v23
    v_and_b32 v11, 0xffff0000, v23
    v_fmac_f32 v70, v32, v10
    v_fmac_f32 v71, v32, v11
    v_fmac_f32 v78, v33, v10
    v_fmac_f32 v79, v33, v11
    v_fmac_f32 v86, v34, v10
    v_fmac_f32 v87, v34, v11
    v_fmac_f32 v94, v35, v10
    v_fmac_f32 v95, v35, v11
    v_lshlrev_b32 v10, 16, v24
    v_and_b32 v11, 0xffff0000, v24
    v_fmac_f32 v64, v36, v10
    v_fmac_f32 v65, v36, v11
    v_fmac_f32 v72, v37, v10
    v_fmac_f32 v73, v37, v11
    v_fmac_f32 v80, v38, v10
    v_fmac_f32 v81, v38, v11
    v_fmac_f32 v88, v39, v10
    v_fmac_f32 v89, v39, v11
    v_lshlrev_b32 v10, 16, v25
    v_and_b32 v11, 0xffff0000, v25
    v_fmac_f32 v66, v36, v10
    v_fmac_f32 v67, v36, v11
    v_fmac_f32 v74, v37, v10
    v_fmac_f32 v75, v37, v11
    v_fmac_f32 v82, v38, v10
    v_fmac_f32 v83, v38, v11
    v_fmac_f32 v90, v39, v10
    v_fmac_f32 v91, v39, v11
    v_lshlrev_b32 v10, 16, v26
    v_and_b32 v11, 0xffff0000, v26
    v_fmac_f32 v68, v36, v10
    v_fmac_f32 v69, v36, v11
    v_fmac_f32 v76, v37, v10
    v_fmac_f32 v77, v37, v11
    v_fmac_f32 v84, v38, v10
    v_fmac_f32 v85, v38, v11
    v_fmac_f32 v92, v39, v10
    v_fmac_f32 v93, v39, v11
    v_lshlrev_b32 v10, 16, v27
    v_and_b32 v11, 0xffff0000, v27
    v_fmac_f32 v70, v36, v10
    v_fmac_f32 v71, v36, v11
    v_fmac_f32 v78, v37, v10
    v_fmac_f32 v79, v37, v11
    v_fmac_f32 v86, v38, v10
    v_fmac_f32 v87, v38, v11
    v_fmac_f32 v94, v39, v10
    v_fmac_f32 v95, v39, v11
    s_nop 1
    v_permlane32_swap_b32 v64, v68
    v_permlane32_swap_b32 v65, v69
    v_permlane32_swap_b32 v66, v70
    v_permlane32_swap_b32 v67, v71
    v_permlane32_swap_b32 v72, v76
    v_permlane32_swap_b32 v73, v77
    v_permlane32_swap_b32 v74, v78
    v_permlane32_swap_b32 v75, v79
    v_permlane32_swap_b32 v80, v84
    v_permlane32_swap_b32 v81, v85
    v_permlane32_swap_b32 v82, v86
    v_permlane32_swap_b32 v83, v87
    v_permlane32_swap_b32 v88, v92
    v_permlane32_swap_b32 v89, v93
    v_permlane32_swap_b32 v90, v94
    v_permlane32_swap_b32 v91, v95
    v_add_f32 v64, v64, v68
    v_add_f32 v65, v65, v69
    v_add_f32 v66, v66, v70
    v_add_f32 v67, v67, v71
    v_add_f32 v72, v72, v76
    v_add_f32 v73, v73, v77
    v_add_f32 v74, v74, v78
    v_add_f32 v75, v75, v79
    v_add_f32 v80, v80, v84
    v_add_f32 v81, v81, v85
    v_add_f32 v82, v82, v86
    v_add_f32 v83, v83, v87
    v_add_f32 v88, v88, v92
    v_add_f32 v89, v89, v93
    v_add_f32 v90, v90, v94
    v_add_f32 v91, v91, v95
    s_nop 1
    v_permlane16_swap_b32 v64, v66
    v_permlane16_swap_b32 v65, v67
    v_permlane16_swap_b32 v72, v74
    v_permlane16_swap_b32 v73, v75
    v_permlane16_swap_b32 v80, v82
    v_permlane16_swap_b32 v81, v83
    v_permlane16_swap_b32 v88, v90
    v_permlane16_swap_b32 v89, v91
    v_add_f32 v64, v64, v66
    v_add_f32 v65, v65, v67
    v_add_f32 v72, v72, v74
    v_add_f32 v73, v73, v75
    v_add_f32 v80, v80, v82
    v_add_f32 v81, v81, v83
    v_add_f32 v88, v88, v90
    v_add_f32 v89, v89, v91
    s_nop 1
    v_add_f32_dpp v64, v64, v64 quad_perm:[1,0,3,2] row_mask:0xf bank_mask:0xf
    v_add_f32_dpp v65, v65, v65 quad_perm:[1,0,3,2] row_mask:0xf bank_mask:0xf
    v_add_f32_dpp v72, v72, v72 quad_perm:[1,0,3,2] row_mask:0xf bank_mask:0xf
    v_add_f32_dpp v73, v73, v73 quad_perm:[1,0,3,2] row_mask:0xf bank_mask:0xf
    v_add_f32_dpp v80, v80, v80 quad_perm:[1,0,3,2] row_mask:0xf bank_mask:0xf
    v_add_f32_dpp v81, v81, v81 quad_perm:[1,0,3,2] row_mask:0xf bank_mask:0xf
    v_add_f32_dpp v88, v88, v88 quad_perm:[1,0,3,2] row_mask:0xf bank_mask:0xf
    v_add_f32_dpp v89, v89, v89 quad_perm:[1,0,3,2] row_mask:0xf bank_mask:0xf
    s_nop 1
    v_add_f32_dpp v64, v64, v64 quad_perm:[2,3,0,1] row_mask:0xf bank_mask:0xf
    v_add_f32_dpp v65, v65, v65 quad_perm:[2,3,0,1] row_mask:0xf bank_mask:0xf
    v_add_f32_dpp v72, v72, v72 quad_perm:[2,3,0,1] row_mask:0xf bank_mask:0xf
    v_add_f32_dpp v73, v73, v73 quad_perm:[2,3,0,1] row_mask:0xf bank_mask:0xf
    v_add_f32_dpp v80, v80, v80 quad_perm:[2,3,0,1] row_mask:0xf bank_mask:0xf
    v_add_f32_dpp v81, v81, v81 quad_perm:[2,3,0,1] row_mask:0xf bank_mask:0xf
    v_add_f32_dpp v88, v88, v88 quad_perm:[2,3,0,1] row_mask:0xf bank_mask:0xf
    v_add_f32_dpp v89, v89, v89 quad_perm:[2,3,0,1] row_mask:0xf bank_mask:0xf
    s_nop 1
    v_add_f32_dpp v64, v64, v64 row_half_mirror row_mask:0xf bank_mask:0xf
    v_add_f32_dpp v65, v65, v65 row_half_mirror row_mask:0xf bank_mask:0xf
    v_add_f32_dpp v72, v72, v72 row_half_mirror row_mask:0xf bank_mask:0xf
    v_add_f32_dpp v73, v73, v73 row_half_mirror row_mask:0xf bank_mask:0xf
    v_add_f32_dpp v80, v80, v80 row_half_mirror row_mask:0xf bank_mask:0xf
    v_add_f32_dpp v81, v81, v81 row_half_mirror row_mask:0xf bank_mask:0xf
    v_add_f32_dpp v88, v88, v88 row_half_mirror row_mask:0xf bank_mask:0xf
    v_add_f32_dpp v89, v89, v89 row_half_mirror row_mask:0xf bank_mask:0xf
    s_nop 1
    v_add_f32_dpp v64, v64, v64 row_mirror row_mask:0xf bank_mask:0xf
    v_add_f32_dpp v65, v65, v65 row_mirror row_mask:0xf bank_mask:0xf
    v_add_f32_dpp v72, v72, v72 row_mirror row_mask:0xf bank_mask:0xf
    v_add_f32_dpp v73, v73, v73 row_mirror row_mask:0xf bank_mask:0xf
    v_add_f32_dpp v80, v80, v80 row_mirror row_mask:0xf bank_mask:0xf
    v_add_f32_dpp v81, v81, v81 row_mirror row_mask:0xf bank_mask:0xf
    v_add_f32_dpp v88, v88, v88 row_mirror row_mask:0xf bank_mask:0xf
    v_add_f32_dpp v89, v89, v89 row_mirror row_mask:0xf bank_mask:0xf
    v_lshlrev_b32 v8, 7, v2
    v_lshrrev_b32 v9, 5, v1
    v_lshlrev_b32 v9, 4, v9
    v_add_u32 v8, v8, v9
    v_bfe_u32 v9, v1, 4, 1
    v_lshlrev_b32 v9, 3, v9
    v_add_u32 v8, v8, v9
    ds_write_b64 v8, v[64:65] offset:20736
    ds_write_b64 v8, v[72:73] offset:20768
    ds_write_b64 v8, v[80:81] offset:20800
    ds_write_b64 v8, v[88:89] offset:20832
    s_waitcnt lgkmcnt(0)
    s_barrier
    s_cmp_ge_u32 s30, 1
    s_cbranch_scc1 L_dn_done
    v_cmp_gt_u32 vcc, 32, v1
    s_and_saveexec_b64 s[44:45], vcc
    v_lshlrev_b32 v8, 2, v1
    ds_read_b32 v16, v8 offset:20736
    ds_read_b32 v17, v8 offset:20864
    ds_read_b32 v18, v8 offset:20992
    ds_read_b32 v19, v8 offset:21120
    ds_read_b32 v20, v8 offset:21248
    ds_read_b32 v21, v8 offset:21376
    ds_read_b32 v22, v8 offset:21504
    ds_read_b32 v23, v8 offset:21632
    v_and_b32 v9, 7, v1
    s_lshl_b32 s25, s2, 3
    v_add_u32 v9, s25, v9
    v_lshrrev_b32 v10, 3, v1
    v_lshlrev_b32 v11, 4, v9
    v_lshlrev_b32 v12, 2, v10
    v_add_u32 v11, v11, v12
    ds_read_b32 v24, v11
    ds_read_b32 v25, v11 offset:10240
    ds_read_b32 v26, v12 offset:20480
    s_waitcnt lgkmcnt(0)
    v_add_f32 v16, v16, v17
    v_add_f32 v16, v16, v18
    v_add_f32 v16, v16, v19
    v_add_f32 v16, v16, v20
    v_add_f32 v16, v16, v21
    v_add_f32 v16, v16, v22
    v_add_f32 v16, v16, v23
    v_cvt_pk_bf16_f32 v16, v16, v16
    v_lshlrev_b32 v16, 16, v16
    v_mul_f32 v16, v16, v26
    v_cvt_pk_bf16_f32 v16, v16, v16
    v_lshlrev_b32 v16, 16, v16
    v_add_f32 v16, v24, v16
    v_cvt_pk_bf16_f32 v16, v16, v16
    v_lshlrev_b32 v16, 16, v16
    v_add_f32 v16, v25, v16
    v_cvt_pk_bf16_f32 v16, v16, v16
    v_mul_u32_u24 v10, 640, v10
    v_add_u32 v10, v10, v9
    v_lshlrev_b32 v10, 1, v10
    buffer_store_short v16, v10, s[40:43], 0 offen
L_dn_done:
    s_endpgm
.section .rodata,"a"
.p2align 6
.amdhsa_kernel attn_kernel
  .amdhsa_next_free_vgpr 128
  .amdhsa_next_free_sgpr 64
  .amdhsa_accum_offset 128
  .amdhsa_group_segment_fixed_size 0
  .amdhsa_kernarg_size 104
  .amdhsa_user_sgpr_count 2
  .amdhsa_user_sgpr_kernarg_segment_ptr 1
  .amdhsa_system_sgpr_workgroup_id_x 1
.end_amdhsa_kernel
.p2align 6
.amdhsa_kernel wo_kernel
  .amdhsa_next_free_vgpr 96
  .amdhsa_next_free_sgpr 32
  .amdhsa_accum_offset 96
  .amdhsa_group_segment_fixed_size 0
  .amdhsa_kernarg_size 104
  .amdhsa_user_sgpr_count 2
  .amdhsa_user_sgpr_kernarg_segment_ptr 1
  .amdhsa_system_sgpr_workgroup_id_x 1
  .amdhsa_system_sgpr_workgroup_id_y 1
.end_amdhsa_kernel
.p2align 6
.amdhsa_kernel gateup_kernel
  .amdhsa_next_free_vgpr 96
  .amdhsa_next_free_sgpr 56
  .amdhsa_accum_offset 96
  .amdhsa_group_segment_fixed_size 0
  .amdhsa_kernarg_size 104
  .amdhsa_user_sgpr_count 2
  .amdhsa_user_sgpr_kernarg_segment_ptr 1
  .amdhsa_system_sgpr_workgroup_id_x 1
.end_amdhsa_kernel
.p2align 6
.amdhsa_kernel down_kernel
  .amdhsa_next_free_vgpr 112
  .amdhsa_next_free_sgpr 56
  .amdhsa_accum_offset 112
  .amdhsa_group_segment_fixed_size 0
  .amdhsa_kernarg_size 104
  .amdhsa_user_sgpr_count 2
  .amdhsa_user_sgpr_kernarg_segment_ptr 1
  .amdhsa_system_sgpr_workgroup_id_x 1
.end_amdhsa_kernel
```

```asm
; @launch grid=(256,1,1) block=(1024,1,1) lds=140800
.amdgcn_target "amdgcn-amd-amdhsa--gfx950"
.text
.globl sequential_preLN__mha_block_cached__moe_arch_mod__decode_kernel
.p2align 8
.type sequential_preLN__mha_block_cached__moe_arch_mod__decode_kernel,@function
sequential_preLN__mha_block_cached__moe_arch_mod__decode_kernel:
    s_cmp_ge_u32 s2, 256
    s_cbranch_scc1 L_done
    s_load_dwordx2 s[4:5], s[0:1], 0
    s_load_dwordx4 s[8:11], s[0:1], 8
    s_load_dwordx4 s[12:15], s[0:1], 24
    s_load_dwordx4 s[80:83], s[0:1], 48
    s_load_dwordx4 s[84:87], s[0:1], 64
    s_load_dwordx4 s[88:91], s[0:1], 80
    s_load_dwordx2 s[6:7], s[0:1], 96
    s_and_b32 s42, s2, 7
    s_lshr_b32 s43, s2, 3
    s_and_b32 s44, s43, 3
    s_lshl_b32 s45, s42, 2
    s_add_u32 s45, s45, s44
    s_lshr_b32 s44, s43, 2
    s_lshr_b32 s46, s44, 1
    s_and_b32 s47, s44, 1
    s_lshl_b32 s40, s46, 5
    s_add_u32 s40, s40, s45
    s_lshl_b32 s40, s40, 1
    s_add_u32 s40, s40, s47
    s_mul_i32 s41, s40, 1572864
    s_lshr_b32 s99, s45, 3
    v_and_b32 v6, 63, v0
    v_lshrrev_b32 v2, 6, v0
    v_lshrrev_b32 v3, 3, v6
    v_and_b32 v4, 7, v6
    v_readfirstlane_b32 s53, v2
    v_lshlrev_b32 v4, 4, v4
    v_mul_u32_u24 v5, 384, v3
    v_add_u32 v1, v5, v4
    v_mul_u32_u24 v5, 40, v2
    v_add_u32 v5, v5, v3
    v_mul_u32_u24 v7, 12288, v5
    v_add_u32 v7, v7, v4
    v_lshlrev_b32 v8, 1, v5
    v_lshlrev_b32 v5, 2, v6
    s_waitcnt lgkmcnt(0)
    s_mov_b32 s56, s4
    s_and_b32 s57, s5, 0xffff
    s_mov_b32 s58, 0x1400
    s_mov_b32 s59, 0x00020000
    s_mul_i32 s48, s46, 1280
    s_add_u32 s4, s4, s48
    s_addc_u32 s5, s5, 0
    s_mov_b32 s28, s4
    s_and_b32 s29, s5, 0xffff
    s_mov_b32 s30, 0x500
    s_mov_b32 s31, 0x00020000
    s_mul_i32 s48, s45, 384
    s_add_u32 s12, s12, s48
    s_addc_u32 s13, s13, 0
    s_sub_u32 s49, 7864320, s48
    s_mov_b32 s24, s12
    s_and_b32 s25, s13, 0xffff
    s_mov_b32 s26, s49
    s_mov_b32 s27, 0x00020000
    s_add_u32 s8, s8, s41
    s_addc_u32 s9, s9, 0
    s_mov_b32 s16, s8
    s_and_b32 s17, s9, 0xffff
    s_mov_b32 s18, 0x180000
    s_mov_b32 s19, 0x00020000
    s_add_u32 s10, s10, s41
    s_addc_u32 s11, s11, 0
    s_mov_b32 s20, s10
    s_and_b32 s21, s11, 0xffff
    s_mov_b32 s22, 0x180000
    s_mov_b32 s23, 0x00020000
    s_mov_b32 s32, s6
    s_and_b32 s33, s7, 0xffff
    s_mov_b32 s34, 0x80000
    s_mov_b32 s35, 0x00020000
    s_mov_b32 s36, s90
    s_and_b32 s37, s91, 0xffff
    s_mov_b32 s38, 0x100
    s_mov_b32 s39, 0x00020000
    s_mov_b32 s60, s14
    s_and_b32 s61, s15, 0xffff
    s_mov_b32 s62, 0x780000
    s_mov_b32 s63, 0x00020000
    s_mov_b32 s64, s82
    s_and_b32 s65, s83, 0xffff
    s_mov_b32 s66, 0x1e0000
    s_mov_b32 s67, 0x00020000
    s_mov_b32 s92, s84
    s_and_b32 s93, s85, 0xffff
    s_mov_b32 s94, 0x1e0000
    s_mov_b32 s95, 0x00020000
    s_mov_b32 s68, s86
    s_and_b32 s69, s87, 0xffff
    s_mov_b32 s70, 0x1e0000
    s_mov_b32 s71, 0x00020000
    s_mov_b32 s72, s80
    s_and_b32 s73, s81, 0xffff
    s_mov_b32 s74, 0x500
    s_mov_b32 s75, 0x00020000
    s_mov_b32 s76, s88
    s_and_b32 s77, s89, 0xffff
    s_mov_b32 s78, 0x1400
    s_mov_b32 s79, 0x00020000
    s_mul_i32 s48, s2, 6554
    s_lshr_b32 s54, s48, 16
    s_mul_i32 s48, s54, 10
    s_sub_u32 s55, s2, s48
    s_mov_b32 s98, 0
    s_cmp_lt_u32 s2, 80
    s_cbranch_scc1 L_role_done
    s_mov_b32 s98, 1
    s_sub_u32 s55, s2, 80
    s_cmp_ge_u32 s55, 24
    s_cselect_b32 s54, 1, 0
    s_mul_i32 s48, s54, 24
    s_sub_u32 s55, s55, s48
    s_cmp_lt_u32 s2, 128
    s_cbranch_scc1 L_role_done
    s_mov_b32 s98, 2
    s_sub_u32 s55, s2, 128
    s_cmp_lt_u32 s2, 148
    s_cbranch_scc1 L_role_done
    s_mov_b32 s98, 3
L_role_done:
    s_cmp_eq_u32 s54, 1
    s_cselect_b32 s64, s92, s64
    s_cselect_b32 s65, s93, s65
    v_mov_b32 v2, -1
    v_lshlrev_b32 v3, 2, v0
    v_cmp_gt_u32 vcc, 200, v0
    s_and_saveexec_b64 s[100:101], vcc
    s_cbranch_execz L_clr1
    s_mul_i32 s48, s40, 800
    buffer_store_dword v2, v3, s[32:35], s48 offen sc0 sc1
    v_cmp_eq_u32 vcc, 0, v0
    s_and_b64 exec, exec, vcc
    s_cbranch_execz L_clr1
    s_lshl_b32 s48, s2, 7
    s_add_u32 s48, s48, 458752
    buffer_store_dword v2, v3, s[32:35], s48 offen sc0 sc1
L_clr1:
    s_mov_b64 exec, s[100:101]
    s_cmp_ge_u32 s98, 2
    s_cbranch_scc1 L_clr3
    s_cmp_eq_u32 s98, 1
    s_cbranch_scc1 L_clr_d
    v_cmp_gt_u32 vcc, 256, v0
    s_and_saveexec_b64 s[100:101], vcc
    s_cbranch_execz L_clr2
    v_lshrrev_b32 v3, 6, v0
    v_mul_u32_u24 v3, 2560, v3
    v_and_b32 v4, 63, v0
    v_lshl_add_u32 v3, v4, 2, v3
    s_mul_i32 s48, s54, 10240
    s_lshl_b32 s49, s55, 8
    s_add_u32 s48, s48, s49
    s_add_u32 s48, s48, 262144
    buffer_store_dword v2, v3, s[32:35], s48 offen sc0 sc1
    s_branch L_clr2
L_clr_d:
    v_cmp_gt_u32 vcc, 128, v0
    s_and_saveexec_b64 s[100:101], vcc
    s_cbranch_execz L_clr2
    v_lshrrev_b32 v3, 5, v0
    v_mul_u32_u24 v3, 3072, v3
    v_and_b32 v4, 31, v0
    v_lshl_add_u32 v3, v4, 2, v3
    s_mul_i32 s48, s54, 16384
    s_lshl_b32 s49, s55, 7
    s_add_u32 s48, s48, s49
    s_add_u32 s48, s48, 360448
    buffer_store_dword v2, v3, s[32:35], s48 offen sc0 sc1
L_clr2:
    s_mov_b64 exec, s[100:101]
L_clr3:
    v_mov_b32 v3, 12928
    v_mov_b32 v4, 16
    ds_write_b32 v3, v4
    buffer_load_dword v46, v5, s[28:31], 0 offen offset:0
    buffer_load_dword v47, v5, s[28:31], 0 offen offset:256
    buffer_load_dword v48, v5, s[28:31], 0 offen offset:512
    buffer_load_dword v49, v5, s[28:31], 0 offen offset:768
    buffer_load_dword v50, v5, s[28:31], 0 offen offset:1024
    buffer_load_ushort v51, v8, s[28:31], 0 offen offset:0
    buffer_load_ushort v52, v8, s[28:31], 0 offen offset:16
    buffer_load_ushort v53, v8, s[28:31], 0 offen offset:32
    buffer_load_ushort v126, v8, s[28:31], 0 offen offset:48
    buffer_load_ushort v127, v8, s[28:31], 0 offen offset:64
    s_mov_b32 s48, 0
    buffer_load_dwordx4 v[102:105], v7, s[24:27], s48 offen offset:0 nt
    buffer_load_dwordx4 v[106:109], v7, s[24:27], s48 offen offset:128 nt
    buffer_load_dwordx4 v[110:113], v7, s[24:27], s48 offen offset:256 nt
    s_mov_b32 s48, 98304
    buffer_load_dwordx4 v[114:117], v7, s[24:27], s48 offen offset:0 nt
    buffer_load_dwordx4 v[118:121], v7, s[24:27], s48 offen offset:128 nt
    buffer_load_dwordx4 v[122:125], v7, s[24:27], s48 offen offset:256 nt
    s_mov_b32 s48, 196608
    buffer_load_dwordx4 v[10:13], v7, s[24:27], s48 offen offset:0 nt
    buffer_load_dwordx4 v[14:17], v7, s[24:27], s48 offen offset:128 nt
    buffer_load_dwordx4 v[18:21], v7, s[24:27], s48 offen offset:256 nt
    s_mov_b32 s48, 294912
    buffer_load_dwordx4 v[22:25], v7, s[24:27], s48 offen offset:0 nt
    buffer_load_dwordx4 v[26:29], v7, s[24:27], s48 offen offset:128 nt
    buffer_load_dwordx4 v[30:33], v7, s[24:27], s48 offen offset:256 nt
    s_mov_b32 s48, 393216
    buffer_load_dwordx4 v[34:37], v7, s[24:27], s48 offen offset:0 nt
    buffer_load_dwordx4 v[38:41], v7, s[24:27], s48 offen offset:128 nt
    buffer_load_dwordx4 v[42:45], v7, s[24:27], s48 offen offset:256 nt
    s_mul_i32 s41, s53, 24576
    s_barrier
    s_add_u32 s48, s41, 0
    buffer_load_dwordx4 v[78:81], v1, s[16:19], s48 offen offset:0 nt
    buffer_load_dwordx4 v[82:85], v1, s[16:19], s48 offen offset:128 nt
    buffer_load_dwordx4 v[86:89], v1, s[16:19], s48 offen offset:256 nt
    s_add_u32 s48, s41, 3072
    buffer_load_dwordx4 v[90:93], v1, s[16:19], s48 offen offset:0 nt
    buffer_load_dwordx4 v[94:97], v1, s[16:19], s48 offen offset:128 nt
    buffer_load_dwordx4 v[98:101], v1, s[16:19], s48 offen offset:256 nt
    s_waitcnt vmcnt(26)
    v_lshlrev_b32 v54, 16, v46
    v_and_b32 v55, 0xffff0000, v46
    v_lshlrev_b32 v56, 16, v47
    v_and_b32 v57, 0xffff0000, v47
    v_lshlrev_b32 v58, 16, v48
    v_and_b32 v59, 0xffff0000, v48
    v_lshlrev_b32 v60, 16, v49
    v_and_b32 v61, 0xffff0000, v49
    v_lshlrev_b32 v62, 16, v50
    v_and_b32 v63, 0xffff0000, v50
    v_add_f32 v2, v54, v55
    v_add_f32 v2, v2, v56
    v_add_f32 v2, v2, v57
    v_add_f32 v2, v2, v58
    v_add_f32 v2, v2, v59
    v_add_f32 v2, v2, v60
    v_add_f32 v2, v2, v61
    v_add_f32 v2, v2, v62
    v_add_f32 v2, v2, v63
    s_nop 1
    v_add_f32_dpp v2, v2, v2 quad_perm:[1,0,3,2] row_mask:0xf bank_mask:0xf
    s_nop 1
    v_add_f32_dpp v2, v2, v2 quad_perm:[2,3,0,1] row_mask:0xf bank_mask:0xf
    s_nop 1
    v_add_f32_dpp v2, v2, v2 row_half_mirror row_mask:0xf bank_mask:0xf
    s_nop 1
    v_add_f32_dpp v2, v2, v2 row_mirror row_mask:0xf bank_mask:0xf
    s_nop 1
    v_readlane_b32 s48, v2, 0
    v_readlane_b32 s49, v2, 16
    v_readlane_b32 s50, v2, 32
    v_readlane_b32 s51, v2, 48
    s_nop 1
    v_mov_b32 v2, s48
    v_add_f32 v2, s49, v2
    v_add_f32 v2, s50, v2
    v_add_f32 v2, s51, v2
    v_mul_f32 v2, 0x3acccccd, v2
    v_sub_f32 v4, v54, v2
    v_mul_f32 v3, v4, v4
    v_sub_f32 v4, v55, v2
    v_fmac_f32 v3, v4, v4
    v_sub_f32 v4, v56, v2
    v_fmac_f32 v3, v4, v4
    v_sub_f32 v4, v57, v2
    v_fmac_f32 v3, v4, v4
    v_sub_f32 v4, v58, v2
    v_fmac_f32 v3, v4, v4
    v_sub_f32 v4, v59, v2
    v_fmac_f32 v3, v4, v4
    v_sub_f32 v4, v60, v2
    v_fmac_f32 v3, v4, v4
    v_sub_f32 v4, v61, v2
    v_fmac_f32 v3, v4, v4
    v_sub_f32 v4, v62, v2
    v_fmac_f32 v3, v4, v4
    v_sub_f32 v4, v63, v2
    v_fmac_f32 v3, v4, v4
    s_nop 1
    v_add_f32_dpp v3, v3, v3 quad_perm:[1,0,3,2] row_mask:0xf bank_mask:0xf
    s_nop 1
    v_add_f32_dpp v3, v3, v3 quad_perm:[2,3,0,1] row_mask:0xf bank_mask:0xf
    s_nop 1
    v_add_f32_dpp v3, v3, v3 row_half_mirror row_mask:0xf bank_mask:0xf
    s_nop 1
    v_add_f32_dpp v3, v3, v3 row_mirror row_mask:0xf bank_mask:0xf
    s_nop 1
    v_readlane_b32 s48, v3, 0
    v_readlane_b32 s49, v3, 16
    v_readlane_b32 s50, v3, 32
    v_readlane_b32 s51, v3, 48
    s_nop 1
    v_mov_b32 v3, s48
    v_add_f32 v3, s49, v3
    v_add_f32 v3, s50, v3
    v_add_f32 v3, s51, v3
    v_mul_f32 v3, 0x3acccccd, v3
    v_cvt_pk_bf16_f32 v2, v2, v2
    v_lshlrev_b32 v2, 16, v2
    v_cvt_pk_bf16_f32 v3, v3, v3
    v_lshlrev_b32 v3, 16, v3
    v_add_f32 v3, 0x3727c5ac, v3
    v_cvt_pk_bf16_f32 v3, v3, v3
    v_lshlrev_b32 v3, 16, v3
    v_sqrt_f32 v3, v3
    s_nop 0
    v_cvt_pk_bf16_f32 v3, v3, v3
    v_lshlrev_b32 v3, 16, v3
    v_rcp_f32 v3, v3
    s_waitcnt vmcnt(21)
    v_lshlrev_b32 v51, 16, v51
    v_sub_f32 v51, v51, v2
    v_cvt_pk_bf16_f32 v51, v51, v51
    v_lshlrev_b32 v51, 16, v51
    v_mul_f32 v51, v51, v3
    v_cvt_pk_bf16_f32 v51, v51, v51
    v_lshlrev_b32 v51, 16, v51
    v_lshlrev_b32 v52, 16, v52
    v_sub_f32 v52, v52, v2
    v_cvt_pk_bf16_f32 v52, v52, v52
    v_lshlrev_b32 v52, 16, v52
    v_mul_f32 v52, v52, v3
    v_cvt_pk_bf16_f32 v52, v52, v52
    v_lshlrev_b32 v52, 16, v52
    v_lshlrev_b32 v53, 16, v53
    v_sub_f32 v53, v53, v2
    v_cvt_pk_bf16_f32 v53, v53, v53
    v_lshlrev_b32 v53, 16, v53
    v_mul_f32 v53, v53, v3
    v_cvt_pk_bf16_f32 v53, v53, v53
    v_lshlrev_b32 v53, 16, v53
    v_lshlrev_b32 v126, 16, v126
    v_sub_f32 v126, v126, v2
    v_cvt_pk_bf16_f32 v126, v126, v126
    v_lshlrev_b32 v126, 16, v126
    v_mul_f32 v126, v126, v3
    v_cvt_pk_bf16_f32 v126, v126, v126
    v_lshlrev_b32 v126, 16, v126
    v_lshlrev_b32 v127, 16, v127
    v_sub_f32 v127, v127, v2
    v_cvt_pk_bf16_f32 v127, v127, v127
    v_lshlrev_b32 v127, 16, v127
    v_mul_f32 v127, v127, v3
    v_cvt_pk_bf16_f32 v127, v127, v127
    v_lshlrev_b32 v127, 16, v127
    s_waitcnt vmcnt(18)
    v_lshlrev_b32 v2, 16, v102
    v_and_b32 v3, 0xffff0000, v102
    v_mul_f32 v54, v51, v2
    v_mul_f32 v55, v51, v3
    v_lshlrev_b32 v2, 16, v103
    v_and_b32 v3, 0xffff0000, v103
    v_mul_f32 v56, v51, v2
    v_mul_f32 v57, v51, v3
    v_lshlrev_b32 v2, 16, v104
    v_and_b32 v3, 0xffff0000, v104
    v_mul_f32 v58, v51, v2
    v_mul_f32 v59, v51, v3
    v_lshlrev_b32 v2, 16, v105
    v_and_b32 v3, 0xffff0000, v105
    v_mul_f32 v60, v51, v2
    v_mul_f32 v61, v51, v3
    v_lshlrev_b32 v2, 16, v106
    v_and_b32 v3, 0xffff0000, v106
    v_mul_f32 v62, v51, v2
    v_mul_f32 v63, v51, v3
    v_lshlrev_b32 v2, 16, v107
    v_and_b32 v3, 0xffff0000, v107
    v_mul_f32 v64, v51, v2
    v_mul_f32 v65, v51, v3
    v_lshlrev_b32 v2, 16, v108
    v_and_b32 v3, 0xffff0000, v108
    v_mul_f32 v66, v51, v2
    v_mul_f32 v67, v51, v3
    v_lshlrev_b32 v2, 16, v109
    v_and_b32 v3, 0xffff0000, v109
    v_mul_f32 v68, v51, v2
    v_mul_f32 v69, v51, v3
    v_lshlrev_b32 v2, 16, v110
    v_and_b32 v3, 0xffff0000, v110
    v_mul_f32 v70, v51, v2
    v_mul_f32 v71, v51, v3
    v_lshlrev_b32 v2, 16, v111
    v_and_b32 v3, 0xffff0000, v111
    v_mul_f32 v72, v51, v2
    v_mul_f32 v73, v51, v3
    v_lshlrev_b32 v2, 16, v112
    v_and_b32 v3, 0xffff0000, v112
    v_mul_f32 v74, v51, v2
    v_mul_f32 v75, v51, v3
    v_lshlrev_b32 v2, 16, v113
    v_and_b32 v3, 0xffff0000, v113
    v_mul_f32 v76, v51, v2
    v_mul_f32 v77, v51, v3
    s_add_u32 s48, s41, 6144
    buffer_load_dwordx4 v[102:105], v1, s[16:19], s48 offen offset:0 nt
    buffer_load_dwordx4 v[106:109], v1, s[16:19], s48 offen offset:128 nt
    buffer_load_dwordx4 v[110:113], v1, s[16:19], s48 offen offset:256 nt
    s_waitcnt vmcnt(18)
    v_lshlrev_b32 v2, 16, v114
    v_and_b32 v3, 0xffff0000, v114
    v_fmac_f32 v54, v52, v2
    v_fmac_f32 v55, v52, v3
    v_lshlrev_b32 v2, 16, v115
    v_and_b32 v3, 0xffff0000, v115
    v_fmac_f32 v56, v52, v2
    v_fmac_f32 v57, v52, v3
    v_lshlrev_b32 v2, 16, v116
    v_and_b32 v3, 0xffff0000, v116
    v_fmac_f32 v58, v52, v2
    v_fmac_f32 v59, v52, v3
    v_lshlrev_b32 v2, 16, v117
    v_and_b32 v3, 0xffff0000, v117
    v_fmac_f32 v60, v52, v2
    v_fmac_f32 v61, v52, v3
    v_lshlrev_b32 v2, 16, v118
    v_and_b32 v3, 0xffff0000, v118
    v_fmac_f32 v62, v52, v2
    v_fmac_f32 v63, v52, v3
    v_lshlrev_b32 v2, 16, v119
    v_and_b32 v3, 0xffff0000, v119
    v_fmac_f32 v64, v52, v2
    v_fmac_f32 v65, v52, v3
    v_lshlrev_b32 v2, 16, v120
    v_and_b32 v3, 0xffff0000, v120
    v_fmac_f32 v66, v52, v2
    v_fmac_f32 v67, v52, v3
    v_lshlrev_b32 v2, 16, v121
    v_and_b32 v3, 0xffff0000, v121
    v_fmac_f32 v68, v52, v2
    v_fmac_f32 v69, v52, v3
    v_lshlrev_b32 v2, 16, v122
    v_and_b32 v3, 0xffff0000, v122
    v_fmac_f32 v70, v52, v2
    v_fmac_f32 v71, v52, v3
    v_lshlrev_b32 v2, 16, v123
    v_and_b32 v3, 0xffff0000, v123
    v_fmac_f32 v72, v52, v2
    v_fmac_f32 v73, v52, v3
    v_lshlrev_b32 v2, 16, v124
    v_and_b32 v3, 0xffff0000, v124
    v_fmac_f32 v74, v52, v2
    v_fmac_f32 v75, v52, v3
    v_lshlrev_b32 v2, 16, v125
    v_and_b32 v3, 0xffff0000, v125
    v_fmac_f32 v76, v52, v2
    v_fmac_f32 v77, v52, v3
    s_add_u32 s48, s41, 9216
    buffer_load_dwordx4 v[114:117], v1, s[16:19], s48 offen offset:0 nt
    buffer_load_dwordx4 v[118:121], v1, s[16:19], s48 offen offset:128 nt
    buffer_load_dwordx4 v[122:125], v1, s[16:19], s48 offen offset:256 nt
    s_waitcnt vmcnt(18)
    v_lshlrev_b32 v2, 16, v10
    v_and_b32 v3, 0xffff0000, v10
    v_fmac_f32 v54, v53, v2
    v_fmac_f32 v55, v53, v3
    v_lshlrev_b32 v2, 16, v11
    v_and_b32 v3, 0xffff0000, v11
    v_fmac_f32 v56, v53, v2
    v_fmac_f32 v57, v53, v3
    v_lshlrev_b32 v2, 16, v12
    v_and_b32 v3, 0xffff0000, v12
    v_fmac_f32 v58, v53, v2
    v_fmac_f32 v59, v53, v3
    v_lshlrev_b32 v2, 16, v13
    v_and_b32 v3, 0xffff0000, v13
    v_fmac_f32 v60, v53, v2
    v_fmac_f32 v61, v53, v3
    v_lshlrev_b32 v2, 16, v14
    v_and_b32 v3, 0xffff0000, v14
    v_fmac_f32 v62, v53, v2
    v_fmac_f32 v63, v53, v3
    v_lshlrev_b32 v2, 16, v15
    v_and_b32 v3, 0xffff0000, v15
    v_fmac_f32 v64, v53, v2
    v_fmac_f32 v65, v53, v3
    v_lshlrev_b32 v2, 16, v16
    v_and_b32 v3, 0xffff0000, v16
    v_fmac_f32 v66, v53, v2
    v_fmac_f32 v67, v53, v3
    v_lshlrev_b32 v2, 16, v17
    v_and_b32 v3, 0xffff0000, v17
    v_fmac_f32 v68, v53, v2
    v_fmac_f32 v69, v53, v3
    v_lshlrev_b32 v2, 16, v18
    v_and_b32 v3, 0xffff0000, v18
    v_fmac_f32 v70, v53, v2
    v_fmac_f32 v71, v53, v3
    v_lshlrev_b32 v2, 16, v19
    v_and_b32 v3, 0xffff0000, v19
    v_fmac_f32 v72, v53, v2
    v_fmac_f32 v73, v53, v3
    v_lshlrev_b32 v2, 16, v20
    v_and_b32 v3, 0xffff0000, v20
    v_fmac_f32 v74, v53, v2
    v_fmac_f32 v75, v53, v3
    v_lshlrev_b32 v2, 16, v21
    v_and_b32 v3, 0xffff0000, v21
    v_fmac_f32 v76, v53, v2
    v_fmac_f32 v77, v53, v3
    s_waitcnt vmcnt(15)
    v_lshlrev_b32 v2, 16, v22
    v_and_b32 v3, 0xffff0000, v22
    v_fmac_f32 v54, v126, v2
    v_fmac_f32 v55, v126, v3
    v_lshlrev_b32 v2, 16, v23
    v_and_b32 v3, 0xffff0000, v23
    v_fmac_f32 v56, v126, v2
    v_fmac_f32 v57, v126, v3
    v_lshlrev_b32 v2, 16, v24
    v_and_b32 v3, 0xffff0000, v24
    v_fmac_f32 v58, v126, v2
    v_fmac_f32 v59, v126, v3
    v_lshlrev_b32 v2, 16, v25
    v_and_b32 v3, 0xffff0000, v25
    v_fmac_f32 v60, v126, v2
    v_fmac_f32 v61, v126, v3
    v_lshlrev_b32 v2, 16, v26
    v_and_b32 v3, 0xffff0000, v26
    v_fmac_f32 v62, v126, v2
    v_fmac_f32 v63, v126, v3
    v_lshlrev_b32 v2, 16, v27
    v_and_b32 v3, 0xffff0000, v27
    v_fmac_f32 v64, v126, v2
    v_fmac_f32 v65, v126, v3
    v_lshlrev_b32 v2, 16, v28
    v_and_b32 v3, 0xffff0000, v28
    v_fmac_f32 v66, v126, v2
    v_fmac_f32 v67, v126, v3
    v_lshlrev_b32 v2, 16, v29
    v_and_b32 v3, 0xffff0000, v29
    v_fmac_f32 v68, v126, v2
    v_fmac_f32 v69, v126, v3
    v_lshlrev_b32 v2, 16, v30
    v_and_b32 v3, 0xffff0000, v30
    v_fmac_f32 v70, v126, v2
    v_fmac_f32 v71, v126, v3
    v_lshlrev_b32 v2, 16, v31
    v_and_b32 v3, 0xffff0000, v31
    v_fmac_f32 v72, v126, v2
    v_fmac_f32 v73, v126, v3
    v_lshlrev_b32 v2, 16, v32
    v_and_b32 v3, 0xffff0000, v32
    v_fmac_f32 v74, v126, v2
    v_fmac_f32 v75, v126, v3
    v_lshlrev_b32 v2, 16, v33
    v_and_b32 v3, 0xffff0000, v33
    v_fmac_f32 v76, v126, v2
    v_fmac_f32 v77, v126, v3
    s_waitcnt vmcnt(12)
    v_lshlrev_b32 v2, 16, v34
    v_and_b32 v3, 0xffff0000, v34
    v_fmac_f32 v54, v127, v2
    v_fmac_f32 v55, v127, v3
    v_lshlrev_b32 v2, 16, v35
    v_and_b32 v3, 0xffff0000, v35
    v_fmac_f32 v56, v127, v2
    v_fmac_f32 v57, v127, v3
    v_lshlrev_b32 v2, 16, v36
    v_and_b32 v3, 0xffff0000, v36
    v_fmac_f32 v58, v127, v2
    v_fmac_f32 v59, v127, v3
    v_lshlrev_b32 v2, 16, v37
    v_and_b32 v3, 0xffff0000, v37
    v_fmac_f32 v60, v127, v2
    v_fmac_f32 v61, v127, v3
    v_lshlrev_b32 v2, 16, v38
    v_and_b32 v3, 0xffff0000, v38
    v_fmac_f32 v62, v127, v2
    v_fmac_f32 v63, v127, v3
    v_lshlrev_b32 v2, 16, v39
    v_and_b32 v3, 0xffff0000, v39
    v_fmac_f32 v64, v127, v2
    v_fmac_f32 v65, v127, v3
    v_lshlrev_b32 v2, 16, v40
    v_and_b32 v3, 0xffff0000, v40
    v_fmac_f32 v66, v127, v2
    v_fmac_f32 v67, v127, v3
    v_lshlrev_b32 v2, 16, v41
    v_and_b32 v3, 0xffff0000, v41
    v_fmac_f32 v68, v127, v2
    v_fmac_f32 v69, v127, v3
    v_lshlrev_b32 v2, 16, v42
    v_and_b32 v3, 0xffff0000, v42
    v_fmac_f32 v70, v127, v2
    v_fmac_f32 v71, v127, v3
    v_lshlrev_b32 v2, 16, v43
    v_and_b32 v3, 0xffff0000, v43
    v_fmac_f32 v72, v127, v2
    v_fmac_f32 v73, v127, v3
    v_lshlrev_b32 v2, 16, v44
    v_and_b32 v3, 0xffff0000, v44
    v_fmac_f32 v74, v127, v2
    v_fmac_f32 v75, v127, v3
    v_lshlrev_b32 v2, 16, v45
    v_and_b32 v3, 0xffff0000, v45
    v_fmac_f32 v76, v127, v2
    v_fmac_f32 v77, v127, v3
    s_nop 1
    v_permlane32_swap_b32 v54, v58
    v_permlane32_swap_b32 v55, v59
    v_permlane32_swap_b32 v56, v60
    v_permlane32_swap_b32 v57, v61
    v_permlane32_swap_b32 v62, v66
    v_permlane32_swap_b32 v63, v67
    v_permlane32_swap_b32 v64, v68
    v_permlane32_swap_b32 v65, v69
    v_permlane32_swap_b32 v70, v74
    v_permlane32_swap_b32 v71, v75
    v_permlane32_swap_b32 v72, v76
    v_permlane32_swap_b32 v73, v77
    v_add_f32 v54, v54, v58
    v_add_f32 v55, v55, v59
    v_add_f32 v56, v56, v60
    v_add_f32 v57, v57, v61
    v_add_f32 v62, v62, v66
    v_add_f32 v63, v63, v67
    v_add_f32 v64, v64, v68
    v_add_f32 v65, v65, v69
    v_add_f32 v70, v70, v74
    v_add_f32 v71, v71, v75
    v_add_f32 v72, v72, v76
    v_add_f32 v73, v73, v77
    s_nop 1
    v_permlane16_swap_b32 v54, v56
    v_permlane16_swap_b32 v55, v57
    v_permlane16_swap_b32 v62, v64
    v_permlane16_swap_b32 v63, v65
    v_permlane16_swap_b32 v70, v72
    v_permlane16_swap_b32 v71, v73
    v_add_f32 v54, v54, v56
    v_add_f32 v55, v55, v57
    v_add_f32 v62, v62, v64
    v_add_f32 v63, v63, v65
    v_add_f32 v70, v70, v72
    v_add_f32 v71, v71, v73
    s_nop 1
    v_add_f32_dpp v54, v54, v54 row_ror:8 row_mask:0xf bank_mask:0xf
    v_add_f32_dpp v55, v55, v55 row_ror:8 row_mask:0xf bank_mask:0xf
    v_add_f32_dpp v62, v62, v62 row_ror:8 row_mask:0xf bank_mask:0xf
    v_add_f32_dpp v63, v63, v63 row_ror:8 row_mask:0xf bank_mask:0xf
    v_add_f32_dpp v70, v70, v70 row_ror:8 row_mask:0xf bank_mask:0xf
    v_add_f32_dpp v71, v71, v71 row_ror:8 row_mask:0xf bank_mask:0xf
    v_lshrrev_b32 v2, 6, v0
    v_mul_u32_u24 v9, 768, v2
    v_and_b32 v2, 7, v6
    v_lshlrev_b32 v2, 5, v2
    v_add_u32 v9, v9, v2
    v_lshrrev_b32 v2, 5, v6
    v_lshlrev_b32 v2, 4, v2
    v_add_u32 v9, v9, v2
    v_bfe_u32 v2, v6, 4, 1
    v_lshlrev_b32 v2, 3, v2
    v_add_u32 v9, v9, v2
    ds_write_b64 v9, v[54:55] offset:0
    ds_write_b64 v9, v[62:63] offset:256
    ds_write_b64 v9, v[70:71] offset:512
    s_waitcnt lgkmcnt(0)
    s_barrier
    v_cmp_gt_u32 vcc, 192, v0
    s_and_saveexec_b64 s[100:101], vcc
    s_cbranch_execz L_q1
    v_lshlrev_b32 v2, 2, v0
    ds_read_b32 v54, v2 offset:0
    ds_read_b32 v55, v2 offset:768
    ds_read_b32 v56, v2 offset:1536
    ds_read_b32 v57, v2 offset:2304
    ds_read_b32 v58, v2 offset:3072
    ds_read_b32 v59, v2 offset:3840
    ds_read_b32 v60, v2 offset:4608
    ds_read_b32 v61, v2 offset:5376
    ds_read_b32 v62, v2 offset:6144
    ds_read_b32 v63, v2 offset:6912
    ds_read_b32 v64, v2 offset:7680
    ds_read_b32 v65, v2 offset:8448
    ds_read_b32 v66, v2 offset:9216
    ds_read_b32 v67, v2 offset:9984
    ds_read_b32 v68, v2 offset:10752
    ds_read_b32 v69, v2 offset:11520
    s_waitcnt lgkmcnt(0)
    v_add_f32 v54, v54, v55
    v_add_f32 v54, v54, v56
    v_add_f32 v54, v54, v57
    v_add_f32 v54, v54, v58
    v_add_f32 v54, v54, v59
    v_add_f32 v54, v54, v60
    v_add_f32 v54, v54, v61
    v_add_f32 v54, v54, v62
    v_add_f32 v54, v54, v63
    v_add_f32 v54, v54, v64
    v_add_f32 v54, v54, v65
    v_add_f32 v54, v54, v66
    v_add_f32 v54, v54, v67
    v_add_f32 v54, v54, v68
    v_add_f32 v54, v54, v69
    v_cvt_pk_bf16_f32 v54, v54, v54
    v_lshlrev_b32 v2, 1, v0
    ds_write_b16 v2, v54 offset:12288
    s_waitcnt lgkmcnt(0)
L_q1:
    s_mov_b64 exec, s[100:101]
    s_barrier
    v_and_b32 v2, 7, v6
    v_lshlrev_b32 v2, 4, v2
    ds_read_b128 v[10:13], v2 offset:12288
    ds_read_b128 v[14:17], v2 offset:12416
    ds_read_b128 v[18:21], v2 offset:12544
    s_waitcnt lgkmcnt(0)
    v_mov_b32 v30, 0xff7fffff
    v_mov_b32 v31, 0
    v_mov_b32 v54, 0
    v_mov_b32 v55, 0
    v_mov_b32 v56, 0
    v_mov_b32 v57, 0
    v_mov_b32 v58, 0
    v_mov_b32 v59, 0
    v_mov_b32 v60, 0
    v_mov_b32 v61, 0
    v_mov_b32 v62, 0
    v_mov_b32 v63, 0
    v_mov_b32 v64, 0
    v_mov_b32 v65, 0
    v_mov_b32 v66, 0
    v_mov_b32 v67, 0
    v_mov_b32 v68, 0
    v_mov_b32 v69, 0
    v_mov_b32 v70, 0
    v_mov_b32 v71, 0
    v_mov_b32 v72, 0
    v_mov_b32 v73, 0
    v_mov_b32 v74, 0
    v_mov_b32 v75, 0
    v_mov_b32 v76, 0
    v_mov_b32 v77, 0
    v_mov_b32 v33, 12928
    v_mov_b32 v34, 1
    s_mov_b32 s52, 0x3fb8aa3b
L_loop:
    s_mov_b64 exec, 1
    ds_add_rtn_u32 v32, v33, v34
    s_mov_b64 exec, -1
    s_waitcnt vmcnt(9)
    v_dot2_f32_bf16 v2, v78, v10, 0
    v_dot2_f32_bf16 v3, v82, v14, 0
    v_dot2_f32_bf16 v4, v86, v18, 0
    v_dot2_f32_bf16 v2, v79, v11, v2
    v_dot2_f32_bf16 v3, v83, v15, v3
    v_dot2_f32_bf16 v4, v87, v19, v4
    v_dot2_f32_bf16 v2, v80, v12, v2
    v_dot2_f32_bf16 v3, v84, v16, v3
    v_dot2_f32_bf16 v4, v88, v20, v4
    v_dot2_f32_bf16 v2, v81, v13, v2
    v_dot2_f32_bf16 v3, v85, v17, v3
    v_dot2_f32_bf16 v4, v89, v21, v4
    s_add_u32 s48, s41, 12288
    buffer_load_dwordx4 v[78:81], v1, s[16:19], s48 offen offset:0 nt
    buffer_load_dwordx4 v[82:85], v1, s[16:19], s48 offen offset:128 nt
    buffer_load_dwordx4 v[86:89], v1, s[16:19], s48 offen offset:256 nt
    v_add_f32 v2, v2, v3
    v_add_f32 v2, v2, v4
    s_nop 1
    v_add_f32_dpp v2, v2, v2 quad_perm:[1,0,3,2] row_mask:0xf bank_mask:0xf
    s_nop 1
    v_add_f32_dpp v2, v2, v2 quad_perm:[2,3,0,1] row_mask:0xf bank_mask:0xf
    s_nop 1
    v_add_f32_dpp v2, v2, v2 row_half_mirror row_mask:0xf bank_mask:0xf
    v_cvt_pk_bf16_f32 v2, v2, v2
    v_lshlrev_b32 v2, 16, v2
    v_mul_f32 v2, 0x3d93cd3a, v2
    v_cvt_pk_bf16_f32 v2, v2, v2
    v_lshlrev_b32 v22, 16, v2
    s_waitcnt vmcnt(9)
    v_dot2_f32_bf16 v2, v90, v10, 0
    v_dot2_f32_bf16 v3, v94, v14, 0
    v_dot2_f32_bf16 v4, v98, v18, 0
    v_dot2_f32_bf16 v2, v91, v11, v2
    v_dot2_f32_bf16 v3, v95, v15, v3
    v_dot2_f32_bf16 v4, v99, v19, v4
    v_dot2_f32_bf16 v2, v92, v12, v2
    v_dot2_f32_bf16 v3, v96, v16, v3
    v_dot2_f32_bf16 v4, v100, v20, v4
    v_dot2_f32_bf16 v2, v93, v13, v2
    v_dot2_f32_bf16 v3, v97, v17, v3
    v_dot2_f32_bf16 v4, v101, v21, v4
    s_add_u32 s48, s41, 15360
    buffer_load_dwordx4 v[90:93], v1, s[16:19], s48 offen offset:0 nt
    buffer_load_dwordx4 v[94:97], v1, s[16:19], s48 offen offset:128 nt
    buffer_load_dwordx4 v[98:101], v1, s[16:19], s48 offen offset:256 nt
    v_add_f32 v2, v2, v3
    v_add_f32 v2, v2, v4
    s_nop 1
    v_add_f32_dpp v2, v2, v2 quad_perm:[1,0,3,2] row_mask:0xf bank_mask:0xf
    s_nop 1
    v_add_f32_dpp v2, v2, v2 quad_perm:[2,3,0,1] row_mask:0xf bank_mask:0xf
    s_nop 1
    v_add_f32_dpp v2, v2, v2 row_half_mirror row_mask:0xf bank_mask:0xf
    v_cvt_pk_bf16_f32 v2, v2, v2
    v_lshlrev_b32 v2, 16, v2
    v_mul_f32 v2, 0x3d93cd3a, v2
    v_cvt_pk_bf16_f32 v2, v2, v2
    v_lshlrev_b32 v23, 16, v2
    s_waitcnt vmcnt(9)
    v_dot2_f32_bf16 v2, v102, v10, 0
    v_dot2_f32_bf16 v3, v106, v14, 0
    v_dot2_f32_bf16 v4, v110, v18, 0
    v_dot2_f32_bf16 v2, v103, v11, v2
    v_dot2_f32_bf16 v3, v107, v15, v3
    v_dot2_f32_bf16 v4, v111, v19, v4
    v_dot2_f32_bf16 v2, v104, v12, v2
    v_dot2_f32_bf16 v3, v108, v16, v3
    v_dot2_f32_bf16 v4, v112, v20, v4
    v_dot2_f32_bf16 v2, v105, v13, v2
    v_dot2_f32_bf16 v3, v109, v17, v3
    v_dot2_f32_bf16 v4, v113, v21, v4
    s_add_u32 s48, s41, 18432
    buffer_load_dwordx4 v[102:105], v1, s[16:19], s48 offen offset:0 nt
    buffer_load_dwordx4 v[106:109], v1, s[16:19], s48 offen offset:128 nt
    buffer_load_dwordx4 v[110:113], v1, s[16:19], s48 offen offset:256 nt
    v_add_f32 v2, v2, v3
    v_add_f32 v2, v2, v4
    s_nop 1
    v_add_f32_dpp v2, v2, v2 quad_perm:[1,0,3,2] row_mask:0xf bank_mask:0xf
    s_nop 1
    v_add_f32_dpp v2, v2, v2 quad_perm:[2,3,0,1] row_mask:0xf bank_mask:0xf
    s_nop 1
    v_add_f32_dpp v2, v2, v2 row_half_mirror row_mask:0xf bank_mask:0xf
    v_cvt_pk_bf16_f32 v2, v2, v2
    v_lshlrev_b32 v2, 16, v2
    v_mul_f32 v2, 0x3d93cd3a, v2
    v_cvt_pk_bf16_f32 v2, v2, v2
    v_lshlrev_b32 v24, 16, v2
    s_waitcnt lgkmcnt(0)
    v_readfirstlane_b32 s49, v32
    s_mul_i32 s47, s49, 24576
    s_waitcnt vmcnt(9)
    v_dot2_f32_bf16 v2, v114, v10, 0
    v_dot2_f32_bf16 v3, v118, v14, 0
    v_dot2_f32_bf16 v4, v122, v18, 0
    v_dot2_f32_bf16 v2, v115, v11, v2
    v_dot2_f32_bf16 v3, v119, v15, v3
    v_dot2_f32_bf16 v4, v123, v19, v4
    v_dot2_f32_bf16 v2, v116, v12, v2
    v_dot2_f32_bf16 v3, v120, v16, v3
    v_dot2_f32_bf16 v4, v124, v20, v4
    v_dot2_f32_bf16 v2, v117, v13, v2
    v_dot2_f32_bf16 v3, v121, v17, v3
    v_dot2_f32_bf16 v4, v125, v21, v4
    s_add_u32 s48, s41, 21504
    buffer_load_dwordx4 v[114:117], v1, s[16:19], s48 offen offset:0 nt
    buffer_load_dwordx4 v[118:121], v1, s[16:19], s48 offen offset:128 nt
    buffer_load_dwordx4 v[122:125], v1, s[16:19], s48 offen offset:256 nt
    v_add_f32 v2, v2, v3
    v_add_f32 v2, v2, v4
    s_nop 1
    v_add_f32_dpp v2, v2, v2 quad_perm:[1,0,3,2] row_mask:0xf bank_mask:0xf
    s_nop 1
    v_add_f32_dpp v2, v2, v2 quad_perm:[2,3,0,1] row_mask:0xf bank_mask:0xf
    s_nop 1
    v_add_f32_dpp v2, v2, v2 row_half_mirror row_mask:0xf bank_mask:0xf
    v_cvt_pk_bf16_f32 v2, v2, v2
    v_lshlrev_b32 v2, 16, v2
    v_mul_f32 v2, 0x3d93cd3a, v2
    v_cvt_pk_bf16_f32 v2, v2, v2
    v_lshlrev_b32 v25, 16, v2
    s_waitcnt vmcnt(9)
    v_dot2_f32_bf16 v2, v78, v10, 0
    v_dot2_f32_bf16 v3, v82, v14, 0
    v_dot2_f32_bf16 v4, v86, v18, 0
    v_dot2_f32_bf16 v2, v79, v11, v2
    v_dot2_f32_bf16 v3, v83, v15, v3
    v_dot2_f32_bf16 v4, v87, v19, v4
    v_dot2_f32_bf16 v2, v80, v12, v2
    v_dot2_f32_bf16 v3, v84, v16, v3
    v_dot2_f32_bf16 v4, v88, v20, v4
    v_dot2_f32_bf16 v2, v81, v13, v2
    v_dot2_f32_bf16 v3, v85, v17, v3
    v_dot2_f32_bf16 v4, v89, v21, v4
    s_add_u32 s48, s41, 0
    buffer_load_dwordx4 v[78:81], v1, s[20:23], s48 offen offset:0 nt
    buffer_load_dwordx4 v[82:85], v1, s[20:23], s48 offen offset:128 nt
    buffer_load_dwordx4 v[86:89], v1, s[20:23], s48 offen offset:256 nt
    v_add_f32 v2, v2, v3
    v_add_f32 v2, v2, v4
    s_nop 1
    v_add_f32_dpp v2, v2, v2 quad_perm:[1,0,3,2] row_mask:0xf bank_mask:0xf
    s_nop 1
    v_add_f32_dpp v2, v2, v2 quad_perm:[2,3,0,1] row_mask:0xf bank_mask:0xf
    s_nop 1
    v_add_f32_dpp v2, v2, v2 row_half_mirror row_mask:0xf bank_mask:0xf
    v_cvt_pk_bf16_f32 v2, v2, v2
    v_lshlrev_b32 v2, 16, v2
    v_mul_f32 v2, 0x3d93cd3a, v2
    v_cvt_pk_bf16_f32 v2, v2, v2
    v_lshlrev_b32 v26, 16, v2
    s_waitcnt vmcnt(9)
    v_dot2_f32_bf16 v2, v90, v10, 0
    v_dot2_f32_bf16 v3, v94, v14, 0
    v_dot2_f32_bf16 v4, v98, v18, 0
    v_dot2_f32_bf16 v2, v91, v11, v2
    v_dot2_f32_bf16 v3, v95, v15, v3
    v_dot2_f32_bf16 v4, v99, v19, v4
    v_dot2_f32_bf16 v2, v92, v12, v2
    v_dot2_f32_bf16 v3, v96, v16, v3
    v_dot2_f32_bf16 v4, v100, v20, v4
    v_dot2_f32_bf16 v2, v93, v13, v2
    v_dot2_f32_bf16 v3, v97, v17, v3
    v_dot2_f32_bf16 v4, v101, v21, v4
    s_add_u32 s48, s41, 3072
    buffer_load_dwordx4 v[90:93], v1, s[20:23], s48 offen offset:0 nt
    buffer_load_dwordx4 v[94:97], v1, s[20:23], s48 offen offset:128 nt
    buffer_load_dwordx4 v[98:101], v1, s[20:23], s48 offen offset:256 nt
    v_add_f32 v2, v2, v3
    v_add_f32 v2, v2, v4
    s_nop 1
    v_add_f32_dpp v2, v2, v2 quad_perm:[1,0,3,2] row_mask:0xf bank_mask:0xf
    s_nop 1
    v_add_f32_dpp v2, v2, v2 quad_perm:[2,3,0,1] row_mask:0xf bank_mask:0xf
    s_nop 1
    v_add_f32_dpp v2, v2, v2 row_half_mirror row_mask:0xf bank_mask:0xf
    v_cvt_pk_bf16_f32 v2, v2, v2
    v_lshlrev_b32 v2, 16, v2
    v_mul_f32 v2, 0x3d93cd3a, v2
    v_cvt_pk_bf16_f32 v2, v2, v2
    v_lshlrev_b32 v27, 16, v2
    s_waitcnt vmcnt(9)
    v_dot2_f32_bf16 v2, v102, v10, 0
    v_dot2_f32_bf16 v3, v106, v14, 0
    v_dot2_f32_bf16 v4, v110, v18, 0
    v_dot2_f32_bf16 v2, v103, v11, v2
    v_dot2_f32_bf16 v3, v107, v15, v3
    v_dot2_f32_bf16 v4, v111, v19, v4
    v_dot2_f32_bf16 v2, v104, v12, v2
    v_dot2_f32_bf16 v3, v108, v16, v3
    v_dot2_f32_bf16 v4, v112, v20, v4
    v_dot2_f32_bf16 v2, v105, v13, v2
    v_dot2_f32_bf16 v3, v109, v17, v3
    v_dot2_f32_bf16 v4, v113, v21, v4
    s_add_u32 s48, s41, 6144
    buffer_load_dwordx4 v[102:105], v1, s[20:23], s48 offen offset:0 nt
    buffer_load_dwordx4 v[106:109], v1, s[20:23], s48 offen offset:128 nt
    buffer_load_dwordx4 v[110:113], v1, s[20:23], s48 offen offset:256 nt
    v_add_f32 v2, v2, v3
    v_add_f32 v2, v2, v4
    s_nop 1
    v_add_f32_dpp v2, v2, v2 quad_perm:[1,0,3,2] row_mask:0xf bank_mask:0xf
    s_nop 1
    v_add_f32_dpp v2, v2, v2 quad_perm:[2,3,0,1] row_mask:0xf bank_mask:0xf
    s_nop 1
    v_add_f32_dpp v2, v2, v2 row_half_mirror row_mask:0xf bank_mask:0xf
    v_cvt_pk_bf16_f32 v2, v2, v2
    v_lshlrev_b32 v2, 16, v2
    v_mul_f32 v2, 0x3d93cd3a, v2
    v_cvt_pk_bf16_f32 v2, v2, v2
    v_lshlrev_b32 v28, 16, v2
    s_waitcnt vmcnt(9)
    v_dot2_f32_bf16 v2, v114, v10, 0
    v_dot2_f32_bf16 v3, v118, v14, 0
    v_dot2_f32_bf16 v4, v122, v18, 0
    v_dot2_f32_bf16 v2, v115, v11, v2
    v_dot2_f32_bf16 v3, v119, v15, v3
    v_dot2_f32_bf16 v4, v123, v19, v4
    v_dot2_f32_bf16 v2, v116, v12, v2
    v_dot2_f32_bf16 v3, v120, v16, v3
    v_dot2_f32_bf16 v4, v124, v20, v4
    v_dot2_f32_bf16 v2, v117, v13, v2
    v_dot2_f32_bf16 v3, v121, v17, v3
    v_dot2_f32_bf16 v4, v125, v21, v4
    s_add_u32 s48, s41, 9216
    buffer_load_dwordx4 v[114:117], v1, s[20:23], s48 offen offset:0 nt
    buffer_load_dwordx4 v[118:121], v1, s[20:23], s48 offen offset:128 nt
    buffer_load_dwordx4 v[122:125], v1, s[20:23], s48 offen offset:256 nt
    v_add_f32 v2, v2, v3
    v_add_f32 v2, v2, v4
    s_nop 1
    v_add_f32_dpp v2, v2, v2 quad_perm:[1,0,3,2] row_mask:0xf bank_mask:0xf
    s_nop 1
    v_add_f32_dpp v2, v2, v2 quad_perm:[2,3,0,1] row_mask:0xf bank_mask:0xf
    s_nop 1
    v_add_f32_dpp v2, v2, v2 row_half_mirror row_mask:0xf bank_mask:0xf
    v_cvt_pk_bf16_f32 v2, v2, v2
    v_lshlrev_b32 v2, 16, v2
    v_mul_f32 v2, 0x3d93cd3a, v2
    v_cvt_pk_bf16_f32 v2, v2, v2
    v_lshlrev_b32 v29, 16, v2
    v_max3_f32 v2, v22, v23, v24
    v_max3_f32 v2, v2, v25, v26
    v_max3_f32 v2, v2, v27, v28
    v_max_f32 v2, v2, v29
    s_nop 1
    v_max_f32_dpp v2, v2, v2 row_ror:8 row_mask:0xf bank_mask:0xf
    s_nop 1
    v_readlane_b32 s48, v2, 0
    v_readlane_b32 s49, v2, 16
    v_readlane_b32 s50, v2, 32
    v_readlane_b32 s51, v2, 48
    s_nop 1
    v_mov_b32 v2, s48
    v_max_f32 v2, s49, v2
    v_max_f32 v2, s50, v2
    v_max_f32 v2, s51, v2
    v_max_f32 v2, v2, v30
    v_sub_f32 v3, v30, v2
    v_mul_f32 v3, s52, v3
    v_exp_f32 v3, v3
    v_mov_b32 v30, v2
    v_mul_f32 v4, s52, v2
    v_fma_f32 v22, v22, s52, -v4
    v_exp_f32 v22, v22
    v_fma_f32 v23, v23, s52, -v4
    v_exp_f32 v23, v23
    v_fma_f32 v24, v24, s52, -v4
    v_exp_f32 v24, v24
    v_fma_f32 v25, v25, s52, -v4
    v_exp_f32 v25, v25
    v_fma_f32 v26, v26, s52, -v4
    v_exp_f32 v26, v26
    v_fma_f32 v27, v27, s52, -v4
    v_exp_f32 v27, v27
    v_fma_f32 v28, v28, s52, -v4
    v_exp_f32 v28, v28
    v_fma_f32 v29, v29, s52, -v4
    v_exp_f32 v29, v29
    v_mul_f32 v31, v31, v3
    v_mul_f32 v54, v54, v3
    v_mul_f32 v55, v55, v3
    v_mul_f32 v56, v56, v3
    v_mul_f32 v57, v57, v3
    v_mul_f32 v58, v58, v3
    v_mul_f32 v59, v59, v3
    v_mul_f32 v60, v60, v3
    v_mul_f32 v61, v61, v3
    v_mul_f32 v62, v62, v3
    v_mul_f32 v63, v63, v3
    v_mul_f32 v64, v64, v3
    v_mul_f32 v65, v65, v3
    v_mul_f32 v66, v66, v3
    v_mul_f32 v67, v67, v3
    v_mul_f32 v68, v68, v3
    v_mul_f32 v69, v69, v3
    v_mul_f32 v70, v70, v3
    v_mul_f32 v71, v71, v3
    v_mul_f32 v72, v72, v3
    v_mul_f32 v73, v73, v3
    v_mul_f32 v74, v74, v3
    v_mul_f32 v75, v75, v3
    v_mul_f32 v76, v76, v3
    v_mul_f32 v77, v77, v3
    v_add_f32 v31, v31, v22
    v_add_f32 v31, v31, v23
    v_add_f32 v31, v31, v24
    v_add_f32 v31, v31, v25
    v_add_f32 v31, v31, v26
    v_add_f32 v31, v31, v27
    v_add_f32 v31, v31, v28
    v_add_f32 v31, v31, v29
    s_waitcnt vmcnt(9)
    v_lshlrev_b32 v4, 16, v78
    v_and_b32 v5, 0xffff0000, v78
    v_fmac_f32 v54, v22, v4
    v_fmac_f32 v55, v22, v5
    v_lshlrev_b32 v4, 16, v79
    v_and_b32 v5, 0xffff0000, v79
    v_fmac_f32 v56, v22, v4
    v_fmac_f32 v57, v22, v5
    v_lshlrev_b32 v4, 16, v80
    v_and_b32 v5, 0xffff0000, v80
    v_fmac_f32 v58, v22, v4
    v_fmac_f32 v59, v22, v5
    v_lshlrev_b32 v4, 16, v81
    v_and_b32 v5, 0xffff0000, v81
    v_fmac_f32 v60, v22, v4
    v_fmac_f32 v61, v22, v5
    v_lshlrev_b32 v4, 16, v82
    v_and_b32 v5, 0xffff0000, v82
    v_fmac_f32 v62, v22, v4
    v_fmac_f32 v63, v22, v5
    v_lshlrev_b32 v4, 16, v83
    v_and_b32 v5, 0xffff0000, v83
    v_fmac_f32 v64, v22, v4
    v_fmac_f32 v65, v22, v5
    v_lshlrev_b32 v4, 16, v84
    v_and_b32 v5, 0xffff0000, v84
    v_fmac_f32 v66, v22, v4
    v_fmac_f32 v67, v22, v5
    v_lshlrev_b32 v4, 16, v85
    v_and_b32 v5, 0xffff0000, v85
    v_fmac_f32 v68, v22, v4
    v_fmac_f32 v69, v22, v5
    v_lshlrev_b32 v4, 16, v86
    v_and_b32 v5, 0xffff0000, v86
    v_fmac_f32 v70, v22, v4
    v_fmac_f32 v71, v22, v5
    v_lshlrev_b32 v4, 16, v87
    v_and_b32 v5, 0xffff0000, v87
    v_fmac_f32 v72, v22, v4
    v_fmac_f32 v73, v22, v5
    v_lshlrev_b32 v4, 16, v88
    v_and_b32 v5, 0xffff0000, v88
    v_fmac_f32 v74, v22, v4
    v_fmac_f32 v75, v22, v5
    v_lshlrev_b32 v4, 16, v89
    v_and_b32 v5, 0xffff0000, v89
    v_fmac_f32 v76, v22, v4
    v_fmac_f32 v77, v22, v5
    s_add_u32 s48, s41, 12288
    buffer_load_dwordx4 v[78:81], v1, s[20:23], s48 offen offset:0 nt
    buffer_load_dwordx4 v[82:85], v1, s[20:23], s48 offen offset:128 nt
    buffer_load_dwordx4 v[86:89], v1, s[20:23], s48 offen offset:256 nt
    s_waitcnt vmcnt(9)
    v_lshlrev_b32 v4, 16, v90
    v_and_b32 v5, 0xffff0000, v90
    v_fmac_f32 v54, v23, v4
    v_fmac_f32 v55, v23, v5
    v_lshlrev_b32 v4, 16, v91
    v_and_b32 v5, 0xffff0000, v91
    v_fmac_f32 v56, v23, v4
    v_fmac_f32 v57, v23, v5
    v_lshlrev_b32 v4, 16, v92
    v_and_b32 v5, 0xffff0000, v92
    v_fmac_f32 v58, v23, v4
    v_fmac_f32 v59, v23, v5
    v_lshlrev_b32 v4, 16, v93
    v_and_b32 v5, 0xffff0000, v93
    v_fmac_f32 v60, v23, v4
    v_fmac_f32 v61, v23, v5
    v_lshlrev_b32 v4, 16, v94
    v_and_b32 v5, 0xffff0000, v94
    v_fmac_f32 v62, v23, v4
    v_fmac_f32 v63, v23, v5
    v_lshlrev_b32 v4, 16, v95
    v_and_b32 v5, 0xffff0000, v95
    v_fmac_f32 v64, v23, v4
    v_fmac_f32 v65, v23, v5
    v_lshlrev_b32 v4, 16, v96
    v_and_b32 v5, 0xffff0000, v96
    v_fmac_f32 v66, v23, v4
    v_fmac_f32 v67, v23, v5
    v_lshlrev_b32 v4, 16, v97
    v_and_b32 v5, 0xffff0000, v97
    v_fmac_f32 v68, v23, v4
    v_fmac_f32 v69, v23, v5
    v_lshlrev_b32 v4, 16, v98
    v_and_b32 v5, 0xffff0000, v98
    v_fmac_f32 v70, v23, v4
    v_fmac_f32 v71, v23, v5
    v_lshlrev_b32 v4, 16, v99
    v_and_b32 v5, 0xffff0000, v99
    v_fmac_f32 v72, v23, v4
    v_fmac_f32 v73, v23, v5
    v_lshlrev_b32 v4, 16, v100
    v_and_b32 v5, 0xffff0000, v100
    v_fmac_f32 v74, v23, v4
    v_fmac_f32 v75, v23, v5
    v_lshlrev_b32 v4, 16, v101
    v_and_b32 v5, 0xffff0000, v101
    v_fmac_f32 v76, v23, v4
    v_fmac_f32 v77, v23, v5
    s_add_u32 s48, s41, 15360
    buffer_load_dwordx4 v[90:93], v1, s[20:23], s48 offen offset:0 nt
    buffer_load_dwordx4 v[94:97], v1, s[20:23], s48 offen offset:128 nt
    buffer_load_dwordx4 v[98:101], v1, s[20:23], s48 offen offset:256 nt
    s_waitcnt vmcnt(9)
    v_lshlrev_b32 v4, 16, v102
    v_and_b32 v5, 0xffff0000, v102
    v_fmac_f32 v54, v24, v4
    v_fmac_f32 v55, v24, v5
    v_lshlrev_b32 v4, 16, v103
    v_and_b32 v5, 0xffff0000, v103
    v_fmac_f32 v56, v24, v4
    v_fmac_f32 v57, v24, v5
    v_lshlrev_b32 v4, 16, v104
    v_and_b32 v5, 0xffff0000, v104
    v_fmac_f32 v58, v24, v4
    v_fmac_f32 v59, v24, v5
    v_lshlrev_b32 v4, 16, v105
    v_and_b32 v5, 0xffff0000, v105
    v_fmac_f32 v60, v24, v4
    v_fmac_f32 v61, v24, v5
    v_lshlrev_b32 v4, 16, v106
    v_and_b32 v5, 0xffff0000, v106
    v_fmac_f32 v62, v24, v4
    v_fmac_f32 v63, v24, v5
    v_lshlrev_b32 v4, 16, v107
    v_and_b32 v5, 0xffff0000, v107
    v_fmac_f32 v64, v24, v4
    v_fmac_f32 v65, v24, v5
    v_lshlrev_b32 v4, 16, v108
    v_and_b32 v5, 0xffff0000, v108
    v_fmac_f32 v66, v24, v4
    v_fmac_f32 v67, v24, v5
    v_lshlrev_b32 v4, 16, v109
    v_and_b32 v5, 0xffff0000, v109
    v_fmac_f32 v68, v24, v4
    v_fmac_f32 v69, v24, v5
    v_lshlrev_b32 v4, 16, v110
    v_and_b32 v5, 0xffff0000, v110
    v_fmac_f32 v70, v24, v4
    v_fmac_f32 v71, v24, v5
    v_lshlrev_b32 v4, 16, v111
    v_and_b32 v5, 0xffff0000, v111
    v_fmac_f32 v72, v24, v4
    v_fmac_f32 v73, v24, v5
    v_lshlrev_b32 v4, 16, v112
    v_and_b32 v5, 0xffff0000, v112
    v_fmac_f32 v74, v24, v4
    v_fmac_f32 v75, v24, v5
    v_lshlrev_b32 v4, 16, v113
    v_and_b32 v5, 0xffff0000, v113
    v_fmac_f32 v76, v24, v4
    v_fmac_f32 v77, v24, v5
    s_add_u32 s48, s41, 18432
    buffer_load_dwordx4 v[102:105], v1, s[20:23], s48 offen offset:0 nt
    buffer_load_dwordx4 v[106:109], v1, s[20:23], s48 offen offset:128 nt
    buffer_load_dwordx4 v[110:113], v1, s[20:23], s48 offen offset:256 nt
    s_waitcnt vmcnt(9)
    v_lshlrev_b32 v4, 16, v114
    v_and_b32 v5, 0xffff0000, v114
    v_fmac_f32 v54, v25, v4
    v_fmac_f32 v55, v25, v5
    v_lshlrev_b32 v4, 16, v115
    v_and_b32 v5, 0xffff0000, v115
    v_fmac_f32 v56, v25, v4
    v_fmac_f32 v57, v25, v5
    v_lshlrev_b32 v4, 16, v116
    v_and_b32 v5, 0xffff0000, v116
    v_fmac_f32 v58, v25, v4
    v_fmac_f32 v59, v25, v5
    v_lshlrev_b32 v4, 16, v117
    v_and_b32 v5, 0xffff0000, v117
    v_fmac_f32 v60, v25, v4
    v_fmac_f32 v61, v25, v5
    v_lshlrev_b32 v4, 16, v118
    v_and_b32 v5, 0xffff0000, v118
    v_fmac_f32 v62, v25, v4
    v_fmac_f32 v63, v25, v5
    v_lshlrev_b32 v4, 16, v119
    v_and_b32 v5, 0xffff0000, v119
    v_fmac_f32 v64, v25, v4
    v_fmac_f32 v65, v25, v5
    v_lshlrev_b32 v4, 16, v120
    v_and_b32 v5, 0xffff0000, v120
    v_fmac_f32 v66, v25, v4
    v_fmac_f32 v67, v25, v5
    v_lshlrev_b32 v4, 16, v121
    v_and_b32 v5, 0xffff0000, v121
    v_fmac_f32 v68, v25, v4
    v_fmac_f32 v69, v25, v5
    v_lshlrev_b32 v4, 16, v122
    v_and_b32 v5, 0xffff0000, v122
    v_fmac_f32 v70, v25, v4
    v_fmac_f32 v71, v25, v5
    v_lshlrev_b32 v4, 16, v123
    v_and_b32 v5, 0xffff0000, v123
    v_fmac_f32 v72, v25, v4
    v_fmac_f32 v73, v25, v5
    v_lshlrev_b32 v4, 16, v124
    v_and_b32 v5, 0xffff0000, v124
    v_fmac_f32 v74, v25, v4
    v_fmac_f32 v75, v25, v5
    v_lshlrev_b32 v4, 16, v125
    v_and_b32 v5, 0xffff0000, v125
    v_fmac_f32 v76, v25, v4
    v_fmac_f32 v77, v25, v5
    s_add_u32 s48, s41, 21504
    buffer_load_dwordx4 v[114:117], v1, s[20:23], s48 offen offset:0 nt
    buffer_load_dwordx4 v[118:121], v1, s[20:23], s48 offen offset:128 nt
    buffer_load_dwordx4 v[122:125], v1, s[20:23], s48 offen offset:256 nt
    s_waitcnt vmcnt(9)
    v_lshlrev_b32 v4, 16, v78
    v_and_b32 v5, 0xffff0000, v78
    v_fmac_f32 v54, v26, v4
    v_fmac_f32 v55, v26, v5
    v_lshlrev_b32 v4, 16, v79
    v_and_b32 v5, 0xffff0000, v79
    v_fmac_f32 v56, v26, v4
    v_fmac_f32 v57, v26, v5
    v_lshlrev_b32 v4, 16, v80
    v_and_b32 v5, 0xffff0000, v80
    v_fmac_f32 v58, v26, v4
    v_fmac_f32 v59, v26, v5
    v_lshlrev_b32 v4, 16, v81
    v_and_b32 v5, 0xffff0000, v81
    v_fmac_f32 v60, v26, v4
    v_fmac_f32 v61, v26, v5
    v_lshlrev_b32 v4, 16, v82
    v_and_b32 v5, 0xffff0000, v82
    v_fmac_f32 v62, v26, v4
    v_fmac_f32 v63, v26, v5
    v_lshlrev_b32 v4, 16, v83
    v_and_b32 v5, 0xffff0000, v83
    v_fmac_f32 v64, v26, v4
    v_fmac_f32 v65, v26, v5
    v_lshlrev_b32 v4, 16, v84
    v_and_b32 v5, 0xffff0000, v84
    v_fmac_f32 v66, v26, v4
    v_fmac_f32 v67, v26, v5
    v_lshlrev_b32 v4, 16, v85
    v_and_b32 v5, 0xffff0000, v85
    v_fmac_f32 v68, v26, v4
    v_fmac_f32 v69, v26, v5
    v_lshlrev_b32 v4, 16, v86
    v_and_b32 v5, 0xffff0000, v86
    v_fmac_f32 v70, v26, v4
    v_fmac_f32 v71, v26, v5
    v_lshlrev_b32 v4, 16, v87
    v_and_b32 v5, 0xffff0000, v87
    v_fmac_f32 v72, v26, v4
    v_fmac_f32 v73, v26, v5
    v_lshlrev_b32 v4, 16, v88
    v_and_b32 v5, 0xffff0000, v88
    v_fmac_f32 v74, v26, v4
    v_fmac_f32 v75, v26, v5
    v_lshlrev_b32 v4, 16, v89
    v_and_b32 v5, 0xffff0000, v89
    v_fmac_f32 v76, v26, v4
    v_fmac_f32 v77, v26, v5
    s_add_u32 s48, s47, 0
    buffer_load_dwordx4 v[78:81], v1, s[16:19], s48 offen offset:0 nt
    buffer_load_dwordx4 v[82:85], v1, s[16:19], s48 offen offset:128 nt
    buffer_load_dwordx4 v[86:89], v1, s[16:19], s48 offen offset:256 nt
    s_waitcnt vmcnt(9)
    v_lshlrev_b32 v4, 16, v90
    v_and_b32 v5, 0xffff0000, v90
    v_fmac_f32 v54, v27, v4
    v_fmac_f32 v55, v27, v5
    v_lshlrev_b32 v4, 16, v91
    v_and_b32 v5, 0xffff0000, v91
    v_fmac_f32 v56, v27, v4
    v_fmac_f32 v57, v27, v5
    v_lshlrev_b32 v4, 16, v92
    v_and_b32 v5, 0xffff0000, v92
    v_fmac_f32 v58, v27, v4
    v_fmac_f32 v59, v27, v5
    v_lshlrev_b32 v4, 16, v93
    v_and_b32 v5, 0xffff0000, v93
    v_fmac_f32 v60, v27, v4
    v_fmac_f32 v61, v27, v5
    v_lshlrev_b32 v4, 16, v94
    v_and_b32 v5, 0xffff0000, v94
    v_fmac_f32 v62, v27, v4
    v_fmac_f32 v63, v27, v5
    v_lshlrev_b32 v4, 16, v95
    v_and_b32 v5, 0xffff0000, v95
    v_fmac_f32 v64, v27, v4
    v_fmac_f32 v65, v27, v5
    v_lshlrev_b32 v4, 16, v96
    v_and_b32 v5, 0xffff0000, v96
    v_fmac_f32 v66, v27, v4
    v_fmac_f32 v67, v27, v5
    v_lshlrev_b32 v4, 16, v97
    v_and_b32 v5, 0xffff0000, v97
    v_fmac_f32 v68, v27, v4
    v_fmac_f32 v69, v27, v5
    v_lshlrev_b32 v4, 16, v98
    v_and_b32 v5, 0xffff0000, v98
    v_fmac_f32 v70, v27, v4
    v_fmac_f32 v71, v27, v5
    v_lshlrev_b32 v4, 16, v99
    v_and_b32 v5, 0xffff0000, v99
    v_fmac_f32 v72, v27, v4
    v_fmac_f32 v73, v27, v5
    v_lshlrev_b32 v4, 16, v100
    v_and_b32 v5, 0xffff0000, v100
    v_fmac_f32 v74, v27, v4
    v_fmac_f32 v75, v27, v5
    v_lshlrev_b32 v4, 16, v101
    v_and_b32 v5, 0xffff0000, v101
    v_fmac_f32 v76, v27, v4
    v_fmac_f32 v77, v27, v5
    s_add_u32 s48, s47, 3072
    buffer_load_dwordx4 v[90:93], v1, s[16:19], s48 offen offset:0 nt
    buffer_load_dwordx4 v[94:97], v1, s[16:19], s48 offen offset:128 nt
    buffer_load_dwordx4 v[98:101], v1, s[16:19], s48 offen offset:256 nt
    s_waitcnt vmcnt(9)
    v_lshlrev_b32 v4, 16, v102
    v_and_b32 v5, 0xffff0000, v102
    v_fmac_f32 v54, v28, v4
    v_fmac_f32 v55, v28, v5
    v_lshlrev_b32 v4, 16, v103
    v_and_b32 v5, 0xffff0000, v103
    v_fmac_f32 v56, v28, v4
    v_fmac_f32 v57, v28, v5
    v_lshlrev_b32 v4, 16, v104
    v_and_b32 v5, 0xffff0000, v104
    v_fmac_f32 v58, v28, v4
    v_fmac_f32 v59, v28, v5
    v_lshlrev_b32 v4, 16, v105
    v_and_b32 v5, 0xffff0000, v105
    v_fmac_f32 v60, v28, v4
    v_fmac_f32 v61, v28, v5
    v_lshlrev_b32 v4, 16, v106
    v_and_b32 v5, 0xffff0000, v106
    v_fmac_f32 v62, v28, v4
    v_fmac_f32 v63, v28, v5
    v_lshlrev_b32 v4, 16, v107
    v_and_b32 v5, 0xffff0000, v107
    v_fmac_f32 v64, v28, v4
    v_fmac_f32 v65, v28, v5
    v_lshlrev_b32 v4, 16, v108
    v_and_b32 v5, 0xffff0000, v108
    v_fmac_f32 v66, v28, v4
    v_fmac_f32 v67, v28, v5
    v_lshlrev_b32 v4, 16, v109
    v_and_b32 v5, 0xffff0000, v109
    v_fmac_f32 v68, v28, v4
    v_fmac_f32 v69, v28, v5
    v_lshlrev_b32 v4, 16, v110
    v_and_b32 v5, 0xffff0000, v110
    v_fmac_f32 v70, v28, v4
    v_fmac_f32 v71, v28, v5
    v_lshlrev_b32 v4, 16, v111
    v_and_b32 v5, 0xffff0000, v111
    v_fmac_f32 v72, v28, v4
    v_fmac_f32 v73, v28, v5
    v_lshlrev_b32 v4, 16, v112
    v_and_b32 v5, 0xffff0000, v112
    v_fmac_f32 v74, v28, v4
    v_fmac_f32 v75, v28, v5
    v_lshlrev_b32 v4, 16, v113
    v_and_b32 v5, 0xffff0000, v113
    v_fmac_f32 v76, v28, v4
    v_fmac_f32 v77, v28, v5
    s_add_u32 s48, s47, 6144
    buffer_load_dwordx4 v[102:105], v1, s[16:19], s48 offen offset:0 nt
    buffer_load_dwordx4 v[106:109], v1, s[16:19], s48 offen offset:128 nt
    buffer_load_dwordx4 v[110:113], v1, s[16:19], s48 offen offset:256 nt
    s_waitcnt vmcnt(9)
    v_lshlrev_b32 v4, 16, v114
    v_and_b32 v5, 0xffff0000, v114
    v_fmac_f32 v54, v29, v4
    v_fmac_f32 v55, v29, v5
    v_lshlrev_b32 v4, 16, v115
    v_and_b32 v5, 0xffff0000, v115
    v_fmac_f32 v56, v29, v4
    v_fmac_f32 v57, v29, v5
    v_lshlrev_b32 v4, 16, v116
    v_and_b32 v5, 0xffff0000, v116
    v_fmac_f32 v58, v29, v4
    v_fmac_f32 v59, v29, v5
    v_lshlrev_b32 v4, 16, v117
    v_and_b32 v5, 0xffff0000, v117
    v_fmac_f32 v60, v29, v4
    v_fmac_f32 v61, v29, v5
    v_lshlrev_b32 v4, 16, v118
    v_and_b32 v5, 0xffff0000, v118
    v_fmac_f32 v62, v29, v4
    v_fmac_f32 v63, v29, v5
    v_lshlrev_b32 v4, 16, v119
    v_and_b32 v5, 0xffff0000, v119
    v_fmac_f32 v64, v29, v4
    v_fmac_f32 v65, v29, v5
    v_lshlrev_b32 v4, 16, v120
    v_and_b32 v5, 0xffff0000, v120
    v_fmac_f32 v66, v29, v4
    v_fmac_f32 v67, v29, v5
    v_lshlrev_b32 v4, 16, v121
    v_and_b32 v5, 0xffff0000, v121
    v_fmac_f32 v68, v29, v4
    v_fmac_f32 v69, v29, v5
    v_lshlrev_b32 v4, 16, v122
    v_and_b32 v5, 0xffff0000, v122
    v_fmac_f32 v70, v29, v4
    v_fmac_f32 v71, v29, v5
    v_lshlrev_b32 v4, 16, v123
    v_and_b32 v5, 0xffff0000, v123
    v_fmac_f32 v72, v29, v4
    v_fmac_f32 v73, v29, v5
    v_lshlrev_b32 v4, 16, v124
    v_and_b32 v5, 0xffff0000, v124
    v_fmac_f32 v74, v29, v4
    v_fmac_f32 v75, v29, v5
    v_lshlrev_b32 v4, 16, v125
    v_and_b32 v5, 0xffff0000, v125
    v_fmac_f32 v76, v29, v4
    v_fmac_f32 v77, v29, v5
    s_add_u32 s48, s47, 9216
    buffer_load_dwordx4 v[114:117], v1, s[16:19], s48 offen offset:0 nt
    buffer_load_dwordx4 v[118:121], v1, s[16:19], s48 offen offset:128 nt
    buffer_load_dwordx4 v[122:125], v1, s[16:19], s48 offen offset:256 nt
    s_mov_b32 s41, s47
    s_cmp_lt_u32 s41, 1572864
    s_cbranch_scc1 L_loop
    s_waitcnt vmcnt(0)
    s_cmp_eq_u32 s98, 3
    s_cbranch_scc1 L_dma_end
    s_cmp_eq_u32 s98, 2
    s_cbranch_scc1 L_dma_e
    v_lshrrev_b32 v126, 3, v6
    v_and_b32 v127, 7, v6
    v_lshlrev_b32 v127, 4, v127
    s_cmp_eq_u32 s98, 1
    s_cbranch_scc1 L_dma_d
    v_mul_u32_u24 v126, 1280, v126
    v_add_u32 v126, v126, v127
    s_mul_i32 s48, s54, 768
    s_mul_i32 s49, s53, 48
    s_add_u32 s48, s48, s49
    s_mul_i32 s48, s48, 1280
    s_lshl_b32 s50, s55, 7
    s_add_u32 s48, s48, s50
    s_lshl_b32 s50, s49, 7
    s_add_u32 s50, s50, 42496
    s_mov_b32 m0, s50
    s_nop 0
    buffer_load_dwordx4 v126, s[60:63], s48 offen nt lds
    s_add_u32 s48, s48, 10240
    s_add_u32 s50, s50, 1024
    s_mov_b32 m0, s50
    s_nop 0
    buffer_load_dwordx4 v126, s[60:63], s48 offen nt lds
    s_add_u32 s48, s48, 10240
    s_add_u32 s50, s50, 1024
    s_mov_b32 m0, s50
    s_nop 0
    buffer_load_dwordx4 v126, s[60:63], s48 offen nt lds
    s_add_u32 s48, s48, 10240
    s_add_u32 s50, s50, 1024
    s_mov_b32 m0, s50
    s_nop 0
    buffer_load_dwordx4 v126, s[60:63], s48 offen nt lds
    s_add_u32 s48, s48, 10240
    s_add_u32 s50, s50, 1024
    s_mov_b32 m0, s50
    s_nop 0
    buffer_load_dwordx4 v126, s[60:63], s48 offen nt lds
    s_add_u32 s48, s48, 10240
    s_add_u32 s50, s50, 1024
    s_mov_b32 m0, s50
    s_nop 0
    buffer_load_dwordx4 v126, s[60:63], s48 offen nt lds
    s_branch L_dma_end
L_dma_d:
    v_mul_u32_u24 v126, 3072, v126
    v_add_u32 v126, v126, v127
    s_mul_i32 s49, s53, 40
    s_mul_i32 s48, s49, 3072
    s_lshl_b32 s50, s55, 7
    s_add_u32 s48, s48, s50
    s_lshl_b32 s50, s49, 7
    s_add_u32 s50, s50, 42496
    s_mov_b32 m0, s50
    s_nop 0
    buffer_load_dwordx4 v126, s[64:67], s48 offen nt lds
    s_add_u32 s48, s48, 24576
    s_add_u32 s50, s50, 1024
    s_mov_b32 m0, s50
    s_nop 0
    buffer_load_dwordx4 v126, s[64:67], s48 offen nt lds
    s_add_u32 s48, s48, 24576
    s_add_u32 s50, s50, 1024
    s_mov_b32 m0, s50
    s_nop 0
    buffer_load_dwordx4 v126, s[64:67], s48 offen nt lds
    s_add_u32 s48, s48, 24576
    s_add_u32 s50, s50, 1024
    s_mov_b32 m0, s50
    s_nop 0
    buffer_load_dwordx4 v126, s[64:67], s48 offen nt lds
    s_add_u32 s48, s48, 24576
    s_add_u32 s50, s50, 1024
    s_mov_b32 m0, s50
    s_nop 0
    buffer_load_dwordx4 v126, s[64:67], s48 offen nt lds
    s_branch L_dma_end
L_dma_e:
    v_lshrrev_b32 v126, 2, v6
    v_and_b32 v127, 3, v6
    v_lshlrev_b32 v127, 4, v127
    v_mul_u32_u24 v126, 1280, v126
    v_add_u32 v126, v126, v127
    s_mul_i32 s49, s53, 96
    s_mul_i32 s48, s49, 1280
    s_lshl_b32 s50, s55, 6
    s_add_u32 s48, s48, s50
    s_lshl_b32 s50, s49, 6
    s_add_u32 s50, s50, 42496
    s_mov_b32 m0, s50
    s_nop 0
    buffer_load_dwordx4 v126, s[68:71], s48 offen nt lds
    s_add_u32 s48, s48, 20480
    s_add_u32 s50, s50, 1024
    s_mov_b32 m0, s50
    s_nop 0
    buffer_load_dwordx4 v126, s[68:71], s48 offen nt lds
    s_add_u32 s48, s48, 20480
    s_add_u32 s50, s50, 1024
    s_mov_b32 m0, s50
    s_nop 0
    buffer_load_dwordx4 v126, s[68:71], s48 offen nt lds
    s_add_u32 s48, s48, 20480
    s_add_u32 s50, s50, 1024
    s_mov_b32 m0, s50
    s_nop 0
    buffer_load_dwordx4 v126, s[68:71], s48 offen nt lds
    s_add_u32 s48, s48, 20480
    s_add_u32 s50, s50, 1024
    s_mov_b32 m0, s50
    s_nop 0
    buffer_load_dwordx4 v126, s[68:71], s48 offen nt lds
    s_add_u32 s48, s48, 20480
    s_add_u32 s50, s50, 1024
    s_mov_b32 m0, s50
    s_nop 0
    buffer_load_dwordx4 v126, s[68:71], s48 offen nt lds
L_dma_end:
    v_mov_b32 v2, v30
    v_mov_b32 v3, v31
    s_nop 1
    v_add_f32_dpp v3, v3, v3 quad_perm:[1,0,3,2] row_mask:0xf bank_mask:0xf
    s_nop 1
    v_add_f32_dpp v3, v3, v3 quad_perm:[2,3,0,1] row_mask:0xf bank_mask:0xf
    s_nop 1
    v_add_f32_dpp v3, v3, v3 row_half_mirror row_mask:0xf bank_mask:0xf
    s_nop 1
    v_add_f32_dpp v3, v3, v3 row_mirror row_mask:0xf bank_mask:0xf
    s_nop 1
    v_readlane_b32 s48, v3, 0
    v_readlane_b32 s49, v3, 16
    v_readlane_b32 s50, v3, 32
    v_readlane_b32 s51, v3, 48
    s_nop 1
    v_mov_b32 v3, s48
    v_add_f32 v3, s49, v3
    v_add_f32 v3, s50, v3
    v_add_f32 v3, s51, v3
    v_mul_f32 v3, 0.125, v3
    s_nop 1
    v_permlane32_swap_b32 v54, v58
    v_permlane32_swap_b32 v55, v59
    v_permlane32_swap_b32 v56, v60
    v_permlane32_swap_b32 v57, v61
    v_permlane32_swap_b32 v62, v66
    v_permlane32_swap_b32 v63, v67
    v_permlane32_swap_b32 v64, v68
    v_permlane32_swap_b32 v65, v69
    v_permlane32_swap_b32 v70, v74
    v_permlane32_swap_b32 v71, v75
    v_permlane32_swap_b32 v72, v76
    v_permlane32_swap_b32 v73, v77
    v_add_f32 v54, v54, v58
    v_add_f32 v55, v55, v59
    v_add_f32 v56, v56, v60
    v_add_f32 v57, v57, v61
    v_add_f32 v62, v62, v66
    v_add_f32 v63, v63, v67
    v_add_f32 v64, v64, v68
    v_add_f32 v65, v65, v69
    v_add_f32 v70, v70, v74
    v_add_f32 v71, v71, v75
    v_add_f32 v72, v72, v76
    v_add_f32 v73, v73, v77
    s_nop 1
    v_permlane16_swap_b32 v54, v56
    v_permlane16_swap_b32 v55, v57
    v_permlane16_swap_b32 v62, v64
    v_permlane16_swap_b32 v63, v65
    v_permlane16_swap_b32 v70, v72
    v_permlane16_swap_b32 v71, v73
    v_add_f32 v54, v54, v56
    v_add_f32 v55, v55, v57
    v_add_f32 v62, v62, v64
    v_add_f32 v63, v63, v65
    v_add_f32 v70, v70, v72
    v_add_f32 v71, v71, v73
    s_nop 1
    v_add_f32_dpp v54, v54, v54 row_ror:8 row_mask:0xf bank_mask:0xf
    v_add_f32_dpp v55, v55, v55 row_ror:8 row_mask:0xf bank_mask:0xf
    v_add_f32_dpp v62, v62, v62 row_ror:8 row_mask:0xf bank_mask:0xf
    v_add_f32_dpp v63, v63, v63 row_ror:8 row_mask:0xf bank_mask:0xf
    v_add_f32_dpp v70, v70, v70 row_ror:8 row_mask:0xf bank_mask:0xf
    v_add_f32_dpp v71, v71, v71 row_ror:8 row_mask:0xf bank_mask:0xf
    ds_write_b64 v9, v[54:55] offset:0
    ds_write_b64 v9, v[62:63] offset:256
    ds_write_b64 v9, v[70:71] offset:512
    v_lshrrev_b32 v4, 6, v0
    v_lshlrev_b32 v4, 3, v4
    ds_write_b64 v4, v[2:3] offset:12800
    s_waitcnt lgkmcnt(0)
    s_barrier
    v_cmp_gt_u32 vcc, 192, v0
    s_and_saveexec_b64 s[100:101], vcc
    s_cbranch_execz L_e1
    v_lshlrev_b32 v2, 2, v0
    v_mov_b32 v4, 0
    ds_read_b32 v54, v2 offset:0
    ds_read_b32 v55, v2 offset:768
    ds_read_b32 v56, v2 offset:1536
    ds_read_b32 v57, v2 offset:2304
    ds_read_b32 v58, v2 offset:3072
    ds_read_b32 v59, v2 offset:3840
    ds_read_b32 v60, v2 offset:4608
    ds_read_b32 v61, v2 offset:5376
    ds_read_b32 v62, v2 offset:6144
    ds_read_b32 v63, v2 offset:6912
    ds_read_b32 v64, v2 offset:7680
    ds_read_b32 v65, v2 offset:8448
    ds_read_b32 v66, v2 offset:9216
    ds_read_b32 v67, v2 offset:9984
    ds_read_b32 v68, v2 offset:10752
    ds_read_b32 v69, v2 offset:11520
    ds_read_b128 v[22:25], v4 offset:12800
    ds_read_b128 v[26:29], v4 offset:12816
    ds_read_b128 v[30:33], v4 offset:12832
    ds_read_b128 v[34:37], v4 offset:12848
    ds_read_b128 v[38:41], v4 offset:12864
    ds_read_b128 v[42:45], v4 offset:12880
    ds_read_b128 v[46:49], v4 offset:12896
    ds_read_b128 v[50:53], v4 offset:12912
    s_waitcnt lgkmcnt(0)
    v_max_f32 v3, v22, v24
    v_max_f32 v3, v3, v26
    v_max_f32 v3, v3, v28
    v_max_f32 v3, v3, v30
    v_max_f32 v3, v3, v32
    v_max_f32 v3, v3, v34
    v_max_f32 v3, v3, v36
    v_max_f32 v3, v3, v38
    v_max_f32 v3, v3, v40
    v_max_f32 v3, v3, v42
    v_max_f32 v3, v3, v44
    v_max_f32 v3, v3, v46
    v_max_f32 v3, v3, v48
    v_max_f32 v3, v3, v50
    v_max_f32 v3, v3, v52
    v_sub_f32 v22, v22, v3
    v_mul_f32 v22, 0x3fb8aa3b, v22
    v_exp_f32 v22, v22
    v_sub_f32 v24, v24, v3
    v_mul_f32 v24, 0x3fb8aa3b, v24
    v_exp_f32 v24, v24
    v_sub_f32 v26, v26, v3
    v_mul_f32 v26, 0x3fb8aa3b, v26
    v_exp_f32 v26, v26
    v_sub_f32 v28, v28, v3
    v_mul_f32 v28, 0x3fb8aa3b, v28
    v_exp_f32 v28, v28
    v_sub_f32 v30, v30, v3
    v_mul_f32 v30, 0x3fb8aa3b, v30
    v_exp_f32 v30, v30
    v_sub_f32 v32, v32, v3
    v_mul_f32 v32, 0x3fb8aa3b, v32
    v_exp_f32 v32, v32
    v_sub_f32 v34, v34, v3
    v_mul_f32 v34, 0x3fb8aa3b, v34
    v_exp_f32 v34, v34
    v_sub_f32 v36, v36, v3
    v_mul_f32 v36, 0x3fb8aa3b, v36
    v_exp_f32 v36, v36
    v_sub_f32 v38, v38, v3
    v_mul_f32 v38, 0x3fb8aa3b, v38
    v_exp_f32 v38, v38
    v_sub_f32 v40, v40, v3
    v_mul_f32 v40, 0x3fb8aa3b, v40
    v_exp_f32 v40, v40
    v_sub_f32 v42, v42, v3
    v_mul_f32 v42, 0x3fb8aa3b, v42
    v_exp_f32 v42, v42
    v_sub_f32 v44, v44, v3
    v_mul_f32 v44, 0x3fb8aa3b, v44
    v_exp_f32 v44, v44
    v_sub_f32 v46, v46, v3
    v_mul_f32 v46, 0x3fb8aa3b, v46
    v_exp_f32 v46, v46
    v_sub_f32 v48, v48, v3
    v_mul_f32 v48, 0x3fb8aa3b, v48
    v_exp_f32 v48, v48
    v_sub_f32 v50, v50, v3
    v_mul_f32 v50, 0x3fb8aa3b, v50
    v_exp_f32 v50, v50
    v_sub_f32 v52, v52, v3
    v_mul_f32 v52, 0x3fb8aa3b, v52
    v_exp_f32 v52, v52
    s_nop 0
    v_mul_f32 v4, v22, v54
    v_mul_f32 v5, v22, v23
    v_fmac_f32 v4, v24, v55
    v_fmac_f32 v5, v24, v25
    v_fmac_f32 v4, v26, v56
    v_fmac_f32 v5, v26, v27
    v_fmac_f32 v4, v28, v57
    v_fmac_f32 v5, v28, v29
    v_fmac_f32 v4, v30, v58
    v_fmac_f32 v5, v30, v31
    v_fmac_f32 v4, v32, v59
    v_fmac_f32 v5, v32, v33
    v_fmac_f32 v4, v34, v60
    v_fmac_f32 v5, v34, v35
    v_fmac_f32 v4, v36, v61
    v_fmac_f32 v5, v36, v37
    v_fmac_f32 v4, v38, v62
    v_fmac_f32 v5, v38, v39
    v_fmac_f32 v4, v40, v63
    v_fmac_f32 v5, v40, v41
    v_fmac_f32 v4, v42, v64
    v_fmac_f32 v5, v42, v43
    v_fmac_f32 v4, v44, v65
    v_fmac_f32 v5, v44, v45
    v_fmac_f32 v4, v46, v66
    v_fmac_f32 v5, v46, v47
    v_fmac_f32 v4, v48, v67
    v_fmac_f32 v5, v48, v49
    v_fmac_f32 v4, v50, v68
    v_fmac_f32 v5, v50, v51
    v_fmac_f32 v4, v52, v69
    v_fmac_f32 v5, v52, v53
    s_mul_i32 s48, s40, 800
    buffer_store_dword v4, v2, s[32:35], s48 offen offset:0 sc0 sc1
    v_mov_b32 v2, v3
    v_mov_b32 v3, v5
    v_cmp_eq_u32 vcc, 0, v0
    s_and_b64 exec, exec, vcc
    s_cbranch_execz L_e1
    v_mov_b32 v4, 768
    buffer_store_dwordx2 v[2:3], v4, s[32:35], s48 offen offset:0 sc0 sc1
    v_mov_b32 v4, 0
    v_mov_b32 v5, 1
    buffer_atomic_add v5, v4, s[36:39], 0 offen sc0 sc1
    s_waitcnt vmcnt(0)
    v_readfirstlane_b32 s48, v5
    s_mov_b64 exec, s[100:101]
    s_cmp_lg_u32 s48, 255
    s_cbranch_scc1 L_e1
    s_mov_b64 exec, -1
    v_lshlrev_b32 v4, 7, v6
    v_mov_b32 v5, 1
    s_mov_b32 s48, 458752
    buffer_store_dword v5, v4, s[32:35], s48 offen sc0 sc1
    s_mov_b32 s48, 466944
    buffer_store_dword v5, v4, s[32:35], s48 offen sc0 sc1
    s_mov_b32 s48, 475136
    buffer_store_dword v5, v4, s[32:35], s48 offen sc0 sc1
    s_mov_b32 s48, 483328
    buffer_store_dword v5, v4, s[32:35], s48 offen sc0 sc1
L_e1:
    s_mov_b64 exec, s[100:101]
    s_cmp_eq_u32 s98, 3
    s_cbranch_scc0 L_tail_go
    s_endpgm
L_tail_go:
    v_lshrrev_b32 v7, 6, v0
    s_cmp_lg_u32 s53, 0
    s_cbranch_scc1 L_gate_done
    s_lshl_b32 s44, s2, 7
    s_add_u32 s44, s44, 458752
    v_mov_b32 v12, 0
    s_mov_b32 s45, 0
L_gate_1:
    buffer_load_dword v13, v12, s[32:35], s44 offen sc0 sc1
    s_waitcnt vmcnt(0)
    v_cmp_ne_u32 vcc, 1, v13
    s_add_u32 s45, s45, 1
    s_cbranch_vccz L_gate_1_ok
    s_cmp_ge_u32 s45, 0x40000
    s_cbranch_scc1 L_gate_1_ok
    s_sleep 6
    s_branch L_gate_1
L_gate_1_ok:
L_gate_done:
    s_cmp_eq_u32 s98, 1
    s_cbranch_scc1 L_tail_d
    s_cmp_eq_u32 s98, 2
    s_cbranch_scc1 L_tail_e
    v_mov_b32 v12, v0
    v_mul_u32_u24 v13, 43691, v12
    v_lshrrev_b32 v13, 24, v13
    v_mul_u32_u24 v14, 384, v13
    v_sub_u32 v12, v12, v14
    v_mul_u32_u24 v14, 43691, v12
    v_lshrrev_b32 v14, 22, v14
    v_mul_u32_u24 v40, 51200, v13
    v_mul_u32_u24 v15, 832, v14
    v_add_u32 v40, v40, v15
    v_lshl_add_u32 v40, v12, 3, v40
    v_lshlrev_b32 v43, 5, v14
    v_lshl_add_u32 v43, v13, 3, v43
    v_mul_u32_u24 v46, 3136, v13
    v_lshl_add_u32 v46, v12, 2, v46
    v_and_b32 v12, 511, v0
    v_add_u32 v12, 1024, v12
    v_mul_u32_u24 v13, 43691, v12
    v_lshrrev_b32 v13, 24, v13
    v_mul_u32_u24 v14, 384, v13
    v_sub_u32 v12, v12, v14
    v_mul_u32_u24 v14, 43691, v12
    v_lshrrev_b32 v14, 22, v14
    v_mul_u32_u24 v41, 51200, v13
    v_mul_u32_u24 v15, 832, v14
    v_add_u32 v41, v41, v15
    v_lshl_add_u32 v41, v12, 3, v41
    v_lshlrev_b32 v44, 5, v14
    v_lshl_add_u32 v44, v13, 3, v44
    v_mul_u32_u24 v47, 3136, v13
    v_lshl_add_u32 v47, v12, 2, v47
    v_and_b32 v12, 3, v6
    v_mul_u32_u24 v8, 3136, v12
    v_lshlrev_b32 v9, 3, v12
    v_lshrrev_b32 v12, 4, v6
    v_lshl_add_u32 v8, v12, 4, v8
    v_mul_u32_u24 v12, 1024, v12
    v_add_u32 v9, v9, v12
    v_bfe_u32 v12, v6, 2, 2
    v_mul_u32_u24 v12, 128, v12
    v_add_u32 v9, v9, v12
    s_mul_i32 s46, s54, 6400
    s_add_u32 s46, s46, 0
    s_barrier
    s_cmp_lg_u32 s53, 0
    s_cbranch_scc1 L_c_noml
    v_bfe_u32 v12, v6, 3, 2
    v_mul_u32_u24 v12, 51200, v12
    v_and_b32 v13, 7, v6
    v_mul_u32_u24 v13, 800, v13
    v_add_u32 v12, v12, v13
    s_mov_b32 s45, 0
L_poll_2:
    buffer_load_dwordx2 v[28:29], v12, s[32:35], s46 offen offset:768 sc0 sc1
    buffer_load_dwordx2 v[16:17], v40, s[32:35], s46 offen offset:0 sc0 sc1
    buffer_load_dwordx2 v[18:19], v40, s[32:35], s46 offen offset:800 sc0 sc1
    buffer_load_dwordx2 v[20:21], v41, s[32:35], s46 offen offset:0 sc0 sc1
    buffer_load_dwordx2 v[22:23], v41, s[32:35], s46 offen offset:800 sc0 sc1
    s_waitcnt vmcnt(0)
    v_max_u32 v14, v16, v17
    v_max3_u32 v14, v14, v18, v19
    v_max3_u32 v14, v14, v20, v21
    v_max3_u32 v14, v14, v22, v23
    v_max3_u32 v14, v14, v28, v29
    v_cmp_eq_u32 vcc, -1, v14
    s_add_u32 s45, s45, 1
    s_cbranch_vccz L_poll_2_ok
    s_cmp_ge_u32 s45, 0x40000
    s_cbranch_scc1 L_poll_2_ok
    s_sleep 2
    s_branch L_poll_2
L_poll_2_ok:
    s_nop 0
    v_mov_b32_dpp v30, v28 quad_perm:[1,0,3,2] row_mask:0xf bank_mask:0xf
    v_mov_b32_dpp v31, v29 quad_perm:[1,0,3,2] row_mask:0xf bank_mask:0xf
    v_max_f32 v32, v28, v30
    v_sub_f32 v28, v28, v32
    v_sub_f32 v30, v30, v32
    v_mul_f32 v28, 0x3fb8aa3b, v28
    v_mul_f32 v30, 0x3fb8aa3b, v30
    v_exp_f32 v28, v28
    v_exp_f32 v30, v30
    s_nop 0
    v_mul_f32 v32, v28, v29
    v_fmac_f32 v32, v30, v31
    v_rcp_f32 v32, v32
    s_nop 0
    v_mul_f32 v28, v28, v32
    v_bfe_u32 v12, v6, 1, 2
    v_lshlrev_b32 v12, 5, v12
    v_bfe_u32 v13, v6, 3, 2
    v_lshl_add_u32 v12, v13, 3, v12
    v_and_b32 v13, 1, v6
    v_lshl_add_u32 v12, v13, 2, v12
    ds_write_b32 v12, v28 offset:13312
    s_waitcnt lgkmcnt(0)
    s_branch L_c_f
L_c_noml:
    s_mov_b32 s45, 0
L_poll_3:
    buffer_load_dwordx2 v[16:17], v40, s[32:35], s46 offen offset:0 sc0 sc1
    buffer_load_dwordx2 v[18:19], v40, s[32:35], s46 offen offset:800 sc0 sc1
    buffer_load_dwordx2 v[20:21], v41, s[32:35], s46 offen offset:0 sc0 sc1
    buffer_load_dwordx2 v[22:23], v41, s[32:35], s46 offen offset:800 sc0 sc1
    s_waitcnt vmcnt(0)
    v_max_u32 v14, v16, v17
    v_max3_u32 v14, v14, v18, v19
    v_max3_u32 v14, v14, v20, v21
    v_max3_u32 v14, v14, v22, v23
    v_cmp_eq_u32 vcc, -1, v14
    s_add_u32 s45, s45, 1
    s_cbranch_vccz L_poll_3_ok
    s_cmp_ge_u32 s45, 0x40000
    s_cbranch_scc1 L_poll_3_ok
    s_sleep 2
    s_branch L_poll_3
L_poll_3_ok:
L_c_f:
    s_barrier
    ds_read_b64 v[30:31], v43 offset:13312
    ds_read_b64 v[32:33], v44 offset:13312
    s_waitcnt lgkmcnt(0)
    v_mul_f32 v12, v30, v16
    v_mul_f32 v13, v30, v17
    v_fmac_f32 v12, v31, v18
    v_fmac_f32 v13, v31, v19
    v_cvt_pk_bf16_f32 v12, v12, v13
    ds_write_b32 v46, v12 offset:29952
    v_mul_f32 v12, v32, v20
    v_mul_f32 v13, v32, v21
    v_fmac_f32 v12, v33, v22
    v_fmac_f32 v13, v33, v23
    v_cvt_pk_bf16_f32 v12, v12, v13
    ds_write_b32 v47, v12 offset:29952
    s_waitcnt lgkmcnt(0)
    s_barrier
    s_lshr_b32 s48, s53, 2
    s_and_b32 s49, s53, 3
    s_mul_i32 s50, s48, 384
    s_add_u32 s50, s50, 29952
    v_add_u32 v12, s50, v8
    s_mul_i32 s50, s48, 24576
    s_lshl_b32 s49, s49, 5
    s_add_u32 s50, s50, s49
    s_add_u32 s50, s50, 42496
    v_add_u32 v13, s50, v9
    s_waitcnt vmcnt(0)
    ds_read_b128 v[16:19], v12 offset:0
    ds_read_b64_tr_b16 v[40:41], v13 offset:0
    ds_read_b64_tr_b16 v[42:43], v13 offset:512
    ds_read_b128 v[20:23], v12 offset:64
    ds_read_b64_tr_b16 v[44:45], v13 offset:4096
    ds_read_b64_tr_b16 v[46:47], v13 offset:4608
    ds_read_b128 v[24:27], v12 offset:128
    ds_read_b64_tr_b16 v[48:49], v13 offset:8192
    ds_read_b64_tr_b16 v[50:51], v13 offset:8704
    ds_read_b128 v[28:31], v12 offset:192
    ds_read_b64_tr_b16 v[52:53], v13 offset:12288
    ds_read_b64_tr_b16 v[54:55], v13 offset:12800
    ds_read_b128 v[32:35], v12 offset:256
    ds_read_b64_tr_b16 v[56:57], v13 offset:16384
    ds_read_b64_tr_b16 v[58:59], v13 offset:16896
    ds_read_b128 v[36:39], v12 offset:320
    ds_read_b64_tr_b16 v[60:61], v13 offset:20480
    ds_read_b64_tr_b16 v[62:63], v13 offset:20992
    s_waitcnt lgkmcnt(15)
    v_mfma_f32_16x16x32_bf16 v[64:67], v[16:19], v[40:43], 0
    s_waitcnt lgkmcnt(12)
    v_mfma_f32_16x16x32_bf16 v[64:67], v[20:23], v[44:47], v[64:67]
    s_waitcnt lgkmcnt(9)
    v_mfma_f32_16x16x32_bf16 v[64:67], v[24:27], v[48:51], v[64:67]
    s_waitcnt lgkmcnt(6)
    v_mfma_f32_16x16x32_bf16 v[64:67], v[28:31], v[52:55], v[64:67]
    s_waitcnt lgkmcnt(3)
    v_mfma_f32_16x16x32_bf16 v[64:67], v[32:35], v[56:59], v[64:67]
    s_waitcnt lgkmcnt(0)
    v_mfma_f32_16x16x32_bf16 v[64:67], v[36:39], v[60:63], v[64:67]
    s_nop 15
    s_lshr_b32 s48, s53, 2
    s_and_b32 s49, s53, 3
    s_mul_i32 s48, s48, 1024
    s_lshl_b32 s49, s49, 6
    s_add_u32 s48, s48, s49
    v_lshlrev_b32 v12, 2, v6
    v_add_u32 v12, s48, v12
    s_mov_b64 exec, 0xffff
    ds_write_b32 v12, v64 offset:13824
    ds_write_b32 v12, v65 offset:14080
    ds_write_b32 v12, v66 offset:14336
    ds_write_b32 v12, v67 offset:14592
    s_mov_b64 exec, -1
    s_waitcnt lgkmcnt(0)
    s_barrier
    s_cmp_ge_u32 s53, 4
    s_cbranch_scc1 L_c_pub_done
    v_lshlrev_b32 v12, 2, v0
    ds_read_b32 v16, v12 offset:13824
    ds_read_b32 v17, v12 offset:14848
    ds_read_b32 v18, v12 offset:15872
    ds_read_b32 v19, v12 offset:16896
    s_waitcnt lgkmcnt(0)
    v_add_f32 v16, v16, v17
    v_add_f32 v18, v18, v19
    v_add_f32 v16, v16, v18
    v_mul_u32_u24 v12, 2560, v7
    v_lshl_add_u32 v12, v6, 2, v12
    s_mul_i32 s48, s54, 10240
    s_lshl_b32 s49, s55, 8
    s_add_u32 s48, s48, s49
    s_add_u32 s48, s48, 262144
    buffer_store_dword v16, v12, s[32:35], s48 offen sc0 sc1
L_c_pub_done:
    s_endpgm
L_tail_e:
    v_and_b32 v12, 3, v6
    v_mul_u32_u24 v8, 3136, v12
    v_lshlrev_b32 v9, 3, v12
    v_lshrrev_b32 v12, 4, v6
    v_lshl_add_u32 v8, v12, 4, v8
    v_mul_u32_u24 v12, 512, v12
    v_add_u32 v9, v9, v12
    v_bfe_u32 v12, v6, 2, 2
    v_mul_u32_u24 v12, 64, v12
    v_add_u32 v9, v9, v12
    s_barrier
    s_cmp_ge_u32 s53, 4
    s_cbranch_scc1 L_e_act
    v_lshlrev_b32 v12, 2, v6
    buffer_load_dword v121, v12, s[72:75], 0 offen offset:0
    buffer_load_dword v122, v12, s[72:75], 0 offen offset:256
    buffer_load_dword v123, v12, s[72:75], 0 offen offset:512
    buffer_load_dword v124, v12, s[72:75], 0 offen offset:768
    buffer_load_dword v125, v12, s[72:75], 0 offen offset:1024
    v_mul_u32_u24 v39, 640, v7
    v_lshlrev_b32 v36, 1, v6
    v_add_u32 v39, v39, v36
    v_lshlrev_b32 v37, 1, v39
    buffer_load_dword v26, v37, s[56:59], 0 offen offset:0
    buffer_load_dword v28, v37, s[56:59], 0 offen offset:256
    buffer_load_dword v30, v37, s[56:59], 0 offen offset:512
    buffer_load_dword v32, v37, s[56:59], 0 offen offset:768
    buffer_load_dword v34, v37, s[56:59], 0 offen offset:1024
    v_lshlrev_b32 v36, 2, v39
    s_mov_b32 s45, 0
L_poll_4:
    s_mov_b32 s44, 262144
    buffer_load_dwordx2 v[40:41], v36, s[32:35], s44 offen offset:0 sc0 sc1
    buffer_load_dwordx2 v[42:43], v36, s[32:35], s44 offen offset:512 sc0 sc1
    buffer_load_dwordx2 v[44:45], v36, s[32:35], s44 offen offset:1024 sc0 sc1
    buffer_load_dwordx2 v[46:47], v36, s[32:35], s44 offen offset:1536 sc0 sc1
    buffer_load_dwordx2 v[48:49], v36, s[32:35], s44 offen offset:2048 sc0 sc1
    s_mov_b32 s44, 272384
    buffer_load_dwordx2 v[50:51], v36, s[32:35], s44 offen offset:0 sc0 sc1
    buffer_load_dwordx2 v[52:53], v36, s[32:35], s44 offen offset:512 sc0 sc1
    buffer_load_dwordx2 v[54:55], v36, s[32:35], s44 offen offset:1024 sc0 sc1
    buffer_load_dwordx2 v[56:57], v36, s[32:35], s44 offen offset:1536 sc0 sc1
    buffer_load_dwordx2 v[58:59], v36, s[32:35], s44 offen offset:2048 sc0 sc1
    s_mov_b32 s44, 282624
    buffer_load_dwordx2 v[60:61], v36, s[32:35], s44 offen offset:0 sc0 sc1
    buffer_load_dwordx2 v[62:63], v36, s[32:35], s44 offen offset:512 sc0 sc1
    buffer_load_dwordx2 v[64:65], v36, s[32:35], s44 offen offset:1024 sc0 sc1
    buffer_load_dwordx2 v[66:67], v36, s[32:35], s44 offen offset:1536 sc0 sc1
    buffer_load_dwordx2 v[68:69], v36, s[32:35], s44 offen offset:2048 sc0 sc1
    s_mov_b32 s44, 292864
    buffer_load_dwordx2 v[70:71], v36, s[32:35], s44 offen offset:0 sc0 sc1
    buffer_load_dwordx2 v[72:73], v36, s[32:35], s44 offen offset:512 sc0 sc1
    buffer_load_dwordx2 v[74:75], v36, s[32:35], s44 offen offset:1024 sc0 sc1
    buffer_load_dwordx2 v[76:77], v36, s[32:35], s44 offen offset:1536 sc0 sc1
    buffer_load_dwordx2 v[78:79], v36, s[32:35], s44 offen offset:2048 sc0 sc1
    s_mov_b32 s44, 303104
    buffer_load_dwordx2 v[80:81], v36, s[32:35], s44 offen offset:0 sc0 sc1
    buffer_load_dwordx2 v[82:83], v36, s[32:35], s44 offen offset:512 sc0 sc1
    buffer_load_dwordx2 v[84:85], v36, s[32:35], s44 offen offset:1024 sc0 sc1
    buffer_load_dwordx2 v[86:87], v36, s[32:35], s44 offen offset:1536 sc0 sc1
    buffer_load_dwordx2 v[88:89], v36, s[32:35], s44 offen offset:2048 sc0 sc1
    s_mov_b32 s44, 313344
    buffer_load_dwordx2 v[90:91], v36, s[32:35], s44 offen offset:0 sc0 sc1
    buffer_load_dwordx2 v[92:93], v36, s[32:35], s44 offen offset:512 sc0 sc1
    buffer_load_dwordx2 v[94:95], v36, s[32:35], s44 offen offset:1024 sc0 sc1
    buffer_load_dwordx2 v[96:97], v36, s[32:35], s44 offen offset:1536 sc0 sc1
    buffer_load_dwordx2 v[98:99], v36, s[32:35], s44 offen offset:2048 sc0 sc1
    s_mov_b32 s44, 323584
    buffer_load_dwordx2 v[100:101], v36, s[32:35], s44 offen offset:0 sc0 sc1
    buffer_load_dwordx2 v[102:103], v36, s[32:35], s44 offen offset:512 sc0 sc1
    buffer_load_dwordx2 v[104:105], v36, s[32:35], s44 offen offset:1024 sc0 sc1
    buffer_load_dwordx2 v[106:107], v36, s[32:35], s44 offen offset:1536 sc0 sc1
    buffer_load_dwordx2 v[108:109], v36, s[32:35], s44 offen offset:2048 sc0 sc1
    s_mov_b32 s44, 333824
    buffer_load_dwordx2 v[110:111], v36, s[32:35], s44 offen offset:0 sc0 sc1
    buffer_load_dwordx2 v[112:113], v36, s[32:35], s44 offen offset:512 sc0 sc1
    buffer_load_dwordx2 v[114:115], v36, s[32:35], s44 offen offset:1024 sc0 sc1
    buffer_load_dwordx2 v[116:117], v36, s[32:35], s44 offen offset:1536 sc0 sc1
    buffer_load_dwordx2 v[118:119], v36, s[32:35], s44 offen offset:2048 sc0 sc1
    s_waitcnt vmcnt(0)
    v_max_u32 v38, v40, v41
    v_max3_u32 v38, v38, v42, v43
    v_max3_u32 v38, v38, v44, v45
    v_max3_u32 v38, v38, v46, v47
    v_max3_u32 v38, v38, v48, v49
    v_max3_u32 v38, v38, v50, v51
    v_max3_u32 v38, v38, v52, v53
    v_max3_u32 v38, v38, v54, v55
    v_max3_u32 v38, v38, v56, v57
    v_max3_u32 v38, v38, v58, v59
    v_max3_u32 v38, v38, v60, v61
    v_max3_u32 v38, v38, v62, v63
    v_max3_u32 v38, v38, v64, v65
    v_max3_u32 v38, v38, v66, v67
    v_max3_u32 v38, v38, v68, v69
    v_max3_u32 v38, v38, v70, v71
    v_max3_u32 v38, v38, v72, v73
    v_max3_u32 v38, v38, v74, v75
    v_max3_u32 v38, v38, v76, v77
    v_max3_u32 v38, v38, v78, v79
    v_max3_u32 v38, v38, v80, v81
    v_max3_u32 v38, v38, v82, v83
    v_max3_u32 v38, v38, v84, v85
    v_max3_u32 v38, v38, v86, v87
    v_max3_u32 v38, v38, v88, v89
    v_max3_u32 v38, v38, v90, v91
    v_max3_u32 v38, v38, v92, v93
    v_max3_u32 v38, v38, v94, v95
    v_max3_u32 v38, v38, v96, v97
    v_max3_u32 v38, v38, v98, v99
    v_max3_u32 v38, v38, v100, v101
    v_max3_u32 v38, v38, v102, v103
    v_max3_u32 v38, v38, v104, v105
    v_max3_u32 v38, v38, v106, v107
    v_max3_u32 v38, v38, v108, v109
    v_max3_u32 v38, v38, v110, v111
    v_max3_u32 v38, v38, v112, v113
    v_max3_u32 v38, v38, v114, v115
    v_max3_u32 v38, v38, v116, v117
    v_max3_u32 v38, v38, v118, v119
    v_cmp_eq_u32 vcc, -1, v38
    s_add_u32 s45, s45, 1
    s_cbranch_vccz L_poll_4_ok
    s_cmp_ge_u32 s45, 0x40000
    s_cbranch_scc1 L_poll_4_ok
    s_sleep 2
    s_branch L_poll_4
L_poll_4_ok:
    v_add_f32 v40, v40, v80
    v_add_f32 v50, v50, v90
    v_add_f32 v60, v60, v100
    v_add_f32 v70, v70, v110
    v_add_f32 v16, v40, v50
    v_add_f32 v38, v60, v70
    v_add_f32 v16, v16, v38
    v_cvt_pk_bf16_f32 v16, v16, v16
    v_lshlrev_b32 v16, 16, v16
    v_add_f32 v41, v41, v81
    v_add_f32 v51, v51, v91
    v_add_f32 v61, v61, v101
    v_add_f32 v71, v71, v111
    v_add_f32 v17, v41, v51
    v_add_f32 v38, v61, v71
    v_add_f32 v17, v17, v38
    v_cvt_pk_bf16_f32 v17, v17, v17
    v_lshlrev_b32 v17, 16, v17
    v_add_f32 v42, v42, v82
    v_add_f32 v52, v52, v92
    v_add_f32 v62, v62, v102
    v_add_f32 v72, v72, v112
    v_add_f32 v18, v42, v52
    v_add_f32 v38, v62, v72
    v_add_f32 v18, v18, v38
    v_cvt_pk_bf16_f32 v18, v18, v18
    v_lshlrev_b32 v18, 16, v18
    v_add_f32 v43, v43, v83
    v_add_f32 v53, v53, v93
    v_add_f32 v63, v63, v103
    v_add_f32 v73, v73, v113
    v_add_f32 v19, v43, v53
    v_add_f32 v38, v63, v73
    v_add_f32 v19, v19, v38
    v_cvt_pk_bf16_f32 v19, v19, v19
    v_lshlrev_b32 v19, 16, v19
    v_add_f32 v44, v44, v84
    v_add_f32 v54, v54, v94
    v_add_f32 v64, v64, v104
    v_add_f32 v74, v74, v114
    v_add_f32 v20, v44, v54
    v_add_f32 v38, v64, v74
    v_add_f32 v20, v20, v38
    v_cvt_pk_bf16_f32 v20, v20, v20
    v_lshlrev_b32 v20, 16, v20
    v_add_f32 v45, v45, v85
    v_add_f32 v55, v55, v95
    v_add_f32 v65, v65, v105
    v_add_f32 v75, v75, v115
    v_add_f32 v21, v45, v55
    v_add_f32 v38, v65, v75
    v_add_f32 v21, v21, v38
    v_cvt_pk_bf16_f32 v21, v21, v21
    v_lshlrev_b32 v21, 16, v21
    v_add_f32 v46, v46, v86
    v_add_f32 v56, v56, v96
    v_add_f32 v66, v66, v106
    v_add_f32 v76, v76, v116
    v_add_f32 v22, v46, v56
    v_add_f32 v38, v66, v76
    v_add_f32 v22, v22, v38
    v_cvt_pk_bf16_f32 v22, v22, v22
    v_lshlrev_b32 v22, 16, v22
    v_add_f32 v47, v47, v87
    v_add_f32 v57, v57, v97
    v_add_f32 v67, v67, v107
    v_add_f32 v77, v77, v117
    v_add_f32 v23, v47, v57
    v_add_f32 v38, v67, v77
    v_add_f32 v23, v23, v38
    v_cvt_pk_bf16_f32 v23, v23, v23
    v_lshlrev_b32 v23, 16, v23
    v_add_f32 v48, v48, v88
    v_add_f32 v58, v58, v98
    v_add_f32 v68, v68, v108
    v_add_f32 v78, v78, v118
    v_add_f32 v24, v48, v58
    v_add_f32 v38, v68, v78
    v_add_f32 v24, v24, v38
    v_cvt_pk_bf16_f32 v24, v24, v24
    v_lshlrev_b32 v24, 16, v24
    v_add_f32 v49, v49, v89
    v_add_f32 v59, v59, v99
    v_add_f32 v69, v69, v109
    v_add_f32 v79, v79, v119
    v_add_f32 v25, v49, v59
    v_add_f32 v38, v69, v79
    v_add_f32 v25, v25, v38
    v_cvt_pk_bf16_f32 v25, v25, v25
    v_lshlrev_b32 v25, 16, v25
    v_and_b32 v27, 0xffff0000, v26
    v_lshlrev_b32 v26, 16, v26
    v_and_b32 v29, 0xffff0000, v28
    v_lshlrev_b32 v28, 16, v28
    v_and_b32 v31, 0xffff0000, v30
    v_lshlrev_b32 v30, 16, v30
    v_and_b32 v33, 0xffff0000, v32
    v_lshlrev_b32 v32, 16, v32
    v_and_b32 v35, 0xffff0000, v34
    v_lshlrev_b32 v34, 16, v34
    v_add_f32 v16, v16, v26
    v_cvt_pk_bf16_f32 v16, v16, v16
    v_lshlrev_b32 v16, 16, v16
    v_add_f32 v17, v17, v27
    v_cvt_pk_bf16_f32 v17, v17, v17
    v_lshlrev_b32 v17, 16, v17
    v_add_f32 v18, v18, v28
    v_cvt_pk_bf16_f32 v18, v18, v18
    v_lshlrev_b32 v18, 16, v18
    v_add_f32 v19, v19, v29
    v_cvt_pk_bf16_f32 v19, v19, v19
    v_lshlrev_b32 v19, 16, v19
    v_add_f32 v20, v20, v30
    v_cvt_pk_bf16_f32 v20, v20, v20
    v_lshlrev_b32 v20, 16, v20
    v_add_f32 v21, v21, v31
    v_cvt_pk_bf16_f32 v21, v21, v21
    v_lshlrev_b32 v21, 16, v21
    v_add_f32 v22, v22, v32
    v_cvt_pk_bf16_f32 v22, v22, v22
    v_lshlrev_b32 v22, 16, v22
    v_add_f32 v23, v23, v33
    v_cvt_pk_bf16_f32 v23, v23, v23
    v_lshlrev_b32 v23, 16, v23
    v_add_f32 v24, v24, v34
    v_cvt_pk_bf16_f32 v24, v24, v24
    v_lshlrev_b32 v24, 16, v24
    v_add_f32 v25, v25, v35
    v_cvt_pk_bf16_f32 v25, v25, v25
    v_lshlrev_b32 v25, 16, v25
    v_add_f32 v36, v16, v17
    v_add_f32 v36, v36, v18
    v_add_f32 v36, v36, v19
    v_add_f32 v36, v36, v20
    v_add_f32 v36, v36, v21
    v_add_f32 v36, v36, v22
    v_add_f32 v36, v36, v23
    v_add_f32 v36, v36, v24
    v_add_f32 v36, v36, v25
    s_nop 1
    v_add_f32_dpp v36, v36, v36 quad_perm:[1,0,3,2] row_mask:0xf bank_mask:0xf
    s_nop 1
    v_add_f32_dpp v36, v36, v36 quad_perm:[2,3,0,1] row_mask:0xf bank_mask:0xf
    s_nop 1
    v_add_f32_dpp v36, v36, v36 row_half_mirror row_mask:0xf bank_mask:0xf
    s_nop 1
    v_add_f32_dpp v36, v36, v36 row_mirror row_mask:0xf bank_mask:0xf
    s_nop 1
    v_readlane_b32 s48, v36, 0
    v_readlane_b32 s49, v36, 16
    v_readlane_b32 s50, v36, 32
    v_readlane_b32 s51, v36, 48
    s_nop 1
    v_mov_b32 v36, s48
    v_add_f32 v36, s49, v36
    v_add_f32 v36, s50, v36
    v_add_f32 v36, s51, v36
    v_mul_f32 v36, 0x3acccccd, v36
    v_sub_f32 v38, v16, v36
    v_mul_f32 v37, v38, v38
    v_sub_f32 v38, v17, v36
    v_fmac_f32 v37, v38, v38
    v_sub_f32 v38, v18, v36
    v_fmac_f32 v37, v38, v38
    v_sub_f32 v38, v19, v36
    v_fmac_f32 v37, v38, v38
    v_sub_f32 v38, v20, v36
    v_fmac_f32 v37, v38, v38
    v_sub_f32 v38, v21, v36
    v_fmac_f32 v37, v38, v38
    v_sub_f32 v38, v22, v36
    v_fmac_f32 v37, v38, v38
    v_sub_f32 v38, v23, v36
    v_fmac_f32 v37, v38, v38
    v_sub_f32 v38, v24, v36
    v_fmac_f32 v37, v38, v38
    v_sub_f32 v38, v25, v36
    v_fmac_f32 v37, v38, v38
    s_nop 1
    v_add_f32_dpp v37, v37, v37 quad_perm:[1,0,3,2] row_mask:0xf bank_mask:0xf
    s_nop 1
    v_add_f32_dpp v37, v37, v37 quad_perm:[2,3,0,1] row_mask:0xf bank_mask:0xf
    s_nop 1
    v_add_f32_dpp v37, v37, v37 row_half_mirror row_mask:0xf bank_mask:0xf
    s_nop 1
    v_add_f32_dpp v37, v37, v37 row_mirror row_mask:0xf bank_mask:0xf
    s_nop 1
    v_readlane_b32 s48, v37, 0
    v_readlane_b32 s49, v37, 16
    v_readlane_b32 s50, v37, 32
    v_readlane_b32 s51, v37, 48
    s_nop 1
    v_mov_b32 v37, s48
    v_add_f32 v37, s49, v37
    v_add_f32 v37, s50, v37
    v_add_f32 v37, s51, v37
    v_mul_f32 v37, 0x3acccccd, v37
    v_cvt_pk_bf16_f32 v36, v36, v36
    v_lshlrev_b32 v36, 16, v36
    v_cvt_pk_bf16_f32 v37, v37, v37
    v_lshlrev_b32 v37, 16, v37
    v_add_f32 v37, 0x3727c5ac, v37
    v_cvt_pk_bf16_f32 v37, v37, v37
    v_lshlrev_b32 v37, 16, v37
    v_sqrt_f32 v37, v37
    s_nop 0
    v_cvt_pk_bf16_f32 v37, v37, v37
    v_lshlrev_b32 v37, 16, v37
    v_rcp_f32 v37, v37
    s_nop 0
    v_sub_f32 v26, v16, v36
    v_cvt_pk_bf16_f32 v26, v26, v26
    v_lshlrev_b32 v26, 16, v26
    v_mul_f32 v26, v26, v37
    v_cvt_pk_bf16_f32 v26, v26, v26
    v_lshlrev_b32 v26, 16, v26
    v_sub_f32 v27, v17, v36
    v_cvt_pk_bf16_f32 v27, v27, v27
    v_lshlrev_b32 v27, 16, v27
    v_mul_f32 v27, v27, v37
    v_cvt_pk_bf16_f32 v27, v27, v27
    v_lshlrev_b32 v27, 16, v27
    v_sub_f32 v28, v18, v36
    v_cvt_pk_bf16_f32 v28, v28, v28
    v_lshlrev_b32 v28, 16, v28
    v_mul_f32 v28, v28, v37
    v_cvt_pk_bf16_f32 v28, v28, v28
    v_lshlrev_b32 v28, 16, v28
    v_sub_f32 v29, v19, v36
    v_cvt_pk_bf16_f32 v29, v29, v29
    v_lshlrev_b32 v29, 16, v29
    v_mul_f32 v29, v29, v37
    v_cvt_pk_bf16_f32 v29, v29, v29
    v_lshlrev_b32 v29, 16, v29
    v_sub_f32 v30, v20, v36
    v_cvt_pk_bf16_f32 v30, v30, v30
    v_lshlrev_b32 v30, 16, v30
    v_mul_f32 v30, v30, v37
    v_cvt_pk_bf16_f32 v30, v30, v30
    v_lshlrev_b32 v30, 16, v30
    v_sub_f32 v31, v21, v36
    v_cvt_pk_bf16_f32 v31, v31, v31
    v_lshlrev_b32 v31, 16, v31
    v_mul_f32 v31, v31, v37
    v_cvt_pk_bf16_f32 v31, v31, v31
    v_lshlrev_b32 v31, 16, v31
    v_sub_f32 v32, v22, v36
    v_cvt_pk_bf16_f32 v32, v32, v32
    v_lshlrev_b32 v32, 16, v32
    v_mul_f32 v32, v32, v37
    v_cvt_pk_bf16_f32 v32, v32, v32
    v_lshlrev_b32 v32, 16, v32
    v_sub_f32 v33, v23, v36
    v_cvt_pk_bf16_f32 v33, v33, v33
    v_lshlrev_b32 v33, 16, v33
    v_mul_f32 v33, v33, v37
    v_cvt_pk_bf16_f32 v33, v33, v33
    v_lshlrev_b32 v33, 16, v33
    v_sub_f32 v34, v24, v36
    v_cvt_pk_bf16_f32 v34, v34, v34
    v_lshlrev_b32 v34, 16, v34
    v_mul_f32 v34, v34, v37
    v_cvt_pk_bf16_f32 v34, v34, v34
    v_lshlrev_b32 v34, 16, v34
    v_sub_f32 v35, v25, v36
    v_cvt_pk_bf16_f32 v35, v35, v35
    v_lshlrev_b32 v35, 16, v35
    v_mul_f32 v35, v35, v37
    v_cvt_pk_bf16_f32 v35, v35, v35
    v_lshlrev_b32 v35, 16, v35
    v_mul_u32_u24 v36, 1344, v7
    v_lshlrev_b32 v37, 2, v6
    v_add_u32 v36, v36, v37
    v_cvt_pk_bf16_f32 v38, v26, v27
    ds_write_b32 v36, v38 offset:18944
    v_cvt_pk_bf16_f32 v38, v28, v29
    ds_write_b32 v36, v38 offset:19200
    v_cvt_pk_bf16_f32 v38, v30, v31
    ds_write_b32 v36, v38 offset:19456
    v_cvt_pk_bf16_f32 v38, v32, v33
    ds_write_b32 v36, v38 offset:19712
    v_cvt_pk_bf16_f32 v38, v34, v35
    ds_write_b32 v36, v38 offset:19968
    v_cvt_pk_bf16_f32 v38, v16, v17
    ds_write_b32 v36, v38 offset:24320
    v_cvt_pk_bf16_f32 v38, v18, v19
    ds_write_b32 v36, v38 offset:24576
    v_cvt_pk_bf16_f32 v38, v20, v21
    ds_write_b32 v36, v38 offset:24832
    v_cvt_pk_bf16_f32 v38, v22, v23
    ds_write_b32 v36, v38 offset:25088
    v_cvt_pk_bf16_f32 v38, v24, v25
    ds_write_b32 v36, v38 offset:25344
    v_lshlrev_b32 v13, 16, v121
    v_and_b32 v14, 0xffff0000, v121
    v_mul_f32 v12, v26, v13
    v_fmac_f32 v12, v27, v14
    v_lshlrev_b32 v13, 16, v122
    v_and_b32 v14, 0xffff0000, v122
    v_fmac_f32 v12, v28, v13
    v_fmac_f32 v12, v29, v14
    v_lshlrev_b32 v13, 16, v123
    v_and_b32 v14, 0xffff0000, v123
    v_fmac_f32 v12, v30, v13
    v_fmac_f32 v12, v31, v14
    v_lshlrev_b32 v13, 16, v124
    v_and_b32 v14, 0xffff0000, v124
    v_fmac_f32 v12, v32, v13
    v_fmac_f32 v12, v33, v14
    v_lshlrev_b32 v13, 16, v125
    v_and_b32 v14, 0xffff0000, v125
    v_fmac_f32 v12, v34, v13
    v_fmac_f32 v12, v35, v14
    s_nop 1
    v_add_f32_dpp v12, v12, v12 quad_perm:[1,0,3,2] row_mask:0xf bank_mask:0xf
    s_nop 1
    v_add_f32_dpp v12, v12, v12 quad_perm:[2,3,0,1] row_mask:0xf bank_mask:0xf
    s_nop 1
    v_add_f32_dpp v12, v12, v12 row_half_mirror row_mask:0xf bank_mask:0xf
    s_nop 1
    v_add_f32_dpp v12, v12, v12 row_mirror row_mask:0xf bank_mask:0xf
    s_nop 1
    v_readlane_b32 s48, v12, 0
    v_readlane_b32 s49, v12, 16
    v_readlane_b32 s50, v12, 32
    v_readlane_b32 s51, v12, 48
    s_nop 1
    v_mov_b32 v12, s48
    v_add_f32 v12, s49, v12
    v_add_f32 v12, s50, v12
    v_add_f32 v12, s51, v12
    v_cvt_pk_bf16_f32 v12, v12, v12
    v_lshlrev_b32 v12, 16, v12
    v_mul_f32 v12, 0xbfb8aa3b, v12
    v_exp_f32 v12, v12
    s_nop 0
    v_add_f32 v12, 1.0, v12
    v_rcp_f32 v12, v12
    s_nop 0
    v_cvt_pk_bf16_f32 v12, v12, v12
    v_lshlrev_b32 v12, 16, v12
    v_lshlrev_b32 v13, 2, v7
    ds_write_b32 v13, v12 offset:29696
    s_branch L_e_wait
L_e_act:
    v_subrev_u32 v15, 256, v0
    v_lshlrev_b32 v12, 4, v15
    v_mul_u32_u24 v13, 43691, v15
    v_lshrrev_b32 v13, 23, v13
    v_mul_u32_u24 v14, 64, v13
    v_add_u32 v14, v14, v12
    s_mov_b32 s45, 0
L_poll_5:
    s_mov_b32 s46, 360448
    buffer_load_dwordx4 v[16:19], v12, s[32:35], s46 offen sc0 sc1
    s_mov_b32 s46, 376832
    buffer_load_dwordx4 v[20:23], v12, s[32:35], s46 offen sc0 sc1
    s_waitcnt vmcnt(0)
    v_max_u32 v15, v16, v17
    v_max3_u32 v15, v15, v18, v19
    v_max3_u32 v15, v15, v20, v21
    v_max3_u32 v15, v15, v22, v23
    v_cmp_eq_u32 vcc, -1, v15
    s_add_u32 s45, s45, 1
    s_cbranch_vccz L_poll_5_ok
    s_cmp_ge_u32 s45, 0x40000
    s_cbranch_scc1 L_poll_5_ok
    s_sleep 2
    s_branch L_poll_5
L_poll_5_ok:
    v_lshlrev_b32 v24, 16, v16
    v_and_b32 v25, 0xffff0000, v16
    v_lshlrev_b32 v26, 16, v20
    v_and_b32 v27, 0xffff0000, v20
    v_mul_f32 v28, 0xbfb8aa3b, v24
    v_mul_f32 v29, 0xbfb8aa3b, v25
    v_exp_f32 v28, v28
    v_exp_f32 v29, v29
    s_nop 0
    v_add_f32 v28, 1.0, v28
    v_add_f32 v29, 1.0, v29
    v_rcp_f32 v28, v28
    v_rcp_f32 v29, v29
    s_nop 0
    v_mul_f32 v24, v24, v28
    v_mul_f32 v25, v25, v29
    v_cvt_pk_bf16_f32 v24, v24, v24
    v_lshlrev_b32 v24, 16, v24
    v_cvt_pk_bf16_f32 v25, v25, v25
    v_lshlrev_b32 v25, 16, v25
    v_mul_f32 v24, v24, v26
    v_mul_f32 v25, v25, v27
    v_cvt_pk_bf16_f32 v32, v24, v25
    v_lshlrev_b32 v24, 16, v17
    v_and_b32 v25, 0xffff0000, v17
    v_lshlrev_b32 v26, 16, v21
    v_and_b32 v27, 0xffff0000, v21
    v_mul_f32 v28, 0xbfb8aa3b, v24
    v_mul_f32 v29, 0xbfb8aa3b, v25
    v_exp_f32 v28, v28
    v_exp_f32 v29, v29
    s_nop 0
    v_add_f32 v28, 1.0, v28
    v_add_f32 v29, 1.0, v29
    v_rcp_f32 v28, v28
    v_rcp_f32 v29, v29
    s_nop 0
    v_mul_f32 v24, v24, v28
    v_mul_f32 v25, v25, v29
    v_cvt_pk_bf16_f32 v24, v24, v24
    v_lshlrev_b32 v24, 16, v24
    v_cvt_pk_bf16_f32 v25, v25, v25
    v_lshlrev_b32 v25, 16, v25
    v_mul_f32 v24, v24, v26
    v_mul_f32 v25, v25, v27
    v_cvt_pk_bf16_f32 v33, v24, v25
    v_lshlrev_b32 v24, 16, v18
    v_and_b32 v25, 0xffff0000, v18
    v_lshlrev_b32 v26, 16, v22
    v_and_b32 v27, 0xffff0000, v22
    v_mul_f32 v28, 0xbfb8aa3b, v24
    v_mul_f32 v29, 0xbfb8aa3b, v25
    v_exp_f32 v28, v28
    v_exp_f32 v29, v29
    s_nop 0
    v_add_f32 v28, 1.0, v28
    v_add_f32 v29, 1.0, v29
    v_rcp_f32 v28, v28
    v_rcp_f32 v29, v29
    s_nop 0
    v_mul_f32 v24, v24, v28
    v_mul_f32 v25, v25, v29
    v_cvt_pk_bf16_f32 v24, v24, v24
    v_lshlrev_b32 v24, 16, v24
    v_cvt_pk_bf16_f32 v25, v25, v25
    v_lshlrev_b32 v25, 16, v25
    v_mul_f32 v24, v24, v26
    v_mul_f32 v25, v25, v27
    v_cvt_pk_bf16_f32 v34, v24, v25
    v_lshlrev_b32 v24, 16, v19
    v_and_b32 v25, 0xffff0000, v19
    v_lshlrev_b32 v26, 16, v23
    v_and_b32 v27, 0xffff0000, v23
    v_mul_f32 v28, 0xbfb8aa3b, v24
    v_mul_f32 v29, 0xbfb8aa3b, v25
    v_exp_f32 v28, v28
    v_exp_f32 v29, v29
    s_nop 0
    v_add_f32 v28, 1.0, v28
    v_add_f32 v29, 1.0, v29
    v_rcp_f32 v28, v28
    v_rcp_f32 v29, v29
    s_nop 0
    v_mul_f32 v24, v24, v28
    v_mul_f32 v25, v25, v29
    v_cvt_pk_bf16_f32 v24, v24, v24
    v_lshlrev_b32 v24, 16, v24
    v_cvt_pk_bf16_f32 v25, v25, v25
    v_lshlrev_b32 v25, 16, v25
    v_mul_f32 v24, v24, v26
    v_mul_f32 v25, v25, v27
    v_cvt_pk_bf16_f32 v35, v24, v25
    ds_write_b128 v14, v[32:35] offset:29952
L_e_wait:
    s_waitcnt lgkmcnt(0)
    s_barrier
    s_lshr_b32 s48, s53, 1
    s_and_b32 s49, s53, 1
    s_mul_i32 s50, s48, 384
    s_add_u32 s50, s50, 29952
    v_add_u32 v12, s50, v8
    s_mul_i32 s50, s48, 12288
    s_lshl_b32 s49, s49, 5
    s_add_u32 s50, s50, s49
    s_add_u32 s50, s50, 42496
    v_add_u32 v13, s50, v9
    s_waitcnt vmcnt(0)
    ds_read_b128 v[16:19], v12 offset:0
    ds_read_b64_tr_b16 v[40:41], v13 offset:0
    ds_read_b64_tr_b16 v[42:43], v13 offset:256
    ds_read_b128 v[20:23], v12 offset:64
    ds_read_b64_tr_b16 v[44:45], v13 offset:2048
    ds_read_b64_tr_b16 v[46:47], v13 offset:2304
    ds_read_b128 v[24:27], v12 offset:128
    ds_read_b64_tr_b16 v[48:49], v13 offset:4096
    ds_read_b64_tr_b16 v[50:51], v13 offset:4352
    ds_read_b128 v[28:31], v12 offset:192
    ds_read_b64_tr_b16 v[52:53], v13 offset:6144
    ds_read_b64_tr_b16 v[54:55], v13 offset:6400
    ds_read_b128 v[32:35], v12 offset:256
    ds_read_b64_tr_b16 v[56:57], v13 offset:8192
    ds_read_b64_tr_b16 v[58:59], v13 offset:8448
    ds_read_b128 v[36:39], v12 offset:320
    ds_read_b64_tr_b16 v[60:61], v13 offset:10240
    ds_read_b64_tr_b16 v[62:63], v13 offset:10496
    s_waitcnt lgkmcnt(15)
    v_mfma_f32_16x16x32_bf16 v[64:67], v[16:19], v[40:43], 0
    s_waitcnt lgkmcnt(12)
    v_mfma_f32_16x16x32_bf16 v[64:67], v[20:23], v[44:47], v[64:67]
    s_waitcnt lgkmcnt(9)
    v_mfma_f32_16x16x32_bf16 v[64:67], v[24:27], v[48:51], v[64:67]
    s_waitcnt lgkmcnt(6)
    v_mfma_f32_16x16x32_bf16 v[64:67], v[28:31], v[52:55], v[64:67]
    s_waitcnt lgkmcnt(3)
    v_mfma_f32_16x16x32_bf16 v[64:67], v[32:35], v[56:59], v[64:67]
    s_waitcnt lgkmcnt(0)
    v_mfma_f32_16x16x32_bf16 v[64:67], v[36:39], v[60:63], v[64:67]
    s_nop 15
    s_lshr_b32 s48, s53, 1
    s_and_b32 s49, s53, 1
    s_mul_i32 s48, s48, 512
    s_lshl_b32 s49, s49, 6
    s_add_u32 s48, s48, s49
    v_lshlrev_b32 v12, 2, v6
    v_add_u32 v12, s48, v12
    s_mov_b64 exec, 0xffff
    ds_write_b32 v12, v64 offset:13824
    ds_write_b32 v12, v65 offset:13952
    ds_write_b32 v12, v66 offset:14080
    ds_write_b32 v12, v67 offset:14208
    s_mov_b64 exec, -1
    s_waitcnt lgkmcnt(0)
    s_barrier
    s_cmp_ge_u32 s53, 2
    s_cbranch_scc1 L_done
    v_lshlrev_b32 v12, 2, v0
    ds_read_b32 v16, v12 offset:13824
    ds_read_b32 v17, v12 offset:14336
    ds_read_b32 v18, v12 offset:14848
    ds_read_b32 v19, v12 offset:15360
    ds_read_b32 v20, v12 offset:15872
    ds_read_b32 v21, v12 offset:16384
    ds_read_b32 v22, v12 offset:16896
    ds_read_b32 v23, v12 offset:17408
    v_and_b32 v13, 31, v0
    s_lshl_b32 s48, s55, 5
    v_add_u32 v13, s48, v13
    v_lshrrev_b32 v14, 5, v0
    v_mul_u32_u24 v15, 1344, v14
    v_lshl_add_u32 v15, v13, 1, v15
    v_lshlrev_b32 v12, 2, v14
    ds_read_u16 v40, v15 offset:18944
    ds_read_u16 v41, v15 offset:24320
    ds_read_b32 v42, v12 offset:29696
    s_waitcnt lgkmcnt(0)
    v_add_f32 v16, v16, v20
    v_add_f32 v17, v17, v21
    v_add_f32 v18, v18, v22
    v_add_f32 v19, v19, v23
    v_add_f32 v16, v16, v18
    v_add_f32 v17, v17, v19
    v_add_f32 v16, v16, v17
    v_lshlrev_b32 v40, 16, v40
    v_lshlrev_b32 v41, 16, v41
    v_cvt_pk_bf16_f32 v16, v16, v16
    v_lshlrev_b32 v16, 16, v16
    v_mul_f32 v16, v16, v42
    v_cvt_pk_bf16_f32 v16, v16, v16
    v_lshlrev_b32 v16, 16, v16
    v_add_f32 v16, v40, v16
    v_cvt_pk_bf16_f32 v16, v16, v16
    v_lshlrev_b32 v16, 16, v16
    v_add_f32 v16, v41, v16
    v_cvt_pk_bf16_f32 v16, v16, v16
    v_mul_u32_u24 v14, 640, v14
    v_add_u32 v14, v14, v13
    v_lshlrev_b32 v14, 1, v14
    buffer_store_short v16, v14, s[76:79], 0 offen
    s_endpgm
L_tail_d:
    v_and_b32 v12, 3, v6
    v_mul_u32_u24 v8, 1344, v12
    v_lshlrev_b32 v9, 3, v12
    v_lshrrev_b32 v12, 4, v6
    v_lshl_add_u32 v8, v12, 4, v8
    v_mul_u32_u24 v12, 1024, v12
    v_add_u32 v9, v9, v12
    v_bfe_u32 v12, v6, 2, 2
    v_mul_u32_u24 v12, 128, v12
    v_add_u32 v9, v9, v12
    s_barrier
    s_cmp_ge_u32 s53, 4
    s_cbranch_scc1 L_d_skipln
    v_mul_u32_u24 v39, 640, v7
    v_lshlrev_b32 v36, 1, v6
    v_add_u32 v39, v39, v36
    v_lshlrev_b32 v37, 1, v39
    buffer_load_dword v26, v37, s[56:59], 0 offen offset:0
    buffer_load_dword v28, v37, s[56:59], 0 offen offset:256
    buffer_load_dword v30, v37, s[56:59], 0 offen offset:512
    buffer_load_dword v32, v37, s[56:59], 0 offen offset:768
    buffer_load_dword v34, v37, s[56:59], 0 offen offset:1024
    v_lshlrev_b32 v36, 2, v39
    s_mov_b32 s45, 0
L_poll_6:
    s_mov_b32 s44, 262144
    buffer_load_dwordx2 v[40:41], v36, s[32:35], s44 offen offset:0 sc0 sc1
    buffer_load_dwordx2 v[42:43], v36, s[32:35], s44 offen offset:512 sc0 sc1
    buffer_load_dwordx2 v[44:45], v36, s[32:35], s44 offen offset:1024 sc0 sc1
    buffer_load_dwordx2 v[46:47], v36, s[32:35], s44 offen offset:1536 sc0 sc1
    buffer_load_dwordx2 v[48:49], v36, s[32:35], s44 offen offset:2048 sc0 sc1
    s_mov_b32 s44, 272384
    buffer_load_dwordx2 v[50:51], v36, s[32:35], s44 offen offset:0 sc0 sc1
    buffer_load_dwordx2 v[52:53], v36, s[32:35], s44 offen offset:512 sc0 sc1
    buffer_load_dwordx2 v[54:55], v36, s[32:35], s44 offen offset:1024 sc0 sc1
    buffer_load_dwordx2 v[56:57], v36, s[32:35], s44 offen offset:1536 sc0 sc1
    buffer_load_dwordx2 v[58:59], v36, s[32:35], s44 offen offset:2048 sc0 sc1
    s_mov_b32 s44, 282624
    buffer_load_dwordx2 v[60:61], v36, s[32:35], s44 offen offset:0 sc0 sc1
    buffer_load_dwordx2 v[62:63], v36, s[32:35], s44 offen offset:512 sc0 sc1
    buffer_load_dwordx2 v[64:65], v36, s[32:35], s44 offen offset:1024 sc0 sc1
    buffer_load_dwordx2 v[66:67], v36, s[32:35], s44 offen offset:1536 sc0 sc1
    buffer_load_dwordx2 v[68:69], v36, s[32:35], s44 offen offset:2048 sc0 sc1
    s_mov_b32 s44, 292864
    buffer_load_dwordx2 v[70:71], v36, s[32:35], s44 offen offset:0 sc0 sc1
    buffer_load_dwordx2 v[72:73], v36, s[32:35], s44 offen offset:512 sc0 sc1
    buffer_load_dwordx2 v[74:75], v36, s[32:35], s44 offen offset:1024 sc0 sc1
    buffer_load_dwordx2 v[76:77], v36, s[32:35], s44 offen offset:1536 sc0 sc1
    buffer_load_dwordx2 v[78:79], v36, s[32:35], s44 offen offset:2048 sc0 sc1
    s_mov_b32 s44, 303104
    buffer_load_dwordx2 v[80:81], v36, s[32:35], s44 offen offset:0 sc0 sc1
    buffer_load_dwordx2 v[82:83], v36, s[32:35], s44 offen offset:512 sc0 sc1
    buffer_load_dwordx2 v[84:85], v36, s[32:35], s44 offen offset:1024 sc0 sc1
    buffer_load_dwordx2 v[86:87], v36, s[32:35], s44 offen offset:1536 sc0 sc1
    buffer_load_dwordx2 v[88:89], v36, s[32:35], s44 offen offset:2048 sc0 sc1
    s_mov_b32 s44, 313344
    buffer_load_dwordx2 v[90:91], v36, s[32:35], s44 offen offset:0 sc0 sc1
    buffer_load_dwordx2 v[92:93], v36, s[32:35], s44 offen offset:512 sc0 sc1
    buffer_load_dwordx2 v[94:95], v36, s[32:35], s44 offen offset:1024 sc0 sc1
    buffer_load_dwordx2 v[96:97], v36, s[32:35], s44 offen offset:1536 sc0 sc1
    buffer_load_dwordx2 v[98:99], v36, s[32:35], s44 offen offset:2048 sc0 sc1
    s_mov_b32 s44, 323584
    buffer_load_dwordx2 v[100:101], v36, s[32:35], s44 offen offset:0 sc0 sc1
    buffer_load_dwordx2 v[102:103], v36, s[32:35], s44 offen offset:512 sc0 sc1
    buffer_load_dwordx2 v[104:105], v36, s[32:35], s44 offen offset:1024 sc0 sc1
    buffer_load_dwordx2 v[106:107], v36, s[32:35], s44 offen offset:1536 sc0 sc1
    buffer_load_dwordx2 v[108:109], v36, s[32:35], s44 offen offset:2048 sc0 sc1
    s_mov_b32 s44, 333824
    buffer_load_dwordx2 v[110:111], v36, s[32:35], s44 offen offset:0 sc0 sc1
    buffer_load_dwordx2 v[112:113], v36, s[32:35], s44 offen offset:512 sc0 sc1
    buffer_load_dwordx2 v[114:115], v36, s[32:35], s44 offen offset:1024 sc0 sc1
    buffer_load_dwordx2 v[116:117], v36, s[32:35], s44 offen offset:1536 sc0 sc1
    buffer_load_dwordx2 v[118:119], v36, s[32:35], s44 offen offset:2048 sc0 sc1
    s_waitcnt vmcnt(0)
    v_max_u32 v38, v40, v41
    v_max3_u32 v38, v38, v42, v43
    v_max3_u32 v38, v38, v44, v45
    v_max3_u32 v38, v38, v46, v47
    v_max3_u32 v38, v38, v48, v49
    v_max3_u32 v38, v38, v50, v51
    v_max3_u32 v38, v38, v52, v53
    v_max3_u32 v38, v38, v54, v55
    v_max3_u32 v38, v38, v56, v57
    v_max3_u32 v38, v38, v58, v59
    v_max3_u32 v38, v38, v60, v61
    v_max3_u32 v38, v38, v62, v63
    v_max3_u32 v38, v38, v64, v65
    v_max3_u32 v38, v38, v66, v67
    v_max3_u32 v38, v38, v68, v69
    v_max3_u32 v38, v38, v70, v71
    v_max3_u32 v38, v38, v72, v73
    v_max3_u32 v38, v38, v74, v75
    v_max3_u32 v38, v38, v76, v77
    v_max3_u32 v38, v38, v78, v79
    v_max3_u32 v38, v38, v80, v81
    v_max3_u32 v38, v38, v82, v83
    v_max3_u32 v38, v38, v84, v85
    v_max3_u32 v38, v38, v86, v87
    v_max3_u32 v38, v38, v88, v89
    v_max3_u32 v38, v38, v90, v91
    v_max3_u32 v38, v38, v92, v93
    v_max3_u32 v38, v38, v94, v95
    v_max3_u32 v38, v38, v96, v97
    v_max3_u32 v38, v38, v98, v99
    v_max3_u32 v38, v38, v100, v101
    v_max3_u32 v38, v38, v102, v103
    v_max3_u32 v38, v38, v104, v105
    v_max3_u32 v38, v38, v106, v107
    v_max3_u32 v38, v38, v108, v109
    v_max3_u32 v38, v38, v110, v111
    v_max3_u32 v38, v38, v112, v113
    v_max3_u32 v38, v38, v114, v115
    v_max3_u32 v38, v38, v116, v117
    v_max3_u32 v38, v38, v118, v119
    v_cmp_eq_u32 vcc, -1, v38
    s_add_u32 s45, s45, 1
    s_cbranch_vccz L_poll_6_ok
    s_cmp_ge_u32 s45, 0x40000
    s_cbranch_scc1 L_poll_6_ok
    s_sleep 2
    s_branch L_poll_6
L_poll_6_ok:
    v_add_f32 v40, v40, v80
    v_add_f32 v50, v50, v90
    v_add_f32 v60, v60, v100
    v_add_f32 v70, v70, v110
    v_add_f32 v16, v40, v50
    v_add_f32 v38, v60, v70
    v_add_f32 v16, v16, v38
    v_cvt_pk_bf16_f32 v16, v16, v16
    v_lshlrev_b32 v16, 16, v16
    v_add_f32 v41, v41, v81
    v_add_f32 v51, v51, v91
    v_add_f32 v61, v61, v101
    v_add_f32 v71, v71, v111
    v_add_f32 v17, v41, v51
    v_add_f32 v38, v61, v71
    v_add_f32 v17, v17, v38
    v_cvt_pk_bf16_f32 v17, v17, v17
    v_lshlrev_b32 v17, 16, v17
    v_add_f32 v42, v42, v82
    v_add_f32 v52, v52, v92
    v_add_f32 v62, v62, v102
    v_add_f32 v72, v72, v112
    v_add_f32 v18, v42, v52
    v_add_f32 v38, v62, v72
    v_add_f32 v18, v18, v38
    v_cvt_pk_bf16_f32 v18, v18, v18
    v_lshlrev_b32 v18, 16, v18
    v_add_f32 v43, v43, v83
    v_add_f32 v53, v53, v93
    v_add_f32 v63, v63, v103
    v_add_f32 v73, v73, v113
    v_add_f32 v19, v43, v53
    v_add_f32 v38, v63, v73
    v_add_f32 v19, v19, v38
    v_cvt_pk_bf16_f32 v19, v19, v19
    v_lshlrev_b32 v19, 16, v19
    v_add_f32 v44, v44, v84
    v_add_f32 v54, v54, v94
    v_add_f32 v64, v64, v104
    v_add_f32 v74, v74, v114
    v_add_f32 v20, v44, v54
    v_add_f32 v38, v64, v74
    v_add_f32 v20, v20, v38
    v_cvt_pk_bf16_f32 v20, v20, v20
    v_lshlrev_b32 v20, 16, v20
    v_add_f32 v45, v45, v85
    v_add_f32 v55, v55, v95
    v_add_f32 v65, v65, v105
    v_add_f32 v75, v75, v115
    v_add_f32 v21, v45, v55
    v_add_f32 v38, v65, v75
    v_add_f32 v21, v21, v38
    v_cvt_pk_bf16_f32 v21, v21, v21
    v_lshlrev_b32 v21, 16, v21
    v_add_f32 v46, v46, v86
    v_add_f32 v56, v56, v96
    v_add_f32 v66, v66, v106
    v_add_f32 v76, v76, v116
    v_add_f32 v22, v46, v56
    v_add_f32 v38, v66, v76
    v_add_f32 v22, v22, v38
    v_cvt_pk_bf16_f32 v22, v22, v22
    v_lshlrev_b32 v22, 16, v22
    v_add_f32 v47, v47, v87
    v_add_f32 v57, v57, v97
    v_add_f32 v67, v67, v107
    v_add_f32 v77, v77, v117
    v_add_f32 v23, v47, v57
    v_add_f32 v38, v67, v77
    v_add_f32 v23, v23, v38
    v_cvt_pk_bf16_f32 v23, v23, v23
    v_lshlrev_b32 v23, 16, v23
    v_add_f32 v48, v48, v88
    v_add_f32 v58, v58, v98
    v_add_f32 v68, v68, v108
    v_add_f32 v78, v78, v118
    v_add_f32 v24, v48, v58
    v_add_f32 v38, v68, v78
    v_add_f32 v24, v24, v38
    v_cvt_pk_bf16_f32 v24, v24, v24
    v_lshlrev_b32 v24, 16, v24
    v_add_f32 v49, v49, v89
    v_add_f32 v59, v59, v99
    v_add_f32 v69, v69, v109
    v_add_f32 v79, v79, v119
    v_add_f32 v25, v49, v59
    v_add_f32 v38, v69, v79
    v_add_f32 v25, v25, v38
    v_cvt_pk_bf16_f32 v25, v25, v25
    v_lshlrev_b32 v25, 16, v25
    v_and_b32 v27, 0xffff0000, v26
    v_lshlrev_b32 v26, 16, v26
    v_and_b32 v29, 0xffff0000, v28
    v_lshlrev_b32 v28, 16, v28
    v_and_b32 v31, 0xffff0000, v30
    v_lshlrev_b32 v30, 16, v30
    v_and_b32 v33, 0xffff0000, v32
    v_lshlrev_b32 v32, 16, v32
    v_and_b32 v35, 0xffff0000, v34
    v_lshlrev_b32 v34, 16, v34
    v_add_f32 v16, v16, v26
    v_cvt_pk_bf16_f32 v16, v16, v16
    v_lshlrev_b32 v16, 16, v16
    v_add_f32 v17, v17, v27
    v_cvt_pk_bf16_f32 v17, v17, v17
    v_lshlrev_b32 v17, 16, v17
    v_add_f32 v18, v18, v28
    v_cvt_pk_bf16_f32 v18, v18, v18
    v_lshlrev_b32 v18, 16, v18
    v_add_f32 v19, v19, v29
    v_cvt_pk_bf16_f32 v19, v19, v19
    v_lshlrev_b32 v19, 16, v19
    v_add_f32 v20, v20, v30
    v_cvt_pk_bf16_f32 v20, v20, v20
    v_lshlrev_b32 v20, 16, v20
    v_add_f32 v21, v21, v31
    v_cvt_pk_bf16_f32 v21, v21, v21
    v_lshlrev_b32 v21, 16, v21
    v_add_f32 v22, v22, v32
    v_cvt_pk_bf16_f32 v22, v22, v22
    v_lshlrev_b32 v22, 16, v22
    v_add_f32 v23, v23, v33
    v_cvt_pk_bf16_f32 v23, v23, v23
    v_lshlrev_b32 v23, 16, v23
    v_add_f32 v24, v24, v34
    v_cvt_pk_bf16_f32 v24, v24, v24
    v_lshlrev_b32 v24, 16, v24
    v_add_f32 v25, v25, v35
    v_cvt_pk_bf16_f32 v25, v25, v25
    v_lshlrev_b32 v25, 16, v25
    v_add_f32 v36, v16, v17
    v_add_f32 v36, v36, v18
    v_add_f32 v36, v36, v19
    v_add_f32 v36, v36, v20
    v_add_f32 v36, v36, v21
    v_add_f32 v36, v36, v22
    v_add_f32 v36, v36, v23
    v_add_f32 v36, v36, v24
    v_add_f32 v36, v36, v25
    s_nop 1
    v_add_f32_dpp v36, v36, v36 quad_perm:[1,0,3,2] row_mask:0xf bank_mask:0xf
    s_nop 1
    v_add_f32_dpp v36, v36, v36 quad_perm:[2,3,0,1] row_mask:0xf bank_mask:0xf
    s_nop 1
    v_add_f32_dpp v36, v36, v36 row_half_mirror row_mask:0xf bank_mask:0xf
    s_nop 1
    v_add_f32_dpp v36, v36, v36 row_mirror row_mask:0xf bank_mask:0xf
    s_nop 1
    v_readlane_b32 s48, v36, 0
    v_readlane_b32 s49, v36, 16
    v_readlane_b32 s50, v36, 32
    v_readlane_b32 s51, v36, 48
    s_nop 1
    v_mov_b32 v36, s48
    v_add_f32 v36, s49, v36
    v_add_f32 v36, s50, v36
    v_add_f32 v36, s51, v36
    v_mul_f32 v36, 0x3acccccd, v36
    v_sub_f32 v38, v16, v36
    v_mul_f32 v37, v38, v38
    v_sub_f32 v38, v17, v36
    v_fmac_f32 v37, v38, v38
    v_sub_f32 v38, v18, v36
    v_fmac_f32 v37, v38, v38
    v_sub_f32 v38, v19, v36
    v_fmac_f32 v37, v38, v38
    v_sub_f32 v38, v20, v36
    v_fmac_f32 v37, v38, v38
    v_sub_f32 v38, v21, v36
    v_fmac_f32 v37, v38, v38
    v_sub_f32 v38, v22, v36
    v_fmac_f32 v37, v38, v38
    v_sub_f32 v38, v23, v36
    v_fmac_f32 v37, v38, v38
    v_sub_f32 v38, v24, v36
    v_fmac_f32 v37, v38, v38
    v_sub_f32 v38, v25, v36
    v_fmac_f32 v37, v38, v38
    s_nop 1
    v_add_f32_dpp v37, v37, v37 quad_perm:[1,0,3,2] row_mask:0xf bank_mask:0xf
    s_nop 1
    v_add_f32_dpp v37, v37, v37 quad_perm:[2,3,0,1] row_mask:0xf bank_mask:0xf
    s_nop 1
    v_add_f32_dpp v37, v37, v37 row_half_mirror row_mask:0xf bank_mask:0xf
    s_nop 1
    v_add_f32_dpp v37, v37, v37 row_mirror row_mask:0xf bank_mask:0xf
    s_nop 1
    v_readlane_b32 s48, v37, 0
    v_readlane_b32 s49, v37, 16
    v_readlane_b32 s50, v37, 32
    v_readlane_b32 s51, v37, 48
    s_nop 1
    v_mov_b32 v37, s48
    v_add_f32 v37, s49, v37
    v_add_f32 v37, s50, v37
    v_add_f32 v37, s51, v37
    v_mul_f32 v37, 0x3acccccd, v37
    v_cvt_pk_bf16_f32 v36, v36, v36
    v_lshlrev_b32 v36, 16, v36
    v_cvt_pk_bf16_f32 v37, v37, v37
    v_lshlrev_b32 v37, 16, v37
    v_add_f32 v37, 0x3727c5ac, v37
    v_cvt_pk_bf16_f32 v37, v37, v37
    v_lshlrev_b32 v37, 16, v37
    v_sqrt_f32 v37, v37
    s_nop 0
    v_cvt_pk_bf16_f32 v37, v37, v37
    v_lshlrev_b32 v37, 16, v37
    v_rcp_f32 v37, v37
    s_nop 0
    v_sub_f32 v26, v16, v36
    v_cvt_pk_bf16_f32 v26, v26, v26
    v_lshlrev_b32 v26, 16, v26
    v_mul_f32 v26, v26, v37
    v_cvt_pk_bf16_f32 v26, v26, v26
    v_lshlrev_b32 v26, 16, v26
    v_sub_f32 v27, v17, v36
    v_cvt_pk_bf16_f32 v27, v27, v27
    v_lshlrev_b32 v27, 16, v27
    v_mul_f32 v27, v27, v37
    v_cvt_pk_bf16_f32 v27, v27, v27
    v_lshlrev_b32 v27, 16, v27
    v_sub_f32 v28, v18, v36
    v_cvt_pk_bf16_f32 v28, v28, v28
    v_lshlrev_b32 v28, 16, v28
    v_mul_f32 v28, v28, v37
    v_cvt_pk_bf16_f32 v28, v28, v28
    v_lshlrev_b32 v28, 16, v28
    v_sub_f32 v29, v19, v36
    v_cvt_pk_bf16_f32 v29, v29, v29
    v_lshlrev_b32 v29, 16, v29
    v_mul_f32 v29, v29, v37
    v_cvt_pk_bf16_f32 v29, v29, v29
    v_lshlrev_b32 v29, 16, v29
    v_sub_f32 v30, v20, v36
    v_cvt_pk_bf16_f32 v30, v30, v30
    v_lshlrev_b32 v30, 16, v30
    v_mul_f32 v30, v30, v37
    v_cvt_pk_bf16_f32 v30, v30, v30
    v_lshlrev_b32 v30, 16, v30
    v_sub_f32 v31, v21, v36
    v_cvt_pk_bf16_f32 v31, v31, v31
    v_lshlrev_b32 v31, 16, v31
    v_mul_f32 v31, v31, v37
    v_cvt_pk_bf16_f32 v31, v31, v31
    v_lshlrev_b32 v31, 16, v31
    v_sub_f32 v32, v22, v36
    v_cvt_pk_bf16_f32 v32, v32, v32
    v_lshlrev_b32 v32, 16, v32
    v_mul_f32 v32, v32, v37
    v_cvt_pk_bf16_f32 v32, v32, v32
    v_lshlrev_b32 v32, 16, v32
    v_sub_f32 v33, v23, v36
    v_cvt_pk_bf16_f32 v33, v33, v33
    v_lshlrev_b32 v33, 16, v33
    v_mul_f32 v33, v33, v37
    v_cvt_pk_bf16_f32 v33, v33, v33
    v_lshlrev_b32 v33, 16, v33
    v_sub_f32 v34, v24, v36
    v_cvt_pk_bf16_f32 v34, v34, v34
    v_lshlrev_b32 v34, 16, v34
    v_mul_f32 v34, v34, v37
    v_cvt_pk_bf16_f32 v34, v34, v34
    v_lshlrev_b32 v34, 16, v34
    v_sub_f32 v35, v25, v36
    v_cvt_pk_bf16_f32 v35, v35, v35
    v_lshlrev_b32 v35, 16, v35
    v_mul_f32 v35, v35, v37
    v_cvt_pk_bf16_f32 v35, v35, v35
    v_lshlrev_b32 v35, 16, v35
    v_mul_u32_u24 v36, 1344, v7
    v_lshlrev_b32 v37, 2, v6
    v_add_u32 v36, v36, v37
    v_cvt_pk_bf16_f32 v38, v26, v27
    ds_write_b32 v36, v38 offset:18944
    v_cvt_pk_bf16_f32 v38, v28, v29
    ds_write_b32 v36, v38 offset:19200
    v_cvt_pk_bf16_f32 v38, v30, v31
    ds_write_b32 v36, v38 offset:19456
    v_cvt_pk_bf16_f32 v38, v32, v33
    ds_write_b32 v36, v38 offset:19712
    v_cvt_pk_bf16_f32 v38, v34, v35
    ds_write_b32 v36, v38 offset:19968
L_d_skipln:
    s_waitcnt vmcnt(0) lgkmcnt(0)
    s_barrier
    s_lshr_b32 s48, s53, 2
    s_and_b32 s49, s53, 3
    s_mul_i32 s50, s48, 320
    s_add_u32 s50, s50, 18944
    v_add_u32 v12, s50, v8
    s_mul_i32 s50, s48, 20480
    s_lshl_b32 s49, s49, 5
    s_add_u32 s50, s50, s49
    s_add_u32 s50, s50, 42496
    v_add_u32 v13, s50, v9
    s_waitcnt vmcnt(0)
    ds_read_b128 v[16:19], v12 offset:0
    ds_read_b64_tr_b16 v[36:37], v13 offset:0
    ds_read_b64_tr_b16 v[38:39], v13 offset:512
    ds_read_b128 v[20:23], v12 offset:64
    ds_read_b64_tr_b16 v[40:41], v13 offset:4096
    ds_read_b64_tr_b16 v[42:43], v13 offset:4608
    ds_read_b128 v[24:27], v12 offset:128
    ds_read_b64_tr_b16 v[44:45], v13 offset:8192
    ds_read_b64_tr_b16 v[46:47], v13 offset:8704
    ds_read_b128 v[28:31], v12 offset:192
    ds_read_b64_tr_b16 v[48:49], v13 offset:12288
    ds_read_b64_tr_b16 v[50:51], v13 offset:12800
    ds_read_b128 v[32:35], v12 offset:256
    ds_read_b64_tr_b16 v[52:53], v13 offset:16384
    ds_read_b64_tr_b16 v[54:55], v13 offset:16896
    s_waitcnt lgkmcnt(12)
    v_mfma_f32_16x16x32_bf16 v[64:67], v[16:19], v[36:39], 0
    s_waitcnt lgkmcnt(9)
    v_mfma_f32_16x16x32_bf16 v[64:67], v[20:23], v[40:43], v[64:67]
    s_waitcnt lgkmcnt(6)
    v_mfma_f32_16x16x32_bf16 v[64:67], v[24:27], v[44:47], v[64:67]
    s_waitcnt lgkmcnt(3)
    v_mfma_f32_16x16x32_bf16 v[64:67], v[28:31], v[48:51], v[64:67]
    s_waitcnt lgkmcnt(0)
    v_mfma_f32_16x16x32_bf16 v[64:67], v[32:35], v[52:55], v[64:67]
    s_nop 15
    s_lshr_b32 s48, s53, 2
    s_and_b32 s49, s53, 3
    s_mul_i32 s48, s48, 1024
    s_lshl_b32 s49, s49, 6
    s_add_u32 s48, s48, s49
    v_lshlrev_b32 v12, 2, v6
    v_add_u32 v12, s48, v12
    s_mov_b64 exec, 0xffff
    ds_write_b32 v12, v64 offset:13824
    ds_write_b32 v12, v65 offset:14080
    ds_write_b32 v12, v66 offset:14336
    ds_write_b32 v12, v67 offset:14592
    s_mov_b64 exec, -1
    s_waitcnt lgkmcnt(0)
    s_barrier
    s_cmp_ge_u32 s53, 4
    s_cbranch_scc1 L_done
    v_lshlrev_b32 v12, 2, v0
    ds_read_b32 v16, v12 offset:13824
    ds_read_b32 v17, v12 offset:14848
    ds_read_b32 v18, v12 offset:15872
    ds_read_b32 v19, v12 offset:16896
    s_waitcnt lgkmcnt(0)
    v_add_f32 v16, v16, v17
    v_add_f32 v18, v18, v19
    v_add_f32 v16, v16, v18
    s_nop 1
    v_mov_b32_dpp v17, v16 quad_perm:[1,0,3,2] row_mask:0xf bank_mask:0xf
    v_cvt_pk_bf16_f32 v16, v16, v17
    v_mul_u32_u24 v12, 3072, v7
    v_lshl_add_u32 v12, v6, 1, v12
    s_mul_i32 s48, s54, 16384
    s_lshl_b32 s49, s55, 7
    s_add_u32 s48, s48, s49
    s_add_u32 s48, s48, 360448
    s_mov_b32 exec_lo, 0x55555555
    s_mov_b32 exec_hi, 0x55555555
    buffer_store_dword v16, v12, s[32:35], s48 offen sc0 sc1
    s_mov_b64 exec, -1
L_done:
    s_endpgm
.section .rodata,"a"
.p2align 6
.amdhsa_kernel sequential_preLN__mha_block_cached__moe_arch_mod__decode_kernel
  .amdhsa_next_free_vgpr 128
  .amdhsa_next_free_sgpr 102
  .amdhsa_accum_offset 128
  .amdhsa_group_segment_fixed_size 0
  .amdhsa_kernarg_size 104
  .amdhsa_user_sgpr_count 2
  .amdhsa_user_sgpr_kernarg_segment_ptr 1
  .amdhsa_system_sgpr_workgroup_id_x 1
.end_amdhsa_kernel
```

```asm
; @launch grid=(256,1,1) block=(1024,1,1) lds=140800
.amdgcn_target "amdgcn-amd-amdhsa--gfx950"
.text
.globl sequential_preLN__mha_block_cached__moe_arch_mod__decode_kernel
.p2align 8
.type sequential_preLN__mha_block_cached__moe_arch_mod__decode_kernel,@function
sequential_preLN__mha_block_cached__moe_arch_mod__decode_kernel:
    s_cmp_ge_u32 s2, 256
    s_cbranch_scc1 L_done
    s_load_dwordx2 s[4:5], s[0:1], 0
    s_load_dwordx4 s[8:11], s[0:1], 8
    s_load_dwordx4 s[12:15], s[0:1], 24
    s_load_dwordx4 s[80:83], s[0:1], 48
    s_load_dwordx4 s[84:87], s[0:1], 64
    s_load_dwordx4 s[88:91], s[0:1], 80
    s_load_dwordx2 s[6:7], s[0:1], 96
    s_and_b32 s42, s2, 7
    s_lshr_b32 s43, s2, 3
    s_and_b32 s44, s43, 3
    s_lshl_b32 s45, s42, 2
    s_add_u32 s45, s45, s44
    s_lshr_b32 s44, s43, 2
    s_lshr_b32 s46, s44, 1
    s_and_b32 s47, s44, 1
    s_lshl_b32 s40, s46, 5
    s_add_u32 s40, s40, s45
    s_lshl_b32 s40, s40, 1
    s_add_u32 s40, s40, s47
    s_mul_i32 s41, s40, 1572864
    s_lshr_b32 s99, s45, 3
    v_and_b32 v6, 63, v0
    v_lshrrev_b32 v2, 6, v0
    v_lshrrev_b32 v3, 3, v6
    v_and_b32 v4, 7, v6
    v_readfirstlane_b32 s53, v2
    v_lshlrev_b32 v4, 4, v4
    v_mul_u32_u24 v5, 384, v3
    v_add_u32 v1, v5, v4
    v_mul_u32_u24 v5, 40, v2
    v_add_u32 v5, v5, v3
    v_mul_u32_u24 v7, 12288, v5
    v_add_u32 v7, v7, v4
    v_lshlrev_b32 v8, 1, v5
    v_lshlrev_b32 v5, 2, v6
    s_waitcnt lgkmcnt(0)
    s_mov_b32 s56, s4
    s_and_b32 s57, s5, 0xffff
    s_mov_b32 s58, 0x1400
    s_mov_b32 s59, 0x00020000
    s_mul_i32 s48, s46, 1280
    s_add_u32 s4, s4, s48
    s_addc_u32 s5, s5, 0
    s_mov_b32 s28, s4
    s_and_b32 s29, s5, 0xffff
    s_mov_b32 s30, 0x500
    s_mov_b32 s31, 0x00020000
    s_mul_i32 s48, s45, 384
    s_add_u32 s12, s12, s48
    s_addc_u32 s13, s13, 0
    s_sub_u32 s49, 7864320, s48
    s_mov_b32 s24, s12
    s_and_b32 s25, s13, 0xffff
    s_mov_b32 s26, s49
    s_mov_b32 s27, 0x00020000
    s_add_u32 s8, s8, s41
    s_addc_u32 s9, s9, 0
    s_mov_b32 s16, s8
    s_and_b32 s17, s9, 0xffff
    s_mov_b32 s18, 0x180000
    s_mov_b32 s19, 0x00020000
    s_add_u32 s10, s10, s41
    s_addc_u32 s11, s11, 0
    s_mov_b32 s20, s10
    s_and_b32 s21, s11, 0xffff
    s_mov_b32 s22, 0x180000
    s_mov_b32 s23, 0x00020000
    s_mov_b32 s32, s6
    s_and_b32 s33, s7, 0xffff
    s_mov_b32 s34, 0x80000
    s_mov_b32 s35, 0x00020000
    s_mov_b32 s36, s90
    s_and_b32 s37, s91, 0xffff
    s_mov_b32 s38, 0x100
    s_mov_b32 s39, 0x00020000
    s_mov_b32 s60, s14
    s_and_b32 s61, s15, 0xffff
    s_mov_b32 s62, 0x780000
    s_mov_b32 s63, 0x00020000
    s_mov_b32 s64, s82
    s_and_b32 s65, s83, 0xffff
    s_mov_b32 s66, 0x1e0000
    s_mov_b32 s67, 0x00020000
    s_mov_b32 s92, s84
    s_and_b32 s93, s85, 0xffff
    s_mov_b32 s94, 0x1e0000
    s_mov_b32 s95, 0x00020000
    s_mov_b32 s68, s86
    s_and_b32 s69, s87, 0xffff
    s_mov_b32 s70, 0x1e0000
    s_mov_b32 s71, 0x00020000
    s_mov_b32 s72, s80
    s_and_b32 s73, s81, 0xffff
    s_mov_b32 s74, 0x500
    s_mov_b32 s75, 0x00020000
    s_mov_b32 s76, s88
    s_and_b32 s77, s89, 0xffff
    s_mov_b32 s78, 0x1400
    s_mov_b32 s79, 0x00020000
    s_mul_i32 s48, s2, 6554
    s_lshr_b32 s54, s48, 16
    s_mul_i32 s48, s54, 10
    s_sub_u32 s55, s2, s48
    s_mov_b32 s98, 0
    s_cmp_lt_u32 s2, 80
    s_cbranch_scc1 L_role_1
    s_mov_b32 s98, 1
    s_sub_u32 s55, s2, 80
    s_cmp_ge_u32 s55, 24
    s_cselect_b32 s54, 1, 0
    s_mul_i32 s48, s54, 24
    s_sub_u32 s55, s55, s48
    s_cmp_lt_u32 s2, 128
    s_cbranch_scc1 L_role_1
    s_mov_b32 s98, 2
    s_sub_u32 s55, s2, 128
    s_cmp_lt_u32 s2, 148
    s_cbranch_scc1 L_role_1
    s_mov_b32 s98, 3
L_role_1:
    v_mov_b32 v2, -1
    v_lshlrev_b32 v3, 2, v0
    v_cmp_gt_u32 vcc, 200, v0
    s_and_saveexec_b64 s[100:101], vcc
    s_cbranch_execz L_clr1
    s_mul_i32 s48, s40, 800
    buffer_store_dword v2, v3, s[32:35], s48 offen sc0 sc1
    v_cmp_eq_u32 vcc, 0, v0
    s_and_b64 exec, exec, vcc
    s_cbranch_execz L_clr1
    s_lshl_b32 s48, s2, 7
    s_add_u32 s48, s48, 458752
    buffer_store_dword v2, v3, s[32:35], s48 offen sc0 sc1
L_clr1:
    s_mov_b64 exec, s[100:101]
    s_cmp_ge_u32 s98, 2
    s_cbranch_scc1 L_clr3
    s_cmp_eq_u32 s98, 1
    s_cbranch_scc1 L_clr_d
    v_cmp_gt_u32 vcc, 256, v0
    s_and_saveexec_b64 s[100:101], vcc
    s_cbranch_execz L_clr2
    v_lshrrev_b32 v3, 6, v0
    v_mul_u32_u24 v3, 2560, v3
    v_and_b32 v4, 63, v0
    v_lshl_add_u32 v3, v4, 2, v3
    s_mul_i32 s48, s54, 10240
    s_lshl_b32 s49, s55, 8
    s_add_u32 s48, s48, s49
    s_add_u32 s48, s48, 262144
    buffer_store_dword v2, v3, s[32:35], s48 offen sc0 sc1
    v_cmp_eq_u32 vcc, 0, v0
    s_and_b64 exec, exec, vcc
    s_cbranch_execz L_clr2
    s_lshl_b32 s48, s2, 2
    s_add_u32 s48, s48, 454656
    buffer_store_dword v2, v3, s[32:35], s48 offen sc0 sc1
    s_branch L_clr2
L_clr_d:
    v_cmp_gt_u32 vcc, 128, v0
    s_and_saveexec_b64 s[100:101], vcc
    s_cbranch_execz L_clr2
    v_lshrrev_b32 v3, 5, v0
    v_mul_u32_u24 v3, 3072, v3
    v_and_b32 v4, 31, v0
    v_lshl_add_u32 v3, v4, 2, v3
    s_mul_i32 s48, s54, 16384
    s_lshl_b32 s49, s55, 7
    s_add_u32 s48, s48, s49
    s_add_u32 s48, s48, 360448
    buffer_store_dword v2, v3, s[32:35], s48 offen sc0 sc1
L_clr2:
    s_mov_b64 exec, s[100:101]
L_clr3:
    v_mov_b32 v3, 12928
    v_mov_b32 v4, 16
    ds_write_b32 v3, v4
    buffer_load_dword v46, v5, s[28:31], 0 offen offset:0
    buffer_load_dword v47, v5, s[28:31], 0 offen offset:256
    buffer_load_dword v48, v5, s[28:31], 0 offen offset:512
    buffer_load_dword v49, v5, s[28:31], 0 offen offset:768
    buffer_load_dword v50, v5, s[28:31], 0 offen offset:1024
    buffer_load_ushort v51, v8, s[28:31], 0 offen offset:0
    buffer_load_ushort v52, v8, s[28:31], 0 offen offset:16
    buffer_load_ushort v53, v8, s[28:31], 0 offen offset:32
    buffer_load_ushort v126, v8, s[28:31], 0 offen offset:48
    buffer_load_ushort v127, v8, s[28:31], 0 offen offset:64
    s_mov_b32 s48, 0
    buffer_load_dwordx4 v[102:105], v7, s[24:27], s48 offen offset:0 nt
    buffer_load_dwordx4 v[106:109], v7, s[24:27], s48 offen offset:128 nt
    buffer_load_dwordx4 v[110:113], v7, s[24:27], s48 offen offset:256 nt
    s_mov_b32 s48, 98304
    buffer_load_dwordx4 v[114:117], v7, s[24:27], s48 offen offset:0 nt
    buffer_load_dwordx4 v[118:121], v7, s[24:27], s48 offen offset:128 nt
    buffer_load_dwordx4 v[122:125], v7, s[24:27], s48 offen offset:256 nt
    s_mov_b32 s48, 196608
    buffer_load_dwordx4 v[10:13], v7, s[24:27], s48 offen offset:0 nt
    buffer_load_dwordx4 v[14:17], v7, s[24:27], s48 offen offset:128 nt
    buffer_load_dwordx4 v[18:21], v7, s[24:27], s48 offen offset:256 nt
    s_mov_b32 s48, 294912
    buffer_load_dwordx4 v[22:25], v7, s[24:27], s48 offen offset:0 nt
    buffer_load_dwordx4 v[26:29], v7, s[24:27], s48 offen offset:128 nt
    buffer_load_dwordx4 v[30:33], v7, s[24:27], s48 offen offset:256 nt
    s_mov_b32 s48, 393216
    buffer_load_dwordx4 v[34:37], v7, s[24:27], s48 offen offset:0 nt
    buffer_load_dwordx4 v[38:41], v7, s[24:27], s48 offen offset:128 nt
    buffer_load_dwordx4 v[42:45], v7, s[24:27], s48 offen offset:256 nt
    s_mul_i32 s41, s53, 24576
    s_barrier
    s_add_u32 s48, s41, 0
    buffer_load_dwordx4 v[78:81], v1, s[16:19], s48 offen offset:0 nt
    buffer_load_dwordx4 v[82:85], v1, s[16:19], s48 offen offset:128 nt
    buffer_load_dwordx4 v[86:89], v1, s[16:19], s48 offen offset:256 nt
    s_add_u32 s48, s41, 3072
    buffer_load_dwordx4 v[90:93], v1, s[16:19], s48 offen offset:0 nt
    buffer_load_dwordx4 v[94:97], v1, s[16:19], s48 offen offset:128 nt
    buffer_load_dwordx4 v[98:101], v1, s[16:19], s48 offen offset:256 nt
    s_waitcnt vmcnt(26)
    v_lshlrev_b32 v54, 16, v46
    v_and_b32 v55, 0xffff0000, v46
    v_lshlrev_b32 v56, 16, v47
    v_and_b32 v57, 0xffff0000, v47
    v_lshlrev_b32 v58, 16, v48
    v_and_b32 v59, 0xffff0000, v48
    v_lshlrev_b32 v60, 16, v49
    v_and_b32 v61, 0xffff0000, v49
    v_lshlrev_b32 v62, 16, v50
    v_and_b32 v63, 0xffff0000, v50
    v_add_f32 v2, v54, v55
    v_add_f32 v2, v2, v56
    v_add_f32 v2, v2, v57
    v_add_f32 v2, v2, v58
    v_add_f32 v2, v2, v59
    v_add_f32 v2, v2, v60
    v_add_f32 v2, v2, v61
    v_add_f32 v2, v2, v62
    v_add_f32 v2, v2, v63
    s_nop 1
    v_add_f32_dpp v2, v2, v2 quad_perm:[1,0,3,2] row_mask:0xf bank_mask:0xf
    s_nop 1
    v_add_f32_dpp v2, v2, v2 quad_perm:[2,3,0,1] row_mask:0xf bank_mask:0xf
    s_nop 1
    v_add_f32_dpp v2, v2, v2 row_half_mirror row_mask:0xf bank_mask:0xf
    s_nop 1
    v_add_f32_dpp v2, v2, v2 row_mirror row_mask:0xf bank_mask:0xf
    s_nop 1
    v_readlane_b32 s48, v2, 0
    v_readlane_b32 s49, v2, 16
    v_readlane_b32 s50, v2, 32
    v_readlane_b32 s51, v2, 48
    s_nop 1
    v_mov_b32 v2, s48
    v_add_f32 v2, s49, v2
    v_add_f32 v2, s50, v2
    v_add_f32 v2, s51, v2
    v_mul_f32 v2, 0x3acccccd, v2
    v_sub_f32 v4, v54, v2
    v_mul_f32 v3, v4, v4
    v_sub_f32 v4, v55, v2
    v_fmac_f32 v3, v4, v4
    v_sub_f32 v4, v56, v2
    v_fmac_f32 v3, v4, v4
    v_sub_f32 v4, v57, v2
    v_fmac_f32 v3, v4, v4
    v_sub_f32 v4, v58, v2
    v_fmac_f32 v3, v4, v4
    v_sub_f32 v4, v59, v2
    v_fmac_f32 v3, v4, v4
    v_sub_f32 v4, v60, v2
    v_fmac_f32 v3, v4, v4
    v_sub_f32 v4, v61, v2
    v_fmac_f32 v3, v4, v4
    v_sub_f32 v4, v62, v2
    v_fmac_f32 v3, v4, v4
    v_sub_f32 v4, v63, v2
    v_fmac_f32 v3, v4, v4
    s_nop 1
    v_add_f32_dpp v3, v3, v3 quad_perm:[1,0,3,2] row_mask:0xf bank_mask:0xf
    s_nop 1
    v_add_f32_dpp v3, v3, v3 quad_perm:[2,3,0,1] row_mask:0xf bank_mask:0xf
    s_nop 1
    v_add_f32_dpp v3, v3, v3 row_half_mirror row_mask:0xf bank_mask:0xf
    s_nop 1
    v_add_f32_dpp v3, v3, v3 row_mirror row_mask:0xf bank_mask:0xf
    s_nop 1
    v_readlane_b32 s48, v3, 0
    v_readlane_b32 s49, v3, 16
    v_readlane_b32 s50, v3, 32
    v_readlane_b32 s51, v3, 48
    s_nop 1
    v_mov_b32 v3, s48
    v_add_f32 v3, s49, v3
    v_add_f32 v3, s50, v3
    v_add_f32 v3, s51, v3
    v_mul_f32 v3, 0x3acccccd, v3
    v_cvt_pk_bf16_f32 v2, v2, v2
    v_lshlrev_b32 v2, 16, v2
    v_cvt_pk_bf16_f32 v3, v3, v3
    v_lshlrev_b32 v3, 16, v3
    v_add_f32 v3, 0x3727c5ac, v3
    v_cvt_pk_bf16_f32 v3, v3, v3
    v_lshlrev_b32 v3, 16, v3
    v_sqrt_f32 v3, v3
    s_nop 0
    v_cvt_pk_bf16_f32 v3, v3, v3
    v_lshlrev_b32 v3, 16, v3
    v_rcp_f32 v3, v3
    s_waitcnt vmcnt(21)
    v_lshlrev_b32 v51, 16, v51
    v_sub_f32 v51, v51, v2
    v_cvt_pk_bf16_f32 v51, v51, v51
    v_lshlrev_b32 v51, 16, v51
    v_mul_f32 v51, v51, v3
    v_cvt_pk_bf16_f32 v51, v51, v51
    v_lshlrev_b32 v51, 16, v51
    v_lshlrev_b32 v52, 16, v52
    v_sub_f32 v52, v52, v2
    v_cvt_pk_bf16_f32 v52, v52, v52
    v_lshlrev_b32 v52, 16, v52
    v_mul_f32 v52, v52, v3
    v_cvt_pk_bf16_f32 v52, v52, v52
    v_lshlrev_b32 v52, 16, v52
    v_lshlrev_b32 v53, 16, v53
    v_sub_f32 v53, v53, v2
    v_cvt_pk_bf16_f32 v53, v53, v53
    v_lshlrev_b32 v53, 16, v53
    v_mul_f32 v53, v53, v3
    v_cvt_pk_bf16_f32 v53, v53, v53
    v_lshlrev_b32 v53, 16, v53
    v_lshlrev_b32 v126, 16, v126
    v_sub_f32 v126, v126, v2
    v_cvt_pk_bf16_f32 v126, v126, v126
    v_lshlrev_b32 v126, 16, v126
    v_mul_f32 v126, v126, v3
    v_cvt_pk_bf16_f32 v126, v126, v126
    v_lshlrev_b32 v126, 16, v126
    v_lshlrev_b32 v127, 16, v127
    v_sub_f32 v127, v127, v2
    v_cvt_pk_bf16_f32 v127, v127, v127
    v_lshlrev_b32 v127, 16, v127
    v_mul_f32 v127, v127, v3
    v_cvt_pk_bf16_f32 v127, v127, v127
    v_lshlrev_b32 v127, 16, v127
    s_waitcnt vmcnt(18)
    v_lshlrev_b32 v2, 16, v102
    v_and_b32 v3, 0xffff0000, v102
    v_mul_f32 v54, v51, v2
    v_mul_f32 v55, v51, v3
    v_lshlrev_b32 v2, 16, v103
    v_and_b32 v3, 0xffff0000, v103
    v_mul_f32 v56, v51, v2
    v_mul_f32 v57, v51, v3
    v_lshlrev_b32 v2, 16, v104
    v_and_b32 v3, 0xffff0000, v104
    v_mul_f32 v58, v51, v2
    v_mul_f32 v59, v51, v3
    v_lshlrev_b32 v2, 16, v105
    v_and_b32 v3, 0xffff0000, v105
    v_mul_f32 v60, v51, v2
    v_mul_f32 v61, v51, v3
    v_lshlrev_b32 v2, 16, v106
    v_and_b32 v3, 0xffff0000, v106
    v_mul_f32 v62, v51, v2
    v_mul_f32 v63, v51, v3
    v_lshlrev_b32 v2, 16, v107
    v_and_b32 v3, 0xffff0000, v107
    v_mul_f32 v64, v51, v2
    v_mul_f32 v65, v51, v3
    v_lshlrev_b32 v2, 16, v108
    v_and_b32 v3, 0xffff0000, v108
    v_mul_f32 v66, v51, v2
    v_mul_f32 v67, v51, v3
    v_lshlrev_b32 v2, 16, v109
    v_and_b32 v3, 0xffff0000, v109
    v_mul_f32 v68, v51, v2
    v_mul_f32 v69, v51, v3
    v_lshlrev_b32 v2, 16, v110
    v_and_b32 v3, 0xffff0000, v110
    v_mul_f32 v70, v51, v2
    v_mul_f32 v71, v51, v3
    v_lshlrev_b32 v2, 16, v111
    v_and_b32 v3, 0xffff0000, v111
    v_mul_f32 v72, v51, v2
    v_mul_f32 v73, v51, v3
    v_lshlrev_b32 v2, 16, v112
    v_and_b32 v3, 0xffff0000, v112
    v_mul_f32 v74, v51, v2
    v_mul_f32 v75, v51, v3
    v_lshlrev_b32 v2, 16, v113
    v_and_b32 v3, 0xffff0000, v113
    v_mul_f32 v76, v51, v2
    v_mul_f32 v77, v51, v3
    s_add_u32 s48, s41, 6144
    buffer_load_dwordx4 v[102:105], v1, s[16:19], s48 offen offset:0 nt
    buffer_load_dwordx4 v[106:109], v1, s[16:19], s48 offen offset:128 nt
    buffer_load_dwordx4 v[110:113], v1, s[16:19], s48 offen offset:256 nt
    s_waitcnt vmcnt(18)
    v_lshlrev_b32 v2, 16, v114
    v_and_b32 v3, 0xffff0000, v114
    v_fmac_f32 v54, v52, v2
    v_fmac_f32 v55, v52, v3
    v_lshlrev_b32 v2, 16, v115
    v_and_b32 v3, 0xffff0000, v115
    v_fmac_f32 v56, v52, v2
    v_fmac_f32 v57, v52, v3
    v_lshlrev_b32 v2, 16, v116
    v_and_b32 v3, 0xffff0000, v116
    v_fmac_f32 v58, v52, v2
    v_fmac_f32 v59, v52, v3
    v_lshlrev_b32 v2, 16, v117
    v_and_b32 v3, 0xffff0000, v117
    v_fmac_f32 v60, v52, v2
    v_fmac_f32 v61, v52, v3
    v_lshlrev_b32 v2, 16, v118
    v_and_b32 v3, 0xffff0000, v118
    v_fmac_f32 v62, v52, v2
    v_fmac_f32 v63, v52, v3
    v_lshlrev_b32 v2, 16, v119
    v_and_b32 v3, 0xffff0000, v119
    v_fmac_f32 v64, v52, v2
    v_fmac_f32 v65, v52, v3
    v_lshlrev_b32 v2, 16, v120
    v_and_b32 v3, 0xffff0000, v120
    v_fmac_f32 v66, v52, v2
    v_fmac_f32 v67, v52, v3
    v_lshlrev_b32 v2, 16, v121
    v_and_b32 v3, 0xffff0000, v121
    v_fmac_f32 v68, v52, v2
    v_fmac_f32 v69, v52, v3
    v_lshlrev_b32 v2, 16, v122
    v_and_b32 v3, 0xffff0000, v122
    v_fmac_f32 v70, v52, v2
    v_fmac_f32 v71, v52, v3
    v_lshlrev_b32 v2, 16, v123
    v_and_b32 v3, 0xffff0000, v123
    v_fmac_f32 v72, v52, v2
    v_fmac_f32 v73, v52, v3
    v_lshlrev_b32 v2, 16, v124
    v_and_b32 v3, 0xffff0000, v124
    v_fmac_f32 v74, v52, v2
    v_fmac_f32 v75, v52, v3
    v_lshlrev_b32 v2, 16, v125
    v_and_b32 v3, 0xffff0000, v125
    v_fmac_f32 v76, v52, v2
    v_fmac_f32 v77, v52, v3
    s_add_u32 s48, s41, 9216
    buffer_load_dwordx4 v[114:117], v1, s[16:19], s48 offen offset:0 nt
    buffer_load_dwordx4 v[118:121], v1, s[16:19], s48 offen offset:128 nt
    buffer_load_dwordx4 v[122:125], v1, s[16:19], s48 offen offset:256 nt
    s_waitcnt vmcnt(18)
    v_lshlrev_b32 v2, 16, v10
    v_and_b32 v3, 0xffff0000, v10
    v_fmac_f32 v54, v53, v2
    v_fmac_f32 v55, v53, v3
    v_lshlrev_b32 v2, 16, v11
    v_and_b32 v3, 0xffff0000, v11
    v_fmac_f32 v56, v53, v2
    v_fmac_f32 v57, v53, v3
    v_lshlrev_b32 v2, 16, v12
    v_and_b32 v3, 0xffff0000, v12
    v_fmac_f32 v58, v53, v2
    v_fmac_f32 v59, v53, v3
    v_lshlrev_b32 v2, 16, v13
    v_and_b32 v3, 0xffff0000, v13
    v_fmac_f32 v60, v53, v2
    v_fmac_f32 v61, v53, v3
    v_lshlrev_b32 v2, 16, v14
    v_and_b32 v3, 0xffff0000, v14
    v_fmac_f32 v62, v53, v2
    v_fmac_f32 v63, v53, v3
    v_lshlrev_b32 v2, 16, v15
    v_and_b32 v3, 0xffff0000, v15
    v_fmac_f32 v64, v53, v2
    v_fmac_f32 v65, v53, v3
    v_lshlrev_b32 v2, 16, v16
    v_and_b32 v3, 0xffff0000, v16
    v_fmac_f32 v66, v53, v2
    v_fmac_f32 v67, v53, v3
    v_lshlrev_b32 v2, 16, v17
    v_and_b32 v3, 0xffff0000, v17
    v_fmac_f32 v68, v53, v2
    v_fmac_f32 v69, v53, v3
    v_lshlrev_b32 v2, 16, v18
    v_and_b32 v3, 0xffff0000, v18
    v_fmac_f32 v70, v53, v2
    v_fmac_f32 v71, v53, v3
    v_lshlrev_b32 v2, 16, v19
    v_and_b32 v3, 0xffff0000, v19
    v_fmac_f32 v72, v53, v2
    v_fmac_f32 v73, v53, v3
    v_lshlrev_b32 v2, 16, v20
    v_and_b32 v3, 0xffff0000, v20
    v_fmac_f32 v74, v53, v2
    v_fmac_f32 v75, v53, v3
    v_lshlrev_b32 v2, 16, v21
    v_and_b32 v3, 0xffff0000, v21
    v_fmac_f32 v76, v53, v2
    v_fmac_f32 v77, v53, v3
    s_waitcnt vmcnt(15)
    v_lshlrev_b32 v2, 16, v22
    v_and_b32 v3, 0xffff0000, v22
    v_fmac_f32 v54, v126, v2
    v_fmac_f32 v55, v126, v3
    v_lshlrev_b32 v2, 16, v23
    v_and_b32 v3, 0xffff0000, v23
    v_fmac_f32 v56, v126, v2
    v_fmac_f32 v57, v126, v3
    v_lshlrev_b32 v2, 16, v24
    v_and_b32 v3, 0xffff0000, v24
    v_fmac_f32 v58, v126, v2
    v_fmac_f32 v59, v126, v3
    v_lshlrev_b32 v2, 16, v25
    v_and_b32 v3, 0xffff0000, v25
    v_fmac_f32 v60, v126, v2
    v_fmac_f32 v61, v126, v3
    v_lshlrev_b32 v2, 16, v26
    v_and_b32 v3, 0xffff0000, v26
    v_fmac_f32 v62, v126, v2
    v_fmac_f32 v63, v126, v3
    v_lshlrev_b32 v2, 16, v27
    v_and_b32 v3, 0xffff0000, v27
    v_fmac_f32 v64, v126, v2
    v_fmac_f32 v65, v126, v3
    v_lshlrev_b32 v2, 16, v28
    v_and_b32 v3, 0xffff0000, v28
    v_fmac_f32 v66, v126, v2
    v_fmac_f32 v67, v126, v3
    v_lshlrev_b32 v2, 16, v29
    v_and_b32 v3, 0xffff0000, v29
    v_fmac_f32 v68, v126, v2
    v_fmac_f32 v69, v126, v3
    v_lshlrev_b32 v2, 16, v30
    v_and_b32 v3, 0xffff0000, v30
    v_fmac_f32 v70, v126, v2
    v_fmac_f32 v71, v126, v3
    v_lshlrev_b32 v2, 16, v31
    v_and_b32 v3, 0xffff0000, v31
    v_fmac_f32 v72, v126, v2
    v_fmac_f32 v73, v126, v3
    v_lshlrev_b32 v2, 16, v32
    v_and_b32 v3, 0xffff0000, v32
    v_fmac_f32 v74, v126, v2
    v_fmac_f32 v75, v126, v3
    v_lshlrev_b32 v2, 16, v33
    v_and_b32 v3, 0xffff0000, v33
    v_fmac_f32 v76, v126, v2
    v_fmac_f32 v77, v126, v3
    s_waitcnt vmcnt(12)
    v_lshlrev_b32 v2, 16, v34
    v_and_b32 v3, 0xffff0000, v34
    v_fmac_f32 v54, v127, v2
    v_fmac_f32 v55, v127, v3
    v_lshlrev_b32 v2, 16, v35
    v_and_b32 v3, 0xffff0000, v35
    v_fmac_f32 v56, v127, v2
    v_fmac_f32 v57, v127, v3
    v_lshlrev_b32 v2, 16, v36
    v_and_b32 v3, 0xffff0000, v36
    v_fmac_f32 v58, v127, v2
    v_fmac_f32 v59, v127, v3
    v_lshlrev_b32 v2, 16, v37
    v_and_b32 v3, 0xffff0000, v37
    v_fmac_f32 v60, v127, v2
    v_fmac_f32 v61, v127, v3
    v_lshlrev_b32 v2, 16, v38
    v_and_b32 v3, 0xffff0000, v38
    v_fmac_f32 v62, v127, v2
    v_fmac_f32 v63, v127, v3
    v_lshlrev_b32 v2, 16, v39
    v_and_b32 v3, 0xffff0000, v39
    v_fmac_f32 v64, v127, v2
    v_fmac_f32 v65, v127, v3
    v_lshlrev_b32 v2, 16, v40
    v_and_b32 v3, 0xffff0000, v40
    v_fmac_f32 v66, v127, v2
    v_fmac_f32 v67, v127, v3
    v_lshlrev_b32 v2, 16, v41
    v_and_b32 v3, 0xffff0000, v41
    v_fmac_f32 v68, v127, v2
    v_fmac_f32 v69, v127, v3
    v_lshlrev_b32 v2, 16, v42
    v_and_b32 v3, 0xffff0000, v42
    v_fmac_f32 v70, v127, v2
    v_fmac_f32 v71, v127, v3
    v_lshlrev_b32 v2, 16, v43
    v_and_b32 v3, 0xffff0000, v43
    v_fmac_f32 v72, v127, v2
    v_fmac_f32 v73, v127, v3
    v_lshlrev_b32 v2, 16, v44
    v_and_b32 v3, 0xffff0000, v44
    v_fmac_f32 v74, v127, v2
    v_fmac_f32 v75, v127, v3
    v_lshlrev_b32 v2, 16, v45
    v_and_b32 v3, 0xffff0000, v45
    v_fmac_f32 v76, v127, v2
    v_fmac_f32 v77, v127, v3
    s_nop 1
    v_permlane32_swap_b32 v54, v58
    v_permlane32_swap_b32 v55, v59
    v_permlane32_swap_b32 v56, v60
    v_permlane32_swap_b32 v57, v61
    v_permlane32_swap_b32 v62, v66
    v_permlane32_swap_b32 v63, v67
    v_permlane32_swap_b32 v64, v68
    v_permlane32_swap_b32 v65, v69
    v_permlane32_swap_b32 v70, v74
    v_permlane32_swap_b32 v71, v75
    v_permlane32_swap_b32 v72, v76
    v_permlane32_swap_b32 v73, v77
    v_add_f32 v54, v54, v58
    v_add_f32 v55, v55, v59
    v_add_f32 v56, v56, v60
    v_add_f32 v57, v57, v61
    v_add_f32 v62, v62, v66
    v_add_f32 v63, v63, v67
    v_add_f32 v64, v64, v68
    v_add_f32 v65, v65, v69
    v_add_f32 v70, v70, v74
    v_add_f32 v71, v71, v75
    v_add_f32 v72, v72, v76
    v_add_f32 v73, v73, v77
    s_nop 1
    v_permlane16_swap_b32 v54, v56
    v_permlane16_swap_b32 v55, v57
    v_permlane16_swap_b32 v62, v64
    v_permlane16_swap_b32 v63, v65
    v_permlane16_swap_b32 v70, v72
    v_permlane16_swap_b32 v71, v73
    v_add_f32 v54, v54, v56
    v_add_f32 v55, v55, v57
    v_add_f32 v62, v62, v64
    v_add_f32 v63, v63, v65
    v_add_f32 v70, v70, v72
    v_add_f32 v71, v71, v73
    s_nop 1
    v_add_f32_dpp v54, v54, v54 row_ror:8 row_mask:0xf bank_mask:0xf
    v_add_f32_dpp v55, v55, v55 row_ror:8 row_mask:0xf bank_mask:0xf
    v_add_f32_dpp v62, v62, v62 row_ror:8 row_mask:0xf bank_mask:0xf
    v_add_f32_dpp v63, v63, v63 row_ror:8 row_mask:0xf bank_mask:0xf
    v_add_f32_dpp v70, v70, v70 row_ror:8 row_mask:0xf bank_mask:0xf
    v_add_f32_dpp v71, v71, v71 row_ror:8 row_mask:0xf bank_mask:0xf
    v_lshrrev_b32 v2, 6, v0
    v_mul_u32_u24 v9, 768, v2
    v_and_b32 v2, 7, v6
    v_lshlrev_b32 v2, 5, v2
    v_add_u32 v9, v9, v2
    v_lshrrev_b32 v2, 5, v6
    v_lshlrev_b32 v2, 4, v2
    v_add_u32 v9, v9, v2
    v_bfe_u32 v2, v6, 4, 1
    v_lshlrev_b32 v2, 3, v2
    v_add_u32 v9, v9, v2
    ds_write_b64 v9, v[54:55] offset:0
    ds_write_b64 v9, v[62:63] offset:256
    ds_write_b64 v9, v[70:71] offset:512
    s_waitcnt lgkmcnt(0)
    s_barrier
    v_cmp_gt_u32 vcc, 192, v0
    s_and_saveexec_b64 s[100:101], vcc
    s_cbranch_execz L_q1
    v_lshlrev_b32 v2, 2, v0
    ds_read_b32 v54, v2 offset:0
    ds_read_b32 v55, v2 offset:768
    ds_read_b32 v56, v2 offset:1536
    ds_read_b32 v57, v2 offset:2304
    ds_read_b32 v58, v2 offset:3072
    ds_read_b32 v59, v2 offset:3840
    ds_read_b32 v60, v2 offset:4608
    ds_read_b32 v61, v2 offset:5376
    ds_read_b32 v62, v2 offset:6144
    ds_read_b32 v63, v2 offset:6912
    ds_read_b32 v64, v2 offset:7680
    ds_read_b32 v65, v2 offset:8448
    ds_read_b32 v66, v2 offset:9216
    ds_read_b32 v67, v2 offset:9984
    ds_read_b32 v68, v2 offset:10752
    ds_read_b32 v69, v2 offset:11520
    s_waitcnt lgkmcnt(0)
    v_add_f32 v54, v54, v55
    v_add_f32 v54, v54, v56
    v_add_f32 v54, v54, v57
    v_add_f32 v54, v54, v58
    v_add_f32 v54, v54, v59
    v_add_f32 v54, v54, v60
    v_add_f32 v54, v54, v61
    v_add_f32 v54, v54, v62
    v_add_f32 v54, v54, v63
    v_add_f32 v54, v54, v64
    v_add_f32 v54, v54, v65
    v_add_f32 v54, v54, v66
    v_add_f32 v54, v54, v67
    v_add_f32 v54, v54, v68
    v_add_f32 v54, v54, v69
    v_cvt_pk_bf16_f32 v54, v54, v54
    v_lshlrev_b32 v2, 1, v0
    ds_write_b16 v2, v54 offset:12288
    s_waitcnt lgkmcnt(0)
L_q1:
    s_mov_b64 exec, s[100:101]
    s_barrier
    v_and_b32 v2, 7, v6
    v_lshlrev_b32 v2, 4, v2
    ds_read_b128 v[10:13], v2 offset:12288
    ds_read_b128 v[14:17], v2 offset:12416
    ds_read_b128 v[18:21], v2 offset:12544
    s_waitcnt lgkmcnt(0)
    v_mov_b32 v30, 0xff7fffff
    v_mov_b32 v31, 0
    v_mov_b32 v54, 0
    v_mov_b32 v55, 0
    v_mov_b32 v56, 0
    v_mov_b32 v57, 0
    v_mov_b32 v58, 0
    v_mov_b32 v59, 0
    v_mov_b32 v60, 0
    v_mov_b32 v61, 0
    v_mov_b32 v62, 0
    v_mov_b32 v63, 0
    v_mov_b32 v64, 0
    v_mov_b32 v65, 0
    v_mov_b32 v66, 0
    v_mov_b32 v67, 0
    v_mov_b32 v68, 0
    v_mov_b32 v69, 0
    v_mov_b32 v70, 0
    v_mov_b32 v71, 0
    v_mov_b32 v72, 0
    v_mov_b32 v73, 0
    v_mov_b32 v74, 0
    v_mov_b32 v75, 0
    v_mov_b32 v76, 0
    v_mov_b32 v77, 0
    v_mov_b32 v33, 12928
    v_mov_b32 v34, 1
    s_mov_b32 s52, 0x3fb8aa3b
L_loop:
    s_mov_b64 exec, 1
    ds_add_rtn_u32 v32, v33, v34
    s_mov_b64 exec, -1
    s_waitcnt vmcnt(9)
    v_dot2_f32_bf16 v2, v78, v10, 0
    v_dot2_f32_bf16 v3, v82, v14, 0
    v_dot2_f32_bf16 v4, v86, v18, 0
    v_dot2_f32_bf16 v2, v79, v11, v2
    v_dot2_f32_bf16 v3, v83, v15, v3
    v_dot2_f32_bf16 v4, v87, v19, v4
    v_dot2_f32_bf16 v2, v80, v12, v2
    v_dot2_f32_bf16 v3, v84, v16, v3
    v_dot2_f32_bf16 v4, v88, v20, v4
    v_dot2_f32_bf16 v2, v81, v13, v2
    v_dot2_f32_bf16 v3, v85, v17, v3
    v_dot2_f32_bf16 v4, v89, v21, v4
    s_add_u32 s48, s41, 12288
    buffer_load_dwordx4 v[78:81], v1, s[16:19], s48 offen offset:0 nt
    buffer_load_dwordx4 v[82:85], v1, s[16:19], s48 offen offset:128 nt
    buffer_load_dwordx4 v[86:89], v1, s[16:19], s48 offen offset:256 nt
    v_add_f32 v2, v2, v3
    v_add_f32 v2, v2, v4
    s_nop 1
    v_add_f32_dpp v2, v2, v2 quad_perm:[1,0,3,2] row_mask:0xf bank_mask:0xf
    s_nop 1
    v_add_f32_dpp v2, v2, v2 quad_perm:[2,3,0,1] row_mask:0xf bank_mask:0xf
    s_nop 1
    v_add_f32_dpp v2, v2, v2 row_half_mirror row_mask:0xf bank_mask:0xf
    v_cvt_pk_bf16_f32 v2, v2, v2
    v_lshlrev_b32 v2, 16, v2
    v_mul_f32 v2, 0x3d93cd3a, v2
    v_cvt_pk_bf16_f32 v2, v2, v2
    v_lshlrev_b32 v22, 16, v2
    s_waitcnt vmcnt(9)
    v_dot2_f32_bf16 v2, v90, v10, 0
    v_dot2_f32_bf16 v3, v94, v14, 0
    v_dot2_f32_bf16 v4, v98, v18, 0
    v_dot2_f32_bf16 v2, v91, v11, v2
    v_dot2_f32_bf16 v3, v95, v15, v3
    v_dot2_f32_bf16 v4, v99, v19, v4
    v_dot2_f32_bf16 v2, v92, v12, v2
    v_dot2_f32_bf16 v3, v96, v16, v3
    v_dot2_f32_bf16 v4, v100, v20, v4
    v_dot2_f32_bf16 v2, v93, v13, v2
    v_dot2_f32_bf16 v3, v97, v17, v3
    v_dot2_f32_bf16 v4, v101, v21, v4
    s_add_u32 s48, s41, 15360
    buffer_load_dwordx4 v[90:93], v1, s[16:19], s48 offen offset:0 nt
    buffer_load_dwordx4 v[94:97], v1, s[16:19], s48 offen offset:128 nt
    buffer_load_dwordx4 v[98:101], v1, s[16:19], s48 offen offset:256 nt
    v_add_f32 v2, v2, v3
    v_add_f32 v2, v2, v4
    s_nop 1
    v_add_f32_dpp v2, v2, v2 quad_perm:[1,0,3,2] row_mask:0xf bank_mask:0xf
    s_nop 1
    v_add_f32_dpp v2, v2, v2 quad_perm:[2,3,0,1] row_mask:0xf bank_mask:0xf
    s_nop 1
    v_add_f32_dpp v2, v2, v2 row_half_mirror row_mask:0xf bank_mask:0xf
    v_cvt_pk_bf16_f32 v2, v2, v2
    v_lshlrev_b32 v2, 16, v2
    v_mul_f32 v2, 0x3d93cd3a, v2
    v_cvt_pk_bf16_f32 v2, v2, v2
    v_lshlrev_b32 v23, 16, v2
    s_waitcnt vmcnt(9)
    v_dot2_f32_bf16 v2, v102, v10, 0
    v_dot2_f32_bf16 v3, v106, v14, 0
    v_dot2_f32_bf16 v4, v110, v18, 0
    v_dot2_f32_bf16 v2, v103, v11, v2
    v_dot2_f32_bf16 v3, v107, v15, v3
    v_dot2_f32_bf16 v4, v111, v19, v4
    v_dot2_f32_bf16 v2, v104, v12, v2
    v_dot2_f32_bf16 v3, v108, v16, v3
    v_dot2_f32_bf16 v4, v112, v20, v4
    v_dot2_f32_bf16 v2, v105, v13, v2
    v_dot2_f32_bf16 v3, v109, v17, v3
    v_dot2_f32_bf16 v4, v113, v21, v4
    s_add_u32 s48, s41, 18432
    buffer_load_dwordx4 v[102:105], v1, s[16:19], s48 offen offset:0 nt
    buffer_load_dwordx4 v[106:109], v1, s[16:19], s48 offen offset:128 nt
    buffer_load_dwordx4 v[110:113], v1, s[16:19], s48 offen offset:256 nt
    v_add_f32 v2, v2, v3
    v_add_f32 v2, v2, v4
    s_nop 1
    v_add_f32_dpp v2, v2, v2 quad_perm:[1,0,3,2] row_mask:0xf bank_mask:0xf
    s_nop 1
    v_add_f32_dpp v2, v2, v2 quad_perm:[2,3,0,1] row_mask:0xf bank_mask:0xf
    s_nop 1
    v_add_f32_dpp v2, v2, v2 row_half_mirror row_mask:0xf bank_mask:0xf
    v_cvt_pk_bf16_f32 v2, v2, v2
    v_lshlrev_b32 v2, 16, v2
    v_mul_f32 v2, 0x3d93cd3a, v2
    v_cvt_pk_bf16_f32 v2, v2, v2
    v_lshlrev_b32 v24, 16, v2
    s_waitcnt lgkmcnt(0)
    v_readfirstlane_b32 s49, v32
    s_mul_i32 s47, s49, 24576
    s_waitcnt vmcnt(9)
    v_dot2_f32_bf16 v2, v114, v10, 0
    v_dot2_f32_bf16 v3, v118, v14, 0
    v_dot2_f32_bf16 v4, v122, v18, 0
    v_dot2_f32_bf16 v2, v115, v11, v2
    v_dot2_f32_bf16 v3, v119, v15, v3
    v_dot2_f32_bf16 v4, v123, v19, v4
    v_dot2_f32_bf16 v2, v116, v12, v2
    v_dot2_f32_bf16 v3, v120, v16, v3
    v_dot2_f32_bf16 v4, v124, v20, v4
    v_dot2_f32_bf16 v2, v117, v13, v2
    v_dot2_f32_bf16 v3, v121, v17, v3
    v_dot2_f32_bf16 v4, v125, v21, v4
    s_add_u32 s48, s41, 21504
    buffer_load_dwordx4 v[114:117], v1, s[16:19], s48 offen offset:0 nt
    buffer_load_dwordx4 v[118:121], v1, s[16:19], s48 offen offset:128 nt
    buffer_load_dwordx4 v[122:125], v1, s[16:19], s48 offen offset:256 nt
    v_add_f32 v2, v2, v3
    v_add_f32 v2, v2, v4
    s_nop 1
    v_add_f32_dpp v2, v2, v2 quad_perm:[1,0,3,2] row_mask:0xf bank_mask:0xf
    s_nop 1
    v_add_f32_dpp v2, v2, v2 quad_perm:[2,3,0,1] row_mask:0xf bank_mask:0xf
    s_nop 1
    v_add_f32_dpp v2, v2, v2 row_half_mirror row_mask:0xf bank_mask:0xf
    v_cvt_pk_bf16_f32 v2, v2, v2
    v_lshlrev_b32 v2, 16, v2
    v_mul_f32 v2, 0x3d93cd3a, v2
    v_cvt_pk_bf16_f32 v2, v2, v2
    v_lshlrev_b32 v25, 16, v2
    s_waitcnt vmcnt(9)
    v_dot2_f32_bf16 v2, v78, v10, 0
    v_dot2_f32_bf16 v3, v82, v14, 0
    v_dot2_f32_bf16 v4, v86, v18, 0
    v_dot2_f32_bf16 v2, v79, v11, v2
    v_dot2_f32_bf16 v3, v83, v15, v3
    v_dot2_f32_bf16 v4, v87, v19, v4
    v_dot2_f32_bf16 v2, v80, v12, v2
    v_dot2_f32_bf16 v3, v84, v16, v3
    v_dot2_f32_bf16 v4, v88, v20, v4
    v_dot2_f32_bf16 v2, v81, v13, v2
    v_dot2_f32_bf16 v3, v85, v17, v3
    v_dot2_f32_bf16 v4, v89, v21, v4
    s_add_u32 s48, s41, 0
    buffer_load_dwordx4 v[78:81], v1, s[20:23], s48 offen offset:0 nt
    buffer_load_dwordx4 v[82:85], v1, s[20:23], s48 offen offset:128 nt
    buffer_load_dwordx4 v[86:89], v1, s[20:23], s48 offen offset:256 nt
    v_add_f32 v2, v2, v3
    v_add_f32 v2, v2, v4
    s_nop 1
    v_add_f32_dpp v2, v2, v2 quad_perm:[1,0,3,2] row_mask:0xf bank_mask:0xf
    s_nop 1
    v_add_f32_dpp v2, v2, v2 quad_perm:[2,3,0,1] row_mask:0xf bank_mask:0xf
    s_nop 1
    v_add_f32_dpp v2, v2, v2 row_half_mirror row_mask:0xf bank_mask:0xf
    v_cvt_pk_bf16_f32 v2, v2, v2
    v_lshlrev_b32 v2, 16, v2
    v_mul_f32 v2, 0x3d93cd3a, v2
    v_cvt_pk_bf16_f32 v2, v2, v2
    v_lshlrev_b32 v26, 16, v2
    s_waitcnt vmcnt(9)
    v_dot2_f32_bf16 v2, v90, v10, 0
    v_dot2_f32_bf16 v3, v94, v14, 0
    v_dot2_f32_bf16 v4, v98, v18, 0
    v_dot2_f32_bf16 v2, v91, v11, v2
    v_dot2_f32_bf16 v3, v95, v15, v3
    v_dot2_f32_bf16 v4, v99, v19, v4
    v_dot2_f32_bf16 v2, v92, v12, v2
    v_dot2_f32_bf16 v3, v96, v16, v3
    v_dot2_f32_bf16 v4, v100, v20, v4
    v_dot2_f32_bf16 v2, v93, v13, v2
    v_dot2_f32_bf16 v3, v97, v17, v3
    v_dot2_f32_bf16 v4, v101, v21, v4
    s_add_u32 s48, s41, 3072
    buffer_load_dwordx4 v[90:93], v1, s[20:23], s48 offen offset:0 nt
    buffer_load_dwordx4 v[94:97], v1, s[20:23], s48 offen offset:128 nt
    buffer_load_dwordx4 v[98:101], v1, s[20:23], s48 offen offset:256 nt
    v_add_f32 v2, v2, v3
    v_add_f32 v2, v2, v4
    s_nop 1
    v_add_f32_dpp v2, v2, v2 quad_perm:[1,0,3,2] row_mask:0xf bank_mask:0xf
    s_nop 1
    v_add_f32_dpp v2, v2, v2 quad_perm:[2,3,0,1] row_mask:0xf bank_mask:0xf
    s_nop 1
    v_add_f32_dpp v2, v2, v2 row_half_mirror row_mask:0xf bank_mask:0xf
    v_cvt_pk_bf16_f32 v2, v2, v2
    v_lshlrev_b32 v2, 16, v2
    v_mul_f32 v2, 0x3d93cd3a, v2
    v_cvt_pk_bf16_f32 v2, v2, v2
    v_lshlrev_b32 v27, 16, v2
    s_waitcnt vmcnt(9)
    v_dot2_f32_bf16 v2, v102, v10, 0
    v_dot2_f32_bf16 v3, v106, v14, 0
    v_dot2_f32_bf16 v4, v110, v18, 0
    v_dot2_f32_bf16 v2, v103, v11, v2
    v_dot2_f32_bf16 v3, v107, v15, v3
    v_dot2_f32_bf16 v4, v111, v19, v4
    v_dot2_f32_bf16 v2, v104, v12, v2
    v_dot2_f32_bf16 v3, v108, v16, v3
    v_dot2_f32_bf16 v4, v112, v20, v4
    v_dot2_f32_bf16 v2, v105, v13, v2
    v_dot2_f32_bf16 v3, v109, v17, v3
    v_dot2_f32_bf16 v4, v113, v21, v4
    s_add_u32 s48, s41, 6144
    buffer_load_dwordx4 v[102:105], v1, s[20:23], s48 offen offset:0 nt
    buffer_load_dwordx4 v[106:109], v1, s[20:23], s48 offen offset:128 nt
    buffer_load_dwordx4 v[110:113], v1, s[20:23], s48 offen offset:256 nt
    v_add_f32 v2, v2, v3
    v_add_f32 v2, v2, v4
    s_nop 1
    v_add_f32_dpp v2, v2, v2 quad_perm:[1,0,3,2] row_mask:0xf bank_mask:0xf
    s_nop 1
    v_add_f32_dpp v2, v2, v2 quad_perm:[2,3,0,1] row_mask:0xf bank_mask:0xf
    s_nop 1
    v_add_f32_dpp v2, v2, v2 row_half_mirror row_mask:0xf bank_mask:0xf
    v_cvt_pk_bf16_f32 v2, v2, v2
    v_lshlrev_b32 v2, 16, v2
    v_mul_f32 v2, 0x3d93cd3a, v2
    v_cvt_pk_bf16_f32 v2, v2, v2
    v_lshlrev_b32 v28, 16, v2
    s_waitcnt vmcnt(9)
    v_dot2_f32_bf16 v2, v114, v10, 0
    v_dot2_f32_bf16 v3, v118, v14, 0
    v_dot2_f32_bf16 v4, v122, v18, 0
    v_dot2_f32_bf16 v2, v115, v11, v2
    v_dot2_f32_bf16 v3, v119, v15, v3
    v_dot2_f32_bf16 v4, v123, v19, v4
    v_dot2_f32_bf16 v2, v116, v12, v2
    v_dot2_f32_bf16 v3, v120, v16, v3
    v_dot2_f32_bf16 v4, v124, v20, v4
    v_dot2_f32_bf16 v2, v117, v13, v2
    v_dot2_f32_bf16 v3, v121, v17, v3
    v_dot2_f32_bf16 v4, v125, v21, v4
    s_add_u32 s48, s41, 9216
    buffer_load_dwordx4 v[114:117], v1, s[20:23], s48 offen offset:0 nt
    buffer_load_dwordx4 v[118:121], v1, s[20:23], s48 offen offset:128 nt
    buffer_load_dwordx4 v[122:125], v1, s[20:23], s48 offen offset:256 nt
    v_add_f32 v2, v2, v3
    v_add_f32 v2, v2, v4
    s_nop 1
    v_add_f32_dpp v2, v2, v2 quad_perm:[1,0,3,2] row_mask:0xf bank_mask:0xf
    s_nop 1
    v_add_f32_dpp v2, v2, v2 quad_perm:[2,3,0,1] row_mask:0xf bank_mask:0xf
    s_nop 1
    v_add_f32_dpp v2, v2, v2 row_half_mirror row_mask:0xf bank_mask:0xf
    v_cvt_pk_bf16_f32 v2, v2, v2
    v_lshlrev_b32 v2, 16, v2
    v_mul_f32 v2, 0x3d93cd3a, v2
    v_cvt_pk_bf16_f32 v2, v2, v2
    v_lshlrev_b32 v29, 16, v2
    v_max3_f32 v2, v22, v23, v24
    v_max3_f32 v2, v2, v25, v26
    v_max3_f32 v2, v2, v27, v28
    v_max_f32 v2, v2, v29
    s_nop 1
    v_max_f32_dpp v2, v2, v2 row_ror:8 row_mask:0xf bank_mask:0xf
    s_nop 1
    v_readlane_b32 s48, v2, 0
    v_readlane_b32 s49, v2, 16
    v_readlane_b32 s50, v2, 32
    v_readlane_b32 s51, v2, 48
    s_nop 1
    v_mov_b32 v2, s48
    v_max_f32 v2, s49, v2
    v_max_f32 v2, s50, v2
    v_max_f32 v2, s51, v2
    v_max_f32 v2, v2, v30
    v_sub_f32 v3, v30, v2
    v_mul_f32 v3, s52, v3
    v_exp_f32 v3, v3
    v_mov_b32 v30, v2
    v_mul_f32 v4, s52, v2
    v_fma_f32 v22, v22, s52, -v4
    v_exp_f32 v22, v22
    v_fma_f32 v23, v23, s52, -v4
    v_exp_f32 v23, v23
    v_fma_f32 v24, v24, s52, -v4
    v_exp_f32 v24, v24
    v_fma_f32 v25, v25, s52, -v4
    v_exp_f32 v25, v25
    v_fma_f32 v26, v26, s52, -v4
    v_exp_f32 v26, v26
    v_fma_f32 v27, v27, s52, -v4
    v_exp_f32 v27, v27
    v_fma_f32 v28, v28, s52, -v4
    v_exp_f32 v28, v28
    v_fma_f32 v29, v29, s52, -v4
    v_exp_f32 v29, v29
    v_mul_f32 v31, v31, v3
    v_mul_f32 v54, v54, v3
    v_mul_f32 v55, v55, v3
    v_mul_f32 v56, v56, v3
    v_mul_f32 v57, v57, v3
    v_mul_f32 v58, v58, v3
    v_mul_f32 v59, v59, v3
    v_mul_f32 v60, v60, v3
    v_mul_f32 v61, v61, v3
    v_mul_f32 v62, v62, v3
    v_mul_f32 v63, v63, v3
    v_mul_f32 v64, v64, v3
    v_mul_f32 v65, v65, v3
    v_mul_f32 v66, v66, v3
    v_mul_f32 v67, v67, v3
    v_mul_f32 v68, v68, v3
    v_mul_f32 v69, v69, v3
    v_mul_f32 v70, v70, v3
    v_mul_f32 v71, v71, v3
    v_mul_f32 v72, v72, v3
    v_mul_f32 v73, v73, v3
    v_mul_f32 v74, v74, v3
    v_mul_f32 v75, v75, v3
    v_mul_f32 v76, v76, v3
    v_mul_f32 v77, v77, v3
    v_add_f32 v31, v31, v22
    v_add_f32 v31, v31, v23
    v_add_f32 v31, v31, v24
    v_add_f32 v31, v31, v25
    v_add_f32 v31, v31, v26
    v_add_f32 v31, v31, v27
    v_add_f32 v31, v31, v28
    v_add_f32 v31, v31, v29
    s_waitcnt vmcnt(9)
    v_lshlrev_b32 v4, 16, v78
    v_and_b32 v5, 0xffff0000, v78
    v_fmac_f32 v54, v22, v4
    v_fmac_f32 v55, v22, v5
    v_lshlrev_b32 v4, 16, v79
    v_and_b32 v5, 0xffff0000, v79
    v_fmac_f32 v56, v22, v4
    v_fmac_f32 v57, v22, v5
    v_lshlrev_b32 v4, 16, v80
    v_and_b32 v5, 0xffff0000, v80
    v_fmac_f32 v58, v22, v4
    v_fmac_f32 v59, v22, v5
    v_lshlrev_b32 v4, 16, v81
    v_and_b32 v5, 0xffff0000, v81
    v_fmac_f32 v60, v22, v4
    v_fmac_f32 v61, v22, v5
    v_lshlrev_b32 v4, 16, v82
    v_and_b32 v5, 0xffff0000, v82
    v_fmac_f32 v62, v22, v4
    v_fmac_f32 v63, v22, v5
    v_lshlrev_b32 v4, 16, v83
    v_and_b32 v5, 0xffff0000, v83
    v_fmac_f32 v64, v22, v4
    v_fmac_f32 v65, v22, v5
    v_lshlrev_b32 v4, 16, v84
    v_and_b32 v5, 0xffff0000, v84
    v_fmac_f32 v66, v22, v4
    v_fmac_f32 v67, v22, v5
    v_lshlrev_b32 v4, 16, v85
    v_and_b32 v5, 0xffff0000, v85
    v_fmac_f32 v68, v22, v4
    v_fmac_f32 v69, v22, v5
    v_lshlrev_b32 v4, 16, v86
    v_and_b32 v5, 0xffff0000, v86
    v_fmac_f32 v70, v22, v4
    v_fmac_f32 v71, v22, v5
    v_lshlrev_b32 v4, 16, v87
    v_and_b32 v5, 0xffff0000, v87
    v_fmac_f32 v72, v22, v4
    v_fmac_f32 v73, v22, v5
    v_lshlrev_b32 v4, 16, v88
    v_and_b32 v5, 0xffff0000, v88
    v_fmac_f32 v74, v22, v4
    v_fmac_f32 v75, v22, v5
    v_lshlrev_b32 v4, 16, v89
    v_and_b32 v5, 0xffff0000, v89
    v_fmac_f32 v76, v22, v4
    v_fmac_f32 v77, v22, v5
    s_add_u32 s48, s41, 12288
    buffer_load_dwordx4 v[78:81], v1, s[20:23], s48 offen offset:0 nt
    buffer_load_dwordx4 v[82:85], v1, s[20:23], s48 offen offset:128 nt
    buffer_load_dwordx4 v[86:89], v1, s[20:23], s48 offen offset:256 nt
    s_waitcnt vmcnt(9)
    v_lshlrev_b32 v4, 16, v90
    v_and_b32 v5, 0xffff0000, v90
    v_fmac_f32 v54, v23, v4
    v_fmac_f32 v55, v23, v5
    v_lshlrev_b32 v4, 16, v91
    v_and_b32 v5, 0xffff0000, v91
    v_fmac_f32 v56, v23, v4
    v_fmac_f32 v57, v23, v5
    v_lshlrev_b32 v4, 16, v92
    v_and_b32 v5, 0xffff0000, v92
    v_fmac_f32 v58, v23, v4
    v_fmac_f32 v59, v23, v5
    v_lshlrev_b32 v4, 16, v93
    v_and_b32 v5, 0xffff0000, v93
    v_fmac_f32 v60, v23, v4
    v_fmac_f32 v61, v23, v5
    v_lshlrev_b32 v4, 16, v94
    v_and_b32 v5, 0xffff0000, v94
    v_fmac_f32 v62, v23, v4
    v_fmac_f32 v63, v23, v5
    v_lshlrev_b32 v4, 16, v95
    v_and_b32 v5, 0xffff0000, v95
    v_fmac_f32 v64, v23, v4
    v_fmac_f32 v65, v23, v5
    v_lshlrev_b32 v4, 16, v96
    v_and_b32 v5, 0xffff0000, v96
    v_fmac_f32 v66, v23, v4
    v_fmac_f32 v67, v23, v5
    v_lshlrev_b32 v4, 16, v97
    v_and_b32 v5, 0xffff0000, v97
    v_fmac_f32 v68, v23, v4
    v_fmac_f32 v69, v23, v5
    v_lshlrev_b32 v4, 16, v98
    v_and_b32 v5, 0xffff0000, v98
    v_fmac_f32 v70, v23, v4
    v_fmac_f32 v71, v23, v5
    v_lshlrev_b32 v4, 16, v99
    v_and_b32 v5, 0xffff0000, v99
    v_fmac_f32 v72, v23, v4
    v_fmac_f32 v73, v23, v5
    v_lshlrev_b32 v4, 16, v100
    v_and_b32 v5, 0xffff0000, v100
    v_fmac_f32 v74, v23, v4
    v_fmac_f32 v75, v23, v5
    v_lshlrev_b32 v4, 16, v101
    v_and_b32 v5, 0xffff0000, v101
    v_fmac_f32 v76, v23, v4
    v_fmac_f32 v77, v23, v5
    s_add_u32 s48, s41, 15360
    buffer_load_dwordx4 v[90:93], v1, s[20:23], s48 offen offset:0 nt
    buffer_load_dwordx4 v[94:97], v1, s[20:23], s48 offen offset:128 nt
    buffer_load_dwordx4 v[98:101], v1, s[20:23], s48 offen offset:256 nt
    s_waitcnt vmcnt(9)
    v_lshlrev_b32 v4, 16, v102
    v_and_b32 v5, 0xffff0000, v102
    v_fmac_f32 v54, v24, v4
    v_fmac_f32 v55, v24, v5
    v_lshlrev_b32 v4, 16, v103
    v_and_b32 v5, 0xffff0000, v103
    v_fmac_f32 v56, v24, v4
    v_fmac_f32 v57, v24, v5
    v_lshlrev_b32 v4, 16, v104
    v_and_b32 v5, 0xffff0000, v104
    v_fmac_f32 v58, v24, v4
    v_fmac_f32 v59, v24, v5
    v_lshlrev_b32 v4, 16, v105
    v_and_b32 v5, 0xffff0000, v105
    v_fmac_f32 v60, v24, v4
    v_fmac_f32 v61, v24, v5
    v_lshlrev_b32 v4, 16, v106
    v_and_b32 v5, 0xffff0000, v106
    v_fmac_f32 v62, v24, v4
    v_fmac_f32 v63, v24, v5
    v_lshlrev_b32 v4, 16, v107
    v_and_b32 v5, 0xffff0000, v107
    v_fmac_f32 v64, v24, v4
    v_fmac_f32 v65, v24, v5
    v_lshlrev_b32 v4, 16, v108
    v_and_b32 v5, 0xffff0000, v108
    v_fmac_f32 v66, v24, v4
    v_fmac_f32 v67, v24, v5
    v_lshlrev_b32 v4, 16, v109
    v_and_b32 v5, 0xffff0000, v109
    v_fmac_f32 v68, v24, v4
    v_fmac_f32 v69, v24, v5
    v_lshlrev_b32 v4, 16, v110
    v_and_b32 v5, 0xffff0000, v110
    v_fmac_f32 v70, v24, v4
    v_fmac_f32 v71, v24, v5
    v_lshlrev_b32 v4, 16, v111
    v_and_b32 v5, 0xffff0000, v111
    v_fmac_f32 v72, v24, v4
    v_fmac_f32 v73, v24, v5
    v_lshlrev_b32 v4, 16, v112
    v_and_b32 v5, 0xffff0000, v112
    v_fmac_f32 v74, v24, v4
    v_fmac_f32 v75, v24, v5
    v_lshlrev_b32 v4, 16, v113
    v_and_b32 v5, 0xffff0000, v113
    v_fmac_f32 v76, v24, v4
    v_fmac_f32 v77, v24, v5
    s_add_u32 s48, s41, 18432
    buffer_load_dwordx4 v[102:105], v1, s[20:23], s48 offen offset:0 nt
    buffer_load_dwordx4 v[106:109], v1, s[20:23], s48 offen offset:128 nt
    buffer_load_dwordx4 v[110:113], v1, s[20:23], s48 offen offset:256 nt
    s_waitcnt vmcnt(9)
    v_lshlrev_b32 v4, 16, v114
    v_and_b32 v5, 0xffff0000, v114
    v_fmac_f32 v54, v25, v4
    v_fmac_f32 v55, v25, v5
    v_lshlrev_b32 v4, 16, v115
    v_and_b32 v5, 0xffff0000, v115
    v_fmac_f32 v56, v25, v4
    v_fmac_f32 v57, v25, v5
    v_lshlrev_b32 v4, 16, v116
    v_and_b32 v5, 0xffff0000, v116
    v_fmac_f32 v58, v25, v4
    v_fmac_f32 v59, v25, v5
    v_lshlrev_b32 v4, 16, v117
    v_and_b32 v5, 0xffff0000, v117
    v_fmac_f32 v60, v25, v4
    v_fmac_f32 v61, v25, v5
    v_lshlrev_b32 v4, 16, v118
    v_and_b32 v5, 0xffff0000, v118
    v_fmac_f32 v62, v25, v4
    v_fmac_f32 v63, v25, v5
    v_lshlrev_b32 v4, 16, v119
    v_and_b32 v5, 0xffff0000, v119
    v_fmac_f32 v64, v25, v4
    v_fmac_f32 v65, v25, v5
    v_lshlrev_b32 v4, 16, v120
    v_and_b32 v5, 0xffff0000, v120
    v_fmac_f32 v66, v25, v4
    v_fmac_f32 v67, v25, v5
    v_lshlrev_b32 v4, 16, v121
    v_and_b32 v5, 0xffff0000, v121
    v_fmac_f32 v68, v25, v4
    v_fmac_f32 v69, v25, v5
    v_lshlrev_b32 v4, 16, v122
    v_and_b32 v5, 0xffff0000, v122
    v_fmac_f32 v70, v25, v4
    v_fmac_f32 v71, v25, v5
    v_lshlrev_b32 v4, 16, v123
    v_and_b32 v5, 0xffff0000, v123
    v_fmac_f32 v72, v25, v4
    v_fmac_f32 v73, v25, v5
    v_lshlrev_b32 v4, 16, v124
    v_and_b32 v5, 0xffff0000, v124
    v_fmac_f32 v74, v25, v4
    v_fmac_f32 v75, v25, v5
    v_lshlrev_b32 v4, 16, v125
    v_and_b32 v5, 0xffff0000, v125
    v_fmac_f32 v76, v25, v4
    v_fmac_f32 v77, v25, v5
    s_add_u32 s48, s41, 21504
    buffer_load_dwordx4 v[114:117], v1, s[20:23], s48 offen offset:0 nt
    buffer_load_dwordx4 v[118:121], v1, s[20:23], s48 offen offset:128 nt
    buffer_load_dwordx4 v[122:125], v1, s[20:23], s48 offen offset:256 nt
    s_waitcnt vmcnt(9)
    v_lshlrev_b32 v4, 16, v78
    v_and_b32 v5, 0xffff0000, v78
    v_fmac_f32 v54, v26, v4
    v_fmac_f32 v55, v26, v5
    v_lshlrev_b32 v4, 16, v79
    v_and_b32 v5, 0xffff0000, v79
    v_fmac_f32 v56, v26, v4
    v_fmac_f32 v57, v26, v5
    v_lshlrev_b32 v4, 16, v80
    v_and_b32 v5, 0xffff0000, v80
    v_fmac_f32 v58, v26, v4
    v_fmac_f32 v59, v26, v5
    v_lshlrev_b32 v4, 16, v81
    v_and_b32 v5, 0xffff0000, v81
    v_fmac_f32 v60, v26, v4
    v_fmac_f32 v61, v26, v5
    v_lshlrev_b32 v4, 16, v82
    v_and_b32 v5, 0xffff0000, v82
    v_fmac_f32 v62, v26, v4
    v_fmac_f32 v63, v26, v5
    v_lshlrev_b32 v4, 16, v83
    v_and_b32 v5, 0xffff0000, v83
    v_fmac_f32 v64, v26, v4
    v_fmac_f32 v65, v26, v5
    v_lshlrev_b32 v4, 16, v84
    v_and_b32 v5, 0xffff0000, v84
    v_fmac_f32 v66, v26, v4
    v_fmac_f32 v67, v26, v5
    v_lshlrev_b32 v4, 16, v85
    v_and_b32 v5, 0xffff0000, v85
    v_fmac_f32 v68, v26, v4
    v_fmac_f32 v69, v26, v5
    v_lshlrev_b32 v4, 16, v86
    v_and_b32 v5, 0xffff0000, v86
    v_fmac_f32 v70, v26, v4
    v_fmac_f32 v71, v26, v5
    v_lshlrev_b32 v4, 16, v87
    v_and_b32 v5, 0xffff0000, v87
    v_fmac_f32 v72, v26, v4
    v_fmac_f32 v73, v26, v5
    v_lshlrev_b32 v4, 16, v88
    v_and_b32 v5, 0xffff0000, v88
    v_fmac_f32 v74, v26, v4
    v_fmac_f32 v75, v26, v5
    v_lshlrev_b32 v4, 16, v89
    v_and_b32 v5, 0xffff0000, v89
    v_fmac_f32 v76, v26, v4
    v_fmac_f32 v77, v26, v5
    s_add_u32 s48, s47, 0
    buffer_load_dwordx4 v[78:81], v1, s[16:19], s48 offen offset:0 nt
    buffer_load_dwordx4 v[82:85], v1, s[16:19], s48 offen offset:128 nt
    buffer_load_dwordx4 v[86:89], v1, s[16:19], s48 offen offset:256 nt
    s_waitcnt vmcnt(9)
    v_lshlrev_b32 v4, 16, v90
    v_and_b32 v5, 0xffff0000, v90
    v_fmac_f32 v54, v27, v4
    v_fmac_f32 v55, v27, v5
    v_lshlrev_b32 v4, 16, v91
    v_and_b32 v5, 0xffff0000, v91
    v_fmac_f32 v56, v27, v4
    v_fmac_f32 v57, v27, v5
    v_lshlrev_b32 v4, 16, v92
    v_and_b32 v5, 0xffff0000, v92
    v_fmac_f32 v58, v27, v4
    v_fmac_f32 v59, v27, v5
    v_lshlrev_b32 v4, 16, v93
    v_and_b32 v5, 0xffff0000, v93
    v_fmac_f32 v60, v27, v4
    v_fmac_f32 v61, v27, v5
    v_lshlrev_b32 v4, 16, v94
    v_and_b32 v5, 0xffff0000, v94
    v_fmac_f32 v62, v27, v4
    v_fmac_f32 v63, v27, v5
    v_lshlrev_b32 v4, 16, v95
    v_and_b32 v5, 0xffff0000, v95
    v_fmac_f32 v64, v27, v4
    v_fmac_f32 v65, v27, v5
    v_lshlrev_b32 v4, 16, v96
    v_and_b32 v5, 0xffff0000, v96
    v_fmac_f32 v66, v27, v4
    v_fmac_f32 v67, v27, v5
    v_lshlrev_b32 v4, 16, v97
    v_and_b32 v5, 0xffff0000, v97
    v_fmac_f32 v68, v27, v4
    v_fmac_f32 v69, v27, v5
    v_lshlrev_b32 v4, 16, v98
    v_and_b32 v5, 0xffff0000, v98
    v_fmac_f32 v70, v27, v4
    v_fmac_f32 v71, v27, v5
    v_lshlrev_b32 v4, 16, v99
    v_and_b32 v5, 0xffff0000, v99
    v_fmac_f32 v72, v27, v4
    v_fmac_f32 v73, v27, v5
    v_lshlrev_b32 v4, 16, v100
    v_and_b32 v5, 0xffff0000, v100
    v_fmac_f32 v74, v27, v4
    v_fmac_f32 v75, v27, v5
    v_lshlrev_b32 v4, 16, v101
    v_and_b32 v5, 0xffff0000, v101
    v_fmac_f32 v76, v27, v4
    v_fmac_f32 v77, v27, v5
    s_add_u32 s48, s47, 3072
    buffer_load_dwordx4 v[90:93], v1, s[16:19], s48 offen offset:0 nt
    buffer_load_dwordx4 v[94:97], v1, s[16:19], s48 offen offset:128 nt
    buffer_load_dwordx4 v[98:101], v1, s[16:19], s48 offen offset:256 nt
    s_waitcnt vmcnt(9)
    v_lshlrev_b32 v4, 16, v102
    v_and_b32 v5, 0xffff0000, v102
    v_fmac_f32 v54, v28, v4
    v_fmac_f32 v55, v28, v5
    v_lshlrev_b32 v4, 16, v103
    v_and_b32 v5, 0xffff0000, v103
    v_fmac_f32 v56, v28, v4
    v_fmac_f32 v57, v28, v5
    v_lshlrev_b32 v4, 16, v104
    v_and_b32 v5, 0xffff0000, v104
    v_fmac_f32 v58, v28, v4
    v_fmac_f32 v59, v28, v5
    v_lshlrev_b32 v4, 16, v105
    v_and_b32 v5, 0xffff0000, v105
    v_fmac_f32 v60, v28, v4
    v_fmac_f32 v61, v28, v5
    v_lshlrev_b32 v4, 16, v106
    v_and_b32 v5, 0xffff0000, v106
    v_fmac_f32 v62, v28, v4
    v_fmac_f32 v63, v28, v5
    v_lshlrev_b32 v4, 16, v107
    v_and_b32 v5, 0xffff0000, v107
    v_fmac_f32 v64, v28, v4
    v_fmac_f32 v65, v28, v5
    v_lshlrev_b32 v4, 16, v108
    v_and_b32 v5, 0xffff0000, v108
    v_fmac_f32 v66, v28, v4
    v_fmac_f32 v67, v28, v5
    v_lshlrev_b32 v4, 16, v109
    v_and_b32 v5, 0xffff0000, v109
    v_fmac_f32 v68, v28, v4
    v_fmac_f32 v69, v28, v5
    v_lshlrev_b32 v4, 16, v110
    v_and_b32 v5, 0xffff0000, v110
    v_fmac_f32 v70, v28, v4
    v_fmac_f32 v71, v28, v5
    v_lshlrev_b32 v4, 16, v111
    v_and_b32 v5, 0xffff0000, v111
    v_fmac_f32 v72, v28, v4
    v_fmac_f32 v73, v28, v5
    v_lshlrev_b32 v4, 16, v112
    v_and_b32 v5, 0xffff0000, v112
    v_fmac_f32 v74, v28, v4
    v_fmac_f32 v75, v28, v5
    v_lshlrev_b32 v4, 16, v113
    v_and_b32 v5, 0xffff0000, v113
    v_fmac_f32 v76, v28, v4
    v_fmac_f32 v77, v28, v5
    s_add_u32 s48, s47, 6144
    buffer_load_dwordx4 v[102:105], v1, s[16:19], s48 offen offset:0 nt
    buffer_load_dwordx4 v[106:109], v1, s[16:19], s48 offen offset:128 nt
    buffer_load_dwordx4 v[110:113], v1, s[16:19], s48 offen offset:256 nt
    s_waitcnt vmcnt(9)
    v_lshlrev_b32 v4, 16, v114
    v_and_b32 v5, 0xffff0000, v114
    v_fmac_f32 v54, v29, v4
    v_fmac_f32 v55, v29, v5
    v_lshlrev_b32 v4, 16, v115
    v_and_b32 v5, 0xffff0000, v115
    v_fmac_f32 v56, v29, v4
    v_fmac_f32 v57, v29, v5
    v_lshlrev_b32 v4, 16, v116
    v_and_b32 v5, 0xffff0000, v116
    v_fmac_f32 v58, v29, v4
    v_fmac_f32 v59, v29, v5
    v_lshlrev_b32 v4, 16, v117
    v_and_b32 v5, 0xffff0000, v117
    v_fmac_f32 v60, v29, v4
    v_fmac_f32 v61, v29, v5
    v_lshlrev_b32 v4, 16, v118
    v_and_b32 v5, 0xffff0000, v118
    v_fmac_f32 v62, v29, v4
    v_fmac_f32 v63, v29, v5
    v_lshlrev_b32 v4, 16, v119
    v_and_b32 v5, 0xffff0000, v119
    v_fmac_f32 v64, v29, v4
    v_fmac_f32 v65, v29, v5
    v_lshlrev_b32 v4, 16, v120
    v_and_b32 v5, 0xffff0000, v120
    v_fmac_f32 v66, v29, v4
    v_fmac_f32 v67, v29, v5
    v_lshlrev_b32 v4, 16, v121
    v_and_b32 v5, 0xffff0000, v121
    v_fmac_f32 v68, v29, v4
    v_fmac_f32 v69, v29, v5
    v_lshlrev_b32 v4, 16, v122
    v_and_b32 v5, 0xffff0000, v122
    v_fmac_f32 v70, v29, v4
    v_fmac_f32 v71, v29, v5
    v_lshlrev_b32 v4, 16, v123
    v_and_b32 v5, 0xffff0000, v123
    v_fmac_f32 v72, v29, v4
    v_fmac_f32 v73, v29, v5
    v_lshlrev_b32 v4, 16, v124
    v_and_b32 v5, 0xffff0000, v124
    v_fmac_f32 v74, v29, v4
    v_fmac_f32 v75, v29, v5
    v_lshlrev_b32 v4, 16, v125
    v_and_b32 v5, 0xffff0000, v125
    v_fmac_f32 v76, v29, v4
    v_fmac_f32 v77, v29, v5
    s_add_u32 s48, s47, 9216
    buffer_load_dwordx4 v[114:117], v1, s[16:19], s48 offen offset:0 nt
    buffer_load_dwordx4 v[118:121], v1, s[16:19], s48 offen offset:128 nt
    buffer_load_dwordx4 v[122:125], v1, s[16:19], s48 offen offset:256 nt
    s_mov_b32 s41, s47
    s_cmp_lt_u32 s41, 1572864
    s_cbranch_scc1 L_loop
    s_waitcnt vmcnt(0)
    v_mov_b32 v2, v30
    v_mov_b32 v3, v31
    s_nop 1
    v_add_f32_dpp v3, v3, v3 quad_perm:[1,0,3,2] row_mask:0xf bank_mask:0xf
    s_nop 1
    v_add_f32_dpp v3, v3, v3 quad_perm:[2,3,0,1] row_mask:0xf bank_mask:0xf
    s_nop 1
    v_add_f32_dpp v3, v3, v3 row_half_mirror row_mask:0xf bank_mask:0xf
    s_nop 1
    v_add_f32_dpp v3, v3, v3 row_mirror row_mask:0xf bank_mask:0xf
    s_nop 1
    v_readlane_b32 s48, v3, 0
    v_readlane_b32 s49, v3, 16
    v_readlane_b32 s50, v3, 32
    v_readlane_b32 s51, v3, 48
    s_nop 1
    v_mov_b32 v3, s48
    v_add_f32 v3, s49, v3
    v_add_f32 v3, s50, v3
    v_add_f32 v3, s51, v3
    v_mul_f32 v3, 0.125, v3
    s_nop 1
    v_permlane32_swap_b32 v54, v58
    v_permlane32_swap_b32 v55, v59
    v_permlane32_swap_b32 v56, v60
    v_permlane32_swap_b32 v57, v61
    v_permlane32_swap_b32 v62, v66
    v_permlane32_swap_b32 v63, v67
    v_permlane32_swap_b32 v64, v68
    v_permlane32_swap_b32 v65, v69
    v_permlane32_swap_b32 v70, v74
    v_permlane32_swap_b32 v71, v75
    v_permlane32_swap_b32 v72, v76
    v_permlane32_swap_b32 v73, v77
    v_add_f32 v54, v54, v58
    v_add_f32 v55, v55, v59
    v_add_f32 v56, v56, v60
    v_add_f32 v57, v57, v61
    v_add_f32 v62, v62, v66
    v_add_f32 v63, v63, v67
    v_add_f32 v64, v64, v68
    v_add_f32 v65, v65, v69
    v_add_f32 v70, v70, v74
    v_add_f32 v71, v71, v75
    v_add_f32 v72, v72, v76
    v_add_f32 v73, v73, v77
    s_nop 1
    v_permlane16_swap_b32 v54, v56
    v_permlane16_swap_b32 v55, v57
    v_permlane16_swap_b32 v62, v64
    v_permlane16_swap_b32 v63, v65
    v_permlane16_swap_b32 v70, v72
    v_permlane16_swap_b32 v71, v73
    v_add_f32 v54, v54, v56
    v_add_f32 v55, v55, v57
    v_add_f32 v62, v62, v64
    v_add_f32 v63, v63, v65
    v_add_f32 v70, v70, v72
    v_add_f32 v71, v71, v73
    s_nop 1
    v_add_f32_dpp v54, v54, v54 row_ror:8 row_mask:0xf bank_mask:0xf
    v_add_f32_dpp v55, v55, v55 row_ror:8 row_mask:0xf bank_mask:0xf
    v_add_f32_dpp v62, v62, v62 row_ror:8 row_mask:0xf bank_mask:0xf
    v_add_f32_dpp v63, v63, v63 row_ror:8 row_mask:0xf bank_mask:0xf
    v_add_f32_dpp v70, v70, v70 row_ror:8 row_mask:0xf bank_mask:0xf
    v_add_f32_dpp v71, v71, v71 row_ror:8 row_mask:0xf bank_mask:0xf
    ds_write_b64 v9, v[54:55] offset:0
    ds_write_b64 v9, v[62:63] offset:256
    ds_write_b64 v9, v[70:71] offset:512
    v_lshrrev_b32 v4, 6, v0
    v_lshlrev_b32 v4, 3, v4
    ds_write_b64 v4, v[2:3] offset:12800
    s_waitcnt lgkmcnt(0)
    s_barrier
    v_cmp_gt_u32 vcc, 192, v0
    s_and_saveexec_b64 s[100:101], vcc
    s_cbranch_execz L_e1
    v_lshlrev_b32 v2, 2, v0
    v_mov_b32 v4, 0
    ds_read_b32 v54, v2 offset:0
    ds_read_b32 v55, v2 offset:768
    ds_read_b32 v56, v2 offset:1536
    ds_read_b32 v57, v2 offset:2304
    ds_read_b32 v58, v2 offset:3072
    ds_read_b32 v59, v2 offset:3840
    ds_read_b32 v60, v2 offset:4608
    ds_read_b32 v61, v2 offset:5376
    ds_read_b32 v62, v2 offset:6144
    ds_read_b32 v63, v2 offset:6912
    ds_read_b32 v64, v2 offset:7680
    ds_read_b32 v65, v2 offset:8448
    ds_read_b32 v66, v2 offset:9216
    ds_read_b32 v67, v2 offset:9984
    ds_read_b32 v68, v2 offset:10752
    ds_read_b32 v69, v2 offset:11520
    ds_read_b128 v[22:25], v4 offset:12800
    ds_read_b128 v[26:29], v4 offset:12816
    ds_read_b128 v[30:33], v4 offset:12832
    ds_read_b128 v[34:37], v4 offset:12848
    ds_read_b128 v[38:41], v4 offset:12864
    ds_read_b128 v[42:45], v4 offset:12880
    ds_read_b128 v[46:49], v4 offset:12896
    ds_read_b128 v[50:53], v4 offset:12912
    s_waitcnt lgkmcnt(0)
    v_max_f32 v3, v22, v24
    v_max_f32 v3, v3, v26
    v_max_f32 v3, v3, v28
    v_max_f32 v3, v3, v30
    v_max_f32 v3, v3, v32
    v_max_f32 v3, v3, v34
    v_max_f32 v3, v3, v36
    v_max_f32 v3, v3, v38
    v_max_f32 v3, v3, v40
    v_max_f32 v3, v3, v42
    v_max_f32 v3, v3, v44
    v_max_f32 v3, v3, v46
    v_max_f32 v3, v3, v48
    v_max_f32 v3, v3, v50
    v_max_f32 v3, v3, v52
    v_sub_f32 v22, v22, v3
    v_mul_f32 v22, 0x3fb8aa3b, v22
    v_exp_f32 v22, v22
    v_sub_f32 v24, v24, v3
    v_mul_f32 v24, 0x3fb8aa3b, v24
    v_exp_f32 v24, v24
    v_sub_f32 v26, v26, v3
    v_mul_f32 v26, 0x3fb8aa3b, v26
    v_exp_f32 v26, v26
    v_sub_f32 v28, v28, v3
    v_mul_f32 v28, 0x3fb8aa3b, v28
    v_exp_f32 v28, v28
    v_sub_f32 v30, v30, v3
    v_mul_f32 v30, 0x3fb8aa3b, v30
    v_exp_f32 v30, v30
    v_sub_f32 v32, v32, v3
    v_mul_f32 v32, 0x3fb8aa3b, v32
    v_exp_f32 v32, v32
    v_sub_f32 v34, v34, v3
    v_mul_f32 v34, 0x3fb8aa3b, v34
    v_exp_f32 v34, v34
    v_sub_f32 v36, v36, v3
    v_mul_f32 v36, 0x3fb8aa3b, v36
    v_exp_f32 v36, v36
    v_sub_f32 v38, v38, v3
    v_mul_f32 v38, 0x3fb8aa3b, v38
    v_exp_f32 v38, v38
    v_sub_f32 v40, v40, v3
    v_mul_f32 v40, 0x3fb8aa3b, v40
    v_exp_f32 v40, v40
    v_sub_f32 v42, v42, v3
    v_mul_f32 v42, 0x3fb8aa3b, v42
    v_exp_f32 v42, v42
    v_sub_f32 v44, v44, v3
    v_mul_f32 v44, 0x3fb8aa3b, v44
    v_exp_f32 v44, v44
    v_sub_f32 v46, v46, v3
    v_mul_f32 v46, 0x3fb8aa3b, v46
    v_exp_f32 v46, v46
    v_sub_f32 v48, v48, v3
    v_mul_f32 v48, 0x3fb8aa3b, v48
    v_exp_f32 v48, v48
    v_sub_f32 v50, v50, v3
    v_mul_f32 v50, 0x3fb8aa3b, v50
    v_exp_f32 v50, v50
    v_sub_f32 v52, v52, v3
    v_mul_f32 v52, 0x3fb8aa3b, v52
    v_exp_f32 v52, v52
    s_nop 0
    v_mul_f32 v4, v22, v54
    v_mul_f32 v5, v22, v23
    v_fmac_f32 v4, v24, v55
    v_fmac_f32 v5, v24, v25
    v_fmac_f32 v4, v26, v56
    v_fmac_f32 v5, v26, v27
    v_fmac_f32 v4, v28, v57
    v_fmac_f32 v5, v28, v29
    v_fmac_f32 v4, v30, v58
    v_fmac_f32 v5, v30, v31
    v_fmac_f32 v4, v32, v59
    v_fmac_f32 v5, v32, v33
    v_fmac_f32 v4, v34, v60
    v_fmac_f32 v5, v34, v35
    v_fmac_f32 v4, v36, v61
    v_fmac_f32 v5, v36, v37
    v_fmac_f32 v4, v38, v62
    v_fmac_f32 v5, v38, v39
    v_fmac_f32 v4, v40, v63
    v_fmac_f32 v5, v40, v41
    v_fmac_f32 v4, v42, v64
    v_fmac_f32 v5, v42, v43
    v_fmac_f32 v4, v44, v65
    v_fmac_f32 v5, v44, v45
    v_fmac_f32 v4, v46, v66
    v_fmac_f32 v5, v46, v47
    v_fmac_f32 v4, v48, v67
    v_fmac_f32 v5, v48, v49
    v_fmac_f32 v4, v50, v68
    v_fmac_f32 v5, v50, v51
    v_fmac_f32 v4, v52, v69
    v_fmac_f32 v5, v52, v53
    s_mul_i32 s48, s40, 800
    buffer_store_dword v4, v2, s[32:35], s48 offen offset:0 sc0 sc1
    v_mov_b32 v2, v3
    v_mov_b32 v3, v5
    v_cmp_eq_u32 vcc, 0, v0
    s_and_b64 exec, exec, vcc
    s_cbranch_execz L_e1
    v_mov_b32 v4, 768
    buffer_store_dwordx2 v[2:3], v4, s[32:35], s48 offen offset:0 sc0 sc1
    v_mov_b32 v4, 0
    v_mov_b32 v5, 1
    buffer_atomic_add v5, v4, s[36:39], 0 offen sc0 sc1
    s_waitcnt vmcnt(0)
    v_mov_b32 v4, 12928
    ds_write_b32 v4, v5
    v_readfirstlane_b32 s48, v5
    s_waitcnt lgkmcnt(0)
    s_mov_b64 exec, s[100:101]
    s_cmp_lg_u32 s48, 255
    s_cbranch_scc1 L_e1
    s_mov_b64 exec, -1
    v_lshlrev_b32 v4, 7, v6
    v_mov_b32 v5, 1
    s_mov_b32 s48, 458752
    buffer_store_dword v5, v4, s[32:35], s48 offen sc0 sc1
    s_mov_b32 s48, 466944
    buffer_store_dword v5, v4, s[32:35], s48 offen sc0 sc1
    s_mov_b32 s48, 475136
    buffer_store_dword v5, v4, s[32:35], s48 offen sc0 sc1
    s_mov_b32 s48, 483328
    buffer_store_dword v5, v4, s[32:35], s48 offen sc0 sc1
L_e1:
    s_mov_b64 exec, s[100:101]
    s_barrier
    v_mov_b32 v12, 12928
    ds_read_b32 v13, v12
    s_waitcnt lgkmcnt(0)
    v_readfirstlane_b32 s97, v13
    s_mul_i32 s48, s97, 6554
    s_lshr_b32 s54, s48, 16
    s_mul_i32 s48, s54, 10
    s_sub_u32 s55, s97, s48
    s_mov_b32 s98, 0
    s_cmp_lt_u32 s97, 80
    s_cbranch_scc1 L_role_2
    s_mov_b32 s98, 1
    s_sub_u32 s55, s97, 80
    s_cmp_ge_u32 s55, 24
    s_cselect_b32 s54, 1, 0
    s_mul_i32 s48, s54, 24
    s_sub_u32 s55, s55, s48
    s_cmp_lt_u32 s97, 128
    s_cbranch_scc1 L_role_2
    s_mov_b32 s98, 2
    s_sub_u32 s55, s97, 128
    s_cmp_lt_u32 s97, 148
    s_cbranch_scc1 L_role_2
    s_mov_b32 s98, 3
L_role_2:
    s_cmp_eq_u32 s54, 1
    s_cselect_b32 s64, s92, s64
    s_cselect_b32 s65, s93, s65
    s_cmp_eq_u32 s98, 3
    s_cbranch_scc1 L_dma_end
    s_cmp_eq_u32 s98, 2
    s_cbranch_scc1 L_dma_e
    v_lshrrev_b32 v126, 3, v6
    v_and_b32 v127, 7, v6
    v_lshlrev_b32 v127, 4, v127
    s_cmp_eq_u32 s98, 1
    s_cbranch_scc1 L_dma_d
    v_mul_u32_u24 v126, 1280, v126
    v_add_u32 v126, v126, v127
    s_mul_i32 s48, s54, 768
    s_mul_i32 s49, s53, 48
    s_add_u32 s48, s48, s49
    s_mul_i32 s48, s48, 1280
    s_lshl_b32 s50, s55, 7
    s_add_u32 s48, s48, s50
    s_lshl_b32 s50, s49, 7
    s_add_u32 s50, s50, 42496
    s_mov_b32 m0, s50
    s_nop 0
    buffer_load_dwordx4 v126, s[60:63], s48 offen nt lds
    s_add_u32 s48, s48, 10240
    s_add_u32 s50, s50, 1024
    s_mov_b32 m0, s50
    s_nop 0
    buffer_load_dwordx4 v126, s[60:63], s48 offen nt lds
    s_add_u32 s48, s48, 10240
    s_add_u32 s50, s50, 1024
    s_mov_b32 m0, s50
    s_nop 0
    buffer_load_dwordx4 v126, s[60:63], s48 offen nt lds
    s_add_u32 s48, s48, 10240
    s_add_u32 s50, s50, 1024
    s_mov_b32 m0, s50
    s_nop 0
    buffer_load_dwordx4 v126, s[60:63], s48 offen nt lds
    s_add_u32 s48, s48, 10240
    s_add_u32 s50, s50, 1024
    s_mov_b32 m0, s50
    s_nop 0
    buffer_load_dwordx4 v126, s[60:63], s48 offen nt lds
    s_add_u32 s48, s48, 10240
    s_add_u32 s50, s50, 1024
    s_mov_b32 m0, s50
    s_nop 0
    buffer_load_dwordx4 v126, s[60:63], s48 offen nt lds
    s_branch L_dma_end
L_dma_d:
    v_mul_u32_u24 v126, 3072, v126
    v_add_u32 v126, v126, v127
    s_mul_i32 s49, s53, 40
    s_mul_i32 s48, s49, 3072
    s_lshl_b32 s50, s55, 7
    s_add_u32 s48, s48, s50
    s_lshl_b32 s50, s49, 7
    s_add_u32 s50, s50, 42496
    s_mov_b32 m0, s50
    s_nop 0
    buffer_load_dwordx4 v126, s[64:67], s48 offen nt lds
    s_add_u32 s48, s48, 24576
    s_add_u32 s50, s50, 1024
    s_mov_b32 m0, s50
    s_nop 0
    buffer_load_dwordx4 v126, s[64:67], s48 offen nt lds
    s_add_u32 s48, s48, 24576
    s_add_u32 s50, s50, 1024
    s_mov_b32 m0, s50
    s_nop 0
    buffer_load_dwordx4 v126, s[64:67], s48 offen nt lds
    s_add_u32 s48, s48, 24576
    s_add_u32 s50, s50, 1024
    s_mov_b32 m0, s50
    s_nop 0
    buffer_load_dwordx4 v126, s[64:67], s48 offen nt lds
    s_add_u32 s48, s48, 24576
    s_add_u32 s50, s50, 1024
    s_mov_b32 m0, s50
    s_nop 0
    buffer_load_dwordx4 v126, s[64:67], s48 offen nt lds
    s_branch L_dma_end
L_dma_e:
    v_lshrrev_b32 v126, 2, v6
    v_and_b32 v127, 3, v6
    v_lshlrev_b32 v127, 4, v127
    v_mul_u32_u24 v126, 1280, v126
    v_add_u32 v126, v126, v127
    s_mul_i32 s49, s53, 96
    s_mul_i32 s48, s49, 1280
    s_lshl_b32 s50, s55, 6
    s_add_u32 s48, s48, s50
    s_lshl_b32 s50, s49, 6
    s_add_u32 s50, s50, 42496
    s_mov_b32 m0, s50
    s_nop 0
    buffer_load_dwordx4 v126, s[68:71], s48 offen nt lds
    s_add_u32 s48, s48, 20480
    s_add_u32 s50, s50, 1024
    s_mov_b32 m0, s50
    s_nop 0
    buffer_load_dwordx4 v126, s[68:71], s48 offen nt lds
    s_add_u32 s48, s48, 20480
    s_add_u32 s50, s50, 1024
    s_mov_b32 m0, s50
    s_nop 0
    buffer_load_dwordx4 v126, s[68:71], s48 offen nt lds
    s_add_u32 s48, s48, 20480
    s_add_u32 s50, s50, 1024
    s_mov_b32 m0, s50
    s_nop 0
    buffer_load_dwordx4 v126, s[68:71], s48 offen nt lds
    s_add_u32 s48, s48, 20480
    s_add_u32 s50, s50, 1024
    s_mov_b32 m0, s50
    s_nop 0
    buffer_load_dwordx4 v126, s[68:71], s48 offen nt lds
    s_add_u32 s48, s48, 20480
    s_add_u32 s50, s50, 1024
    s_mov_b32 m0, s50
    s_nop 0
    buffer_load_dwordx4 v126, s[68:71], s48 offen nt lds
L_dma_end:
    s_cmp_eq_u32 s98, 3
    s_cbranch_scc0 L_tail_go
    s_endpgm
L_tail_go:
    v_lshrrev_b32 v7, 6, v0
    s_cmp_lg_u32 s53, 0
    s_cbranch_scc1 L_gate_done
    s_lshl_b32 s44, s2, 7
    s_add_u32 s44, s44, 458752
    v_mov_b32 v122, 0
    s_mov_b32 s45, 0
    buffer_load_dword v123, v122, s[32:35], s44 offen sc0 sc1
L_gate_3:
    s_sleep 6
    buffer_load_dword v124, v122, s[32:35], s44 offen sc0 sc1
    s_waitcnt vmcnt(1)
    v_cmp_ne_u32 vcc, 1, v123
    s_cbranch_vccz L_gate_3_ok
    s_sleep 6
    buffer_load_dword v123, v122, s[32:35], s44 offen sc0 sc1
    s_waitcnt vmcnt(1)
    v_cmp_ne_u32 vcc, 1, v124
    s_add_u32 s45, s45, 1
    s_cbranch_vccz L_gate_3_ok
    s_cmp_lt_u32 s45, 0x20000
    s_cbranch_scc1 L_gate_3
L_gate_3_ok:
L_gate_done:
    s_cmp_eq_u32 s98, 1
    s_cbranch_scc1 L_tail_d
    s_cmp_eq_u32 s98, 2
    s_cbranch_scc1 L_tail_e
    v_mov_b32 v12, v0
    v_mul_u32_u24 v13, 43691, v12
    v_lshrrev_b32 v13, 24, v13
    v_mul_u32_u24 v14, 384, v13
    v_sub_u32 v12, v12, v14
    v_mul_u32_u24 v14, 43691, v12
    v_lshrrev_b32 v14, 22, v14
    v_mul_u32_u24 v40, 51200, v13
    v_mul_u32_u24 v15, 832, v14
    v_add_u32 v40, v40, v15
    v_lshl_add_u32 v40, v12, 3, v40
    v_lshlrev_b32 v43, 5, v14
    v_lshl_add_u32 v43, v13, 3, v43
    v_mul_u32_u24 v46, 3136, v13
    v_lshl_add_u32 v46, v12, 2, v46
    v_and_b32 v12, 511, v0
    v_add_u32 v12, 1024, v12
    v_mul_u32_u24 v13, 43691, v12
    v_lshrrev_b32 v13, 24, v13
    v_mul_u32_u24 v14, 384, v13
    v_sub_u32 v12, v12, v14
    v_mul_u32_u24 v14, 43691, v12
    v_lshrrev_b32 v14, 22, v14
    v_mul_u32_u24 v41, 51200, v13
    v_mul_u32_u24 v15, 832, v14
    v_add_u32 v41, v41, v15
    v_lshl_add_u32 v41, v12, 3, v41
    v_lshlrev_b32 v44, 5, v14
    v_lshl_add_u32 v44, v13, 3, v44
    v_mul_u32_u24 v47, 3136, v13
    v_lshl_add_u32 v47, v12, 2, v47
    v_and_b32 v12, 3, v6
    v_mul_u32_u24 v8, 3136, v12
    v_lshlrev_b32 v9, 3, v12
    v_lshrrev_b32 v12, 4, v6
    v_lshl_add_u32 v8, v12, 4, v8
    v_mul_u32_u24 v12, 1024, v12
    v_add_u32 v9, v9, v12
    v_bfe_u32 v12, v6, 2, 2
    v_mul_u32_u24 v12, 128, v12
    v_add_u32 v9, v9, v12
    s_mul_i32 s46, s54, 6400
    s_add_u32 s46, s46, 0
    s_barrier
    s_cmp_lg_u32 s53, 0
    s_cbranch_scc1 L_c_noml
    v_bfe_u32 v12, v6, 3, 2
    v_mul_u32_u24 v12, 51200, v12
    v_and_b32 v13, 7, v6
    v_mul_u32_u24 v13, 800, v13
    v_add_u32 v12, v12, v13
    s_mov_b32 s45, 0
    buffer_load_dwordx2 v[80:81], v40, s[32:35], s46 offen offset:0 sc0 sc1
    buffer_load_dwordx2 v[82:83], v40, s[32:35], s46 offen offset:800 sc0 sc1
    buffer_load_dwordx2 v[84:85], v41, s[32:35], s46 offen offset:0 sc0 sc1
    buffer_load_dwordx2 v[86:87], v41, s[32:35], s46 offen offset:800 sc0 sc1
    buffer_load_dwordx2 v[88:89], v12, s[32:35], s46 offen offset:768 sc0 sc1
L_pl_4:
    buffer_load_dwordx2 v[96:97], v40, s[32:35], s46 offen offset:0 sc0 sc1
    buffer_load_dwordx2 v[98:99], v40, s[32:35], s46 offen offset:800 sc0 sc1
    buffer_load_dwordx2 v[100:101], v41, s[32:35], s46 offen offset:0 sc0 sc1
    buffer_load_dwordx2 v[102:103], v41, s[32:35], s46 offen offset:800 sc0 sc1
    buffer_load_dwordx2 v[104:105], v12, s[32:35], s46 offen offset:768 sc0 sc1
    s_waitcnt vmcnt(5)
    v_max_u32 v14, v80, v81
    v_max3_u32 v14, v14, v82, v83
    v_max3_u32 v14, v14, v84, v85
    v_max3_u32 v14, v14, v86, v87
    v_max3_u32 v14, v14, v88, v89
    v_cmp_eq_u32 vcc, -1, v14
    s_cbranch_vccz L_pl_4_a
    buffer_load_dwordx2 v[80:81], v40, s[32:35], s46 offen offset:0 sc0 sc1
    buffer_load_dwordx2 v[82:83], v40, s[32:35], s46 offen offset:800 sc0 sc1
    buffer_load_dwordx2 v[84:85], v41, s[32:35], s46 offen offset:0 sc0 sc1
    buffer_load_dwordx2 v[86:87], v41, s[32:35], s46 offen offset:800 sc0 sc1
    buffer_load_dwordx2 v[88:89], v12, s[32:35], s46 offen offset:768 sc0 sc1
    s_waitcnt vmcnt(5)
    v_max_u32 v14, v96, v97
    v_max3_u32 v14, v14, v98, v99
    v_max3_u32 v14, v14, v100, v101
    v_max3_u32 v14, v14, v102, v103
    v_max3_u32 v14, v14, v104, v105
    v_cmp_eq_u32 vcc, -1, v14
    s_cbranch_vccz L_pl_4_b
    s_add_u32 s45, s45, 1
    s_cmp_lt_u32 s45, 0x20000
    s_cbranch_scc1 L_pl_4
L_pl_4_b:
    v_mov_b32 v16, v96
    v_mov_b32 v17, v97
    v_mov_b32 v18, v98
    v_mov_b32 v19, v99
    v_mov_b32 v20, v100
    v_mov_b32 v21, v101
    v_mov_b32 v22, v102
    v_mov_b32 v23, v103
    v_mov_b32 v24, v104
    v_mov_b32 v25, v105
    s_branch L_pl_4_e
L_pl_4_a:
    v_mov_b32 v16, v80
    v_mov_b32 v17, v81
    v_mov_b32 v18, v82
    v_mov_b32 v19, v83
    v_mov_b32 v20, v84
    v_mov_b32 v21, v85
    v_mov_b32 v22, v86
    v_mov_b32 v23, v87
    v_mov_b32 v24, v88
    v_mov_b32 v25, v89
L_pl_4_e:
    v_mov_b32 v28, v24
    v_mov_b32 v29, v25
    s_nop 1
    v_mov_b32_dpp v30, v28 quad_perm:[1,0,3,2] row_mask:0xf bank_mask:0xf
    v_mov_b32_dpp v31, v29 quad_perm:[1,0,3,2] row_mask:0xf bank_mask:0xf
    v_max_f32 v32, v28, v30
    v_sub_f32 v28, v28, v32
    v_sub_f32 v30, v30, v32
    v_mul_f32 v28, 0x3fb8aa3b, v28
    v_mul_f32 v30, 0x3fb8aa3b, v30
    v_exp_f32 v28, v28
    v_exp_f32 v30, v30
    s_nop 0
    v_mul_f32 v32, v28, v29
    v_fmac_f32 v32, v30, v31
    v_rcp_f32 v32, v32
    s_nop 0
    v_mul_f32 v28, v28, v32
    v_bfe_u32 v12, v6, 1, 2
    v_lshlrev_b32 v12, 5, v12
    v_bfe_u32 v13, v6, 3, 2
    v_lshl_add_u32 v12, v13, 3, v12
    v_and_b32 v13, 1, v6
    v_lshl_add_u32 v12, v13, 2, v12
    ds_write_b32 v12, v28 offset:13312
    s_waitcnt lgkmcnt(0)
    s_branch L_c_f
L_c_noml:
    s_mov_b32 s45, 0
    buffer_load_dwordx2 v[80:81], v40, s[32:35], s46 offen offset:0 sc0 sc1
    buffer_load_dwordx2 v[82:83], v40, s[32:35], s46 offen offset:800 sc0 sc1
    buffer_load_dwordx2 v[84:85], v41, s[32:35], s46 offen offset:0 sc0 sc1
    buffer_load_dwordx2 v[86:87], v41, s[32:35], s46 offen offset:800 sc0 sc1
L_pl_5:
    buffer_load_dwordx2 v[96:97], v40, s[32:35], s46 offen offset:0 sc0 sc1
    buffer_load_dwordx2 v[98:99], v40, s[32:35], s46 offen offset:800 sc0 sc1
    buffer_load_dwordx2 v[100:101], v41, s[32:35], s46 offen offset:0 sc0 sc1
    buffer_load_dwordx2 v[102:103], v41, s[32:35], s46 offen offset:800 sc0 sc1
    s_waitcnt vmcnt(4)
    v_max_u32 v14, v80, v81
    v_max3_u32 v14, v14, v82, v83
    v_max3_u32 v14, v14, v84, v85
    v_max3_u32 v14, v14, v86, v87
    v_cmp_eq_u32 vcc, -1, v14
    s_cbranch_vccz L_pl_5_a
    buffer_load_dwordx2 v[80:81], v40, s[32:35], s46 offen offset:0 sc0 sc1
    buffer_load_dwordx2 v[82:83], v40, s[32:35], s46 offen offset:800 sc0 sc1
    buffer_load_dwordx2 v[84:85], v41, s[32:35], s46 offen offset:0 sc0 sc1
    buffer_load_dwordx2 v[86:87], v41, s[32:35], s46 offen offset:800 sc0 sc1
    s_waitcnt vmcnt(4)
    v_max_u32 v14, v96, v97
    v_max3_u32 v14, v14, v98, v99
    v_max3_u32 v14, v14, v100, v101
    v_max3_u32 v14, v14, v102, v103
    v_cmp_eq_u32 vcc, -1, v14
    s_cbranch_vccz L_pl_5_b
    s_add_u32 s45, s45, 1
    s_cmp_lt_u32 s45, 0x20000
    s_cbranch_scc1 L_pl_5
L_pl_5_b:
    v_mov_b32 v16, v96
    v_mov_b32 v17, v97
    v_mov_b32 v18, v98
    v_mov_b32 v19, v99
    v_mov_b32 v20, v100
    v_mov_b32 v21, v101
    v_mov_b32 v22, v102
    v_mov_b32 v23, v103
    s_branch L_pl_5_e
L_pl_5_a:
    v_mov_b32 v16, v80
    v_mov_b32 v17, v81
    v_mov_b32 v18, v82
    v_mov_b32 v19, v83
    v_mov_b32 v20, v84
    v_mov_b32 v21, v85
    v_mov_b32 v22, v86
    v_mov_b32 v23, v87
L_pl_5_e:
L_c_f:
    s_barrier
    ds_read_b64 v[30:31], v43 offset:13312
    ds_read_b64 v[32:33], v44 offset:13312
    s_waitcnt lgkmcnt(0)
    v_mul_f32 v12, v30, v16
    v_mul_f32 v13, v30, v17
    v_fmac_f32 v12, v31, v18
    v_fmac_f32 v13, v31, v19
    v_cvt_pk_bf16_f32 v12, v12, v13
    ds_write_b32 v46, v12 offset:29952
    v_mul_f32 v12, v32, v20
    v_mul_f32 v13, v32, v21
    v_fmac_f32 v12, v33, v22
    v_fmac_f32 v13, v33, v23
    v_cvt_pk_bf16_f32 v12, v12, v13
    ds_write_b32 v47, v12 offset:29952
    s_waitcnt lgkmcnt(0)
    s_barrier
    s_lshr_b32 s48, s53, 2
    s_and_b32 s49, s53, 3
    s_mul_i32 s50, s48, 384
    s_add_u32 s50, s50, 29952
    v_add_u32 v12, s50, v8
    s_mul_i32 s50, s48, 24576
    s_lshl_b32 s49, s49, 5
    s_add_u32 s50, s50, s49
    s_add_u32 s50, s50, 42496
    v_add_u32 v13, s50, v9
    s_waitcnt vmcnt(0)
    ds_read_b128 v[16:19], v12 offset:0
    ds_read_b64_tr_b16 v[40:41], v13 offset:0
    ds_read_b64_tr_b16 v[42:43], v13 offset:512
    ds_read_b128 v[20:23], v12 offset:64
    ds_read_b64_tr_b16 v[44:45], v13 offset:4096
    ds_read_b64_tr_b16 v[46:47], v13 offset:4608
    ds_read_b128 v[24:27], v12 offset:128
    ds_read_b64_tr_b16 v[48:49], v13 offset:8192
    ds_read_b64_tr_b16 v[50:51], v13 offset:8704
    ds_read_b128 v[28:31], v12 offset:192
    ds_read_b64_tr_b16 v[52:53], v13 offset:12288
    ds_read_b64_tr_b16 v[54:55], v13 offset:12800
    ds_read_b128 v[32:35], v12 offset:256
    ds_read_b64_tr_b16 v[56:57], v13 offset:16384
    ds_read_b64_tr_b16 v[58:59], v13 offset:16896
    ds_read_b128 v[36:39], v12 offset:320
    ds_read_b64_tr_b16 v[60:61], v13 offset:20480
    ds_read_b64_tr_b16 v[62:63], v13 offset:20992
    s_waitcnt lgkmcnt(15)
    v_mfma_f32_16x16x32_bf16 v[64:67], v[16:19], v[40:43], 0
    s_waitcnt lgkmcnt(12)
    v_mfma_f32_16x16x32_bf16 v[64:67], v[20:23], v[44:47], v[64:67]
    s_waitcnt lgkmcnt(9)
    v_mfma_f32_16x16x32_bf16 v[64:67], v[24:27], v[48:51], v[64:67]
    s_waitcnt lgkmcnt(6)
    v_mfma_f32_16x16x32_bf16 v[64:67], v[28:31], v[52:55], v[64:67]
    s_waitcnt lgkmcnt(3)
    v_mfma_f32_16x16x32_bf16 v[64:67], v[32:35], v[56:59], v[64:67]
    s_waitcnt lgkmcnt(0)
    v_mfma_f32_16x16x32_bf16 v[64:67], v[36:39], v[60:63], v[64:67]
    s_nop 15
    s_lshr_b32 s48, s53, 2
    s_and_b32 s49, s53, 3
    s_mul_i32 s48, s48, 1024
    s_lshl_b32 s49, s49, 6
    s_add_u32 s48, s48, s49
    v_lshlrev_b32 v12, 2, v6
    v_add_u32 v12, s48, v12
    s_mov_b64 exec, 0xffff
    ds_write_b32 v12, v64 offset:13824
    ds_write_b32 v12, v65 offset:14080
    ds_write_b32 v12, v66 offset:14336
    ds_write_b32 v12, v67 offset:14592
    s_mov_b64 exec, -1
    s_waitcnt lgkmcnt(0)
    s_barrier
    s_cmp_ge_u32 s53, 4
    s_cbranch_scc1 L_c_pub_done
    v_lshlrev_b32 v12, 2, v0
    ds_read_b32 v16, v12 offset:13824
    ds_read_b32 v17, v12 offset:14848
    ds_read_b32 v18, v12 offset:15872
    ds_read_b32 v19, v12 offset:16896
    s_waitcnt lgkmcnt(0)
    v_add_f32 v16, v16, v17
    v_add_f32 v18, v18, v19
    v_add_f32 v16, v16, v18
    v_mul_u32_u24 v12, 2560, v7
    v_lshl_add_u32 v12, v6, 2, v12
    s_mul_i32 s48, s54, 10240
    s_lshl_b32 s49, s55, 8
    s_add_u32 s48, s48, s49
    s_add_u32 s48, s48, 262144
    buffer_store_dword v16, v12, s[32:35], s48 offen sc0 sc1
    s_cmp_lg_u32 s53, 0
    s_cbranch_scc1 L_c_pub_done
    s_lshl_b32 s48, s97, 2
    s_add_u32 s48, s48, 454656
    v_mov_b32 v12, 0
    v_mov_b32 v13, 1
    s_mov_b64 exec, 1
    buffer_store_dword v13, v12, s[32:35], s48 offen sc0 sc1
    s_mov_b64 exec, -1
L_c_pub_done:
    s_endpgm
L_tail_e:
    v_and_b32 v12, 3, v6
    v_mul_u32_u24 v8, 3136, v12
    v_lshlrev_b32 v9, 3, v12
    v_lshrrev_b32 v12, 4, v6
    v_lshl_add_u32 v8, v12, 4, v8
    v_mul_u32_u24 v12, 512, v12
    v_add_u32 v9, v9, v12
    v_bfe_u32 v12, v6, 2, 2
    v_mul_u32_u24 v12, 64, v12
    v_add_u32 v9, v9, v12
    s_barrier
    v_min_u32 v57, 39, v6
    s_lshr_b32 s48, s53, 2
    s_mul_i32 s48, s48, 40
    v_add_u32 v57, s48, v57
    v_cmp_gt_u32 vcc, 40, v6
    s_nop 1
    v_cndmask_b32_e64 v56, 0, 1.0, vcc
    s_and_b32 s49, s53, 3
    s_mul_i32 s50, s49, 1280
    v_lshlrev_b32 v58, 3, v57
    buffer_load_dwordx2 v[48:49], v58, s[56:59], s50 offen
    buffer_load_dwordx2 v[50:51], v58, s[72:75], 0 offen
    s_mul_i32 s51, s49, 1344
    v_add_u32 v62, s51, v58
    v_lshlrev_b32 v59, 4, v57
    s_mul_i32 s50, s49, 2560
    s_add_u32 s50, s50, 262144
    s_mov_b32 s45, 0
    s_mov_b32 s44, s50
    buffer_load_dwordx4 v[64:67], v59, s[32:35], s44 offen sc0 sc1
    s_add_u32 s44, s44, 10240
    buffer_load_dwordx4 v[68:71], v59, s[32:35], s44 offen sc0 sc1
    s_add_u32 s44, s44, 10240
    buffer_load_dwordx4 v[72:75], v59, s[32:35], s44 offen sc0 sc1
    s_add_u32 s44, s44, 10240
    buffer_load_dwordx4 v[76:79], v59, s[32:35], s44 offen sc0 sc1
    s_add_u32 s44, s44, 10240
    buffer_load_dwordx4 v[80:83], v59, s[32:35], s44 offen sc0 sc1
    s_add_u32 s44, s44, 10240
    buffer_load_dwordx4 v[84:87], v59, s[32:35], s44 offen sc0 sc1
    s_add_u32 s44, s44, 10240
    buffer_load_dwordx4 v[88:91], v59, s[32:35], s44 offen sc0 sc1
    s_add_u32 s44, s44, 10240
    buffer_load_dwordx4 v[92:95], v59, s[32:35], s44 offen sc0 sc1
L_pl_6:
    s_mov_b32 s44, s50
    buffer_load_dwordx4 v[96:99], v59, s[32:35], s44 offen sc0 sc1
    s_add_u32 s44, s44, 10240
    buffer_load_dwordx4 v[100:103], v59, s[32:35], s44 offen sc0 sc1
    s_add_u32 s44, s44, 10240
    buffer_load_dwordx4 v[104:107], v59, s[32:35], s44 offen sc0 sc1
    s_add_u32 s44, s44, 10240
    buffer_load_dwordx4 v[108:111], v59, s[32:35], s44 offen sc0 sc1
    s_add_u32 s44, s44, 10240
    buffer_load_dwordx4 v[112:115], v59, s[32:35], s44 offen sc0 sc1
    s_add_u32 s44, s44, 10240
    buffer_load_dwordx4 v[116:119], v59, s[32:35], s44 offen sc0 sc1
    s_add_u32 s44, s44, 10240
    buffer_load_dwordx4 v[120:123], v59, s[32:35], s44 offen sc0 sc1
    s_add_u32 s44, s44, 10240
    buffer_load_dwordx4 v[124:127], v59, s[32:35], s44 offen sc0 sc1
    s_waitcnt vmcnt(8)
    v_max_u32 v60, v64, v65
    v_max3_u32 v60, v60, v66, v67
    v_max3_u32 v60, v60, v68, v69
    v_max3_u32 v60, v60, v70, v71
    v_max3_u32 v60, v60, v72, v73
    v_max3_u32 v60, v60, v74, v75
    v_max3_u32 v60, v60, v76, v77
    v_max3_u32 v60, v60, v78, v79
    v_max3_u32 v60, v60, v80, v81
    v_max3_u32 v60, v60, v82, v83
    v_max3_u32 v60, v60, v84, v85
    v_max3_u32 v60, v60, v86, v87
    v_max3_u32 v60, v60, v88, v89
    v_max3_u32 v60, v60, v90, v91
    v_max3_u32 v60, v60, v92, v93
    v_max3_u32 v60, v60, v94, v95
    v_cmp_eq_u32 vcc, -1, v60
    s_cbranch_vccz L_pl_6_a
    s_mov_b32 s44, s50
    buffer_load_dwordx4 v[64:67], v59, s[32:35], s44 offen sc0 sc1
    s_add_u32 s44, s44, 10240
    buffer_load_dwordx4 v[68:71], v59, s[32:35], s44 offen sc0 sc1
    s_add_u32 s44, s44, 10240
    buffer_load_dwordx4 v[72:75], v59, s[32:35], s44 offen sc0 sc1
    s_add_u32 s44, s44, 10240
    buffer_load_dwordx4 v[76:79], v59, s[32:35], s44 offen sc0 sc1
    s_add_u32 s44, s44, 10240
    buffer_load_dwordx4 v[80:83], v59, s[32:35], s44 offen sc0 sc1
    s_add_u32 s44, s44, 10240
    buffer_load_dwordx4 v[84:87], v59, s[32:35], s44 offen sc0 sc1
    s_add_u32 s44, s44, 10240
    buffer_load_dwordx4 v[88:91], v59, s[32:35], s44 offen sc0 sc1
    s_add_u32 s44, s44, 10240
    buffer_load_dwordx4 v[92:95], v59, s[32:35], s44 offen sc0 sc1
    s_waitcnt vmcnt(8)
    v_max_u32 v60, v96, v97
    v_max3_u32 v60, v60, v98, v99
    v_max3_u32 v60, v60, v100, v101
    v_max3_u32 v60, v60, v102, v103
    v_max3_u32 v60, v60, v104, v105
    v_max3_u32 v60, v60, v106, v107
    v_max3_u32 v60, v60, v108, v109
    v_max3_u32 v60, v60, v110, v111
    v_max3_u32 v60, v60, v112, v113
    v_max3_u32 v60, v60, v114, v115
    v_max3_u32 v60, v60, v116, v117
    v_max3_u32 v60, v60, v118, v119
    v_max3_u32 v60, v60, v120, v121
    v_max3_u32 v60, v60, v122, v123
    v_max3_u32 v60, v60, v124, v125
    v_max3_u32 v60, v60, v126, v127
    v_cmp_eq_u32 vcc, -1, v60
    s_cbranch_vccz L_pl_6_b
    s_add_u32 s45, s45, 1
    s_cmp_lt_u32 s45, 0x20000
    s_cbranch_scc1 L_pl_6
L_pl_6_b:
    v_mov_b32 v16, v96
    v_mov_b32 v17, v97
    v_mov_b32 v18, v98
    v_mov_b32 v19, v99
    v_mov_b32 v20, v100
    v_mov_b32 v21, v101
    v_mov_b32 v22, v102
    v_mov_b32 v23, v103
    v_mov_b32 v24, v104
    v_mov_b32 v25, v105
    v_mov_b32 v26, v106
    v_mov_b32 v27, v107
    v_mov_b32 v28, v108
    v_mov_b32 v29, v109
    v_mov_b32 v30, v110
    v_mov_b32 v31, v111
    v_mov_b32 v32, v112
    v_mov_b32 v33, v113
    v_mov_b32 v34, v114
    v_mov_b32 v35, v115
    v_mov_b32 v36, v116
    v_mov_b32 v37, v117
    v_mov_b32 v38, v118
    v_mov_b32 v39, v119
    v_mov_b32 v40, v120
    v_mov_b32 v41, v121
    v_mov_b32 v42, v122
    v_mov_b32 v43, v123
    v_mov_b32 v44, v124
    v_mov_b32 v45, v125
    v_mov_b32 v46, v126
    v_mov_b32 v47, v127
    s_branch L_pl_6_e
L_pl_6_a:
    v_mov_b32 v16, v64
    v_mov_b32 v17, v65
    v_mov_b32 v18, v66
    v_mov_b32 v19, v67
    v_mov_b32 v20, v68
    v_mov_b32 v21, v69
    v_mov_b32 v22, v70
    v_mov_b32 v23, v71
    v_mov_b32 v24, v72
    v_mov_b32 v25, v73
    v_mov_b32 v26, v74
    v_mov_b32 v27, v75
    v_mov_b32 v28, v76
    v_mov_b32 v29, v77
    v_mov_b32 v30, v78
    v_mov_b32 v31, v79
    v_mov_b32 v32, v80
    v_mov_b32 v33, v81
    v_mov_b32 v34, v82
    v_mov_b32 v35, v83
    v_mov_b32 v36, v84
    v_mov_b32 v37, v85
    v_mov_b32 v38, v86
    v_mov_b32 v39, v87
    v_mov_b32 v40, v88
    v_mov_b32 v41, v89
    v_mov_b32 v42, v90
    v_mov_b32 v43, v91
    v_mov_b32 v44, v92
    v_mov_b32 v45, v93
    v_mov_b32 v46, v94
    v_mov_b32 v47, v95
L_pl_6_e:
    v_add_f32 v16, v16, v32
    v_add_f32 v20, v20, v36
    v_add_f32 v24, v24, v40
    v_add_f32 v28, v28, v44
    v_add_f32 v52, v16, v20
    v_add_f32 v60, v24, v28
    v_add_f32 v52, v52, v60
    v_cvt_pk_bf16_f32 v52, v52, v52
    v_lshlrev_b32 v52, 16, v52
    v_add_f32 v17, v17, v33
    v_add_f32 v21, v21, v37
    v_add_f32 v25, v25, v41
    v_add_f32 v29, v29, v45
    v_add_f32 v53, v17, v21
    v_add_f32 v60, v25, v29
    v_add_f32 v53, v53, v60
    v_cvt_pk_bf16_f32 v53, v53, v53
    v_lshlrev_b32 v53, 16, v53
    v_add_f32 v18, v18, v34
    v_add_f32 v22, v22, v38
    v_add_f32 v26, v26, v42
    v_add_f32 v30, v30, v46
    v_add_f32 v54, v18, v22
    v_add_f32 v60, v26, v30
    v_add_f32 v54, v54, v60
    v_cvt_pk_bf16_f32 v54, v54, v54
    v_lshlrev_b32 v54, 16, v54
    v_add_f32 v19, v19, v35
    v_add_f32 v23, v23, v39
    v_add_f32 v27, v27, v43
    v_add_f32 v31, v31, v47
    v_add_f32 v55, v19, v23
    v_add_f32 v60, v27, v31
    v_add_f32 v55, v55, v60
    v_cvt_pk_bf16_f32 v55, v55, v55
    v_lshlrev_b32 v55, 16, v55
    v_lshlrev_b32 v58, 16, v48
    v_and_b32 v59, 0xffff0000, v48
    v_lshlrev_b32 v60, 16, v49
    v_and_b32 v61, 0xffff0000, v49
    v_add_f32 v52, v52, v58
    v_cvt_pk_bf16_f32 v52, v52, v52
    v_lshlrev_b32 v52, 16, v52
    v_add_f32 v53, v53, v59
    v_cvt_pk_bf16_f32 v53, v53, v53
    v_lshlrev_b32 v53, 16, v53
    v_add_f32 v54, v54, v60
    v_cvt_pk_bf16_f32 v54, v54, v54
    v_lshlrev_b32 v54, 16, v54
    v_add_f32 v55, v55, v61
    v_cvt_pk_bf16_f32 v55, v55, v55
    v_lshlrev_b32 v55, 16, v55
    v_add_f32 v58, v52, v53
    v_add_f32 v59, v54, v55
    v_add_f32 v58, v58, v59
    v_mul_f32 v58, v58, v56
    s_nop 1
    v_add_f32_dpp v58, v58, v58 quad_perm:[1,0,3,2] row_mask:0xf bank_mask:0xf
    s_nop 1
    v_add_f32_dpp v58, v58, v58 quad_perm:[2,3,0,1] row_mask:0xf bank_mask:0xf
    s_nop 1
    v_add_f32_dpp v58, v58, v58 row_half_mirror row_mask:0xf bank_mask:0xf
    s_nop 1
    v_add_f32_dpp v58, v58, v58 row_mirror row_mask:0xf bank_mask:0xf
    s_nop 1
    v_readlane_b32 s48, v58, 0
    v_readlane_b32 s49, v58, 16
    v_readlane_b32 s50, v58, 32
    v_readlane_b32 s51, v58, 48
    s_nop 1
    v_mov_b32 v58, s48
    v_add_f32 v58, s49, v58
    v_add_f32 v58, s50, v58
    v_add_f32 v58, s51, v58
    v_mul_f32 v58, 0x3bcccccd, v58
    v_sub_f32 v60, v52, v58
    v_mul_f32 v59, v60, v60
    v_sub_f32 v60, v53, v58
    v_fmac_f32 v59, v60, v60
    v_sub_f32 v60, v54, v58
    v_fmac_f32 v59, v60, v60
    v_sub_f32 v60, v55, v58
    v_fmac_f32 v59, v60, v60
    v_mul_f32 v59, v59, v56
    s_nop 1
    v_add_f32_dpp v59, v59, v59 quad_perm:[1,0,3,2] row_mask:0xf bank_mask:0xf
    s_nop 1
    v_add_f32_dpp v59, v59, v59 quad_perm:[2,3,0,1] row_mask:0xf bank_mask:0xf
    s_nop 1
    v_add_f32_dpp v59, v59, v59 row_half_mirror row_mask:0xf bank_mask:0xf
    s_nop 1
    v_add_f32_dpp v59, v59, v59 row_mirror row_mask:0xf bank_mask:0xf
    s_nop 1
    v_readlane_b32 s48, v59, 0
    v_readlane_b32 s49, v59, 16
    v_readlane_b32 s50, v59, 32
    v_readlane_b32 s51, v59, 48
    s_nop 1
    v_mov_b32 v59, s48
    v_add_f32 v59, s49, v59
    v_add_f32 v59, s50, v59
    v_add_f32 v59, s51, v59
    s_lshl_b32 s49, s53, 5
    s_and_b32 s49, s49, 96
    s_and_b32 s50, s53, 12
    s_lshl_b32 s50, s50, 1
    s_add_u32 s50, s50, s49
    v_mov_b32 v60, s50
    v_mov_b32 v61, s49
    ds_write_b64 v60, v[58:59] offset:29696
    s_waitcnt lgkmcnt(0)
    s_barrier
    ds_read_b128 v[16:19], v61 offset:29696
    ds_read_b128 v[20:23], v61 offset:29712
    s_waitcnt lgkmcnt(0)
    v_add_f32 v24, v16, v18
    v_add_f32 v25, v20, v22
    v_add_f32 v24, v24, v25
    v_mul_f32 v24, 0.25, v24
    v_add_f32 v25, v17, v19
    v_add_f32 v26, v21, v23
    v_add_f32 v25, v25, v26
    v_sub_f32 v16, v16, v24
    v_sub_f32 v18, v18, v24
    v_sub_f32 v20, v20, v24
    v_sub_f32 v22, v22, v24
    v_mul_f32 v26, v16, v16
    v_fmac_f32 v26, v18, v18
    v_fmac_f32 v26, v20, v20
    v_fmac_f32 v26, v22, v22
    v_mov_b32 v27, 0x43200000
    v_fmac_f32 v25, v26, v27
    v_mul_f32 v25, 0x3acccccd, v25
    v_cvt_pk_bf16_f32 v24, v24, v24
    v_lshlrev_b32 v24, 16, v24
    v_cvt_pk_bf16_f32 v25, v25, v25
    v_lshlrev_b32 v25, 16, v25
    v_add_f32 v25, 0x3727c5ac, v25
    v_cvt_pk_bf16_f32 v25, v25, v25
    v_lshlrev_b32 v25, 16, v25
    v_sqrt_f32 v25, v25
    s_nop 0
    v_cvt_pk_bf16_f32 v25, v25, v25
    v_lshlrev_b32 v25, 16, v25
    v_rcp_f32 v25, v25
    s_nop 0
    v_sub_f32 v28, v52, v24
    v_cvt_pk_bf16_f32 v28, v28, v28
    v_lshlrev_b32 v28, 16, v28
    v_mul_f32 v28, v28, v25
    v_cvt_pk_bf16_f32 v28, v28, v28
    v_lshlrev_b32 v28, 16, v28
    v_sub_f32 v29, v53, v24
    v_cvt_pk_bf16_f32 v29, v29, v29
    v_lshlrev_b32 v29, 16, v29
    v_mul_f32 v29, v29, v25
    v_cvt_pk_bf16_f32 v29, v29, v29
    v_lshlrev_b32 v29, 16, v29
    v_sub_f32 v30, v54, v24
    v_cvt_pk_bf16_f32 v30, v30, v30
    v_lshlrev_b32 v30, 16, v30
    v_mul_f32 v30, v30, v25
    v_cvt_pk_bf16_f32 v30, v30, v30
    v_lshlrev_b32 v30, 16, v30
    v_sub_f32 v31, v55, v24
    v_cvt_pk_bf16_f32 v31, v31, v31
    v_lshlrev_b32 v31, 16, v31
    v_mul_f32 v31, v31, v25
    v_cvt_pk_bf16_f32 v31, v31, v31
    v_lshlrev_b32 v31, 16, v31
    v_cvt_pk_bf16_f32 v32, v28, v29
    v_cvt_pk_bf16_f32 v33, v30, v31
    v_cvt_pk_bf16_f32 v34, v52, v53
    v_cvt_pk_bf16_f32 v35, v54, v55
    v_lshlrev_b32 v58, 16, v50
    v_and_b32 v59, 0xffff0000, v50
    v_mul_f32 v36, v28, v58
    v_fmac_f32 v36, v29, v59
    v_lshlrev_b32 v58, 16, v51
    v_and_b32 v59, 0xffff0000, v51
    v_fmac_f32 v36, v30, v58
    v_fmac_f32 v36, v31, v59
    v_mul_f32 v36, v36, v56
    s_nop 1
    v_add_f32_dpp v36, v36, v36 quad_perm:[1,0,3,2] row_mask:0xf bank_mask:0xf
    s_nop 1
    v_add_f32_dpp v36, v36, v36 quad_perm:[2,3,0,1] row_mask:0xf bank_mask:0xf
    s_nop 1
    v_add_f32_dpp v36, v36, v36 row_half_mirror row_mask:0xf bank_mask:0xf
    s_nop 1
    v_add_f32_dpp v36, v36, v36 row_mirror row_mask:0xf bank_mask:0xf
    s_nop 1
    v_readlane_b32 s48, v36, 0
    v_readlane_b32 s49, v36, 16
    v_readlane_b32 s50, v36, 32
    v_readlane_b32 s51, v36, 48
    s_nop 1
    v_mov_b32 v36, s48
    v_add_f32 v36, s49, v36
    v_add_f32 v36, s50, v36
    v_add_f32 v36, s51, v36
    v_lshrrev_b32 v60, 1, v60
    ds_write_b32 v60, v36 offset:29824
    s_mov_b32 exec_lo, -1
    s_mov_b32 exec_hi, 0xff
    ds_write_b64 v62, v[32:33] offset:18944
    ds_write_b64 v62, v[34:35] offset:24320
    s_mov_b64 exec, -1
    s_cmp_lt_u32 s53, 4
    s_cbranch_scc1 L_e_wait
L_e_act:
    v_subrev_u32 v15, 256, v0
    v_lshlrev_b32 v12, 4, v15
    v_mul_u32_u24 v13, 43691, v15
    v_lshrrev_b32 v13, 23, v13
    v_mul_u32_u24 v14, 64, v13
    v_add_u32 v14, v14, v12
    s_mov_b32 s45, 0
    s_mov_b32 s46, 360448
    buffer_load_dwordx4 v[80:83], v12, s[32:35], s46 offen sc0 sc1
    s_mov_b32 s46, 376832
    buffer_load_dwordx4 v[84:87], v12, s[32:35], s46 offen sc0 sc1
L_pl_7:
    s_mov_b32 s46, 360448
    buffer_load_dwordx4 v[96:99], v12, s[32:35], s46 offen sc0 sc1
    s_mov_b32 s46, 376832
    buffer_load_dwordx4 v[100:103], v12, s[32:35], s46 offen sc0 sc1
    s_waitcnt vmcnt(2)
    v_max_u32 v15, v80, v81
    v_max3_u32 v15, v15, v82, v83
    v_max3_u32 v15, v15, v84, v85
    v_max3_u32 v15, v15, v86, v87
    v_cmp_eq_u32 vcc, -1, v15
    s_cbranch_vccz L_pl_7_a
    s_mov_b32 s46, 360448
    buffer_load_dwordx4 v[80:83], v12, s[32:35], s46 offen sc0 sc1
    s_mov_b32 s46, 376832
    buffer_load_dwordx4 v[84:87], v12, s[32:35], s46 offen sc0 sc1
    s_waitcnt vmcnt(2)
    v_max_u32 v15, v96, v97
    v_max3_u32 v15, v15, v98, v99
    v_max3_u32 v15, v15, v100, v101
    v_max3_u32 v15, v15, v102, v103
    v_cmp_eq_u32 vcc, -1, v15
    s_cbranch_vccz L_pl_7_b
    s_add_u32 s45, s45, 1
    s_cmp_lt_u32 s45, 0x20000
    s_cbranch_scc1 L_pl_7
L_pl_7_b:
    v_mov_b32 v16, v96
    v_mov_b32 v17, v97
    v_mov_b32 v18, v98
    v_mov_b32 v19, v99
    v_mov_b32 v20, v100
    v_mov_b32 v21, v101
    v_mov_b32 v22, v102
    v_mov_b32 v23, v103
    s_branch L_pl_7_e
L_pl_7_a:
    v_mov_b32 v16, v80
    v_mov_b32 v17, v81
    v_mov_b32 v18, v82
    v_mov_b32 v19, v83
    v_mov_b32 v20, v84
    v_mov_b32 v21, v85
    v_mov_b32 v22, v86
    v_mov_b32 v23, v87
L_pl_7_e:
    v_lshlrev_b32 v24, 16, v16
    v_and_b32 v25, 0xffff0000, v16
    v_lshlrev_b32 v26, 16, v20
    v_and_b32 v27, 0xffff0000, v20
    v_mul_f32 v28, 0xbfb8aa3b, v24
    v_mul_f32 v29, 0xbfb8aa3b, v25
    v_exp_f32 v28, v28
    v_exp_f32 v29, v29
    s_nop 0
    v_add_f32 v28, 1.0, v28
    v_add_f32 v29, 1.0, v29
    v_rcp_f32 v28, v28
    v_rcp_f32 v29, v29
    s_nop 0
    v_mul_f32 v24, v24, v28
    v_mul_f32 v25, v25, v29
    v_cvt_pk_bf16_f32 v24, v24, v24
    v_lshlrev_b32 v24, 16, v24
    v_cvt_pk_bf16_f32 v25, v25, v25
    v_lshlrev_b32 v25, 16, v25
    v_mul_f32 v24, v24, v26
    v_mul_f32 v25, v25, v27
    v_cvt_pk_bf16_f32 v32, v24, v25
    v_lshlrev_b32 v24, 16, v17
    v_and_b32 v25, 0xffff0000, v17
    v_lshlrev_b32 v26, 16, v21
    v_and_b32 v27, 0xffff0000, v21
    v_mul_f32 v28, 0xbfb8aa3b, v24
    v_mul_f32 v29, 0xbfb8aa3b, v25
    v_exp_f32 v28, v28
    v_exp_f32 v29, v29
    s_nop 0
    v_add_f32 v28, 1.0, v28
    v_add_f32 v29, 1.0, v29
    v_rcp_f32 v28, v28
    v_rcp_f32 v29, v29
    s_nop 0
    v_mul_f32 v24, v24, v28
    v_mul_f32 v25, v25, v29
    v_cvt_pk_bf16_f32 v24, v24, v24
    v_lshlrev_b32 v24, 16, v24
    v_cvt_pk_bf16_f32 v25, v25, v25
    v_lshlrev_b32 v25, 16, v25
    v_mul_f32 v24, v24, v26
    v_mul_f32 v25, v25, v27
    v_cvt_pk_bf16_f32 v33, v24, v25
    v_lshlrev_b32 v24, 16, v18
    v_and_b32 v25, 0xffff0000, v18
    v_lshlrev_b32 v26, 16, v22
    v_and_b32 v27, 0xffff0000, v22
    v_mul_f32 v28, 0xbfb8aa3b, v24
    v_mul_f32 v29, 0xbfb8aa3b, v25
    v_exp_f32 v28, v28
    v_exp_f32 v29, v29
    s_nop 0
    v_add_f32 v28, 1.0, v28
    v_add_f32 v29, 1.0, v29
    v_rcp_f32 v28, v28
    v_rcp_f32 v29, v29
    s_nop 0
    v_mul_f32 v24, v24, v28
    v_mul_f32 v25, v25, v29
    v_cvt_pk_bf16_f32 v24, v24, v24
    v_lshlrev_b32 v24, 16, v24
    v_cvt_pk_bf16_f32 v25, v25, v25
    v_lshlrev_b32 v25, 16, v25
    v_mul_f32 v24, v24, v26
    v_mul_f32 v25, v25, v27
    v_cvt_pk_bf16_f32 v34, v24, v25
    v_lshlrev_b32 v24, 16, v19
    v_and_b32 v25, 0xffff0000, v19
    v_lshlrev_b32 v26, 16, v23
    v_and_b32 v27, 0xffff0000, v23
    v_mul_f32 v28, 0xbfb8aa3b, v24
    v_mul_f32 v29, 0xbfb8aa3b, v25
    v_exp_f32 v28, v28
    v_exp_f32 v29, v29
    s_nop 0
    v_add_f32 v28, 1.0, v28
    v_add_f32 v29, 1.0, v29
    v_rcp_f32 v28, v28
    v_rcp_f32 v29, v29
    s_nop 0
    v_mul_f32 v24, v24, v28
    v_mul_f32 v25, v25, v29
    v_cvt_pk_bf16_f32 v24, v24, v24
    v_lshlrev_b32 v24, 16, v24
    v_cvt_pk_bf16_f32 v25, v25, v25
    v_lshlrev_b32 v25, 16, v25
    v_mul_f32 v24, v24, v26
    v_mul_f32 v25, v25, v27
    v_cvt_pk_bf16_f32 v35, v24, v25
    ds_write_b128 v14, v[32:35] offset:29952
L_e_wait:
    s_waitcnt lgkmcnt(0)
    s_barrier
    s_lshr_b32 s48, s53, 1
    s_and_b32 s49, s53, 1
    s_mul_i32 s50, s48, 384
    s_add_u32 s50, s50, 29952
    v_add_u32 v12, s50, v8
    s_mul_i32 s50, s48, 12288
    s_lshl_b32 s49, s49, 5
    s_add_u32 s50, s50, s49
    s_add_u32 s50, s50, 42496
    v_add_u32 v13, s50, v9
    s_waitcnt vmcnt(0)
    ds_read_b128 v[16:19], v12 offset:0
    ds_read_b64_tr_b16 v[40:41], v13 offset:0
    ds_read_b64_tr_b16 v[42:43], v13 offset:256
    ds_read_b128 v[20:23], v12 offset:64
    ds_read_b64_tr_b16 v[44:45], v13 offset:2048
    ds_read_b64_tr_b16 v[46:47], v13 offset:2304
    ds_read_b128 v[24:27], v12 offset:128
    ds_read_b64_tr_b16 v[48:49], v13 offset:4096
    ds_read_b64_tr_b16 v[50:51], v13 offset:4352
    ds_read_b128 v[28:31], v12 offset:192
    ds_read_b64_tr_b16 v[52:53], v13 offset:6144
    ds_read_b64_tr_b16 v[54:55], v13 offset:6400
    ds_read_b128 v[32:35], v12 offset:256
    ds_read_b64_tr_b16 v[56:57], v13 offset:8192
    ds_read_b64_tr_b16 v[58:59], v13 offset:8448
    ds_read_b128 v[36:39], v12 offset:320
    ds_read_b64_tr_b16 v[60:61], v13 offset:10240
    ds_read_b64_tr_b16 v[62:63], v13 offset:10496
    s_waitcnt lgkmcnt(15)
    v_mfma_f32_16x16x32_bf16 v[64:67], v[16:19], v[40:43], 0
    s_waitcnt lgkmcnt(12)
    v_mfma_f32_16x16x32_bf16 v[64:67], v[20:23], v[44:47], v[64:67]
    s_waitcnt lgkmcnt(9)
    v_mfma_f32_16x16x32_bf16 v[64:67], v[24:27], v[48:51], v[64:67]
    s_waitcnt lgkmcnt(6)
    v_mfma_f32_16x16x32_bf16 v[64:67], v[28:31], v[52:55], v[64:67]
    s_waitcnt lgkmcnt(3)
    v_mfma_f32_16x16x32_bf16 v[64:67], v[32:35], v[56:59], v[64:67]
    s_waitcnt lgkmcnt(0)
    v_mfma_f32_16x16x32_bf16 v[64:67], v[36:39], v[60:63], v[64:67]
    s_nop 15
    s_lshr_b32 s48, s53, 1
    s_and_b32 s49, s53, 1
    s_mul_i32 s48, s48, 512
    s_lshl_b32 s49, s49, 6
    s_add_u32 s48, s48, s49
    v_lshlrev_b32 v12, 2, v6
    v_add_u32 v12, s48, v12
    s_mov_b64 exec, 0xffff
    ds_write_b32 v12, v64 offset:13824
    ds_write_b32 v12, v65 offset:13952
    ds_write_b32 v12, v66 offset:14080
    ds_write_b32 v12, v67 offset:14208
    s_mov_b64 exec, -1
    s_waitcnt lgkmcnt(0)
    s_barrier
    s_cmp_ge_u32 s53, 2
    s_cbranch_scc1 L_done
    v_lshlrev_b32 v12, 2, v0
    ds_read_b32 v16, v12 offset:13824
    ds_read_b32 v17, v12 offset:14336
    ds_read_b32 v18, v12 offset:14848
    ds_read_b32 v19, v12 offset:15360
    ds_read_b32 v20, v12 offset:15872
    ds_read_b32 v21, v12 offset:16384
    ds_read_b32 v22, v12 offset:16896
    ds_read_b32 v23, v12 offset:17408
    v_and_b32 v13, 31, v0
    s_lshl_b32 s48, s55, 5
    v_add_u32 v13, s48, v13
    v_lshrrev_b32 v14, 5, v0
    v_mul_u32_u24 v15, 1344, v14
    v_lshl_add_u32 v15, v13, 1, v15
    v_lshlrev_b32 v12, 4, v14
    ds_read_u16 v40, v15 offset:18944
    ds_read_u16 v41, v15 offset:24320
    ds_read_b128 v[44:47], v12 offset:29824
    s_waitcnt lgkmcnt(0)
    v_add_f32 v44, v44, v45
    v_add_f32 v46, v46, v47
    v_add_f32 v42, v44, v46
    v_cvt_pk_bf16_f32 v42, v42, v42
    v_lshlrev_b32 v42, 16, v42
    v_mul_f32 v42, 0xbfb8aa3b, v42
    v_exp_f32 v42, v42
    s_nop 0
    v_add_f32 v42, 1.0, v42
    v_rcp_f32 v42, v42
    s_nop 0
    v_cvt_pk_bf16_f32 v42, v42, v42
    v_lshlrev_b32 v42, 16, v42
    v_add_f32 v16, v16, v20
    v_add_f32 v17, v17, v21
    v_add_f32 v18, v18, v22
    v_add_f32 v19, v19, v23
    v_add_f32 v16, v16, v18
    v_add_f32 v17, v17, v19
    v_add_f32 v16, v16, v17
    v_lshlrev_b32 v40, 16, v40
    v_lshlrev_b32 v41, 16, v41
    v_cvt_pk_bf16_f32 v16, v16, v16
    v_lshlrev_b32 v16, 16, v16
    v_mul_f32 v16, v16, v42
    v_cvt_pk_bf16_f32 v16, v16, v16
    v_lshlrev_b32 v16, 16, v16
    v_add_f32 v16, v40, v16
    v_cvt_pk_bf16_f32 v16, v16, v16
    v_lshlrev_b32 v16, 16, v16
    v_add_f32 v16, v41, v16
    v_cvt_pk_bf16_f32 v16, v16, v16
    v_mul_u32_u24 v14, 640, v14
    v_add_u32 v14, v14, v13
    v_lshlrev_b32 v14, 1, v14
    buffer_store_short v16, v14, s[76:79], 0 offen
    s_endpgm
L_tail_d:
    v_and_b32 v12, 3, v6
    v_mul_u32_u24 v8, 1344, v12
    v_lshlrev_b32 v9, 3, v12
    v_lshrrev_b32 v12, 4, v6
    v_lshl_add_u32 v8, v12, 4, v8
    v_mul_u32_u24 v12, 1024, v12
    v_add_u32 v9, v9, v12
    v_bfe_u32 v12, v6, 2, 2
    v_mul_u32_u24 v12, 128, v12
    v_add_u32 v9, v9, v12
    s_barrier
    v_min_u32 v57, 39, v6
    s_lshr_b32 s48, s53, 2
    s_mul_i32 s48, s48, 40
    v_add_u32 v57, s48, v57
    v_cmp_gt_u32 vcc, 40, v6
    s_nop 1
    v_cndmask_b32_e64 v56, 0, 1.0, vcc
    s_and_b32 s49, s53, 3
    s_mul_i32 s50, s49, 1280
    v_lshlrev_b32 v58, 3, v57
    buffer_load_dwordx2 v[48:49], v58, s[56:59], s50 offen
    s_mul_i32 s51, s49, 1344
    v_add_u32 v62, s51, v58
    v_lshlrev_b32 v59, 4, v57
    s_mul_i32 s50, s49, 2560
    s_add_u32 s50, s50, 262144
    s_mov_b32 s45, 0
    s_mov_b32 s44, s50
    buffer_load_dwordx4 v[64:67], v59, s[32:35], s44 offen sc0 sc1
    s_add_u32 s44, s44, 10240
    buffer_load_dwordx4 v[68:71], v59, s[32:35], s44 offen sc0 sc1
    s_add_u32 s44, s44, 10240
    buffer_load_dwordx4 v[72:75], v59, s[32:35], s44 offen sc0 sc1
    s_add_u32 s44, s44, 10240
    buffer_load_dwordx4 v[76:79], v59, s[32:35], s44 offen sc0 sc1
    s_add_u32 s44, s44, 10240
    buffer_load_dwordx4 v[80:83], v59, s[32:35], s44 offen sc0 sc1
    s_add_u32 s44, s44, 10240
    buffer_load_dwordx4 v[84:87], v59, s[32:35], s44 offen sc0 sc1
    s_add_u32 s44, s44, 10240
    buffer_load_dwordx4 v[88:91], v59, s[32:35], s44 offen sc0 sc1
    s_add_u32 s44, s44, 10240
    buffer_load_dwordx4 v[92:95], v59, s[32:35], s44 offen sc0 sc1
L_pl_8:
    s_mov_b32 s44, s50
    buffer_load_dwordx4 v[96:99], v59, s[32:35], s44 offen sc0 sc1
    s_add_u32 s44, s44, 10240
    buffer_load_dwordx4 v[100:103], v59, s[32:35], s44 offen sc0 sc1
    s_add_u32 s44, s44, 10240
    buffer_load_dwordx4 v[104:107], v59, s[32:35], s44 offen sc0 sc1
    s_add_u32 s44, s44, 10240
    buffer_load_dwordx4 v[108:111], v59, s[32:35], s44 offen sc0 sc1
    s_add_u32 s44, s44, 10240
    buffer_load_dwordx4 v[112:115], v59, s[32:35], s44 offen sc0 sc1
    s_add_u32 s44, s44, 10240
    buffer_load_dwordx4 v[116:119], v59, s[32:35], s44 offen sc0 sc1
    s_add_u32 s44, s44, 10240
    buffer_load_dwordx4 v[120:123], v59, s[32:35], s44 offen sc0 sc1
    s_add_u32 s44, s44, 10240
    buffer_load_dwordx4 v[124:127], v59, s[32:35], s44 offen sc0 sc1
    s_waitcnt vmcnt(8)
    v_max_u32 v60, v64, v65
    v_max3_u32 v60, v60, v66, v67
    v_max3_u32 v60, v60, v68, v69
    v_max3_u32 v60, v60, v70, v71
    v_max3_u32 v60, v60, v72, v73
    v_max3_u32 v60, v60, v74, v75
    v_max3_u32 v60, v60, v76, v77
    v_max3_u32 v60, v60, v78, v79
    v_max3_u32 v60, v60, v80, v81
    v_max3_u32 v60, v60, v82, v83
    v_max3_u32 v60, v60, v84, v85
    v_max3_u32 v60, v60, v86, v87
    v_max3_u32 v60, v60, v88, v89
    v_max3_u32 v60, v60, v90, v91
    v_max3_u32 v60, v60, v92, v93
    v_max3_u32 v60, v60, v94, v95
    v_cmp_eq_u32 vcc, -1, v60
    s_cbranch_vccz L_pl_8_a
    s_mov_b32 s44, s50
    buffer_load_dwordx4 v[64:67], v59, s[32:35], s44 offen sc0 sc1
    s_add_u32 s44, s44, 10240
    buffer_load_dwordx4 v[68:71], v59, s[32:35], s44 offen sc0 sc1
    s_add_u32 s44, s44, 10240
    buffer_load_dwordx4 v[72:75], v59, s[32:35], s44 offen sc0 sc1
    s_add_u32 s44, s44, 10240
    buffer_load_dwordx4 v[76:79], v59, s[32:35], s44 offen sc0 sc1
    s_add_u32 s44, s44, 10240
    buffer_load_dwordx4 v[80:83], v59, s[32:35], s44 offen sc0 sc1
    s_add_u32 s44, s44, 10240
    buffer_load_dwordx4 v[84:87], v59, s[32:35], s44 offen sc0 sc1
    s_add_u32 s44, s44, 10240
    buffer_load_dwordx4 v[88:91], v59, s[32:35], s44 offen sc0 sc1
    s_add_u32 s44, s44, 10240
    buffer_load_dwordx4 v[92:95], v59, s[32:35], s44 offen sc0 sc1
    s_waitcnt vmcnt(8)
    v_max_u32 v60, v96, v97
    v_max3_u32 v60, v60, v98, v99
    v_max3_u32 v60, v60, v100, v101
    v_max3_u32 v60, v60, v102, v103
    v_max3_u32 v60, v60, v104, v105
    v_max3_u32 v60, v60, v106, v107
    v_max3_u32 v60, v60, v108, v109
    v_max3_u32 v60, v60, v110, v111
    v_max3_u32 v60, v60, v112, v113
    v_max3_u32 v60, v60, v114, v115
    v_max3_u32 v60, v60, v116, v117
    v_max3_u32 v60, v60, v118, v119
    v_max3_u32 v60, v60, v120, v121
    v_max3_u32 v60, v60, v122, v123
    v_max3_u32 v60, v60, v124, v125
    v_max3_u32 v60, v60, v126, v127
    v_cmp_eq_u32 vcc, -1, v60
    s_cbranch_vccz L_pl_8_b
    s_add_u32 s45, s45, 1
    s_cmp_lt_u32 s45, 0x20000
    s_cbranch_scc1 L_pl_8
L_pl_8_b:
    v_mov_b32 v16, v96
    v_mov_b32 v17, v97
    v_mov_b32 v18, v98
    v_mov_b32 v19, v99
    v_mov_b32 v20, v100
    v_mov_b32 v21, v101
    v_mov_b32 v22, v102
    v_mov_b32 v23, v103
    v_mov_b32 v24, v104
    v_mov_b32 v25, v105
    v_mov_b32 v26, v106
    v_mov_b32 v27, v107
    v_mov_b32 v28, v108
    v_mov_b32 v29, v109
    v_mov_b32 v30, v110
    v_mov_b32 v31, v111
    v_mov_b32 v32, v112
    v_mov_b32 v33, v113
    v_mov_b32 v34, v114
    v_mov_b32 v35, v115
    v_mov_b32 v36, v116
    v_mov_b32 v37, v117
    v_mov_b32 v38, v118
    v_mov_b32 v39, v119
    v_mov_b32 v40, v120
    v_mov_b32 v41, v121
    v_mov_b32 v42, v122
    v_mov_b32 v43, v123
    v_mov_b32 v44, v124
    v_mov_b32 v45, v125
    v_mov_b32 v46, v126
    v_mov_b32 v47, v127
    s_branch L_pl_8_e
L_pl_8_a:
    v_mov_b32 v16, v64
    v_mov_b32 v17, v65
    v_mov_b32 v18, v66
    v_mov_b32 v19, v67
    v_mov_b32 v20, v68
    v_mov_b32 v21, v69
    v_mov_b32 v22, v70
    v_mov_b32 v23, v71
    v_mov_b32 v24, v72
    v_mov_b32 v25, v73
    v_mov_b32 v26, v74
    v_mov_b32 v27, v75
    v_mov_b32 v28, v76
    v_mov_b32 v29, v77
    v_mov_b32 v30, v78
    v_mov_b32 v31, v79
    v_mov_b32 v32, v80
    v_mov_b32 v33, v81
    v_mov_b32 v34, v82
    v_mov_b32 v35, v83
    v_mov_b32 v36, v84
    v_mov_b32 v37, v85
    v_mov_b32 v38, v86
    v_mov_b32 v39, v87
    v_mov_b32 v40, v88
    v_mov_b32 v41, v89
    v_mov_b32 v42, v90
    v_mov_b32 v43, v91
    v_mov_b32 v44, v92
    v_mov_b32 v45, v93
    v_mov_b32 v46, v94
    v_mov_b32 v47, v95
L_pl_8_e:
    v_add_f32 v16, v16, v32
    v_add_f32 v20, v20, v36
    v_add_f32 v24, v24, v40
    v_add_f32 v28, v28, v44
    v_add_f32 v52, v16, v20
    v_add_f32 v60, v24, v28
    v_add_f32 v52, v52, v60
    v_cvt_pk_bf16_f32 v52, v52, v52
    v_lshlrev_b32 v52, 16, v52
    v_add_f32 v17, v17, v33
    v_add_f32 v21, v21, v37
    v_add_f32 v25, v25, v41
    v_add_f32 v29, v29, v45
    v_add_f32 v53, v17, v21
    v_add_f32 v60, v25, v29
    v_add_f32 v53, v53, v60
    v_cvt_pk_bf16_f32 v53, v53, v53
    v_lshlrev_b32 v53, 16, v53
    v_add_f32 v18, v18, v34
    v_add_f32 v22, v22, v38
    v_add_f32 v26, v26, v42
    v_add_f32 v30, v30, v46
    v_add_f32 v54, v18, v22
    v_add_f32 v60, v26, v30
    v_add_f32 v54, v54, v60
    v_cvt_pk_bf16_f32 v54, v54, v54
    v_lshlrev_b32 v54, 16, v54
    v_add_f32 v19, v19, v35
    v_add_f32 v23, v23, v39
    v_add_f32 v27, v27, v43
    v_add_f32 v31, v31, v47
    v_add_f32 v55, v19, v23
    v_add_f32 v60, v27, v31
    v_add_f32 v55, v55, v60
    v_cvt_pk_bf16_f32 v55, v55, v55
    v_lshlrev_b32 v55, 16, v55
    v_lshlrev_b32 v58, 16, v48
    v_and_b32 v59, 0xffff0000, v48
    v_lshlrev_b32 v60, 16, v49
    v_and_b32 v61, 0xffff0000, v49
    v_add_f32 v52, v52, v58
    v_cvt_pk_bf16_f32 v52, v52, v52
    v_lshlrev_b32 v52, 16, v52
    v_add_f32 v53, v53, v59
    v_cvt_pk_bf16_f32 v53, v53, v53
    v_lshlrev_b32 v53, 16, v53
    v_add_f32 v54, v54, v60
    v_cvt_pk_bf16_f32 v54, v54, v54
    v_lshlrev_b32 v54, 16, v54
    v_add_f32 v55, v55, v61
    v_cvt_pk_bf16_f32 v55, v55, v55
    v_lshlrev_b32 v55, 16, v55
    v_add_f32 v58, v52, v53
    v_add_f32 v59, v54, v55
    v_add_f32 v58, v58, v59
    v_mul_f32 v58, v58, v56
    s_nop 1
    v_add_f32_dpp v58, v58, v58 quad_perm:[1,0,3,2] row_mask:0xf bank_mask:0xf
    s_nop 1
    v_add_f32_dpp v58, v58, v58 quad_perm:[2,3,0,1] row_mask:0xf bank_mask:0xf
    s_nop 1
    v_add_f32_dpp v58, v58, v58 row_half_mirror row_mask:0xf bank_mask:0xf
    s_nop 1
    v_add_f32_dpp v58, v58, v58 row_mirror row_mask:0xf bank_mask:0xf
    s_nop 1
    v_readlane_b32 s48, v58, 0
    v_readlane_b32 s49, v58, 16
    v_readlane_b32 s50, v58, 32
    v_readlane_b32 s51, v58, 48
    s_nop 1
    v_mov_b32 v58, s48
    v_add_f32 v58, s49, v58
    v_add_f32 v58, s50, v58
    v_add_f32 v58, s51, v58
    v_mul_f32 v58, 0x3bcccccd, v58
    v_sub_f32 v60, v52, v58
    v_mul_f32 v59, v60, v60
    v_sub_f32 v60, v53, v58
    v_fmac_f32 v59, v60, v60
    v_sub_f32 v60, v54, v58
    v_fmac_f32 v59, v60, v60
    v_sub_f32 v60, v55, v58
    v_fmac_f32 v59, v60, v60
    v_mul_f32 v59, v59, v56
    s_nop 1
    v_add_f32_dpp v59, v59, v59 quad_perm:[1,0,3,2] row_mask:0xf bank_mask:0xf
    s_nop 1
    v_add_f32_dpp v59, v59, v59 quad_perm:[2,3,0,1] row_mask:0xf bank_mask:0xf
    s_nop 1
    v_add_f32_dpp v59, v59, v59 row_half_mirror row_mask:0xf bank_mask:0xf
    s_nop 1
    v_add_f32_dpp v59, v59, v59 row_mirror row_mask:0xf bank_mask:0xf
    s_nop 1
    v_readlane_b32 s48, v59, 0
    v_readlane_b32 s49, v59, 16
    v_readlane_b32 s50, v59, 32
    v_readlane_b32 s51, v59, 48
    s_nop 1
    v_mov_b32 v59, s48
    v_add_f32 v59, s49, v59
    v_add_f32 v59, s50, v59
    v_add_f32 v59, s51, v59
    s_lshl_b32 s49, s53, 5
    s_and_b32 s49, s49, 96
    s_and_b32 s50, s53, 12
    s_lshl_b32 s50, s50, 1
    s_add_u32 s50, s50, s49
    v_mov_b32 v60, s50
    v_mov_b32 v61, s49
    ds_write_b64 v60, v[58:59] offset:29696
    s_waitcnt lgkmcnt(0)
    s_barrier
    ds_read_b128 v[16:19], v61 offset:29696
    ds_read_b128 v[20:23], v61 offset:29712
    s_waitcnt lgkmcnt(0)
    v_add_f32 v24, v16, v18
    v_add_f32 v25, v20, v22
    v_add_f32 v24, v24, v25
    v_mul_f32 v24, 0.25, v24
    v_add_f32 v25, v17, v19
    v_add_f32 v26, v21, v23
    v_add_f32 v25, v25, v26
    v_sub_f32 v16, v16, v24
    v_sub_f32 v18, v18, v24
    v_sub_f32 v20, v20, v24
    v_sub_f32 v22, v22, v24
    v_mul_f32 v26, v16, v16
    v_fmac_f32 v26, v18, v18
    v_fmac_f32 v26, v20, v20
    v_fmac_f32 v26, v22, v22
    v_mov_b32 v27, 0x43200000
    v_fmac_f32 v25, v26, v27
    v_mul_f32 v25, 0x3acccccd, v25
    v_cvt_pk_bf16_f32 v24, v24, v24
    v_lshlrev_b32 v24, 16, v24
    v_cvt_pk_bf16_f32 v25, v25, v25
    v_lshlrev_b32 v25, 16, v25
    v_add_f32 v25, 0x3727c5ac, v25
    v_cvt_pk_bf16_f32 v25, v25, v25
    v_lshlrev_b32 v25, 16, v25
    v_sqrt_f32 v25, v25
    s_nop 0
    v_cvt_pk_bf16_f32 v25, v25, v25
    v_lshlrev_b32 v25, 16, v25
    v_rcp_f32 v25, v25
    s_nop 0
    v_sub_f32 v28, v52, v24
    v_cvt_pk_bf16_f32 v28, v28, v28
    v_lshlrev_b32 v28, 16, v28
    v_mul_f32 v28, v28, v25
    v_cvt_pk_bf16_f32 v28, v28, v28
    v_lshlrev_b32 v28, 16, v28
    v_sub_f32 v29, v53, v24
    v_cvt_pk_bf16_f32 v29, v29, v29
    v_lshlrev_b32 v29, 16, v29
    v_mul_f32 v29, v29, v25
    v_cvt_pk_bf16_f32 v29, v29, v29
    v_lshlrev_b32 v29, 16, v29
    v_sub_f32 v30, v54, v24
    v_cvt_pk_bf16_f32 v30, v30, v30
    v_lshlrev_b32 v30, 16, v30
    v_mul_f32 v30, v30, v25
    v_cvt_pk_bf16_f32 v30, v30, v30
    v_lshlrev_b32 v30, 16, v30
    v_sub_f32 v31, v55, v24
    v_cvt_pk_bf16_f32 v31, v31, v31
    v_lshlrev_b32 v31, 16, v31
    v_mul_f32 v31, v31, v25
    v_cvt_pk_bf16_f32 v31, v31, v31
    v_lshlrev_b32 v31, 16, v31
    v_cvt_pk_bf16_f32 v32, v28, v29
    v_cvt_pk_bf16_f32 v33, v30, v31
    s_mov_b32 exec_lo, -1
    s_mov_b32 exec_hi, 0xff
    ds_write_b64 v62, v[32:33] offset:18944
    s_mov_b64 exec, -1
    s_waitcnt vmcnt(0) lgkmcnt(0)
    s_barrier
    s_lshr_b32 s48, s53, 2
    s_and_b32 s49, s53, 3
    s_mul_i32 s50, s48, 320
    s_add_u32 s50, s50, 18944
    v_add_u32 v12, s50, v8
    s_mul_i32 s50, s48, 20480
    s_lshl_b32 s49, s49, 5
    s_add_u32 s50, s50, s49
    s_add_u32 s50, s50, 42496
    v_add_u32 v13, s50, v9
    s_waitcnt vmcnt(0)
    ds_read_b128 v[16:19], v12 offset:0
    ds_read_b64_tr_b16 v[36:37], v13 offset:0
    ds_read_b64_tr_b16 v[38:39], v13 offset:512
    ds_read_b128 v[20:23], v12 offset:64
    ds_read_b64_tr_b16 v[40:41], v13 offset:4096
    ds_read_b64_tr_b16 v[42:43], v13 offset:4608
    ds_read_b128 v[24:27], v12 offset:128
    ds_read_b64_tr_b16 v[44:45], v13 offset:8192
    ds_read_b64_tr_b16 v[46:47], v13 offset:8704
    ds_read_b128 v[28:31], v12 offset:192
    ds_read_b64_tr_b16 v[48:49], v13 offset:12288
    ds_read_b64_tr_b16 v[50:51], v13 offset:12800
    ds_read_b128 v[32:35], v12 offset:256
    ds_read_b64_tr_b16 v[52:53], v13 offset:16384
    ds_read_b64_tr_b16 v[54:55], v13 offset:16896
    s_waitcnt lgkmcnt(12)
    v_mfma_f32_16x16x32_bf16 v[64:67], v[16:19], v[36:39], 0
    s_waitcnt lgkmcnt(9)
    v_mfma_f32_16x16x32_bf16 v[64:67], v[20:23], v[40:43], v[64:67]
    s_waitcnt lgkmcnt(6)
    v_mfma_f32_16x16x32_bf16 v[64:67], v[24:27], v[44:47], v[64:67]
    s_waitcnt lgkmcnt(3)
    v_mfma_f32_16x16x32_bf16 v[64:67], v[28:31], v[48:51], v[64:67]
    s_waitcnt lgkmcnt(0)
    v_mfma_f32_16x16x32_bf16 v[64:67], v[32:35], v[52:55], v[64:67]
    s_nop 15
    s_lshr_b32 s48, s53, 2
    s_and_b32 s49, s53, 3
    s_mul_i32 s48, s48, 1024
    s_lshl_b32 s49, s49, 6
    s_add_u32 s48, s48, s49
    v_lshlrev_b32 v12, 2, v6
    v_add_u32 v12, s48, v12
    s_mov_b64 exec, 0xffff
    ds_write_b32 v12, v64 offset:13824
    ds_write_b32 v12, v65 offset:14080
    ds_write_b32 v12, v66 offset:14336
    ds_write_b32 v12, v67 offset:14592
    s_mov_b64 exec, -1
    s_waitcnt lgkmcnt(0)
    s_barrier
    s_cmp_ge_u32 s53, 4
    s_cbranch_scc1 L_done
    v_lshlrev_b32 v12, 2, v0
    ds_read_b32 v16, v12 offset:13824
    ds_read_b32 v17, v12 offset:14848
    ds_read_b32 v18, v12 offset:15872
    ds_read_b32 v19, v12 offset:16896
    s_waitcnt lgkmcnt(0)
    v_add_f32 v16, v16, v17
    v_add_f32 v18, v18, v19
    v_add_f32 v16, v16, v18
    s_nop 1
    v_mov_b32_dpp v17, v16 quad_perm:[1,0,3,2] row_mask:0xf bank_mask:0xf
    v_cvt_pk_bf16_f32 v16, v16, v17
    v_mul_u32_u24 v12, 3072, v7
    v_lshl_add_u32 v12, v6, 1, v12
    s_mul_i32 s48, s54, 16384
    s_lshl_b32 s49, s55, 7
    s_add_u32 s48, s48, s49
    s_add_u32 s48, s48, 360448
    s_mov_b32 exec_lo, 0x55555555
    s_mov_b32 exec_hi, 0x55555555
    buffer_store_dword v16, v12, s[32:35], s48 offen sc0 sc1
    s_mov_b64 exec, -1
L_done:
    s_endpgm
.section .rodata,"a"
.p2align 6
.amdhsa_kernel sequential_preLN__mha_block_cached__moe_arch_mod__decode_kernel
  .amdhsa_next_free_vgpr 128
  .amdhsa_next_free_sgpr 102
  .amdhsa_accum_offset 128
  .amdhsa_group_segment_fixed_size 0
  .amdhsa_kernarg_size 104
  .amdhsa_user_sgpr_count 2
  .amdhsa_user_sgpr_kernarg_segment_ptr 1
  .amdhsa_system_sgpr_workgroup_id_x 1
.end_amdhsa_kernel
```

```asm
; @launch grid=(256,1,1) block=(1024,1,1) lds=140800
.amdgcn_target "amdgcn-amd-amdhsa--gfx950"
.text
.globl sequential_preLN__mha_block_cached__moe_arch_mod__decode_kernel
.p2align 8
.type sequential_preLN__mha_block_cached__moe_arch_mod__decode_kernel,@function
sequential_preLN__mha_block_cached__moe_arch_mod__decode_kernel:
    s_cmp_ge_u32 s2, 256
    s_cbranch_scc1 L_done
    s_load_dwordx2 s[4:5], s[0:1], 0
    s_load_dwordx4 s[8:11], s[0:1], 8
    s_load_dwordx4 s[12:15], s[0:1], 24
    s_load_dwordx4 s[80:83], s[0:1], 48
    s_load_dwordx4 s[84:87], s[0:1], 64
    s_load_dwordx4 s[88:91], s[0:1], 80
    s_load_dwordx2 s[6:7], s[0:1], 96
    s_and_b32 s42, s2, 7
    s_lshr_b32 s43, s2, 3
    s_and_b32 s44, s43, 3
    s_lshl_b32 s45, s42, 2
    s_add_u32 s45, s45, s44
    s_lshr_b32 s44, s43, 2
    s_lshr_b32 s46, s44, 1
    s_and_b32 s47, s44, 1
    s_lshl_b32 s40, s46, 5
    s_add_u32 s40, s40, s45
    s_lshl_b32 s40, s40, 1
    s_add_u32 s40, s40, s47
    s_mul_i32 s41, s40, 1572864
    s_lshr_b32 s99, s45, 3
    s_mov_b32 s96, 1572864
    v_and_b32 v6, 63, v0
    v_lshrrev_b32 v2, 6, v0
    v_lshrrev_b32 v3, 3, v6
    v_and_b32 v4, 7, v6
    v_readfirstlane_b32 s53, v2
    v_lshlrev_b32 v4, 4, v4
    v_mul_u32_u24 v5, 384, v3
    v_add_u32 v1, v5, v4
    v_mul_u32_u24 v5, 40, v2
    v_add_u32 v5, v5, v3
    v_mul_u32_u24 v7, 12288, v5
    v_add_u32 v7, v7, v4
    v_lshlrev_b32 v8, 1, v5
    v_lshlrev_b32 v5, 2, v6
    s_waitcnt lgkmcnt(0)
    s_mov_b32 s56, s4
    s_and_b32 s57, s5, 0xffff
    s_mov_b32 s58, 0x1400
    s_mov_b32 s59, 0x00020000
    s_mul_i32 s48, s46, 1280
    s_add_u32 s4, s4, s48
    s_addc_u32 s5, s5, 0
    s_mov_b32 s28, s4
    s_and_b32 s29, s5, 0xffff
    s_mov_b32 s30, 0x500
    s_mov_b32 s31, 0x00020000
    s_mul_i32 s48, s45, 384
    s_add_u32 s12, s12, s48
    s_addc_u32 s13, s13, 0
    s_sub_u32 s49, 7864320, s48
    s_mov_b32 s24, s12
    s_and_b32 s25, s13, 0xffff
    s_mov_b32 s26, s49
    s_mov_b32 s27, 0x00020000
    s_add_u32 s8, s8, s41
    s_addc_u32 s9, s9, 0
    s_mov_b32 s16, s8
    s_and_b32 s17, s9, 0xffff
    s_mov_b32 s18, s96
    s_mov_b32 s19, 0x00020000
    s_add_u32 s10, s10, s41
    s_addc_u32 s11, s11, 0
    s_mov_b32 s20, s10
    s_and_b32 s21, s11, 0xffff
    s_mov_b32 s22, s96
    s_mov_b32 s23, 0x00020000
    s_mov_b32 s32, s6
    s_and_b32 s33, s7, 0xffff
    s_mov_b32 s34, 0x200000
    s_mov_b32 s35, 0x00020000
    s_mov_b32 s36, s90
    s_and_b32 s37, s91, 0xffff
    s_mov_b32 s38, 0x100
    s_mov_b32 s39, 0x00020000
    s_mov_b32 s60, s14
    s_and_b32 s61, s15, 0xffff
    s_mov_b32 s62, 0x780000
    s_mov_b32 s63, 0x00020000
    s_mov_b32 s64, s82
    s_and_b32 s65, s83, 0xffff
    s_mov_b32 s66, 0x1e0000
    s_mov_b32 s67, 0x00020000
    s_mov_b32 s92, s84
    s_and_b32 s93, s85, 0xffff
    s_mov_b32 s94, 0x1e0000
    s_mov_b32 s95, 0x00020000
    s_mov_b32 s68, s86
    s_and_b32 s69, s87, 0xffff
    s_mov_b32 s70, 0x1e0000
    s_mov_b32 s71, 0x00020000
    s_mov_b32 s72, s80
    s_and_b32 s73, s81, 0xffff
    s_mov_b32 s74, 0x500
    s_mov_b32 s75, 0x00020000
    s_mov_b32 s76, s88
    s_and_b32 s77, s89, 0xffff
    s_mov_b32 s78, 0x1400
    s_mov_b32 s79, 0x00020000
    s_mul_i32 s48, s2, 6554
    s_lshr_b32 s54, s48, 16
    s_mul_i32 s48, s54, 10
    s_sub_u32 s55, s2, s48
    s_mov_b32 s98, 0
    s_cmp_lt_u32 s2, 80
    s_cbranch_scc1 L_role_1
    s_mov_b32 s98, 1
    s_sub_u32 s55, s2, 80
    s_cmp_ge_u32 s55, 24
    s_cselect_b32 s54, 1, 0
    s_mul_i32 s48, s54, 24
    s_sub_u32 s55, s55, s48
    s_cmp_lt_u32 s2, 128
    s_cbranch_scc1 L_role_1
    s_mov_b32 s98, 2
    s_sub_u32 s55, s2, 128
    s_cmp_lt_u32 s2, 148
    s_cbranch_scc1 L_role_1
    s_mov_b32 s98, 3
L_role_1:
    v_mov_b32 v2, -1
    v_lshlrev_b32 v3, 2, v0
    v_cmp_gt_u32 vcc, 384, v0
    s_and_saveexec_b64 s[100:101], vcc
    s_cbranch_execz L_clr1
    s_mul_i32 s48, s40, 1536
    s_add_u32 s48, s48, 1048576
    buffer_store_dword v2, v3, s[32:35], s48 offen sc0 sc1
    v_cmp_eq_u32 vcc, 0, v0
    s_and_b64 exec, exec, vcc
    s_cbranch_execz L_clr1
    s_lshl_b32 s48, s2, 7
    s_add_u32 s48, s48, 458752
    buffer_store_dword v2, v3, s[32:35], s48 offen sc0 sc1
    buffer_store_dword v2, v3, s[32:35], s48 offen offset:4 sc0 sc1
L_clr1:
    s_mov_b64 exec, s[100:101]
    s_cmp_ge_u32 s98, 2
    s_cbranch_scc1 L_clr3
    s_cmp_eq_u32 s98, 1
    s_cbranch_scc1 L_clr_d
    v_cmp_gt_u32 vcc, 256, v0
    s_and_saveexec_b64 s[100:101], vcc
    s_cbranch_execz L_clr2
    v_lshrrev_b32 v3, 6, v0
    v_mul_u32_u24 v3, 2560, v3
    v_and_b32 v4, 63, v0
    v_lshl_add_u32 v3, v4, 2, v3
    s_mul_i32 s48, s54, 10240
    s_lshl_b32 s49, s55, 8
    s_add_u32 s48, s48, s49
    s_add_u32 s48, s48, 262144
    buffer_store_dword v2, v3, s[32:35], s48 offen sc0 sc1
    v_cmp_eq_u32 vcc, 0, v0
    s_and_b64 exec, exec, vcc
    s_cbranch_execz L_clr2
    s_lshl_b32 s48, s2, 2
    s_add_u32 s48, s48, 454656
    buffer_store_dword v2, v3, s[32:35], s48 offen sc0 sc1
    s_branch L_clr2
L_clr_d:
    v_cmp_gt_u32 vcc, 128, v0
    s_and_saveexec_b64 s[100:101], vcc
    s_cbranch_execz L_clr2
    v_lshrrev_b32 v3, 5, v0
    v_mul_u32_u24 v3, 3072, v3
    v_and_b32 v4, 31, v0
    v_lshl_add_u32 v3, v4, 2, v3
    s_mul_i32 s48, s54, 16384
    s_lshl_b32 s49, s55, 7
    s_add_u32 s48, s48, s49
    s_add_u32 s48, s48, 360448
    buffer_store_dword v2, v3, s[32:35], s48 offen sc0 sc1
L_clr2:
    s_mov_b64 exec, s[100:101]
L_clr3:
    v_mov_b32 v3, 12928
    v_mov_b32 v4, 16
    ds_write_b32 v3, v4
    buffer_load_dword v46, v5, s[28:31], 0 offen offset:0
    buffer_load_dword v47, v5, s[28:31], 0 offen offset:256
    buffer_load_dword v48, v5, s[28:31], 0 offen offset:512
    buffer_load_dword v49, v5, s[28:31], 0 offen offset:768
    buffer_load_dword v50, v5, s[28:31], 0 offen offset:1024
    buffer_load_ushort v51, v8, s[28:31], 0 offen offset:0
    buffer_load_ushort v52, v8, s[28:31], 0 offen offset:16
    buffer_load_ushort v53, v8, s[28:31], 0 offen offset:32
    buffer_load_ushort v126, v8, s[28:31], 0 offen offset:48
    buffer_load_ushort v127, v8, s[28:31], 0 offen offset:64
    s_mov_b32 s48, 0
    buffer_load_dwordx4 v[102:105], v7, s[24:27], s48 offen offset:0 nt
    buffer_load_dwordx4 v[106:109], v7, s[24:27], s48 offen offset:128 nt
    buffer_load_dwordx4 v[110:113], v7, s[24:27], s48 offen offset:256 nt
    s_mov_b32 s48, 98304
    buffer_load_dwordx4 v[114:117], v7, s[24:27], s48 offen offset:0 nt
    buffer_load_dwordx4 v[118:121], v7, s[24:27], s48 offen offset:128 nt
    buffer_load_dwordx4 v[122:125], v7, s[24:27], s48 offen offset:256 nt
    s_mov_b32 s48, 196608
    buffer_load_dwordx4 v[10:13], v7, s[24:27], s48 offen offset:0 nt
    buffer_load_dwordx4 v[14:17], v7, s[24:27], s48 offen offset:128 nt
    buffer_load_dwordx4 v[18:21], v7, s[24:27], s48 offen offset:256 nt
    s_mov_b32 s48, 294912
    buffer_load_dwordx4 v[22:25], v7, s[24:27], s48 offen offset:0 nt
    buffer_load_dwordx4 v[26:29], v7, s[24:27], s48 offen offset:128 nt
    buffer_load_dwordx4 v[30:33], v7, s[24:27], s48 offen offset:256 nt
    s_mov_b32 s48, 393216
    buffer_load_dwordx4 v[34:37], v7, s[24:27], s48 offen offset:0 nt
    buffer_load_dwordx4 v[38:41], v7, s[24:27], s48 offen offset:128 nt
    buffer_load_dwordx4 v[42:45], v7, s[24:27], s48 offen offset:256 nt
    s_mul_i32 s41, s53, 24576
    s_barrier
    s_add_u32 s48, s41, 0
    buffer_load_dwordx4 v[78:81], v1, s[16:19], s48 offen offset:0 nt
    buffer_load_dwordx4 v[82:85], v1, s[16:19], s48 offen offset:128 nt
    buffer_load_dwordx4 v[86:89], v1, s[16:19], s48 offen offset:256 nt
    s_add_u32 s48, s41, 3072
    buffer_load_dwordx4 v[90:93], v1, s[16:19], s48 offen offset:0 nt
    buffer_load_dwordx4 v[94:97], v1, s[16:19], s48 offen offset:128 nt
    buffer_load_dwordx4 v[98:101], v1, s[16:19], s48 offen offset:256 nt
    s_waitcnt vmcnt(26)
    v_lshlrev_b32 v54, 16, v46
    v_and_b32 v55, 0xffff0000, v46
    v_lshlrev_b32 v56, 16, v47
    v_and_b32 v57, 0xffff0000, v47
    v_lshlrev_b32 v58, 16, v48
    v_and_b32 v59, 0xffff0000, v48
    v_lshlrev_b32 v60, 16, v49
    v_and_b32 v61, 0xffff0000, v49
    v_lshlrev_b32 v62, 16, v50
    v_and_b32 v63, 0xffff0000, v50
    v_add_f32 v2, v54, v55
    v_add_f32 v2, v2, v56
    v_add_f32 v2, v2, v57
    v_add_f32 v2, v2, v58
    v_add_f32 v2, v2, v59
    v_add_f32 v2, v2, v60
    v_add_f32 v2, v2, v61
    v_add_f32 v2, v2, v62
    v_add_f32 v2, v2, v63
    s_nop 1
    v_add_f32_dpp v2, v2, v2 quad_perm:[1,0,3,2] row_mask:0xf bank_mask:0xf
    s_nop 1
    v_add_f32_dpp v2, v2, v2 quad_perm:[2,3,0,1] row_mask:0xf bank_mask:0xf
    s_nop 1
    v_add_f32_dpp v2, v2, v2 row_half_mirror row_mask:0xf bank_mask:0xf
    s_nop 1
    v_add_f32_dpp v2, v2, v2 row_mirror row_mask:0xf bank_mask:0xf
    s_nop 1
    v_readlane_b32 s48, v2, 0
    v_readlane_b32 s49, v2, 16
    v_readlane_b32 s50, v2, 32
    v_readlane_b32 s51, v2, 48
    s_nop 1
    v_mov_b32 v2, s48
    v_add_f32 v2, s49, v2
    v_add_f32 v2, s50, v2
    v_add_f32 v2, s51, v2
    v_mul_f32 v2, 0x3acccccd, v2
    v_sub_f32 v4, v54, v2
    v_mul_f32 v3, v4, v4
    v_sub_f32 v4, v55, v2
    v_fmac_f32 v3, v4, v4
    v_sub_f32 v4, v56, v2
    v_fmac_f32 v3, v4, v4
    v_sub_f32 v4, v57, v2
    v_fmac_f32 v3, v4, v4
    v_sub_f32 v4, v58, v2
    v_fmac_f32 v3, v4, v4
    v_sub_f32 v4, v59, v2
    v_fmac_f32 v3, v4, v4
    v_sub_f32 v4, v60, v2
    v_fmac_f32 v3, v4, v4
    v_sub_f32 v4, v61, v2
    v_fmac_f32 v3, v4, v4
    v_sub_f32 v4, v62, v2
    v_fmac_f32 v3, v4, v4
    v_sub_f32 v4, v63, v2
    v_fmac_f32 v3, v4, v4
    s_nop 1
    v_add_f32_dpp v3, v3, v3 quad_perm:[1,0,3,2] row_mask:0xf bank_mask:0xf
    s_nop 1
    v_add_f32_dpp v3, v3, v3 quad_perm:[2,3,0,1] row_mask:0xf bank_mask:0xf
    s_nop 1
    v_add_f32_dpp v3, v3, v3 row_half_mirror row_mask:0xf bank_mask:0xf
    s_nop 1
    v_add_f32_dpp v3, v3, v3 row_mirror row_mask:0xf bank_mask:0xf
    s_nop 1
    v_readlane_b32 s48, v3, 0
    v_readlane_b32 s49, v3, 16
    v_readlane_b32 s50, v3, 32
    v_readlane_b32 s51, v3, 48
    s_nop 1
    v_mov_b32 v3, s48
    v_add_f32 v3, s49, v3
    v_add_f32 v3, s50, v3
    v_add_f32 v3, s51, v3
    v_mul_f32 v3, 0x3acccccd, v3
    v_cvt_pk_bf16_f32 v2, v2, v2
    v_lshlrev_b32 v2, 16, v2
    v_cvt_pk_bf16_f32 v3, v3, v3
    v_lshlrev_b32 v3, 16, v3
    v_add_f32 v3, 0x3727c5ac, v3
    v_cvt_pk_bf16_f32 v3, v3, v3
    v_lshlrev_b32 v3, 16, v3
    v_sqrt_f32 v3, v3
    s_nop 0
    v_cvt_pk_bf16_f32 v3, v3, v3
    v_lshlrev_b32 v3, 16, v3
    v_rcp_f32 v3, v3
    s_waitcnt vmcnt(21)
    v_lshlrev_b32 v51, 16, v51
    v_sub_f32 v51, v51, v2
    v_cvt_pk_bf16_f32 v51, v51, v51
    v_lshlrev_b32 v51, 16, v51
    v_mul_f32 v51, v51, v3
    v_cvt_pk_bf16_f32 v51, v51, v51
    v_lshlrev_b32 v51, 16, v51
    v_lshlrev_b32 v52, 16, v52
    v_sub_f32 v52, v52, v2
    v_cvt_pk_bf16_f32 v52, v52, v52
    v_lshlrev_b32 v52, 16, v52
    v_mul_f32 v52, v52, v3
    v_cvt_pk_bf16_f32 v52, v52, v52
    v_lshlrev_b32 v52, 16, v52
    v_lshlrev_b32 v53, 16, v53
    v_sub_f32 v53, v53, v2
    v_cvt_pk_bf16_f32 v53, v53, v53
    v_lshlrev_b32 v53, 16, v53
    v_mul_f32 v53, v53, v3
    v_cvt_pk_bf16_f32 v53, v53, v53
    v_lshlrev_b32 v53, 16, v53
    v_lshlrev_b32 v126, 16, v126
    v_sub_f32 v126, v126, v2
    v_cvt_pk_bf16_f32 v126, v126, v126
    v_lshlrev_b32 v126, 16, v126
    v_mul_f32 v126, v126, v3
    v_cvt_pk_bf16_f32 v126, v126, v126
    v_lshlrev_b32 v126, 16, v126
    v_lshlrev_b32 v127, 16, v127
    v_sub_f32 v127, v127, v2
    v_cvt_pk_bf16_f32 v127, v127, v127
    v_lshlrev_b32 v127, 16, v127
    v_mul_f32 v127, v127, v3
    v_cvt_pk_bf16_f32 v127, v127, v127
    v_lshlrev_b32 v127, 16, v127
    s_waitcnt vmcnt(18)
    v_lshlrev_b32 v2, 16, v102
    v_and_b32 v3, 0xffff0000, v102
    v_mul_f32 v54, v51, v2
    v_mul_f32 v55, v51, v3
    v_lshlrev_b32 v2, 16, v103
    v_and_b32 v3, 0xffff0000, v103
    v_mul_f32 v56, v51, v2
    v_mul_f32 v57, v51, v3
    v_lshlrev_b32 v2, 16, v104
    v_and_b32 v3, 0xffff0000, v104
    v_mul_f32 v58, v51, v2
    v_mul_f32 v59, v51, v3
    v_lshlrev_b32 v2, 16, v105
    v_and_b32 v3, 0xffff0000, v105
    v_mul_f32 v60, v51, v2
    v_mul_f32 v61, v51, v3
    v_lshlrev_b32 v2, 16, v106
    v_and_b32 v3, 0xffff0000, v106
    v_mul_f32 v62, v51, v2
    v_mul_f32 v63, v51, v3
    v_lshlrev_b32 v2, 16, v107
    v_and_b32 v3, 0xffff0000, v107
    v_mul_f32 v64, v51, v2
    v_mul_f32 v65, v51, v3
    v_lshlrev_b32 v2, 16, v108
    v_and_b32 v3, 0xffff0000, v108
    v_mul_f32 v66, v51, v2
    v_mul_f32 v67, v51, v3
    v_lshlrev_b32 v2, 16, v109
    v_and_b32 v3, 0xffff0000, v109
    v_mul_f32 v68, v51, v2
    v_mul_f32 v69, v51, v3
    v_lshlrev_b32 v2, 16, v110
    v_and_b32 v3, 0xffff0000, v110
    v_mul_f32 v70, v51, v2
    v_mul_f32 v71, v51, v3
    v_lshlrev_b32 v2, 16, v111
    v_and_b32 v3, 0xffff0000, v111
    v_mul_f32 v72, v51, v2
    v_mul_f32 v73, v51, v3
    v_lshlrev_b32 v2, 16, v112
    v_and_b32 v3, 0xffff0000, v112
    v_mul_f32 v74, v51, v2
    v_mul_f32 v75, v51, v3
    v_lshlrev_b32 v2, 16, v113
    v_and_b32 v3, 0xffff0000, v113
    v_mul_f32 v76, v51, v2
    v_mul_f32 v77, v51, v3
    s_add_u32 s48, s41, 6144
    buffer_load_dwordx4 v[102:105], v1, s[16:19], s48 offen offset:0 nt
    buffer_load_dwordx4 v[106:109], v1, s[16:19], s48 offen offset:128 nt
    buffer_load_dwordx4 v[110:113], v1, s[16:19], s48 offen offset:256 nt
    s_waitcnt vmcnt(18)
    v_lshlrev_b32 v2, 16, v114
    v_and_b32 v3, 0xffff0000, v114
    v_fmac_f32 v54, v52, v2
    v_fmac_f32 v55, v52, v3
    v_lshlrev_b32 v2, 16, v115
    v_and_b32 v3, 0xffff0000, v115
    v_fmac_f32 v56, v52, v2
    v_fmac_f32 v57, v52, v3
    v_lshlrev_b32 v2, 16, v116
    v_and_b32 v3, 0xffff0000, v116
    v_fmac_f32 v58, v52, v2
    v_fmac_f32 v59, v52, v3
    v_lshlrev_b32 v2, 16, v117
    v_and_b32 v3, 0xffff0000, v117
    v_fmac_f32 v60, v52, v2
    v_fmac_f32 v61, v52, v3
    v_lshlrev_b32 v2, 16, v118
    v_and_b32 v3, 0xffff0000, v118
    v_fmac_f32 v62, v52, v2
    v_fmac_f32 v63, v52, v3
    v_lshlrev_b32 v2, 16, v119
    v_and_b32 v3, 0xffff0000, v119
    v_fmac_f32 v64, v52, v2
    v_fmac_f32 v65, v52, v3
    v_lshlrev_b32 v2, 16, v120
    v_and_b32 v3, 0xffff0000, v120
    v_fmac_f32 v66, v52, v2
    v_fmac_f32 v67, v52, v3
    v_lshlrev_b32 v2, 16, v121
    v_and_b32 v3, 0xffff0000, v121
    v_fmac_f32 v68, v52, v2
    v_fmac_f32 v69, v52, v3
    v_lshlrev_b32 v2, 16, v122
    v_and_b32 v3, 0xffff0000, v122
    v_fmac_f32 v70, v52, v2
    v_fmac_f32 v71, v52, v3
    v_lshlrev_b32 v2, 16, v123
    v_and_b32 v3, 0xffff0000, v123
    v_fmac_f32 v72, v52, v2
    v_fmac_f32 v73, v52, v3
    v_lshlrev_b32 v2, 16, v124
    v_and_b32 v3, 0xffff0000, v124
    v_fmac_f32 v74, v52, v2
    v_fmac_f32 v75, v52, v3
    v_lshlrev_b32 v2, 16, v125
    v_and_b32 v3, 0xffff0000, v125
    v_fmac_f32 v76, v52, v2
    v_fmac_f32 v77, v52, v3
    s_add_u32 s48, s41, 9216
    buffer_load_dwordx4 v[114:117], v1, s[16:19], s48 offen offset:0 nt
    buffer_load_dwordx4 v[118:121], v1, s[16:19], s48 offen offset:128 nt
    buffer_load_dwordx4 v[122:125], v1, s[16:19], s48 offen offset:256 nt
    s_waitcnt vmcnt(18)
    v_lshlrev_b32 v2, 16, v10
    v_and_b32 v3, 0xffff0000, v10
    v_fmac_f32 v54, v53, v2
    v_fmac_f32 v55, v53, v3
    v_lshlrev_b32 v2, 16, v11
    v_and_b32 v3, 0xffff0000, v11
    v_fmac_f32 v56, v53, v2
    v_fmac_f32 v57, v53, v3
    v_lshlrev_b32 v2, 16, v12
    v_and_b32 v3, 0xffff0000, v12
    v_fmac_f32 v58, v53, v2
    v_fmac_f32 v59, v53, v3
    v_lshlrev_b32 v2, 16, v13
    v_and_b32 v3, 0xffff0000, v13
    v_fmac_f32 v60, v53, v2
    v_fmac_f32 v61, v53, v3
    v_lshlrev_b32 v2, 16, v14
    v_and_b32 v3, 0xffff0000, v14
    v_fmac_f32 v62, v53, v2
    v_fmac_f32 v63, v53, v3
    v_lshlrev_b32 v2, 16, v15
    v_and_b32 v3, 0xffff0000, v15
    v_fmac_f32 v64, v53, v2
    v_fmac_f32 v65, v53, v3
    v_lshlrev_b32 v2, 16, v16
    v_and_b32 v3, 0xffff0000, v16
    v_fmac_f32 v66, v53, v2
    v_fmac_f32 v67, v53, v3
    v_lshlrev_b32 v2, 16, v17
    v_and_b32 v3, 0xffff0000, v17
    v_fmac_f32 v68, v53, v2
    v_fmac_f32 v69, v53, v3
    v_lshlrev_b32 v2, 16, v18
    v_and_b32 v3, 0xffff0000, v18
    v_fmac_f32 v70, v53, v2
    v_fmac_f32 v71, v53, v3
    v_lshlrev_b32 v2, 16, v19
    v_and_b32 v3, 0xffff0000, v19
    v_fmac_f32 v72, v53, v2
    v_fmac_f32 v73, v53, v3
    v_lshlrev_b32 v2, 16, v20
    v_and_b32 v3, 0xffff0000, v20
    v_fmac_f32 v74, v53, v2
    v_fmac_f32 v75, v53, v3
    v_lshlrev_b32 v2, 16, v21
    v_and_b32 v3, 0xffff0000, v21
    v_fmac_f32 v76, v53, v2
    v_fmac_f32 v77, v53, v3
    s_waitcnt vmcnt(15)
    v_lshlrev_b32 v2, 16, v22
    v_and_b32 v3, 0xffff0000, v22
    v_fmac_f32 v54, v126, v2
    v_fmac_f32 v55, v126, v3
    v_lshlrev_b32 v2, 16, v23
    v_and_b32 v3, 0xffff0000, v23
    v_fmac_f32 v56, v126, v2
    v_fmac_f32 v57, v126, v3
    v_lshlrev_b32 v2, 16, v24
    v_and_b32 v3, 0xffff0000, v24
    v_fmac_f32 v58, v126, v2
    v_fmac_f32 v59, v126, v3
    v_lshlrev_b32 v2, 16, v25
    v_and_b32 v3, 0xffff0000, v25
    v_fmac_f32 v60, v126, v2
    v_fmac_f32 v61, v126, v3
    v_lshlrev_b32 v2, 16, v26
    v_and_b32 v3, 0xffff0000, v26
    v_fmac_f32 v62, v126, v2
    v_fmac_f32 v63, v126, v3
    v_lshlrev_b32 v2, 16, v27
    v_and_b32 v3, 0xffff0000, v27
    v_fmac_f32 v64, v126, v2
    v_fmac_f32 v65, v126, v3
    v_lshlrev_b32 v2, 16, v28
    v_and_b32 v3, 0xffff0000, v28
    v_fmac_f32 v66, v126, v2
    v_fmac_f32 v67, v126, v3
    v_lshlrev_b32 v2, 16, v29
    v_and_b32 v3, 0xffff0000, v29
    v_fmac_f32 v68, v126, v2
    v_fmac_f32 v69, v126, v3
    v_lshlrev_b32 v2, 16, v30
    v_and_b32 v3, 0xffff0000, v30
    v_fmac_f32 v70, v126, v2
    v_fmac_f32 v71, v126, v3
    v_lshlrev_b32 v2, 16, v31
    v_and_b32 v3, 0xffff0000, v31
    v_fmac_f32 v72, v126, v2
    v_fmac_f32 v73, v126, v3
    v_lshlrev_b32 v2, 16, v32
    v_and_b32 v3, 0xffff0000, v32
    v_fmac_f32 v74, v126, v2
    v_fmac_f32 v75, v126, v3
    v_lshlrev_b32 v2, 16, v33
    v_and_b32 v3, 0xffff0000, v33
    v_fmac_f32 v76, v126, v2
    v_fmac_f32 v77, v126, v3
    s_waitcnt vmcnt(12)
    v_lshlrev_b32 v2, 16, v34
    v_and_b32 v3, 0xffff0000, v34
    v_fmac_f32 v54, v127, v2
    v_fmac_f32 v55, v127, v3
    v_lshlrev_b32 v2, 16, v35
    v_and_b32 v3, 0xffff0000, v35
    v_fmac_f32 v56, v127, v2
    v_fmac_f32 v57, v127, v3
    v_lshlrev_b32 v2, 16, v36
    v_and_b32 v3, 0xffff0000, v36
    v_fmac_f32 v58, v127, v2
    v_fmac_f32 v59, v127, v3
    v_lshlrev_b32 v2, 16, v37
    v_and_b32 v3, 0xffff0000, v37
    v_fmac_f32 v60, v127, v2
    v_fmac_f32 v61, v127, v3
    v_lshlrev_b32 v2, 16, v38
    v_and_b32 v3, 0xffff0000, v38
    v_fmac_f32 v62, v127, v2
    v_fmac_f32 v63, v127, v3
    v_lshlrev_b32 v2, 16, v39
    v_and_b32 v3, 0xffff0000, v39
    v_fmac_f32 v64, v127, v2
    v_fmac_f32 v65, v127, v3
    v_lshlrev_b32 v2, 16, v40
    v_and_b32 v3, 0xffff0000, v40
    v_fmac_f32 v66, v127, v2
    v_fmac_f32 v67, v127, v3
    v_lshlrev_b32 v2, 16, v41
    v_and_b32 v3, 0xffff0000, v41
    v_fmac_f32 v68, v127, v2
    v_fmac_f32 v69, v127, v3
    v_lshlrev_b32 v2, 16, v42
    v_and_b32 v3, 0xffff0000, v42
    v_fmac_f32 v70, v127, v2
    v_fmac_f32 v71, v127, v3
    v_lshlrev_b32 v2, 16, v43
    v_and_b32 v3, 0xffff0000, v43
    v_fmac_f32 v72, v127, v2
    v_fmac_f32 v73, v127, v3
    v_lshlrev_b32 v2, 16, v44
    v_and_b32 v3, 0xffff0000, v44
    v_fmac_f32 v74, v127, v2
    v_fmac_f32 v75, v127, v3
    v_lshlrev_b32 v2, 16, v45
    v_and_b32 v3, 0xffff0000, v45
    v_fmac_f32 v76, v127, v2
    v_fmac_f32 v77, v127, v3
    s_nop 1
    v_permlane32_swap_b32 v54, v58
    v_permlane32_swap_b32 v55, v59
    v_permlane32_swap_b32 v56, v60
    v_permlane32_swap_b32 v57, v61
    v_permlane32_swap_b32 v62, v66
    v_permlane32_swap_b32 v63, v67
    v_permlane32_swap_b32 v64, v68
    v_permlane32_swap_b32 v65, v69
    v_permlane32_swap_b32 v70, v74
    v_permlane32_swap_b32 v71, v75
    v_permlane32_swap_b32 v72, v76
    v_permlane32_swap_b32 v73, v77
    v_add_f32 v54, v54, v58
    v_add_f32 v55, v55, v59
    v_add_f32 v56, v56, v60
    v_add_f32 v57, v57, v61
    v_add_f32 v62, v62, v66
    v_add_f32 v63, v63, v67
    v_add_f32 v64, v64, v68
    v_add_f32 v65, v65, v69
    v_add_f32 v70, v70, v74
    v_add_f32 v71, v71, v75
    v_add_f32 v72, v72, v76
    v_add_f32 v73, v73, v77
    s_nop 1
    v_permlane16_swap_b32 v54, v56
    v_permlane16_swap_b32 v55, v57
    v_permlane16_swap_b32 v62, v64
    v_permlane16_swap_b32 v63, v65
    v_permlane16_swap_b32 v70, v72
    v_permlane16_swap_b32 v71, v73
    v_add_f32 v54, v54, v56
    v_add_f32 v55, v55, v57
    v_add_f32 v62, v62, v64
    v_add_f32 v63, v63, v65
    v_add_f32 v70, v70, v72
    v_add_f32 v71, v71, v73
    s_nop 1
    v_add_f32_dpp v54, v54, v54 row_ror:8 row_mask:0xf bank_mask:0xf
    v_add_f32_dpp v55, v55, v55 row_ror:8 row_mask:0xf bank_mask:0xf
    v_add_f32_dpp v62, v62, v62 row_ror:8 row_mask:0xf bank_mask:0xf
    v_add_f32_dpp v63, v63, v63 row_ror:8 row_mask:0xf bank_mask:0xf
    v_add_f32_dpp v70, v70, v70 row_ror:8 row_mask:0xf bank_mask:0xf
    v_add_f32_dpp v71, v71, v71 row_ror:8 row_mask:0xf bank_mask:0xf
    v_lshrrev_b32 v2, 6, v0
    v_mul_u32_u24 v9, 768, v2
    v_and_b32 v2, 7, v6
    v_lshlrev_b32 v2, 5, v2
    v_add_u32 v9, v9, v2
    v_lshrrev_b32 v2, 5, v6
    v_lshlrev_b32 v2, 4, v2
    v_add_u32 v9, v9, v2
    v_bfe_u32 v2, v6, 4, 1
    v_lshlrev_b32 v2, 3, v2
    v_add_u32 v9, v9, v2
    ds_write_b64 v9, v[54:55] offset:0
    ds_write_b64 v9, v[62:63] offset:256
    ds_write_b64 v9, v[70:71] offset:512
    s_waitcnt lgkmcnt(0)
    s_barrier
    v_cmp_gt_u32 vcc, 192, v0
    s_and_saveexec_b64 s[100:101], vcc
    s_cbranch_execz L_q1
    v_lshlrev_b32 v2, 2, v0
    ds_read_b32 v54, v2 offset:0
    ds_read_b32 v55, v2 offset:768
    ds_read_b32 v56, v2 offset:1536
    ds_read_b32 v57, v2 offset:2304
    ds_read_b32 v58, v2 offset:3072
    ds_read_b32 v59, v2 offset:3840
    ds_read_b32 v60, v2 offset:4608
    ds_read_b32 v61, v2 offset:5376
    ds_read_b32 v62, v2 offset:6144
    ds_read_b32 v63, v2 offset:6912
    ds_read_b32 v64, v2 offset:7680
    ds_read_b32 v65, v2 offset:8448
    ds_read_b32 v66, v2 offset:9216
    ds_read_b32 v67, v2 offset:9984
    ds_read_b32 v68, v2 offset:10752
    ds_read_b32 v69, v2 offset:11520
    s_waitcnt lgkmcnt(0)
    v_add_f32 v54, v54, v55
    v_add_f32 v54, v54, v56
    v_add_f32 v54, v54, v57
    v_add_f32 v54, v54, v58
    v_add_f32 v54, v54, v59
    v_add_f32 v54, v54, v60
    v_add_f32 v54, v54, v61
    v_add_f32 v54, v54, v62
    v_add_f32 v54, v54, v63
    v_add_f32 v54, v54, v64
    v_add_f32 v54, v54, v65
    v_add_f32 v54, v54, v66
    v_add_f32 v54, v54, v67
    v_add_f32 v54, v54, v68
    v_add_f32 v54, v54, v69
    v_cvt_pk_bf16_f32 v54, v54, v54
    v_lshlrev_b32 v2, 1, v0
    ds_write_b16 v2, v54 offset:12288
    v_cmp_eq_u32 vcc, 0, v0
    s_and_b64 exec, exec, vcc
    s_cbranch_execz L_q2
    v_mov_b32 v3, 1
    v_mov_b32 v2, 4
    buffer_atomic_add v3, v2, s[36:39], 0 offen sc1
L_q2:
    s_waitcnt lgkmcnt(0)
L_q1:
    s_mov_b64 exec, s[100:101]
    s_barrier
    v_and_b32 v2, 7, v6
    v_lshlrev_b32 v2, 4, v2
    ds_read_b128 v[10:13], v2 offset:12288
    ds_read_b128 v[14:17], v2 offset:12416
    ds_read_b128 v[18:21], v2 offset:12544
    s_waitcnt lgkmcnt(0)
    v_mov_b32 v30, 0xff7fffff
    v_mov_b32 v31, 0
    v_mov_b32 v54, 0
    v_mov_b32 v55, 0
    v_mov_b32 v56, 0
    v_mov_b32 v57, 0
    v_mov_b32 v58, 0
    v_mov_b32 v59, 0
    v_mov_b32 v60, 0
    v_mov_b32 v61, 0
    v_mov_b32 v62, 0
    v_mov_b32 v63, 0
    v_mov_b32 v64, 0
    v_mov_b32 v65, 0
    v_mov_b32 v66, 0
    v_mov_b32 v67, 0
    v_mov_b32 v68, 0
    v_mov_b32 v69, 0
    v_mov_b32 v70, 0
    v_mov_b32 v71, 0
    v_mov_b32 v72, 0
    v_mov_b32 v73, 0
    v_mov_b32 v74, 0
    v_mov_b32 v75, 0
    v_mov_b32 v76, 0
    v_mov_b32 v77, 0
    v_mov_b32 v33, 12928
    v_mov_b32 v34, 1
    s_mov_b32 s52, 0x3fb8aa3b
L_loop:
    s_mov_b64 exec, 1
    ds_add_rtn_u32 v32, v33, v34
    s_mov_b64 exec, -1
    s_waitcnt vmcnt(9)
    v_dot2_f32_bf16 v2, v78, v10, 0
    v_dot2_f32_bf16 v3, v82, v14, 0
    v_dot2_f32_bf16 v4, v86, v18, 0
    v_dot2_f32_bf16 v2, v79, v11, v2
    v_dot2_f32_bf16 v3, v83, v15, v3
    v_dot2_f32_bf16 v4, v87, v19, v4
    v_dot2_f32_bf16 v2, v80, v12, v2
    v_dot2_f32_bf16 v3, v84, v16, v3
    v_dot2_f32_bf16 v4, v88, v20, v4
    v_dot2_f32_bf16 v2, v81, v13, v2
    v_dot2_f32_bf16 v3, v85, v17, v3
    v_dot2_f32_bf16 v4, v89, v21, v4
    s_add_u32 s48, s41, 12288
    buffer_load_dwordx4 v[78:81], v1, s[16:19], s48 offen offset:0 nt
    buffer_load_dwordx4 v[82:85], v1, s[16:19], s48 offen offset:128 nt
    buffer_load_dwordx4 v[86:89], v1, s[16:19], s48 offen offset:256 nt
    v_add_f32 v2, v2, v3
    v_add_f32 v2, v2, v4
    s_nop 1
    v_add_f32_dpp v2, v2, v2 quad_perm:[1,0,3,2] row_mask:0xf bank_mask:0xf
    s_nop 1
    v_add_f32_dpp v2, v2, v2 quad_perm:[2,3,0,1] row_mask:0xf bank_mask:0xf
    s_nop 1
    v_add_f32_dpp v2, v2, v2 row_half_mirror row_mask:0xf bank_mask:0xf
    v_cvt_pk_bf16_f32 v2, v2, v2
    v_lshlrev_b32 v2, 16, v2
    v_mul_f32 v2, 0x3d93cd3a, v2
    v_cvt_pk_bf16_f32 v2, v2, v2
    v_lshlrev_b32 v22, 16, v2
    s_waitcnt vmcnt(9)
    v_dot2_f32_bf16 v2, v90, v10, 0
    v_dot2_f32_bf16 v3, v94, v14, 0
    v_dot2_f32_bf16 v4, v98, v18, 0
    v_dot2_f32_bf16 v2, v91, v11, v2
    v_dot2_f32_bf16 v3, v95, v15, v3
    v_dot2_f32_bf16 v4, v99, v19, v4
    v_dot2_f32_bf16 v2, v92, v12, v2
    v_dot2_f32_bf16 v3, v96, v16, v3
    v_dot2_f32_bf16 v4, v100, v20, v4
    v_dot2_f32_bf16 v2, v93, v13, v2
    v_dot2_f32_bf16 v3, v97, v17, v3
    v_dot2_f32_bf16 v4, v101, v21, v4
    s_add_u32 s48, s41, 15360
    buffer_load_dwordx4 v[90:93], v1, s[16:19], s48 offen offset:0 nt
    buffer_load_dwordx4 v[94:97], v1, s[16:19], s48 offen offset:128 nt
    buffer_load_dwordx4 v[98:101], v1, s[16:19], s48 offen offset:256 nt
    v_add_f32 v2, v2, v3
    v_add_f32 v2, v2, v4
    s_nop 1
    v_add_f32_dpp v2, v2, v2 quad_perm:[1,0,3,2] row_mask:0xf bank_mask:0xf
    s_nop 1
    v_add_f32_dpp v2, v2, v2 quad_perm:[2,3,0,1] row_mask:0xf bank_mask:0xf
    s_nop 1
    v_add_f32_dpp v2, v2, v2 row_half_mirror row_mask:0xf bank_mask:0xf
    v_cvt_pk_bf16_f32 v2, v2, v2
    v_lshlrev_b32 v2, 16, v2
    v_mul_f32 v2, 0x3d93cd3a, v2
    v_cvt_pk_bf16_f32 v2, v2, v2
    v_lshlrev_b32 v23, 16, v2
    s_waitcnt vmcnt(9)
    v_dot2_f32_bf16 v2, v102, v10, 0
    v_dot2_f32_bf16 v3, v106, v14, 0
    v_dot2_f32_bf16 v4, v110, v18, 0
    v_dot2_f32_bf16 v2, v103, v11, v2
    v_dot2_f32_bf16 v3, v107, v15, v3
    v_dot2_f32_bf16 v4, v111, v19, v4
    v_dot2_f32_bf16 v2, v104, v12, v2
    v_dot2_f32_bf16 v3, v108, v16, v3
    v_dot2_f32_bf16 v4, v112, v20, v4
    v_dot2_f32_bf16 v2, v105, v13, v2
    v_dot2_f32_bf16 v3, v109, v17, v3
    v_dot2_f32_bf16 v4, v113, v21, v4
    s_add_u32 s48, s41, 18432
    buffer_load_dwordx4 v[102:105], v1, s[16:19], s48 offen offset:0 nt
    buffer_load_dwordx4 v[106:109], v1, s[16:19], s48 offen offset:128 nt
    buffer_load_dwordx4 v[110:113], v1, s[16:19], s48 offen offset:256 nt
    v_add_f32 v2, v2, v3
    v_add_f32 v2, v2, v4
    s_nop 1
    v_add_f32_dpp v2, v2, v2 quad_perm:[1,0,3,2] row_mask:0xf bank_mask:0xf
    s_nop 1
    v_add_f32_dpp v2, v2, v2 quad_perm:[2,3,0,1] row_mask:0xf bank_mask:0xf
    s_nop 1
    v_add_f32_dpp v2, v2, v2 row_half_mirror row_mask:0xf bank_mask:0xf
    v_cvt_pk_bf16_f32 v2, v2, v2
    v_lshlrev_b32 v2, 16, v2
    v_mul_f32 v2, 0x3d93cd3a, v2
    v_cvt_pk_bf16_f32 v2, v2, v2
    v_lshlrev_b32 v24, 16, v2
    s_waitcnt lgkmcnt(0)
    v_readfirstlane_b32 s49, v32
    s_mul_i32 s47, s49, 24576
    s_waitcnt vmcnt(9)
    v_dot2_f32_bf16 v2, v114, v10, 0
    v_dot2_f32_bf16 v3, v118, v14, 0
    v_dot2_f32_bf16 v4, v122, v18, 0
    v_dot2_f32_bf16 v2, v115, v11, v2
    v_dot2_f32_bf16 v3, v119, v15, v3
    v_dot2_f32_bf16 v4, v123, v19, v4
    v_dot2_f32_bf16 v2, v116, v12, v2
    v_dot2_f32_bf16 v3, v120, v16, v3
    v_dot2_f32_bf16 v4, v124, v20, v4
    v_dot2_f32_bf16 v2, v117, v13, v2
    v_dot2_f32_bf16 v3, v121, v17, v3
    v_dot2_f32_bf16 v4, v125, v21, v4
    s_add_u32 s48, s41, 21504
    buffer_load_dwordx4 v[114:117], v1, s[16:19], s48 offen offset:0 nt
    buffer_load_dwordx4 v[118:121], v1, s[16:19], s48 offen offset:128 nt
    buffer_load_dwordx4 v[122:125], v1, s[16:19], s48 offen offset:256 nt
    v_add_f32 v2, v2, v3
    v_add_f32 v2, v2, v4
    s_nop 1
    v_add_f32_dpp v2, v2, v2 quad_perm:[1,0,3,2] row_mask:0xf bank_mask:0xf
    s_nop 1
    v_add_f32_dpp v2, v2, v2 quad_perm:[2,3,0,1] row_mask:0xf bank_mask:0xf
    s_nop 1
    v_add_f32_dpp v2, v2, v2 row_half_mirror row_mask:0xf bank_mask:0xf
    v_cvt_pk_bf16_f32 v2, v2, v2
    v_lshlrev_b32 v2, 16, v2
    v_mul_f32 v2, 0x3d93cd3a, v2
    v_cvt_pk_bf16_f32 v2, v2, v2
    v_lshlrev_b32 v25, 16, v2
    s_waitcnt vmcnt(9)
    v_dot2_f32_bf16 v2, v78, v10, 0
    v_dot2_f32_bf16 v3, v82, v14, 0
    v_dot2_f32_bf16 v4, v86, v18, 0
    v_dot2_f32_bf16 v2, v79, v11, v2
    v_dot2_f32_bf16 v3, v83, v15, v3
    v_dot2_f32_bf16 v4, v87, v19, v4
    v_dot2_f32_bf16 v2, v80, v12, v2
    v_dot2_f32_bf16 v3, v84, v16, v3
    v_dot2_f32_bf16 v4, v88, v20, v4
    v_dot2_f32_bf16 v2, v81, v13, v2
    v_dot2_f32_bf16 v3, v85, v17, v3
    v_dot2_f32_bf16 v4, v89, v21, v4
    s_add_u32 s48, s41, 0
    buffer_load_dwordx4 v[78:81], v1, s[20:23], s48 offen offset:0 nt
    buffer_load_dwordx4 v[82:85], v1, s[20:23], s48 offen offset:128 nt
    buffer_load_dwordx4 v[86:89], v1, s[20:23], s48 offen offset:256 nt
    v_add_f32 v2, v2, v3
    v_add_f32 v2, v2, v4
    s_nop 1
    v_add_f32_dpp v2, v2, v2 quad_perm:[1,0,3,2] row_mask:0xf bank_mask:0xf
    s_nop 1
    v_add_f32_dpp v2, v2, v2 quad_perm:[2,3,0,1] row_mask:0xf bank_mask:0xf
    s_nop 1
    v_add_f32_dpp v2, v2, v2 row_half_mirror row_mask:0xf bank_mask:0xf
    v_cvt_pk_bf16_f32 v2, v2, v2
    v_lshlrev_b32 v2, 16, v2
    v_mul_f32 v2, 0x3d93cd3a, v2
    v_cvt_pk_bf16_f32 v2, v2, v2
    v_lshlrev_b32 v26, 16, v2
    s_waitcnt vmcnt(9)
    v_dot2_f32_bf16 v2, v90, v10, 0
    v_dot2_f32_bf16 v3, v94, v14, 0
    v_dot2_f32_bf16 v4, v98, v18, 0
    v_dot2_f32_bf16 v2, v91, v11, v2
    v_dot2_f32_bf16 v3, v95, v15, v3
    v_dot2_f32_bf16 v4, v99, v19, v4
    v_dot2_f32_bf16 v2, v92, v12, v2
    v_dot2_f32_bf16 v3, v96, v16, v3
    v_dot2_f32_bf16 v4, v100, v20, v4
    v_dot2_f32_bf16 v2, v93, v13, v2
    v_dot2_f32_bf16 v3, v97, v17, v3
    v_dot2_f32_bf16 v4, v101, v21, v4
    s_add_u32 s48, s41, 3072
    buffer_load_dwordx4 v[90:93], v1, s[20:23], s48 offen offset:0 nt
    buffer_load_dwordx4 v[94:97], v1, s[20:23], s48 offen offset:128 nt
    buffer_load_dwordx4 v[98:101], v1, s[20:23], s48 offen offset:256 nt
    v_add_f32 v2, v2, v3
    v_add_f32 v2, v2, v4
    s_nop 1
    v_add_f32_dpp v2, v2, v2 quad_perm:[1,0,3,2] row_mask:0xf bank_mask:0xf
    s_nop 1
    v_add_f32_dpp v2, v2, v2 quad_perm:[2,3,0,1] row_mask:0xf bank_mask:0xf
    s_nop 1
    v_add_f32_dpp v2, v2, v2 row_half_mirror row_mask:0xf bank_mask:0xf
    v_cvt_pk_bf16_f32 v2, v2, v2
    v_lshlrev_b32 v2, 16, v2
    v_mul_f32 v2, 0x3d93cd3a, v2
    v_cvt_pk_bf16_f32 v2, v2, v2
    v_lshlrev_b32 v27, 16, v2
    s_waitcnt vmcnt(9)
    v_dot2_f32_bf16 v2, v102, v10, 0
    v_dot2_f32_bf16 v3, v106, v14, 0
    v_dot2_f32_bf16 v4, v110, v18, 0
    v_dot2_f32_bf16 v2, v103, v11, v2
    v_dot2_f32_bf16 v3, v107, v15, v3
    v_dot2_f32_bf16 v4, v111, v19, v4
    v_dot2_f32_bf16 v2, v104, v12, v2
    v_dot2_f32_bf16 v3, v108, v16, v3
    v_dot2_f32_bf16 v4, v112, v20, v4
    v_dot2_f32_bf16 v2, v105, v13, v2
    v_dot2_f32_bf16 v3, v109, v17, v3
    v_dot2_f32_bf16 v4, v113, v21, v4
    s_add_u32 s48, s41, 6144
    buffer_load_dwordx4 v[102:105], v1, s[20:23], s48 offen offset:0 nt
    buffer_load_dwordx4 v[106:109], v1, s[20:23], s48 offen offset:128 nt
    buffer_load_dwordx4 v[110:113], v1, s[20:23], s48 offen offset:256 nt
    v_add_f32 v2, v2, v3
    v_add_f32 v2, v2, v4
    s_nop 1
    v_add_f32_dpp v2, v2, v2 quad_perm:[1,0,3,2] row_mask:0xf bank_mask:0xf
    s_nop 1
    v_add_f32_dpp v2, v2, v2 quad_perm:[2,3,0,1] row_mask:0xf bank_mask:0xf
    s_nop 1
    v_add_f32_dpp v2, v2, v2 row_half_mirror row_mask:0xf bank_mask:0xf
    v_cvt_pk_bf16_f32 v2, v2, v2
    v_lshlrev_b32 v2, 16, v2
    v_mul_f32 v2, 0x3d93cd3a, v2
    v_cvt_pk_bf16_f32 v2, v2, v2
    v_lshlrev_b32 v28, 16, v2
    s_waitcnt vmcnt(9)
    v_dot2_f32_bf16 v2, v114, v10, 0
    v_dot2_f32_bf16 v3, v118, v14, 0
    v_dot2_f32_bf16 v4, v122, v18, 0
    v_dot2_f32_bf16 v2, v115, v11, v2
    v_dot2_f32_bf16 v3, v119, v15, v3
    v_dot2_f32_bf16 v4, v123, v19, v4
    v_dot2_f32_bf16 v2, v116, v12, v2
    v_dot2_f32_bf16 v3, v120, v16, v3
    v_dot2_f32_bf16 v4, v124, v20, v4
    v_dot2_f32_bf16 v2, v117, v13, v2
    v_dot2_f32_bf16 v3, v121, v17, v3
    v_dot2_f32_bf16 v4, v125, v21, v4
    s_add_u32 s48, s41, 9216
    buffer_load_dwordx4 v[114:117], v1, s[20:23], s48 offen offset:0 nt
    buffer_load_dwordx4 v[118:121], v1, s[20:23], s48 offen offset:128 nt
    buffer_load_dwordx4 v[122:125], v1, s[20:23], s48 offen offset:256 nt
    v_add_f32 v2, v2, v3
    v_add_f32 v2, v2, v4
    s_nop 1
    v_add_f32_dpp v2, v2, v2 quad_perm:[1,0,3,2] row_mask:0xf bank_mask:0xf
    s_nop 1
    v_add_f32_dpp v2, v2, v2 quad_perm:[2,3,0,1] row_mask:0xf bank_mask:0xf
    s_nop 1
    v_add_f32_dpp v2, v2, v2 row_half_mirror row_mask:0xf bank_mask:0xf
    v_cvt_pk_bf16_f32 v2, v2, v2
    v_lshlrev_b32 v2, 16, v2
    v_mul_f32 v2, 0x3d93cd3a, v2
    v_cvt_pk_bf16_f32 v2, v2, v2
    v_lshlrev_b32 v29, 16, v2
    v_max3_f32 v2, v22, v23, v24
    v_max3_f32 v2, v2, v25, v26
    v_max3_f32 v2, v2, v27, v28
    v_max_f32 v2, v2, v29
    s_nop 1
    v_max_f32_dpp v2, v2, v2 row_ror:8 row_mask:0xf bank_mask:0xf
    s_nop 1
    v_readlane_b32 s48, v2, 0
    v_readlane_b32 s49, v2, 16
    v_readlane_b32 s50, v2, 32
    v_readlane_b32 s51, v2, 48
    s_nop 1
    v_mov_b32 v2, s48
    v_max_f32 v2, s49, v2
    v_max_f32 v2, s50, v2
    v_max_f32 v2, s51, v2
    v_max_f32 v2, v2, v30
    v_sub_f32 v3, v30, v2
    v_mul_f32 v3, s52, v3
    v_exp_f32 v3, v3
    v_mov_b32 v30, v2
    v_mul_f32 v4, s52, v2
    v_fma_f32 v22, v22, s52, -v4
    v_exp_f32 v22, v22
    v_fma_f32 v23, v23, s52, -v4
    v_exp_f32 v23, v23
    v_fma_f32 v24, v24, s52, -v4
    v_exp_f32 v24, v24
    v_fma_f32 v25, v25, s52, -v4
    v_exp_f32 v25, v25
    v_fma_f32 v26, v26, s52, -v4
    v_exp_f32 v26, v26
    v_fma_f32 v27, v27, s52, -v4
    v_exp_f32 v27, v27
    v_fma_f32 v28, v28, s52, -v4
    v_exp_f32 v28, v28
    v_fma_f32 v29, v29, s52, -v4
    v_exp_f32 v29, v29
    v_mul_f32 v31, v31, v3
    v_mul_f32 v54, v54, v3
    v_mul_f32 v55, v55, v3
    v_mul_f32 v56, v56, v3
    v_mul_f32 v57, v57, v3
    v_mul_f32 v58, v58, v3
    v_mul_f32 v59, v59, v3
    v_mul_f32 v60, v60, v3
    v_mul_f32 v61, v61, v3
    v_mul_f32 v62, v62, v3
    v_mul_f32 v63, v63, v3
    v_mul_f32 v64, v64, v3
    v_mul_f32 v65, v65, v3
    v_mul_f32 v66, v66, v3
    v_mul_f32 v67, v67, v3
    v_mul_f32 v68, v68, v3
    v_mul_f32 v69, v69, v3
    v_mul_f32 v70, v70, v3
    v_mul_f32 v71, v71, v3
    v_mul_f32 v72, v72, v3
    v_mul_f32 v73, v73, v3
    v_mul_f32 v74, v74, v3
    v_mul_f32 v75, v75, v3
    v_mul_f32 v76, v76, v3
    v_mul_f32 v77, v77, v3
    v_add_f32 v31, v31, v22
    v_add_f32 v31, v31, v23
    v_add_f32 v31, v31, v24
    v_add_f32 v31, v31, v25
    v_add_f32 v31, v31, v26
    v_add_f32 v31, v31, v27
    v_add_f32 v31, v31, v28
    v_add_f32 v31, v31, v29
    s_waitcnt vmcnt(9)
    v_lshlrev_b32 v4, 16, v78
    v_and_b32 v5, 0xffff0000, v78
    v_fmac_f32 v54, v22, v4
    v_fmac_f32 v55, v22, v5
    v_lshlrev_b32 v4, 16, v79
    v_and_b32 v5, 0xffff0000, v79
    v_fmac_f32 v56, v22, v4
    v_fmac_f32 v57, v22, v5
    v_lshlrev_b32 v4, 16, v80
    v_and_b32 v5, 0xffff0000, v80
    v_fmac_f32 v58, v22, v4
    v_fmac_f32 v59, v22, v5
    v_lshlrev_b32 v4, 16, v81
    v_and_b32 v5, 0xffff0000, v81
    v_fmac_f32 v60, v22, v4
    v_fmac_f32 v61, v22, v5
    v_lshlrev_b32 v4, 16, v82
    v_and_b32 v5, 0xffff0000, v82
    v_fmac_f32 v62, v22, v4
    v_fmac_f32 v63, v22, v5
    v_lshlrev_b32 v4, 16, v83
    v_and_b32 v5, 0xffff0000, v83
    v_fmac_f32 v64, v22, v4
    v_fmac_f32 v65, v22, v5
    v_lshlrev_b32 v4, 16, v84
    v_and_b32 v5, 0xffff0000, v84
    v_fmac_f32 v66, v22, v4
    v_fmac_f32 v67, v22, v5
    v_lshlrev_b32 v4, 16, v85
    v_and_b32 v5, 0xffff0000, v85
    v_fmac_f32 v68, v22, v4
    v_fmac_f32 v69, v22, v5
    v_lshlrev_b32 v4, 16, v86
    v_and_b32 v5, 0xffff0000, v86
    v_fmac_f32 v70, v22, v4
    v_fmac_f32 v71, v22, v5
    v_lshlrev_b32 v4, 16, v87
    v_and_b32 v5, 0xffff0000, v87
    v_fmac_f32 v72, v22, v4
    v_fmac_f32 v73, v22, v5
    v_lshlrev_b32 v4, 16, v88
    v_and_b32 v5, 0xffff0000, v88
    v_fmac_f32 v74, v22, v4
    v_fmac_f32 v75, v22, v5
    v_lshlrev_b32 v4, 16, v89
    v_and_b32 v5, 0xffff0000, v89
    v_fmac_f32 v76, v22, v4
    v_fmac_f32 v77, v22, v5
    s_add_u32 s48, s41, 12288
    buffer_load_dwordx4 v[78:81], v1, s[20:23], s48 offen offset:0 nt
    buffer_load_dwordx4 v[82:85], v1, s[20:23], s48 offen offset:128 nt
    buffer_load_dwordx4 v[86:89], v1, s[20:23], s48 offen offset:256 nt
    s_waitcnt vmcnt(9)
    v_lshlrev_b32 v4, 16, v90
    v_and_b32 v5, 0xffff0000, v90
    v_fmac_f32 v54, v23, v4
    v_fmac_f32 v55, v23, v5
    v_lshlrev_b32 v4, 16, v91
    v_and_b32 v5, 0xffff0000, v91
    v_fmac_f32 v56, v23, v4
    v_fmac_f32 v57, v23, v5
    v_lshlrev_b32 v4, 16, v92
    v_and_b32 v5, 0xffff0000, v92
    v_fmac_f32 v58, v23, v4
    v_fmac_f32 v59, v23, v5
    v_lshlrev_b32 v4, 16, v93
    v_and_b32 v5, 0xffff0000, v93
    v_fmac_f32 v60, v23, v4
    v_fmac_f32 v61, v23, v5
    v_lshlrev_b32 v4, 16, v94
    v_and_b32 v5, 0xffff0000, v94
    v_fmac_f32 v62, v23, v4
    v_fmac_f32 v63, v23, v5
    v_lshlrev_b32 v4, 16, v95
    v_and_b32 v5, 0xffff0000, v95
    v_fmac_f32 v64, v23, v4
    v_fmac_f32 v65, v23, v5
    v_lshlrev_b32 v4, 16, v96
    v_and_b32 v5, 0xffff0000, v96
    v_fmac_f32 v66, v23, v4
    v_fmac_f32 v67, v23, v5
    v_lshlrev_b32 v4, 16, v97
    v_and_b32 v5, 0xffff0000, v97
    v_fmac_f32 v68, v23, v4
    v_fmac_f32 v69, v23, v5
    v_lshlrev_b32 v4, 16, v98
    v_and_b32 v5, 0xffff0000, v98
    v_fmac_f32 v70, v23, v4
    v_fmac_f32 v71, v23, v5
    v_lshlrev_b32 v4, 16, v99
    v_and_b32 v5, 0xffff0000, v99
    v_fmac_f32 v72, v23, v4
    v_fmac_f32 v73, v23, v5
    v_lshlrev_b32 v4, 16, v100
    v_and_b32 v5, 0xffff0000, v100
    v_fmac_f32 v74, v23, v4
    v_fmac_f32 v75, v23, v5
    v_lshlrev_b32 v4, 16, v101
    v_and_b32 v5, 0xffff0000, v101
    v_fmac_f32 v76, v23, v4
    v_fmac_f32 v77, v23, v5
    s_add_u32 s48, s41, 15360
    buffer_load_dwordx4 v[90:93], v1, s[20:23], s48 offen offset:0 nt
    buffer_load_dwordx4 v[94:97], v1, s[20:23], s48 offen offset:128 nt
    buffer_load_dwordx4 v[98:101], v1, s[20:23], s48 offen offset:256 nt
    s_waitcnt vmcnt(9)
    v_lshlrev_b32 v4, 16, v102
    v_and_b32 v5, 0xffff0000, v102
    v_fmac_f32 v54, v24, v4
    v_fmac_f32 v55, v24, v5
    v_lshlrev_b32 v4, 16, v103
    v_and_b32 v5, 0xffff0000, v103
    v_fmac_f32 v56, v24, v4
    v_fmac_f32 v57, v24, v5
    v_lshlrev_b32 v4, 16, v104
    v_and_b32 v5, 0xffff0000, v104
    v_fmac_f32 v58, v24, v4
    v_fmac_f32 v59, v24, v5
    v_lshlrev_b32 v4, 16, v105
    v_and_b32 v5, 0xffff0000, v105
    v_fmac_f32 v60, v24, v4
    v_fmac_f32 v61, v24, v5
    v_lshlrev_b32 v4, 16, v106
    v_and_b32 v5, 0xffff0000, v106
    v_fmac_f32 v62, v24, v4
    v_fmac_f32 v63, v24, v5
    v_lshlrev_b32 v4, 16, v107
    v_and_b32 v5, 0xffff0000, v107
    v_fmac_f32 v64, v24, v4
    v_fmac_f32 v65, v24, v5
    v_lshlrev_b32 v4, 16, v108
    v_and_b32 v5, 0xffff0000, v108
    v_fmac_f32 v66, v24, v4
    v_fmac_f32 v67, v24, v5
    v_lshlrev_b32 v4, 16, v109
    v_and_b32 v5, 0xffff0000, v109
    v_fmac_f32 v68, v24, v4
    v_fmac_f32 v69, v24, v5
    v_lshlrev_b32 v4, 16, v110
    v_and_b32 v5, 0xffff0000, v110
    v_fmac_f32 v70, v24, v4
    v_fmac_f32 v71, v24, v5
    v_lshlrev_b32 v4, 16, v111
    v_and_b32 v5, 0xffff0000, v111
    v_fmac_f32 v72, v24, v4
    v_fmac_f32 v73, v24, v5
    v_lshlrev_b32 v4, 16, v112
    v_and_b32 v5, 0xffff0000, v112
    v_fmac_f32 v74, v24, v4
    v_fmac_f32 v75, v24, v5
    v_lshlrev_b32 v4, 16, v113
    v_and_b32 v5, 0xffff0000, v113
    v_fmac_f32 v76, v24, v4
    v_fmac_f32 v77, v24, v5
    s_add_u32 s48, s41, 18432
    buffer_load_dwordx4 v[102:105], v1, s[20:23], s48 offen offset:0 nt
    buffer_load_dwordx4 v[106:109], v1, s[20:23], s48 offen offset:128 nt
    buffer_load_dwordx4 v[110:113], v1, s[20:23], s48 offen offset:256 nt
    s_waitcnt vmcnt(9)
    v_lshlrev_b32 v4, 16, v114
    v_and_b32 v5, 0xffff0000, v114
    v_fmac_f32 v54, v25, v4
    v_fmac_f32 v55, v25, v5
    v_lshlrev_b32 v4, 16, v115
    v_and_b32 v5, 0xffff0000, v115
    v_fmac_f32 v56, v25, v4
    v_fmac_f32 v57, v25, v5
    v_lshlrev_b32 v4, 16, v116
    v_and_b32 v5, 0xffff0000, v116
    v_fmac_f32 v58, v25, v4
    v_fmac_f32 v59, v25, v5
    v_lshlrev_b32 v4, 16, v117
    v_and_b32 v5, 0xffff0000, v117
    v_fmac_f32 v60, v25, v4
    v_fmac_f32 v61, v25, v5
    v_lshlrev_b32 v4, 16, v118
    v_and_b32 v5, 0xffff0000, v118
    v_fmac_f32 v62, v25, v4
    v_fmac_f32 v63, v25, v5
    v_lshlrev_b32 v4, 16, v119
    v_and_b32 v5, 0xffff0000, v119
    v_fmac_f32 v64, v25, v4
    v_fmac_f32 v65, v25, v5
    v_lshlrev_b32 v4, 16, v120
    v_and_b32 v5, 0xffff0000, v120
    v_fmac_f32 v66, v25, v4
    v_fmac_f32 v67, v25, v5
    v_lshlrev_b32 v4, 16, v121
    v_and_b32 v5, 0xffff0000, v121
    v_fmac_f32 v68, v25, v4
    v_fmac_f32 v69, v25, v5
    v_lshlrev_b32 v4, 16, v122
    v_and_b32 v5, 0xffff0000, v122
    v_fmac_f32 v70, v25, v4
    v_fmac_f32 v71, v25, v5
    v_lshlrev_b32 v4, 16, v123
    v_and_b32 v5, 0xffff0000, v123
    v_fmac_f32 v72, v25, v4
    v_fmac_f32 v73, v25, v5
    v_lshlrev_b32 v4, 16, v124
    v_and_b32 v5, 0xffff0000, v124
    v_fmac_f32 v74, v25, v4
    v_fmac_f32 v75, v25, v5
    v_lshlrev_b32 v4, 16, v125
    v_and_b32 v5, 0xffff0000, v125
    v_fmac_f32 v76, v25, v4
    v_fmac_f32 v77, v25, v5
    s_add_u32 s48, s41, 21504
    buffer_load_dwordx4 v[114:117], v1, s[20:23], s48 offen offset:0 nt
    buffer_load_dwordx4 v[118:121], v1, s[20:23], s48 offen offset:128 nt
    buffer_load_dwordx4 v[122:125], v1, s[20:23], s48 offen offset:256 nt
    s_waitcnt vmcnt(9)
    v_lshlrev_b32 v4, 16, v78
    v_and_b32 v5, 0xffff0000, v78
    v_fmac_f32 v54, v26, v4
    v_fmac_f32 v55, v26, v5
    v_lshlrev_b32 v4, 16, v79
    v_and_b32 v5, 0xffff0000, v79
    v_fmac_f32 v56, v26, v4
    v_fmac_f32 v57, v26, v5
    v_lshlrev_b32 v4, 16, v80
    v_and_b32 v5, 0xffff0000, v80
    v_fmac_f32 v58, v26, v4
    v_fmac_f32 v59, v26, v5
    v_lshlrev_b32 v4, 16, v81
    v_and_b32 v5, 0xffff0000, v81
    v_fmac_f32 v60, v26, v4
    v_fmac_f32 v61, v26, v5
    v_lshlrev_b32 v4, 16, v82
    v_and_b32 v5, 0xffff0000, v82
    v_fmac_f32 v62, v26, v4
    v_fmac_f32 v63, v26, v5
    v_lshlrev_b32 v4, 16, v83
    v_and_b32 v5, 0xffff0000, v83
    v_fmac_f32 v64, v26, v4
    v_fmac_f32 v65, v26, v5
    v_lshlrev_b32 v4, 16, v84
    v_and_b32 v5, 0xffff0000, v84
    v_fmac_f32 v66, v26, v4
    v_fmac_f32 v67, v26, v5
    v_lshlrev_b32 v4, 16, v85
    v_and_b32 v5, 0xffff0000, v85
    v_fmac_f32 v68, v26, v4
    v_fmac_f32 v69, v26, v5
    v_lshlrev_b32 v4, 16, v86
    v_and_b32 v5, 0xffff0000, v86
    v_fmac_f32 v70, v26, v4
    v_fmac_f32 v71, v26, v5
    v_lshlrev_b32 v4, 16, v87
    v_and_b32 v5, 0xffff0000, v87
    v_fmac_f32 v72, v26, v4
    v_fmac_f32 v73, v26, v5
    v_lshlrev_b32 v4, 16, v88
    v_and_b32 v5, 0xffff0000, v88
    v_fmac_f32 v74, v26, v4
    v_fmac_f32 v75, v26, v5
    v_lshlrev_b32 v4, 16, v89
    v_and_b32 v5, 0xffff0000, v89
    v_fmac_f32 v76, v26, v4
    v_fmac_f32 v77, v26, v5
    s_add_u32 s48, s47, 0
    buffer_load_dwordx4 v[78:81], v1, s[16:19], s48 offen offset:0 nt
    buffer_load_dwordx4 v[82:85], v1, s[16:19], s48 offen offset:128 nt
    buffer_load_dwordx4 v[86:89], v1, s[16:19], s48 offen offset:256 nt
    s_waitcnt vmcnt(9)
    v_lshlrev_b32 v4, 16, v90
    v_and_b32 v5, 0xffff0000, v90
    v_fmac_f32 v54, v27, v4
    v_fmac_f32 v55, v27, v5
    v_lshlrev_b32 v4, 16, v91
    v_and_b32 v5, 0xffff0000, v91
    v_fmac_f32 v56, v27, v4
    v_fmac_f32 v57, v27, v5
    v_lshlrev_b32 v4, 16, v92
    v_and_b32 v5, 0xffff0000, v92
    v_fmac_f32 v58, v27, v4
    v_fmac_f32 v59, v27, v5
    v_lshlrev_b32 v4, 16, v93
    v_and_b32 v5, 0xffff0000, v93
    v_fmac_f32 v60, v27, v4
    v_fmac_f32 v61, v27, v5
    v_lshlrev_b32 v4, 16, v94
    v_and_b32 v5, 0xffff0000, v94
    v_fmac_f32 v62, v27, v4
    v_fmac_f32 v63, v27, v5
    v_lshlrev_b32 v4, 16, v95
    v_and_b32 v5, 0xffff0000, v95
    v_fmac_f32 v64, v27, v4
    v_fmac_f32 v65, v27, v5
    v_lshlrev_b32 v4, 16, v96
    v_and_b32 v5, 0xffff0000, v96
    v_fmac_f32 v66, v27, v4
    v_fmac_f32 v67, v27, v5
    v_lshlrev_b32 v4, 16, v97
    v_and_b32 v5, 0xffff0000, v97
    v_fmac_f32 v68, v27, v4
    v_fmac_f32 v69, v27, v5
    v_lshlrev_b32 v4, 16, v98
    v_and_b32 v5, 0xffff0000, v98
    v_fmac_f32 v70, v27, v4
    v_fmac_f32 v71, v27, v5
    v_lshlrev_b32 v4, 16, v99
    v_and_b32 v5, 0xffff0000, v99
    v_fmac_f32 v72, v27, v4
    v_fmac_f32 v73, v27, v5
    v_lshlrev_b32 v4, 16, v100
    v_and_b32 v5, 0xffff0000, v100
    v_fmac_f32 v74, v27, v4
    v_fmac_f32 v75, v27, v5
    v_lshlrev_b32 v4, 16, v101
    v_and_b32 v5, 0xffff0000, v101
    v_fmac_f32 v76, v27, v4
    v_fmac_f32 v77, v27, v5
    s_add_u32 s48, s47, 3072
    buffer_load_dwordx4 v[90:93], v1, s[16:19], s48 offen offset:0 nt
    buffer_load_dwordx4 v[94:97], v1, s[16:19], s48 offen offset:128 nt
    buffer_load_dwordx4 v[98:101], v1, s[16:19], s48 offen offset:256 nt
    s_waitcnt vmcnt(9)
    v_lshlrev_b32 v4, 16, v102
    v_and_b32 v5, 0xffff0000, v102
    v_fmac_f32 v54, v28, v4
    v_fmac_f32 v55, v28, v5
    v_lshlrev_b32 v4, 16, v103
    v_and_b32 v5, 0xffff0000, v103
    v_fmac_f32 v56, v28, v4
    v_fmac_f32 v57, v28, v5
    v_lshlrev_b32 v4, 16, v104
    v_and_b32 v5, 0xffff0000, v104
    v_fmac_f32 v58, v28, v4
    v_fmac_f32 v59, v28, v5
    v_lshlrev_b32 v4, 16, v105
    v_and_b32 v5, 0xffff0000, v105
    v_fmac_f32 v60, v28, v4
    v_fmac_f32 v61, v28, v5
    v_lshlrev_b32 v4, 16, v106
    v_and_b32 v5, 0xffff0000, v106
    v_fmac_f32 v62, v28, v4
    v_fmac_f32 v63, v28, v5
    v_lshlrev_b32 v4, 16, v107
    v_and_b32 v5, 0xffff0000, v107
    v_fmac_f32 v64, v28, v4
    v_fmac_f32 v65, v28, v5
    v_lshlrev_b32 v4, 16, v108
    v_and_b32 v5, 0xffff0000, v108
    v_fmac_f32 v66, v28, v4
    v_fmac_f32 v67, v28, v5
    v_lshlrev_b32 v4, 16, v109
    v_and_b32 v5, 0xffff0000, v109
    v_fmac_f32 v68, v28, v4
    v_fmac_f32 v69, v28, v5
    v_lshlrev_b32 v4, 16, v110
    v_and_b32 v5, 0xffff0000, v110
    v_fmac_f32 v70, v28, v4
    v_fmac_f32 v71, v28, v5
    v_lshlrev_b32 v4, 16, v111
    v_and_b32 v5, 0xffff0000, v111
    v_fmac_f32 v72, v28, v4
    v_fmac_f32 v73, v28, v5
    v_lshlrev_b32 v4, 16, v112
    v_and_b32 v5, 0xffff0000, v112
    v_fmac_f32 v74, v28, v4
    v_fmac_f32 v75, v28, v5
    v_lshlrev_b32 v4, 16, v113
    v_and_b32 v5, 0xffff0000, v113
    v_fmac_f32 v76, v28, v4
    v_fmac_f32 v77, v28, v5
    s_add_u32 s48, s47, 6144
    buffer_load_dwordx4 v[102:105], v1, s[16:19], s48 offen offset:0 nt
    buffer_load_dwordx4 v[106:109], v1, s[16:19], s48 offen offset:128 nt
    buffer_load_dwordx4 v[110:113], v1, s[16:19], s48 offen offset:256 nt
    s_waitcnt vmcnt(9)
    v_lshlrev_b32 v4, 16, v114
    v_and_b32 v5, 0xffff0000, v114
    v_fmac_f32 v54, v29, v4
    v_fmac_f32 v55, v29, v5
    v_lshlrev_b32 v4, 16, v115
    v_and_b32 v5, 0xffff0000, v115
    v_fmac_f32 v56, v29, v4
    v_fmac_f32 v57, v29, v5
    v_lshlrev_b32 v4, 16, v116
    v_and_b32 v5, 0xffff0000, v116
    v_fmac_f32 v58, v29, v4
    v_fmac_f32 v59, v29, v5
    v_lshlrev_b32 v4, 16, v117
    v_and_b32 v5, 0xffff0000, v117
    v_fmac_f32 v60, v29, v4
    v_fmac_f32 v61, v29, v5
    v_lshlrev_b32 v4, 16, v118
    v_and_b32 v5, 0xffff0000, v118
    v_fmac_f32 v62, v29, v4
    v_fmac_f32 v63, v29, v5
    v_lshlrev_b32 v4, 16, v119
    v_and_b32 v5, 0xffff0000, v119
    v_fmac_f32 v64, v29, v4
    v_fmac_f32 v65, v29, v5
    v_lshlrev_b32 v4, 16, v120
    v_and_b32 v5, 0xffff0000, v120
    v_fmac_f32 v66, v29, v4
    v_fmac_f32 v67, v29, v5
    v_lshlrev_b32 v4, 16, v121
    v_and_b32 v5, 0xffff0000, v121
    v_fmac_f32 v68, v29, v4
    v_fmac_f32 v69, v29, v5
    v_lshlrev_b32 v4, 16, v122
    v_and_b32 v5, 0xffff0000, v122
    v_fmac_f32 v70, v29, v4
    v_fmac_f32 v71, v29, v5
    v_lshlrev_b32 v4, 16, v123
    v_and_b32 v5, 0xffff0000, v123
    v_fmac_f32 v72, v29, v4
    v_fmac_f32 v73, v29, v5
    v_lshlrev_b32 v4, 16, v124
    v_and_b32 v5, 0xffff0000, v124
    v_fmac_f32 v74, v29, v4
    v_fmac_f32 v75, v29, v5
    v_lshlrev_b32 v4, 16, v125
    v_and_b32 v5, 0xffff0000, v125
    v_fmac_f32 v76, v29, v4
    v_fmac_f32 v77, v29, v5
    s_add_u32 s48, s47, 9216
    buffer_load_dwordx4 v[114:117], v1, s[16:19], s48 offen offset:0 nt
    buffer_load_dwordx4 v[118:121], v1, s[16:19], s48 offen offset:128 nt
    buffer_load_dwordx4 v[122:125], v1, s[16:19], s48 offen offset:256 nt
    s_mov_b32 s41, s47
    s_cmp_lt_u32 s41, s96
    s_cbranch_scc1 L_loop
    s_waitcnt vmcnt(0)
    v_mov_b32 v2, v30
    v_mov_b32 v3, v31
    s_nop 1
    v_add_f32_dpp v3, v3, v3 quad_perm:[1,0,3,2] row_mask:0xf bank_mask:0xf
    s_nop 1
    v_add_f32_dpp v3, v3, v3 quad_perm:[2,3,0,1] row_mask:0xf bank_mask:0xf
    s_nop 1
    v_add_f32_dpp v3, v3, v3 row_half_mirror row_mask:0xf bank_mask:0xf
    s_nop 1
    v_add_f32_dpp v3, v3, v3 row_mirror row_mask:0xf bank_mask:0xf
    s_nop 1
    v_readlane_b32 s48, v3, 0
    v_readlane_b32 s49, v3, 16
    v_readlane_b32 s50, v3, 32
    v_readlane_b32 s51, v3, 48
    s_nop 1
    v_mov_b32 v3, s48
    v_add_f32 v3, s49, v3
    v_add_f32 v3, s50, v3
    v_add_f32 v3, s51, v3
    v_mul_f32 v3, 0.125, v3
    s_nop 1
    v_permlane32_swap_b32 v54, v58
    v_permlane32_swap_b32 v55, v59
    v_permlane32_swap_b32 v56, v60
    v_permlane32_swap_b32 v57, v61
    v_permlane32_swap_b32 v62, v66
    v_permlane32_swap_b32 v63, v67
    v_permlane32_swap_b32 v64, v68
    v_permlane32_swap_b32 v65, v69
    v_permlane32_swap_b32 v70, v74
    v_permlane32_swap_b32 v71, v75
    v_permlane32_swap_b32 v72, v76
    v_permlane32_swap_b32 v73, v77
    v_add_f32 v54, v54, v58
    v_add_f32 v55, v55, v59
    v_add_f32 v56, v56, v60
    v_add_f32 v57, v57, v61
    v_add_f32 v62, v62, v66
    v_add_f32 v63, v63, v67
    v_add_f32 v64, v64, v68
    v_add_f32 v65, v65, v69
    v_add_f32 v70, v70, v74
    v_add_f32 v71, v71, v75
    v_add_f32 v72, v72, v76
    v_add_f32 v73, v73, v77
    s_nop 1
    v_permlane16_swap_b32 v54, v56
    v_permlane16_swap_b32 v55, v57
    v_permlane16_swap_b32 v62, v64
    v_permlane16_swap_b32 v63, v65
    v_permlane16_swap_b32 v70, v72
    v_permlane16_swap_b32 v71, v73
    v_add_f32 v54, v54, v56
    v_add_f32 v55, v55, v57
    v_add_f32 v62, v62, v64
    v_add_f32 v63, v63, v65
    v_add_f32 v70, v70, v72
    v_add_f32 v71, v71, v73
    s_nop 1
    v_add_f32_dpp v54, v54, v54 row_ror:8 row_mask:0xf bank_mask:0xf
    v_add_f32_dpp v55, v55, v55 row_ror:8 row_mask:0xf bank_mask:0xf
    v_add_f32_dpp v62, v62, v62 row_ror:8 row_mask:0xf bank_mask:0xf
    v_add_f32_dpp v63, v63, v63 row_ror:8 row_mask:0xf bank_mask:0xf
    v_add_f32_dpp v70, v70, v70 row_ror:8 row_mask:0xf bank_mask:0xf
    v_add_f32_dpp v71, v71, v71 row_ror:8 row_mask:0xf bank_mask:0xf
    ds_write_b64 v9, v[54:55] offset:0
    ds_write_b64 v9, v[62:63] offset:256
    ds_write_b64 v9, v[70:71] offset:512
    v_lshrrev_b32 v4, 6, v0
    v_lshlrev_b32 v4, 3, v4
    ds_write_b64 v4, v[2:3] offset:12800
    s_waitcnt lgkmcnt(0)
    s_barrier
    s_cmp_lg_u32 s53, 3
    s_cbranch_scc1 L_noarr
    s_mov_b64 exec, 1
    v_mov_b32 v4, 0
    v_mov_b32 v5, 1
    buffer_atomic_add v5, v4, s[36:39], 0 offen sc0 sc1
    s_waitcnt vmcnt(0)
    v_mov_b32 v4, 12928
    ds_write_b32 v4, v5
    v_readfirstlane_b32 s48, v5
    s_waitcnt lgkmcnt(0)
    s_mov_b64 exec, -1
    v_lshlrev_b32 v4, 7, v6
    v_mov_b32 v5, 1
    s_cmp_lg_u32 s48, 247
    s_cbranch_scc1 L_e3
    s_mov_b32 s48, 458756
    buffer_store_dword v5, v4, s[32:35], s48 offen sc0 sc1
    s_mov_b32 s48, 466948
    buffer_store_dword v5, v4, s[32:35], s48 offen sc0 sc1
    s_mov_b32 s48, 475140
    buffer_store_dword v5, v4, s[32:35], s48 offen sc0 sc1
    s_mov_b32 s48, 483332
    buffer_store_dword v5, v4, s[32:35], s48 offen sc0 sc1
    s_branch L_e2
L_e3:
    s_cmp_lg_u32 s48, 255
    s_cbranch_scc1 L_e2
    s_mov_b32 s48, 458752
    buffer_store_dword v5, v4, s[32:35], s48 offen sc0 sc1
    s_mov_b32 s48, 466944
    buffer_store_dword v5, v4, s[32:35], s48 offen sc0 sc1
    s_mov_b32 s48, 475136
    buffer_store_dword v5, v4, s[32:35], s48 offen sc0 sc1
    s_mov_b32 s48, 483328
    buffer_store_dword v5, v4, s[32:35], s48 offen sc0 sc1
    s_branch L_e2
L_noarr:
    v_cmp_gt_u32 vcc, 192, v0
    s_and_saveexec_b64 s[100:101], vcc
    s_cbranch_execz L_e1
    v_lshlrev_b32 v2, 2, v0
    v_mov_b32 v4, 0
    ds_read_b32 v54, v2 offset:0
    ds_read_b32 v55, v2 offset:768
    ds_read_b32 v56, v2 offset:1536
    ds_read_b32 v57, v2 offset:2304
    ds_read_b32 v58, v2 offset:3072
    ds_read_b32 v59, v2 offset:3840
    ds_read_b32 v60, v2 offset:4608
    ds_read_b32 v61, v2 offset:5376
    ds_read_b32 v62, v2 offset:6144
    ds_read_b32 v63, v2 offset:6912
    ds_read_b32 v64, v2 offset:7680
    ds_read_b32 v65, v2 offset:8448
    ds_read_b32 v66, v2 offset:9216
    ds_read_b32 v67, v2 offset:9984
    ds_read_b32 v68, v2 offset:10752
    ds_read_b32 v69, v2 offset:11520
    ds_read_b128 v[22:25], v4 offset:12800
    ds_read_b128 v[26:29], v4 offset:12816
    ds_read_b128 v[30:33], v4 offset:12832
    ds_read_b128 v[34:37], v4 offset:12848
    ds_read_b128 v[38:41], v4 offset:12864
    ds_read_b128 v[42:45], v4 offset:12880
    ds_read_b128 v[46:49], v4 offset:12896
    ds_read_b128 v[50:53], v4 offset:12912
    s_waitcnt lgkmcnt(0)
    v_max_f32 v3, v22, v24
    v_max_f32 v3, v3, v26
    v_max_f32 v3, v3, v28
    v_max_f32 v3, v3, v30
    v_max_f32 v3, v3, v32
    v_max_f32 v3, v3, v34
    v_max_f32 v3, v3, v36
    v_max_f32 v3, v3, v38
    v_max_f32 v3, v3, v40
    v_max_f32 v3, v3, v42
    v_max_f32 v3, v3, v44
    v_max_f32 v3, v3, v46
    v_max_f32 v3, v3, v48
    v_max_f32 v3, v3, v50
    v_max_f32 v3, v3, v52
    v_sub_f32 v22, v22, v3
    v_mul_f32 v22, 0x3fb8aa3b, v22
    v_exp_f32 v22, v22
    v_sub_f32 v24, v24, v3
    v_mul_f32 v24, 0x3fb8aa3b, v24
    v_exp_f32 v24, v24
    v_sub_f32 v26, v26, v3
    v_mul_f32 v26, 0x3fb8aa3b, v26
    v_exp_f32 v26, v26
    v_sub_f32 v28, v28, v3
    v_mul_f32 v28, 0x3fb8aa3b, v28
    v_exp_f32 v28, v28
    v_sub_f32 v30, v30, v3
    v_mul_f32 v30, 0x3fb8aa3b, v30
    v_exp_f32 v30, v30
    v_sub_f32 v32, v32, v3
    v_mul_f32 v32, 0x3fb8aa3b, v32
    v_exp_f32 v32, v32
    v_sub_f32 v34, v34, v3
    v_mul_f32 v34, 0x3fb8aa3b, v34
    v_exp_f32 v34, v34
    v_sub_f32 v36, v36, v3
    v_mul_f32 v36, 0x3fb8aa3b, v36
    v_exp_f32 v36, v36
    v_sub_f32 v38, v38, v3
    v_mul_f32 v38, 0x3fb8aa3b, v38
    v_exp_f32 v38, v38
    v_sub_f32 v40, v40, v3
    v_mul_f32 v40, 0x3fb8aa3b, v40
    v_exp_f32 v40, v40
    v_sub_f32 v42, v42, v3
    v_mul_f32 v42, 0x3fb8aa3b, v42
    v_exp_f32 v42, v42
    v_sub_f32 v44, v44, v3
    v_mul_f32 v44, 0x3fb8aa3b, v44
    v_exp_f32 v44, v44
    v_sub_f32 v46, v46, v3
    v_mul_f32 v46, 0x3fb8aa3b, v46
    v_exp_f32 v46, v46
    v_sub_f32 v48, v48, v3
    v_mul_f32 v48, 0x3fb8aa3b, v48
    v_exp_f32 v48, v48
    v_sub_f32 v50, v50, v3
    v_mul_f32 v50, 0x3fb8aa3b, v50
    v_exp_f32 v50, v50
    v_sub_f32 v52, v52, v3
    v_mul_f32 v52, 0x3fb8aa3b, v52
    v_exp_f32 v52, v52
    s_nop 0
    v_mul_f32 v4, v22, v54
    v_mul_f32 v5, v22, v23
    v_fmac_f32 v4, v24, v55
    v_fmac_f32 v5, v24, v25
    v_fmac_f32 v4, v26, v56
    v_fmac_f32 v5, v26, v27
    v_fmac_f32 v4, v28, v57
    v_fmac_f32 v5, v28, v29
    v_fmac_f32 v4, v30, v58
    v_fmac_f32 v5, v30, v31
    v_fmac_f32 v4, v32, v59
    v_fmac_f32 v5, v32, v33
    v_fmac_f32 v4, v34, v60
    v_fmac_f32 v5, v34, v35
    v_fmac_f32 v4, v36, v61
    v_fmac_f32 v5, v36, v37
    v_fmac_f32 v4, v38, v62
    v_fmac_f32 v5, v38, v39
    v_fmac_f32 v4, v40, v63
    v_fmac_f32 v5, v40, v41
    v_fmac_f32 v4, v42, v64
    v_fmac_f32 v5, v42, v43
    v_fmac_f32 v4, v44, v65
    v_fmac_f32 v5, v44, v45
    v_fmac_f32 v4, v46, v66
    v_fmac_f32 v5, v46, v47
    v_fmac_f32 v4, v48, v67
    v_fmac_f32 v5, v48, v49
    v_fmac_f32 v4, v50, v68
    v_fmac_f32 v5, v50, v51
    v_fmac_f32 v4, v52, v69
    v_fmac_f32 v5, v52, v53
    v_mov_b32 v12, v4
    v_mov_b32 v14, v3
    v_mov_b32 v15, v5
    v_mov_b32_dpp v13, v4 quad_perm:[1,0,3,2] row_mask:0xf bank_mask:0xf
    v_lshlrev_b32 v2, 3, v0
    s_mul_i32 s48, s40, 1536
    s_add_u32 s48, s48, 1048576
    s_mov_b32 exec_lo, 0x55555555
    s_mov_b32 exec_hi, 0x55555555
    buffer_store_dwordx4 v[12:15], v2, s[32:35], s48 offen sc0 sc1
L_e1:
    s_mov_b64 exec, s[100:101]
L_e2:
    s_barrier
    v_mov_b32 v12, 12928
    ds_read_b32 v13, v12
    s_waitcnt lgkmcnt(0)
    v_readfirstlane_b32 s97, v13
    s_mul_i32 s48, s97, 6554
    s_lshr_b32 s54, s48, 16
    s_mul_i32 s48, s54, 10
    s_sub_u32 s55, s97, s48
    s_mov_b32 s98, 0
    s_cmp_lt_u32 s97, 80
    s_cbranch_scc1 L_role_2
    s_mov_b32 s98, 1
    s_sub_u32 s55, s97, 80
    s_cmp_ge_u32 s55, 24
    s_cselect_b32 s54, 1, 0
    s_mul_i32 s48, s54, 24
    s_sub_u32 s55, s55, s48
    s_cmp_lt_u32 s97, 128
    s_cbranch_scc1 L_role_2
    s_mov_b32 s98, 2
    s_sub_u32 s55, s97, 128
    s_cmp_lt_u32 s97, 148
    s_cbranch_scc1 L_role_2
    s_mov_b32 s98, 3
L_role_2:
    s_cmp_eq_u32 s54, 1
    s_cselect_b32 s64, s92, s64
    s_cselect_b32 s65, s93, s65
    s_cmp_eq_u32 s98, 3
    s_cbranch_scc1 L_dma_end
    s_cmp_eq_u32 s98, 2
    s_cbranch_scc1 L_dma_e
    v_lshrrev_b32 v126, 3, v6
    v_and_b32 v127, 7, v6
    v_lshlrev_b32 v127, 4, v127
    s_cmp_eq_u32 s98, 1
    s_cbranch_scc1 L_dma_d
    v_mul_u32_u24 v126, 1280, v126
    v_add_u32 v126, v126, v127
    s_mul_i32 s48, s54, 768
    s_mul_i32 s49, s53, 48
    s_add_u32 s48, s48, s49
    s_mul_i32 s48, s48, 1280
    s_lshl_b32 s50, s55, 7
    s_add_u32 s48, s48, s50
    s_lshl_b32 s50, s49, 7
    s_add_u32 s50, s50, 42496
    s_mov_b32 m0, s50
    s_nop 0
    buffer_load_dwordx4 v126, s[60:63], s48 offen nt lds
    s_add_u32 s48, s48, 10240
    s_add_u32 s50, s50, 1024
    s_mov_b32 m0, s50
    s_nop 0
    buffer_load_dwordx4 v126, s[60:63], s48 offen nt lds
    s_add_u32 s48, s48, 10240
    s_add_u32 s50, s50, 1024
    s_mov_b32 m0, s50
    s_nop 0
    buffer_load_dwordx4 v126, s[60:63], s48 offen nt lds
    s_add_u32 s48, s48, 10240
    s_add_u32 s50, s50, 1024
    s_mov_b32 m0, s50
    s_nop 0
    buffer_load_dwordx4 v126, s[60:63], s48 offen nt lds
    s_add_u32 s48, s48, 10240
    s_add_u32 s50, s50, 1024
    s_mov_b32 m0, s50
    s_nop 0
    buffer_load_dwordx4 v126, s[60:63], s48 offen nt lds
    s_add_u32 s48, s48, 10240
    s_add_u32 s50, s50, 1024
    s_mov_b32 m0, s50
    s_nop 0
    buffer_load_dwordx4 v126, s[60:63], s48 offen nt lds
    s_branch L_dma_end
L_dma_d:
    v_mul_u32_u24 v126, 3072, v126
    v_add_u32 v126, v126, v127
    s_mul_i32 s49, s53, 40
    s_mul_i32 s48, s49, 3072
    s_lshl_b32 s50, s55, 7
    s_add_u32 s48, s48, s50
    s_lshl_b32 s50, s49, 7
    s_add_u32 s50, s50, 42496
    s_mov_b32 m0, s50
    s_nop 0
    buffer_load_dwordx4 v126, s[64:67], s48 offen nt lds
    s_add_u32 s48, s48, 24576
    s_add_u32 s50, s50, 1024
    s_mov_b32 m0, s50
    s_nop 0
    buffer_load_dwordx4 v126, s[64:67], s48 offen nt lds
    s_add_u32 s48, s48, 24576
    s_add_u32 s50, s50, 1024
    s_mov_b32 m0, s50
    s_nop 0
    buffer_load_dwordx4 v126, s[64:67], s48 offen nt lds
    s_add_u32 s48, s48, 24576
    s_add_u32 s50, s50, 1024
    s_mov_b32 m0, s50
    s_nop 0
    buffer_load_dwordx4 v126, s[64:67], s48 offen nt lds
    s_add_u32 s48, s48, 24576
    s_add_u32 s50, s50, 1024
    s_mov_b32 m0, s50
    s_nop 0
    buffer_load_dwordx4 v126, s[64:67], s48 offen nt lds
    s_branch L_dma_end
L_dma_e:
    v_lshrrev_b32 v126, 2, v6
    v_and_b32 v127, 3, v6
    v_lshlrev_b32 v127, 4, v127
    v_mul_u32_u24 v126, 1280, v126
    v_add_u32 v126, v126, v127
    s_mul_i32 s49, s53, 96
    s_mul_i32 s48, s49, 1280
    s_lshl_b32 s50, s55, 6
    s_add_u32 s48, s48, s50
    s_lshl_b32 s50, s49, 6
    s_add_u32 s50, s50, 42496
    s_mov_b32 m0, s50
    s_nop 0
    buffer_load_dwordx4 v126, s[68:71], s48 offen nt lds
    s_add_u32 s48, s48, 20480
    s_add_u32 s50, s50, 1024
    s_mov_b32 m0, s50
    s_nop 0
    buffer_load_dwordx4 v126, s[68:71], s48 offen nt lds
    s_add_u32 s48, s48, 20480
    s_add_u32 s50, s50, 1024
    s_mov_b32 m0, s50
    s_nop 0
    buffer_load_dwordx4 v126, s[68:71], s48 offen nt lds
    s_add_u32 s48, s48, 20480
    s_add_u32 s50, s50, 1024
    s_mov_b32 m0, s50
    s_nop 0
    buffer_load_dwordx4 v126, s[68:71], s48 offen nt lds
    s_add_u32 s48, s48, 20480
    s_add_u32 s50, s50, 1024
    s_mov_b32 m0, s50
    s_nop 0
    buffer_load_dwordx4 v126, s[68:71], s48 offen nt lds
    s_add_u32 s48, s48, 20480
    s_add_u32 s50, s50, 1024
    s_mov_b32 m0, s50
    s_nop 0
    buffer_load_dwordx4 v126, s[68:71], s48 offen nt lds
L_dma_end:
    s_cmp_eq_u32 s98, 3
    s_cbranch_scc0 L_tail_go
    s_endpgm
L_tail_go:
    v_lshrrev_b32 v7, 6, v0
    s_cmp_eq_u32 s98, 0
    s_cbranch_scc1 L_tail_c
    s_cmp_lg_u32 s53, 0
    s_cbranch_scc1 L_gate_done
    s_lshl_b32 s44, s2, 7
    s_add_u32 s44, s44, 458752
    v_mov_b32 v122, 0
    s_mov_b32 s45, 0
    buffer_load_dword v123, v122, s[32:35], s44 offen sc0 sc1
L_gate_3:
    s_sleep 6
    buffer_load_dword v124, v122, s[32:35], s44 offen sc0 sc1
    s_waitcnt vmcnt(1)
    v_cmp_ne_u32 vcc, 1, v123
    s_cbranch_vccz L_gate_3_ok
    s_sleep 6
    buffer_load_dword v123, v122, s[32:35], s44 offen sc0 sc1
    s_waitcnt vmcnt(1)
    v_cmp_ne_u32 vcc, 1, v124
    s_add_u32 s45, s45, 1
    s_cbranch_vccz L_gate_3_ok
    s_cmp_lt_u32 s45, 0x20000
    s_cbranch_scc1 L_gate_3
L_gate_3_ok:
L_gate_done:
    s_cmp_eq_u32 s98, 1
    s_cbranch_scc1 L_tail_d
    s_branch L_tail_e
L_tail_c:
    v_mov_b32 v12, v0
    v_mul_u32_u24 v13, 43691, v12
    v_lshrrev_b32 v13, 24, v13
    v_mul_u32_u24 v14, 384, v13
    v_sub_u32 v12, v12, v14
    v_mul_u32_u24 v14, 43691, v12
    v_lshrrev_b32 v14, 22, v14
    v_mul_u32_u24 v40, 98304, v13
    v_mul_u32_u24 v15, 1536, v14
    v_add_u32 v40, v40, v15
    v_lshl_add_u32 v40, v12, 4, v40
    v_mul_u32_u24 v46, 3136, v13
    v_lshl_add_u32 v46, v12, 2, v46
    v_and_b32 v12, 511, v0
    v_add_u32 v12, 1024, v12
    v_mul_u32_u24 v13, 43691, v12
    v_lshrrev_b32 v13, 24, v13
    v_mul_u32_u24 v14, 384, v13
    v_sub_u32 v12, v12, v14
    v_mul_u32_u24 v14, 43691, v12
    v_lshrrev_b32 v14, 22, v14
    v_mul_u32_u24 v41, 98304, v13
    v_mul_u32_u24 v15, 1536, v14
    v_add_u32 v41, v41, v15
    v_lshl_add_u32 v41, v12, 4, v41
    v_mul_u32_u24 v47, 3136, v13
    v_lshl_add_u32 v47, v12, 2, v47
    v_and_b32 v12, 3, v6
    v_mul_u32_u24 v8, 3136, v12
    v_lshlrev_b32 v9, 3, v12
    v_lshrrev_b32 v12, 4, v6
    v_lshl_add_u32 v8, v12, 4, v8
    v_mul_u32_u24 v12, 1024, v12
    v_add_u32 v9, v9, v12
    v_bfe_u32 v12, v6, 2, 2
    v_mul_u32_u24 v12, 128, v12
    v_add_u32 v9, v9, v12
    s_mul_i32 s46, s54, 12288
    s_add_u32 s46, s46, 1048576
    s_cmp_lg_u32 s53, 0
    s_cbranch_scc1 L_c_f
    v_mov_b32 v12, 4
    s_mov_b32 s45, 0
L_c_clr:
    buffer_load_dword v13, v12, s[36:39], 0 offen sc0 sc1
    s_waitcnt vmcnt(0)
    v_cmp_gt_u32 vcc, 256, v13
    s_add_u32 s45, s45, 1
    s_cbranch_vccz L_c_clr_ok
    s_cmp_ge_u32 s45, 0x20000
    s_cbranch_scc1 L_c_clr_ok
    s_sleep 8
    s_branch L_c_clr
L_c_clr_ok:
    s_lshl_b32 s44, s2, 7
    s_add_u32 s44, s44, 458752
    v_mov_b32 v12, 0
    s_mov_b32 s45, 0
L_c_fl:
    buffer_load_dwordx2 v[14:15], v12, s[32:35], s44 offen sc0 sc1
    s_waitcnt vmcnt(0)
    v_min_u32 v14, v14, v15
    v_cmp_ne_u32 vcc, 1, v14
    s_add_u32 s45, s45, 1
    s_cbranch_vccz L_c_f
    s_cmp_ge_u32 s45, 0x20000
    s_cbranch_scc1 L_c_f
    s_sleep 6
    s_branch L_c_fl
L_c_f:
    s_barrier
    s_mov_b32 s45, 0
    buffer_load_dwordx4 v[64:67], v40, s[32:35], s46 offen offset:0 sc0 sc1
    buffer_load_dwordx4 v[68:71], v40, s[32:35], s46 offen offset:1536 sc0 sc1
    buffer_load_dwordx4 v[72:75], v41, s[32:35], s46 offen offset:0 sc0 sc1
    buffer_load_dwordx4 v[76:79], v41, s[32:35], s46 offen offset:1536 sc0 sc1
L_pl_4:
    buffer_load_dwordx4 v[96:99], v40, s[32:35], s46 offen offset:0 sc0 sc1
    buffer_load_dwordx4 v[100:103], v40, s[32:35], s46 offen offset:1536 sc0 sc1
    buffer_load_dwordx4 v[104:107], v41, s[32:35], s46 offen offset:0 sc0 sc1
    buffer_load_dwordx4 v[108:111], v41, s[32:35], s46 offen offset:1536 sc0 sc1
    s_waitcnt vmcnt(4)
    v_max_u32 v14, v64, v65
    v_max3_u32 v14, v14, v66, v67
    v_max3_u32 v14, v14, v68, v69
    v_max3_u32 v14, v14, v70, v71
    v_max3_u32 v14, v14, v72, v73
    v_max3_u32 v14, v14, v74, v75
    v_max3_u32 v14, v14, v76, v77
    v_max3_u32 v14, v14, v78, v79
    v_cmp_eq_u32 vcc, -1, v14
    s_cbranch_vccz L_pl_4_a
    buffer_load_dwordx4 v[64:67], v40, s[32:35], s46 offen offset:0 sc0 sc1
    buffer_load_dwordx4 v[68:71], v40, s[32:35], s46 offen offset:1536 sc0 sc1
    buffer_load_dwordx4 v[72:75], v41, s[32:35], s46 offen offset:0 sc0 sc1
    buffer_load_dwordx4 v[76:79], v41, s[32:35], s46 offen offset:1536 sc0 sc1
    s_waitcnt vmcnt(4)
    v_max_u32 v14, v96, v97
    v_max3_u32 v14, v14, v98, v99
    v_max3_u32 v14, v14, v100, v101
    v_max3_u32 v14, v14, v102, v103
    v_max3_u32 v14, v14, v104, v105
    v_max3_u32 v14, v14, v106, v107
    v_max3_u32 v14, v14, v108, v109
    v_max3_u32 v14, v14, v110, v111
    v_cmp_eq_u32 vcc, -1, v14
    s_cbranch_vccz L_pl_4_b
    s_add_u32 s45, s45, 1
    s_cmp_lt_u32 s45, 0x20000
    s_cbranch_scc1 L_pl_4
L_pl_4_b:
    v_mov_b32 v16, v96
    v_mov_b32 v17, v97
    v_mov_b32 v18, v98
    v_mov_b32 v19, v99
    v_mov_b32 v20, v100
    v_mov_b32 v21, v101
    v_mov_b32 v22, v102
    v_mov_b32 v23, v103
    v_mov_b32 v24, v104
    v_mov_b32 v25, v105
    v_mov_b32 v26, v106
    v_mov_b32 v27, v107
    v_mov_b32 v28, v108
    v_mov_b32 v29, v109
    v_mov_b32 v30, v110
    v_mov_b32 v31, v111
    s_branch L_pl_4_e
L_pl_4_a:
    v_mov_b32 v16, v64
    v_mov_b32 v17, v65
    v_mov_b32 v18, v66
    v_mov_b32 v19, v67
    v_mov_b32 v20, v68
    v_mov_b32 v21, v69
    v_mov_b32 v22, v70
    v_mov_b32 v23, v71
    v_mov_b32 v24, v72
    v_mov_b32 v25, v73
    v_mov_b32 v26, v74
    v_mov_b32 v27, v75
    v_mov_b32 v28, v76
    v_mov_b32 v29, v77
    v_mov_b32 v30, v78
    v_mov_b32 v31, v79
L_pl_4_e:
    v_max_f32 v12, v18, v22
    v_sub_f32 v13, v18, v12
    v_sub_f32 v14, v22, v12
    v_mul_f32 v13, 0x3fb8aa3b, v13
    v_mul_f32 v14, 0x3fb8aa3b, v14
    v_exp_f32 v13, v13
    v_exp_f32 v14, v14
    s_nop 0
    v_mul_f32 v15, v13, v19
    v_fmac_f32 v15, v14, v23
    v_rcp_f32 v15, v15
    s_nop 0
    v_mul_f32 v13, v13, v15
    v_mul_f32 v14, v14, v15
    v_mul_f32 v12, v13, v16
    v_mul_f32 v15, v13, v17
    v_fmac_f32 v12, v14, v20
    v_fmac_f32 v15, v14, v21
    v_cvt_pk_bf16_f32 v12, v12, v15
    ds_write_b32 v46, v12 offset:29952
    v_max_f32 v12, v26, v30
    v_sub_f32 v13, v26, v12
    v_sub_f32 v14, v30, v12
    v_mul_f32 v13, 0x3fb8aa3b, v13
    v_mul_f32 v14, 0x3fb8aa3b, v14
    v_exp_f32 v13, v13
    v_exp_f32 v14, v14
    s_nop 0
    v_mul_f32 v15, v13, v27
    v_fmac_f32 v15, v14, v31
    v_rcp_f32 v15, v15
    s_nop 0
    v_mul_f32 v13, v13, v15
    v_mul_f32 v14, v14, v15
    v_mul_f32 v12, v13, v24
    v_mul_f32 v15, v13, v25
    v_fmac_f32 v12, v14, v28
    v_fmac_f32 v15, v14, v29
    v_cvt_pk_bf16_f32 v12, v12, v15
    ds_write_b32 v47, v12 offset:29952
    s_waitcnt lgkmcnt(0)
    s_barrier
    s_lshr_b32 s48, s53, 2
    s_and_b32 s49, s53, 3
    s_mul_i32 s50, s48, 384
    s_add_u32 s50, s50, 29952
    v_add_u32 v12, s50, v8
    s_mul_i32 s50, s48, 24576
    s_lshl_b32 s49, s49, 5
    s_add_u32 s50, s50, s49
    s_add_u32 s50, s50, 42496
    v_add_u32 v13, s50, v9
    s_waitcnt vmcnt(0)
    ds_read_b128 v[16:19], v12 offset:0
    ds_read_b64_tr_b16 v[40:41], v13 offset:0
    ds_read_b64_tr_b16 v[42:43], v13 offset:512
    ds_read_b128 v[20:23], v12 offset:64
    ds_read_b64_tr_b16 v[44:45], v13 offset:4096
    ds_read_b64_tr_b16 v[46:47], v13 offset:4608
    ds_read_b128 v[24:27], v12 offset:128
    ds_read_b64_tr_b16 v[48:49], v13 offset:8192
    ds_read_b64_tr_b16 v[50:51], v13 offset:8704
    ds_read_b128 v[28:31], v12 offset:192
    ds_read_b64_tr_b16 v[52:53], v13 offset:12288
    ds_read_b64_tr_b16 v[54:55], v13 offset:12800
    ds_read_b128 v[32:35], v12 offset:256
    ds_read_b64_tr_b16 v[56:57], v13 offset:16384
    ds_read_b64_tr_b16 v[58:59], v13 offset:16896
    ds_read_b128 v[36:39], v12 offset:320
    ds_read_b64_tr_b16 v[60:61], v13 offset:20480
    ds_read_b64_tr_b16 v[62:63], v13 offset:20992
    s_waitcnt lgkmcnt(15)
    v_mfma_f32_16x16x32_bf16 v[64:67], v[16:19], v[40:43], 0
    s_waitcnt lgkmcnt(12)
    v_mfma_f32_16x16x32_bf16 v[64:67], v[20:23], v[44:47], v[64:67]
    s_waitcnt lgkmcnt(9)
    v_mfma_f32_16x16x32_bf16 v[64:67], v[24:27], v[48:51], v[64:67]
    s_waitcnt lgkmcnt(6)
    v_mfma_f32_16x16x32_bf16 v[64:67], v[28:31], v[52:55], v[64:67]
    s_waitcnt lgkmcnt(3)
    v_mfma_f32_16x16x32_bf16 v[64:67], v[32:35], v[56:59], v[64:67]
    s_waitcnt lgkmcnt(0)
    v_mfma_f32_16x16x32_bf16 v[64:67], v[36:39], v[60:63], v[64:67]
    s_nop 15
    s_lshr_b32 s48, s53, 2
    s_and_b32 s49, s53, 3
    s_mul_i32 s48, s48, 1024
    s_lshl_b32 s49, s49, 6
    s_add_u32 s48, s48, s49
    v_lshlrev_b32 v12, 2, v6
    v_add_u32 v12, s48, v12
    s_mov_b64 exec, 0xffff
    ds_write_b32 v12, v64 offset:13824
    ds_write_b32 v12, v65 offset:14080
    ds_write_b32 v12, v66 offset:14336
    ds_write_b32 v12, v67 offset:14592
    s_mov_b64 exec, -1
    s_waitcnt lgkmcnt(0)
    s_barrier
    s_cmp_ge_u32 s53, 4
    s_cbranch_scc1 L_c_pub_done
    v_lshlrev_b32 v12, 2, v0
    ds_read_b32 v16, v12 offset:13824
    ds_read_b32 v17, v12 offset:14848
    ds_read_b32 v18, v12 offset:15872
    ds_read_b32 v19, v12 offset:16896
    s_waitcnt lgkmcnt(0)
    v_add_f32 v16, v16, v17
    v_add_f32 v18, v18, v19
    v_add_f32 v16, v16, v18
    v_mul_u32_u24 v12, 2560, v7
    v_lshl_add_u32 v12, v6, 2, v12
    s_mul_i32 s48, s54, 10240
    s_lshl_b32 s49, s55, 8
    s_add_u32 s48, s48, s49
    s_add_u32 s48, s48, 262144
    buffer_store_dword v16, v12, s[32:35], s48 offen sc0 sc1
    s_cmp_lg_u32 s53, 0
    s_cbranch_scc1 L_c_pub_done
    s_lshl_b32 s48, s97, 2
    s_add_u32 s48, s48, 454656
    v_mov_b32 v12, 0
    v_mov_b32 v13, 1
    s_mov_b64 exec, 1
    buffer_store_dword v13, v12, s[32:35], s48 offen sc0 sc1
    s_mov_b64 exec, -1
L_c_pub_done:
    s_endpgm
L_tail_e:
    v_and_b32 v12, 3, v6
    v_mul_u32_u24 v8, 3136, v12
    v_lshlrev_b32 v9, 3, v12
    v_lshrrev_b32 v12, 4, v6
    v_lshl_add_u32 v8, v12, 4, v8
    v_mul_u32_u24 v12, 512, v12
    v_add_u32 v9, v9, v12
    v_bfe_u32 v12, v6, 2, 2
    v_mul_u32_u24 v12, 64, v12
    v_add_u32 v9, v9, v12
    s_barrier
    v_min_u32 v57, 39, v6
    s_lshr_b32 s48, s53, 2
    s_mul_i32 s48, s48, 40
    v_add_u32 v57, s48, v57
    v_cmp_gt_u32 vcc, 40, v6
    s_nop 1
    v_cndmask_b32_e64 v56, 0, 1.0, vcc
    s_and_b32 s49, s53, 3
    s_mul_i32 s50, s49, 1280
    v_lshlrev_b32 v58, 3, v57
    buffer_load_dwordx2 v[48:49], v58, s[56:59], s50 offen
    buffer_load_dwordx2 v[50:51], v58, s[72:75], 0 offen
    s_mul_i32 s51, s49, 1344
    v_add_u32 v62, s51, v58
    v_lshlrev_b32 v59, 4, v57
    s_mul_i32 s50, s49, 2560
    s_add_u32 s50, s50, 262144
    s_mov_b32 s45, 0
    s_mov_b32 s44, s50
    buffer_load_dwordx4 v[64:67], v59, s[32:35], s44 offen sc0 sc1
    s_add_u32 s44, s44, 10240
    buffer_load_dwordx4 v[68:71], v59, s[32:35], s44 offen sc0 sc1
    s_add_u32 s44, s44, 10240
    buffer_load_dwordx4 v[72:75], v59, s[32:35], s44 offen sc0 sc1
    s_add_u32 s44, s44, 10240
    buffer_load_dwordx4 v[76:79], v59, s[32:35], s44 offen sc0 sc1
    s_add_u32 s44, s44, 10240
    buffer_load_dwordx4 v[80:83], v59, s[32:35], s44 offen sc0 sc1
    s_add_u32 s44, s44, 10240
    buffer_load_dwordx4 v[84:87], v59, s[32:35], s44 offen sc0 sc1
    s_add_u32 s44, s44, 10240
    buffer_load_dwordx4 v[88:91], v59, s[32:35], s44 offen sc0 sc1
    s_add_u32 s44, s44, 10240
    buffer_load_dwordx4 v[92:95], v59, s[32:35], s44 offen sc0 sc1
L_pl_5:
    s_mov_b32 s44, s50
    buffer_load_dwordx4 v[96:99], v59, s[32:35], s44 offen sc0 sc1
    s_add_u32 s44, s44, 10240
    buffer_load_dwordx4 v[100:103], v59, s[32:35], s44 offen sc0 sc1
    s_add_u32 s44, s44, 10240
    buffer_load_dwordx4 v[104:107], v59, s[32:35], s44 offen sc0 sc1
    s_add_u32 s44, s44, 10240
    buffer_load_dwordx4 v[108:111], v59, s[32:35], s44 offen sc0 sc1
    s_add_u32 s44, s44, 10240
    buffer_load_dwordx4 v[112:115], v59, s[32:35], s44 offen sc0 sc1
    s_add_u32 s44, s44, 10240
    buffer_load_dwordx4 v[116:119], v59, s[32:35], s44 offen sc0 sc1
    s_add_u32 s44, s44, 10240
    buffer_load_dwordx4 v[120:123], v59, s[32:35], s44 offen sc0 sc1
    s_add_u32 s44, s44, 10240
    buffer_load_dwordx4 v[124:127], v59, s[32:35], s44 offen sc0 sc1
    s_waitcnt vmcnt(8)
    v_max_u32 v60, v64, v65
    v_max3_u32 v60, v60, v66, v67
    v_max3_u32 v60, v60, v68, v69
    v_max3_u32 v60, v60, v70, v71
    v_max3_u32 v60, v60, v72, v73
    v_max3_u32 v60, v60, v74, v75
    v_max3_u32 v60, v60, v76, v77
    v_max3_u32 v60, v60, v78, v79
    v_max3_u32 v60, v60, v80, v81
    v_max3_u32 v60, v60, v82, v83
    v_max3_u32 v60, v60, v84, v85
    v_max3_u32 v60, v60, v86, v87
    v_max3_u32 v60, v60, v88, v89
    v_max3_u32 v60, v60, v90, v91
    v_max3_u32 v60, v60, v92, v93
    v_max3_u32 v60, v60, v94, v95
    v_cmp_eq_u32 vcc, -1, v60
    s_cbranch_vccz L_pl_5_a
    s_mov_b32 s44, s50
    buffer_load_dwordx4 v[64:67], v59, s[32:35], s44 offen sc0 sc1
    s_add_u32 s44, s44, 10240
    buffer_load_dwordx4 v[68:71], v59, s[32:35], s44 offen sc0 sc1
    s_add_u32 s44, s44, 10240
    buffer_load_dwordx4 v[72:75], v59, s[32:35], s44 offen sc0 sc1
    s_add_u32 s44, s44, 10240
    buffer_load_dwordx4 v[76:79], v59, s[32:35], s44 offen sc0 sc1
    s_add_u32 s44, s44, 10240
    buffer_load_dwordx4 v[80:83], v59, s[32:35], s44 offen sc0 sc1
    s_add_u32 s44, s44, 10240
    buffer_load_dwordx4 v[84:87], v59, s[32:35], s44 offen sc0 sc1
    s_add_u32 s44, s44, 10240
    buffer_load_dwordx4 v[88:91], v59, s[32:35], s44 offen sc0 sc1
    s_add_u32 s44, s44, 10240
    buffer_load_dwordx4 v[92:95], v59, s[32:35], s44 offen sc0 sc1
    s_waitcnt vmcnt(8)
    v_max_u32 v60, v96, v97
    v_max3_u32 v60, v60, v98, v99
    v_max3_u32 v60, v60, v100, v101
    v_max3_u32 v60, v60, v102, v103
    v_max3_u32 v60, v60, v104, v105
    v_max3_u32 v60, v60, v106, v107
    v_max3_u32 v60, v60, v108, v109
    v_max3_u32 v60, v60, v110, v111
    v_max3_u32 v60, v60, v112, v113
    v_max3_u32 v60, v60, v114, v115
    v_max3_u32 v60, v60, v116, v117
    v_max3_u32 v60, v60, v118, v119
    v_max3_u32 v60, v60, v120, v121
    v_max3_u32 v60, v60, v122, v123
    v_max3_u32 v60, v60, v124, v125
    v_max3_u32 v60, v60, v126, v127
    v_cmp_eq_u32 vcc, -1, v60
    s_cbranch_vccz L_pl_5_b
    s_add_u32 s45, s45, 1
    s_cmp_lt_u32 s45, 0x20000
    s_cbranch_scc1 L_pl_5
L_pl_5_b:
    v_mov_b32 v16, v96
    v_mov_b32 v17, v97
    v_mov_b32 v18, v98
    v_mov_b32 v19, v99
    v_mov_b32 v20, v100
    v_mov_b32 v21, v101
    v_mov_b32 v22, v102
    v_mov_b32 v23, v103
    v_mov_b32 v24, v104
    v_mov_b32 v25, v105
    v_mov_b32 v26, v106
    v_mov_b32 v27, v107
    v_mov_b32 v28, v108
    v_mov_b32 v29, v109
    v_mov_b32 v30, v110
    v_mov_b32 v31, v111
    v_mov_b32 v32, v112
    v_mov_b32 v33, v113
    v_mov_b32 v34, v114
    v_mov_b32 v35, v115
    v_mov_b32 v36, v116
    v_mov_b32 v37, v117
    v_mov_b32 v38, v118
    v_mov_b32 v39, v119
    v_mov_b32 v40, v120
    v_mov_b32 v41, v121
    v_mov_b32 v42, v122
    v_mov_b32 v43, v123
    v_mov_b32 v44, v124
    v_mov_b32 v45, v125
    v_mov_b32 v46, v126
    v_mov_b32 v47, v127
    s_branch L_pl_5_e
L_pl_5_a:
    v_mov_b32 v16, v64
    v_mov_b32 v17, v65
    v_mov_b32 v18, v66
    v_mov_b32 v19, v67
    v_mov_b32 v20, v68
    v_mov_b32 v21, v69
    v_mov_b32 v22, v70
    v_mov_b32 v23, v71
    v_mov_b32 v24, v72
    v_mov_b32 v25, v73
    v_mov_b32 v26, v74
    v_mov_b32 v27, v75
    v_mov_b32 v28, v76
    v_mov_b32 v29, v77
    v_mov_b32 v30, v78
    v_mov_b32 v31, v79
    v_mov_b32 v32, v80
    v_mov_b32 v33, v81
    v_mov_b32 v34, v82
    v_mov_b32 v35, v83
    v_mov_b32 v36, v84
    v_mov_b32 v37, v85
    v_mov_b32 v38, v86
    v_mov_b32 v39, v87
    v_mov_b32 v40, v88
    v_mov_b32 v41, v89
    v_mov_b32 v42, v90
    v_mov_b32 v43, v91
    v_mov_b32 v44, v92
    v_mov_b32 v45, v93
    v_mov_b32 v46, v94
    v_mov_b32 v47, v95
L_pl_5_e:
    v_add_f32 v16, v16, v32
    v_add_f32 v20, v20, v36
    v_add_f32 v24, v24, v40
    v_add_f32 v28, v28, v44
    v_add_f32 v52, v16, v20
    v_add_f32 v60, v24, v28
    v_add_f32 v52, v52, v60
    v_cvt_pk_bf16_f32 v52, v52, v52
    v_lshlrev_b32 v52, 16, v52
    v_add_f32 v17, v17, v33
    v_add_f32 v21, v21, v37
    v_add_f32 v25, v25, v41
    v_add_f32 v29, v29, v45
    v_add_f32 v53, v17, v21
    v_add_f32 v60, v25, v29
    v_add_f32 v53, v53, v60
    v_cvt_pk_bf16_f32 v53, v53, v53
    v_lshlrev_b32 v53, 16, v53
    v_add_f32 v18, v18, v34
    v_add_f32 v22, v22, v38
    v_add_f32 v26, v26, v42
    v_add_f32 v30, v30, v46
    v_add_f32 v54, v18, v22
    v_add_f32 v60, v26, v30
    v_add_f32 v54, v54, v60
    v_cvt_pk_bf16_f32 v54, v54, v54
    v_lshlrev_b32 v54, 16, v54
    v_add_f32 v19, v19, v35
    v_add_f32 v23, v23, v39
    v_add_f32 v27, v27, v43
    v_add_f32 v31, v31, v47
    v_add_f32 v55, v19, v23
    v_add_f32 v60, v27, v31
    v_add_f32 v55, v55, v60
    v_cvt_pk_bf16_f32 v55, v55, v55
    v_lshlrev_b32 v55, 16, v55
    v_lshlrev_b32 v58, 16, v48
    v_and_b32 v59, 0xffff0000, v48
    v_lshlrev_b32 v60, 16, v49
    v_and_b32 v61, 0xffff0000, v49
    v_add_f32 v52, v52, v58
    v_cvt_pk_bf16_f32 v52, v52, v52
    v_lshlrev_b32 v52, 16, v52
    v_add_f32 v53, v53, v59
    v_cvt_pk_bf16_f32 v53, v53, v53
    v_lshlrev_b32 v53, 16, v53
    v_add_f32 v54, v54, v60
    v_cvt_pk_bf16_f32 v54, v54, v54
    v_lshlrev_b32 v54, 16, v54
    v_add_f32 v55, v55, v61
    v_cvt_pk_bf16_f32 v55, v55, v55
    v_lshlrev_b32 v55, 16, v55
    v_add_f32 v58, v52, v53
    v_add_f32 v59, v54, v55
    v_add_f32 v58, v58, v59
    v_mul_f32 v58, v58, v56
    s_nop 1
    v_add_f32_dpp v58, v58, v58 quad_perm:[1,0,3,2] row_mask:0xf bank_mask:0xf
    s_nop 1
    v_add_f32_dpp v58, v58, v58 quad_perm:[2,3,0,1] row_mask:0xf bank_mask:0xf
    s_nop 1
    v_add_f32_dpp v58, v58, v58 row_half_mirror row_mask:0xf bank_mask:0xf
    s_nop 1
    v_add_f32_dpp v58, v58, v58 row_mirror row_mask:0xf bank_mask:0xf
    s_nop 1
    v_readlane_b32 s48, v58, 0
    v_readlane_b32 s49, v58, 16
    v_readlane_b32 s50, v58, 32
    v_readlane_b32 s51, v58, 48
    s_nop 1
    v_mov_b32 v58, s48
    v_add_f32 v58, s49, v58
    v_add_f32 v58, s50, v58
    v_add_f32 v58, s51, v58
    v_mul_f32 v58, 0x3bcccccd, v58
    v_sub_f32 v60, v52, v58
    v_mul_f32 v59, v60, v60
    v_sub_f32 v60, v53, v58
    v_fmac_f32 v59, v60, v60
    v_sub_f32 v60, v54, v58
    v_fmac_f32 v59, v60, v60
    v_sub_f32 v60, v55, v58
    v_fmac_f32 v59, v60, v60
    v_mul_f32 v59, v59, v56
    s_nop 1
    v_add_f32_dpp v59, v59, v59 quad_perm:[1,0,3,2] row_mask:0xf bank_mask:0xf
    s_nop 1
    v_add_f32_dpp v59, v59, v59 quad_perm:[2,3,0,1] row_mask:0xf bank_mask:0xf
    s_nop 1
    v_add_f32_dpp v59, v59, v59 row_half_mirror row_mask:0xf bank_mask:0xf
    s_nop 1
    v_add_f32_dpp v59, v59, v59 row_mirror row_mask:0xf bank_mask:0xf
    s_nop 1
    v_readlane_b32 s48, v59, 0
    v_readlane_b32 s49, v59, 16
    v_readlane_b32 s50, v59, 32
    v_readlane_b32 s51, v59, 48
    s_nop 1
    v_mov_b32 v59, s48
    v_add_f32 v59, s49, v59
    v_add_f32 v59, s50, v59
    v_add_f32 v59, s51, v59
    s_lshl_b32 s49, s53, 5
    s_and_b32 s49, s49, 96
    s_and_b32 s50, s53, 12
    s_lshl_b32 s50, s50, 1
    s_add_u32 s50, s50, s49
    v_mov_b32 v60, s50
    v_mov_b32 v61, s49
    ds_write_b64 v60, v[58:59] offset:29696
    s_waitcnt lgkmcnt(0)
    s_barrier
    ds_read_b128 v[16:19], v61 offset:29696
    ds_read_b128 v[20:23], v61 offset:29712
    s_waitcnt lgkmcnt(0)
    v_add_f32 v24, v16, v18
    v_add_f32 v25, v20, v22
    v_add_f32 v24, v24, v25
    v_mul_f32 v24, 0.25, v24
    v_add_f32 v25, v17, v19
    v_add_f32 v26, v21, v23
    v_add_f32 v25, v25, v26
    v_sub_f32 v16, v16, v24
    v_sub_f32 v18, v18, v24
    v_sub_f32 v20, v20, v24
    v_sub_f32 v22, v22, v24
    v_mul_f32 v26, v16, v16
    v_fmac_f32 v26, v18, v18
    v_fmac_f32 v26, v20, v20
    v_fmac_f32 v26, v22, v22
    v_mov_b32 v27, 0x43200000
    v_fmac_f32 v25, v26, v27
    v_mul_f32 v25, 0x3acccccd, v25
    v_cvt_pk_bf16_f32 v24, v24, v24
    v_lshlrev_b32 v24, 16, v24
    v_cvt_pk_bf16_f32 v25, v25, v25
    v_lshlrev_b32 v25, 16, v25
    v_add_f32 v25, 0x3727c5ac, v25
    v_cvt_pk_bf16_f32 v25, v25, v25
    v_lshlrev_b32 v25, 16, v25
    v_sqrt_f32 v25, v25
    s_nop 0
    v_cvt_pk_bf16_f32 v25, v25, v25
    v_lshlrev_b32 v25, 16, v25
    v_rcp_f32 v25, v25
    s_nop 0
    v_sub_f32 v28, v52, v24
    v_cvt_pk_bf16_f32 v28, v28, v28
    v_lshlrev_b32 v28, 16, v28
    v_mul_f32 v28, v28, v25
    v_cvt_pk_bf16_f32 v28, v28, v28
    v_lshlrev_b32 v28, 16, v28
    v_sub_f32 v29, v53, v24
    v_cvt_pk_bf16_f32 v29, v29, v29
    v_lshlrev_b32 v29, 16, v29
    v_mul_f32 v29, v29, v25
    v_cvt_pk_bf16_f32 v29, v29, v29
    v_lshlrev_b32 v29, 16, v29
    v_sub_f32 v30, v54, v24
    v_cvt_pk_bf16_f32 v30, v30, v30
    v_lshlrev_b32 v30, 16, v30
    v_mul_f32 v30, v30, v25
    v_cvt_pk_bf16_f32 v30, v30, v30
    v_lshlrev_b32 v30, 16, v30
    v_sub_f32 v31, v55, v24
    v_cvt_pk_bf16_f32 v31, v31, v31
    v_lshlrev_b32 v31, 16, v31
    v_mul_f32 v31, v31, v25
    v_cvt_pk_bf16_f32 v31, v31, v31
    v_lshlrev_b32 v31, 16, v31
    v_cvt_pk_bf16_f32 v32, v28, v29
    v_cvt_pk_bf16_f32 v33, v30, v31
    v_cvt_pk_bf16_f32 v34, v52, v53
    v_cvt_pk_bf16_f32 v35, v54, v55
    v_lshlrev_b32 v58, 16, v50
    v_and_b32 v59, 0xffff0000, v50
    v_mul_f32 v36, v28, v58
    v_fmac_f32 v36, v29, v59
    v_lshlrev_b32 v58, 16, v51
    v_and_b32 v59, 0xffff0000, v51
    v_fmac_f32 v36, v30, v58
    v_fmac_f32 v36, v31, v59
    v_mul_f32 v36, v36, v56
    s_nop 1
    v_add_f32_dpp v36, v36, v36 quad_perm:[1,0,3,2] row_mask:0xf bank_mask:0xf
    s_nop 1
    v_add_f32_dpp v36, v36, v36 quad_perm:[2,3,0,1] row_mask:0xf bank_mask:0xf
    s_nop 1
    v_add_f32_dpp v36, v36, v36 row_half_mirror row_mask:0xf bank_mask:0xf
    s_nop 1
    v_add_f32_dpp v36, v36, v36 row_mirror row_mask:0xf bank_mask:0xf
    s_nop 1
    v_readlane_b32 s48, v36, 0
    v_readlane_b32 s49, v36, 16
    v_readlane_b32 s50, v36, 32
    v_readlane_b32 s51, v36, 48
    s_nop 1
    v_mov_b32 v36, s48
    v_add_f32 v36, s49, v36
    v_add_f32 v36, s50, v36
    v_add_f32 v36, s51, v36
    v_lshrrev_b32 v60, 1, v60
    ds_write_b32 v60, v36 offset:29824
    s_mov_b32 exec_lo, -1
    s_mov_b32 exec_hi, 0xff
    ds_write_b64 v62, v[32:33] offset:18944
    ds_write_b64 v62, v[34:35] offset:24320
    s_mov_b64 exec, -1
    s_cmp_lt_u32 s53, 4
    s_cbranch_scc1 L_e_wait
L_e_act:
    v_subrev_u32 v15, 256, v0
    v_lshlrev_b32 v12, 4, v15
    v_mul_u32_u24 v13, 43691, v15
    v_lshrrev_b32 v13, 23, v13
    v_mul_u32_u24 v14, 64, v13
    v_add_u32 v14, v14, v12
    s_mov_b32 s45, 0
    s_mov_b32 s46, 360448
    buffer_load_dwordx4 v[80:83], v12, s[32:35], s46 offen sc0 sc1
    s_mov_b32 s46, 376832
    buffer_load_dwordx4 v[84:87], v12, s[32:35], s46 offen sc0 sc1
L_pl_6:
    s_mov_b32 s46, 360448
    buffer_load_dwordx4 v[96:99], v12, s[32:35], s46 offen sc0 sc1
    s_mov_b32 s46, 376832
    buffer_load_dwordx4 v[100:103], v12, s[32:35], s46 offen sc0 sc1
    s_waitcnt vmcnt(2)
    v_max_u32 v15, v80, v81
    v_max3_u32 v15, v15, v82, v83
    v_max3_u32 v15, v15, v84, v85
    v_max3_u32 v15, v15, v86, v87
    v_cmp_eq_u32 vcc, -1, v15
    s_cbranch_vccz L_pl_6_a
    s_mov_b32 s46, 360448
    buffer_load_dwordx4 v[80:83], v12, s[32:35], s46 offen sc0 sc1
    s_mov_b32 s46, 376832
    buffer_load_dwordx4 v[84:87], v12, s[32:35], s46 offen sc0 sc1
    s_waitcnt vmcnt(2)
    v_max_u32 v15, v96, v97
    v_max3_u32 v15, v15, v98, v99
    v_max3_u32 v15, v15, v100, v101
    v_max3_u32 v15, v15, v102, v103
    v_cmp_eq_u32 vcc, -1, v15
    s_cbranch_vccz L_pl_6_b
    s_add_u32 s45, s45, 1
    s_cmp_lt_u32 s45, 0x20000
    s_cbranch_scc1 L_pl_6
L_pl_6_b:
    v_mov_b32 v16, v96
    v_mov_b32 v17, v97
    v_mov_b32 v18, v98
    v_mov_b32 v19, v99
    v_mov_b32 v20, v100
    v_mov_b32 v21, v101
    v_mov_b32 v22, v102
    v_mov_b32 v23, v103
    s_branch L_pl_6_e
L_pl_6_a:
    v_mov_b32 v16, v80
    v_mov_b32 v17, v81
    v_mov_b32 v18, v82
    v_mov_b32 v19, v83
    v_mov_b32 v20, v84
    v_mov_b32 v21, v85
    v_mov_b32 v22, v86
    v_mov_b32 v23, v87
L_pl_6_e:
    v_lshlrev_b32 v24, 16, v16
    v_and_b32 v25, 0xffff0000, v16
    v_lshlrev_b32 v26, 16, v20
    v_and_b32 v27, 0xffff0000, v20
    v_mul_f32 v28, 0xbfb8aa3b, v24
    v_mul_f32 v29, 0xbfb8aa3b, v25
    v_exp_f32 v28, v28
    v_exp_f32 v29, v29
    s_nop 0
    v_add_f32 v28, 1.0, v28
    v_add_f32 v29, 1.0, v29
    v_rcp_f32 v28, v28
    v_rcp_f32 v29, v29
    s_nop 0
    v_mul_f32 v24, v24, v28
    v_mul_f32 v25, v25, v29
    v_cvt_pk_bf16_f32 v24, v24, v24
    v_lshlrev_b32 v24, 16, v24
    v_cvt_pk_bf16_f32 v25, v25, v25
    v_lshlrev_b32 v25, 16, v25
    v_mul_f32 v24, v24, v26
    v_mul_f32 v25, v25, v27
    v_cvt_pk_bf16_f32 v32, v24, v25
    v_lshlrev_b32 v24, 16, v17
    v_and_b32 v25, 0xffff0000, v17
    v_lshlrev_b32 v26, 16, v21
    v_and_b32 v27, 0xffff0000, v21
    v_mul_f32 v28, 0xbfb8aa3b, v24
    v_mul_f32 v29, 0xbfb8aa3b, v25
    v_exp_f32 v28, v28
    v_exp_f32 v29, v29
    s_nop 0
    v_add_f32 v28, 1.0, v28
    v_add_f32 v29, 1.0, v29
    v_rcp_f32 v28, v28
    v_rcp_f32 v29, v29
    s_nop 0
    v_mul_f32 v24, v24, v28
    v_mul_f32 v25, v25, v29
    v_cvt_pk_bf16_f32 v24, v24, v24
    v_lshlrev_b32 v24, 16, v24
    v_cvt_pk_bf16_f32 v25, v25, v25
    v_lshlrev_b32 v25, 16, v25
    v_mul_f32 v24, v24, v26
    v_mul_f32 v25, v25, v27
    v_cvt_pk_bf16_f32 v33, v24, v25
    v_lshlrev_b32 v24, 16, v18
    v_and_b32 v25, 0xffff0000, v18
    v_lshlrev_b32 v26, 16, v22
    v_and_b32 v27, 0xffff0000, v22
    v_mul_f32 v28, 0xbfb8aa3b, v24
    v_mul_f32 v29, 0xbfb8aa3b, v25
    v_exp_f32 v28, v28
    v_exp_f32 v29, v29
    s_nop 0
    v_add_f32 v28, 1.0, v28
    v_add_f32 v29, 1.0, v29
    v_rcp_f32 v28, v28
    v_rcp_f32 v29, v29
    s_nop 0
    v_mul_f32 v24, v24, v28
    v_mul_f32 v25, v25, v29
    v_cvt_pk_bf16_f32 v24, v24, v24
    v_lshlrev_b32 v24, 16, v24
    v_cvt_pk_bf16_f32 v25, v25, v25
    v_lshlrev_b32 v25, 16, v25
    v_mul_f32 v24, v24, v26
    v_mul_f32 v25, v25, v27
    v_cvt_pk_bf16_f32 v34, v24, v25
    v_lshlrev_b32 v24, 16, v19
    v_and_b32 v25, 0xffff0000, v19
    v_lshlrev_b32 v26, 16, v23
    v_and_b32 v27, 0xffff0000, v23
    v_mul_f32 v28, 0xbfb8aa3b, v24
    v_mul_f32 v29, 0xbfb8aa3b, v25
    v_exp_f32 v28, v28
    v_exp_f32 v29, v29
    s_nop 0
    v_add_f32 v28, 1.0, v28
    v_add_f32 v29, 1.0, v29
    v_rcp_f32 v28, v28
    v_rcp_f32 v29, v29
    s_nop 0
    v_mul_f32 v24, v24, v28
    v_mul_f32 v25, v25, v29
    v_cvt_pk_bf16_f32 v24, v24, v24
    v_lshlrev_b32 v24, 16, v24
    v_cvt_pk_bf16_f32 v25, v25, v25
    v_lshlrev_b32 v25, 16, v25
    v_mul_f32 v24, v24, v26
    v_mul_f32 v25, v25, v27
    v_cvt_pk_bf16_f32 v35, v24, v25
    ds_write_b128 v14, v[32:35] offset:29952
L_e_wait:
    s_waitcnt lgkmcnt(0)
    s_barrier
    s_lshr_b32 s48, s53, 1
    s_and_b32 s49, s53, 1
    s_mul_i32 s50, s48, 384
    s_add_u32 s50, s50, 29952
    v_add_u32 v12, s50, v8
    s_mul_i32 s50, s48, 12288
    s_lshl_b32 s49, s49, 5
    s_add_u32 s50, s50, s49
    s_add_u32 s50, s50, 42496
    v_add_u32 v13, s50, v9
    s_waitcnt vmcnt(0)
    ds_read_b128 v[16:19], v12 offset:0
    ds_read_b64_tr_b16 v[40:41], v13 offset:0
    ds_read_b64_tr_b16 v[42:43], v13 offset:256
    ds_read_b128 v[20:23], v12 offset:64
    ds_read_b64_tr_b16 v[44:45], v13 offset:2048
    ds_read_b64_tr_b16 v[46:47], v13 offset:2304
    ds_read_b128 v[24:27], v12 offset:128
    ds_read_b64_tr_b16 v[48:49], v13 offset:4096
    ds_read_b64_tr_b16 v[50:51], v13 offset:4352
    ds_read_b128 v[28:31], v12 offset:192
    ds_read_b64_tr_b16 v[52:53], v13 offset:6144
    ds_read_b64_tr_b16 v[54:55], v13 offset:6400
    ds_read_b128 v[32:35], v12 offset:256
    ds_read_b64_tr_b16 v[56:57], v13 offset:8192
    ds_read_b64_tr_b16 v[58:59], v13 offset:8448
    ds_read_b128 v[36:39], v12 offset:320
    ds_read_b64_tr_b16 v[60:61], v13 offset:10240
    ds_read_b64_tr_b16 v[62:63], v13 offset:10496
    s_waitcnt lgkmcnt(15)
    v_mfma_f32_16x16x32_bf16 v[64:67], v[16:19], v[40:43], 0
    s_waitcnt lgkmcnt(12)
    v_mfma_f32_16x16x32_bf16 v[64:67], v[20:23], v[44:47], v[64:67]
    s_waitcnt lgkmcnt(9)
    v_mfma_f32_16x16x32_bf16 v[64:67], v[24:27], v[48:51], v[64:67]
    s_waitcnt lgkmcnt(6)
    v_mfma_f32_16x16x32_bf16 v[64:67], v[28:31], v[52:55], v[64:67]
    s_waitcnt lgkmcnt(3)
    v_mfma_f32_16x16x32_bf16 v[64:67], v[32:35], v[56:59], v[64:67]
    s_waitcnt lgkmcnt(0)
    v_mfma_f32_16x16x32_bf16 v[64:67], v[36:39], v[60:63], v[64:67]
    s_nop 15
    s_lshr_b32 s48, s53, 1
    s_and_b32 s49, s53, 1
    s_mul_i32 s48, s48, 512
    s_lshl_b32 s49, s49, 6
    s_add_u32 s48, s48, s49
    v_lshlrev_b32 v12, 2, v6
    v_add_u32 v12, s48, v12
    s_mov_b64 exec, 0xffff
    ds_write_b32 v12, v64 offset:13824
    ds_write_b32 v12, v65 offset:13952
    ds_write_b32 v12, v66 offset:14080
    ds_write_b32 v12, v67 offset:14208
    s_mov_b64 exec, -1
    s_waitcnt lgkmcnt(0)
    s_barrier
    s_cmp_ge_u32 s53, 2
    s_cbranch_scc1 L_done
    v_lshlrev_b32 v12, 2, v0
    ds_read_b32 v16, v12 offset:13824
    ds_read_b32 v17, v12 offset:14336
    ds_read_b32 v18, v12 offset:14848
    ds_read_b32 v19, v12 offset:15360
    ds_read_b32 v20, v12 offset:15872
    ds_read_b32 v21, v12 offset:16384
    ds_read_b32 v22, v12 offset:16896
    ds_read_b32 v23, v12 offset:17408
    v_and_b32 v13, 31, v0
    s_lshl_b32 s48, s55, 5
    v_add_u32 v13, s48, v13
    v_lshrrev_b32 v14, 5, v0
    v_mul_u32_u24 v15, 1344, v14
    v_lshl_add_u32 v15, v13, 1, v15
    v_lshlrev_b32 v12, 4, v14
    ds_read_u16 v40, v15 offset:18944
    ds_read_u16 v41, v15 offset:24320
    ds_read_b128 v[44:47], v12 offset:29824
    s_waitcnt lgkmcnt(0)
    v_add_f32 v44, v44, v45
    v_add_f32 v46, v46, v47
    v_add_f32 v42, v44, v46
    v_cvt_pk_bf16_f32 v42, v42, v42
    v_lshlrev_b32 v42, 16, v42
    v_mul_f32 v42, 0xbfb8aa3b, v42
    v_exp_f32 v42, v42
    s_nop 0
    v_add_f32 v42, 1.0, v42
    v_rcp_f32 v42, v42
    s_nop 0
    v_cvt_pk_bf16_f32 v42, v42, v42
    v_lshlrev_b32 v42, 16, v42
    v_add_f32 v16, v16, v20
    v_add_f32 v17, v17, v21
    v_add_f32 v18, v18, v22
    v_add_f32 v19, v19, v23
    v_add_f32 v16, v16, v18
    v_add_f32 v17, v17, v19
    v_add_f32 v16, v16, v17
    v_lshlrev_b32 v40, 16, v40
    v_lshlrev_b32 v41, 16, v41
    v_cvt_pk_bf16_f32 v16, v16, v16
    v_lshlrev_b32 v16, 16, v16
    v_mul_f32 v16, v16, v42
    v_cvt_pk_bf16_f32 v16, v16, v16
    v_lshlrev_b32 v16, 16, v16
    v_add_f32 v16, v40, v16
    v_cvt_pk_bf16_f32 v16, v16, v16
    v_lshlrev_b32 v16, 16, v16
    v_add_f32 v16, v41, v16
    v_cvt_pk_bf16_f32 v16, v16, v16
    v_mul_u32_u24 v14, 640, v14
    v_add_u32 v14, v14, v13
    v_lshlrev_b32 v14, 1, v14
    buffer_store_short v16, v14, s[76:79], 0 offen
    s_endpgm
L_tail_d:
    v_and_b32 v12, 3, v6
    v_mul_u32_u24 v8, 1344, v12
    v_lshlrev_b32 v9, 3, v12
    v_lshrrev_b32 v12, 4, v6
    v_lshl_add_u32 v8, v12, 4, v8
    v_mul_u32_u24 v12, 1024, v12
    v_add_u32 v9, v9, v12
    v_bfe_u32 v12, v6, 2, 2
    v_mul_u32_u24 v12, 128, v12
    v_add_u32 v9, v9, v12
    s_barrier
    v_min_u32 v57, 39, v6
    s_lshr_b32 s48, s53, 2
    s_mul_i32 s48, s48, 40
    v_add_u32 v57, s48, v57
    v_cmp_gt_u32 vcc, 40, v6
    s_nop 1
    v_cndmask_b32_e64 v56, 0, 1.0, vcc
    s_and_b32 s49, s53, 3
    s_mul_i32 s50, s49, 1280
    v_lshlrev_b32 v58, 3, v57
    buffer_load_dwordx2 v[48:49], v58, s[56:59], s50 offen
    s_mul_i32 s51, s49, 1344
    v_add_u32 v62, s51, v58
    v_lshlrev_b32 v59, 4, v57
    s_mul_i32 s50, s49, 2560
    s_add_u32 s50, s50, 262144
    s_mov_b32 s45, 0
    s_mov_b32 s44, s50
    buffer_load_dwordx4 v[64:67], v59, s[32:35], s44 offen sc0 sc1
    s_add_u32 s44, s44, 10240
    buffer_load_dwordx4 v[68:71], v59, s[32:35], s44 offen sc0 sc1
    s_add_u32 s44, s44, 10240
    buffer_load_dwordx4 v[72:75], v59, s[32:35], s44 offen sc0 sc1
    s_add_u32 s44, s44, 10240
    buffer_load_dwordx4 v[76:79], v59, s[32:35], s44 offen sc0 sc1
    s_add_u32 s44, s44, 10240
    buffer_load_dwordx4 v[80:83], v59, s[32:35], s44 offen sc0 sc1
    s_add_u32 s44, s44, 10240
    buffer_load_dwordx4 v[84:87], v59, s[32:35], s44 offen sc0 sc1
    s_add_u32 s44, s44, 10240
    buffer_load_dwordx4 v[88:91], v59, s[32:35], s44 offen sc0 sc1
    s_add_u32 s44, s44, 10240
    buffer_load_dwordx4 v[92:95], v59, s[32:35], s44 offen sc0 sc1
L_pl_7:
    s_mov_b32 s44, s50
    buffer_load_dwordx4 v[96:99], v59, s[32:35], s44 offen sc0 sc1
    s_add_u32 s44, s44, 10240
    buffer_load_dwordx4 v[100:103], v59, s[32:35], s44 offen sc0 sc1
    s_add_u32 s44, s44, 10240
    buffer_load_dwordx4 v[104:107], v59, s[32:35], s44 offen sc0 sc1
    s_add_u32 s44, s44, 10240
    buffer_load_dwordx4 v[108:111], v59, s[32:35], s44 offen sc0 sc1
    s_add_u32 s44, s44, 10240
    buffer_load_dwordx4 v[112:115], v59, s[32:35], s44 offen sc0 sc1
    s_add_u32 s44, s44, 10240
    buffer_load_dwordx4 v[116:119], v59, s[32:35], s44 offen sc0 sc1
    s_add_u32 s44, s44, 10240
    buffer_load_dwordx4 v[120:123], v59, s[32:35], s44 offen sc0 sc1
    s_add_u32 s44, s44, 10240
    buffer_load_dwordx4 v[124:127], v59, s[32:35], s44 offen sc0 sc1
    s_waitcnt vmcnt(8)
    v_max_u32 v60, v64, v65
    v_max3_u32 v60, v60, v66, v67
    v_max3_u32 v60, v60, v68, v69
    v_max3_u32 v60, v60, v70, v71
    v_max3_u32 v60, v60, v72, v73
    v_max3_u32 v60, v60, v74, v75
    v_max3_u32 v60, v60, v76, v77
    v_max3_u32 v60, v60, v78, v79
    v_max3_u32 v60, v60, v80, v81
    v_max3_u32 v60, v60, v82, v83
    v_max3_u32 v60, v60, v84, v85
    v_max3_u32 v60, v60, v86, v87
    v_max3_u32 v60, v60, v88, v89
    v_max3_u32 v60, v60, v90, v91
    v_max3_u32 v60, v60, v92, v93
    v_max3_u32 v60, v60, v94, v95
    v_cmp_eq_u32 vcc, -1, v60
    s_cbranch_vccz L_pl_7_a
    s_mov_b32 s44, s50
    buffer_load_dwordx4 v[64:67], v59, s[32:35], s44 offen sc0 sc1
    s_add_u32 s44, s44, 10240
    buffer_load_dwordx4 v[68:71], v59, s[32:35], s44 offen sc0 sc1
    s_add_u32 s44, s44, 10240
    buffer_load_dwordx4 v[72:75], v59, s[32:35], s44 offen sc0 sc1
    s_add_u32 s44, s44, 10240
    buffer_load_dwordx4 v[76:79], v59, s[32:35], s44 offen sc0 sc1
    s_add_u32 s44, s44, 10240
    buffer_load_dwordx4 v[80:83], v59, s[32:35], s44 offen sc0 sc1
    s_add_u32 s44, s44, 10240
    buffer_load_dwordx4 v[84:87], v59, s[32:35], s44 offen sc0 sc1
    s_add_u32 s44, s44, 10240
    buffer_load_dwordx4 v[88:91], v59, s[32:35], s44 offen sc0 sc1
    s_add_u32 s44, s44, 10240
    buffer_load_dwordx4 v[92:95], v59, s[32:35], s44 offen sc0 sc1
    s_waitcnt vmcnt(8)
    v_max_u32 v60, v96, v97
    v_max3_u32 v60, v60, v98, v99
    v_max3_u32 v60, v60, v100, v101
    v_max3_u32 v60, v60, v102, v103
    v_max3_u32 v60, v60, v104, v105
    v_max3_u32 v60, v60, v106, v107
    v_max3_u32 v60, v60, v108, v109
    v_max3_u32 v60, v60, v110, v111
    v_max3_u32 v60, v60, v112, v113
    v_max3_u32 v60, v60, v114, v115
    v_max3_u32 v60, v60, v116, v117
    v_max3_u32 v60, v60, v118, v119
    v_max3_u32 v60, v60, v120, v121
    v_max3_u32 v60, v60, v122, v123
    v_max3_u32 v60, v60, v124, v125
    v_max3_u32 v60, v60, v126, v127
    v_cmp_eq_u32 vcc, -1, v60
    s_cbranch_vccz L_pl_7_b
    s_add_u32 s45, s45, 1
    s_cmp_lt_u32 s45, 0x20000
    s_cbranch_scc1 L_pl_7
L_pl_7_b:
    v_mov_b32 v16, v96
    v_mov_b32 v17, v97
    v_mov_b32 v18, v98
    v_mov_b32 v19, v99
    v_mov_b32 v20, v100
    v_mov_b32 v21, v101
    v_mov_b32 v22, v102
    v_mov_b32 v23, v103
    v_mov_b32 v24, v104
    v_mov_b32 v25, v105
    v_mov_b32 v26, v106
    v_mov_b32 v27, v107
    v_mov_b32 v28, v108
    v_mov_b32 v29, v109
    v_mov_b32 v30, v110
    v_mov_b32 v31, v111
    v_mov_b32 v32, v112
    v_mov_b32 v33, v113
    v_mov_b32 v34, v114
    v_mov_b32 v35, v115
    v_mov_b32 v36, v116
    v_mov_b32 v37, v117
    v_mov_b32 v38, v118
    v_mov_b32 v39, v119
    v_mov_b32 v40, v120
    v_mov_b32 v41, v121
    v_mov_b32 v42, v122
    v_mov_b32 v43, v123
    v_mov_b32 v44, v124
    v_mov_b32 v45, v125
    v_mov_b32 v46, v126
    v_mov_b32 v47, v127
    s_branch L_pl_7_e
L_pl_7_a:
    v_mov_b32 v16, v64
    v_mov_b32 v17, v65
    v_mov_b32 v18, v66
    v_mov_b32 v19, v67
    v_mov_b32 v20, v68
    v_mov_b32 v21, v69
    v_mov_b32 v22, v70
    v_mov_b32 v23, v71
    v_mov_b32 v24, v72
    v_mov_b32 v25, v73
    v_mov_b32 v26, v74
    v_mov_b32 v27, v75
    v_mov_b32 v28, v76
    v_mov_b32 v29, v77
    v_mov_b32 v30, v78
    v_mov_b32 v31, v79
    v_mov_b32 v32, v80
    v_mov_b32 v33, v81
    v_mov_b32 v34, v82
    v_mov_b32 v35, v83
    v_mov_b32 v36, v84
    v_mov_b32 v37, v85
    v_mov_b32 v38, v86
    v_mov_b32 v39, v87
    v_mov_b32 v40, v88
    v_mov_b32 v41, v89
    v_mov_b32 v42, v90
    v_mov_b32 v43, v91
    v_mov_b32 v44, v92
    v_mov_b32 v45, v93
    v_mov_b32 v46, v94
    v_mov_b32 v47, v95
L_pl_7_e:
    v_add_f32 v16, v16, v32
    v_add_f32 v20, v20, v36
    v_add_f32 v24, v24, v40
    v_add_f32 v28, v28, v44
    v_add_f32 v52, v16, v20
    v_add_f32 v60, v24, v28
    v_add_f32 v52, v52, v60
    v_cvt_pk_bf16_f32 v52, v52, v52
    v_lshlrev_b32 v52, 16, v52
    v_add_f32 v17, v17, v33
    v_add_f32 v21, v21, v37
    v_add_f32 v25, v25, v41
    v_add_f32 v29, v29, v45
    v_add_f32 v53, v17, v21
    v_add_f32 v60, v25, v29
    v_add_f32 v53, v53, v60
    v_cvt_pk_bf16_f32 v53, v53, v53
    v_lshlrev_b32 v53, 16, v53
    v_add_f32 v18, v18, v34
    v_add_f32 v22, v22, v38
    v_add_f32 v26, v26, v42
    v_add_f32 v30, v30, v46
    v_add_f32 v54, v18, v22
    v_add_f32 v60, v26, v30
    v_add_f32 v54, v54, v60
    v_cvt_pk_bf16_f32 v54, v54, v54
    v_lshlrev_b32 v54, 16, v54
    v_add_f32 v19, v19, v35
    v_add_f32 v23, v23, v39
    v_add_f32 v27, v27, v43
    v_add_f32 v31, v31, v47
    v_add_f32 v55, v19, v23
    v_add_f32 v60, v27, v31
    v_add_f32 v55, v55, v60
    v_cvt_pk_bf16_f32 v55, v55, v55
    v_lshlrev_b32 v55, 16, v55
    v_lshlrev_b32 v58, 16, v48
    v_and_b32 v59, 0xffff0000, v48
    v_lshlrev_b32 v60, 16, v49
    v_and_b32 v61, 0xffff0000, v49
    v_add_f32 v52, v52, v58
    v_cvt_pk_bf16_f32 v52, v52, v52
    v_lshlrev_b32 v52, 16, v52
    v_add_f32 v53, v53, v59
    v_cvt_pk_bf16_f32 v53, v53, v53
    v_lshlrev_b32 v53, 16, v53
    v_add_f32 v54, v54, v60
    v_cvt_pk_bf16_f32 v54, v54, v54
    v_lshlrev_b32 v54, 16, v54
    v_add_f32 v55, v55, v61
    v_cvt_pk_bf16_f32 v55, v55, v55
    v_lshlrev_b32 v55, 16, v55
    v_add_f32 v58, v52, v53
    v_add_f32 v59, v54, v55
    v_add_f32 v58, v58, v59
    v_mul_f32 v58, v58, v56
    s_nop 1
    v_add_f32_dpp v58, v58, v58 quad_perm:[1,0,3,2] row_mask:0xf bank_mask:0xf
    s_nop 1
    v_add_f32_dpp v58, v58, v58 quad_perm:[2,3,0,1] row_mask:0xf bank_mask:0xf
    s_nop 1
    v_add_f32_dpp v58, v58, v58 row_half_mirror row_mask:0xf bank_mask:0xf
    s_nop 1
    v_add_f32_dpp v58, v58, v58 row_mirror row_mask:0xf bank_mask:0xf
    s_nop 1
    v_readlane_b32 s48, v58, 0
    v_readlane_b32 s49, v58, 16
    v_readlane_b32 s50, v58, 32
    v_readlane_b32 s51, v58, 48
    s_nop 1
    v_mov_b32 v58, s48
    v_add_f32 v58, s49, v58
    v_add_f32 v58, s50, v58
    v_add_f32 v58, s51, v58
    v_mul_f32 v58, 0x3bcccccd, v58
    v_sub_f32 v60, v52, v58
    v_mul_f32 v59, v60, v60
    v_sub_f32 v60, v53, v58
    v_fmac_f32 v59, v60, v60
    v_sub_f32 v60, v54, v58
    v_fmac_f32 v59, v60, v60
    v_sub_f32 v60, v55, v58
    v_fmac_f32 v59, v60, v60
    v_mul_f32 v59, v59, v56
    s_nop 1
    v_add_f32_dpp v59, v59, v59 quad_perm:[1,0,3,2] row_mask:0xf bank_mask:0xf
    s_nop 1
    v_add_f32_dpp v59, v59, v59 quad_perm:[2,3,0,1] row_mask:0xf bank_mask:0xf
    s_nop 1
    v_add_f32_dpp v59, v59, v59 row_half_mirror row_mask:0xf bank_mask:0xf
    s_nop 1
    v_add_f32_dpp v59, v59, v59 row_mirror row_mask:0xf bank_mask:0xf
    s_nop 1
    v_readlane_b32 s48, v59, 0
    v_readlane_b32 s49, v59, 16
    v_readlane_b32 s50, v59, 32
    v_readlane_b32 s51, v59, 48
    s_nop 1
    v_mov_b32 v59, s48
    v_add_f32 v59, s49, v59
    v_add_f32 v59, s50, v59
    v_add_f32 v59, s51, v59
    s_lshl_b32 s49, s53, 5
    s_and_b32 s49, s49, 96
    s_and_b32 s50, s53, 12
    s_lshl_b32 s50, s50, 1
    s_add_u32 s50, s50, s49
    v_mov_b32 v60, s50
    v_mov_b32 v61, s49
    ds_write_b64 v60, v[58:59] offset:29696
    s_waitcnt lgkmcnt(0)
    s_barrier
    ds_read_b128 v[16:19], v61 offset:29696
    ds_read_b128 v[20:23], v61 offset:29712
    s_waitcnt lgkmcnt(0)
    v_add_f32 v24, v16, v18
    v_add_f32 v25, v20, v22
    v_add_f32 v24, v24, v25
    v_mul_f32 v24, 0.25, v24
    v_add_f32 v25, v17, v19
    v_add_f32 v26, v21, v23
    v_add_f32 v25, v25, v26
    v_sub_f32 v16, v16, v24
    v_sub_f32 v18, v18, v24
    v_sub_f32 v20, v20, v24
    v_sub_f32 v22, v22, v24
    v_mul_f32 v26, v16, v16
    v_fmac_f32 v26, v18, v18
    v_fmac_f32 v26, v20, v20
    v_fmac_f32 v26, v22, v22
    v_mov_b32 v27, 0x43200000
    v_fmac_f32 v25, v26, v27
    v_mul_f32 v25, 0x3acccccd, v25
    v_cvt_pk_bf16_f32 v24, v24, v24
    v_lshlrev_b32 v24, 16, v24
    v_cvt_pk_bf16_f32 v25, v25, v25
    v_lshlrev_b32 v25, 16, v25
    v_add_f32 v25, 0x3727c5ac, v25
    v_cvt_pk_bf16_f32 v25, v25, v25
    v_lshlrev_b32 v25, 16, v25
    v_sqrt_f32 v25, v25
    s_nop 0
    v_cvt_pk_bf16_f32 v25, v25, v25
    v_lshlrev_b32 v25, 16, v25
    v_rcp_f32 v25, v25
    s_nop 0
    v_sub_f32 v28, v52, v24
    v_cvt_pk_bf16_f32 v28, v28, v28
    v_lshlrev_b32 v28, 16, v28
    v_mul_f32 v28, v28, v25
    v_cvt_pk_bf16_f32 v28, v28, v28
    v_lshlrev_b32 v28, 16, v28
    v_sub_f32 v29, v53, v24
    v_cvt_pk_bf16_f32 v29, v29, v29
    v_lshlrev_b32 v29, 16, v29
    v_mul_f32 v29, v29, v25
    v_cvt_pk_bf16_f32 v29, v29, v29
    v_lshlrev_b32 v29, 16, v29
    v_sub_f32 v30, v54, v24
    v_cvt_pk_bf16_f32 v30, v30, v30
    v_lshlrev_b32 v30, 16, v30
    v_mul_f32 v30, v30, v25
    v_cvt_pk_bf16_f32 v30, v30, v30
    v_lshlrev_b32 v30, 16, v30
    v_sub_f32 v31, v55, v24
    v_cvt_pk_bf16_f32 v31, v31, v31
    v_lshlrev_b32 v31, 16, v31
    v_mul_f32 v31, v31, v25
    v_cvt_pk_bf16_f32 v31, v31, v31
    v_lshlrev_b32 v31, 16, v31
    v_cvt_pk_bf16_f32 v32, v28, v29
    v_cvt_pk_bf16_f32 v33, v30, v31
    s_mov_b32 exec_lo, -1
    s_mov_b32 exec_hi, 0xff
    ds_write_b64 v62, v[32:33] offset:18944
    s_mov_b64 exec, -1
    s_waitcnt vmcnt(0) lgkmcnt(0)
    s_barrier
    s_lshr_b32 s48, s53, 2
    s_and_b32 s49, s53, 3
    s_mul_i32 s50, s48, 320
    s_add_u32 s50, s50, 18944
    v_add_u32 v12, s50, v8
    s_mul_i32 s50, s48, 20480
    s_lshl_b32 s49, s49, 5
    s_add_u32 s50, s50, s49
    s_add_u32 s50, s50, 42496
    v_add_u32 v13, s50, v9
    s_waitcnt vmcnt(0)
    ds_read_b128 v[16:19], v12 offset:0
    ds_read_b64_tr_b16 v[36:37], v13 offset:0
    ds_read_b64_tr_b16 v[38:39], v13 offset:512
    ds_read_b128 v[20:23], v12 offset:64
    ds_read_b64_tr_b16 v[40:41], v13 offset:4096
    ds_read_b64_tr_b16 v[42:43], v13 offset:4608
    ds_read_b128 v[24:27], v12 offset:128
    ds_read_b64_tr_b16 v[44:45], v13 offset:8192
    ds_read_b64_tr_b16 v[46:47], v13 offset:8704
    ds_read_b128 v[28:31], v12 offset:192
    ds_read_b64_tr_b16 v[48:49], v13 offset:12288
    ds_read_b64_tr_b16 v[50:51], v13 offset:12800
    ds_read_b128 v[32:35], v12 offset:256
    ds_read_b64_tr_b16 v[52:53], v13 offset:16384
    ds_read_b64_tr_b16 v[54:55], v13 offset:16896
    s_waitcnt lgkmcnt(12)
    v_mfma_f32_16x16x32_bf16 v[64:67], v[16:19], v[36:39], 0
    s_waitcnt lgkmcnt(9)
    v_mfma_f32_16x16x32_bf16 v[64:67], v[20:23], v[40:43], v[64:67]
    s_waitcnt lgkmcnt(6)
    v_mfma_f32_16x16x32_bf16 v[64:67], v[24:27], v[44:47], v[64:67]
    s_waitcnt lgkmcnt(3)
    v_mfma_f32_16x16x32_bf16 v[64:67], v[28:31], v[48:51], v[64:67]
    s_waitcnt lgkmcnt(0)
    v_mfma_f32_16x16x32_bf16 v[64:67], v[32:35], v[52:55], v[64:67]
    s_nop 15
    s_lshr_b32 s48, s53, 2
    s_and_b32 s49, s53, 3
    s_mul_i32 s48, s48, 1024
    s_lshl_b32 s49, s49, 6
    s_add_u32 s48, s48, s49
    v_lshlrev_b32 v12, 2, v6
    v_add_u32 v12, s48, v12
    s_mov_b64 exec, 0xffff
    ds_write_b32 v12, v64 offset:13824
    ds_write_b32 v12, v65 offset:14080
    ds_write_b32 v12, v66 offset:14336
    ds_write_b32 v12, v67 offset:14592
    s_mov_b64 exec, -1
    s_waitcnt lgkmcnt(0)
    s_barrier
    s_cmp_ge_u32 s53, 4
    s_cbranch_scc1 L_done
    v_lshlrev_b32 v12, 2, v0
    ds_read_b32 v16, v12 offset:13824
    ds_read_b32 v17, v12 offset:14848
    ds_read_b32 v18, v12 offset:15872
    ds_read_b32 v19, v12 offset:16896
    s_waitcnt lgkmcnt(0)
    v_add_f32 v16, v16, v17
    v_add_f32 v18, v18, v19
    v_add_f32 v16, v16, v18
    s_nop 1
    v_mov_b32_dpp v17, v16 quad_perm:[1,0,3,2] row_mask:0xf bank_mask:0xf
    v_cvt_pk_bf16_f32 v16, v16, v17
    v_mul_u32_u24 v12, 3072, v7
    v_lshl_add_u32 v12, v6, 1, v12
    s_mul_i32 s48, s54, 16384
    s_lshl_b32 s49, s55, 7
    s_add_u32 s48, s48, s49
    s_add_u32 s48, s48, 360448
    s_mov_b32 exec_lo, 0x55555555
    s_mov_b32 exec_hi, 0x55555555
    buffer_store_dword v16, v12, s[32:35], s48 offen sc0 sc1
    s_mov_b64 exec, -1
L_done:
    s_endpgm
.section .rodata,"a"
.p2align 6
.amdhsa_kernel sequential_preLN__mha_block_cached__moe_arch_mod__decode_kernel
  .amdhsa_next_free_vgpr 128
  .amdhsa_next_free_sgpr 102
  .amdhsa_accum_offset 128
  .amdhsa_group_segment_fixed_size 0
  .amdhsa_kernarg_size 104
  .amdhsa_user_sgpr_count 2
  .amdhsa_user_sgpr_kernarg_segment_ptr 1
  .amdhsa_system_sgpr_workgroup_id_x 1
.end_amdhsa_kernel
```

```asm
; @launch grid=(256,1,1) block=(1024,1,1) lds=140800
.amdgcn_target "amdgcn-amd-amdhsa--gfx950"
.text
.globl sequential_preLN__mha_block_cached__moe_arch_mod__decode_kernel
.p2align 8
.type sequential_preLN__mha_block_cached__moe_arch_mod__decode_kernel,@function
sequential_preLN__mha_block_cached__moe_arch_mod__decode_kernel:
    s_cmp_ge_u32 s2, 256
    s_cbranch_scc1 L_done
    s_load_dwordx2 s[4:5], s[0:1], 0
    s_load_dwordx4 s[8:11], s[0:1], 8
    s_load_dwordx4 s[12:15], s[0:1], 24
    s_load_dwordx4 s[80:83], s[0:1], 48
    s_load_dwordx4 s[84:87], s[0:1], 64
    s_load_dwordx4 s[88:91], s[0:1], 80
    s_load_dwordx2 s[6:7], s[0:1], 96
    s_and_b32 s42, s2, 7
    s_lshr_b32 s43, s2, 3
    s_and_b32 s44, s43, 3
    s_lshl_b32 s45, s42, 2
    s_add_u32 s45, s45, s44
    s_lshr_b32 s44, s43, 2
    s_lshr_b32 s46, s44, 1
    s_and_b32 s47, s44, 1
    s_lshl_b32 s40, s46, 5
    s_add_u32 s40, s40, s45
    s_lshl_b32 s40, s40, 1
    s_add_u32 s40, s40, s47
    s_mul_i32 s41, s40, 1572864
    s_lshr_b32 s99, s45, 3
    s_mov_b32 s96, 1572864
    v_and_b32 v6, 63, v0
    v_lshrrev_b32 v2, 6, v0
    v_lshrrev_b32 v3, 3, v6
    v_and_b32 v4, 7, v6
    v_readfirstlane_b32 s53, v2
    v_lshlrev_b32 v4, 4, v4
    v_mul_u32_u24 v5, 384, v3
    v_add_u32 v1, v5, v4
    v_mul_u32_u24 v5, 40, v2
    v_add_u32 v5, v5, v3
    v_mul_u32_u24 v7, 12288, v5
    v_add_u32 v7, v7, v4
    v_lshlrev_b32 v8, 1, v5
    v_lshlrev_b32 v5, 2, v6
    s_waitcnt lgkmcnt(0)
    s_mov_b32 s56, s4
    s_and_b32 s57, s5, 0xffff
    s_mov_b32 s58, 0x1400
    s_mov_b32 s59, 0x00020000
    s_mul_i32 s48, s46, 1280
    s_add_u32 s4, s4, s48
    s_addc_u32 s5, s5, 0
    s_mov_b32 s28, s4
    s_and_b32 s29, s5, 0xffff
    s_mov_b32 s30, 0x500
    s_mov_b32 s31, 0x00020000
    s_mul_i32 s48, s45, 384
    s_add_u32 s12, s12, s48
    s_addc_u32 s13, s13, 0
    s_sub_u32 s49, 7864320, s48
    s_mov_b32 s24, s12
    s_and_b32 s25, s13, 0xffff
    s_mov_b32 s26, s49
    s_mov_b32 s27, 0x00020000
    s_add_u32 s8, s8, s41
    s_addc_u32 s9, s9, 0
    s_mov_b32 s16, s8
    s_and_b32 s17, s9, 0xffff
    s_mov_b32 s18, s96
    s_mov_b32 s19, 0x00020000
    s_add_u32 s10, s10, s41
    s_addc_u32 s11, s11, 0
    s_mov_b32 s20, s10
    s_and_b32 s21, s11, 0xffff
    s_mov_b32 s22, s96
    s_mov_b32 s23, 0x00020000
    s_mov_b32 s32, s6
    s_and_b32 s33, s7, 0xffff
    s_mov_b32 s34, 0x200000
    s_mov_b32 s35, 0x00020000
    s_mov_b32 s36, s90
    s_and_b32 s37, s91, 0xffff
    s_mov_b32 s38, 0x100
    s_mov_b32 s39, 0x00020000
    s_mov_b32 s60, s14
    s_and_b32 s61, s15, 0xffff
    s_mov_b32 s62, 0x780000
    s_mov_b32 s63, 0x00020000
    s_mov_b32 s64, s82
    s_and_b32 s65, s83, 0xffff
    s_mov_b32 s66, 0x1e0000
    s_mov_b32 s67, 0x00020000
    s_mov_b32 s92, s84
    s_and_b32 s93, s85, 0xffff
    s_mov_b32 s94, 0x1e0000
    s_mov_b32 s95, 0x00020000
    s_mov_b32 s68, s86
    s_and_b32 s69, s87, 0xffff
    s_mov_b32 s70, 0x1e0000
    s_mov_b32 s71, 0x00020000
    s_mov_b32 s72, s80
    s_and_b32 s73, s81, 0xffff
    s_mov_b32 s74, 0x500
    s_mov_b32 s75, 0x00020000
    s_mov_b32 s76, s88
    s_and_b32 s77, s89, 0xffff
    s_mov_b32 s78, 0x1400
    s_mov_b32 s79, 0x00020000
    s_mul_i32 s48, s2, 6554
    s_lshr_b32 s54, s48, 16
    s_mul_i32 s48, s54, 10
    s_sub_u32 s55, s2, s48
    s_mov_b32 s98, 0
    s_cmp_lt_u32 s2, 80
    s_cbranch_scc1 L_role_1
    s_mov_b32 s98, 1
    s_sub_u32 s55, s2, 80
    s_cmp_ge_u32 s55, 24
    s_cselect_b32 s54, 1, 0
    s_mul_i32 s48, s54, 24
    s_sub_u32 s55, s55, s48
    s_cmp_lt_u32 s2, 128
    s_cbranch_scc1 L_role_1
    s_mov_b32 s98, 2
    s_sub_u32 s55, s2, 128
    s_cmp_lt_u32 s2, 148
    s_cbranch_scc1 L_role_1
    s_mov_b32 s98, 3
L_role_1:
    v_mov_b32 v2, -1
    v_lshlrev_b32 v3, 2, v0
    v_cmp_gt_u32 vcc, 384, v0
    s_and_saveexec_b64 s[100:101], vcc
    s_cbranch_execz L_clr1
    s_mul_i32 s48, s40, 1536
    s_add_u32 s48, s48, 1048576
    buffer_store_dword v2, v3, s[32:35], s48 offen sc0 sc1
    v_cmp_eq_u32 vcc, 0, v0
    s_and_b64 exec, exec, vcc
    s_cbranch_execz L_clr1
    s_lshl_b32 s48, s2, 7
    s_add_u32 s48, s48, 458752
    buffer_store_dword v2, v3, s[32:35], s48 offen sc0 sc1
    buffer_store_dword v2, v3, s[32:35], s48 offen offset:4 sc0 sc1
L_clr1:
    s_mov_b64 exec, s[100:101]
    s_cmp_ge_u32 s98, 2
    s_cbranch_scc1 L_clr3
    s_cmp_eq_u32 s98, 1
    s_cbranch_scc1 L_clr_d
    v_cmp_gt_u32 vcc, 256, v0
    s_and_saveexec_b64 s[100:101], vcc
    s_cbranch_execz L_clr2
    v_lshrrev_b32 v3, 6, v0
    v_mul_u32_u24 v3, 2560, v3
    v_and_b32 v4, 63, v0
    v_lshl_add_u32 v3, v4, 2, v3
    s_mul_i32 s48, s54, 10240
    s_lshl_b32 s49, s55, 8
    s_add_u32 s48, s48, s49
    s_add_u32 s48, s48, 262144
    buffer_store_dword v2, v3, s[32:35], s48 offen sc0 sc1
    v_cmp_eq_u32 vcc, 0, v0
    s_and_b64 exec, exec, vcc
    s_cbranch_execz L_clr2
    s_lshl_b32 s48, s2, 2
    s_add_u32 s48, s48, 454656
    buffer_store_dword v2, v3, s[32:35], s48 offen sc0 sc1
    s_branch L_clr2
L_clr_d:
    v_cmp_gt_u32 vcc, 128, v0
    s_and_saveexec_b64 s[100:101], vcc
    s_cbranch_execz L_clr2
    v_lshrrev_b32 v3, 5, v0
    v_mul_u32_u24 v3, 3072, v3
    v_and_b32 v4, 31, v0
    v_lshl_add_u32 v3, v4, 2, v3
    s_mul_i32 s48, s54, 16384
    s_lshl_b32 s49, s55, 7
    s_add_u32 s48, s48, s49
    s_add_u32 s48, s48, 360448
    buffer_store_dword v2, v3, s[32:35], s48 offen sc0 sc1
L_clr2:
    s_mov_b64 exec, s[100:101]
L_clr3:
    v_mov_b32 v3, 12928
    v_mov_b32 v4, 16
    ds_write_b32 v3, v4
    buffer_load_dword v46, v5, s[28:31], 0 offen offset:0
    buffer_load_dword v47, v5, s[28:31], 0 offen offset:256
    buffer_load_dword v48, v5, s[28:31], 0 offen offset:512
    buffer_load_dword v49, v5, s[28:31], 0 offen offset:768
    buffer_load_dword v50, v5, s[28:31], 0 offen offset:1024
    buffer_load_ushort v51, v8, s[28:31], 0 offen offset:0
    buffer_load_ushort v52, v8, s[28:31], 0 offen offset:16
    buffer_load_ushort v53, v8, s[28:31], 0 offen offset:32
    buffer_load_ushort v126, v8, s[28:31], 0 offen offset:48
    buffer_load_ushort v127, v8, s[28:31], 0 offen offset:64
    s_mov_b32 s48, 0
    buffer_load_dwordx4 v[102:105], v7, s[24:27], s48 offen offset:0 nt
    buffer_load_dwordx4 v[106:109], v7, s[24:27], s48 offen offset:128 nt
    buffer_load_dwordx4 v[110:113], v7, s[24:27], s48 offen offset:256 nt
    s_mov_b32 s48, 98304
    buffer_load_dwordx4 v[114:117], v7, s[24:27], s48 offen offset:0 nt
    buffer_load_dwordx4 v[118:121], v7, s[24:27], s48 offen offset:128 nt
    buffer_load_dwordx4 v[122:125], v7, s[24:27], s48 offen offset:256 nt
    s_mov_b32 s48, 196608
    buffer_load_dwordx4 v[10:13], v7, s[24:27], s48 offen offset:0 nt
    buffer_load_dwordx4 v[14:17], v7, s[24:27], s48 offen offset:128 nt
    buffer_load_dwordx4 v[18:21], v7, s[24:27], s48 offen offset:256 nt
    s_mov_b32 s48, 294912
    buffer_load_dwordx4 v[22:25], v7, s[24:27], s48 offen offset:0 nt
    buffer_load_dwordx4 v[26:29], v7, s[24:27], s48 offen offset:128 nt
    buffer_load_dwordx4 v[30:33], v7, s[24:27], s48 offen offset:256 nt
    s_mov_b32 s48, 393216
    buffer_load_dwordx4 v[34:37], v7, s[24:27], s48 offen offset:0 nt
    buffer_load_dwordx4 v[38:41], v7, s[24:27], s48 offen offset:128 nt
    buffer_load_dwordx4 v[42:45], v7, s[24:27], s48 offen offset:256 nt
    s_mul_i32 s41, s53, 24576
    s_barrier
    s_add_u32 s48, s41, 0
    buffer_load_dwordx4 v[78:81], v1, s[16:19], s48 offen offset:0 nt
    buffer_load_dwordx4 v[82:85], v1, s[16:19], s48 offen offset:128 nt
    buffer_load_dwordx4 v[86:89], v1, s[16:19], s48 offen offset:256 nt
    s_add_u32 s48, s41, 3072
    buffer_load_dwordx4 v[90:93], v1, s[16:19], s48 offen offset:0 nt
    buffer_load_dwordx4 v[94:97], v1, s[16:19], s48 offen offset:128 nt
    buffer_load_dwordx4 v[98:101], v1, s[16:19], s48 offen offset:256 nt
    s_waitcnt vmcnt(26)
    v_lshlrev_b32 v54, 16, v46
    v_and_b32 v55, 0xffff0000, v46
    v_lshlrev_b32 v56, 16, v47
    v_and_b32 v57, 0xffff0000, v47
    v_lshlrev_b32 v58, 16, v48
    v_and_b32 v59, 0xffff0000, v48
    v_lshlrev_b32 v60, 16, v49
    v_and_b32 v61, 0xffff0000, v49
    v_lshlrev_b32 v62, 16, v50
    v_and_b32 v63, 0xffff0000, v50
    v_add_f32 v2, v54, v55
    v_add_f32 v2, v2, v56
    v_add_f32 v2, v2, v57
    v_add_f32 v2, v2, v58
    v_add_f32 v2, v2, v59
    v_add_f32 v2, v2, v60
    v_add_f32 v2, v2, v61
    v_add_f32 v2, v2, v62
    v_add_f32 v2, v2, v63
    s_nop 1
    v_add_f32_dpp v2, v2, v2 quad_perm:[1,0,3,2] row_mask:0xf bank_mask:0xf
    s_nop 1
    v_add_f32_dpp v2, v2, v2 quad_perm:[2,3,0,1] row_mask:0xf bank_mask:0xf
    s_nop 1
    v_add_f32_dpp v2, v2, v2 row_half_mirror row_mask:0xf bank_mask:0xf
    s_nop 1
    v_add_f32_dpp v2, v2, v2 row_mirror row_mask:0xf bank_mask:0xf
    s_nop 1
    v_readlane_b32 s48, v2, 0
    v_readlane_b32 s49, v2, 16
    v_readlane_b32 s50, v2, 32
    v_readlane_b32 s51, v2, 48
    s_nop 1
    v_mov_b32 v2, s48
    v_add_f32 v2, s49, v2
    v_add_f32 v2, s50, v2
    v_add_f32 v2, s51, v2
    v_mul_f32 v2, 0x3acccccd, v2
    v_sub_f32 v4, v54, v2
    v_mul_f32 v3, v4, v4
    v_sub_f32 v4, v55, v2
    v_fmac_f32 v3, v4, v4
    v_sub_f32 v4, v56, v2
    v_fmac_f32 v3, v4, v4
    v_sub_f32 v4, v57, v2
    v_fmac_f32 v3, v4, v4
    v_sub_f32 v4, v58, v2
    v_fmac_f32 v3, v4, v4
    v_sub_f32 v4, v59, v2
    v_fmac_f32 v3, v4, v4
    v_sub_f32 v4, v60, v2
    v_fmac_f32 v3, v4, v4
    v_sub_f32 v4, v61, v2
    v_fmac_f32 v3, v4, v4
    v_sub_f32 v4, v62, v2
    v_fmac_f32 v3, v4, v4
    v_sub_f32 v4, v63, v2
    v_fmac_f32 v3, v4, v4
    s_nop 1
    v_add_f32_dpp v3, v3, v3 quad_perm:[1,0,3,2] row_mask:0xf bank_mask:0xf
    s_nop 1
    v_add_f32_dpp v3, v3, v3 quad_perm:[2,3,0,1] row_mask:0xf bank_mask:0xf
    s_nop 1
    v_add_f32_dpp v3, v3, v3 row_half_mirror row_mask:0xf bank_mask:0xf
    s_nop 1
    v_add_f32_dpp v3, v3, v3 row_mirror row_mask:0xf bank_mask:0xf
    s_nop 1
    v_readlane_b32 s48, v3, 0
    v_readlane_b32 s49, v3, 16
    v_readlane_b32 s50, v3, 32
    v_readlane_b32 s51, v3, 48
    s_nop 1
    v_mov_b32 v3, s48
    v_add_f32 v3, s49, v3
    v_add_f32 v3, s50, v3
    v_add_f32 v3, s51, v3
    v_mul_f32 v3, 0x3acccccd, v3
    v_cvt_pk_bf16_f32 v2, v2, v2
    v_lshlrev_b32 v2, 16, v2
    v_cvt_pk_bf16_f32 v3, v3, v3
    v_lshlrev_b32 v3, 16, v3
    v_add_f32 v3, 0x3727c5ac, v3
    v_cvt_pk_bf16_f32 v3, v3, v3
    v_lshlrev_b32 v3, 16, v3
    v_sqrt_f32 v3, v3
    s_nop 0
    v_cvt_pk_bf16_f32 v3, v3, v3
    v_lshlrev_b32 v3, 16, v3
    v_rcp_f32 v3, v3
    s_waitcnt vmcnt(21)
    v_lshlrev_b32 v51, 16, v51
    v_sub_f32 v51, v51, v2
    v_cvt_pk_bf16_f32 v51, v51, v51
    v_lshlrev_b32 v51, 16, v51
    v_mul_f32 v51, v51, v3
    v_cvt_pk_bf16_f32 v51, v51, v51
    v_lshlrev_b32 v51, 16, v51
    v_lshlrev_b32 v52, 16, v52
    v_sub_f32 v52, v52, v2
    v_cvt_pk_bf16_f32 v52, v52, v52
    v_lshlrev_b32 v52, 16, v52
    v_mul_f32 v52, v52, v3
    v_cvt_pk_bf16_f32 v52, v52, v52
    v_lshlrev_b32 v52, 16, v52
    v_lshlrev_b32 v53, 16, v53
    v_sub_f32 v53, v53, v2
    v_cvt_pk_bf16_f32 v53, v53, v53
    v_lshlrev_b32 v53, 16, v53
    v_mul_f32 v53, v53, v3
    v_cvt_pk_bf16_f32 v53, v53, v53
    v_lshlrev_b32 v53, 16, v53
    v_lshlrev_b32 v126, 16, v126
    v_sub_f32 v126, v126, v2
    v_cvt_pk_bf16_f32 v126, v126, v126
    v_lshlrev_b32 v126, 16, v126
    v_mul_f32 v126, v126, v3
    v_cvt_pk_bf16_f32 v126, v126, v126
    v_lshlrev_b32 v126, 16, v126
    v_lshlrev_b32 v127, 16, v127
    v_sub_f32 v127, v127, v2
    v_cvt_pk_bf16_f32 v127, v127, v127
    v_lshlrev_b32 v127, 16, v127
    v_mul_f32 v127, v127, v3
    v_cvt_pk_bf16_f32 v127, v127, v127
    v_lshlrev_b32 v127, 16, v127
    s_waitcnt vmcnt(18)
    v_lshlrev_b32 v2, 16, v102
    v_and_b32 v3, 0xffff0000, v102
    v_mul_f32 v54, v51, v2
    v_mul_f32 v55, v51, v3
    v_lshlrev_b32 v2, 16, v103
    v_and_b32 v3, 0xffff0000, v103
    v_mul_f32 v56, v51, v2
    v_mul_f32 v57, v51, v3
    v_lshlrev_b32 v2, 16, v104
    v_and_b32 v3, 0xffff0000, v104
    v_mul_f32 v58, v51, v2
    v_mul_f32 v59, v51, v3
    v_lshlrev_b32 v2, 16, v105
    v_and_b32 v3, 0xffff0000, v105
    v_mul_f32 v60, v51, v2
    v_mul_f32 v61, v51, v3
    v_lshlrev_b32 v2, 16, v106
    v_and_b32 v3, 0xffff0000, v106
    v_mul_f32 v62, v51, v2
    v_mul_f32 v63, v51, v3
    v_lshlrev_b32 v2, 16, v107
    v_and_b32 v3, 0xffff0000, v107
    v_mul_f32 v64, v51, v2
    v_mul_f32 v65, v51, v3
    v_lshlrev_b32 v2, 16, v108
    v_and_b32 v3, 0xffff0000, v108
    v_mul_f32 v66, v51, v2
    v_mul_f32 v67, v51, v3
    v_lshlrev_b32 v2, 16, v109
    v_and_b32 v3, 0xffff0000, v109
    v_mul_f32 v68, v51, v2
    v_mul_f32 v69, v51, v3
    v_lshlrev_b32 v2, 16, v110
    v_and_b32 v3, 0xffff0000, v110
    v_mul_f32 v70, v51, v2
    v_mul_f32 v71, v51, v3
    v_lshlrev_b32 v2, 16, v111
    v_and_b32 v3, 0xffff0000, v111
    v_mul_f32 v72, v51, v2
    v_mul_f32 v73, v51, v3
    v_lshlrev_b32 v2, 16, v112
    v_and_b32 v3, 0xffff0000, v112
    v_mul_f32 v74, v51, v2
    v_mul_f32 v75, v51, v3
    v_lshlrev_b32 v2, 16, v113
    v_and_b32 v3, 0xffff0000, v113
    v_mul_f32 v76, v51, v2
    v_mul_f32 v77, v51, v3
    s_add_u32 s48, s41, 6144
    buffer_load_dwordx4 v[102:105], v1, s[16:19], s48 offen offset:0 nt
    buffer_load_dwordx4 v[106:109], v1, s[16:19], s48 offen offset:128 nt
    buffer_load_dwordx4 v[110:113], v1, s[16:19], s48 offen offset:256 nt
    s_waitcnt vmcnt(18)
    v_lshlrev_b32 v2, 16, v114
    v_and_b32 v3, 0xffff0000, v114
    v_fmac_f32 v54, v52, v2
    v_fmac_f32 v55, v52, v3
    v_lshlrev_b32 v2, 16, v115
    v_and_b32 v3, 0xffff0000, v115
    v_fmac_f32 v56, v52, v2
    v_fmac_f32 v57, v52, v3
    v_lshlrev_b32 v2, 16, v116
    v_and_b32 v3, 0xffff0000, v116
    v_fmac_f32 v58, v52, v2
    v_fmac_f32 v59, v52, v3
    v_lshlrev_b32 v2, 16, v117
    v_and_b32 v3, 0xffff0000, v117
    v_fmac_f32 v60, v52, v2
    v_fmac_f32 v61, v52, v3
    v_lshlrev_b32 v2, 16, v118
    v_and_b32 v3, 0xffff0000, v118
    v_fmac_f32 v62, v52, v2
    v_fmac_f32 v63, v52, v3
    v_lshlrev_b32 v2, 16, v119
    v_and_b32 v3, 0xffff0000, v119
    v_fmac_f32 v64, v52, v2
    v_fmac_f32 v65, v52, v3
    v_lshlrev_b32 v2, 16, v120
    v_and_b32 v3, 0xffff0000, v120
    v_fmac_f32 v66, v52, v2
    v_fmac_f32 v67, v52, v3
    v_lshlrev_b32 v2, 16, v121
    v_and_b32 v3, 0xffff0000, v121
    v_fmac_f32 v68, v52, v2
    v_fmac_f32 v69, v52, v3
    v_lshlrev_b32 v2, 16, v122
    v_and_b32 v3, 0xffff0000, v122
    v_fmac_f32 v70, v52, v2
    v_fmac_f32 v71, v52, v3
    v_lshlrev_b32 v2, 16, v123
    v_and_b32 v3, 0xffff0000, v123
    v_fmac_f32 v72, v52, v2
    v_fmac_f32 v73, v52, v3
    v_lshlrev_b32 v2, 16, v124
    v_and_b32 v3, 0xffff0000, v124
    v_fmac_f32 v74, v52, v2
    v_fmac_f32 v75, v52, v3
    v_lshlrev_b32 v2, 16, v125
    v_and_b32 v3, 0xffff0000, v125
    v_fmac_f32 v76, v52, v2
    v_fmac_f32 v77, v52, v3
    s_add_u32 s48, s41, 9216
    buffer_load_dwordx4 v[114:117], v1, s[16:19], s48 offen offset:0 nt
    buffer_load_dwordx4 v[118:121], v1, s[16:19], s48 offen offset:128 nt
    buffer_load_dwordx4 v[122:125], v1, s[16:19], s48 offen offset:256 nt
    s_waitcnt vmcnt(18)
    v_lshlrev_b32 v2, 16, v10
    v_and_b32 v3, 0xffff0000, v10
    v_fmac_f32 v54, v53, v2
    v_fmac_f32 v55, v53, v3
    v_lshlrev_b32 v2, 16, v11
    v_and_b32 v3, 0xffff0000, v11
    v_fmac_f32 v56, v53, v2
    v_fmac_f32 v57, v53, v3
    v_lshlrev_b32 v2, 16, v12
    v_and_b32 v3, 0xffff0000, v12
    v_fmac_f32 v58, v53, v2
    v_fmac_f32 v59, v53, v3
    v_lshlrev_b32 v2, 16, v13
    v_and_b32 v3, 0xffff0000, v13
    v_fmac_f32 v60, v53, v2
    v_fmac_f32 v61, v53, v3
    v_lshlrev_b32 v2, 16, v14
    v_and_b32 v3, 0xffff0000, v14
    v_fmac_f32 v62, v53, v2
    v_fmac_f32 v63, v53, v3
    v_lshlrev_b32 v2, 16, v15
    v_and_b32 v3, 0xffff0000, v15
    v_fmac_f32 v64, v53, v2
    v_fmac_f32 v65, v53, v3
    v_lshlrev_b32 v2, 16, v16
    v_and_b32 v3, 0xffff0000, v16
    v_fmac_f32 v66, v53, v2
    v_fmac_f32 v67, v53, v3
    v_lshlrev_b32 v2, 16, v17
    v_and_b32 v3, 0xffff0000, v17
    v_fmac_f32 v68, v53, v2
    v_fmac_f32 v69, v53, v3
    v_lshlrev_b32 v2, 16, v18
    v_and_b32 v3, 0xffff0000, v18
    v_fmac_f32 v70, v53, v2
    v_fmac_f32 v71, v53, v3
    v_lshlrev_b32 v2, 16, v19
    v_and_b32 v3, 0xffff0000, v19
    v_fmac_f32 v72, v53, v2
    v_fmac_f32 v73, v53, v3
    v_lshlrev_b32 v2, 16, v20
    v_and_b32 v3, 0xffff0000, v20
    v_fmac_f32 v74, v53, v2
    v_fmac_f32 v75, v53, v3
    v_lshlrev_b32 v2, 16, v21
    v_and_b32 v3, 0xffff0000, v21
    v_fmac_f32 v76, v53, v2
    v_fmac_f32 v77, v53, v3
    s_waitcnt vmcnt(15)
    v_lshlrev_b32 v2, 16, v22
    v_and_b32 v3, 0xffff0000, v22
    v_fmac_f32 v54, v126, v2
    v_fmac_f32 v55, v126, v3
    v_lshlrev_b32 v2, 16, v23
    v_and_b32 v3, 0xffff0000, v23
    v_fmac_f32 v56, v126, v2
    v_fmac_f32 v57, v126, v3
    v_lshlrev_b32 v2, 16, v24
    v_and_b32 v3, 0xffff0000, v24
    v_fmac_f32 v58, v126, v2
    v_fmac_f32 v59, v126, v3
    v_lshlrev_b32 v2, 16, v25
    v_and_b32 v3, 0xffff0000, v25
    v_fmac_f32 v60, v126, v2
    v_fmac_f32 v61, v126, v3
    v_lshlrev_b32 v2, 16, v26
    v_and_b32 v3, 0xffff0000, v26
    v_fmac_f32 v62, v126, v2
    v_fmac_f32 v63, v126, v3
    v_lshlrev_b32 v2, 16, v27
    v_and_b32 v3, 0xffff0000, v27
    v_fmac_f32 v64, v126, v2
    v_fmac_f32 v65, v126, v3
    v_lshlrev_b32 v2, 16, v28
    v_and_b32 v3, 0xffff0000, v28
    v_fmac_f32 v66, v126, v2
    v_fmac_f32 v67, v126, v3
    v_lshlrev_b32 v2, 16, v29
    v_and_b32 v3, 0xffff0000, v29
    v_fmac_f32 v68, v126, v2
    v_fmac_f32 v69, v126, v3
    v_lshlrev_b32 v2, 16, v30
    v_and_b32 v3, 0xffff0000, v30
    v_fmac_f32 v70, v126, v2
    v_fmac_f32 v71, v126, v3
    v_lshlrev_b32 v2, 16, v31
    v_and_b32 v3, 0xffff0000, v31
    v_fmac_f32 v72, v126, v2
    v_fmac_f32 v73, v126, v3
    v_lshlrev_b32 v2, 16, v32
    v_and_b32 v3, 0xffff0000, v32
    v_fmac_f32 v74, v126, v2
    v_fmac_f32 v75, v126, v3
    v_lshlrev_b32 v2, 16, v33
    v_and_b32 v3, 0xffff0000, v33
    v_fmac_f32 v76, v126, v2
    v_fmac_f32 v77, v126, v3
    s_waitcnt vmcnt(12)
    v_lshlrev_b32 v2, 16, v34
    v_and_b32 v3, 0xffff0000, v34
    v_fmac_f32 v54, v127, v2
    v_fmac_f32 v55, v127, v3
    v_lshlrev_b32 v2, 16, v35
    v_and_b32 v3, 0xffff0000, v35
    v_fmac_f32 v56, v127, v2
    v_fmac_f32 v57, v127, v3
    v_lshlrev_b32 v2, 16, v36
    v_and_b32 v3, 0xffff0000, v36
    v_fmac_f32 v58, v127, v2
    v_fmac_f32 v59, v127, v3
    v_lshlrev_b32 v2, 16, v37
    v_and_b32 v3, 0xffff0000, v37
    v_fmac_f32 v60, v127, v2
    v_fmac_f32 v61, v127, v3
    v_lshlrev_b32 v2, 16, v38
    v_and_b32 v3, 0xffff0000, v38
    v_fmac_f32 v62, v127, v2
    v_fmac_f32 v63, v127, v3
    v_lshlrev_b32 v2, 16, v39
    v_and_b32 v3, 0xffff0000, v39
    v_fmac_f32 v64, v127, v2
    v_fmac_f32 v65, v127, v3
    v_lshlrev_b32 v2, 16, v40
    v_and_b32 v3, 0xffff0000, v40
    v_fmac_f32 v66, v127, v2
    v_fmac_f32 v67, v127, v3
    v_lshlrev_b32 v2, 16, v41
    v_and_b32 v3, 0xffff0000, v41
    v_fmac_f32 v68, v127, v2
    v_fmac_f32 v69, v127, v3
    v_lshlrev_b32 v2, 16, v42
    v_and_b32 v3, 0xffff0000, v42
    v_fmac_f32 v70, v127, v2
    v_fmac_f32 v71, v127, v3
    v_lshlrev_b32 v2, 16, v43
    v_and_b32 v3, 0xffff0000, v43
    v_fmac_f32 v72, v127, v2
    v_fmac_f32 v73, v127, v3
    v_lshlrev_b32 v2, 16, v44
    v_and_b32 v3, 0xffff0000, v44
    v_fmac_f32 v74, v127, v2
    v_fmac_f32 v75, v127, v3
    v_lshlrev_b32 v2, 16, v45
    v_and_b32 v3, 0xffff0000, v45
    v_fmac_f32 v76, v127, v2
    v_fmac_f32 v77, v127, v3
    s_nop 1
    v_permlane32_swap_b32 v54, v58
    v_permlane32_swap_b32 v55, v59
    v_permlane32_swap_b32 v56, v60
    v_permlane32_swap_b32 v57, v61
    v_permlane32_swap_b32 v62, v66
    v_permlane32_swap_b32 v63, v67
    v_permlane32_swap_b32 v64, v68
    v_permlane32_swap_b32 v65, v69
    v_permlane32_swap_b32 v70, v74
    v_permlane32_swap_b32 v71, v75
    v_permlane32_swap_b32 v72, v76
    v_permlane32_swap_b32 v73, v77
    v_add_f32 v54, v54, v58
    v_add_f32 v55, v55, v59
    v_add_f32 v56, v56, v60
    v_add_f32 v57, v57, v61
    v_add_f32 v62, v62, v66
    v_add_f32 v63, v63, v67
    v_add_f32 v64, v64, v68
    v_add_f32 v65, v65, v69
    v_add_f32 v70, v70, v74
    v_add_f32 v71, v71, v75
    v_add_f32 v72, v72, v76
    v_add_f32 v73, v73, v77
    s_nop 1
    v_permlane16_swap_b32 v54, v56
    v_permlane16_swap_b32 v55, v57
    v_permlane16_swap_b32 v62, v64
    v_permlane16_swap_b32 v63, v65
    v_permlane16_swap_b32 v70, v72
    v_permlane16_swap_b32 v71, v73
    v_add_f32 v54, v54, v56
    v_add_f32 v55, v55, v57
    v_add_f32 v62, v62, v64
    v_add_f32 v63, v63, v65
    v_add_f32 v70, v70, v72
    v_add_f32 v71, v71, v73
    s_nop 1
    v_add_f32_dpp v54, v54, v54 row_ror:8 row_mask:0xf bank_mask:0xf
    v_add_f32_dpp v55, v55, v55 row_ror:8 row_mask:0xf bank_mask:0xf
    v_add_f32_dpp v62, v62, v62 row_ror:8 row_mask:0xf bank_mask:0xf
    v_add_f32_dpp v63, v63, v63 row_ror:8 row_mask:0xf bank_mask:0xf
    v_add_f32_dpp v70, v70, v70 row_ror:8 row_mask:0xf bank_mask:0xf
    v_add_f32_dpp v71, v71, v71 row_ror:8 row_mask:0xf bank_mask:0xf
    v_lshrrev_b32 v2, 6, v0
    v_mul_u32_u24 v9, 768, v2
    v_and_b32 v2, 7, v6
    v_lshlrev_b32 v2, 5, v2
    v_add_u32 v9, v9, v2
    v_lshrrev_b32 v2, 5, v6
    v_lshlrev_b32 v2, 4, v2
    v_add_u32 v9, v9, v2
    v_bfe_u32 v2, v6, 4, 1
    v_lshlrev_b32 v2, 3, v2
    v_add_u32 v9, v9, v2
    ds_write_b64 v9, v[54:55] offset:0
    ds_write_b64 v9, v[62:63] offset:256
    ds_write_b64 v9, v[70:71] offset:512
    s_waitcnt lgkmcnt(0)
    s_barrier
    v_cmp_gt_u32 vcc, 192, v0
    s_and_saveexec_b64 s[100:101], vcc
    s_cbranch_execz L_q1
    v_lshlrev_b32 v2, 2, v0
    ds_read_b32 v54, v2 offset:0
    ds_read_b32 v55, v2 offset:768
    ds_read_b32 v56, v2 offset:1536
    ds_read_b32 v57, v2 offset:2304
    ds_read_b32 v58, v2 offset:3072
    ds_read_b32 v59, v2 offset:3840
    ds_read_b32 v60, v2 offset:4608
    ds_read_b32 v61, v2 offset:5376
    ds_read_b32 v62, v2 offset:6144
    ds_read_b32 v63, v2 offset:6912
    ds_read_b32 v64, v2 offset:7680
    ds_read_b32 v65, v2 offset:8448
    ds_read_b32 v66, v2 offset:9216
    ds_read_b32 v67, v2 offset:9984
    ds_read_b32 v68, v2 offset:10752
    ds_read_b32 v69, v2 offset:11520
    s_waitcnt lgkmcnt(0)
    v_add_f32 v54, v54, v55
    v_add_f32 v54, v54, v56
    v_add_f32 v54, v54, v57
    v_add_f32 v54, v54, v58
    v_add_f32 v54, v54, v59
    v_add_f32 v54, v54, v60
    v_add_f32 v54, v54, v61
    v_add_f32 v54, v54, v62
    v_add_f32 v54, v54, v63
    v_add_f32 v54, v54, v64
    v_add_f32 v54, v54, v65
    v_add_f32 v54, v54, v66
    v_add_f32 v54, v54, v67
    v_add_f32 v54, v54, v68
    v_add_f32 v54, v54, v69
    v_cvt_pk_bf16_f32 v54, v54, v54
    v_lshlrev_b32 v2, 1, v0
    ds_write_b16 v2, v54 offset:12288
    v_cmp_eq_u32 vcc, 0, v0
    s_and_b64 exec, exec, vcc
    s_cbranch_execz L_q2
    v_mov_b32 v3, 1
    v_mov_b32 v2, 4
    buffer_atomic_add v3, v2, s[36:39], 0 offen sc1
L_q2:
    s_waitcnt lgkmcnt(0)
L_q1:
    s_mov_b64 exec, s[100:101]
    s_barrier
    v_and_b32 v2, 7, v6
    v_lshlrev_b32 v2, 4, v2
    ds_read_b128 v[10:13], v2 offset:12288
    ds_read_b128 v[14:17], v2 offset:12416
    ds_read_b128 v[18:21], v2 offset:12544
    s_waitcnt lgkmcnt(0)
    v_mov_b32 v30, 0xff7fffff
    v_mov_b32 v31, 0
    v_mov_b32 v54, 0
    v_mov_b32 v55, 0
    v_mov_b32 v56, 0
    v_mov_b32 v57, 0
    v_mov_b32 v58, 0
    v_mov_b32 v59, 0
    v_mov_b32 v60, 0
    v_mov_b32 v61, 0
    v_mov_b32 v62, 0
    v_mov_b32 v63, 0
    v_mov_b32 v64, 0
    v_mov_b32 v65, 0
    v_mov_b32 v66, 0
    v_mov_b32 v67, 0
    v_mov_b32 v68, 0
    v_mov_b32 v69, 0
    v_mov_b32 v70, 0
    v_mov_b32 v71, 0
    v_mov_b32 v72, 0
    v_mov_b32 v73, 0
    v_mov_b32 v74, 0
    v_mov_b32 v75, 0
    v_mov_b32 v76, 0
    v_mov_b32 v77, 0
    v_mov_b32 v33, 12928
    v_mov_b32 v34, 1
    s_mov_b32 s52, 0x3fb8aa3b
L_loop:
    s_mov_b64 exec, 1
    ds_add_rtn_u32 v32, v33, v34
    s_mov_b64 exec, -1
    s_waitcnt vmcnt(9)
    v_dot2_f32_bf16 v2, v78, v10, 0
    v_dot2_f32_bf16 v3, v82, v14, 0
    v_dot2_f32_bf16 v4, v86, v18, 0
    v_dot2_f32_bf16 v2, v79, v11, v2
    v_dot2_f32_bf16 v3, v83, v15, v3
    v_dot2_f32_bf16 v4, v87, v19, v4
    v_dot2_f32_bf16 v2, v80, v12, v2
    v_dot2_f32_bf16 v3, v84, v16, v3
    v_dot2_f32_bf16 v4, v88, v20, v4
    v_dot2_f32_bf16 v2, v81, v13, v2
    v_dot2_f32_bf16 v3, v85, v17, v3
    v_dot2_f32_bf16 v4, v89, v21, v4
    s_add_u32 s48, s41, 12288
    buffer_load_dwordx4 v[78:81], v1, s[16:19], s48 offen offset:0 nt
    buffer_load_dwordx4 v[82:85], v1, s[16:19], s48 offen offset:128 nt
    buffer_load_dwordx4 v[86:89], v1, s[16:19], s48 offen offset:256 nt
    v_add_f32 v2, v2, v3
    v_add_f32 v2, v2, v4
    s_nop 1
    v_add_f32_dpp v2, v2, v2 quad_perm:[1,0,3,2] row_mask:0xf bank_mask:0xf
    s_nop 1
    v_add_f32_dpp v2, v2, v2 quad_perm:[2,3,0,1] row_mask:0xf bank_mask:0xf
    s_nop 1
    v_add_f32_dpp v2, v2, v2 row_half_mirror row_mask:0xf bank_mask:0xf
    v_cvt_pk_bf16_f32 v2, v2, v2
    v_lshlrev_b32 v2, 16, v2
    v_mul_f32 v2, 0x3d93cd3a, v2
    v_cvt_pk_bf16_f32 v2, v2, v2
    v_lshlrev_b32 v22, 16, v2
    s_waitcnt vmcnt(9)
    v_dot2_f32_bf16 v2, v90, v10, 0
    v_dot2_f32_bf16 v3, v94, v14, 0
    v_dot2_f32_bf16 v4, v98, v18, 0
    v_dot2_f32_bf16 v2, v91, v11, v2
    v_dot2_f32_bf16 v3, v95, v15, v3
    v_dot2_f32_bf16 v4, v99, v19, v4
    v_dot2_f32_bf16 v2, v92, v12, v2
    v_dot2_f32_bf16 v3, v96, v16, v3
    v_dot2_f32_bf16 v4, v100, v20, v4
    v_dot2_f32_bf16 v2, v93, v13, v2
    v_dot2_f32_bf16 v3, v97, v17, v3
    v_dot2_f32_bf16 v4, v101, v21, v4
    s_add_u32 s48, s41, 15360
    buffer_load_dwordx4 v[90:93], v1, s[16:19], s48 offen offset:0 nt
    buffer_load_dwordx4 v[94:97], v1, s[16:19], s48 offen offset:128 nt
    buffer_load_dwordx4 v[98:101], v1, s[16:19], s48 offen offset:256 nt
    v_add_f32 v2, v2, v3
    v_add_f32 v2, v2, v4
    s_nop 1
    v_add_f32_dpp v2, v2, v2 quad_perm:[1,0,3,2] row_mask:0xf bank_mask:0xf
    s_nop 1
    v_add_f32_dpp v2, v2, v2 quad_perm:[2,3,0,1] row_mask:0xf bank_mask:0xf
    s_nop 1
    v_add_f32_dpp v2, v2, v2 row_half_mirror row_mask:0xf bank_mask:0xf
    v_cvt_pk_bf16_f32 v2, v2, v2
    v_lshlrev_b32 v2, 16, v2
    v_mul_f32 v2, 0x3d93cd3a, v2
    v_cvt_pk_bf16_f32 v2, v2, v2
    v_lshlrev_b32 v23, 16, v2
    s_waitcnt vmcnt(9)
    v_dot2_f32_bf16 v2, v102, v10, 0
    v_dot2_f32_bf16 v3, v106, v14, 0
    v_dot2_f32_bf16 v4, v110, v18, 0
    v_dot2_f32_bf16 v2, v103, v11, v2
    v_dot2_f32_bf16 v3, v107, v15, v3
    v_dot2_f32_bf16 v4, v111, v19, v4
    v_dot2_f32_bf16 v2, v104, v12, v2
    v_dot2_f32_bf16 v3, v108, v16, v3
    v_dot2_f32_bf16 v4, v112, v20, v4
    v_dot2_f32_bf16 v2, v105, v13, v2
    v_dot2_f32_bf16 v3, v109, v17, v3
    v_dot2_f32_bf16 v4, v113, v21, v4
    s_add_u32 s48, s41, 18432
    buffer_load_dwordx4 v[102:105], v1, s[16:19], s48 offen offset:0 nt
    buffer_load_dwordx4 v[106:109], v1, s[16:19], s48 offen offset:128 nt
    buffer_load_dwordx4 v[110:113], v1, s[16:19], s48 offen offset:256 nt
    v_add_f32 v2, v2, v3
    v_add_f32 v2, v2, v4
    s_nop 1
    v_add_f32_dpp v2, v2, v2 quad_perm:[1,0,3,2] row_mask:0xf bank_mask:0xf
    s_nop 1
    v_add_f32_dpp v2, v2, v2 quad_perm:[2,3,0,1] row_mask:0xf bank_mask:0xf
    s_nop 1
    v_add_f32_dpp v2, v2, v2 row_half_mirror row_mask:0xf bank_mask:0xf
    v_cvt_pk_bf16_f32 v2, v2, v2
    v_lshlrev_b32 v2, 16, v2
    v_mul_f32 v2, 0x3d93cd3a, v2
    v_cvt_pk_bf16_f32 v2, v2, v2
    v_lshlrev_b32 v24, 16, v2
    s_waitcnt lgkmcnt(0)
    v_readfirstlane_b32 s49, v32
    s_mul_i32 s47, s49, 24576
    s_waitcnt vmcnt(9)
    v_dot2_f32_bf16 v2, v114, v10, 0
    v_dot2_f32_bf16 v3, v118, v14, 0
    v_dot2_f32_bf16 v4, v122, v18, 0
    v_dot2_f32_bf16 v2, v115, v11, v2
    v_dot2_f32_bf16 v3, v119, v15, v3
    v_dot2_f32_bf16 v4, v123, v19, v4
    v_dot2_f32_bf16 v2, v116, v12, v2
    v_dot2_f32_bf16 v3, v120, v16, v3
    v_dot2_f32_bf16 v4, v124, v20, v4
    v_dot2_f32_bf16 v2, v117, v13, v2
    v_dot2_f32_bf16 v3, v121, v17, v3
    v_dot2_f32_bf16 v4, v125, v21, v4
    s_add_u32 s48, s41, 21504
    buffer_load_dwordx4 v[114:117], v1, s[16:19], s48 offen offset:0 nt
    buffer_load_dwordx4 v[118:121], v1, s[16:19], s48 offen offset:128 nt
    buffer_load_dwordx4 v[122:125], v1, s[16:19], s48 offen offset:256 nt
    v_add_f32 v2, v2, v3
    v_add_f32 v2, v2, v4
    s_nop 1
    v_add_f32_dpp v2, v2, v2 quad_perm:[1,0,3,2] row_mask:0xf bank_mask:0xf
    s_nop 1
    v_add_f32_dpp v2, v2, v2 quad_perm:[2,3,0,1] row_mask:0xf bank_mask:0xf
    s_nop 1
    v_add_f32_dpp v2, v2, v2 row_half_mirror row_mask:0xf bank_mask:0xf
    v_cvt_pk_bf16_f32 v2, v2, v2
    v_lshlrev_b32 v2, 16, v2
    v_mul_f32 v2, 0x3d93cd3a, v2
    v_cvt_pk_bf16_f32 v2, v2, v2
    v_lshlrev_b32 v25, 16, v2
    s_waitcnt vmcnt(9)
    v_dot2_f32_bf16 v2, v78, v10, 0
    v_dot2_f32_bf16 v3, v82, v14, 0
    v_dot2_f32_bf16 v4, v86, v18, 0
    v_dot2_f32_bf16 v2, v79, v11, v2
    v_dot2_f32_bf16 v3, v83, v15, v3
    v_dot2_f32_bf16 v4, v87, v19, v4
    v_dot2_f32_bf16 v2, v80, v12, v2
    v_dot2_f32_bf16 v3, v84, v16, v3
    v_dot2_f32_bf16 v4, v88, v20, v4
    v_dot2_f32_bf16 v2, v81, v13, v2
    v_dot2_f32_bf16 v3, v85, v17, v3
    v_dot2_f32_bf16 v4, v89, v21, v4
    s_add_u32 s48, s41, 0
    buffer_load_dwordx4 v[78:81], v1, s[20:23], s48 offen offset:0 nt
    buffer_load_dwordx4 v[82:85], v1, s[20:23], s48 offen offset:128 nt
    buffer_load_dwordx4 v[86:89], v1, s[20:23], s48 offen offset:256 nt
    v_add_f32 v2, v2, v3
    v_add_f32 v2, v2, v4
    s_nop 1
    v_add_f32_dpp v2, v2, v2 quad_perm:[1,0,3,2] row_mask:0xf bank_mask:0xf
    s_nop 1
    v_add_f32_dpp v2, v2, v2 quad_perm:[2,3,0,1] row_mask:0xf bank_mask:0xf
    s_nop 1
    v_add_f32_dpp v2, v2, v2 row_half_mirror row_mask:0xf bank_mask:0xf
    v_cvt_pk_bf16_f32 v2, v2, v2
    v_lshlrev_b32 v2, 16, v2
    v_mul_f32 v2, 0x3d93cd3a, v2
    v_cvt_pk_bf16_f32 v2, v2, v2
    v_lshlrev_b32 v26, 16, v2
    s_waitcnt vmcnt(9)
    v_dot2_f32_bf16 v2, v90, v10, 0
    v_dot2_f32_bf16 v3, v94, v14, 0
    v_dot2_f32_bf16 v4, v98, v18, 0
    v_dot2_f32_bf16 v2, v91, v11, v2
    v_dot2_f32_bf16 v3, v95, v15, v3
    v_dot2_f32_bf16 v4, v99, v19, v4
    v_dot2_f32_bf16 v2, v92, v12, v2
    v_dot2_f32_bf16 v3, v96, v16, v3
    v_dot2_f32_bf16 v4, v100, v20, v4
    v_dot2_f32_bf16 v2, v93, v13, v2
    v_dot2_f32_bf16 v3, v97, v17, v3
    v_dot2_f32_bf16 v4, v101, v21, v4
    s_add_u32 s48, s41, 3072
    buffer_load_dwordx4 v[90:93], v1, s[20:23], s48 offen offset:0 nt
    buffer_load_dwordx4 v[94:97], v1, s[20:23], s48 offen offset:128 nt
    buffer_load_dwordx4 v[98:101], v1, s[20:23], s48 offen offset:256 nt
    v_add_f32 v2, v2, v3
    v_add_f32 v2, v2, v4
    s_nop 1
    v_add_f32_dpp v2, v2, v2 quad_perm:[1,0,3,2] row_mask:0xf bank_mask:0xf
    s_nop 1
    v_add_f32_dpp v2, v2, v2 quad_perm:[2,3,0,1] row_mask:0xf bank_mask:0xf
    s_nop 1
    v_add_f32_dpp v2, v2, v2 row_half_mirror row_mask:0xf bank_mask:0xf
    v_cvt_pk_bf16_f32 v2, v2, v2
    v_lshlrev_b32 v2, 16, v2
    v_mul_f32 v2, 0x3d93cd3a, v2
    v_cvt_pk_bf16_f32 v2, v2, v2
    v_lshlrev_b32 v27, 16, v2
    s_waitcnt vmcnt(9)
    v_dot2_f32_bf16 v2, v102, v10, 0
    v_dot2_f32_bf16 v3, v106, v14, 0
    v_dot2_f32_bf16 v4, v110, v18, 0
    v_dot2_f32_bf16 v2, v103, v11, v2
    v_dot2_f32_bf16 v3, v107, v15, v3
    v_dot2_f32_bf16 v4, v111, v19, v4
    v_dot2_f32_bf16 v2, v104, v12, v2
    v_dot2_f32_bf16 v3, v108, v16, v3
    v_dot2_f32_bf16 v4, v112, v20, v4
    v_dot2_f32_bf16 v2, v105, v13, v2
    v_dot2_f32_bf16 v3, v109, v17, v3
    v_dot2_f32_bf16 v4, v113, v21, v4
    s_add_u32 s48, s41, 6144
    buffer_load_dwordx4 v[102:105], v1, s[20:23], s48 offen offset:0 nt
    buffer_load_dwordx4 v[106:109], v1, s[20:23], s48 offen offset:128 nt
    buffer_load_dwordx4 v[110:113], v1, s[20:23], s48 offen offset:256 nt
    v_add_f32 v2, v2, v3
    v_add_f32 v2, v2, v4
    s_nop 1
    v_add_f32_dpp v2, v2, v2 quad_perm:[1,0,3,2] row_mask:0xf bank_mask:0xf
    s_nop 1
    v_add_f32_dpp v2, v2, v2 quad_perm:[2,3,0,1] row_mask:0xf bank_mask:0xf
    s_nop 1
    v_add_f32_dpp v2, v2, v2 row_half_mirror row_mask:0xf bank_mask:0xf
    v_cvt_pk_bf16_f32 v2, v2, v2
    v_lshlrev_b32 v2, 16, v2
    v_mul_f32 v2, 0x3d93cd3a, v2
    v_cvt_pk_bf16_f32 v2, v2, v2
    v_lshlrev_b32 v28, 16, v2
    s_waitcnt vmcnt(9)
    v_dot2_f32_bf16 v2, v114, v10, 0
    v_dot2_f32_bf16 v3, v118, v14, 0
    v_dot2_f32_bf16 v4, v122, v18, 0
    v_dot2_f32_bf16 v2, v115, v11, v2
    v_dot2_f32_bf16 v3, v119, v15, v3
    v_dot2_f32_bf16 v4, v123, v19, v4
    v_dot2_f32_bf16 v2, v116, v12, v2
    v_dot2_f32_bf16 v3, v120, v16, v3
    v_dot2_f32_bf16 v4, v124, v20, v4
    v_dot2_f32_bf16 v2, v117, v13, v2
    v_dot2_f32_bf16 v3, v121, v17, v3
    v_dot2_f32_bf16 v4, v125, v21, v4
    s_add_u32 s48, s41, 9216
    buffer_load_dwordx4 v[114:117], v1, s[20:23], s48 offen offset:0 nt
    buffer_load_dwordx4 v[118:121], v1, s[20:23], s48 offen offset:128 nt
    buffer_load_dwordx4 v[122:125], v1, s[20:23], s48 offen offset:256 nt
    v_add_f32 v2, v2, v3
    v_add_f32 v2, v2, v4
    s_nop 1
    v_add_f32_dpp v2, v2, v2 quad_perm:[1,0,3,2] row_mask:0xf bank_mask:0xf
    s_nop 1
    v_add_f32_dpp v2, v2, v2 quad_perm:[2,3,0,1] row_mask:0xf bank_mask:0xf
    s_nop 1
    v_add_f32_dpp v2, v2, v2 row_half_mirror row_mask:0xf bank_mask:0xf
    v_cvt_pk_bf16_f32 v2, v2, v2
    v_lshlrev_b32 v2, 16, v2
    v_mul_f32 v2, 0x3d93cd3a, v2
    v_cvt_pk_bf16_f32 v2, v2, v2
    v_lshlrev_b32 v29, 16, v2
    v_max3_f32 v2, v22, v23, v24
    v_max3_f32 v2, v2, v25, v26
    v_max3_f32 v2, v2, v27, v28
    v_max_f32 v2, v2, v29
    s_nop 1
    v_max_f32_dpp v2, v2, v2 row_ror:8 row_mask:0xf bank_mask:0xf
    s_nop 1
    v_readlane_b32 s48, v2, 0
    v_readlane_b32 s49, v2, 16
    v_readlane_b32 s50, v2, 32
    v_readlane_b32 s51, v2, 48
    s_nop 1
    v_mov_b32 v2, s48
    v_max_f32 v2, s49, v2
    v_max_f32 v2, s50, v2
    v_max_f32 v2, s51, v2
    v_max_f32 v2, v2, v30
    v_sub_f32 v3, v30, v2
    v_mul_f32 v3, s52, v3
    v_exp_f32 v3, v3
    v_mov_b32 v30, v2
    v_mul_f32 v4, s52, v2
    v_fma_f32 v22, v22, s52, -v4
    v_exp_f32 v22, v22
    v_fma_f32 v23, v23, s52, -v4
    v_exp_f32 v23, v23
    v_fma_f32 v24, v24, s52, -v4
    v_exp_f32 v24, v24
    v_fma_f32 v25, v25, s52, -v4
    v_exp_f32 v25, v25
    v_fma_f32 v26, v26, s52, -v4
    v_exp_f32 v26, v26
    v_fma_f32 v27, v27, s52, -v4
    v_exp_f32 v27, v27
    v_fma_f32 v28, v28, s52, -v4
    v_exp_f32 v28, v28
    v_fma_f32 v29, v29, s52, -v4
    v_exp_f32 v29, v29
    v_mul_f32 v31, v31, v3
    v_mul_f32 v54, v54, v3
    v_mul_f32 v55, v55, v3
    v_mul_f32 v56, v56, v3
    v_mul_f32 v57, v57, v3
    v_mul_f32 v58, v58, v3
    v_mul_f32 v59, v59, v3
    v_mul_f32 v60, v60, v3
    v_mul_f32 v61, v61, v3
    v_mul_f32 v62, v62, v3
    v_mul_f32 v63, v63, v3
    v_mul_f32 v64, v64, v3
    v_mul_f32 v65, v65, v3
    v_mul_f32 v66, v66, v3
    v_mul_f32 v67, v67, v3
    v_mul_f32 v68, v68, v3
    v_mul_f32 v69, v69, v3
    v_mul_f32 v70, v70, v3
    v_mul_f32 v71, v71, v3
    v_mul_f32 v72, v72, v3
    v_mul_f32 v73, v73, v3
    v_mul_f32 v74, v74, v3
    v_mul_f32 v75, v75, v3
    v_mul_f32 v76, v76, v3
    v_mul_f32 v77, v77, v3
    v_add_f32 v31, v31, v22
    v_add_f32 v31, v31, v23
    v_add_f32 v31, v31, v24
    v_add_f32 v31, v31, v25
    v_add_f32 v31, v31, v26
    v_add_f32 v31, v31, v27
    v_add_f32 v31, v31, v28
    v_add_f32 v31, v31, v29
    s_waitcnt vmcnt(9)
    v_lshlrev_b32 v4, 16, v78
    v_and_b32 v5, 0xffff0000, v78
    v_fmac_f32 v54, v22, v4
    v_fmac_f32 v55, v22, v5
    v_lshlrev_b32 v4, 16, v79
    v_and_b32 v5, 0xffff0000, v79
    v_fmac_f32 v56, v22, v4
    v_fmac_f32 v57, v22, v5
    v_lshlrev_b32 v4, 16, v80
    v_and_b32 v5, 0xffff0000, v80
    v_fmac_f32 v58, v22, v4
    v_fmac_f32 v59, v22, v5
    v_lshlrev_b32 v4, 16, v81
    v_and_b32 v5, 0xffff0000, v81
    v_fmac_f32 v60, v22, v4
    v_fmac_f32 v61, v22, v5
    v_lshlrev_b32 v4, 16, v82
    v_and_b32 v5, 0xffff0000, v82
    v_fmac_f32 v62, v22, v4
    v_fmac_f32 v63, v22, v5
    v_lshlrev_b32 v4, 16, v83
    v_and_b32 v5, 0xffff0000, v83
    v_fmac_f32 v64, v22, v4
    v_fmac_f32 v65, v22, v5
    v_lshlrev_b32 v4, 16, v84
    v_and_b32 v5, 0xffff0000, v84
    v_fmac_f32 v66, v22, v4
    v_fmac_f32 v67, v22, v5
    v_lshlrev_b32 v4, 16, v85
    v_and_b32 v5, 0xffff0000, v85
    v_fmac_f32 v68, v22, v4
    v_fmac_f32 v69, v22, v5
    v_lshlrev_b32 v4, 16, v86
    v_and_b32 v5, 0xffff0000, v86
    v_fmac_f32 v70, v22, v4
    v_fmac_f32 v71, v22, v5
    v_lshlrev_b32 v4, 16, v87
    v_and_b32 v5, 0xffff0000, v87
    v_fmac_f32 v72, v22, v4
    v_fmac_f32 v73, v22, v5
    v_lshlrev_b32 v4, 16, v88
    v_and_b32 v5, 0xffff0000, v88
    v_fmac_f32 v74, v22, v4
    v_fmac_f32 v75, v22, v5
    v_lshlrev_b32 v4, 16, v89
    v_and_b32 v5, 0xffff0000, v89
    v_fmac_f32 v76, v22, v4
    v_fmac_f32 v77, v22, v5
    s_add_u32 s48, s41, 12288
    buffer_load_dwordx4 v[78:81], v1, s[20:23], s48 offen offset:0 nt
    buffer_load_dwordx4 v[82:85], v1, s[20:23], s48 offen offset:128 nt
    buffer_load_dwordx4 v[86:89], v1, s[20:23], s48 offen offset:256 nt
    s_waitcnt vmcnt(9)
    v_lshlrev_b32 v4, 16, v90
    v_and_b32 v5, 0xffff0000, v90
    v_fmac_f32 v54, v23, v4
    v_fmac_f32 v55, v23, v5
    v_lshlrev_b32 v4, 16, v91
    v_and_b32 v5, 0xffff0000, v91
    v_fmac_f32 v56, v23, v4
    v_fmac_f32 v57, v23, v5
    v_lshlrev_b32 v4, 16, v92
    v_and_b32 v5, 0xffff0000, v92
    v_fmac_f32 v58, v23, v4
    v_fmac_f32 v59, v23, v5
    v_lshlrev_b32 v4, 16, v93
    v_and_b32 v5, 0xffff0000, v93
    v_fmac_f32 v60, v23, v4
    v_fmac_f32 v61, v23, v5
    v_lshlrev_b32 v4, 16, v94
    v_and_b32 v5, 0xffff0000, v94
    v_fmac_f32 v62, v23, v4
    v_fmac_f32 v63, v23, v5
    v_lshlrev_b32 v4, 16, v95
    v_and_b32 v5, 0xffff0000, v95
    v_fmac_f32 v64, v23, v4
    v_fmac_f32 v65, v23, v5
    v_lshlrev_b32 v4, 16, v96
    v_and_b32 v5, 0xffff0000, v96
    v_fmac_f32 v66, v23, v4
    v_fmac_f32 v67, v23, v5
    v_lshlrev_b32 v4, 16, v97
    v_and_b32 v5, 0xffff0000, v97
    v_fmac_f32 v68, v23, v4
    v_fmac_f32 v69, v23, v5
    v_lshlrev_b32 v4, 16, v98
    v_and_b32 v5, 0xffff0000, v98
    v_fmac_f32 v70, v23, v4
    v_fmac_f32 v71, v23, v5
    v_lshlrev_b32 v4, 16, v99
    v_and_b32 v5, 0xffff0000, v99
    v_fmac_f32 v72, v23, v4
    v_fmac_f32 v73, v23, v5
    v_lshlrev_b32 v4, 16, v100
    v_and_b32 v5, 0xffff0000, v100
    v_fmac_f32 v74, v23, v4
    v_fmac_f32 v75, v23, v5
    v_lshlrev_b32 v4, 16, v101
    v_and_b32 v5, 0xffff0000, v101
    v_fmac_f32 v76, v23, v4
    v_fmac_f32 v77, v23, v5
    s_add_u32 s48, s41, 15360
    buffer_load_dwordx4 v[90:93], v1, s[20:23], s48 offen offset:0 nt
    buffer_load_dwordx4 v[94:97], v1, s[20:23], s48 offen offset:128 nt
    buffer_load_dwordx4 v[98:101], v1, s[20:23], s48 offen offset:256 nt
    s_waitcnt vmcnt(9)
    v_lshlrev_b32 v4, 16, v102
    v_and_b32 v5, 0xffff0000, v102
    v_fmac_f32 v54, v24, v4
    v_fmac_f32 v55, v24, v5
    v_lshlrev_b32 v4, 16, v103
    v_and_b32 v5, 0xffff0000, v103
    v_fmac_f32 v56, v24, v4
    v_fmac_f32 v57, v24, v5
    v_lshlrev_b32 v4, 16, v104
    v_and_b32 v5, 0xffff0000, v104
    v_fmac_f32 v58, v24, v4
    v_fmac_f32 v59, v24, v5
    v_lshlrev_b32 v4, 16, v105
    v_and_b32 v5, 0xffff0000, v105
    v_fmac_f32 v60, v24, v4
    v_fmac_f32 v61, v24, v5
    v_lshlrev_b32 v4, 16, v106
    v_and_b32 v5, 0xffff0000, v106
    v_fmac_f32 v62, v24, v4
    v_fmac_f32 v63, v24, v5
    v_lshlrev_b32 v4, 16, v107
    v_and_b32 v5, 0xffff0000, v107
    v_fmac_f32 v64, v24, v4
    v_fmac_f32 v65, v24, v5
    v_lshlrev_b32 v4, 16, v108
    v_and_b32 v5, 0xffff0000, v108
    v_fmac_f32 v66, v24, v4
    v_fmac_f32 v67, v24, v5
    v_lshlrev_b32 v4, 16, v109
    v_and_b32 v5, 0xffff0000, v109
    v_fmac_f32 v68, v24, v4
    v_fmac_f32 v69, v24, v5
    v_lshlrev_b32 v4, 16, v110
    v_and_b32 v5, 0xffff0000, v110
    v_fmac_f32 v70, v24, v4
    v_fmac_f32 v71, v24, v5
    v_lshlrev_b32 v4, 16, v111
    v_and_b32 v5, 0xffff0000, v111
    v_fmac_f32 v72, v24, v4
    v_fmac_f32 v73, v24, v5
    v_lshlrev_b32 v4, 16, v112
    v_and_b32 v5, 0xffff0000, v112
    v_fmac_f32 v74, v24, v4
    v_fmac_f32 v75, v24, v5
    v_lshlrev_b32 v4, 16, v113
    v_and_b32 v5, 0xffff0000, v113
    v_fmac_f32 v76, v24, v4
    v_fmac_f32 v77, v24, v5
    s_add_u32 s48, s41, 18432
    buffer_load_dwordx4 v[102:105], v1, s[20:23], s48 offen offset:0 nt
    buffer_load_dwordx4 v[106:109], v1, s[20:23], s48 offen offset:128 nt
    buffer_load_dwordx4 v[110:113], v1, s[20:23], s48 offen offset:256 nt
    s_waitcnt vmcnt(9)
    v_lshlrev_b32 v4, 16, v114
    v_and_b32 v5, 0xffff0000, v114
    v_fmac_f32 v54, v25, v4
    v_fmac_f32 v55, v25, v5
    v_lshlrev_b32 v4, 16, v115
    v_and_b32 v5, 0xffff0000, v115
    v_fmac_f32 v56, v25, v4
    v_fmac_f32 v57, v25, v5
    v_lshlrev_b32 v4, 16, v116
    v_and_b32 v5, 0xffff0000, v116
    v_fmac_f32 v58, v25, v4
    v_fmac_f32 v59, v25, v5
    v_lshlrev_b32 v4, 16, v117
    v_and_b32 v5, 0xffff0000, v117
    v_fmac_f32 v60, v25, v4
    v_fmac_f32 v61, v25, v5
    v_lshlrev_b32 v4, 16, v118
    v_and_b32 v5, 0xffff0000, v118
    v_fmac_f32 v62, v25, v4
    v_fmac_f32 v63, v25, v5
    v_lshlrev_b32 v4, 16, v119
    v_and_b32 v5, 0xffff0000, v119
    v_fmac_f32 v64, v25, v4
    v_fmac_f32 v65, v25, v5
    v_lshlrev_b32 v4, 16, v120
    v_and_b32 v5, 0xffff0000, v120
    v_fmac_f32 v66, v25, v4
    v_fmac_f32 v67, v25, v5
    v_lshlrev_b32 v4, 16, v121
    v_and_b32 v5, 0xffff0000, v121
    v_fmac_f32 v68, v25, v4
    v_fmac_f32 v69, v25, v5
    v_lshlrev_b32 v4, 16, v122
    v_and_b32 v5, 0xffff0000, v122
    v_fmac_f32 v70, v25, v4
    v_fmac_f32 v71, v25, v5
    v_lshlrev_b32 v4, 16, v123
    v_and_b32 v5, 0xffff0000, v123
    v_fmac_f32 v72, v25, v4
    v_fmac_f32 v73, v25, v5
    v_lshlrev_b32 v4, 16, v124
    v_and_b32 v5, 0xffff0000, v124
    v_fmac_f32 v74, v25, v4
    v_fmac_f32 v75, v25, v5
    v_lshlrev_b32 v4, 16, v125
    v_and_b32 v5, 0xffff0000, v125
    v_fmac_f32 v76, v25, v4
    v_fmac_f32 v77, v25, v5
    s_add_u32 s48, s41, 21504
    buffer_load_dwordx4 v[114:117], v1, s[20:23], s48 offen offset:0 nt
    buffer_load_dwordx4 v[118:121], v1, s[20:23], s48 offen offset:128 nt
    buffer_load_dwordx4 v[122:125], v1, s[20:23], s48 offen offset:256 nt
    s_waitcnt vmcnt(9)
    v_lshlrev_b32 v4, 16, v78
    v_and_b32 v5, 0xffff0000, v78
    v_fmac_f32 v54, v26, v4
    v_fmac_f32 v55, v26, v5
    v_lshlrev_b32 v4, 16, v79
    v_and_b32 v5, 0xffff0000, v79
    v_fmac_f32 v56, v26, v4
    v_fmac_f32 v57, v26, v5
    v_lshlrev_b32 v4, 16, v80
    v_and_b32 v5, 0xffff0000, v80
    v_fmac_f32 v58, v26, v4
    v_fmac_f32 v59, v26, v5
    v_lshlrev_b32 v4, 16, v81
    v_and_b32 v5, 0xffff0000, v81
    v_fmac_f32 v60, v26, v4
    v_fmac_f32 v61, v26, v5
    v_lshlrev_b32 v4, 16, v82
    v_and_b32 v5, 0xffff0000, v82
    v_fmac_f32 v62, v26, v4
    v_fmac_f32 v63, v26, v5
    v_lshlrev_b32 v4, 16, v83
    v_and_b32 v5, 0xffff0000, v83
    v_fmac_f32 v64, v26, v4
    v_fmac_f32 v65, v26, v5
    v_lshlrev_b32 v4, 16, v84
    v_and_b32 v5, 0xffff0000, v84
    v_fmac_f32 v66, v26, v4
    v_fmac_f32 v67, v26, v5
    v_lshlrev_b32 v4, 16, v85
    v_and_b32 v5, 0xffff0000, v85
    v_fmac_f32 v68, v26, v4
    v_fmac_f32 v69, v26, v5
    v_lshlrev_b32 v4, 16, v86
    v_and_b32 v5, 0xffff0000, v86
    v_fmac_f32 v70, v26, v4
    v_fmac_f32 v71, v26, v5
    v_lshlrev_b32 v4, 16, v87
    v_and_b32 v5, 0xffff0000, v87
    v_fmac_f32 v72, v26, v4
    v_fmac_f32 v73, v26, v5
    v_lshlrev_b32 v4, 16, v88
    v_and_b32 v5, 0xffff0000, v88
    v_fmac_f32 v74, v26, v4
    v_fmac_f32 v75, v26, v5
    v_lshlrev_b32 v4, 16, v89
    v_and_b32 v5, 0xffff0000, v89
    v_fmac_f32 v76, v26, v4
    v_fmac_f32 v77, v26, v5
    s_add_u32 s48, s47, 0
    buffer_load_dwordx4 v[78:81], v1, s[16:19], s48 offen offset:0 nt
    buffer_load_dwordx4 v[82:85], v1, s[16:19], s48 offen offset:128 nt
    buffer_load_dwordx4 v[86:89], v1, s[16:19], s48 offen offset:256 nt
    s_waitcnt vmcnt(9)
    v_lshlrev_b32 v4, 16, v90
    v_and_b32 v5, 0xffff0000, v90
    v_fmac_f32 v54, v27, v4
    v_fmac_f32 v55, v27, v5
    v_lshlrev_b32 v4, 16, v91
    v_and_b32 v5, 0xffff0000, v91
    v_fmac_f32 v56, v27, v4
    v_fmac_f32 v57, v27, v5
    v_lshlrev_b32 v4, 16, v92
    v_and_b32 v5, 0xffff0000, v92
    v_fmac_f32 v58, v27, v4
    v_fmac_f32 v59, v27, v5
    v_lshlrev_b32 v4, 16, v93
    v_and_b32 v5, 0xffff0000, v93
    v_fmac_f32 v60, v27, v4
    v_fmac_f32 v61, v27, v5
    v_lshlrev_b32 v4, 16, v94
    v_and_b32 v5, 0xffff0000, v94
    v_fmac_f32 v62, v27, v4
    v_fmac_f32 v63, v27, v5
    v_lshlrev_b32 v4, 16, v95
    v_and_b32 v5, 0xffff0000, v95
    v_fmac_f32 v64, v27, v4
    v_fmac_f32 v65, v27, v5
    v_lshlrev_b32 v4, 16, v96
    v_and_b32 v5, 0xffff0000, v96
    v_fmac_f32 v66, v27, v4
    v_fmac_f32 v67, v27, v5
    v_lshlrev_b32 v4, 16, v97
    v_and_b32 v5, 0xffff0000, v97
    v_fmac_f32 v68, v27, v4
    v_fmac_f32 v69, v27, v5
    v_lshlrev_b32 v4, 16, v98
    v_and_b32 v5, 0xffff0000, v98
    v_fmac_f32 v70, v27, v4
    v_fmac_f32 v71, v27, v5
    v_lshlrev_b32 v4, 16, v99
    v_and_b32 v5, 0xffff0000, v99
    v_fmac_f32 v72, v27, v4
    v_fmac_f32 v73, v27, v5
    v_lshlrev_b32 v4, 16, v100
    v_and_b32 v5, 0xffff0000, v100
    v_fmac_f32 v74, v27, v4
    v_fmac_f32 v75, v27, v5
    v_lshlrev_b32 v4, 16, v101
    v_and_b32 v5, 0xffff0000, v101
    v_fmac_f32 v76, v27, v4
    v_fmac_f32 v77, v27, v5
    s_add_u32 s48, s47, 3072
    buffer_load_dwordx4 v[90:93], v1, s[16:19], s48 offen offset:0 nt
    buffer_load_dwordx4 v[94:97], v1, s[16:19], s48 offen offset:128 nt
    buffer_load_dwordx4 v[98:101], v1, s[16:19], s48 offen offset:256 nt
    s_waitcnt vmcnt(9)
    v_lshlrev_b32 v4, 16, v102
    v_and_b32 v5, 0xffff0000, v102
    v_fmac_f32 v54, v28, v4
    v_fmac_f32 v55, v28, v5
    v_lshlrev_b32 v4, 16, v103
    v_and_b32 v5, 0xffff0000, v103
    v_fmac_f32 v56, v28, v4
    v_fmac_f32 v57, v28, v5
    v_lshlrev_b32 v4, 16, v104
    v_and_b32 v5, 0xffff0000, v104
    v_fmac_f32 v58, v28, v4
    v_fmac_f32 v59, v28, v5
    v_lshlrev_b32 v4, 16, v105
    v_and_b32 v5, 0xffff0000, v105
    v_fmac_f32 v60, v28, v4
    v_fmac_f32 v61, v28, v5
    v_lshlrev_b32 v4, 16, v106
    v_and_b32 v5, 0xffff0000, v106
    v_fmac_f32 v62, v28, v4
    v_fmac_f32 v63, v28, v5
    v_lshlrev_b32 v4, 16, v107
    v_and_b32 v5, 0xffff0000, v107
    v_fmac_f32 v64, v28, v4
    v_fmac_f32 v65, v28, v5
    v_lshlrev_b32 v4, 16, v108
    v_and_b32 v5, 0xffff0000, v108
    v_fmac_f32 v66, v28, v4
    v_fmac_f32 v67, v28, v5
    v_lshlrev_b32 v4, 16, v109
    v_and_b32 v5, 0xffff0000, v109
    v_fmac_f32 v68, v28, v4
    v_fmac_f32 v69, v28, v5
    v_lshlrev_b32 v4, 16, v110
    v_and_b32 v5, 0xffff0000, v110
    v_fmac_f32 v70, v28, v4
    v_fmac_f32 v71, v28, v5
    v_lshlrev_b32 v4, 16, v111
    v_and_b32 v5, 0xffff0000, v111
    v_fmac_f32 v72, v28, v4
    v_fmac_f32 v73, v28, v5
    v_lshlrev_b32 v4, 16, v112
    v_and_b32 v5, 0xffff0000, v112
    v_fmac_f32 v74, v28, v4
    v_fmac_f32 v75, v28, v5
    v_lshlrev_b32 v4, 16, v113
    v_and_b32 v5, 0xffff0000, v113
    v_fmac_f32 v76, v28, v4
    v_fmac_f32 v77, v28, v5
    s_add_u32 s48, s47, 6144
    buffer_load_dwordx4 v[102:105], v1, s[16:19], s48 offen offset:0 nt
    buffer_load_dwordx4 v[106:109], v1, s[16:19], s48 offen offset:128 nt
    buffer_load_dwordx4 v[110:113], v1, s[16:19], s48 offen offset:256 nt
    s_waitcnt vmcnt(9)
    v_lshlrev_b32 v4, 16, v114
    v_and_b32 v5, 0xffff0000, v114
    v_fmac_f32 v54, v29, v4
    v_fmac_f32 v55, v29, v5
    v_lshlrev_b32 v4, 16, v115
    v_and_b32 v5, 0xffff0000, v115
    v_fmac_f32 v56, v29, v4
    v_fmac_f32 v57, v29, v5
    v_lshlrev_b32 v4, 16, v116
    v_and_b32 v5, 0xffff0000, v116
    v_fmac_f32 v58, v29, v4
    v_fmac_f32 v59, v29, v5
    v_lshlrev_b32 v4, 16, v117
    v_and_b32 v5, 0xffff0000, v117
    v_fmac_f32 v60, v29, v4
    v_fmac_f32 v61, v29, v5
    v_lshlrev_b32 v4, 16, v118
    v_and_b32 v5, 0xffff0000, v118
    v_fmac_f32 v62, v29, v4
    v_fmac_f32 v63, v29, v5
    v_lshlrev_b32 v4, 16, v119
    v_and_b32 v5, 0xffff0000, v119
    v_fmac_f32 v64, v29, v4
    v_fmac_f32 v65, v29, v5
    v_lshlrev_b32 v4, 16, v120
    v_and_b32 v5, 0xffff0000, v120
    v_fmac_f32 v66, v29, v4
    v_fmac_f32 v67, v29, v5
    v_lshlrev_b32 v4, 16, v121
    v_and_b32 v5, 0xffff0000, v121
    v_fmac_f32 v68, v29, v4
    v_fmac_f32 v69, v29, v5
    v_lshlrev_b32 v4, 16, v122
    v_and_b32 v5, 0xffff0000, v122
    v_fmac_f32 v70, v29, v4
    v_fmac_f32 v71, v29, v5
    v_lshlrev_b32 v4, 16, v123
    v_and_b32 v5, 0xffff0000, v123
    v_fmac_f32 v72, v29, v4
    v_fmac_f32 v73, v29, v5
    v_lshlrev_b32 v4, 16, v124
    v_and_b32 v5, 0xffff0000, v124
    v_fmac_f32 v74, v29, v4
    v_fmac_f32 v75, v29, v5
    v_lshlrev_b32 v4, 16, v125
    v_and_b32 v5, 0xffff0000, v125
    v_fmac_f32 v76, v29, v4
    v_fmac_f32 v77, v29, v5
    s_add_u32 s48, s47, 9216
    buffer_load_dwordx4 v[114:117], v1, s[16:19], s48 offen offset:0 nt
    buffer_load_dwordx4 v[118:121], v1, s[16:19], s48 offen offset:128 nt
    buffer_load_dwordx4 v[122:125], v1, s[16:19], s48 offen offset:256 nt
    s_mov_b32 s41, s47
    s_cmp_lt_u32 s41, s96
    s_cbranch_scc1 L_loop
L_pool_end:
    s_waitcnt vmcnt(0)
    v_mov_b32 v2, v30
    v_mov_b32 v3, v31
    s_nop 1
    v_add_f32_dpp v3, v3, v3 quad_perm:[1,0,3,2] row_mask:0xf bank_mask:0xf
    s_nop 1
    v_add_f32_dpp v3, v3, v3 quad_perm:[2,3,0,1] row_mask:0xf bank_mask:0xf
    s_nop 1
    v_add_f32_dpp v3, v3, v3 row_half_mirror row_mask:0xf bank_mask:0xf
    s_nop 1
    v_add_f32_dpp v3, v3, v3 row_mirror row_mask:0xf bank_mask:0xf
    s_nop 1
    v_readlane_b32 s48, v3, 0
    v_readlane_b32 s49, v3, 16
    v_readlane_b32 s50, v3, 32
    v_readlane_b32 s51, v3, 48
    s_nop 1
    v_mov_b32 v3, s48
    v_add_f32 v3, s49, v3
    v_add_f32 v3, s50, v3
    v_add_f32 v3, s51, v3
    v_mul_f32 v3, 0.125, v3
    s_nop 1
    v_permlane32_swap_b32 v54, v58
    v_permlane32_swap_b32 v55, v59
    v_permlane32_swap_b32 v56, v60
    v_permlane32_swap_b32 v57, v61
    v_permlane32_swap_b32 v62, v66
    v_permlane32_swap_b32 v63, v67
    v_permlane32_swap_b32 v64, v68
    v_permlane32_swap_b32 v65, v69
    v_permlane32_swap_b32 v70, v74
    v_permlane32_swap_b32 v71, v75
    v_permlane32_swap_b32 v72, v76
    v_permlane32_swap_b32 v73, v77
    v_add_f32 v54, v54, v58
    v_add_f32 v55, v55, v59
    v_add_f32 v56, v56, v60
    v_add_f32 v57, v57, v61
    v_add_f32 v62, v62, v66
    v_add_f32 v63, v63, v67
    v_add_f32 v64, v64, v68
    v_add_f32 v65, v65, v69
    v_add_f32 v70, v70, v74
    v_add_f32 v71, v71, v75
    v_add_f32 v72, v72, v76
    v_add_f32 v73, v73, v77
    s_nop 1
    v_permlane16_swap_b32 v54, v56
    v_permlane16_swap_b32 v55, v57
    v_permlane16_swap_b32 v62, v64
    v_permlane16_swap_b32 v63, v65
    v_permlane16_swap_b32 v70, v72
    v_permlane16_swap_b32 v71, v73
    v_add_f32 v54, v54, v56
    v_add_f32 v55, v55, v57
    v_add_f32 v62, v62, v64
    v_add_f32 v63, v63, v65
    v_add_f32 v70, v70, v72
    v_add_f32 v71, v71, v73
    s_nop 1
    v_add_f32_dpp v54, v54, v54 row_ror:8 row_mask:0xf bank_mask:0xf
    v_add_f32_dpp v55, v55, v55 row_ror:8 row_mask:0xf bank_mask:0xf
    v_add_f32_dpp v62, v62, v62 row_ror:8 row_mask:0xf bank_mask:0xf
    v_add_f32_dpp v63, v63, v63 row_ror:8 row_mask:0xf bank_mask:0xf
    v_add_f32_dpp v70, v70, v70 row_ror:8 row_mask:0xf bank_mask:0xf
    v_add_f32_dpp v71, v71, v71 row_ror:8 row_mask:0xf bank_mask:0xf
    ds_write_b64 v9, v[54:55] offset:0
    ds_write_b64 v9, v[62:63] offset:256
    ds_write_b64 v9, v[70:71] offset:512
    v_lshrrev_b32 v4, 6, v0
    v_lshlrev_b32 v4, 3, v4
    ds_write_b64 v4, v[2:3] offset:12800
    s_waitcnt lgkmcnt(0)
    s_barrier
    s_cmp_lg_u32 s53, 3
    s_cbranch_scc1 L_noarr
    s_mov_b64 exec, 1
    v_mov_b32 v4, 0
    v_mov_b32 v5, 1
    buffer_atomic_add v5, v4, s[36:39], 0 offen sc0 sc1
    s_waitcnt vmcnt(0)
    v_mov_b32 v4, 12928
    ds_write_b32 v4, v5
    v_readfirstlane_b32 s48, v5
    s_waitcnt lgkmcnt(0)
    s_mov_b64 exec, -1
    v_lshlrev_b32 v4, 7, v6
    v_mov_b32 v5, 1
    s_cmp_lg_u32 s48, 247
    s_cbranch_scc1 L_e3
    s_mov_b32 s48, 458756
    buffer_store_dword v5, v4, s[32:35], s48 offen sc0 sc1
    s_mov_b32 s48, 466948
    buffer_store_dword v5, v4, s[32:35], s48 offen sc0 sc1
    s_mov_b32 s48, 475140
    buffer_store_dword v5, v4, s[32:35], s48 offen sc0 sc1
    s_mov_b32 s48, 483332
    buffer_store_dword v5, v4, s[32:35], s48 offen sc0 sc1
    s_branch L_e2
L_e3:
    s_cmp_lg_u32 s48, 255
    s_cbranch_scc1 L_e2
    s_mov_b32 s48, 458752
    buffer_store_dword v5, v4, s[32:35], s48 offen sc0 sc1
    s_mov_b32 s48, 466944
    buffer_store_dword v5, v4, s[32:35], s48 offen sc0 sc1
    s_mov_b32 s48, 475136
    buffer_store_dword v5, v4, s[32:35], s48 offen sc0 sc1
    s_mov_b32 s48, 483328
    buffer_store_dword v5, v4, s[32:35], s48 offen sc0 sc1
    s_branch L_e2
L_noarr:
    v_cmp_gt_u32 vcc, 192, v0
    s_and_saveexec_b64 s[100:101], vcc
    s_cbranch_execz L_e1
    v_lshlrev_b32 v2, 2, v0
    v_mov_b32 v4, 0
    ds_read_b32 v54, v2 offset:0
    ds_read_b32 v55, v2 offset:768
    ds_read_b32 v56, v2 offset:1536
    ds_read_b32 v57, v2 offset:2304
    ds_read_b32 v58, v2 offset:3072
    ds_read_b32 v59, v2 offset:3840
    ds_read_b32 v60, v2 offset:4608
    ds_read_b32 v61, v2 offset:5376
    ds_read_b32 v62, v2 offset:6144
    ds_read_b32 v63, v2 offset:6912
    ds_read_b32 v64, v2 offset:7680
    ds_read_b32 v65, v2 offset:8448
    ds_read_b32 v66, v2 offset:9216
    ds_read_b32 v67, v2 offset:9984
    ds_read_b32 v68, v2 offset:10752
    ds_read_b32 v69, v2 offset:11520
    ds_read_b128 v[22:25], v4 offset:12800
    ds_read_b128 v[26:29], v4 offset:12816
    ds_read_b128 v[30:33], v4 offset:12832
    ds_read_b128 v[34:37], v4 offset:12848
    ds_read_b128 v[38:41], v4 offset:12864
    ds_read_b128 v[42:45], v4 offset:12880
    ds_read_b128 v[46:49], v4 offset:12896
    ds_read_b128 v[50:53], v4 offset:12912
    s_waitcnt lgkmcnt(0)
    v_max_f32 v3, v22, v24
    v_max_f32 v3, v3, v26
    v_max_f32 v3, v3, v28
    v_max_f32 v3, v3, v30
    v_max_f32 v3, v3, v32
    v_max_f32 v3, v3, v34
    v_max_f32 v3, v3, v36
    v_max_f32 v3, v3, v38
    v_max_f32 v3, v3, v40
    v_max_f32 v3, v3, v42
    v_max_f32 v3, v3, v44
    v_max_f32 v3, v3, v46
    v_max_f32 v3, v3, v48
    v_max_f32 v3, v3, v50
    v_max_f32 v3, v3, v52
    v_sub_f32 v22, v22, v3
    v_mul_f32 v22, 0x3fb8aa3b, v22
    v_exp_f32 v22, v22
    v_sub_f32 v24, v24, v3
    v_mul_f32 v24, 0x3fb8aa3b, v24
    v_exp_f32 v24, v24
    v_sub_f32 v26, v26, v3
    v_mul_f32 v26, 0x3fb8aa3b, v26
    v_exp_f32 v26, v26
    v_sub_f32 v28, v28, v3
    v_mul_f32 v28, 0x3fb8aa3b, v28
    v_exp_f32 v28, v28
    v_sub_f32 v30, v30, v3
    v_mul_f32 v30, 0x3fb8aa3b, v30
    v_exp_f32 v30, v30
    v_sub_f32 v32, v32, v3
    v_mul_f32 v32, 0x3fb8aa3b, v32
    v_exp_f32 v32, v32
    v_sub_f32 v34, v34, v3
    v_mul_f32 v34, 0x3fb8aa3b, v34
    v_exp_f32 v34, v34
    v_sub_f32 v36, v36, v3
    v_mul_f32 v36, 0x3fb8aa3b, v36
    v_exp_f32 v36, v36
    v_sub_f32 v38, v38, v3
    v_mul_f32 v38, 0x3fb8aa3b, v38
    v_exp_f32 v38, v38
    v_sub_f32 v40, v40, v3
    v_mul_f32 v40, 0x3fb8aa3b, v40
    v_exp_f32 v40, v40
    v_sub_f32 v42, v42, v3
    v_mul_f32 v42, 0x3fb8aa3b, v42
    v_exp_f32 v42, v42
    v_sub_f32 v44, v44, v3
    v_mul_f32 v44, 0x3fb8aa3b, v44
    v_exp_f32 v44, v44
    v_sub_f32 v46, v46, v3
    v_mul_f32 v46, 0x3fb8aa3b, v46
    v_exp_f32 v46, v46
    v_sub_f32 v48, v48, v3
    v_mul_f32 v48, 0x3fb8aa3b, v48
    v_exp_f32 v48, v48
    v_sub_f32 v50, v50, v3
    v_mul_f32 v50, 0x3fb8aa3b, v50
    v_exp_f32 v50, v50
    v_sub_f32 v52, v52, v3
    v_mul_f32 v52, 0x3fb8aa3b, v52
    v_exp_f32 v52, v52
    s_nop 0
    v_mul_f32 v4, v22, v54
    v_mul_f32 v5, v22, v23
    v_fmac_f32 v4, v24, v55
    v_fmac_f32 v5, v24, v25
    v_fmac_f32 v4, v26, v56
    v_fmac_f32 v5, v26, v27
    v_fmac_f32 v4, v28, v57
    v_fmac_f32 v5, v28, v29
    v_fmac_f32 v4, v30, v58
    v_fmac_f32 v5, v30, v31
    v_fmac_f32 v4, v32, v59
    v_fmac_f32 v5, v32, v33
    v_fmac_f32 v4, v34, v60
    v_fmac_f32 v5, v34, v35
    v_fmac_f32 v4, v36, v61
    v_fmac_f32 v5, v36, v37
    v_fmac_f32 v4, v38, v62
    v_fmac_f32 v5, v38, v39
    v_fmac_f32 v4, v40, v63
    v_fmac_f32 v5, v40, v41
    v_fmac_f32 v4, v42, v64
    v_fmac_f32 v5, v42, v43
    v_fmac_f32 v4, v44, v65
    v_fmac_f32 v5, v44, v45
    v_fmac_f32 v4, v46, v66
    v_fmac_f32 v5, v46, v47
    v_fmac_f32 v4, v48, v67
    v_fmac_f32 v5, v48, v49
    v_fmac_f32 v4, v50, v68
    v_fmac_f32 v5, v50, v51
    v_fmac_f32 v4, v52, v69
    v_fmac_f32 v5, v52, v53
    v_mov_b32 v12, v4
    v_mov_b32 v14, v3
    v_mov_b32 v15, v5
    v_mov_b32_dpp v13, v4 quad_perm:[1,0,3,2] row_mask:0xf bank_mask:0xf
    v_lshlrev_b32 v2, 3, v0
    s_mul_i32 s48, s40, 1536
    s_add_u32 s48, s48, 1048576
    s_mov_b32 exec_lo, 0x55555555
    s_mov_b32 exec_hi, 0x55555555
    buffer_store_dwordx4 v[12:15], v2, s[32:35], s48 offen sc0 sc1
L_e1:
    s_mov_b64 exec, s[100:101]
L_e2:
    s_barrier
    v_mov_b32 v12, 12928
    ds_read_b32 v13, v12
    s_waitcnt lgkmcnt(0)
    v_readfirstlane_b32 s97, v13
    s_mul_i32 s48, s97, 6554
    s_lshr_b32 s54, s48, 16
    s_mul_i32 s48, s54, 10
    s_sub_u32 s55, s97, s48
    s_mov_b32 s98, 0
    s_cmp_lt_u32 s97, 80
    s_cbranch_scc1 L_role_2
    s_mov_b32 s98, 1
    s_sub_u32 s55, s97, 80
    s_cmp_ge_u32 s55, 24
    s_cselect_b32 s54, 1, 0
    s_mul_i32 s48, s54, 24
    s_sub_u32 s55, s55, s48
    s_cmp_lt_u32 s97, 128
    s_cbranch_scc1 L_role_2
    s_mov_b32 s98, 2
    s_sub_u32 s55, s97, 128
    s_cmp_lt_u32 s97, 148
    s_cbranch_scc1 L_role_2
    s_mov_b32 s98, 3
L_role_2:
    s_cmp_eq_u32 s54, 1
    s_cselect_b32 s64, s92, s64
    s_cselect_b32 s65, s93, s65
    s_cmp_eq_u32 s98, 3
    s_cbranch_scc1 L_dma_end
    s_cmp_eq_u32 s98, 2
    s_cbranch_scc1 L_dma_e
    v_lshrrev_b32 v126, 3, v6
    v_and_b32 v127, 7, v6
    v_lshlrev_b32 v127, 4, v127
    s_cmp_eq_u32 s98, 1
    s_cbranch_scc1 L_dma_d
    v_mul_u32_u24 v126, 1280, v126
    v_add_u32 v126, v126, v127
    s_mul_i32 s48, s54, 768
    s_mul_i32 s49, s53, 48
    s_add_u32 s48, s48, s49
    s_mul_i32 s48, s48, 1280
    s_lshl_b32 s50, s55, 7
    s_add_u32 s48, s48, s50
    s_lshl_b32 s50, s49, 7
    s_add_u32 s50, s50, 42496
    s_mov_b32 m0, s50
    s_nop 0
    buffer_load_dwordx4 v126, s[60:63], s48 offen nt lds
    s_add_u32 s48, s48, 10240
    s_add_u32 s50, s50, 1024
    s_mov_b32 m0, s50
    s_nop 0
    buffer_load_dwordx4 v126, s[60:63], s48 offen nt lds
    s_add_u32 s48, s48, 10240
    s_add_u32 s50, s50, 1024
    s_mov_b32 m0, s50
    s_nop 0
    buffer_load_dwordx4 v126, s[60:63], s48 offen nt lds
    s_add_u32 s48, s48, 10240
    s_add_u32 s50, s50, 1024
    s_mov_b32 m0, s50
    s_nop 0
    buffer_load_dwordx4 v126, s[60:63], s48 offen nt lds
    s_add_u32 s48, s48, 10240
    s_add_u32 s50, s50, 1024
    s_mov_b32 m0, s50
    s_nop 0
    buffer_load_dwordx4 v126, s[60:63], s48 offen nt lds
    s_add_u32 s48, s48, 10240
    s_add_u32 s50, s50, 1024
    s_mov_b32 m0, s50
    s_nop 0
    buffer_load_dwordx4 v126, s[60:63], s48 offen nt lds
    s_branch L_dma_end
L_dma_d:
    v_mul_u32_u24 v126, 3072, v126
    v_add_u32 v126, v126, v127
    s_mul_i32 s49, s53, 40
    s_mul_i32 s48, s49, 3072
    s_lshl_b32 s50, s55, 7
    s_add_u32 s48, s48, s50
    s_lshl_b32 s50, s49, 7
    s_add_u32 s50, s50, 42496
    s_mov_b32 m0, s50
    s_nop 0
    buffer_load_dwordx4 v126, s[64:67], s48 offen nt lds
    s_add_u32 s48, s48, 24576
    s_add_u32 s50, s50, 1024
    s_mov_b32 m0, s50
    s_nop 0
    buffer_load_dwordx4 v126, s[64:67], s48 offen nt lds
    s_add_u32 s48, s48, 24576
    s_add_u32 s50, s50, 1024
    s_mov_b32 m0, s50
    s_nop 0
    buffer_load_dwordx4 v126, s[64:67], s48 offen nt lds
    s_add_u32 s48, s48, 24576
    s_add_u32 s50, s50, 1024
    s_mov_b32 m0, s50
    s_nop 0
    buffer_load_dwordx4 v126, s[64:67], s48 offen nt lds
    s_add_u32 s48, s48, 24576
    s_add_u32 s50, s50, 1024
    s_mov_b32 m0, s50
    s_nop 0
    buffer_load_dwordx4 v126, s[64:67], s48 offen nt lds
    s_branch L_dma_end
L_dma_e:
    v_lshrrev_b32 v126, 2, v6
    v_and_b32 v127, 3, v6
    v_lshlrev_b32 v127, 4, v127
    v_mul_u32_u24 v126, 1280, v126
    v_add_u32 v126, v126, v127
    s_mul_i32 s49, s53, 96
    s_mul_i32 s48, s49, 1280
    s_lshl_b32 s50, s55, 6
    s_add_u32 s48, s48, s50
    s_lshl_b32 s50, s49, 6
    s_add_u32 s50, s50, 42496
    s_mov_b32 m0, s50
    s_nop 0
    buffer_load_dwordx4 v126, s[68:71], s48 offen nt lds
    s_add_u32 s48, s48, 20480
    s_add_u32 s50, s50, 1024
    s_mov_b32 m0, s50
    s_nop 0
    buffer_load_dwordx4 v126, s[68:71], s48 offen nt lds
    s_add_u32 s48, s48, 20480
    s_add_u32 s50, s50, 1024
    s_mov_b32 m0, s50
    s_nop 0
    buffer_load_dwordx4 v126, s[68:71], s48 offen nt lds
    s_add_u32 s48, s48, 20480
    s_add_u32 s50, s50, 1024
    s_mov_b32 m0, s50
    s_nop 0
    buffer_load_dwordx4 v126, s[68:71], s48 offen nt lds
    s_add_u32 s48, s48, 20480
    s_add_u32 s50, s50, 1024
    s_mov_b32 m0, s50
    s_nop 0
    buffer_load_dwordx4 v126, s[68:71], s48 offen nt lds
    s_add_u32 s48, s48, 20480
    s_add_u32 s50, s50, 1024
    s_mov_b32 m0, s50
    s_nop 0
    buffer_load_dwordx4 v126, s[68:71], s48 offen nt lds
L_dma_end:
    s_cmp_eq_u32 s98, 3
    s_cbranch_scc0 L_tail_go
    s_endpgm
L_tail_go:
    v_lshrrev_b32 v7, 6, v0
    s_cmp_eq_u32 s98, 0
    s_cbranch_scc1 L_tail_c
    s_cmp_eq_u32 s98, 1
    s_cbranch_scc1 L_tail_d
    s_cmp_lg_u32 s53, 0
    s_cbranch_scc1 L_gate_done
    s_lshl_b32 s44, s2, 7
    s_add_u32 s44, s44, 458752
    v_mov_b32 v122, 0
    s_mov_b32 s45, 0
    buffer_load_dword v123, v122, s[32:35], s44 offen sc0 sc1
L_gate_3:
    s_sleep 6
    buffer_load_dword v124, v122, s[32:35], s44 offen sc0 sc1
    s_waitcnt vmcnt(1)
    v_cmp_ne_u32 vcc, 1, v123
    s_cbranch_vccz L_gate_3_ok
    s_sleep 6
    buffer_load_dword v123, v122, s[32:35], s44 offen sc0 sc1
    s_waitcnt vmcnt(1)
    v_cmp_ne_u32 vcc, 1, v124
    s_add_u32 s45, s45, 1
    s_cbranch_vccz L_gate_3_ok
    s_cmp_lt_u32 s45, 0x20000
    s_cbranch_scc1 L_gate_3
L_gate_3_ok:
L_gate_done:
    s_cmp_eq_u32 s98, 1
    s_cbranch_scc1 L_tail_d
    s_branch L_tail_e
L_tail_c:
    v_mov_b32 v12, v0
    v_mul_u32_u24 v13, 43691, v12
    v_lshrrev_b32 v13, 24, v13
    v_mul_u32_u24 v14, 384, v13
    v_sub_u32 v12, v12, v14
    v_mul_u32_u24 v14, 43691, v12
    v_lshrrev_b32 v14, 22, v14
    v_mul_u32_u24 v40, 98304, v13
    v_mul_u32_u24 v15, 1536, v14
    v_add_u32 v40, v40, v15
    v_lshl_add_u32 v40, v12, 4, v40
    v_mul_u32_u24 v46, 3136, v13
    v_lshl_add_u32 v46, v12, 2, v46
    v_and_b32 v12, 511, v0
    v_add_u32 v12, 1024, v12
    v_mul_u32_u24 v13, 43691, v12
    v_lshrrev_b32 v13, 24, v13
    v_mul_u32_u24 v14, 384, v13
    v_sub_u32 v12, v12, v14
    v_mul_u32_u24 v14, 43691, v12
    v_lshrrev_b32 v14, 22, v14
    v_mul_u32_u24 v41, 98304, v13
    v_mul_u32_u24 v15, 1536, v14
    v_add_u32 v41, v41, v15
    v_lshl_add_u32 v41, v12, 4, v41
    v_mul_u32_u24 v47, 3136, v13
    v_lshl_add_u32 v47, v12, 2, v47
    v_and_b32 v12, 3, v6
    v_mul_u32_u24 v8, 3136, v12
    v_lshlrev_b32 v9, 3, v12
    v_lshrrev_b32 v12, 4, v6
    v_lshl_add_u32 v8, v12, 4, v8
    v_mul_u32_u24 v12, 1024, v12
    v_add_u32 v9, v9, v12
    v_bfe_u32 v12, v6, 2, 2
    v_mul_u32_u24 v12, 128, v12
    v_add_u32 v9, v9, v12
    s_mul_i32 s46, s54, 12288
    s_add_u32 s46, s46, 1048576
    s_cmp_lg_u32 s53, 0
    s_cbranch_scc1 L_c_f
    v_mov_b32 v12, 4
    s_mov_b32 s45, 0
L_c_clr:
    buffer_load_dword v13, v12, s[36:39], 0 offen sc0 sc1
    s_waitcnt vmcnt(0)
    v_cmp_gt_u32 vcc, 256, v13
    s_add_u32 s45, s45, 1
    s_cbranch_vccz L_c_clr_ok
    s_cmp_ge_u32 s45, 0x20000
    s_cbranch_scc1 L_c_clr_ok
    s_sleep 8
    s_branch L_c_clr
L_c_clr_ok:
    s_lshl_b32 s44, s2, 7
    s_add_u32 s44, s44, 458752
    v_mov_b32 v12, 0
    s_mov_b32 s45, 0
L_c_fl:
    buffer_load_dwordx2 v[14:15], v12, s[32:35], s44 offen sc0 sc1
    s_waitcnt vmcnt(0)
    v_min_u32 v14, v14, v15
    v_cmp_ne_u32 vcc, 1, v14
    s_add_u32 s45, s45, 1
    s_cbranch_vccz L_c_f
    s_cmp_ge_u32 s45, 0x20000
    s_cbranch_scc1 L_c_f
    s_sleep 6
    s_branch L_c_fl
L_c_f:
    s_waitcnt vmcnt(0)
    s_barrier
    s_lshr_b32 s48, s53, 2
    s_and_b32 s49, s53, 3
    s_mul_i32 s50, s48, 24576
    s_lshl_b32 s49, s49, 5
    s_add_u32 s50, s50, s49
    s_add_u32 s50, s50, 42496
    v_add_u32 v13, s50, v9
    ds_read_b64_tr_b16 v[80:81], v13 offset:0
    ds_read_b64_tr_b16 v[82:83], v13 offset:512
    ds_read_b64_tr_b16 v[84:85], v13 offset:4096
    ds_read_b64_tr_b16 v[86:87], v13 offset:4608
    ds_read_b64_tr_b16 v[88:89], v13 offset:8192
    ds_read_b64_tr_b16 v[90:91], v13 offset:8704
    ds_read_b64_tr_b16 v[92:93], v13 offset:12288
    ds_read_b64_tr_b16 v[94:95], v13 offset:12800
    ds_read_b64_tr_b16 v[112:113], v13 offset:16384
    ds_read_b64_tr_b16 v[114:115], v13 offset:16896
    ds_read_b64_tr_b16 v[116:117], v13 offset:20480
    ds_read_b64_tr_b16 v[118:119], v13 offset:20992
    s_mov_b32 s45, 0
    buffer_load_dwordx4 v[64:67], v40, s[32:35], s46 offen offset:0 sc0 sc1
    buffer_load_dwordx4 v[68:71], v40, s[32:35], s46 offen offset:1536 sc0 sc1
    buffer_load_dwordx4 v[72:75], v41, s[32:35], s46 offen offset:0 sc0 sc1
    buffer_load_dwordx4 v[76:79], v41, s[32:35], s46 offen offset:1536 sc0 sc1
    s_sleep 10
L_pl_4:
    buffer_load_dwordx4 v[96:99], v40, s[32:35], s46 offen offset:0 sc0 sc1
    buffer_load_dwordx4 v[100:103], v40, s[32:35], s46 offen offset:1536 sc0 sc1
    buffer_load_dwordx4 v[104:107], v41, s[32:35], s46 offen offset:0 sc0 sc1
    buffer_load_dwordx4 v[108:111], v41, s[32:35], s46 offen offset:1536 sc0 sc1
    s_waitcnt vmcnt(4)
    v_max_u32 v14, v64, v65
    v_max3_u32 v14, v14, v66, v67
    v_max3_u32 v14, v14, v68, v69
    v_max3_u32 v14, v14, v70, v71
    v_max3_u32 v14, v14, v72, v73
    v_max3_u32 v14, v14, v74, v75
    v_max3_u32 v14, v14, v76, v77
    v_max3_u32 v14, v14, v78, v79
    v_cmp_eq_u32 vcc, -1, v14
    s_cbranch_vccz L_pl_4_a
    buffer_load_dwordx4 v[64:67], v40, s[32:35], s46 offen offset:0 sc0 sc1
    buffer_load_dwordx4 v[68:71], v40, s[32:35], s46 offen offset:1536 sc0 sc1
    buffer_load_dwordx4 v[72:75], v41, s[32:35], s46 offen offset:0 sc0 sc1
    buffer_load_dwordx4 v[76:79], v41, s[32:35], s46 offen offset:1536 sc0 sc1
    s_waitcnt vmcnt(4)
    v_max_u32 v14, v96, v97
    v_max3_u32 v14, v14, v98, v99
    v_max3_u32 v14, v14, v100, v101
    v_max3_u32 v14, v14, v102, v103
    v_max3_u32 v14, v14, v104, v105
    v_max3_u32 v14, v14, v106, v107
    v_max3_u32 v14, v14, v108, v109
    v_max3_u32 v14, v14, v110, v111
    v_cmp_eq_u32 vcc, -1, v14
    s_cbranch_vccz L_pl_4_b
    s_add_u32 s45, s45, 1
    s_cmp_lt_u32 s45, 0x20000
    s_cbranch_scc1 L_pl_4
L_pl_4_b:
    v_mov_b32 v16, v96
    v_mov_b32 v17, v97
    v_mov_b32 v18, v98
    v_mov_b32 v19, v99
    v_mov_b32 v20, v100
    v_mov_b32 v21, v101
    v_mov_b32 v22, v102
    v_mov_b32 v23, v103
    v_mov_b32 v24, v104
    v_mov_b32 v25, v105
    v_mov_b32 v26, v106
    v_mov_b32 v27, v107
    v_mov_b32 v28, v108
    v_mov_b32 v29, v109
    v_mov_b32 v30, v110
    v_mov_b32 v31, v111
    s_branch L_pl_4_e
L_pl_4_a:
    v_mov_b32 v16, v64
    v_mov_b32 v17, v65
    v_mov_b32 v18, v66
    v_mov_b32 v19, v67
    v_mov_b32 v20, v68
    v_mov_b32 v21, v69
    v_mov_b32 v22, v70
    v_mov_b32 v23, v71
    v_mov_b32 v24, v72
    v_mov_b32 v25, v73
    v_mov_b32 v26, v74
    v_mov_b32 v27, v75
    v_mov_b32 v28, v76
    v_mov_b32 v29, v77
    v_mov_b32 v30, v78
    v_mov_b32 v31, v79
L_pl_4_e:
    v_max_f32 v12, v18, v22
    v_sub_f32 v13, v18, v12
    v_sub_f32 v14, v22, v12
    v_mul_f32 v13, 0x3fb8aa3b, v13
    v_mul_f32 v14, 0x3fb8aa3b, v14
    v_exp_f32 v13, v13
    v_exp_f32 v14, v14
    s_nop 0
    v_mul_f32 v15, v13, v19
    v_fmac_f32 v15, v14, v23
    v_rcp_f32 v15, v15
    s_nop 0
    v_mul_f32 v13, v13, v15
    v_mul_f32 v14, v14, v15
    v_mul_f32 v12, v13, v16
    v_mul_f32 v15, v13, v17
    v_fmac_f32 v12, v14, v20
    v_fmac_f32 v15, v14, v21
    v_cvt_pk_bf16_f32 v12, v12, v15
    ds_write_b32 v46, v12 offset:29952
    v_max_f32 v12, v26, v30
    v_sub_f32 v13, v26, v12
    v_sub_f32 v14, v30, v12
    v_mul_f32 v13, 0x3fb8aa3b, v13
    v_mul_f32 v14, 0x3fb8aa3b, v14
    v_exp_f32 v13, v13
    v_exp_f32 v14, v14
    s_nop 0
    v_mul_f32 v15, v13, v27
    v_fmac_f32 v15, v14, v31
    v_rcp_f32 v15, v15
    s_nop 0
    v_mul_f32 v13, v13, v15
    v_mul_f32 v14, v14, v15
    v_mul_f32 v12, v13, v24
    v_mul_f32 v15, v13, v25
    v_fmac_f32 v12, v14, v28
    v_fmac_f32 v15, v14, v29
    v_cvt_pk_bf16_f32 v12, v12, v15
    ds_write_b32 v47, v12 offset:29952
    s_waitcnt lgkmcnt(0)
    s_barrier
    s_lshr_b32 s48, s53, 2
    s_mul_i32 s50, s48, 384
    s_add_u32 s50, s50, 29952
    v_add_u32 v12, s50, v8
    ds_read_b128 v[16:19], v12 offset:0
    ds_read_b128 v[20:23], v12 offset:64
    ds_read_b128 v[24:27], v12 offset:128
    ds_read_b128 v[28:31], v12 offset:192
    ds_read_b128 v[32:35], v12 offset:256
    ds_read_b128 v[36:39], v12 offset:320
    s_waitcnt lgkmcnt(5)
    v_mfma_f32_16x16x32_bf16 v[48:51], v[16:19], v[80:83], 0
    s_waitcnt lgkmcnt(4)
    v_mfma_f32_16x16x32_bf16 v[48:51], v[20:23], v[84:87], v[48:51]
    s_waitcnt lgkmcnt(3)
    v_mfma_f32_16x16x32_bf16 v[48:51], v[24:27], v[88:91], v[48:51]
    s_waitcnt lgkmcnt(2)
    v_mfma_f32_16x16x32_bf16 v[48:51], v[28:31], v[92:95], v[48:51]
    s_waitcnt lgkmcnt(1)
    v_mfma_f32_16x16x32_bf16 v[48:51], v[32:35], v[112:115], v[48:51]
    s_waitcnt lgkmcnt(0)
    v_mfma_f32_16x16x32_bf16 v[48:51], v[36:39], v[116:119], v[48:51]
    s_nop 15
    s_lshr_b32 s48, s53, 2
    s_and_b32 s49, s53, 3
    s_mul_i32 s48, s48, 1024
    s_lshl_b32 s49, s49, 6
    s_add_u32 s48, s48, s49
    v_lshlrev_b32 v12, 2, v6
    v_add_u32 v12, s48, v12
    s_mov_b64 exec, 0xffff
    ds_write_b32 v12, v48 offset:13824
    ds_write_b32 v12, v49 offset:14080
    ds_write_b32 v12, v50 offset:14336
    ds_write_b32 v12, v51 offset:14592
    s_mov_b64 exec, -1
    s_waitcnt lgkmcnt(0)
    s_barrier
    s_cmp_ge_u32 s53, 4
    s_cbranch_scc1 L_c_pub_done
    v_lshlrev_b32 v12, 2, v0
    ds_read_b32 v16, v12 offset:13824
    ds_read_b32 v17, v12 offset:14848
    ds_read_b32 v18, v12 offset:15872
    ds_read_b32 v19, v12 offset:16896
    s_waitcnt lgkmcnt(0)
    v_add_f32 v16, v16, v17
    v_add_f32 v18, v18, v19
    v_add_f32 v16, v16, v18
    v_mul_u32_u24 v12, 2560, v7
    v_lshl_add_u32 v12, v6, 2, v12
    s_mul_i32 s48, s54, 10240
    s_lshl_b32 s49, s55, 8
    s_add_u32 s48, s48, s49
    s_add_u32 s48, s48, 262144
    buffer_store_dword v16, v12, s[32:35], s48 offen sc0 sc1
L_c_pub_done:
    s_endpgm
L_tail_e:
    v_and_b32 v12, 3, v6
    v_mul_u32_u24 v8, 3136, v12
    v_lshlrev_b32 v9, 3, v12
    v_lshrrev_b32 v12, 4, v6
    v_lshl_add_u32 v8, v12, 4, v8
    v_mul_u32_u24 v12, 512, v12
    v_add_u32 v9, v9, v12
    v_bfe_u32 v12, v6, 2, 2
    v_mul_u32_u24 v12, 64, v12
    v_add_u32 v9, v9, v12
    s_barrier
    v_min_u32 v57, 39, v6
    s_lshr_b32 s48, s53, 2
    s_mul_i32 s48, s48, 40
    v_add_u32 v57, s48, v57
    v_cmp_gt_u32 vcc, 40, v6
    s_nop 1
    v_cndmask_b32_e64 v56, 0, 1.0, vcc
    s_and_b32 s49, s53, 3
    s_mul_i32 s50, s49, 1280
    v_lshlrev_b32 v58, 3, v57
    buffer_load_dwordx2 v[48:49], v58, s[56:59], s50 offen
    buffer_load_dwordx2 v[50:51], v58, s[72:75], 0 offen
    s_mul_i32 s51, s49, 1344
    v_add_u32 v62, s51, v58
    v_lshlrev_b32 v59, 4, v57
    s_mul_i32 s50, s49, 2560
    s_add_u32 s50, s50, 262144
    s_mov_b32 s45, 0
    s_mov_b32 s44, s50
    buffer_load_dwordx4 v[64:67], v59, s[32:35], s44 offen sc0 sc1
    s_add_u32 s44, s44, 10240
    buffer_load_dwordx4 v[68:71], v59, s[32:35], s44 offen sc0 sc1
    s_add_u32 s44, s44, 10240
    buffer_load_dwordx4 v[72:75], v59, s[32:35], s44 offen sc0 sc1
    s_add_u32 s44, s44, 10240
    buffer_load_dwordx4 v[76:79], v59, s[32:35], s44 offen sc0 sc1
    s_add_u32 s44, s44, 10240
    buffer_load_dwordx4 v[80:83], v59, s[32:35], s44 offen sc0 sc1
    s_add_u32 s44, s44, 10240
    buffer_load_dwordx4 v[84:87], v59, s[32:35], s44 offen sc0 sc1
    s_add_u32 s44, s44, 10240
    buffer_load_dwordx4 v[88:91], v59, s[32:35], s44 offen sc0 sc1
    s_add_u32 s44, s44, 10240
    buffer_load_dwordx4 v[92:95], v59, s[32:35], s44 offen sc0 sc1
    s_sleep 10
L_pl_5:
    s_mov_b32 s44, s50
    buffer_load_dwordx4 v[96:99], v59, s[32:35], s44 offen sc0 sc1
    s_add_u32 s44, s44, 10240
    buffer_load_dwordx4 v[100:103], v59, s[32:35], s44 offen sc0 sc1
    s_add_u32 s44, s44, 10240
    buffer_load_dwordx4 v[104:107], v59, s[32:35], s44 offen sc0 sc1
    s_add_u32 s44, s44, 10240
    buffer_load_dwordx4 v[108:111], v59, s[32:35], s44 offen sc0 sc1
    s_add_u32 s44, s44, 10240
    buffer_load_dwordx4 v[112:115], v59, s[32:35], s44 offen sc0 sc1
    s_add_u32 s44, s44, 10240
    buffer_load_dwordx4 v[116:119], v59, s[32:35], s44 offen sc0 sc1
    s_add_u32 s44, s44, 10240
    buffer_load_dwordx4 v[120:123], v59, s[32:35], s44 offen sc0 sc1
    s_add_u32 s44, s44, 10240
    buffer_load_dwordx4 v[124:127], v59, s[32:35], s44 offen sc0 sc1
    s_waitcnt vmcnt(8)
    v_max_u32 v60, v64, v65
    v_max3_u32 v60, v60, v66, v67
    v_max3_u32 v60, v60, v68, v69
    v_max3_u32 v60, v60, v70, v71
    v_max3_u32 v60, v60, v72, v73
    v_max3_u32 v60, v60, v74, v75
    v_max3_u32 v60, v60, v76, v77
    v_max3_u32 v60, v60, v78, v79
    v_max3_u32 v60, v60, v80, v81
    v_max3_u32 v60, v60, v82, v83
    v_max3_u32 v60, v60, v84, v85
    v_max3_u32 v60, v60, v86, v87
    v_max3_u32 v60, v60, v88, v89
    v_max3_u32 v60, v60, v90, v91
    v_max3_u32 v60, v60, v92, v93
    v_max3_u32 v60, v60, v94, v95
    v_cmp_eq_u32 vcc, -1, v60
    s_cbranch_vccz L_pl_5_a
    s_mov_b32 s44, s50
    buffer_load_dwordx4 v[64:67], v59, s[32:35], s44 offen sc0 sc1
    s_add_u32 s44, s44, 10240
    buffer_load_dwordx4 v[68:71], v59, s[32:35], s44 offen sc0 sc1
    s_add_u32 s44, s44, 10240
    buffer_load_dwordx4 v[72:75], v59, s[32:35], s44 offen sc0 sc1
    s_add_u32 s44, s44, 10240
    buffer_load_dwordx4 v[76:79], v59, s[32:35], s44 offen sc0 sc1
    s_add_u32 s44, s44, 10240
    buffer_load_dwordx4 v[80:83], v59, s[32:35], s44 offen sc0 sc1
    s_add_u32 s44, s44, 10240
    buffer_load_dwordx4 v[84:87], v59, s[32:35], s44 offen sc0 sc1
    s_add_u32 s44, s44, 10240
    buffer_load_dwordx4 v[88:91], v59, s[32:35], s44 offen sc0 sc1
    s_add_u32 s44, s44, 10240
    buffer_load_dwordx4 v[92:95], v59, s[32:35], s44 offen sc0 sc1
    s_waitcnt vmcnt(8)
    v_max_u32 v60, v96, v97
    v_max3_u32 v60, v60, v98, v99
    v_max3_u32 v60, v60, v100, v101
    v_max3_u32 v60, v60, v102, v103
    v_max3_u32 v60, v60, v104, v105
    v_max3_u32 v60, v60, v106, v107
    v_max3_u32 v60, v60, v108, v109
    v_max3_u32 v60, v60, v110, v111
    v_max3_u32 v60, v60, v112, v113
    v_max3_u32 v60, v60, v114, v115
    v_max3_u32 v60, v60, v116, v117
    v_max3_u32 v60, v60, v118, v119
    v_max3_u32 v60, v60, v120, v121
    v_max3_u32 v60, v60, v122, v123
    v_max3_u32 v60, v60, v124, v125
    v_max3_u32 v60, v60, v126, v127
    v_cmp_eq_u32 vcc, -1, v60
    s_cbranch_vccz L_pl_5_b
    s_add_u32 s45, s45, 1
    s_cmp_lt_u32 s45, 0x20000
    s_cbranch_scc1 L_pl_5
L_pl_5_b:
    v_mov_b32 v16, v96
    v_mov_b32 v17, v97
    v_mov_b32 v18, v98
    v_mov_b32 v19, v99
    v_mov_b32 v20, v100
    v_mov_b32 v21, v101
    v_mov_b32 v22, v102
    v_mov_b32 v23, v103
    v_mov_b32 v24, v104
    v_mov_b32 v25, v105
    v_mov_b32 v26, v106
    v_mov_b32 v27, v107
    v_mov_b32 v28, v108
    v_mov_b32 v29, v109
    v_mov_b32 v30, v110
    v_mov_b32 v31, v111
    v_mov_b32 v32, v112
    v_mov_b32 v33, v113
    v_mov_b32 v34, v114
    v_mov_b32 v35, v115
    v_mov_b32 v36, v116
    v_mov_b32 v37, v117
    v_mov_b32 v38, v118
    v_mov_b32 v39, v119
    v_mov_b32 v40, v120
    v_mov_b32 v41, v121
    v_mov_b32 v42, v122
    v_mov_b32 v43, v123
    v_mov_b32 v44, v124
    v_mov_b32 v45, v125
    v_mov_b32 v46, v126
    v_mov_b32 v47, v127
    s_branch L_pl_5_e
L_pl_5_a:
    v_mov_b32 v16, v64
    v_mov_b32 v17, v65
    v_mov_b32 v18, v66
    v_mov_b32 v19, v67
    v_mov_b32 v20, v68
    v_mov_b32 v21, v69
    v_mov_b32 v22, v70
    v_mov_b32 v23, v71
    v_mov_b32 v24, v72
    v_mov_b32 v25, v73
    v_mov_b32 v26, v74
    v_mov_b32 v27, v75
    v_mov_b32 v28, v76
    v_mov_b32 v29, v77
    v_mov_b32 v30, v78
    v_mov_b32 v31, v79
    v_mov_b32 v32, v80
    v_mov_b32 v33, v81
    v_mov_b32 v34, v82
    v_mov_b32 v35, v83
    v_mov_b32 v36, v84
    v_mov_b32 v37, v85
    v_mov_b32 v38, v86
    v_mov_b32 v39, v87
    v_mov_b32 v40, v88
    v_mov_b32 v41, v89
    v_mov_b32 v42, v90
    v_mov_b32 v43, v91
    v_mov_b32 v44, v92
    v_mov_b32 v45, v93
    v_mov_b32 v46, v94
    v_mov_b32 v47, v95
L_pl_5_e:
    v_add_f32 v16, v16, v32
    v_add_f32 v20, v20, v36
    v_add_f32 v24, v24, v40
    v_add_f32 v28, v28, v44
    v_add_f32 v52, v16, v20
    v_add_f32 v60, v24, v28
    v_add_f32 v52, v52, v60
    v_cvt_pk_bf16_f32 v52, v52, v52
    v_lshlrev_b32 v52, 16, v52
    v_add_f32 v17, v17, v33
    v_add_f32 v21, v21, v37
    v_add_f32 v25, v25, v41
    v_add_f32 v29, v29, v45
    v_add_f32 v53, v17, v21
    v_add_f32 v60, v25, v29
    v_add_f32 v53, v53, v60
    v_cvt_pk_bf16_f32 v53, v53, v53
    v_lshlrev_b32 v53, 16, v53
    v_add_f32 v18, v18, v34
    v_add_f32 v22, v22, v38
    v_add_f32 v26, v26, v42
    v_add_f32 v30, v30, v46
    v_add_f32 v54, v18, v22
    v_add_f32 v60, v26, v30
    v_add_f32 v54, v54, v60
    v_cvt_pk_bf16_f32 v54, v54, v54
    v_lshlrev_b32 v54, 16, v54
    v_add_f32 v19, v19, v35
    v_add_f32 v23, v23, v39
    v_add_f32 v27, v27, v43
    v_add_f32 v31, v31, v47
    v_add_f32 v55, v19, v23
    v_add_f32 v60, v27, v31
    v_add_f32 v55, v55, v60
    v_cvt_pk_bf16_f32 v55, v55, v55
    v_lshlrev_b32 v55, 16, v55
    v_lshlrev_b32 v58, 16, v48
    v_and_b32 v59, 0xffff0000, v48
    v_lshlrev_b32 v60, 16, v49
    v_and_b32 v61, 0xffff0000, v49
    v_add_f32 v52, v52, v58
    v_cvt_pk_bf16_f32 v52, v52, v52
    v_lshlrev_b32 v52, 16, v52
    v_add_f32 v53, v53, v59
    v_cvt_pk_bf16_f32 v53, v53, v53
    v_lshlrev_b32 v53, 16, v53
    v_add_f32 v54, v54, v60
    v_cvt_pk_bf16_f32 v54, v54, v54
    v_lshlrev_b32 v54, 16, v54
    v_add_f32 v55, v55, v61
    v_cvt_pk_bf16_f32 v55, v55, v55
    v_lshlrev_b32 v55, 16, v55
    v_add_f32 v58, v52, v53
    v_add_f32 v59, v54, v55
    v_add_f32 v58, v58, v59
    v_mul_f32 v58, v58, v56
    s_nop 1
    v_add_f32_dpp v58, v58, v58 quad_perm:[1,0,3,2] row_mask:0xf bank_mask:0xf
    s_nop 1
    v_add_f32_dpp v58, v58, v58 quad_perm:[2,3,0,1] row_mask:0xf bank_mask:0xf
    s_nop 1
    v_add_f32_dpp v58, v58, v58 row_half_mirror row_mask:0xf bank_mask:0xf
    s_nop 1
    v_add_f32_dpp v58, v58, v58 row_mirror row_mask:0xf bank_mask:0xf
    s_nop 1
    v_readlane_b32 s48, v58, 0
    v_readlane_b32 s49, v58, 16
    v_readlane_b32 s50, v58, 32
    v_readlane_b32 s51, v58, 48
    s_nop 1
    v_mov_b32 v58, s48
    v_add_f32 v58, s49, v58
    v_add_f32 v58, s50, v58
    v_add_f32 v58, s51, v58
    v_mul_f32 v58, 0x3bcccccd, v58
    v_sub_f32 v60, v52, v58
    v_mul_f32 v59, v60, v60
    v_sub_f32 v60, v53, v58
    v_fmac_f32 v59, v60, v60
    v_sub_f32 v60, v54, v58
    v_fmac_f32 v59, v60, v60
    v_sub_f32 v60, v55, v58
    v_fmac_f32 v59, v60, v60
    v_mul_f32 v59, v59, v56
    s_nop 1
    v_add_f32_dpp v59, v59, v59 quad_perm:[1,0,3,2] row_mask:0xf bank_mask:0xf
    s_nop 1
    v_add_f32_dpp v59, v59, v59 quad_perm:[2,3,0,1] row_mask:0xf bank_mask:0xf
    s_nop 1
    v_add_f32_dpp v59, v59, v59 row_half_mirror row_mask:0xf bank_mask:0xf
    s_nop 1
    v_add_f32_dpp v59, v59, v59 row_mirror row_mask:0xf bank_mask:0xf
    s_nop 1
    v_readlane_b32 s48, v59, 0
    v_readlane_b32 s49, v59, 16
    v_readlane_b32 s50, v59, 32
    v_readlane_b32 s51, v59, 48
    s_nop 1
    v_mov_b32 v59, s48
    v_add_f32 v59, s49, v59
    v_add_f32 v59, s50, v59
    v_add_f32 v59, s51, v59
    s_lshl_b32 s49, s53, 5
    s_and_b32 s49, s49, 96
    s_and_b32 s50, s53, 12
    s_lshl_b32 s50, s50, 1
    s_add_u32 s50, s50, s49
    v_mov_b32 v60, s50
    v_mov_b32 v61, s49
    ds_write_b64 v60, v[58:59] offset:29696
    s_waitcnt lgkmcnt(0)
    s_barrier
    ds_read_b128 v[16:19], v61 offset:29696
    ds_read_b128 v[20:23], v61 offset:29712
    s_waitcnt lgkmcnt(0)
    v_add_f32 v24, v16, v18
    v_add_f32 v25, v20, v22
    v_add_f32 v24, v24, v25
    v_mul_f32 v24, 0.25, v24
    v_add_f32 v25, v17, v19
    v_add_f32 v26, v21, v23
    v_add_f32 v25, v25, v26
    v_sub_f32 v16, v16, v24
    v_sub_f32 v18, v18, v24
    v_sub_f32 v20, v20, v24
    v_sub_f32 v22, v22, v24
    v_mul_f32 v26, v16, v16
    v_fmac_f32 v26, v18, v18
    v_fmac_f32 v26, v20, v20
    v_fmac_f32 v26, v22, v22
    v_mov_b32 v27, 0x43200000
    v_fmac_f32 v25, v26, v27
    v_mul_f32 v25, 0x3acccccd, v25
    v_cvt_pk_bf16_f32 v24, v24, v24
    v_lshlrev_b32 v24, 16, v24
    v_cvt_pk_bf16_f32 v25, v25, v25
    v_lshlrev_b32 v25, 16, v25
    v_add_f32 v25, 0x3727c5ac, v25
    v_cvt_pk_bf16_f32 v25, v25, v25
    v_lshlrev_b32 v25, 16, v25
    v_sqrt_f32 v25, v25
    s_nop 0
    v_cvt_pk_bf16_f32 v25, v25, v25
    v_lshlrev_b32 v25, 16, v25
    v_rcp_f32 v25, v25
    s_nop 0
    v_sub_f32 v28, v52, v24
    v_cvt_pk_bf16_f32 v28, v28, v28
    v_lshlrev_b32 v28, 16, v28
    v_mul_f32 v28, v28, v25
    v_cvt_pk_bf16_f32 v28, v28, v28
    v_lshlrev_b32 v28, 16, v28
    v_sub_f32 v29, v53, v24
    v_cvt_pk_bf16_f32 v29, v29, v29
    v_lshlrev_b32 v29, 16, v29
    v_mul_f32 v29, v29, v25
    v_cvt_pk_bf16_f32 v29, v29, v29
    v_lshlrev_b32 v29, 16, v29
    v_sub_f32 v30, v54, v24
    v_cvt_pk_bf16_f32 v30, v30, v30
    v_lshlrev_b32 v30, 16, v30
    v_mul_f32 v30, v30, v25
    v_cvt_pk_bf16_f32 v30, v30, v30
    v_lshlrev_b32 v30, 16, v30
    v_sub_f32 v31, v55, v24
    v_cvt_pk_bf16_f32 v31, v31, v31
    v_lshlrev_b32 v31, 16, v31
    v_mul_f32 v31, v31, v25
    v_cvt_pk_bf16_f32 v31, v31, v31
    v_lshlrev_b32 v31, 16, v31
    v_cvt_pk_bf16_f32 v32, v28, v29
    v_cvt_pk_bf16_f32 v33, v30, v31
    v_cvt_pk_bf16_f32 v34, v52, v53
    v_cvt_pk_bf16_f32 v35, v54, v55
    v_lshlrev_b32 v58, 16, v50
    v_and_b32 v59, 0xffff0000, v50
    v_mul_f32 v36, v28, v58
    v_fmac_f32 v36, v29, v59
    v_lshlrev_b32 v58, 16, v51
    v_and_b32 v59, 0xffff0000, v51
    v_fmac_f32 v36, v30, v58
    v_fmac_f32 v36, v31, v59
    v_mul_f32 v36, v36, v56
    s_nop 1
    v_add_f32_dpp v36, v36, v36 quad_perm:[1,0,3,2] row_mask:0xf bank_mask:0xf
    s_nop 1
    v_add_f32_dpp v36, v36, v36 quad_perm:[2,3,0,1] row_mask:0xf bank_mask:0xf
    s_nop 1
    v_add_f32_dpp v36, v36, v36 row_half_mirror row_mask:0xf bank_mask:0xf
    s_nop 1
    v_add_f32_dpp v36, v36, v36 row_mirror row_mask:0xf bank_mask:0xf
    s_nop 1
    v_readlane_b32 s48, v36, 0
    v_readlane_b32 s49, v36, 16
    v_readlane_b32 s50, v36, 32
    v_readlane_b32 s51, v36, 48
    s_nop 1
    v_mov_b32 v36, s48
    v_add_f32 v36, s49, v36
    v_add_f32 v36, s50, v36
    v_add_f32 v36, s51, v36
    v_lshrrev_b32 v60, 1, v60
    ds_write_b32 v60, v36 offset:29824
    s_mov_b32 exec_lo, -1
    s_mov_b32 exec_hi, 0xff
    ds_write_b64 v62, v[32:33] offset:18944
    ds_write_b64 v62, v[34:35] offset:24320
    s_mov_b64 exec, -1
    s_waitcnt vmcnt(0)
    s_lshr_b32 s48, s53, 1
    s_and_b32 s49, s53, 1
    s_mul_i32 s50, s48, 12288
    s_lshl_b32 s49, s49, 5
    s_add_u32 s50, s50, s49
    s_add_u32 s50, s50, 42496
    v_add_u32 v13, s50, v9
    ds_read_b64_tr_b16 v[40:41], v13 offset:0
    ds_read_b64_tr_b16 v[42:43], v13 offset:256
    ds_read_b64_tr_b16 v[44:45], v13 offset:2048
    ds_read_b64_tr_b16 v[46:47], v13 offset:2304
    ds_read_b64_tr_b16 v[48:49], v13 offset:4096
    ds_read_b64_tr_b16 v[50:51], v13 offset:4352
    ds_read_b64_tr_b16 v[52:53], v13 offset:6144
    ds_read_b64_tr_b16 v[54:55], v13 offset:6400
    ds_read_b64_tr_b16 v[56:57], v13 offset:8192
    ds_read_b64_tr_b16 v[58:59], v13 offset:8448
    ds_read_b64_tr_b16 v[60:61], v13 offset:10240
    ds_read_b64_tr_b16 v[62:63], v13 offset:10496
    s_cmp_lt_u32 s53, 4
    s_cbranch_scc1 L_e_wait
L_e_act:
    v_subrev_u32 v15, 256, v0
    v_lshlrev_b32 v12, 4, v15
    v_mul_u32_u24 v13, 43691, v15
    v_lshrrev_b32 v13, 23, v13
    v_mul_u32_u24 v14, 64, v13
    v_add_u32 v14, v14, v12
    s_mov_b32 s45, 0
    s_mov_b32 s46, 360448
    buffer_load_dwordx4 v[80:83], v12, s[32:35], s46 offen sc0 sc1
    s_mov_b32 s46, 376832
    buffer_load_dwordx4 v[84:87], v12, s[32:35], s46 offen sc0 sc1
    s_sleep 10
L_pl_6:
    s_mov_b32 s46, 360448
    buffer_load_dwordx4 v[96:99], v12, s[32:35], s46 offen sc0 sc1
    s_mov_b32 s46, 376832
    buffer_load_dwordx4 v[100:103], v12, s[32:35], s46 offen sc0 sc1
    s_waitcnt vmcnt(2)
    v_max_u32 v15, v80, v81
    v_max3_u32 v15, v15, v82, v83
    v_max3_u32 v15, v15, v84, v85
    v_max3_u32 v15, v15, v86, v87
    v_cmp_eq_u32 vcc, -1, v15
    s_cbranch_vccz L_pl_6_a
    s_mov_b32 s46, 360448
    buffer_load_dwordx4 v[80:83], v12, s[32:35], s46 offen sc0 sc1
    s_mov_b32 s46, 376832
    buffer_load_dwordx4 v[84:87], v12, s[32:35], s46 offen sc0 sc1
    s_waitcnt vmcnt(2)
    v_max_u32 v15, v96, v97
    v_max3_u32 v15, v15, v98, v99
    v_max3_u32 v15, v15, v100, v101
    v_max3_u32 v15, v15, v102, v103
    v_cmp_eq_u32 vcc, -1, v15
    s_cbranch_vccz L_pl_6_b
    s_add_u32 s45, s45, 1
    s_cmp_lt_u32 s45, 0x20000
    s_cbranch_scc1 L_pl_6
L_pl_6_b:
    v_mov_b32 v16, v96
    v_mov_b32 v17, v97
    v_mov_b32 v18, v98
    v_mov_b32 v19, v99
    v_mov_b32 v20, v100
    v_mov_b32 v21, v101
    v_mov_b32 v22, v102
    v_mov_b32 v23, v103
    s_branch L_pl_6_e
L_pl_6_a:
    v_mov_b32 v16, v80
    v_mov_b32 v17, v81
    v_mov_b32 v18, v82
    v_mov_b32 v19, v83
    v_mov_b32 v20, v84
    v_mov_b32 v21, v85
    v_mov_b32 v22, v86
    v_mov_b32 v23, v87
L_pl_6_e:
    v_lshlrev_b32 v24, 16, v16
    v_and_b32 v25, 0xffff0000, v16
    v_lshlrev_b32 v26, 16, v20
    v_and_b32 v27, 0xffff0000, v20
    v_mul_f32 v24, v24, v26
    v_mul_f32 v25, v25, v27
    v_cvt_pk_bf16_f32 v32, v24, v25
    v_lshlrev_b32 v24, 16, v17
    v_and_b32 v25, 0xffff0000, v17
    v_lshlrev_b32 v26, 16, v21
    v_and_b32 v27, 0xffff0000, v21
    v_mul_f32 v24, v24, v26
    v_mul_f32 v25, v25, v27
    v_cvt_pk_bf16_f32 v33, v24, v25
    v_lshlrev_b32 v24, 16, v18
    v_and_b32 v25, 0xffff0000, v18
    v_lshlrev_b32 v26, 16, v22
    v_and_b32 v27, 0xffff0000, v22
    v_mul_f32 v24, v24, v26
    v_mul_f32 v25, v25, v27
    v_cvt_pk_bf16_f32 v34, v24, v25
    v_lshlrev_b32 v24, 16, v19
    v_and_b32 v25, 0xffff0000, v19
    v_lshlrev_b32 v26, 16, v23
    v_and_b32 v27, 0xffff0000, v23
    v_mul_f32 v24, v24, v26
    v_mul_f32 v25, v25, v27
    v_cvt_pk_bf16_f32 v35, v24, v25
    ds_write_b128 v14, v[32:35] offset:29952
L_e_wait:
    s_waitcnt lgkmcnt(0)
    s_barrier
    s_lshr_b32 s48, s53, 1
    s_mul_i32 s50, s48, 384
    s_add_u32 s50, s50, 29952
    v_add_u32 v12, s50, v8
    ds_read_b128 v[16:19], v12 offset:0
    ds_read_b128 v[20:23], v12 offset:64
    ds_read_b128 v[24:27], v12 offset:128
    ds_read_b128 v[28:31], v12 offset:192
    ds_read_b128 v[32:35], v12 offset:256
    ds_read_b128 v[36:39], v12 offset:320
    s_waitcnt lgkmcnt(5)
    v_mfma_f32_16x16x32_bf16 v[64:67], v[16:19], v[40:43], 0
    s_waitcnt lgkmcnt(4)
    v_mfma_f32_16x16x32_bf16 v[64:67], v[20:23], v[44:47], v[64:67]
    s_waitcnt lgkmcnt(3)
    v_mfma_f32_16x16x32_bf16 v[64:67], v[24:27], v[48:51], v[64:67]
    s_waitcnt lgkmcnt(2)
    v_mfma_f32_16x16x32_bf16 v[64:67], v[28:31], v[52:55], v[64:67]
    s_waitcnt lgkmcnt(1)
    v_mfma_f32_16x16x32_bf16 v[64:67], v[32:35], v[56:59], v[64:67]
    s_waitcnt lgkmcnt(0)
    v_mfma_f32_16x16x32_bf16 v[64:67], v[36:39], v[60:63], v[64:67]
    s_nop 15
    s_lshr_b32 s48, s53, 1
    s_and_b32 s49, s53, 1
    s_mul_i32 s48, s48, 512
    s_lshl_b32 s49, s49, 6
    s_add_u32 s48, s48, s49
    v_lshlrev_b32 v12, 2, v6
    v_add_u32 v12, s48, v12
    s_mov_b64 exec, 0xffff
    ds_write_b32 v12, v64 offset:13824
    ds_write_b32 v12, v65 offset:13952
    ds_write_b32 v12, v66 offset:14080
    ds_write_b32 v12, v67 offset:14208
    s_mov_b64 exec, -1
    s_waitcnt lgkmcnt(0)
    s_barrier
    s_cmp_ge_u32 s53, 2
    s_cbranch_scc1 L_done
    v_lshlrev_b32 v12, 2, v0
    ds_read_b32 v16, v12 offset:13824
    ds_read_b32 v17, v12 offset:14336
    ds_read_b32 v18, v12 offset:14848
    ds_read_b32 v19, v12 offset:15360
    ds_read_b32 v20, v12 offset:15872
    ds_read_b32 v21, v12 offset:16384
    ds_read_b32 v22, v12 offset:16896
    ds_read_b32 v23, v12 offset:17408
    v_and_b32 v13, 31, v0
    s_lshl_b32 s48, s55, 5
    v_add_u32 v13, s48, v13
    v_lshrrev_b32 v14, 5, v0
    v_mul_u32_u24 v15, 1344, v14
    v_lshl_add_u32 v15, v13, 1, v15
    v_lshlrev_b32 v12, 4, v14
    ds_read_u16 v40, v15 offset:18944
    ds_read_u16 v41, v15 offset:24320
    ds_read_b128 v[44:47], v12 offset:29824
    s_waitcnt lgkmcnt(0)
    v_add_f32 v44, v44, v45
    v_add_f32 v46, v46, v47
    v_add_f32 v42, v44, v46
    v_cvt_pk_bf16_f32 v42, v42, v42
    v_lshlrev_b32 v42, 16, v42
    v_mul_f32 v42, 0xbfb8aa3b, v42
    v_exp_f32 v42, v42
    s_nop 0
    v_add_f32 v42, 1.0, v42
    v_rcp_f32 v42, v42
    s_nop 0
    v_cvt_pk_bf16_f32 v42, v42, v42
    v_lshlrev_b32 v42, 16, v42
    v_add_f32 v16, v16, v20
    v_add_f32 v17, v17, v21
    v_add_f32 v18, v18, v22
    v_add_f32 v19, v19, v23
    v_add_f32 v16, v16, v18
    v_add_f32 v17, v17, v19
    v_add_f32 v16, v16, v17
    v_lshlrev_b32 v40, 16, v40
    v_lshlrev_b32 v41, 16, v41
    v_cvt_pk_bf16_f32 v16, v16, v16
    v_lshlrev_b32 v16, 16, v16
    v_mul_f32 v16, v16, v42
    v_cvt_pk_bf16_f32 v16, v16, v16
    v_lshlrev_b32 v16, 16, v16
    v_add_f32 v16, v40, v16
    v_cvt_pk_bf16_f32 v16, v16, v16
    v_lshlrev_b32 v16, 16, v16
    v_add_f32 v16, v41, v16
    v_cvt_pk_bf16_f32 v16, v16, v16
    v_mul_u32_u24 v14, 640, v14
    v_add_u32 v14, v14, v13
    v_lshlrev_b32 v14, 1, v14
    buffer_store_short v16, v14, s[76:79], 0 offen
    s_endpgm
L_tail_d:
    v_and_b32 v12, 15, v6
    v_min_u32 v12, 4, v12
    v_mul_u32_u24 v8, 1344, v12
    v_and_b32 v12, 3, v6
    v_lshlrev_b32 v9, 3, v12
    v_lshrrev_b32 v12, 4, v6
    v_lshl_add_u32 v8, v12, 4, v8
    v_mul_u32_u24 v12, 1024, v12
    v_add_u32 v9, v9, v12
    v_bfe_u32 v12, v6, 2, 2
    v_mul_u32_u24 v12, 128, v12
    v_add_u32 v9, v9, v12
    v_cmp_gt_u32 vcc, 320, v0
    s_and_saveexec_b64 s[100:101], vcc
    v_lshlrev_b32 v12, 2, v0
    v_mov_b32 v13, 0x3f803f80
    ds_write_b32 v12, v13 offset:24320
    s_mov_b64 exec, s[100:101]
    s_waitcnt vmcnt(0) lgkmcnt(0)
    s_barrier
    s_lshr_b32 s48, s53, 2
    s_and_b32 s49, s53, 3
    s_mul_i32 s50, s48, 20480
    s_lshl_b32 s49, s49, 5
    s_add_u32 s50, s50, s49
    s_add_u32 s50, s50, 42496
    v_add_u32 v13, s50, v9
    ds_read_b64_tr_b16 v[16:17], v13 offset:0
    ds_read_b64_tr_b16 v[18:19], v13 offset:512
    ds_read_b64_tr_b16 v[20:21], v13 offset:4096
    ds_read_b64_tr_b16 v[22:23], v13 offset:4608
    ds_read_b64_tr_b16 v[24:25], v13 offset:8192
    ds_read_b64_tr_b16 v[26:27], v13 offset:8704
    ds_read_b64_tr_b16 v[28:29], v13 offset:12288
    ds_read_b64_tr_b16 v[30:31], v13 offset:12800
    ds_read_b64_tr_b16 v[32:33], v13 offset:16384
    ds_read_b64_tr_b16 v[34:35], v13 offset:16896
    v_min_u32 v57, 39, v6
    s_lshr_b32 s48, s53, 2
    s_mul_i32 s48, s48, 40
    v_add_u32 v57, s48, v57
    v_cmp_gt_u32 vcc, 40, v6
    s_nop 1
    v_cndmask_b32_e64 v56, 0, 1.0, vcc
    s_and_b32 s49, s53, 3
    s_mul_i32 s50, s49, 1280
    v_lshlrev_b32 v58, 3, v57
    buffer_load_dwordx2 v[48:49], v58, s[56:59], s50 offen
    s_mul_i32 s51, s49, 1344
    v_add_u32 v62, s51, v58
    v_lshlrev_b32 v59, 4, v57
    s_mul_i32 s50, s49, 2560
    s_add_u32 s50, s50, 262144
    s_lshl_b32 s49, s53, 5
    s_and_b32 s49, s49, 96
    s_and_b32 s48, s53, 12
    s_lshl_b32 s48, s48, 1
    s_add_u32 s48, s48, s49
    v_mov_b32 v63, s48
    s_waitcnt vmcnt(0)
    v_and_b32 v51, 0xffff0000, v49
    v_lshlrev_b32 v50, 16, v49
    v_and_b32 v49, 0xffff0000, v48
    v_lshlrev_b32 v48, 16, v48
    s_mov_b32 s46, s50
    s_cmp_lg_u32 s53, 0
    s_cbranch_scc1 L_d_gate_done
    s_lshl_b32 s44, s2, 7
    s_add_u32 s44, s44, 458752
    v_mov_b32 v122, 0
    s_mov_b32 s45, 0
    buffer_load_dword v123, v122, s[32:35], s44 offen sc0 sc1
L_gate_7:
    s_sleep 6
    buffer_load_dword v124, v122, s[32:35], s44 offen sc0 sc1
    s_waitcnt vmcnt(1)
    v_cmp_ne_u32 vcc, 1, v123
    s_cbranch_vccz L_gate_7_ok
    s_sleep 6
    buffer_load_dword v123, v122, s[32:35], s44 offen sc0 sc1
    s_waitcnt vmcnt(1)
    v_cmp_ne_u32 vcc, 1, v124
    s_add_u32 s45, s45, 1
    s_cbranch_vccz L_gate_7_ok
    s_cmp_lt_u32 s45, 0x20000
    s_cbranch_scc1 L_gate_7
L_gate_7_ok:
L_d_gate_done:
    s_barrier
    s_mov_b32 s45, 0
    s_mov_b32 s44, s46
    buffer_load_dwordx4 v[64:67], v59, s[32:35], s44 offen sc0 sc1
    s_add_u32 s44, s44, 10240
    buffer_load_dwordx4 v[68:71], v59, s[32:35], s44 offen sc0 sc1
    s_add_u32 s44, s44, 10240
    buffer_load_dwordx4 v[72:75], v59, s[32:35], s44 offen sc0 sc1
    s_add_u32 s44, s44, 10240
    buffer_load_dwordx4 v[76:79], v59, s[32:35], s44 offen sc0 sc1
    s_add_u32 s44, s44, 10240
    buffer_load_dwordx4 v[80:83], v59, s[32:35], s44 offen sc0 sc1
    s_add_u32 s44, s44, 10240
    buffer_load_dwordx4 v[84:87], v59, s[32:35], s44 offen sc0 sc1
    s_add_u32 s44, s44, 10240
    buffer_load_dwordx4 v[88:91], v59, s[32:35], s44 offen sc0 sc1
    s_add_u32 s44, s44, 10240
    buffer_load_dwordx4 v[92:95], v59, s[32:35], s44 offen sc0 sc1
    s_sleep 10
L_pc_8:
    s_mov_b32 s44, s46
    buffer_load_dwordx4 v[96:99], v59, s[32:35], s44 offen sc0 sc1
    s_add_u32 s44, s44, 10240
    buffer_load_dwordx4 v[100:103], v59, s[32:35], s44 offen sc0 sc1
    s_add_u32 s44, s44, 10240
    buffer_load_dwordx4 v[104:107], v59, s[32:35], s44 offen sc0 sc1
    s_add_u32 s44, s44, 10240
    buffer_load_dwordx4 v[108:111], v59, s[32:35], s44 offen sc0 sc1
    s_add_u32 s44, s44, 10240
    buffer_load_dwordx4 v[112:115], v59, s[32:35], s44 offen sc0 sc1
    s_add_u32 s44, s44, 10240
    buffer_load_dwordx4 v[116:119], v59, s[32:35], s44 offen sc0 sc1
    s_add_u32 s44, s44, 10240
    buffer_load_dwordx4 v[120:123], v59, s[32:35], s44 offen sc0 sc1
    s_add_u32 s44, s44, 10240
    buffer_load_dwordx4 v[124:127], v59, s[32:35], s44 offen sc0 sc1
    s_waitcnt vmcnt(8)
    v_max_u32 v60, v64, v65
    v_max3_u32 v60, v60, v66, v67
    v_max3_u32 v60, v60, v68, v69
    v_max3_u32 v60, v60, v70, v71
    v_max3_u32 v60, v60, v72, v73
    v_max3_u32 v60, v60, v74, v75
    v_max3_u32 v60, v60, v76, v77
    v_max3_u32 v60, v60, v78, v79
    v_max3_u32 v60, v60, v80, v81
    v_max3_u32 v60, v60, v82, v83
    v_max3_u32 v60, v60, v84, v85
    v_max3_u32 v60, v60, v86, v87
    v_max3_u32 v60, v60, v88, v89
    v_max3_u32 v60, v60, v90, v91
    v_max3_u32 v60, v60, v92, v93
    v_max3_u32 v60, v60, v94, v95
    v_cmp_eq_u32 vcc, -1, v60
    s_cbranch_vccz L_pc_8_a
    s_mov_b32 s44, s46
    buffer_load_dwordx4 v[64:67], v59, s[32:35], s44 offen sc0 sc1
    s_add_u32 s44, s44, 10240
    buffer_load_dwordx4 v[68:71], v59, s[32:35], s44 offen sc0 sc1
    s_add_u32 s44, s44, 10240
    buffer_load_dwordx4 v[72:75], v59, s[32:35], s44 offen sc0 sc1
    s_add_u32 s44, s44, 10240
    buffer_load_dwordx4 v[76:79], v59, s[32:35], s44 offen sc0 sc1
    s_add_u32 s44, s44, 10240
    buffer_load_dwordx4 v[80:83], v59, s[32:35], s44 offen sc0 sc1
    s_add_u32 s44, s44, 10240
    buffer_load_dwordx4 v[84:87], v59, s[32:35], s44 offen sc0 sc1
    s_add_u32 s44, s44, 10240
    buffer_load_dwordx4 v[88:91], v59, s[32:35], s44 offen sc0 sc1
    s_add_u32 s44, s44, 10240
    buffer_load_dwordx4 v[92:95], v59, s[32:35], s44 offen sc0 sc1
    s_waitcnt vmcnt(8)
    v_max_u32 v60, v96, v97
    v_max3_u32 v60, v60, v98, v99
    v_max3_u32 v60, v60, v100, v101
    v_max3_u32 v60, v60, v102, v103
    v_max3_u32 v60, v60, v104, v105
    v_max3_u32 v60, v60, v106, v107
    v_max3_u32 v60, v60, v108, v109
    v_max3_u32 v60, v60, v110, v111
    v_max3_u32 v60, v60, v112, v113
    v_max3_u32 v60, v60, v114, v115
    v_max3_u32 v60, v60, v116, v117
    v_max3_u32 v60, v60, v118, v119
    v_max3_u32 v60, v60, v120, v121
    v_max3_u32 v60, v60, v122, v123
    v_max3_u32 v60, v60, v124, v125
    v_max3_u32 v60, v60, v126, v127
    v_cmp_eq_u32 vcc, -1, v60
    s_cbranch_vccz L_pc_8_b
    s_add_u32 s45, s45, 1
    s_cmp_lt_u32 s45, 0x20000
    s_cbranch_scc1 L_pc_8
L_pc_8_b:
    v_add_f32 v96, v96, v112
    v_add_f32 v100, v100, v116
    v_add_f32 v104, v104, v120
    v_add_f32 v108, v108, v124
    v_add_f32 v97, v97, v113
    v_add_f32 v101, v101, v117
    v_add_f32 v105, v105, v121
    v_add_f32 v109, v109, v125
    v_add_f32 v98, v98, v114
    v_add_f32 v102, v102, v118
    v_add_f32 v106, v106, v122
    v_add_f32 v110, v110, v126
    v_add_f32 v99, v99, v115
    v_add_f32 v103, v103, v119
    v_add_f32 v107, v107, v123
    v_add_f32 v111, v111, v127
    v_add_f32 v96, v96, v100
    v_add_f32 v104, v104, v108
    v_add_f32 v97, v97, v101
    v_add_f32 v105, v105, v109
    v_add_f32 v98, v98, v102
    v_add_f32 v106, v106, v110
    v_add_f32 v99, v99, v103
    v_add_f32 v107, v107, v111
    v_add_f32 v52, v96, v104
    v_add_f32 v53, v97, v105
    v_add_f32 v54, v98, v106
    v_add_f32 v55, v99, v107
    s_branch L_pc_8_e
L_pc_8_a:
    v_add_f32 v64, v64, v80
    v_add_f32 v68, v68, v84
    v_add_f32 v72, v72, v88
    v_add_f32 v76, v76, v92
    v_add_f32 v65, v65, v81
    v_add_f32 v69, v69, v85
    v_add_f32 v73, v73, v89
    v_add_f32 v77, v77, v93
    v_add_f32 v66, v66, v82
    v_add_f32 v70, v70, v86
    v_add_f32 v74, v74, v90
    v_add_f32 v78, v78, v94
    v_add_f32 v67, v67, v83
    v_add_f32 v71, v71, v87
    v_add_f32 v75, v75, v91
    v_add_f32 v79, v79, v95
    v_add_f32 v64, v64, v68
    v_add_f32 v72, v72, v76
    v_add_f32 v65, v65, v69
    v_add_f32 v73, v73, v77
    v_add_f32 v66, v66, v70
    v_add_f32 v74, v74, v78
    v_add_f32 v67, v67, v71
    v_add_f32 v75, v75, v79
    v_add_f32 v52, v64, v72
    v_add_f32 v53, v65, v73
    v_add_f32 v54, v66, v74
    v_add_f32 v55, v67, v75
L_pc_8_e:
    v_cvt_pk_bf16_f32 v52, v52, v52
    v_lshlrev_b32 v52, 16, v52
    v_cvt_pk_bf16_f32 v53, v53, v53
    v_lshlrev_b32 v53, 16, v53
    v_cvt_pk_bf16_f32 v54, v54, v54
    v_lshlrev_b32 v54, 16, v54
    v_cvt_pk_bf16_f32 v55, v55, v55
    v_lshlrev_b32 v55, 16, v55
    v_add_f32 v52, v52, v48
    v_add_f32 v53, v53, v49
    v_add_f32 v54, v54, v50
    v_add_f32 v55, v55, v51
    v_cvt_pk_bf16_f32 v60, v52, v53
    v_cvt_pk_bf16_f32 v61, v54, v55
    s_mov_b32 exec_lo, -1
    s_mov_b32 exec_hi, 0xff
    ds_write_b64 v62, v[60:61] offset:18944
    s_mov_b64 exec, -1
    v_lshlrev_b32 v52, 16, v60
    v_and_b32 v53, 0xffff0000, v60
    v_lshlrev_b32 v54, 16, v61
    v_and_b32 v55, 0xffff0000, v61
    v_add_f32 v58, v52, v53
    v_add_f32 v59, v54, v55
    v_add_f32 v58, v58, v59
    v_mul_f32 v58, v58, v56
    s_nop 1
    v_add_f32_dpp v58, v58, v58 quad_perm:[1,0,3,2] row_mask:0xf bank_mask:0xf
    s_nop 1
    v_add_f32_dpp v58, v58, v58 quad_perm:[2,3,0,1] row_mask:0xf bank_mask:0xf
    s_nop 1
    v_add_f32_dpp v58, v58, v58 row_half_mirror row_mask:0xf bank_mask:0xf
    s_nop 1
    v_add_f32_dpp v58, v58, v58 row_mirror row_mask:0xf bank_mask:0xf
    s_nop 1
    v_readlane_b32 s44, v58, 0
    v_readlane_b32 s45, v58, 16
    v_readlane_b32 s46, v58, 32
    v_readlane_b32 s47, v58, 48
    s_nop 1
    v_mov_b32 v58, s44
    v_add_f32 v58, s45, v58
    v_add_f32 v58, s46, v58
    v_add_f32 v58, s47, v58
    v_mul_f32 v58, 0x3bcccccd, v58
    v_sub_f32 v60, v52, v58
    v_mul_f32 v59, v60, v60
    v_sub_f32 v60, v53, v58
    v_fmac_f32 v59, v60, v60
    v_sub_f32 v60, v54, v58
    v_fmac_f32 v59, v60, v60
    v_sub_f32 v60, v55, v58
    v_fmac_f32 v59, v60, v60
    v_mul_f32 v59, v59, v56
    s_nop 1
    v_add_f32_dpp v59, v59, v59 quad_perm:[1,0,3,2] row_mask:0xf bank_mask:0xf
    s_nop 1
    v_add_f32_dpp v59, v59, v59 quad_perm:[2,3,0,1] row_mask:0xf bank_mask:0xf
    s_nop 1
    v_add_f32_dpp v59, v59, v59 row_half_mirror row_mask:0xf bank_mask:0xf
    s_nop 1
    v_add_f32_dpp v59, v59, v59 row_mirror row_mask:0xf bank_mask:0xf
    s_nop 1
    v_readlane_b32 s44, v59, 0
    v_readlane_b32 s45, v59, 16
    v_readlane_b32 s46, v59, 32
    v_readlane_b32 s47, v59, 48
    s_nop 1
    v_mov_b32 v59, s44
    v_add_f32 v59, s45, v59
    v_add_f32 v59, s46, v59
    v_add_f32 v59, s47, v59
    ds_write_b64 v63, v[58:59] offset:29696
    s_waitcnt lgkmcnt(0)
    s_barrier
    s_lshr_b32 s48, s53, 2
    s_mul_i32 s50, s48, 320
    s_add_u32 s50, s50, 18944
    v_add_u32 v12, s50, v8
    s_cmp_ge_u32 s53, 4
    s_cbranch_scc1 L_d_h1
    s_lshl_b32 s49, s53, 5
    v_mov_b32 v60, s49
    ds_read_b64 v[2:3], v60 offset:29696
    ds_read_b64 v[4:5], v60 offset:29704
    ds_read_b64 v[10:11], v60 offset:29712
    ds_read_b64 v[14:15], v60 offset:29720
L_d_h1:
    ds_read_b128 v[36:39], v12 offset:0
    ds_read_b128 v[40:43], v12 offset:64
    ds_read_b128 v[44:47], v12 offset:128
    ds_read_b128 v[48:51], v12 offset:192
    ds_read_b128 v[52:55], v12 offset:256
    s_cmp_ge_u32 s53, 4
    s_cbranch_scc1 L_d_h2
    s_waitcnt lgkmcnt(5)
    v_add_f32 v1, v2, v4
    v_add_f32 v12, v10, v14
    v_add_f32 v1, v1, v12
    v_mul_f32 v60, 0.25, v1
    v_add_f32 v12, v3, v5
    v_add_f32 v13, v11, v15
    v_add_f32 v12, v12, v13
    v_sub_f32 v2, v2, v60
    v_sub_f32 v4, v4, v60
    v_sub_f32 v10, v10, v60
    v_sub_f32 v14, v14, v60
    v_mul_f32 v13, v2, v2
    v_fmac_f32 v13, v4, v4
    v_fmac_f32 v13, v10, v10
    v_fmac_f32 v13, v14, v14
    v_mov_b32 v1, 0x43200000
    v_fmac_f32 v12, v13, v1
    v_mul_f32 v61, 0x3acccccd, v12
    v_cvt_pk_bf16_f32 v60, v60, v60
    v_lshlrev_b32 v60, 16, v60
    v_cvt_pk_bf16_f32 v61, v61, v61
    v_lshlrev_b32 v61, 16, v61
    v_add_f32 v61, 0x3727c5ac, v61
    v_cvt_pk_bf16_f32 v61, v61, v61
    v_lshlrev_b32 v61, 16, v61
    v_sqrt_f32 v61, v61
    s_nop 0
    v_cvt_pk_bf16_f32 v61, v61, v61
    v_lshlrev_b32 v61, 16, v61
    v_rcp_f32 v61, v61
L_d_h2:
    s_waitcnt lgkmcnt(4)
    v_mfma_f32_16x16x32_bf16 v[56:59], v[36:39], v[16:19], 0
    s_waitcnt lgkmcnt(3)
    v_mfma_f32_16x16x32_bf16 v[56:59], v[40:43], v[20:23], v[56:59]
    s_waitcnt lgkmcnt(2)
    v_mfma_f32_16x16x32_bf16 v[56:59], v[44:47], v[24:27], v[56:59]
    s_waitcnt lgkmcnt(1)
    v_mfma_f32_16x16x32_bf16 v[56:59], v[48:51], v[28:31], v[56:59]
    s_waitcnt lgkmcnt(0)
    v_mfma_f32_16x16x32_bf16 v[56:59], v[52:55], v[32:35], v[56:59]
    s_nop 15
    s_lshr_b32 s48, s53, 2
    s_and_b32 s49, s53, 3
    s_mul_i32 s48, s48, 1280
    s_lshl_b32 s49, s49, 6
    s_add_u32 s48, s48, s49
    v_lshlrev_b32 v12, 2, v6
    v_add_u32 v12, s48, v12
    s_mov_b64 exec, 0xffff
    ds_write_b32 v12, v56 offset:13824
    ds_write_b32 v12, v57 offset:14080
    ds_write_b32 v12, v58 offset:14336
    ds_write_b32 v12, v59 offset:14592
    s_mov_b64 exec, 0xffff0000
    ds_write_b32 v12, v56 offset:14784
    s_mov_b64 exec, -1
    s_waitcnt lgkmcnt(0)
    s_barrier
    s_cmp_ge_u32 s53, 4
    s_cbranch_scc1 L_done
    v_lshlrev_b32 v12, 2, v0
    v_lshlrev_b32 v13, 2, v6
    ds_read_b32 v16, v12 offset:13824
    ds_read_b32 v17, v12 offset:15104
    ds_read_b32 v18, v12 offset:16384
    ds_read_b32 v19, v12 offset:17664
    ds_read_b32 v20, v13 offset:14848
    ds_read_b32 v21, v13 offset:16128
    ds_read_b32 v22, v13 offset:17408
    ds_read_b32 v23, v13 offset:18688
    s_waitcnt lgkmcnt(0)
    v_add_f32 v16, v16, v17
    v_add_f32 v20, v20, v21
    v_add_f32 v18, v18, v19
    v_add_f32 v22, v22, v23
    v_add_f32 v16, v16, v18
    v_add_f32 v20, v20, v22
    v_fma_f32 v16, -v60, v20, v16
    v_mul_f32 v16, v16, v61
    s_cmp_lg_u32 s54, 0
    s_cbranch_scc1 L_d_nosilu
    v_cvt_pk_bf16_f32 v16, v16, v16
    v_lshlrev_b32 v16, 16, v16
    v_mul_f32 v18, 0xbfb8aa3b, v16
    v_exp_f32 v18, v18
    s_nop 0
    v_add_f32 v18, 1.0, v18
    v_rcp_f32 v18, v18
    s_nop 0
    v_mul_f32 v16, v16, v18
L_d_nosilu:
    s_nop 1
    v_mov_b32_dpp v17, v16 quad_perm:[1,0,3,2] row_mask:0xf bank_mask:0xf
    v_cvt_pk_bf16_f32 v16, v16, v17
    v_mul_u32_u24 v12, 3072, v7
    v_lshl_add_u32 v12, v6, 1, v12
    s_mul_i32 s48, s54, 16384
    s_lshl_b32 s49, s55, 7
    s_add_u32 s48, s48, s49
    s_add_u32 s48, s48, 360448
    s_mov_b32 exec_lo, 0x55555555
    s_mov_b32 exec_hi, 0x55555555
    buffer_store_dword v16, v12, s[32:35], s48 offen sc0 sc1
    s_mov_b64 exec, -1
L_done:
    s_endpgm
.section .rodata,"a"
.p2align 6
.amdhsa_kernel sequential_preLN__mha_block_cached__moe_arch_mod__decode_kernel
  .amdhsa_next_free_vgpr 128
  .amdhsa_next_free_sgpr 102
  .amdhsa_accum_offset 128
  .amdhsa_group_segment_fixed_size 0
  .amdhsa_kernarg_size 104
  .amdhsa_user_sgpr_count 2
  .amdhsa_user_sgpr_kernarg_segment_ptr 1
  .amdhsa_system_sgpr_workgroup_id_x 1
.end_amdhsa_kernel
```

```asm
; @launch grid=(256,1,1) block=(1024,1,1) lds=140800
.amdgcn_target "amdgcn-amd-amdhsa--gfx950"
.text
.globl sequential_preLN__mha_block_cached__moe_arch_mod__decode_kernel
.p2align 8
.type sequential_preLN__mha_block_cached__moe_arch_mod__decode_kernel,@function
sequential_preLN__mha_block_cached__moe_arch_mod__decode_kernel:
    s_cmp_ge_u32 s2, 256
    s_cbranch_scc1 L_done
    s_load_dwordx2 s[4:5], s[0:1], 0
    s_load_dwordx4 s[8:11], s[0:1], 8
    s_load_dwordx4 s[12:15], s[0:1], 24
    s_load_dwordx4 s[80:83], s[0:1], 48
    s_load_dwordx4 s[84:87], s[0:1], 64
    s_load_dwordx4 s[88:91], s[0:1], 80
    s_load_dwordx2 s[6:7], s[0:1], 96
    s_and_b32 s42, s2, 7
    s_lshr_b32 s43, s2, 3
    s_and_b32 s44, s43, 3
    s_lshl_b32 s45, s42, 2
    s_add_u32 s45, s45, s44
    s_lshr_b32 s44, s43, 2
    s_lshr_b32 s46, s44, 1
    s_and_b32 s47, s44, 1
    s_lshl_b32 s40, s46, 5
    s_add_u32 s40, s40, s45
    s_lshl_b32 s40, s40, 1
    s_add_u32 s40, s40, s47
    s_mul_i32 s41, s40, 1572864
    s_lshr_b32 s99, s45, 3
    s_mov_b32 s96, 1572864
    v_and_b32 v6, 63, v0
    v_lshrrev_b32 v2, 6, v0
    v_lshrrev_b32 v3, 3, v6
    v_and_b32 v4, 7, v6
    v_readfirstlane_b32 s53, v2
    v_lshlrev_b32 v4, 4, v4
    v_mul_u32_u24 v5, 384, v3
    v_add_u32 v1, v5, v4
    v_mul_u32_u24 v5, 40, v2
    v_add_u32 v5, v5, v3
    v_mul_u32_u24 v7, 12288, v5
    v_add_u32 v7, v7, v4
    v_lshlrev_b32 v8, 1, v5
    v_lshlrev_b32 v5, 2, v6
    s_waitcnt lgkmcnt(0)
    s_mov_b32 s56, s4
    s_and_b32 s57, s5, 0xffff
    s_mov_b32 s58, 0x1400
    s_mov_b32 s59, 0x00020000
    s_mul_i32 s48, s46, 1280
    s_add_u32 s4, s4, s48
    s_addc_u32 s5, s5, 0
    s_mov_b32 s28, s4
    s_and_b32 s29, s5, 0xffff
    s_mov_b32 s30, 0x500
    s_mov_b32 s31, 0x00020000
    s_mul_i32 s48, s45, 384
    s_add_u32 s12, s12, s48
    s_addc_u32 s13, s13, 0
    s_sub_u32 s49, 7864320, s48
    s_mov_b32 s24, s12
    s_and_b32 s25, s13, 0xffff
    s_mov_b32 s26, s49
    s_mov_b32 s27, 0x00020000
    s_add_u32 s8, s8, s41
    s_addc_u32 s9, s9, 0
    s_mov_b32 s16, s8
    s_and_b32 s17, s9, 0xffff
    s_mov_b32 s18, s96
    s_mov_b32 s19, 0x00020000
    s_add_u32 s10, s10, s41
    s_addc_u32 s11, s11, 0
    s_mov_b32 s20, s10
    s_and_b32 s21, s11, 0xffff
    s_mov_b32 s22, s96
    s_mov_b32 s23, 0x00020000
    s_mov_b32 s32, s6
    s_and_b32 s33, s7, 0xffff
    s_mov_b32 s34, 0x200000
    s_mov_b32 s35, 0x00020000
    s_mov_b32 s36, s90
    s_and_b32 s37, s91, 0xffff
    s_mov_b32 s38, 0x100
    s_mov_b32 s39, 0x00020000
    s_mov_b32 s60, s14
    s_and_b32 s61, s15, 0xffff
    s_mov_b32 s62, 0x780000
    s_mov_b32 s63, 0x00020000
    s_mov_b32 s64, s82
    s_and_b32 s65, s83, 0xffff
    s_mov_b32 s66, 0x1e0000
    s_mov_b32 s67, 0x00020000
    s_mov_b32 s92, s84
    s_and_b32 s93, s85, 0xffff
    s_mov_b32 s94, 0x1e0000
    s_mov_b32 s95, 0x00020000
    s_mov_b32 s68, s86
    s_and_b32 s69, s87, 0xffff
    s_mov_b32 s70, 0x1e0000
    s_mov_b32 s71, 0x00020000
    s_mov_b32 s72, s80
    s_and_b32 s73, s81, 0xffff
    s_mov_b32 s74, 0x500
    s_mov_b32 s75, 0x00020000
    s_mov_b32 s76, s88
    s_and_b32 s77, s89, 0xffff
    s_mov_b32 s78, 0x1400
    s_mov_b32 s79, 0x00020000
    s_mul_i32 s48, s2, 6554
    s_lshr_b32 s54, s48, 16
    s_mul_i32 s48, s54, 10
    s_sub_u32 s55, s2, s48
    s_mov_b32 s98, 0
    s_cmp_lt_u32 s2, 80
    s_cbranch_scc1 L_role_1
    s_mov_b32 s98, 1
    s_sub_u32 s55, s2, 80
    s_cmp_ge_u32 s55, 24
    s_cselect_b32 s54, 1, 0
    s_mul_i32 s48, s54, 24
    s_sub_u32 s55, s55, s48
    s_cmp_lt_u32 s2, 128
    s_cbranch_scc1 L_role_1
    s_mov_b32 s98, 2
    s_sub_u32 s55, s2, 128
    s_cmp_lt_u32 s2, 148
    s_cbranch_scc1 L_role_1
    s_mov_b32 s98, 3
L_role_1:
    v_mov_b32 v2, -1
    v_lshlrev_b32 v3, 2, v0
    v_cmp_gt_u32 vcc, 384, v0
    s_and_saveexec_b64 s[100:101], vcc
    s_cbranch_execz L_clr1
    s_mul_i32 s48, s40, 1536
    s_add_u32 s48, s48, 1048576
    buffer_store_dword v2, v3, s[32:35], s48 offen sc0 sc1
    v_cmp_eq_u32 vcc, 0, v0
    s_and_b64 exec, exec, vcc
    s_cbranch_execz L_clr1
    s_lshl_b32 s48, s2, 7
    s_add_u32 s48, s48, 458752
    buffer_store_dword v2, v3, s[32:35], s48 offen sc0 sc1
    buffer_store_dword v2, v3, s[32:35], s48 offen offset:4 sc0 sc1
L_clr1:
    s_mov_b64 exec, s[100:101]
    s_cmp_ge_u32 s98, 2
    s_cbranch_scc1 L_clr3
    s_cmp_eq_u32 s98, 1
    s_cbranch_scc1 L_clr_d
    v_cmp_gt_u32 vcc, 256, v0
    s_and_saveexec_b64 s[100:101], vcc
    s_cbranch_execz L_clr2
    v_lshrrev_b32 v3, 6, v0
    v_mul_u32_u24 v3, 2560, v3
    v_and_b32 v4, 63, v0
    v_lshl_add_u32 v3, v4, 2, v3
    s_mul_i32 s48, s54, 10240
    s_lshl_b32 s49, s55, 8
    s_add_u32 s48, s48, s49
    s_add_u32 s48, s48, 262144
    buffer_store_dword v2, v3, s[32:35], s48 offen sc0 sc1
    v_cmp_eq_u32 vcc, 0, v0
    s_and_b64 exec, exec, vcc
    s_cbranch_execz L_clr2
    s_lshl_b32 s48, s2, 2
    s_add_u32 s48, s48, 454656
    buffer_store_dword v2, v3, s[32:35], s48 offen sc0 sc1
    s_branch L_clr2
L_clr_d:
    v_cmp_gt_u32 vcc, 128, v0
    s_and_saveexec_b64 s[100:101], vcc
    s_cbranch_execz L_clr2
    v_lshrrev_b32 v3, 5, v0
    v_mul_u32_u24 v3, 3072, v3
    v_and_b32 v4, 31, v0
    v_lshl_add_u32 v3, v4, 2, v3
    s_mul_i32 s48, s54, 16384
    s_lshl_b32 s49, s55, 7
    s_add_u32 s48, s48, s49
    s_add_u32 s48, s48, 360448
    buffer_store_dword v2, v3, s[32:35], s48 offen sc0 sc1
L_clr2:
    s_mov_b64 exec, s[100:101]
L_clr3:
    v_mov_b32 v3, 12928
    v_mov_b32 v4, 16
    ds_write_b32 v3, v4
    buffer_load_dword v46, v5, s[28:31], 0 offen offset:0
    buffer_load_dword v47, v5, s[28:31], 0 offen offset:256
    buffer_load_dword v48, v5, s[28:31], 0 offen offset:512
    buffer_load_dword v49, v5, s[28:31], 0 offen offset:768
    buffer_load_dword v50, v5, s[28:31], 0 offen offset:1024
    buffer_load_ushort v51, v8, s[28:31], 0 offen offset:0
    buffer_load_ushort v52, v8, s[28:31], 0 offen offset:16
    buffer_load_ushort v53, v8, s[28:31], 0 offen offset:32
    buffer_load_ushort v126, v8, s[28:31], 0 offen offset:48
    buffer_load_ushort v127, v8, s[28:31], 0 offen offset:64
    s_mov_b32 s48, 0
    buffer_load_dwordx4 v[102:105], v7, s[24:27], s48 offen offset:0 nt
    buffer_load_dwordx4 v[106:109], v7, s[24:27], s48 offen offset:128 nt
    buffer_load_dwordx4 v[110:113], v7, s[24:27], s48 offen offset:256 nt
    s_mov_b32 s48, 98304
    buffer_load_dwordx4 v[114:117], v7, s[24:27], s48 offen offset:0 nt
    buffer_load_dwordx4 v[118:121], v7, s[24:27], s48 offen offset:128 nt
    buffer_load_dwordx4 v[122:125], v7, s[24:27], s48 offen offset:256 nt
    s_mov_b32 s48, 196608
    buffer_load_dwordx4 v[10:13], v7, s[24:27], s48 offen offset:0 nt
    buffer_load_dwordx4 v[14:17], v7, s[24:27], s48 offen offset:128 nt
    buffer_load_dwordx4 v[18:21], v7, s[24:27], s48 offen offset:256 nt
    s_mov_b32 s48, 294912
    buffer_load_dwordx4 v[22:25], v7, s[24:27], s48 offen offset:0 nt
    buffer_load_dwordx4 v[26:29], v7, s[24:27], s48 offen offset:128 nt
    buffer_load_dwordx4 v[30:33], v7, s[24:27], s48 offen offset:256 nt
    s_mov_b32 s48, 393216
    buffer_load_dwordx4 v[34:37], v7, s[24:27], s48 offen offset:0 nt
    buffer_load_dwordx4 v[38:41], v7, s[24:27], s48 offen offset:128 nt
    buffer_load_dwordx4 v[42:45], v7, s[24:27], s48 offen offset:256 nt
    s_mul_i32 s41, s53, 24576
    s_barrier
    s_add_u32 s48, s41, 0
    buffer_load_dwordx4 v[78:81], v1, s[16:19], s48 offen offset:0 nt
    buffer_load_dwordx4 v[82:85], v1, s[16:19], s48 offen offset:128 nt
    buffer_load_dwordx4 v[86:89], v1, s[16:19], s48 offen offset:256 nt
    s_add_u32 s48, s41, 3072
    buffer_load_dwordx4 v[90:93], v1, s[16:19], s48 offen offset:0 nt
    buffer_load_dwordx4 v[94:97], v1, s[16:19], s48 offen offset:128 nt
    buffer_load_dwordx4 v[98:101], v1, s[16:19], s48 offen offset:256 nt
    s_waitcnt vmcnt(26)
    v_lshlrev_b32 v54, 16, v46
    v_and_b32 v55, 0xffff0000, v46
    v_lshlrev_b32 v56, 16, v47
    v_and_b32 v57, 0xffff0000, v47
    v_lshlrev_b32 v58, 16, v48
    v_and_b32 v59, 0xffff0000, v48
    v_lshlrev_b32 v60, 16, v49
    v_and_b32 v61, 0xffff0000, v49
    v_lshlrev_b32 v62, 16, v50
    v_and_b32 v63, 0xffff0000, v50
    v_add_f32 v2, v54, v55
    v_add_f32 v2, v2, v56
    v_add_f32 v2, v2, v57
    v_add_f32 v2, v2, v58
    v_add_f32 v2, v2, v59
    v_add_f32 v2, v2, v60
    v_add_f32 v2, v2, v61
    v_add_f32 v2, v2, v62
    v_add_f32 v2, v2, v63
    s_nop 1
    v_add_f32_dpp v2, v2, v2 quad_perm:[1,0,3,2] row_mask:0xf bank_mask:0xf
    s_nop 1
    v_add_f32_dpp v2, v2, v2 quad_perm:[2,3,0,1] row_mask:0xf bank_mask:0xf
    s_nop 1
    v_add_f32_dpp v2, v2, v2 row_half_mirror row_mask:0xf bank_mask:0xf
    s_nop 1
    v_add_f32_dpp v2, v2, v2 row_mirror row_mask:0xf bank_mask:0xf
    s_nop 1
    v_readlane_b32 s48, v2, 0
    v_readlane_b32 s49, v2, 16
    v_readlane_b32 s50, v2, 32
    v_readlane_b32 s51, v2, 48
    s_nop 1
    v_mov_b32 v2, s48
    v_add_f32 v2, s49, v2
    v_add_f32 v2, s50, v2
    v_add_f32 v2, s51, v2
    v_mul_f32 v2, 0x3acccccd, v2
    v_sub_f32 v4, v54, v2
    v_mul_f32 v3, v4, v4
    v_sub_f32 v4, v55, v2
    v_fmac_f32 v3, v4, v4
    v_sub_f32 v4, v56, v2
    v_fmac_f32 v3, v4, v4
    v_sub_f32 v4, v57, v2
    v_fmac_f32 v3, v4, v4
    v_sub_f32 v4, v58, v2
    v_fmac_f32 v3, v4, v4
    v_sub_f32 v4, v59, v2
    v_fmac_f32 v3, v4, v4
    v_sub_f32 v4, v60, v2
    v_fmac_f32 v3, v4, v4
    v_sub_f32 v4, v61, v2
    v_fmac_f32 v3, v4, v4
    v_sub_f32 v4, v62, v2
    v_fmac_f32 v3, v4, v4
    v_sub_f32 v4, v63, v2
    v_fmac_f32 v3, v4, v4
    s_nop 1
    v_add_f32_dpp v3, v3, v3 quad_perm:[1,0,3,2] row_mask:0xf bank_mask:0xf
    s_nop 1
    v_add_f32_dpp v3, v3, v3 quad_perm:[2,3,0,1] row_mask:0xf bank_mask:0xf
    s_nop 1
    v_add_f32_dpp v3, v3, v3 row_half_mirror row_mask:0xf bank_mask:0xf
    s_nop 1
    v_add_f32_dpp v3, v3, v3 row_mirror row_mask:0xf bank_mask:0xf
    s_nop 1
    v_readlane_b32 s48, v3, 0
    v_readlane_b32 s49, v3, 16
    v_readlane_b32 s50, v3, 32
    v_readlane_b32 s51, v3, 48
    s_nop 1
    v_mov_b32 v3, s48
    v_add_f32 v3, s49, v3
    v_add_f32 v3, s50, v3
    v_add_f32 v3, s51, v3
    v_mul_f32 v3, 0x3acccccd, v3
    v_cvt_pk_bf16_f32 v2, v2, v2
    v_lshlrev_b32 v2, 16, v2
    v_cvt_pk_bf16_f32 v3, v3, v3
    v_lshlrev_b32 v3, 16, v3
    v_add_f32 v3, 0x3727c5ac, v3
    v_cvt_pk_bf16_f32 v3, v3, v3
    v_lshlrev_b32 v3, 16, v3
    v_sqrt_f32 v3, v3
    s_nop 0
    v_cvt_pk_bf16_f32 v3, v3, v3
    v_lshlrev_b32 v3, 16, v3
    v_rcp_f32 v3, v3
    s_waitcnt vmcnt(21)
    v_lshlrev_b32 v51, 16, v51
    v_sub_f32 v51, v51, v2
    v_cvt_pk_bf16_f32 v51, v51, v51
    v_lshlrev_b32 v51, 16, v51
    v_mul_f32 v51, v51, v3
    v_cvt_pk_bf16_f32 v51, v51, v51
    v_lshlrev_b32 v51, 16, v51
    v_lshlrev_b32 v52, 16, v52
    v_sub_f32 v52, v52, v2
    v_cvt_pk_bf16_f32 v52, v52, v52
    v_lshlrev_b32 v52, 16, v52
    v_mul_f32 v52, v52, v3
    v_cvt_pk_bf16_f32 v52, v52, v52
    v_lshlrev_b32 v52, 16, v52
    v_lshlrev_b32 v53, 16, v53
    v_sub_f32 v53, v53, v2
    v_cvt_pk_bf16_f32 v53, v53, v53
    v_lshlrev_b32 v53, 16, v53
    v_mul_f32 v53, v53, v3
    v_cvt_pk_bf16_f32 v53, v53, v53
    v_lshlrev_b32 v53, 16, v53
    v_lshlrev_b32 v126, 16, v126
    v_sub_f32 v126, v126, v2
    v_cvt_pk_bf16_f32 v126, v126, v126
    v_lshlrev_b32 v126, 16, v126
    v_mul_f32 v126, v126, v3
    v_cvt_pk_bf16_f32 v126, v126, v126
    v_lshlrev_b32 v126, 16, v126
    v_lshlrev_b32 v127, 16, v127
    v_sub_f32 v127, v127, v2
    v_cvt_pk_bf16_f32 v127, v127, v127
    v_lshlrev_b32 v127, 16, v127
    v_mul_f32 v127, v127, v3
    v_cvt_pk_bf16_f32 v127, v127, v127
    v_lshlrev_b32 v127, 16, v127
    s_waitcnt vmcnt(18)
    v_lshlrev_b32 v2, 16, v102
    v_and_b32 v3, 0xffff0000, v102
    v_mul_f32 v54, v51, v2
    v_mul_f32 v55, v51, v3
    v_lshlrev_b32 v2, 16, v103
    v_and_b32 v3, 0xffff0000, v103
    v_mul_f32 v56, v51, v2
    v_mul_f32 v57, v51, v3
    v_lshlrev_b32 v2, 16, v104
    v_and_b32 v3, 0xffff0000, v104
    v_mul_f32 v58, v51, v2
    v_mul_f32 v59, v51, v3
    v_lshlrev_b32 v2, 16, v105
    v_and_b32 v3, 0xffff0000, v105
    v_mul_f32 v60, v51, v2
    v_mul_f32 v61, v51, v3
    v_lshlrev_b32 v2, 16, v106
    v_and_b32 v3, 0xffff0000, v106
    v_mul_f32 v62, v51, v2
    v_mul_f32 v63, v51, v3
    v_lshlrev_b32 v2, 16, v107
    v_and_b32 v3, 0xffff0000, v107
    v_mul_f32 v64, v51, v2
    v_mul_f32 v65, v51, v3
    v_lshlrev_b32 v2, 16, v108
    v_and_b32 v3, 0xffff0000, v108
    v_mul_f32 v66, v51, v2
    v_mul_f32 v67, v51, v3
    v_lshlrev_b32 v2, 16, v109
    v_and_b32 v3, 0xffff0000, v109
    v_mul_f32 v68, v51, v2
    v_mul_f32 v69, v51, v3
    v_lshlrev_b32 v2, 16, v110
    v_and_b32 v3, 0xffff0000, v110
    v_mul_f32 v70, v51, v2
    v_mul_f32 v71, v51, v3
    v_lshlrev_b32 v2, 16, v111
    v_and_b32 v3, 0xffff0000, v111
    v_mul_f32 v72, v51, v2
    v_mul_f32 v73, v51, v3
    v_lshlrev_b32 v2, 16, v112
    v_and_b32 v3, 0xffff0000, v112
    v_mul_f32 v74, v51, v2
    v_mul_f32 v75, v51, v3
    v_lshlrev_b32 v2, 16, v113
    v_and_b32 v3, 0xffff0000, v113
    v_mul_f32 v76, v51, v2
    v_mul_f32 v77, v51, v3
    s_add_u32 s48, s41, 6144
    buffer_load_dwordx4 v[102:105], v1, s[16:19], s48 offen offset:0 nt
    buffer_load_dwordx4 v[106:109], v1, s[16:19], s48 offen offset:128 nt
    buffer_load_dwordx4 v[110:113], v1, s[16:19], s48 offen offset:256 nt
    s_waitcnt vmcnt(18)
    v_lshlrev_b32 v2, 16, v114
    v_and_b32 v3, 0xffff0000, v114
    v_fmac_f32 v54, v52, v2
    v_fmac_f32 v55, v52, v3
    v_lshlrev_b32 v2, 16, v115
    v_and_b32 v3, 0xffff0000, v115
    v_fmac_f32 v56, v52, v2
    v_fmac_f32 v57, v52, v3
    v_lshlrev_b32 v2, 16, v116
    v_and_b32 v3, 0xffff0000, v116
    v_fmac_f32 v58, v52, v2
    v_fmac_f32 v59, v52, v3
    v_lshlrev_b32 v2, 16, v117
    v_and_b32 v3, 0xffff0000, v117
    v_fmac_f32 v60, v52, v2
    v_fmac_f32 v61, v52, v3
    v_lshlrev_b32 v2, 16, v118
    v_and_b32 v3, 0xffff0000, v118
    v_fmac_f32 v62, v52, v2
    v_fmac_f32 v63, v52, v3
    v_lshlrev_b32 v2, 16, v119
    v_and_b32 v3, 0xffff0000, v119
    v_fmac_f32 v64, v52, v2
    v_fmac_f32 v65, v52, v3
    v_lshlrev_b32 v2, 16, v120
    v_and_b32 v3, 0xffff0000, v120
    v_fmac_f32 v66, v52, v2
    v_fmac_f32 v67, v52, v3
    v_lshlrev_b32 v2, 16, v121
    v_and_b32 v3, 0xffff0000, v121
    v_fmac_f32 v68, v52, v2
    v_fmac_f32 v69, v52, v3
    v_lshlrev_b32 v2, 16, v122
    v_and_b32 v3, 0xffff0000, v122
    v_fmac_f32 v70, v52, v2
    v_fmac_f32 v71, v52, v3
    v_lshlrev_b32 v2, 16, v123
    v_and_b32 v3, 0xffff0000, v123
    v_fmac_f32 v72, v52, v2
    v_fmac_f32 v73, v52, v3
    v_lshlrev_b32 v2, 16, v124
    v_and_b32 v3, 0xffff0000, v124
    v_fmac_f32 v74, v52, v2
    v_fmac_f32 v75, v52, v3
    v_lshlrev_b32 v2, 16, v125
    v_and_b32 v3, 0xffff0000, v125
    v_fmac_f32 v76, v52, v2
    v_fmac_f32 v77, v52, v3
    s_add_u32 s48, s41, 9216
    buffer_load_dwordx4 v[114:117], v1, s[16:19], s48 offen offset:0 nt
    buffer_load_dwordx4 v[118:121], v1, s[16:19], s48 offen offset:128 nt
    buffer_load_dwordx4 v[122:125], v1, s[16:19], s48 offen offset:256 nt
    s_waitcnt vmcnt(18)
    v_lshlrev_b32 v2, 16, v10
    v_and_b32 v3, 0xffff0000, v10
    v_fmac_f32 v54, v53, v2
    v_fmac_f32 v55, v53, v3
    v_lshlrev_b32 v2, 16, v11
    v_and_b32 v3, 0xffff0000, v11
    v_fmac_f32 v56, v53, v2
    v_fmac_f32 v57, v53, v3
    v_lshlrev_b32 v2, 16, v12
    v_and_b32 v3, 0xffff0000, v12
    v_fmac_f32 v58, v53, v2
    v_fmac_f32 v59, v53, v3
    v_lshlrev_b32 v2, 16, v13
    v_and_b32 v3, 0xffff0000, v13
    v_fmac_f32 v60, v53, v2
    v_fmac_f32 v61, v53, v3
    v_lshlrev_b32 v2, 16, v14
    v_and_b32 v3, 0xffff0000, v14
    v_fmac_f32 v62, v53, v2
    v_fmac_f32 v63, v53, v3
    v_lshlrev_b32 v2, 16, v15
    v_and_b32 v3, 0xffff0000, v15
    v_fmac_f32 v64, v53, v2
    v_fmac_f32 v65, v53, v3
    v_lshlrev_b32 v2, 16, v16
    v_and_b32 v3, 0xffff0000, v16
    v_fmac_f32 v66, v53, v2
    v_fmac_f32 v67, v53, v3
    v_lshlrev_b32 v2, 16, v17
    v_and_b32 v3, 0xffff0000, v17
    v_fmac_f32 v68, v53, v2
    v_fmac_f32 v69, v53, v3
    v_lshlrev_b32 v2, 16, v18
    v_and_b32 v3, 0xffff0000, v18
    v_fmac_f32 v70, v53, v2
    v_fmac_f32 v71, v53, v3
    v_lshlrev_b32 v2, 16, v19
    v_and_b32 v3, 0xffff0000, v19
    v_fmac_f32 v72, v53, v2
    v_fmac_f32 v73, v53, v3
    v_lshlrev_b32 v2, 16, v20
    v_and_b32 v3, 0xffff0000, v20
    v_fmac_f32 v74, v53, v2
    v_fmac_f32 v75, v53, v3
    v_lshlrev_b32 v2, 16, v21
    v_and_b32 v3, 0xffff0000, v21
    v_fmac_f32 v76, v53, v2
    v_fmac_f32 v77, v53, v3
    s_waitcnt vmcnt(15)
    v_lshlrev_b32 v2, 16, v22
    v_and_b32 v3, 0xffff0000, v22
    v_fmac_f32 v54, v126, v2
    v_fmac_f32 v55, v126, v3
    v_lshlrev_b32 v2, 16, v23
    v_and_b32 v3, 0xffff0000, v23
    v_fmac_f32 v56, v126, v2
    v_fmac_f32 v57, v126, v3
    v_lshlrev_b32 v2, 16, v24
    v_and_b32 v3, 0xffff0000, v24
    v_fmac_f32 v58, v126, v2
    v_fmac_f32 v59, v126, v3
    v_lshlrev_b32 v2, 16, v25
    v_and_b32 v3, 0xffff0000, v25
    v_fmac_f32 v60, v126, v2
    v_fmac_f32 v61, v126, v3
    v_lshlrev_b32 v2, 16, v26
    v_and_b32 v3, 0xffff0000, v26
    v_fmac_f32 v62, v126, v2
    v_fmac_f32 v63, v126, v3
    v_lshlrev_b32 v2, 16, v27
    v_and_b32 v3, 0xffff0000, v27
    v_fmac_f32 v64, v126, v2
    v_fmac_f32 v65, v126, v3
    v_lshlrev_b32 v2, 16, v28
    v_and_b32 v3, 0xffff0000, v28
    v_fmac_f32 v66, v126, v2
    v_fmac_f32 v67, v126, v3
    v_lshlrev_b32 v2, 16, v29
    v_and_b32 v3, 0xffff0000, v29
    v_fmac_f32 v68, v126, v2
    v_fmac_f32 v69, v126, v3
    v_lshlrev_b32 v2, 16, v30
    v_and_b32 v3, 0xffff0000, v30
    v_fmac_f32 v70, v126, v2
    v_fmac_f32 v71, v126, v3
    v_lshlrev_b32 v2, 16, v31
    v_and_b32 v3, 0xffff0000, v31
    v_fmac_f32 v72, v126, v2
    v_fmac_f32 v73, v126, v3
    v_lshlrev_b32 v2, 16, v32
    v_and_b32 v3, 0xffff0000, v32
    v_fmac_f32 v74, v126, v2
    v_fmac_f32 v75, v126, v3
    v_lshlrev_b32 v2, 16, v33
    v_and_b32 v3, 0xffff0000, v33
    v_fmac_f32 v76, v126, v2
    v_fmac_f32 v77, v126, v3
    s_waitcnt vmcnt(12)
    v_lshlrev_b32 v2, 16, v34
    v_and_b32 v3, 0xffff0000, v34
    v_fmac_f32 v54, v127, v2
    v_fmac_f32 v55, v127, v3
    v_lshlrev_b32 v2, 16, v35
    v_and_b32 v3, 0xffff0000, v35
    v_fmac_f32 v56, v127, v2
    v_fmac_f32 v57, v127, v3
    v_lshlrev_b32 v2, 16, v36
    v_and_b32 v3, 0xffff0000, v36
    v_fmac_f32 v58, v127, v2
    v_fmac_f32 v59, v127, v3
    v_lshlrev_b32 v2, 16, v37
    v_and_b32 v3, 0xffff0000, v37
    v_fmac_f32 v60, v127, v2
    v_fmac_f32 v61, v127, v3
    v_lshlrev_b32 v2, 16, v38
    v_and_b32 v3, 0xffff0000, v38
    v_fmac_f32 v62, v127, v2
    v_fmac_f32 v63, v127, v3
    v_lshlrev_b32 v2, 16, v39
    v_and_b32 v3, 0xffff0000, v39
    v_fmac_f32 v64, v127, v2
    v_fmac_f32 v65, v127, v3
    v_lshlrev_b32 v2, 16, v40
    v_and_b32 v3, 0xffff0000, v40
    v_fmac_f32 v66, v127, v2
    v_fmac_f32 v67, v127, v3
    v_lshlrev_b32 v2, 16, v41
    v_and_b32 v3, 0xffff0000, v41
    v_fmac_f32 v68, v127, v2
    v_fmac_f32 v69, v127, v3
    v_lshlrev_b32 v2, 16, v42
    v_and_b32 v3, 0xffff0000, v42
    v_fmac_f32 v70, v127, v2
    v_fmac_f32 v71, v127, v3
    v_lshlrev_b32 v2, 16, v43
    v_and_b32 v3, 0xffff0000, v43
    v_fmac_f32 v72, v127, v2
    v_fmac_f32 v73, v127, v3
    v_lshlrev_b32 v2, 16, v44
    v_and_b32 v3, 0xffff0000, v44
    v_fmac_f32 v74, v127, v2
    v_fmac_f32 v75, v127, v3
    v_lshlrev_b32 v2, 16, v45
    v_and_b32 v3, 0xffff0000, v45
    v_fmac_f32 v76, v127, v2
    v_fmac_f32 v77, v127, v3
    s_nop 1
    v_permlane32_swap_b32 v54, v58
    v_permlane32_swap_b32 v55, v59
    v_permlane32_swap_b32 v56, v60
    v_permlane32_swap_b32 v57, v61
    v_permlane32_swap_b32 v62, v66
    v_permlane32_swap_b32 v63, v67
    v_permlane32_swap_b32 v64, v68
    v_permlane32_swap_b32 v65, v69
    v_permlane32_swap_b32 v70, v74
    v_permlane32_swap_b32 v71, v75
    v_permlane32_swap_b32 v72, v76
    v_permlane32_swap_b32 v73, v77
    v_add_f32 v54, v54, v58
    v_add_f32 v55, v55, v59
    v_add_f32 v56, v56, v60
    v_add_f32 v57, v57, v61
    v_add_f32 v62, v62, v66
    v_add_f32 v63, v63, v67
    v_add_f32 v64, v64, v68
    v_add_f32 v65, v65, v69
    v_add_f32 v70, v70, v74
    v_add_f32 v71, v71, v75
    v_add_f32 v72, v72, v76
    v_add_f32 v73, v73, v77
    s_nop 1
    v_permlane16_swap_b32 v54, v56
    v_permlane16_swap_b32 v55, v57
    v_permlane16_swap_b32 v62, v64
    v_permlane16_swap_b32 v63, v65
    v_permlane16_swap_b32 v70, v72
    v_permlane16_swap_b32 v71, v73
    v_add_f32 v54, v54, v56
    v_add_f32 v55, v55, v57
    v_add_f32 v62, v62, v64
    v_add_f32 v63, v63, v65
    v_add_f32 v70, v70, v72
    v_add_f32 v71, v71, v73
    s_nop 1
    v_add_f32_dpp v54, v54, v54 row_ror:8 row_mask:0xf bank_mask:0xf
    v_add_f32_dpp v55, v55, v55 row_ror:8 row_mask:0xf bank_mask:0xf
    v_add_f32_dpp v62, v62, v62 row_ror:8 row_mask:0xf bank_mask:0xf
    v_add_f32_dpp v63, v63, v63 row_ror:8 row_mask:0xf bank_mask:0xf
    v_add_f32_dpp v70, v70, v70 row_ror:8 row_mask:0xf bank_mask:0xf
    v_add_f32_dpp v71, v71, v71 row_ror:8 row_mask:0xf bank_mask:0xf
    v_lshrrev_b32 v2, 6, v0
    v_mul_u32_u24 v9, 768, v2
    v_and_b32 v2, 7, v6
    v_lshlrev_b32 v2, 5, v2
    v_add_u32 v9, v9, v2
    v_lshrrev_b32 v2, 5, v6
    v_lshlrev_b32 v2, 4, v2
    v_add_u32 v9, v9, v2
    v_bfe_u32 v2, v6, 4, 1
    v_lshlrev_b32 v2, 3, v2
    v_add_u32 v9, v9, v2
    ds_write_b64 v9, v[54:55] offset:0
    ds_write_b64 v9, v[62:63] offset:256
    ds_write_b64 v9, v[70:71] offset:512
    s_waitcnt lgkmcnt(0)
    s_barrier
    v_cmp_gt_u32 vcc, 192, v0
    s_and_saveexec_b64 s[100:101], vcc
    s_cbranch_execz L_q1
    v_lshlrev_b32 v2, 2, v0
    ds_read_b32 v54, v2 offset:0
    ds_read_b32 v55, v2 offset:768
    ds_read_b32 v56, v2 offset:1536
    ds_read_b32 v57, v2 offset:2304
    ds_read_b32 v58, v2 offset:3072
    ds_read_b32 v59, v2 offset:3840
    ds_read_b32 v60, v2 offset:4608
    ds_read_b32 v61, v2 offset:5376
    ds_read_b32 v62, v2 offset:6144
    ds_read_b32 v63, v2 offset:6912
    ds_read_b32 v64, v2 offset:7680
    ds_read_b32 v65, v2 offset:8448
    ds_read_b32 v66, v2 offset:9216
    ds_read_b32 v67, v2 offset:9984
    ds_read_b32 v68, v2 offset:10752
    ds_read_b32 v69, v2 offset:11520
    s_waitcnt lgkmcnt(0)
    v_add_f32 v54, v54, v55
    v_add_f32 v54, v54, v56
    v_add_f32 v54, v54, v57
    v_add_f32 v54, v54, v58
    v_add_f32 v54, v54, v59
    v_add_f32 v54, v54, v60
    v_add_f32 v54, v54, v61
    v_add_f32 v54, v54, v62
    v_add_f32 v54, v54, v63
    v_add_f32 v54, v54, v64
    v_add_f32 v54, v54, v65
    v_add_f32 v54, v54, v66
    v_add_f32 v54, v54, v67
    v_add_f32 v54, v54, v68
    v_add_f32 v54, v54, v69
    v_cvt_pk_bf16_f32 v54, v54, v54
    v_lshlrev_b32 v2, 1, v0
    ds_write_b16 v2, v54 offset:12288
    v_cmp_eq_u32 vcc, 0, v0
    s_and_b64 exec, exec, vcc
    s_cbranch_execz L_q2
    v_mov_b32 v3, 1
    v_mov_b32 v2, 4
    buffer_atomic_add v3, v2, s[36:39], 0 offen sc1
L_q2:
    s_waitcnt lgkmcnt(0)
L_q1:
    s_mov_b64 exec, s[100:101]
    s_barrier
    v_and_b32 v2, 7, v6
    v_lshlrev_b32 v2, 4, v2
    ds_read_b128 v[10:13], v2 offset:12288
    ds_read_b128 v[14:17], v2 offset:12416
    ds_read_b128 v[18:21], v2 offset:12544
    s_waitcnt lgkmcnt(0)
    v_mov_b32 v30, 0xff7fffff
    v_mov_b32 v31, 0
    v_mov_b32 v54, 0
    v_mov_b32 v55, 0
    v_mov_b32 v56, 0
    v_mov_b32 v57, 0
    v_mov_b32 v58, 0
    v_mov_b32 v59, 0
    v_mov_b32 v60, 0
    v_mov_b32 v61, 0
    v_mov_b32 v62, 0
    v_mov_b32 v63, 0
    v_mov_b32 v64, 0
    v_mov_b32 v65, 0
    v_mov_b32 v66, 0
    v_mov_b32 v67, 0
    v_mov_b32 v68, 0
    v_mov_b32 v69, 0
    v_mov_b32 v70, 0
    v_mov_b32 v71, 0
    v_mov_b32 v72, 0
    v_mov_b32 v73, 0
    v_mov_b32 v74, 0
    v_mov_b32 v75, 0
    v_mov_b32 v76, 0
    v_mov_b32 v77, 0
    v_mov_b32 v33, 12928
    v_mov_b32 v34, 1
    s_mov_b32 s52, 0x3fb8aa3b
L_loop:
    s_mov_b64 exec, 1
    ds_add_rtn_u32 v32, v33, v34
    s_mov_b64 exec, -1
    s_waitcnt vmcnt(9)
    v_dot2_f32_bf16 v2, v78, v10, 0
    v_dot2_f32_bf16 v3, v82, v14, 0
    v_dot2_f32_bf16 v4, v86, v18, 0
    v_dot2_f32_bf16 v2, v79, v11, v2
    v_dot2_f32_bf16 v3, v83, v15, v3
    v_dot2_f32_bf16 v4, v87, v19, v4
    v_dot2_f32_bf16 v2, v80, v12, v2
    v_dot2_f32_bf16 v3, v84, v16, v3
    v_dot2_f32_bf16 v4, v88, v20, v4
    v_dot2_f32_bf16 v2, v81, v13, v2
    v_dot2_f32_bf16 v3, v85, v17, v3
    v_dot2_f32_bf16 v4, v89, v21, v4
    s_add_u32 s48, s41, 12288
    buffer_load_dwordx4 v[78:81], v1, s[16:19], s48 offen offset:0 nt
    buffer_load_dwordx4 v[82:85], v1, s[16:19], s48 offen offset:128 nt
    buffer_load_dwordx4 v[86:89], v1, s[16:19], s48 offen offset:256 nt
    v_add_f32 v2, v2, v3
    v_add_f32 v2, v2, v4
    s_nop 1
    v_add_f32_dpp v2, v2, v2 quad_perm:[1,0,3,2] row_mask:0xf bank_mask:0xf
    s_nop 1
    v_add_f32_dpp v2, v2, v2 quad_perm:[2,3,0,1] row_mask:0xf bank_mask:0xf
    s_nop 1
    v_add_f32_dpp v2, v2, v2 row_half_mirror row_mask:0xf bank_mask:0xf
    v_cvt_pk_bf16_f32 v2, v2, v2
    v_lshlrev_b32 v2, 16, v2
    v_mul_f32 v2, 0x3d93cd3a, v2
    v_cvt_pk_bf16_f32 v2, v2, v2
    v_lshlrev_b32 v22, 16, v2
    s_waitcnt vmcnt(9)
    v_dot2_f32_bf16 v2, v90, v10, 0
    v_dot2_f32_bf16 v3, v94, v14, 0
    v_dot2_f32_bf16 v4, v98, v18, 0
    v_dot2_f32_bf16 v2, v91, v11, v2
    v_dot2_f32_bf16 v3, v95, v15, v3
    v_dot2_f32_bf16 v4, v99, v19, v4
    v_dot2_f32_bf16 v2, v92, v12, v2
    v_dot2_f32_bf16 v3, v96, v16, v3
    v_dot2_f32_bf16 v4, v100, v20, v4
    v_dot2_f32_bf16 v2, v93, v13, v2
    v_dot2_f32_bf16 v3, v97, v17, v3
    v_dot2_f32_bf16 v4, v101, v21, v4
    s_add_u32 s48, s41, 15360
    buffer_load_dwordx4 v[90:93], v1, s[16:19], s48 offen offset:0 nt
    buffer_load_dwordx4 v[94:97], v1, s[16:19], s48 offen offset:128 nt
    buffer_load_dwordx4 v[98:101], v1, s[16:19], s48 offen offset:256 nt
    v_add_f32 v2, v2, v3
    v_add_f32 v2, v2, v4
    s_nop 1
    v_add_f32_dpp v2, v2, v2 quad_perm:[1,0,3,2] row_mask:0xf bank_mask:0xf
    s_nop 1
    v_add_f32_dpp v2, v2, v2 quad_perm:[2,3,0,1] row_mask:0xf bank_mask:0xf
    s_nop 1
    v_add_f32_dpp v2, v2, v2 row_half_mirror row_mask:0xf bank_mask:0xf
    v_cvt_pk_bf16_f32 v2, v2, v2
    v_lshlrev_b32 v2, 16, v2
    v_mul_f32 v2, 0x3d93cd3a, v2
    v_cvt_pk_bf16_f32 v2, v2, v2
    v_lshlrev_b32 v23, 16, v2
    s_waitcnt vmcnt(9)
    v_dot2_f32_bf16 v2, v102, v10, 0
    v_dot2_f32_bf16 v3, v106, v14, 0
    v_dot2_f32_bf16 v4, v110, v18, 0
    v_dot2_f32_bf16 v2, v103, v11, v2
    v_dot2_f32_bf16 v3, v107, v15, v3
    v_dot2_f32_bf16 v4, v111, v19, v4
    v_dot2_f32_bf16 v2, v104, v12, v2
    v_dot2_f32_bf16 v3, v108, v16, v3
    v_dot2_f32_bf16 v4, v112, v20, v4
    v_dot2_f32_bf16 v2, v105, v13, v2
    v_dot2_f32_bf16 v3, v109, v17, v3
    v_dot2_f32_bf16 v4, v113, v21, v4
    s_add_u32 s48, s41, 18432
    buffer_load_dwordx4 v[102:105], v1, s[16:19], s48 offen offset:0 nt
    buffer_load_dwordx4 v[106:109], v1, s[16:19], s48 offen offset:128 nt
    buffer_load_dwordx4 v[110:113], v1, s[16:19], s48 offen offset:256 nt
    v_add_f32 v2, v2, v3
    v_add_f32 v2, v2, v4
    s_nop 1
    v_add_f32_dpp v2, v2, v2 quad_perm:[1,0,3,2] row_mask:0xf bank_mask:0xf
    s_nop 1
    v_add_f32_dpp v2, v2, v2 quad_perm:[2,3,0,1] row_mask:0xf bank_mask:0xf
    s_nop 1
    v_add_f32_dpp v2, v2, v2 row_half_mirror row_mask:0xf bank_mask:0xf
    v_cvt_pk_bf16_f32 v2, v2, v2
    v_lshlrev_b32 v2, 16, v2
    v_mul_f32 v2, 0x3d93cd3a, v2
    v_cvt_pk_bf16_f32 v2, v2, v2
    v_lshlrev_b32 v24, 16, v2
    s_waitcnt lgkmcnt(0)
    v_readfirstlane_b32 s49, v32
    s_mul_i32 s47, s49, 24576
    s_waitcnt vmcnt(9)
    v_dot2_f32_bf16 v2, v114, v10, 0
    v_dot2_f32_bf16 v3, v118, v14, 0
    v_dot2_f32_bf16 v4, v122, v18, 0
    v_dot2_f32_bf16 v2, v115, v11, v2
    v_dot2_f32_bf16 v3, v119, v15, v3
    v_dot2_f32_bf16 v4, v123, v19, v4
    v_dot2_f32_bf16 v2, v116, v12, v2
    v_dot2_f32_bf16 v3, v120, v16, v3
    v_dot2_f32_bf16 v4, v124, v20, v4
    v_dot2_f32_bf16 v2, v117, v13, v2
    v_dot2_f32_bf16 v3, v121, v17, v3
    v_dot2_f32_bf16 v4, v125, v21, v4
    s_add_u32 s48, s41, 21504
    buffer_load_dwordx4 v[114:117], v1, s[16:19], s48 offen offset:0 nt
    buffer_load_dwordx4 v[118:121], v1, s[16:19], s48 offen offset:128 nt
    buffer_load_dwordx4 v[122:125], v1, s[16:19], s48 offen offset:256 nt
    v_add_f32 v2, v2, v3
    v_add_f32 v2, v2, v4
    s_nop 1
    v_add_f32_dpp v2, v2, v2 quad_perm:[1,0,3,2] row_mask:0xf bank_mask:0xf
    s_nop 1
    v_add_f32_dpp v2, v2, v2 quad_perm:[2,3,0,1] row_mask:0xf bank_mask:0xf
    s_nop 1
    v_add_f32_dpp v2, v2, v2 row_half_mirror row_mask:0xf bank_mask:0xf
    v_cvt_pk_bf16_f32 v2, v2, v2
    v_lshlrev_b32 v2, 16, v2
    v_mul_f32 v2, 0x3d93cd3a, v2
    v_cvt_pk_bf16_f32 v2, v2, v2
    v_lshlrev_b32 v25, 16, v2
    s_waitcnt vmcnt(9)
    v_dot2_f32_bf16 v2, v78, v10, 0
    v_dot2_f32_bf16 v3, v82, v14, 0
    v_dot2_f32_bf16 v4, v86, v18, 0
    v_dot2_f32_bf16 v2, v79, v11, v2
    v_dot2_f32_bf16 v3, v83, v15, v3
    v_dot2_f32_bf16 v4, v87, v19, v4
    v_dot2_f32_bf16 v2, v80, v12, v2
    v_dot2_f32_bf16 v3, v84, v16, v3
    v_dot2_f32_bf16 v4, v88, v20, v4
    v_dot2_f32_bf16 v2, v81, v13, v2
    v_dot2_f32_bf16 v3, v85, v17, v3
    v_dot2_f32_bf16 v4, v89, v21, v4
    s_add_u32 s48, s41, 0
    buffer_load_dwordx4 v[78:81], v1, s[20:23], s48 offen offset:0 nt
    buffer_load_dwordx4 v[82:85], v1, s[20:23], s48 offen offset:128 nt
    buffer_load_dwordx4 v[86:89], v1, s[20:23], s48 offen offset:256 nt
    v_add_f32 v2, v2, v3
    v_add_f32 v2, v2, v4
    s_nop 1
    v_add_f32_dpp v2, v2, v2 quad_perm:[1,0,3,2] row_mask:0xf bank_mask:0xf
    s_nop 1
    v_add_f32_dpp v2, v2, v2 quad_perm:[2,3,0,1] row_mask:0xf bank_mask:0xf
    s_nop 1
    v_add_f32_dpp v2, v2, v2 row_half_mirror row_mask:0xf bank_mask:0xf
    v_cvt_pk_bf16_f32 v2, v2, v2
    v_lshlrev_b32 v2, 16, v2
    v_mul_f32 v2, 0x3d93cd3a, v2
    v_cvt_pk_bf16_f32 v2, v2, v2
    v_lshlrev_b32 v26, 16, v2
    s_waitcnt vmcnt(9)
    v_dot2_f32_bf16 v2, v90, v10, 0
    v_dot2_f32_bf16 v3, v94, v14, 0
    v_dot2_f32_bf16 v4, v98, v18, 0
    v_dot2_f32_bf16 v2, v91, v11, v2
    v_dot2_f32_bf16 v3, v95, v15, v3
    v_dot2_f32_bf16 v4, v99, v19, v4
    v_dot2_f32_bf16 v2, v92, v12, v2
    v_dot2_f32_bf16 v3, v96, v16, v3
    v_dot2_f32_bf16 v4, v100, v20, v4
    v_dot2_f32_bf16 v2, v93, v13, v2
    v_dot2_f32_bf16 v3, v97, v17, v3
    v_dot2_f32_bf16 v4, v101, v21, v4
    s_add_u32 s48, s41, 3072
    buffer_load_dwordx4 v[90:93], v1, s[20:23], s48 offen offset:0 nt
    buffer_load_dwordx4 v[94:97], v1, s[20:23], s48 offen offset:128 nt
    buffer_load_dwordx4 v[98:101], v1, s[20:23], s48 offen offset:256 nt
    v_add_f32 v2, v2, v3
    v_add_f32 v2, v2, v4
    s_nop 1
    v_add_f32_dpp v2, v2, v2 quad_perm:[1,0,3,2] row_mask:0xf bank_mask:0xf
    s_nop 1
    v_add_f32_dpp v2, v2, v2 quad_perm:[2,3,0,1] row_mask:0xf bank_mask:0xf
    s_nop 1
    v_add_f32_dpp v2, v2, v2 row_half_mirror row_mask:0xf bank_mask:0xf
    v_cvt_pk_bf16_f32 v2, v2, v2
    v_lshlrev_b32 v2, 16, v2
    v_mul_f32 v2, 0x3d93cd3a, v2
    v_cvt_pk_bf16_f32 v2, v2, v2
    v_lshlrev_b32 v27, 16, v2
    s_waitcnt vmcnt(9)
    v_dot2_f32_bf16 v2, v102, v10, 0
    v_dot2_f32_bf16 v3, v106, v14, 0
    v_dot2_f32_bf16 v4, v110, v18, 0
    v_dot2_f32_bf16 v2, v103, v11, v2
    v_dot2_f32_bf16 v3, v107, v15, v3
    v_dot2_f32_bf16 v4, v111, v19, v4
    v_dot2_f32_bf16 v2, v104, v12, v2
    v_dot2_f32_bf16 v3, v108, v16, v3
    v_dot2_f32_bf16 v4, v112, v20, v4
    v_dot2_f32_bf16 v2, v105, v13, v2
    v_dot2_f32_bf16 v3, v109, v17, v3
    v_dot2_f32_bf16 v4, v113, v21, v4
    s_add_u32 s48, s41, 6144
    buffer_load_dwordx4 v[102:105], v1, s[20:23], s48 offen offset:0 nt
    buffer_load_dwordx4 v[106:109], v1, s[20:23], s48 offen offset:128 nt
    buffer_load_dwordx4 v[110:113], v1, s[20:23], s48 offen offset:256 nt
    v_add_f32 v2, v2, v3
    v_add_f32 v2, v2, v4
    s_nop 1
    v_add_f32_dpp v2, v2, v2 quad_perm:[1,0,3,2] row_mask:0xf bank_mask:0xf
    s_nop 1
    v_add_f32_dpp v2, v2, v2 quad_perm:[2,3,0,1] row_mask:0xf bank_mask:0xf
    s_nop 1
    v_add_f32_dpp v2, v2, v2 row_half_mirror row_mask:0xf bank_mask:0xf
    v_cvt_pk_bf16_f32 v2, v2, v2
    v_lshlrev_b32 v2, 16, v2
    v_mul_f32 v2, 0x3d93cd3a, v2
    v_cvt_pk_bf16_f32 v2, v2, v2
    v_lshlrev_b32 v28, 16, v2
    s_waitcnt vmcnt(9)
    v_dot2_f32_bf16 v2, v114, v10, 0
    v_dot2_f32_bf16 v3, v118, v14, 0
    v_dot2_f32_bf16 v4, v122, v18, 0
    v_dot2_f32_bf16 v2, v115, v11, v2
    v_dot2_f32_bf16 v3, v119, v15, v3
    v_dot2_f32_bf16 v4, v123, v19, v4
    v_dot2_f32_bf16 v2, v116, v12, v2
    v_dot2_f32_bf16 v3, v120, v16, v3
    v_dot2_f32_bf16 v4, v124, v20, v4
    v_dot2_f32_bf16 v2, v117, v13, v2
    v_dot2_f32_bf16 v3, v121, v17, v3
    v_dot2_f32_bf16 v4, v125, v21, v4
    s_add_u32 s48, s41, 9216
    buffer_load_dwordx4 v[114:117], v1, s[20:23], s48 offen offset:0 nt
    buffer_load_dwordx4 v[118:121], v1, s[20:23], s48 offen offset:128 nt
    buffer_load_dwordx4 v[122:125], v1, s[20:23], s48 offen offset:256 nt
    v_add_f32 v2, v2, v3
    v_add_f32 v2, v2, v4
    s_nop 1
    v_add_f32_dpp v2, v2, v2 quad_perm:[1,0,3,2] row_mask:0xf bank_mask:0xf
    s_nop 1
    v_add_f32_dpp v2, v2, v2 quad_perm:[2,3,0,1] row_mask:0xf bank_mask:0xf
    s_nop 1
    v_add_f32_dpp v2, v2, v2 row_half_mirror row_mask:0xf bank_mask:0xf
    v_cvt_pk_bf16_f32 v2, v2, v2
    v_lshlrev_b32 v2, 16, v2
    v_mul_f32 v2, 0x3d93cd3a, v2
    v_cvt_pk_bf16_f32 v2, v2, v2
    v_lshlrev_b32 v29, 16, v2
    v_max3_f32 v2, v22, v23, v24
    v_max3_f32 v2, v2, v25, v26
    v_max3_f32 v2, v2, v27, v28
    v_max_f32 v2, v2, v29
    s_nop 1
    v_max_f32_dpp v2, v2, v2 row_ror:8 row_mask:0xf bank_mask:0xf
    s_nop 1
    v_readlane_b32 s48, v2, 0
    v_readlane_b32 s49, v2, 16
    v_readlane_b32 s50, v2, 32
    v_readlane_b32 s51, v2, 48
    s_nop 1
    v_mov_b32 v2, s48
    v_max_f32 v2, s49, v2
    v_max_f32 v2, s50, v2
    v_max_f32 v2, s51, v2
    v_max_f32 v2, v2, v30
    v_sub_f32 v3, v30, v2
    v_mul_f32 v3, s52, v3
    v_exp_f32 v3, v3
    v_mov_b32 v30, v2
    v_mul_f32 v4, s52, v2
    v_fma_f32 v22, v22, s52, -v4
    v_exp_f32 v22, v22
    v_fma_f32 v23, v23, s52, -v4
    v_exp_f32 v23, v23
    v_fma_f32 v24, v24, s52, -v4
    v_exp_f32 v24, v24
    v_fma_f32 v25, v25, s52, -v4
    v_exp_f32 v25, v25
    v_fma_f32 v26, v26, s52, -v4
    v_exp_f32 v26, v26
    v_fma_f32 v27, v27, s52, -v4
    v_exp_f32 v27, v27
    v_fma_f32 v28, v28, s52, -v4
    v_exp_f32 v28, v28
    v_fma_f32 v29, v29, s52, -v4
    v_exp_f32 v29, v29
    v_mul_f32 v31, v31, v3
    v_mul_f32 v54, v54, v3
    v_mul_f32 v55, v55, v3
    v_mul_f32 v56, v56, v3
    v_mul_f32 v57, v57, v3
    v_mul_f32 v58, v58, v3
    v_mul_f32 v59, v59, v3
    v_mul_f32 v60, v60, v3
    v_mul_f32 v61, v61, v3
    v_mul_f32 v62, v62, v3
    v_mul_f32 v63, v63, v3
    v_mul_f32 v64, v64, v3
    v_mul_f32 v65, v65, v3
    v_mul_f32 v66, v66, v3
    v_mul_f32 v67, v67, v3
    v_mul_f32 v68, v68, v3
    v_mul_f32 v69, v69, v3
    v_mul_f32 v70, v70, v3
    v_mul_f32 v71, v71, v3
    v_mul_f32 v72, v72, v3
    v_mul_f32 v73, v73, v3
    v_mul_f32 v74, v74, v3
    v_mul_f32 v75, v75, v3
    v_mul_f32 v76, v76, v3
    v_mul_f32 v77, v77, v3
    v_add_f32 v31, v31, v22
    v_add_f32 v31, v31, v23
    v_add_f32 v31, v31, v24
    v_add_f32 v31, v31, v25
    v_add_f32 v31, v31, v26
    v_add_f32 v31, v31, v27
    v_add_f32 v31, v31, v28
    v_add_f32 v31, v31, v29
    s_waitcnt vmcnt(9)
    v_lshlrev_b32 v4, 16, v78
    v_and_b32 v5, 0xffff0000, v78
    v_fmac_f32 v54, v22, v4
    v_fmac_f32 v55, v22, v5
    v_lshlrev_b32 v4, 16, v79
    v_and_b32 v5, 0xffff0000, v79
    v_fmac_f32 v56, v22, v4
    v_fmac_f32 v57, v22, v5
    v_lshlrev_b32 v4, 16, v80
    v_and_b32 v5, 0xffff0000, v80
    v_fmac_f32 v58, v22, v4
    v_fmac_f32 v59, v22, v5
    v_lshlrev_b32 v4, 16, v81
    v_and_b32 v5, 0xffff0000, v81
    v_fmac_f32 v60, v22, v4
    v_fmac_f32 v61, v22, v5
    v_lshlrev_b32 v4, 16, v82
    v_and_b32 v5, 0xffff0000, v82
    v_fmac_f32 v62, v22, v4
    v_fmac_f32 v63, v22, v5
    v_lshlrev_b32 v4, 16, v83
    v_and_b32 v5, 0xffff0000, v83
    v_fmac_f32 v64, v22, v4
    v_fmac_f32 v65, v22, v5
    v_lshlrev_b32 v4, 16, v84
    v_and_b32 v5, 0xffff0000, v84
    v_fmac_f32 v66, v22, v4
    v_fmac_f32 v67, v22, v5
    v_lshlrev_b32 v4, 16, v85
    v_and_b32 v5, 0xffff0000, v85
    v_fmac_f32 v68, v22, v4
    v_fmac_f32 v69, v22, v5
    v_lshlrev_b32 v4, 16, v86
    v_and_b32 v5, 0xffff0000, v86
    v_fmac_f32 v70, v22, v4
    v_fmac_f32 v71, v22, v5
    v_lshlrev_b32 v4, 16, v87
    v_and_b32 v5, 0xffff0000, v87
    v_fmac_f32 v72, v22, v4
    v_fmac_f32 v73, v22, v5
    v_lshlrev_b32 v4, 16, v88
    v_and_b32 v5, 0xffff0000, v88
    v_fmac_f32 v74, v22, v4
    v_fmac_f32 v75, v22, v5
    v_lshlrev_b32 v4, 16, v89
    v_and_b32 v5, 0xffff0000, v89
    v_fmac_f32 v76, v22, v4
    v_fmac_f32 v77, v22, v5
    s_add_u32 s48, s41, 12288
    buffer_load_dwordx4 v[78:81], v1, s[20:23], s48 offen offset:0 nt
    buffer_load_dwordx4 v[82:85], v1, s[20:23], s48 offen offset:128 nt
    buffer_load_dwordx4 v[86:89], v1, s[20:23], s48 offen offset:256 nt
    s_waitcnt vmcnt(9)
    v_lshlrev_b32 v4, 16, v90
    v_and_b32 v5, 0xffff0000, v90
    v_fmac_f32 v54, v23, v4
    v_fmac_f32 v55, v23, v5
    v_lshlrev_b32 v4, 16, v91
    v_and_b32 v5, 0xffff0000, v91
    v_fmac_f32 v56, v23, v4
    v_fmac_f32 v57, v23, v5
    v_lshlrev_b32 v4, 16, v92
    v_and_b32 v5, 0xffff0000, v92
    v_fmac_f32 v58, v23, v4
    v_fmac_f32 v59, v23, v5
    v_lshlrev_b32 v4, 16, v93
    v_and_b32 v5, 0xffff0000, v93
    v_fmac_f32 v60, v23, v4
    v_fmac_f32 v61, v23, v5
    v_lshlrev_b32 v4, 16, v94
    v_and_b32 v5, 0xffff0000, v94
    v_fmac_f32 v62, v23, v4
    v_fmac_f32 v63, v23, v5
    v_lshlrev_b32 v4, 16, v95
    v_and_b32 v5, 0xffff0000, v95
    v_fmac_f32 v64, v23, v4
    v_fmac_f32 v65, v23, v5
    v_lshlrev_b32 v4, 16, v96
    v_and_b32 v5, 0xffff0000, v96
    v_fmac_f32 v66, v23, v4
    v_fmac_f32 v67, v23, v5
    v_lshlrev_b32 v4, 16, v97
    v_and_b32 v5, 0xffff0000, v97
    v_fmac_f32 v68, v23, v4
    v_fmac_f32 v69, v23, v5
    v_lshlrev_b32 v4, 16, v98
    v_and_b32 v5, 0xffff0000, v98
    v_fmac_f32 v70, v23, v4
    v_fmac_f32 v71, v23, v5
    v_lshlrev_b32 v4, 16, v99
    v_and_b32 v5, 0xffff0000, v99
    v_fmac_f32 v72, v23, v4
    v_fmac_f32 v73, v23, v5
    v_lshlrev_b32 v4, 16, v100
    v_and_b32 v5, 0xffff0000, v100
    v_fmac_f32 v74, v23, v4
    v_fmac_f32 v75, v23, v5
    v_lshlrev_b32 v4, 16, v101
    v_and_b32 v5, 0xffff0000, v101
    v_fmac_f32 v76, v23, v4
    v_fmac_f32 v77, v23, v5
    s_add_u32 s48, s41, 15360
    buffer_load_dwordx4 v[90:93], v1, s[20:23], s48 offen offset:0 nt
    buffer_load_dwordx4 v[94:97], v1, s[20:23], s48 offen offset:128 nt
    buffer_load_dwordx4 v[98:101], v1, s[20:23], s48 offen offset:256 nt
    s_waitcnt vmcnt(9)
    v_lshlrev_b32 v4, 16, v102
    v_and_b32 v5, 0xffff0000, v102
    v_fmac_f32 v54, v24, v4
    v_fmac_f32 v55, v24, v5
    v_lshlrev_b32 v4, 16, v103
    v_and_b32 v5, 0xffff0000, v103
    v_fmac_f32 v56, v24, v4
    v_fmac_f32 v57, v24, v5
    v_lshlrev_b32 v4, 16, v104
    v_and_b32 v5, 0xffff0000, v104
    v_fmac_f32 v58, v24, v4
    v_fmac_f32 v59, v24, v5
    v_lshlrev_b32 v4, 16, v105
    v_and_b32 v5, 0xffff0000, v105
    v_fmac_f32 v60, v24, v4
    v_fmac_f32 v61, v24, v5
    v_lshlrev_b32 v4, 16, v106
    v_and_b32 v5, 0xffff0000, v106
    v_fmac_f32 v62, v24, v4
    v_fmac_f32 v63, v24, v5
    v_lshlrev_b32 v4, 16, v107
    v_and_b32 v5, 0xffff0000, v107
    v_fmac_f32 v64, v24, v4
    v_fmac_f32 v65, v24, v5
    v_lshlrev_b32 v4, 16, v108
    v_and_b32 v5, 0xffff0000, v108
    v_fmac_f32 v66, v24, v4
    v_fmac_f32 v67, v24, v5
    v_lshlrev_b32 v4, 16, v109
    v_and_b32 v5, 0xffff0000, v109
    v_fmac_f32 v68, v24, v4
    v_fmac_f32 v69, v24, v5
    v_lshlrev_b32 v4, 16, v110
    v_and_b32 v5, 0xffff0000, v110
    v_fmac_f32 v70, v24, v4
    v_fmac_f32 v71, v24, v5
    v_lshlrev_b32 v4, 16, v111
    v_and_b32 v5, 0xffff0000, v111
    v_fmac_f32 v72, v24, v4
    v_fmac_f32 v73, v24, v5
    v_lshlrev_b32 v4, 16, v112
    v_and_b32 v5, 0xffff0000, v112
    v_fmac_f32 v74, v24, v4
    v_fmac_f32 v75, v24, v5
    v_lshlrev_b32 v4, 16, v113
    v_and_b32 v5, 0xffff0000, v113
    v_fmac_f32 v76, v24, v4
    v_fmac_f32 v77, v24, v5
    s_add_u32 s48, s41, 18432
    buffer_load_dwordx4 v[102:105], v1, s[20:23], s48 offen offset:0 nt
    buffer_load_dwordx4 v[106:109], v1, s[20:23], s48 offen offset:128 nt
    buffer_load_dwordx4 v[110:113], v1, s[20:23], s48 offen offset:256 nt
    s_waitcnt vmcnt(9)
    v_lshlrev_b32 v4, 16, v114
    v_and_b32 v5, 0xffff0000, v114
    v_fmac_f32 v54, v25, v4
    v_fmac_f32 v55, v25, v5
    v_lshlrev_b32 v4, 16, v115
    v_and_b32 v5, 0xffff0000, v115
    v_fmac_f32 v56, v25, v4
    v_fmac_f32 v57, v25, v5
    v_lshlrev_b32 v4, 16, v116
    v_and_b32 v5, 0xffff0000, v116
    v_fmac_f32 v58, v25, v4
    v_fmac_f32 v59, v25, v5
    v_lshlrev_b32 v4, 16, v117
    v_and_b32 v5, 0xffff0000, v117
    v_fmac_f32 v60, v25, v4
    v_fmac_f32 v61, v25, v5
    v_lshlrev_b32 v4, 16, v118
    v_and_b32 v5, 0xffff0000, v118
    v_fmac_f32 v62, v25, v4
    v_fmac_f32 v63, v25, v5
    v_lshlrev_b32 v4, 16, v119
    v_and_b32 v5, 0xffff0000, v119
    v_fmac_f32 v64, v25, v4
    v_fmac_f32 v65, v25, v5
    v_lshlrev_b32 v4, 16, v120
    v_and_b32 v5, 0xffff0000, v120
    v_fmac_f32 v66, v25, v4
    v_fmac_f32 v67, v25, v5
    v_lshlrev_b32 v4, 16, v121
    v_and_b32 v5, 0xffff0000, v121
    v_fmac_f32 v68, v25, v4
    v_fmac_f32 v69, v25, v5
    v_lshlrev_b32 v4, 16, v122
    v_and_b32 v5, 0xffff0000, v122
    v_fmac_f32 v70, v25, v4
    v_fmac_f32 v71, v25, v5
    v_lshlrev_b32 v4, 16, v123
    v_and_b32 v5, 0xffff0000, v123
    v_fmac_f32 v72, v25, v4
    v_fmac_f32 v73, v25, v5
    v_lshlrev_b32 v4, 16, v124
    v_and_b32 v5, 0xffff0000, v124
    v_fmac_f32 v74, v25, v4
    v_fmac_f32 v75, v25, v5
    v_lshlrev_b32 v4, 16, v125
    v_and_b32 v5, 0xffff0000, v125
    v_fmac_f32 v76, v25, v4
    v_fmac_f32 v77, v25, v5
    s_add_u32 s48, s41, 21504
    buffer_load_dwordx4 v[114:117], v1, s[20:23], s48 offen offset:0 nt
    buffer_load_dwordx4 v[118:121], v1, s[20:23], s48 offen offset:128 nt
    buffer_load_dwordx4 v[122:125], v1, s[20:23], s48 offen offset:256 nt
    s_waitcnt vmcnt(9)
    v_lshlrev_b32 v4, 16, v78
    v_and_b32 v5, 0xffff0000, v78
    v_fmac_f32 v54, v26, v4
    v_fmac_f32 v55, v26, v5
    v_lshlrev_b32 v4, 16, v79
    v_and_b32 v5, 0xffff0000, v79
    v_fmac_f32 v56, v26, v4
    v_fmac_f32 v57, v26, v5
    v_lshlrev_b32 v4, 16, v80
    v_and_b32 v5, 0xffff0000, v80
    v_fmac_f32 v58, v26, v4
    v_fmac_f32 v59, v26, v5
    v_lshlrev_b32 v4, 16, v81
    v_and_b32 v5, 0xffff0000, v81
    v_fmac_f32 v60, v26, v4
    v_fmac_f32 v61, v26, v5
    v_lshlrev_b32 v4, 16, v82
    v_and_b32 v5, 0xffff0000, v82
    v_fmac_f32 v62, v26, v4
    v_fmac_f32 v63, v26, v5
    v_lshlrev_b32 v4, 16, v83
    v_and_b32 v5, 0xffff0000, v83
    v_fmac_f32 v64, v26, v4
    v_fmac_f32 v65, v26, v5
    v_lshlrev_b32 v4, 16, v84
    v_and_b32 v5, 0xffff0000, v84
    v_fmac_f32 v66, v26, v4
    v_fmac_f32 v67, v26, v5
    v_lshlrev_b32 v4, 16, v85
    v_and_b32 v5, 0xffff0000, v85
    v_fmac_f32 v68, v26, v4
    v_fmac_f32 v69, v26, v5
    v_lshlrev_b32 v4, 16, v86
    v_and_b32 v5, 0xffff0000, v86
    v_fmac_f32 v70, v26, v4
    v_fmac_f32 v71, v26, v5
    v_lshlrev_b32 v4, 16, v87
    v_and_b32 v5, 0xffff0000, v87
    v_fmac_f32 v72, v26, v4
    v_fmac_f32 v73, v26, v5
    v_lshlrev_b32 v4, 16, v88
    v_and_b32 v5, 0xffff0000, v88
    v_fmac_f32 v74, v26, v4
    v_fmac_f32 v75, v26, v5
    v_lshlrev_b32 v4, 16, v89
    v_and_b32 v5, 0xffff0000, v89
    v_fmac_f32 v76, v26, v4
    v_fmac_f32 v77, v26, v5
    s_add_u32 s48, s47, 0
    buffer_load_dwordx4 v[78:81], v1, s[16:19], s48 offen offset:0 nt
    buffer_load_dwordx4 v[82:85], v1, s[16:19], s48 offen offset:128 nt
    buffer_load_dwordx4 v[86:89], v1, s[16:19], s48 offen offset:256 nt
    s_waitcnt vmcnt(9)
    v_lshlrev_b32 v4, 16, v90
    v_and_b32 v5, 0xffff0000, v90
    v_fmac_f32 v54, v27, v4
    v_fmac_f32 v55, v27, v5
    v_lshlrev_b32 v4, 16, v91
    v_and_b32 v5, 0xffff0000, v91
    v_fmac_f32 v56, v27, v4
    v_fmac_f32 v57, v27, v5
    v_lshlrev_b32 v4, 16, v92
    v_and_b32 v5, 0xffff0000, v92
    v_fmac_f32 v58, v27, v4
    v_fmac_f32 v59, v27, v5
    v_lshlrev_b32 v4, 16, v93
    v_and_b32 v5, 0xffff0000, v93
    v_fmac_f32 v60, v27, v4
    v_fmac_f32 v61, v27, v5
    v_lshlrev_b32 v4, 16, v94
    v_and_b32 v5, 0xffff0000, v94
    v_fmac_f32 v62, v27, v4
    v_fmac_f32 v63, v27, v5
    v_lshlrev_b32 v4, 16, v95
    v_and_b32 v5, 0xffff0000, v95
    v_fmac_f32 v64, v27, v4
    v_fmac_f32 v65, v27, v5
    v_lshlrev_b32 v4, 16, v96
    v_and_b32 v5, 0xffff0000, v96
    v_fmac_f32 v66, v27, v4
    v_fmac_f32 v67, v27, v5
    v_lshlrev_b32 v4, 16, v97
    v_and_b32 v5, 0xffff0000, v97
    v_fmac_f32 v68, v27, v4
    v_fmac_f32 v69, v27, v5
    v_lshlrev_b32 v4, 16, v98
    v_and_b32 v5, 0xffff0000, v98
    v_fmac_f32 v70, v27, v4
    v_fmac_f32 v71, v27, v5
    v_lshlrev_b32 v4, 16, v99
    v_and_b32 v5, 0xffff0000, v99
    v_fmac_f32 v72, v27, v4
    v_fmac_f32 v73, v27, v5
    v_lshlrev_b32 v4, 16, v100
    v_and_b32 v5, 0xffff0000, v100
    v_fmac_f32 v74, v27, v4
    v_fmac_f32 v75, v27, v5
    v_lshlrev_b32 v4, 16, v101
    v_and_b32 v5, 0xffff0000, v101
    v_fmac_f32 v76, v27, v4
    v_fmac_f32 v77, v27, v5
    s_add_u32 s48, s47, 3072
    buffer_load_dwordx4 v[90:93], v1, s[16:19], s48 offen offset:0 nt
    buffer_load_dwordx4 v[94:97], v1, s[16:19], s48 offen offset:128 nt
    buffer_load_dwordx4 v[98:101], v1, s[16:19], s48 offen offset:256 nt
    s_waitcnt vmcnt(9)
    v_lshlrev_b32 v4, 16, v102
    v_and_b32 v5, 0xffff0000, v102
    v_fmac_f32 v54, v28, v4
    v_fmac_f32 v55, v28, v5
    v_lshlrev_b32 v4, 16, v103
    v_and_b32 v5, 0xffff0000, v103
    v_fmac_f32 v56, v28, v4
    v_fmac_f32 v57, v28, v5
    v_lshlrev_b32 v4, 16, v104
    v_and_b32 v5, 0xffff0000, v104
    v_fmac_f32 v58, v28, v4
    v_fmac_f32 v59, v28, v5
    v_lshlrev_b32 v4, 16, v105
    v_and_b32 v5, 0xffff0000, v105
    v_fmac_f32 v60, v28, v4
    v_fmac_f32 v61, v28, v5
    v_lshlrev_b32 v4, 16, v106
    v_and_b32 v5, 0xffff0000, v106
    v_fmac_f32 v62, v28, v4
    v_fmac_f32 v63, v28, v5
    v_lshlrev_b32 v4, 16, v107
    v_and_b32 v5, 0xffff0000, v107
    v_fmac_f32 v64, v28, v4
    v_fmac_f32 v65, v28, v5
    v_lshlrev_b32 v4, 16, v108
    v_and_b32 v5, 0xffff0000, v108
    v_fmac_f32 v66, v28, v4
    v_fmac_f32 v67, v28, v5
    v_lshlrev_b32 v4, 16, v109
    v_and_b32 v5, 0xffff0000, v109
    v_fmac_f32 v68, v28, v4
    v_fmac_f32 v69, v28, v5
    v_lshlrev_b32 v4, 16, v110
    v_and_b32 v5, 0xffff0000, v110
    v_fmac_f32 v70, v28, v4
    v_fmac_f32 v71, v28, v5
    v_lshlrev_b32 v4, 16, v111
    v_and_b32 v5, 0xffff0000, v111
    v_fmac_f32 v72, v28, v4
    v_fmac_f32 v73, v28, v5
    v_lshlrev_b32 v4, 16, v112
    v_and_b32 v5, 0xffff0000, v112
    v_fmac_f32 v74, v28, v4
    v_fmac_f32 v75, v28, v5
    v_lshlrev_b32 v4, 16, v113
    v_and_b32 v5, 0xffff0000, v113
    v_fmac_f32 v76, v28, v4
    v_fmac_f32 v77, v28, v5
    s_add_u32 s48, s47, 6144
    buffer_load_dwordx4 v[102:105], v1, s[16:19], s48 offen offset:0 nt
    buffer_load_dwordx4 v[106:109], v1, s[16:19], s48 offen offset:128 nt
    buffer_load_dwordx4 v[110:113], v1, s[16:19], s48 offen offset:256 nt
    s_waitcnt vmcnt(9)
    v_lshlrev_b32 v4, 16, v114
    v_and_b32 v5, 0xffff0000, v114
    v_fmac_f32 v54, v29, v4
    v_fmac_f32 v55, v29, v5
    v_lshlrev_b32 v4, 16, v115
    v_and_b32 v5, 0xffff0000, v115
    v_fmac_f32 v56, v29, v4
    v_fmac_f32 v57, v29, v5
    v_lshlrev_b32 v4, 16, v116
    v_and_b32 v5, 0xffff0000, v116
    v_fmac_f32 v58, v29, v4
    v_fmac_f32 v59, v29, v5
    v_lshlrev_b32 v4, 16, v117
    v_and_b32 v5, 0xffff0000, v117
    v_fmac_f32 v60, v29, v4
    v_fmac_f32 v61, v29, v5
    v_lshlrev_b32 v4, 16, v118
    v_and_b32 v5, 0xffff0000, v118
    v_fmac_f32 v62, v29, v4
    v_fmac_f32 v63, v29, v5
    v_lshlrev_b32 v4, 16, v119
    v_and_b32 v5, 0xffff0000, v119
    v_fmac_f32 v64, v29, v4
    v_fmac_f32 v65, v29, v5
    v_lshlrev_b32 v4, 16, v120
    v_and_b32 v5, 0xffff0000, v120
    v_fmac_f32 v66, v29, v4
    v_fmac_f32 v67, v29, v5
    v_lshlrev_b32 v4, 16, v121
    v_and_b32 v5, 0xffff0000, v121
    v_fmac_f32 v68, v29, v4
    v_fmac_f32 v69, v29, v5
    v_lshlrev_b32 v4, 16, v122
    v_and_b32 v5, 0xffff0000, v122
    v_fmac_f32 v70, v29, v4
    v_fmac_f32 v71, v29, v5
    v_lshlrev_b32 v4, 16, v123
    v_and_b32 v5, 0xffff0000, v123
    v_fmac_f32 v72, v29, v4
    v_fmac_f32 v73, v29, v5
    v_lshlrev_b32 v4, 16, v124
    v_and_b32 v5, 0xffff0000, v124
    v_fmac_f32 v74, v29, v4
    v_fmac_f32 v75, v29, v5
    v_lshlrev_b32 v4, 16, v125
    v_and_b32 v5, 0xffff0000, v125
    v_fmac_f32 v76, v29, v4
    v_fmac_f32 v77, v29, v5
    s_add_u32 s48, s47, 9216
    buffer_load_dwordx4 v[114:117], v1, s[16:19], s48 offen offset:0 nt
    buffer_load_dwordx4 v[118:121], v1, s[16:19], s48 offen offset:128 nt
    buffer_load_dwordx4 v[122:125], v1, s[16:19], s48 offen offset:256 nt
    s_mov_b32 s41, s47
    s_cmp_lt_u32 s41, s96
    s_cbranch_scc1 L_loop
L_pool_end:
    v_mov_b32 v2, v30
    v_mov_b32 v3, v31
    s_nop 1
    v_add_f32_dpp v3, v3, v3 quad_perm:[1,0,3,2] row_mask:0xf bank_mask:0xf
    s_nop 1
    v_add_f32_dpp v3, v3, v3 quad_perm:[2,3,0,1] row_mask:0xf bank_mask:0xf
    s_nop 1
    v_add_f32_dpp v3, v3, v3 row_half_mirror row_mask:0xf bank_mask:0xf
    s_nop 1
    v_add_f32_dpp v3, v3, v3 row_mirror row_mask:0xf bank_mask:0xf
    s_nop 1
    v_readlane_b32 s48, v3, 0
    v_readlane_b32 s49, v3, 16
    v_readlane_b32 s50, v3, 32
    v_readlane_b32 s51, v3, 48
    s_nop 1
    v_mov_b32 v3, s48
    v_add_f32 v3, s49, v3
    v_add_f32 v3, s50, v3
    v_add_f32 v3, s51, v3
    v_mul_f32 v3, 0.125, v3
    s_nop 1
    v_permlane32_swap_b32 v54, v58
    v_permlane32_swap_b32 v55, v59
    v_permlane32_swap_b32 v56, v60
    v_permlane32_swap_b32 v57, v61
    v_permlane32_swap_b32 v62, v66
    v_permlane32_swap_b32 v63, v67
    v_permlane32_swap_b32 v64, v68
    v_permlane32_swap_b32 v65, v69
    v_permlane32_swap_b32 v70, v74
    v_permlane32_swap_b32 v71, v75
    v_permlane32_swap_b32 v72, v76
    v_permlane32_swap_b32 v73, v77
    v_add_f32 v54, v54, v58
    v_add_f32 v55, v55, v59
    v_add_f32 v56, v56, v60
    v_add_f32 v57, v57, v61
    v_add_f32 v62, v62, v66
    v_add_f32 v63, v63, v67
    v_add_f32 v64, v64, v68
    v_add_f32 v65, v65, v69
    v_add_f32 v70, v70, v74
    v_add_f32 v71, v71, v75
    v_add_f32 v72, v72, v76
    v_add_f32 v73, v73, v77
    s_nop 1
    v_permlane16_swap_b32 v54, v56
    v_permlane16_swap_b32 v55, v57
    v_permlane16_swap_b32 v62, v64
    v_permlane16_swap_b32 v63, v65
    v_permlane16_swap_b32 v70, v72
    v_permlane16_swap_b32 v71, v73
    v_add_f32 v54, v54, v56
    v_add_f32 v55, v55, v57
    v_add_f32 v62, v62, v64
    v_add_f32 v63, v63, v65
    v_add_f32 v70, v70, v72
    v_add_f32 v71, v71, v73
    s_nop 1
    v_add_f32_dpp v54, v54, v54 row_ror:8 row_mask:0xf bank_mask:0xf
    v_add_f32_dpp v55, v55, v55 row_ror:8 row_mask:0xf bank_mask:0xf
    v_add_f32_dpp v62, v62, v62 row_ror:8 row_mask:0xf bank_mask:0xf
    v_add_f32_dpp v63, v63, v63 row_ror:8 row_mask:0xf bank_mask:0xf
    v_add_f32_dpp v70, v70, v70 row_ror:8 row_mask:0xf bank_mask:0xf
    v_add_f32_dpp v71, v71, v71 row_ror:8 row_mask:0xf bank_mask:0xf
    ds_write_b64 v9, v[54:55] offset:0
    ds_write_b64 v9, v[62:63] offset:256
    ds_write_b64 v9, v[70:71] offset:512
    v_lshrrev_b32 v4, 6, v0
    v_lshlrev_b32 v4, 3, v4
    ds_write_b64 v4, v[2:3] offset:12800
    s_waitcnt lgkmcnt(0)
    s_barrier
    s_cmp_lg_u32 s53, 3
    s_cbranch_scc1 L_noarr
    s_mov_b64 exec, 1
    v_mov_b32 v4, 0
    v_mov_b32 v5, 1
    buffer_atomic_add v5, v4, s[36:39], 0 offen sc0 sc1
    s_waitcnt vmcnt(0)
    v_mov_b32 v4, 12928
    ds_write_b32 v4, v5
    v_readfirstlane_b32 s48, v5
    s_waitcnt lgkmcnt(0)
    s_mov_b64 exec, -1
    v_lshlrev_b32 v4, 7, v6
    v_mov_b32 v5, 1
    s_cmp_lg_u32 s48, 247
    s_cbranch_scc1 L_e3
    s_mov_b32 s48, 458756
    buffer_store_dword v5, v4, s[32:35], s48 offen sc0 sc1
    s_mov_b32 s48, 466948
    buffer_store_dword v5, v4, s[32:35], s48 offen sc0 sc1
    s_mov_b32 s48, 475140
    buffer_store_dword v5, v4, s[32:35], s48 offen sc0 sc1
    s_mov_b32 s48, 483332
    buffer_store_dword v5, v4, s[32:35], s48 offen sc0 sc1
    s_branch L_e2
L_e3:
    s_cmp_lg_u32 s48, 255
    s_cbranch_scc1 L_e2
    s_mov_b32 s48, 458752
    buffer_store_dword v5, v4, s[32:35], s48 offen sc0 sc1
    s_mov_b32 s48, 466944
    buffer_store_dword v5, v4, s[32:35], s48 offen sc0 sc1
    s_mov_b32 s48, 475136
    buffer_store_dword v5, v4, s[32:35], s48 offen sc0 sc1
    s_mov_b32 s48, 483328
    buffer_store_dword v5, v4, s[32:35], s48 offen sc0 sc1
    s_branch L_e2
L_noarr:
    v_cmp_gt_u32 vcc, 192, v0
    s_and_saveexec_b64 s[100:101], vcc
    s_cbranch_execz L_e1
    v_lshlrev_b32 v2, 2, v0
    v_and_b32 v4, 15, v6
    v_lshlrev_b32 v4, 3, v4
    ds_read_b64 v[22:23], v4 offset:12800
    ds_read_b32 v54, v2 offset:0
    ds_read_b32 v55, v2 offset:768
    ds_read_b32 v56, v2 offset:1536
    ds_read_b32 v57, v2 offset:2304
    ds_read_b32 v58, v2 offset:3072
    ds_read_b32 v59, v2 offset:3840
    ds_read_b32 v60, v2 offset:4608
    ds_read_b32 v61, v2 offset:5376
    s_waitcnt lgkmcnt(8)
    ds_read_b32 v62, v2 offset:6144
    ds_read_b32 v63, v2 offset:6912
    ds_read_b32 v64, v2 offset:7680
    ds_read_b32 v65, v2 offset:8448
    ds_read_b32 v66, v2 offset:9216
    ds_read_b32 v67, v2 offset:9984
    ds_read_b32 v68, v2 offset:10752
    ds_read_b32 v69, v2 offset:11520
    v_mov_b32 v3, v22
    s_nop 1
    v_max_f32_dpp v3, v3, v3 quad_perm:[1,0,3,2] row_mask:0xf bank_mask:0xf
    s_nop 1
    v_max_f32_dpp v3, v3, v3 quad_perm:[2,3,0,1] row_mask:0xf bank_mask:0xf
    s_nop 1
    v_max_f32_dpp v3, v3, v3 row_half_mirror row_mask:0xf bank_mask:0xf
    s_nop 1
    v_max_f32_dpp v3, v3, v3 row_mirror row_mask:0xf bank_mask:0xf
    v_sub_f32 v24, v22, v3
    v_mul_f32 v24, 0x3fb8aa3b, v24
    v_exp_f32 v24, v24
    s_nop 0
    v_mul_f32 v5, v24, v23
    s_nop 1
    v_add_f32_dpp v5, v5, v5 quad_perm:[1,0,3,2] row_mask:0xf bank_mask:0xf
    s_nop 1
    v_add_f32_dpp v5, v5, v5 quad_perm:[2,3,0,1] row_mask:0xf bank_mask:0xf
    s_nop 1
    v_add_f32_dpp v5, v5, v5 row_half_mirror row_mask:0xf bank_mask:0xf
    s_nop 1
    v_add_f32_dpp v5, v5, v5 row_mirror row_mask:0xf bank_mask:0xf
    s_waitcnt lgkmcnt(0)
    v_mul_f32_dpp v4, v24, v54 row_newbcast:0 row_mask:0xf bank_mask:0xf
    v_mul_f32_dpp v25, v24, v55 row_newbcast:1 row_mask:0xf bank_mask:0xf
    v_fmac_f32_dpp v4, v24, v56 row_newbcast:2 row_mask:0xf bank_mask:0xf
    v_fmac_f32_dpp v25, v24, v57 row_newbcast:3 row_mask:0xf bank_mask:0xf
    v_fmac_f32_dpp v4, v24, v58 row_newbcast:4 row_mask:0xf bank_mask:0xf
    v_fmac_f32_dpp v25, v24, v59 row_newbcast:5 row_mask:0xf bank_mask:0xf
    v_fmac_f32_dpp v4, v24, v60 row_newbcast:6 row_mask:0xf bank_mask:0xf
    v_fmac_f32_dpp v25, v24, v61 row_newbcast:7 row_mask:0xf bank_mask:0xf
    v_fmac_f32_dpp v4, v24, v62 row_newbcast:8 row_mask:0xf bank_mask:0xf
    v_fmac_f32_dpp v25, v24, v63 row_newbcast:9 row_mask:0xf bank_mask:0xf
    v_fmac_f32_dpp v4, v24, v64 row_newbcast:10 row_mask:0xf bank_mask:0xf
    v_fmac_f32_dpp v25, v24, v65 row_newbcast:11 row_mask:0xf bank_mask:0xf
    v_fmac_f32_dpp v4, v24, v66 row_newbcast:12 row_mask:0xf bank_mask:0xf
    v_fmac_f32_dpp v25, v24, v67 row_newbcast:13 row_mask:0xf bank_mask:0xf
    v_fmac_f32_dpp v4, v24, v68 row_newbcast:14 row_mask:0xf bank_mask:0xf
    v_fmac_f32_dpp v25, v24, v69 row_newbcast:15 row_mask:0xf bank_mask:0xf
    v_add_f32 v4, v4, v25
    v_mov_b32 v12, v4
    v_mov_b32 v14, v3
    v_mov_b32 v15, v5
    v_mov_b32_dpp v13, v4 quad_perm:[1,0,3,2] row_mask:0xf bank_mask:0xf
    v_lshlrev_b32 v2, 3, v0
    s_mul_i32 s48, s40, 1536
    s_add_u32 s48, s48, 1048576
    s_mov_b32 exec_lo, 0x55555555
    s_mov_b32 exec_hi, 0x55555555
    buffer_store_dwordx4 v[12:15], v2, s[32:35], s48 offen sc0 sc1
L_e1:
    s_mov_b64 exec, s[100:101]
L_e2:
    s_waitcnt vmcnt(0)
    s_barrier
    v_mov_b32 v12, 12928
    ds_read_b32 v13, v12
    s_waitcnt lgkmcnt(0)
    v_readfirstlane_b32 s97, v13
    s_mul_i32 s48, s97, 6554
    s_lshr_b32 s54, s48, 16
    s_mul_i32 s48, s54, 10
    s_sub_u32 s55, s97, s48
    s_mov_b32 s98, 0
    s_cmp_lt_u32 s97, 80
    s_cbranch_scc1 L_role_2
    s_mov_b32 s98, 1
    s_sub_u32 s55, s97, 80
    s_cmp_ge_u32 s55, 24
    s_cselect_b32 s54, 1, 0
    s_mul_i32 s48, s54, 24
    s_sub_u32 s55, s55, s48
    s_cmp_lt_u32 s97, 128
    s_cbranch_scc1 L_role_2
    s_mov_b32 s98, 2
    s_sub_u32 s55, s97, 128
    s_cmp_lt_u32 s97, 148
    s_cbranch_scc1 L_role_2
    s_mov_b32 s98, 3
L_role_2:
    s_cmp_eq_u32 s54, 1
    s_cselect_b32 s64, s92, s64
    s_cselect_b32 s65, s93, s65
    s_cmp_eq_u32 s98, 3
    s_cbranch_scc1 L_dma_end
    s_cmp_eq_u32 s98, 2
    s_cbranch_scc1 L_dma_e
    v_lshrrev_b32 v126, 3, v6
    v_and_b32 v127, 7, v6
    v_lshlrev_b32 v127, 4, v127
    s_cmp_eq_u32 s98, 1
    s_cbranch_scc1 L_dma_d
    v_mul_u32_u24 v126, 1280, v126
    v_add_u32 v126, v126, v127
    s_mul_i32 s48, s54, 768
    s_mul_i32 s49, s53, 48
    s_add_u32 s48, s48, s49
    s_mul_i32 s48, s48, 1280
    s_lshl_b32 s50, s55, 7
    s_add_u32 s48, s48, s50
    s_lshl_b32 s50, s49, 7
    s_add_u32 s50, s50, 42496
    s_mov_b32 m0, s50
    s_nop 0
    buffer_load_dwordx4 v126, s[60:63], s48 offen nt lds
    s_add_u32 s48, s48, 10240
    s_add_u32 s50, s50, 1024
    s_mov_b32 m0, s50
    s_nop 0
    buffer_load_dwordx4 v126, s[60:63], s48 offen nt lds
    s_add_u32 s48, s48, 10240
    s_add_u32 s50, s50, 1024
    s_mov_b32 m0, s50
    s_nop 0
    buffer_load_dwordx4 v126, s[60:63], s48 offen nt lds
    s_add_u32 s48, s48, 10240
    s_add_u32 s50, s50, 1024
    s_mov_b32 m0, s50
    s_nop 0
    buffer_load_dwordx4 v126, s[60:63], s48 offen nt lds
    s_add_u32 s48, s48, 10240
    s_add_u32 s50, s50, 1024
    s_mov_b32 m0, s50
    s_nop 0
    buffer_load_dwordx4 v126, s[60:63], s48 offen nt lds
    s_add_u32 s48, s48, 10240
    s_add_u32 s50, s50, 1024
    s_mov_b32 m0, s50
    s_nop 0
    buffer_load_dwordx4 v126, s[60:63], s48 offen nt lds
    s_branch L_dma_end
L_dma_d:
    v_mul_u32_u24 v126, 3072, v126
    v_add_u32 v126, v126, v127
    s_mul_i32 s49, s53, 40
    s_mul_i32 s48, s49, 3072
    s_lshl_b32 s50, s55, 7
    s_add_u32 s48, s48, s50
    s_lshl_b32 s50, s49, 7
    s_add_u32 s50, s50, 42496
    s_mov_b32 m0, s50
    s_nop 0
    buffer_load_dwordx4 v126, s[64:67], s48 offen nt lds
    s_add_u32 s48, s48, 24576
    s_add_u32 s50, s50, 1024
    s_mov_b32 m0, s50
    s_nop 0
    buffer_load_dwordx4 v126, s[64:67], s48 offen nt lds
    s_add_u32 s48, s48, 24576
    s_add_u32 s50, s50, 1024
    s_mov_b32 m0, s50
    s_nop 0
    buffer_load_dwordx4 v126, s[64:67], s48 offen nt lds
    s_add_u32 s48, s48, 24576
    s_add_u32 s50, s50, 1024
    s_mov_b32 m0, s50
    s_nop 0
    buffer_load_dwordx4 v126, s[64:67], s48 offen nt lds
    s_add_u32 s48, s48, 24576
    s_add_u32 s50, s50, 1024
    s_mov_b32 m0, s50
    s_nop 0
    buffer_load_dwordx4 v126, s[64:67], s48 offen nt lds
    s_branch L_dma_end
L_dma_e:
    v_lshrrev_b32 v126, 2, v6
    v_and_b32 v127, 3, v6
    v_lshlrev_b32 v127, 4, v127
    v_mul_u32_u24 v126, 1280, v126
    v_add_u32 v126, v126, v127
    s_mul_i32 s49, s53, 96
    s_mul_i32 s48, s49, 1280
    s_lshl_b32 s50, s55, 6
    s_add_u32 s48, s48, s50
    s_lshl_b32 s50, s49, 6
    s_add_u32 s50, s50, 42496
    s_mov_b32 m0, s50
    s_nop 0
    buffer_load_dwordx4 v126, s[68:71], s48 offen nt lds
    s_add_u32 s48, s48, 20480
    s_add_u32 s50, s50, 1024
    s_mov_b32 m0, s50
    s_nop 0
    buffer_load_dwordx4 v126, s[68:71], s48 offen nt lds
    s_add_u32 s48, s48, 20480
    s_add_u32 s50, s50, 1024
    s_mov_b32 m0, s50
    s_nop 0
    buffer_load_dwordx4 v126, s[68:71], s48 offen nt lds
    s_add_u32 s48, s48, 20480
    s_add_u32 s50, s50, 1024
    s_mov_b32 m0, s50
    s_nop 0
    buffer_load_dwordx4 v126, s[68:71], s48 offen nt lds
    s_add_u32 s48, s48, 20480
    s_add_u32 s50, s50, 1024
    s_mov_b32 m0, s50
    s_nop 0
    buffer_load_dwordx4 v126, s[68:71], s48 offen nt lds
    s_add_u32 s48, s48, 20480
    s_add_u32 s50, s50, 1024
    s_mov_b32 m0, s50
    s_nop 0
    buffer_load_dwordx4 v126, s[68:71], s48 offen nt lds
L_dma_end:
    s_cmp_eq_u32 s98, 3
    s_cbranch_scc0 L_tail_go
    s_endpgm
L_tail_go:
    v_lshrrev_b32 v7, 6, v0
    s_cmp_eq_u32 s98, 0
    s_cbranch_scc1 L_tail_c
    s_cmp_eq_u32 s98, 1
    s_cbranch_scc1 L_tail_d
    s_cmp_lg_u32 s53, 0
    s_cbranch_scc1 L_gate_done
    s_lshl_b32 s44, s2, 7
    s_add_u32 s44, s44, 458752
    v_mov_b32 v122, 0
    s_mov_b32 s45, 0
    buffer_load_dword v123, v122, s[32:35], s44 offen sc0 sc1
L_gate_3:
    s_sleep 6
    buffer_load_dword v124, v122, s[32:35], s44 offen sc0 sc1
    s_waitcnt vmcnt(1)
    v_cmp_ne_u32 vcc, 1, v123
    s_cbranch_vccz L_gate_3_ok
    s_sleep 6
    buffer_load_dword v123, v122, s[32:35], s44 offen sc0 sc1
    s_waitcnt vmcnt(1)
    v_cmp_ne_u32 vcc, 1, v124
    s_add_u32 s45, s45, 1
    s_cbranch_vccz L_gate_3_ok
    s_cmp_lt_u32 s45, 0x20000
    s_cbranch_scc1 L_gate_3
L_gate_3_ok:
L_gate_done:
    s_cmp_eq_u32 s98, 1
    s_cbranch_scc1 L_tail_d
    s_branch L_tail_e
L_tail_c:
    v_mov_b32 v12, v0
    v_mul_u32_u24 v13, 43691, v12
    v_lshrrev_b32 v13, 24, v13
    v_mul_u32_u24 v14, 384, v13
    v_sub_u32 v12, v12, v14
    v_mul_u32_u24 v14, 43691, v12
    v_lshrrev_b32 v14, 22, v14
    v_mul_u32_u24 v40, 98304, v13
    v_mul_u32_u24 v15, 1536, v14
    v_add_u32 v40, v40, v15
    v_lshl_add_u32 v40, v12, 4, v40
    v_mul_u32_u24 v46, 3136, v13
    v_lshl_add_u32 v46, v12, 2, v46
    v_and_b32 v12, 511, v0
    v_add_u32 v12, 1024, v12
    v_mul_u32_u24 v13, 43691, v12
    v_lshrrev_b32 v13, 24, v13
    v_mul_u32_u24 v14, 384, v13
    v_sub_u32 v12, v12, v14
    v_mul_u32_u24 v14, 43691, v12
    v_lshrrev_b32 v14, 22, v14
    v_mul_u32_u24 v41, 98304, v13
    v_mul_u32_u24 v15, 1536, v14
    v_add_u32 v41, v41, v15
    v_lshl_add_u32 v41, v12, 4, v41
    v_mul_u32_u24 v47, 3136, v13
    v_lshl_add_u32 v47, v12, 2, v47
    v_and_b32 v12, 3, v6
    v_mul_u32_u24 v8, 3136, v12
    v_lshlrev_b32 v9, 3, v12
    v_lshrrev_b32 v12, 4, v6
    v_lshl_add_u32 v8, v12, 4, v8
    v_mul_u32_u24 v12, 1024, v12
    v_add_u32 v9, v9, v12
    v_bfe_u32 v12, v6, 2, 2
    v_mul_u32_u24 v12, 128, v12
    v_add_u32 v9, v9, v12
    s_mul_i32 s46, s54, 12288
    s_add_u32 s46, s46, 1048576
    s_cmp_lg_u32 s53, 0
    s_cbranch_scc1 L_c_f
    v_mov_b32 v12, 4
    s_mov_b32 s45, 0
L_c_clr:
    buffer_load_dword v13, v12, s[36:39], 0 offen sc0 sc1
    s_waitcnt vmcnt(0)
    v_cmp_gt_u32 vcc, 256, v13
    s_add_u32 s45, s45, 1
    s_cbranch_vccz L_c_clr_ok
    s_cmp_ge_u32 s45, 0x20000
    s_cbranch_scc1 L_c_clr_ok
    s_sleep 8
    s_branch L_c_clr
L_c_clr_ok:
    s_lshl_b32 s44, s2, 7
    s_add_u32 s44, s44, 458752
    v_mov_b32 v12, 0
    s_mov_b32 s45, 0
L_c_fl:
    buffer_load_dwordx2 v[14:15], v12, s[32:35], s44 offen sc0 sc1
    s_waitcnt vmcnt(0)
    v_min_u32 v14, v14, v15
    v_cmp_ne_u32 vcc, 1, v14
    s_add_u32 s45, s45, 1
    s_cbranch_vccz L_c_f
    s_cmp_ge_u32 s45, 0x20000
    s_cbranch_scc1 L_c_f
    s_sleep 6
    s_branch L_c_fl
L_c_f:
    s_waitcnt vmcnt(0)
    s_barrier
    s_lshr_b32 s48, s53, 2
    s_and_b32 s49, s53, 3
    s_mul_i32 s50, s48, 24576
    s_lshl_b32 s49, s49, 5
    s_add_u32 s50, s50, s49
    s_add_u32 s50, s50, 42496
    v_add_u32 v13, s50, v9
    ds_read_b64_tr_b16 v[80:81], v13 offset:0
    ds_read_b64_tr_b16 v[82:83], v13 offset:512
    ds_read_b64_tr_b16 v[84:85], v13 offset:4096
    ds_read_b64_tr_b16 v[86:87], v13 offset:4608
    ds_read_b64_tr_b16 v[88:89], v13 offset:8192
    ds_read_b64_tr_b16 v[90:91], v13 offset:8704
    ds_read_b64_tr_b16 v[92:93], v13 offset:12288
    ds_read_b64_tr_b16 v[94:95], v13 offset:12800
    ds_read_b64_tr_b16 v[112:113], v13 offset:16384
    ds_read_b64_tr_b16 v[114:115], v13 offset:16896
    ds_read_b64_tr_b16 v[116:117], v13 offset:20480
    ds_read_b64_tr_b16 v[118:119], v13 offset:20992
    s_cmp_ge_u32 s53, 8
    s_cbranch_scc1 L_c_one
    s_mov_b32 s45, 0
    buffer_load_dwordx4 v[64:67], v40, s[32:35], s46 offen offset:0 sc0 sc1
    buffer_load_dwordx4 v[68:71], v40, s[32:35], s46 offen offset:1536 sc0 sc1
    buffer_load_dwordx4 v[72:75], v41, s[32:35], s46 offen offset:0 sc0 sc1
    buffer_load_dwordx4 v[76:79], v41, s[32:35], s46 offen offset:1536 sc0 sc1
    s_sleep 10
L_pc_4:
    buffer_load_dwordx4 v[96:99], v40, s[32:35], s46 offen offset:0 sc0 sc1
    buffer_load_dwordx4 v[100:103], v40, s[32:35], s46 offen offset:1536 sc0 sc1
    buffer_load_dwordx4 v[104:107], v41, s[32:35], s46 offen offset:0 sc0 sc1
    buffer_load_dwordx4 v[108:111], v41, s[32:35], s46 offen offset:1536 sc0 sc1
    s_waitcnt vmcnt(4)
    v_max_u32 v14, v64, v65
    v_max3_u32 v14, v14, v66, v67
    v_max3_u32 v14, v14, v68, v69
    v_max3_u32 v14, v14, v70, v71
    v_max3_u32 v14, v14, v72, v73
    v_max3_u32 v14, v14, v74, v75
    v_max3_u32 v14, v14, v76, v77
    v_max3_u32 v14, v14, v78, v79
    v_cmp_eq_u32 vcc, -1, v14
    s_cbranch_vccz L_pc_4_a
    buffer_load_dwordx4 v[64:67], v40, s[32:35], s46 offen offset:0 sc0 sc1
    buffer_load_dwordx4 v[68:71], v40, s[32:35], s46 offen offset:1536 sc0 sc1
    buffer_load_dwordx4 v[72:75], v41, s[32:35], s46 offen offset:0 sc0 sc1
    buffer_load_dwordx4 v[76:79], v41, s[32:35], s46 offen offset:1536 sc0 sc1
    s_waitcnt vmcnt(4)
    v_max_u32 v14, v96, v97
    v_max3_u32 v14, v14, v98, v99
    v_max3_u32 v14, v14, v100, v101
    v_max3_u32 v14, v14, v102, v103
    v_max3_u32 v14, v14, v104, v105
    v_max3_u32 v14, v14, v106, v107
    v_max3_u32 v14, v14, v108, v109
    v_max3_u32 v14, v14, v110, v111
    v_cmp_eq_u32 vcc, -1, v14
    s_cbranch_vccz L_pc_4_b
    s_add_u32 s45, s45, 1
    s_cmp_lt_u32 s45, 0x20000
    s_cbranch_scc1 L_pc_4
L_pc_4_b:
    v_max_f32 v12, v98, v102
    v_sub_f32 v13, v98, v12
    v_sub_f32 v14, v102, v12
    v_mul_f32 v13, 0x3fb8aa3b, v13
    v_mul_f32 v14, 0x3fb8aa3b, v14
    v_exp_f32 v13, v13
    v_exp_f32 v14, v14
    s_nop 0
    v_mul_f32 v15, v13, v99
    v_fmac_f32 v15, v14, v103
    v_rcp_f32 v15, v15
    s_nop 0
    v_mul_f32 v13, v13, v15
    v_mul_f32 v14, v14, v15
    v_mul_f32 v12, v13, v96
    v_mul_f32 v15, v13, v97
    v_fmac_f32 v12, v14, v100
    v_fmac_f32 v15, v14, v101
    v_cvt_pk_bf16_f32 v12, v12, v15
    ds_write_b32 v46, v12 offset:29952
    v_max_f32 v12, v106, v110
    v_sub_f32 v13, v106, v12
    v_sub_f32 v14, v110, v12
    v_mul_f32 v13, 0x3fb8aa3b, v13
    v_mul_f32 v14, 0x3fb8aa3b, v14
    v_exp_f32 v13, v13
    v_exp_f32 v14, v14
    s_nop 0
    v_mul_f32 v15, v13, v107
    v_fmac_f32 v15, v14, v111
    v_rcp_f32 v15, v15
    s_nop 0
    v_mul_f32 v13, v13, v15
    v_mul_f32 v14, v14, v15
    v_mul_f32 v12, v13, v104
    v_mul_f32 v15, v13, v105
    v_fmac_f32 v12, v14, v108
    v_fmac_f32 v15, v14, v109
    v_cvt_pk_bf16_f32 v12, v12, v15
    ds_write_b32 v47, v12 offset:29952
    s_branch L_pc_4_e
L_pc_4_a:
    v_max_f32 v12, v66, v70
    v_sub_f32 v13, v66, v12
    v_sub_f32 v14, v70, v12
    v_mul_f32 v13, 0x3fb8aa3b, v13
    v_mul_f32 v14, 0x3fb8aa3b, v14
    v_exp_f32 v13, v13
    v_exp_f32 v14, v14
    s_nop 0
    v_mul_f32 v15, v13, v67
    v_fmac_f32 v15, v14, v71
    v_rcp_f32 v15, v15
    s_nop 0
    v_mul_f32 v13, v13, v15
    v_mul_f32 v14, v14, v15
    v_mul_f32 v12, v13, v64
    v_mul_f32 v15, v13, v65
    v_fmac_f32 v12, v14, v68
    v_fmac_f32 v15, v14, v69
    v_cvt_pk_bf16_f32 v12, v12, v15
    ds_write_b32 v46, v12 offset:29952
    v_max_f32 v12, v74, v78
    v_sub_f32 v13, v74, v12
    v_sub_f32 v14, v78, v12
    v_mul_f32 v13, 0x3fb8aa3b, v13
    v_mul_f32 v14, 0x3fb8aa3b, v14
    v_exp_f32 v13, v13
    v_exp_f32 v14, v14
    s_nop 0
    v_mul_f32 v15, v13, v75
    v_fmac_f32 v15, v14, v79
    v_rcp_f32 v15, v15
    s_nop 0
    v_mul_f32 v13, v13, v15
    v_mul_f32 v14, v14, v15
    v_mul_f32 v12, v13, v72
    v_mul_f32 v15, v13, v73
    v_fmac_f32 v12, v14, v76
    v_fmac_f32 v15, v14, v77
    v_cvt_pk_bf16_f32 v12, v12, v15
    ds_write_b32 v47, v12 offset:29952
L_pc_4_e:
    s_branch L_c_items_done
L_c_one:
    s_mov_b32 s45, 0
    buffer_load_dwordx4 v[64:67], v40, s[32:35], s46 offen offset:0 sc0 sc1
    buffer_load_dwordx4 v[68:71], v40, s[32:35], s46 offen offset:1536 sc0 sc1
    s_sleep 10
L_pc_5:
    buffer_load_dwordx4 v[96:99], v40, s[32:35], s46 offen offset:0 sc0 sc1
    buffer_load_dwordx4 v[100:103], v40, s[32:35], s46 offen offset:1536 sc0 sc1
    s_waitcnt vmcnt(2)
    v_max_u32 v14, v64, v65
    v_max3_u32 v14, v14, v66, v67
    v_max3_u32 v14, v14, v68, v69
    v_max3_u32 v14, v14, v70, v71
    v_cmp_eq_u32 vcc, -1, v14
    s_cbranch_vccz L_pc_5_a
    buffer_load_dwordx4 v[64:67], v40, s[32:35], s46 offen offset:0 sc0 sc1
    buffer_load_dwordx4 v[68:71], v40, s[32:35], s46 offen offset:1536 sc0 sc1
    s_waitcnt vmcnt(2)
    v_max_u32 v14, v96, v97
    v_max3_u32 v14, v14, v98, v99
    v_max3_u32 v14, v14, v100, v101
    v_max3_u32 v14, v14, v102, v103
    v_cmp_eq_u32 vcc, -1, v14
    s_cbranch_vccz L_pc_5_b
    s_add_u32 s45, s45, 1
    s_cmp_lt_u32 s45, 0x20000
    s_cbranch_scc1 L_pc_5
L_pc_5_b:
    v_max_f32 v12, v98, v102
    v_sub_f32 v13, v98, v12
    v_sub_f32 v14, v102, v12
    v_mul_f32 v13, 0x3fb8aa3b, v13
    v_mul_f32 v14, 0x3fb8aa3b, v14
    v_exp_f32 v13, v13
    v_exp_f32 v14, v14
    s_nop 0
    v_mul_f32 v15, v13, v99
    v_fmac_f32 v15, v14, v103
    v_rcp_f32 v15, v15
    s_nop 0
    v_mul_f32 v13, v13, v15
    v_mul_f32 v14, v14, v15
    v_mul_f32 v12, v13, v96
    v_mul_f32 v15, v13, v97
    v_fmac_f32 v12, v14, v100
    v_fmac_f32 v15, v14, v101
    v_cvt_pk_bf16_f32 v12, v12, v15
    ds_write_b32 v46, v12 offset:29952
    s_branch L_pc_5_e
L_pc_5_a:
    v_max_f32 v12, v66, v70
    v_sub_f32 v13, v66, v12
    v_sub_f32 v14, v70, v12
    v_mul_f32 v13, 0x3fb8aa3b, v13
    v_mul_f32 v14, 0x3fb8aa3b, v14
    v_exp_f32 v13, v13
    v_exp_f32 v14, v14
    s_nop 0
    v_mul_f32 v15, v13, v67
    v_fmac_f32 v15, v14, v71
    v_rcp_f32 v15, v15
    s_nop 0
    v_mul_f32 v13, v13, v15
    v_mul_f32 v14, v14, v15
    v_mul_f32 v12, v13, v64
    v_mul_f32 v15, v13, v65
    v_fmac_f32 v12, v14, v68
    v_fmac_f32 v15, v14, v69
    v_cvt_pk_bf16_f32 v12, v12, v15
    ds_write_b32 v46, v12 offset:29952
L_pc_5_e:
L_c_items_done:
    s_waitcnt lgkmcnt(0)
    s_barrier
    s_lshr_b32 s48, s53, 2
    s_mul_i32 s50, s48, 384
    s_add_u32 s50, s50, 29952
    v_add_u32 v12, s50, v8
    ds_read_b128 v[16:19], v12 offset:0
    ds_read_b128 v[20:23], v12 offset:64
    ds_read_b128 v[24:27], v12 offset:128
    ds_read_b128 v[28:31], v12 offset:192
    ds_read_b128 v[32:35], v12 offset:256
    ds_read_b128 v[36:39], v12 offset:320
    s_waitcnt lgkmcnt(5)
    v_mfma_f32_16x16x32_bf16 v[48:51], v[16:19], v[80:83], 0
    s_waitcnt lgkmcnt(4)
    v_mfma_f32_16x16x32_bf16 v[48:51], v[20:23], v[84:87], v[48:51]
    s_waitcnt lgkmcnt(3)
    v_mfma_f32_16x16x32_bf16 v[48:51], v[24:27], v[88:91], v[48:51]
    s_waitcnt lgkmcnt(2)
    v_mfma_f32_16x16x32_bf16 v[48:51], v[28:31], v[92:95], v[48:51]
    s_waitcnt lgkmcnt(1)
    v_mfma_f32_16x16x32_bf16 v[48:51], v[32:35], v[112:115], v[48:51]
    s_waitcnt lgkmcnt(0)
    v_mfma_f32_16x16x32_bf16 v[48:51], v[36:39], v[116:119], v[48:51]
    s_nop 15
    s_lshr_b32 s48, s53, 2
    s_and_b32 s49, s53, 3
    s_mul_i32 s48, s48, 1024
    s_lshl_b32 s49, s49, 6
    s_add_u32 s48, s48, s49
    v_lshlrev_b32 v12, 2, v6
    v_add_u32 v12, s48, v12
    s_mov_b64 exec, 0xffff
    ds_write_b32 v12, v48 offset:13824
    ds_write_b32 v12, v49 offset:14080
    ds_write_b32 v12, v50 offset:14336
    ds_write_b32 v12, v51 offset:14592
    s_mov_b64 exec, -1
    s_waitcnt lgkmcnt(0)
    s_barrier
    s_cmp_ge_u32 s53, 4
    s_cbranch_scc1 L_c_pub_done
    v_lshlrev_b32 v12, 2, v0
    ds_read_b32 v16, v12 offset:13824
    ds_read_b32 v17, v12 offset:14848
    ds_read_b32 v18, v12 offset:15872
    ds_read_b32 v19, v12 offset:16896
    s_waitcnt lgkmcnt(0)
    v_add_f32 v16, v16, v17
    v_add_f32 v18, v18, v19
    v_add_f32 v16, v16, v18
    v_mul_u32_u24 v12, 2560, v7
    v_lshl_add_u32 v12, v6, 2, v12
    s_mul_i32 s48, s54, 10240
    s_lshl_b32 s49, s55, 8
    s_add_u32 s48, s48, s49
    s_add_u32 s48, s48, 262144
    buffer_store_dword v16, v12, s[32:35], s48 offen sc0 sc1
L_c_pub_done:
    s_endpgm
L_tail_e:
    v_and_b32 v12, 3, v6
    v_mul_u32_u24 v8, 3136, v12
    v_lshlrev_b32 v9, 3, v12
    v_lshrrev_b32 v12, 4, v6
    v_lshl_add_u32 v8, v12, 4, v8
    v_mul_u32_u24 v12, 512, v12
    v_add_u32 v9, v9, v12
    v_bfe_u32 v12, v6, 2, 2
    v_mul_u32_u24 v12, 64, v12
    v_add_u32 v9, v9, v12
    s_barrier
    v_min_u32 v57, 39, v6
    s_lshr_b32 s48, s53, 2
    s_mul_i32 s48, s48, 40
    v_add_u32 v57, s48, v57
    v_cmp_gt_u32 vcc, 40, v6
    s_nop 1
    v_cndmask_b32_e64 v56, 0, 1.0, vcc
    s_and_b32 s49, s53, 3
    s_mul_i32 s50, s49, 1280
    v_lshlrev_b32 v58, 3, v57
    buffer_load_dwordx2 v[48:49], v58, s[56:59], s50 offen
    buffer_load_dwordx2 v[50:51], v58, s[72:75], 0 offen
    s_mul_i32 s51, s49, 1344
    v_add_u32 v62, s51, v58
    v_lshlrev_b32 v59, 4, v57
    s_mul_i32 s50, s49, 2560
    s_add_u32 s50, s50, 262144
    s_mov_b32 s45, 0
    s_mov_b32 s44, s50
    buffer_load_dwordx4 v[64:67], v59, s[32:35], s44 offen sc0 sc1
    s_add_u32 s44, s44, 10240
    buffer_load_dwordx4 v[68:71], v59, s[32:35], s44 offen sc0 sc1
    s_add_u32 s44, s44, 10240
    buffer_load_dwordx4 v[72:75], v59, s[32:35], s44 offen sc0 sc1
    s_add_u32 s44, s44, 10240
    buffer_load_dwordx4 v[76:79], v59, s[32:35], s44 offen sc0 sc1
    s_add_u32 s44, s44, 10240
    buffer_load_dwordx4 v[80:83], v59, s[32:35], s44 offen sc0 sc1
    s_add_u32 s44, s44, 10240
    buffer_load_dwordx4 v[84:87], v59, s[32:35], s44 offen sc0 sc1
    s_add_u32 s44, s44, 10240
    buffer_load_dwordx4 v[88:91], v59, s[32:35], s44 offen sc0 sc1
    s_add_u32 s44, s44, 10240
    buffer_load_dwordx4 v[92:95], v59, s[32:35], s44 offen sc0 sc1
    s_sleep 10
L_pl_6:
    s_mov_b32 s44, s50
    buffer_load_dwordx4 v[96:99], v59, s[32:35], s44 offen sc0 sc1
    s_add_u32 s44, s44, 10240
    buffer_load_dwordx4 v[100:103], v59, s[32:35], s44 offen sc0 sc1
    s_add_u32 s44, s44, 10240
    buffer_load_dwordx4 v[104:107], v59, s[32:35], s44 offen sc0 sc1
    s_add_u32 s44, s44, 10240
    buffer_load_dwordx4 v[108:111], v59, s[32:35], s44 offen sc0 sc1
    s_add_u32 s44, s44, 10240
    buffer_load_dwordx4 v[112:115], v59, s[32:35], s44 offen sc0 sc1
    s_add_u32 s44, s44, 10240
    buffer_load_dwordx4 v[116:119], v59, s[32:35], s44 offen sc0 sc1
    s_add_u32 s44, s44, 10240
    buffer_load_dwordx4 v[120:123], v59, s[32:35], s44 offen sc0 sc1
    s_add_u32 s44, s44, 10240
    buffer_load_dwordx4 v[124:127], v59, s[32:35], s44 offen sc0 sc1
    s_waitcnt vmcnt(8)
    v_max_u32 v60, v64, v65
    v_max3_u32 v60, v60, v66, v67
    v_max3_u32 v60, v60, v68, v69
    v_max3_u32 v60, v60, v70, v71
    v_max3_u32 v60, v60, v72, v73
    v_max3_u32 v60, v60, v74, v75
    v_max3_u32 v60, v60, v76, v77
    v_max3_u32 v60, v60, v78, v79
    v_max3_u32 v60, v60, v80, v81
    v_max3_u32 v60, v60, v82, v83
    v_max3_u32 v60, v60, v84, v85
    v_max3_u32 v60, v60, v86, v87
    v_max3_u32 v60, v60, v88, v89
    v_max3_u32 v60, v60, v90, v91
    v_max3_u32 v60, v60, v92, v93
    v_max3_u32 v60, v60, v94, v95
    v_cmp_eq_u32 vcc, -1, v60
    s_cbranch_vccz L_pl_6_a
    s_mov_b32 s44, s50
    buffer_load_dwordx4 v[64:67], v59, s[32:35], s44 offen sc0 sc1
    s_add_u32 s44, s44, 10240
    buffer_load_dwordx4 v[68:71], v59, s[32:35], s44 offen sc0 sc1
    s_add_u32 s44, s44, 10240
    buffer_load_dwordx4 v[72:75], v59, s[32:35], s44 offen sc0 sc1
    s_add_u32 s44, s44, 10240
    buffer_load_dwordx4 v[76:79], v59, s[32:35], s44 offen sc0 sc1
    s_add_u32 s44, s44, 10240
    buffer_load_dwordx4 v[80:83], v59, s[32:35], s44 offen sc0 sc1
    s_add_u32 s44, s44, 10240
    buffer_load_dwordx4 v[84:87], v59, s[32:35], s44 offen sc0 sc1
    s_add_u32 s44, s44, 10240
    buffer_load_dwordx4 v[88:91], v59, s[32:35], s44 offen sc0 sc1
    s_add_u32 s44, s44, 10240
    buffer_load_dwordx4 v[92:95], v59, s[32:35], s44 offen sc0 sc1
    s_waitcnt vmcnt(8)
    v_max_u32 v60, v96, v97
    v_max3_u32 v60, v60, v98, v99
    v_max3_u32 v60, v60, v100, v101
    v_max3_u32 v60, v60, v102, v103
    v_max3_u32 v60, v60, v104, v105
    v_max3_u32 v60, v60, v106, v107
    v_max3_u32 v60, v60, v108, v109
    v_max3_u32 v60, v60, v110, v111
    v_max3_u32 v60, v60, v112, v113
    v_max3_u32 v60, v60, v114, v115
    v_max3_u32 v60, v60, v116, v117
    v_max3_u32 v60, v60, v118, v119
    v_max3_u32 v60, v60, v120, v121
    v_max3_u32 v60, v60, v122, v123
    v_max3_u32 v60, v60, v124, v125
    v_max3_u32 v60, v60, v126, v127
    v_cmp_eq_u32 vcc, -1, v60
    s_cbranch_vccz L_pl_6_b
    s_add_u32 s45, s45, 1
    s_cmp_lt_u32 s45, 0x20000
    s_cbranch_scc1 L_pl_6
L_pl_6_b:
    v_mov_b32 v16, v96
    v_mov_b32 v17, v97
    v_mov_b32 v18, v98
    v_mov_b32 v19, v99
    v_mov_b32 v20, v100
    v_mov_b32 v21, v101
    v_mov_b32 v22, v102
    v_mov_b32 v23, v103
    v_mov_b32 v24, v104
    v_mov_b32 v25, v105
    v_mov_b32 v26, v106
    v_mov_b32 v27, v107
    v_mov_b32 v28, v108
    v_mov_b32 v29, v109
    v_mov_b32 v30, v110
    v_mov_b32 v31, v111
    v_mov_b32 v32, v112
    v_mov_b32 v33, v113
    v_mov_b32 v34, v114
    v_mov_b32 v35, v115
    v_mov_b32 v36, v116
    v_mov_b32 v37, v117
    v_mov_b32 v38, v118
    v_mov_b32 v39, v119
    v_mov_b32 v40, v120
    v_mov_b32 v41, v121
    v_mov_b32 v42, v122
    v_mov_b32 v43, v123
    v_mov_b32 v44, v124
    v_mov_b32 v45, v125
    v_mov_b32 v46, v126
    v_mov_b32 v47, v127
    s_branch L_pl_6_e
L_pl_6_a:
    v_mov_b32 v16, v64
    v_mov_b32 v17, v65
    v_mov_b32 v18, v66
    v_mov_b32 v19, v67
    v_mov_b32 v20, v68
    v_mov_b32 v21, v69
    v_mov_b32 v22, v70
    v_mov_b32 v23, v71
    v_mov_b32 v24, v72
    v_mov_b32 v25, v73
    v_mov_b32 v26, v74
    v_mov_b32 v27, v75
    v_mov_b32 v28, v76
    v_mov_b32 v29, v77
    v_mov_b32 v30, v78
    v_mov_b32 v31, v79
    v_mov_b32 v32, v80
    v_mov_b32 v33, v81
    v_mov_b32 v34, v82
    v_mov_b32 v35, v83
    v_mov_b32 v36, v84
    v_mov_b32 v37, v85
    v_mov_b32 v38, v86
    v_mov_b32 v39, v87
    v_mov_b32 v40, v88
    v_mov_b32 v41, v89
    v_mov_b32 v42, v90
    v_mov_b32 v43, v91
    v_mov_b32 v44, v92
    v_mov_b32 v45, v93
    v_mov_b32 v46, v94
    v_mov_b32 v47, v95
L_pl_6_e:
    v_add_f32 v16, v16, v32
    v_add_f32 v20, v20, v36
    v_add_f32 v24, v24, v40
    v_add_f32 v28, v28, v44
    v_add_f32 v52, v16, v20
    v_add_f32 v60, v24, v28
    v_add_f32 v52, v52, v60
    v_cvt_pk_bf16_f32 v52, v52, v52
    v_lshlrev_b32 v52, 16, v52
    v_add_f32 v17, v17, v33
    v_add_f32 v21, v21, v37
    v_add_f32 v25, v25, v41
    v_add_f32 v29, v29, v45
    v_add_f32 v53, v17, v21
    v_add_f32 v60, v25, v29
    v_add_f32 v53, v53, v60
    v_cvt_pk_bf16_f32 v53, v53, v53
    v_lshlrev_b32 v53, 16, v53
    v_add_f32 v18, v18, v34
    v_add_f32 v22, v22, v38
    v_add_f32 v26, v26, v42
    v_add_f32 v30, v30, v46
    v_add_f32 v54, v18, v22
    v_add_f32 v60, v26, v30
    v_add_f32 v54, v54, v60
    v_cvt_pk_bf16_f32 v54, v54, v54
    v_lshlrev_b32 v54, 16, v54
    v_add_f32 v19, v19, v35
    v_add_f32 v23, v23, v39
    v_add_f32 v27, v27, v43
    v_add_f32 v31, v31, v47
    v_add_f32 v55, v19, v23
    v_add_f32 v60, v27, v31
    v_add_f32 v55, v55, v60
    v_cvt_pk_bf16_f32 v55, v55, v55
    v_lshlrev_b32 v55, 16, v55
    v_lshlrev_b32 v58, 16, v48
    v_and_b32 v59, 0xffff0000, v48
    v_lshlrev_b32 v60, 16, v49
    v_and_b32 v61, 0xffff0000, v49
    v_add_f32 v52, v52, v58
    v_cvt_pk_bf16_f32 v52, v52, v52
    v_lshlrev_b32 v52, 16, v52
    v_add_f32 v53, v53, v59
    v_cvt_pk_bf16_f32 v53, v53, v53
    v_lshlrev_b32 v53, 16, v53
    v_add_f32 v54, v54, v60
    v_cvt_pk_bf16_f32 v54, v54, v54
    v_lshlrev_b32 v54, 16, v54
    v_add_f32 v55, v55, v61
    v_cvt_pk_bf16_f32 v55, v55, v55
    v_lshlrev_b32 v55, 16, v55
    v_add_f32 v58, v52, v53
    v_add_f32 v59, v54, v55
    v_add_f32 v58, v58, v59
    v_mul_f32 v58, v58, v56
    s_nop 1
    v_add_f32_dpp v58, v58, v58 quad_perm:[1,0,3,2] row_mask:0xf bank_mask:0xf
    s_nop 1
    v_add_f32_dpp v58, v58, v58 quad_perm:[2,3,0,1] row_mask:0xf bank_mask:0xf
    s_nop 1
    v_add_f32_dpp v58, v58, v58 row_half_mirror row_mask:0xf bank_mask:0xf
    s_nop 1
    v_add_f32_dpp v58, v58, v58 row_mirror row_mask:0xf bank_mask:0xf
    s_nop 1
    v_readlane_b32 s48, v58, 0
    v_readlane_b32 s49, v58, 16
    v_readlane_b32 s50, v58, 32
    v_readlane_b32 s51, v58, 48
    s_nop 1
    v_mov_b32 v58, s48
    v_add_f32 v58, s49, v58
    v_add_f32 v58, s50, v58
    v_add_f32 v58, s51, v58
    v_mul_f32 v58, 0x3bcccccd, v58
    v_sub_f32 v60, v52, v58
    v_mul_f32 v59, v60, v60
    v_sub_f32 v60, v53, v58
    v_fmac_f32 v59, v60, v60
    v_sub_f32 v60, v54, v58
    v_fmac_f32 v59, v60, v60
    v_sub_f32 v60, v55, v58
    v_fmac_f32 v59, v60, v60
    v_mul_f32 v59, v59, v56
    s_nop 1
    v_add_f32_dpp v59, v59, v59 quad_perm:[1,0,3,2] row_mask:0xf bank_mask:0xf
    s_nop 1
    v_add_f32_dpp v59, v59, v59 quad_perm:[2,3,0,1] row_mask:0xf bank_mask:0xf
    s_nop 1
    v_add_f32_dpp v59, v59, v59 row_half_mirror row_mask:0xf bank_mask:0xf
    s_nop 1
    v_add_f32_dpp v59, v59, v59 row_mirror row_mask:0xf bank_mask:0xf
    s_nop 1
    v_readlane_b32 s48, v59, 0
    v_readlane_b32 s49, v59, 16
    v_readlane_b32 s50, v59, 32
    v_readlane_b32 s51, v59, 48
    s_nop 1
    v_mov_b32 v59, s48
    v_add_f32 v59, s49, v59
    v_add_f32 v59, s50, v59
    v_add_f32 v59, s51, v59
    s_lshl_b32 s49, s53, 5
    s_and_b32 s49, s49, 96
    s_and_b32 s50, s53, 12
    s_lshl_b32 s50, s50, 1
    s_add_u32 s50, s50, s49
    v_mov_b32 v60, s50
    v_mov_b32 v61, s49
    ds_write_b64 v60, v[58:59] offset:29696
    s_waitcnt lgkmcnt(0)
    s_barrier
    ds_read_b128 v[16:19], v61 offset:29696
    ds_read_b128 v[20:23], v61 offset:29712
    s_waitcnt lgkmcnt(0)
    v_add_f32 v24, v16, v18
    v_add_f32 v25, v20, v22
    v_add_f32 v24, v24, v25
    v_mul_f32 v24, 0.25, v24
    v_add_f32 v25, v17, v19
    v_add_f32 v26, v21, v23
    v_add_f32 v25, v25, v26
    v_sub_f32 v16, v16, v24
    v_sub_f32 v18, v18, v24
    v_sub_f32 v20, v20, v24
    v_sub_f32 v22, v22, v24
    v_mul_f32 v26, v16, v16
    v_fmac_f32 v26, v18, v18
    v_fmac_f32 v26, v20, v20
    v_fmac_f32 v26, v22, v22
    v_mov_b32 v27, 0x43200000
    v_fmac_f32 v25, v26, v27
    v_mul_f32 v25, 0x3acccccd, v25
    v_cvt_pk_bf16_f32 v24, v24, v24
    v_lshlrev_b32 v24, 16, v24
    v_cvt_pk_bf16_f32 v25, v25, v25
    v_lshlrev_b32 v25, 16, v25
    v_add_f32 v25, 0x3727c5ac, v25
    v_cvt_pk_bf16_f32 v25, v25, v25
    v_lshlrev_b32 v25, 16, v25
    v_sqrt_f32 v25, v25
    s_nop 0
    v_cvt_pk_bf16_f32 v25, v25, v25
    v_lshlrev_b32 v25, 16, v25
    v_rcp_f32 v25, v25
    s_nop 0
    v_sub_f32 v28, v52, v24
    v_cvt_pk_bf16_f32 v28, v28, v28
    v_lshlrev_b32 v28, 16, v28
    v_mul_f32 v28, v28, v25
    v_cvt_pk_bf16_f32 v28, v28, v28
    v_lshlrev_b32 v28, 16, v28
    v_sub_f32 v29, v53, v24
    v_cvt_pk_bf16_f32 v29, v29, v29
    v_lshlrev_b32 v29, 16, v29
    v_mul_f32 v29, v29, v25
    v_cvt_pk_bf16_f32 v29, v29, v29
    v_lshlrev_b32 v29, 16, v29
    v_sub_f32 v30, v54, v24
    v_cvt_pk_bf16_f32 v30, v30, v30
    v_lshlrev_b32 v30, 16, v30
    v_mul_f32 v30, v30, v25
    v_cvt_pk_bf16_f32 v30, v30, v30
    v_lshlrev_b32 v30, 16, v30
    v_sub_f32 v31, v55, v24
    v_cvt_pk_bf16_f32 v31, v31, v31
    v_lshlrev_b32 v31, 16, v31
    v_mul_f32 v31, v31, v25
    v_cvt_pk_bf16_f32 v31, v31, v31
    v_lshlrev_b32 v31, 16, v31
    v_cvt_pk_bf16_f32 v32, v28, v29
    v_cvt_pk_bf16_f32 v33, v30, v31
    v_cvt_pk_bf16_f32 v34, v52, v53
    v_cvt_pk_bf16_f32 v35, v54, v55
    v_lshlrev_b32 v58, 16, v50
    v_and_b32 v59, 0xffff0000, v50
    v_mul_f32 v36, v28, v58
    v_fmac_f32 v36, v29, v59
    v_lshlrev_b32 v58, 16, v51
    v_and_b32 v59, 0xffff0000, v51
    v_fmac_f32 v36, v30, v58
    v_fmac_f32 v36, v31, v59
    v_mul_f32 v36, v36, v56
    s_nop 1
    v_add_f32_dpp v36, v36, v36 quad_perm:[1,0,3,2] row_mask:0xf bank_mask:0xf
    s_nop 1
    v_add_f32_dpp v36, v36, v36 quad_perm:[2,3,0,1] row_mask:0xf bank_mask:0xf
    s_nop 1
    v_add_f32_dpp v36, v36, v36 row_half_mirror row_mask:0xf bank_mask:0xf
    s_nop 1
    v_add_f32_dpp v36, v36, v36 row_mirror row_mask:0xf bank_mask:0xf
    s_nop 1
    v_readlane_b32 s48, v36, 0
    v_readlane_b32 s49, v36, 16
    v_readlane_b32 s50, v36, 32
    v_readlane_b32 s51, v36, 48
    s_nop 1
    v_mov_b32 v36, s48
    v_add_f32 v36, s49, v36
    v_add_f32 v36, s50, v36
    v_add_f32 v36, s51, v36
    v_lshrrev_b32 v60, 1, v60
    ds_write_b32 v60, v36 offset:29824
    s_mov_b32 exec_lo, -1
    s_mov_b32 exec_hi, 0xff
    ds_write_b64 v62, v[32:33] offset:18944
    ds_write_b64 v62, v[34:35] offset:24320
    s_mov_b64 exec, -1
    s_waitcnt vmcnt(0)
    s_lshr_b32 s48, s53, 1
    s_and_b32 s49, s53, 1
    s_mul_i32 s50, s48, 12288
    s_lshl_b32 s49, s49, 5
    s_add_u32 s50, s50, s49
    s_add_u32 s50, s50, 42496
    v_add_u32 v13, s50, v9
    ds_read_b64_tr_b16 v[40:41], v13 offset:0
    ds_read_b64_tr_b16 v[42:43], v13 offset:256
    ds_read_b64_tr_b16 v[44:45], v13 offset:2048
    ds_read_b64_tr_b16 v[46:47], v13 offset:2304
    ds_read_b64_tr_b16 v[48:49], v13 offset:4096
    ds_read_b64_tr_b16 v[50:51], v13 offset:4352
    ds_read_b64_tr_b16 v[52:53], v13 offset:6144
    ds_read_b64_tr_b16 v[54:55], v13 offset:6400
    ds_read_b64_tr_b16 v[56:57], v13 offset:8192
    ds_read_b64_tr_b16 v[58:59], v13 offset:8448
    ds_read_b64_tr_b16 v[60:61], v13 offset:10240
    ds_read_b64_tr_b16 v[62:63], v13 offset:10496
    s_waitcnt lgkmcnt(0)
    s_barrier
    s_cmp_ge_u32 s53, 2
    s_cbranch_scc1 L_e_pre_done
    v_and_b32 v13, 31, v0
    s_lshl_b32 s48, s55, 5
    v_add_u32 v13, s48, v13
    v_lshrrev_b32 v14, 5, v0
    v_mul_u32_u24 v15, 1344, v14
    v_lshl_add_u32 v15, v13, 1, v15
    v_lshlrev_b32 v12, 4, v14
    ds_read_u16 v70, v15 offset:18944
    ds_read_u16 v71, v15 offset:24320
    ds_read_b128 v[76:79], v12 offset:29824
    v_mul_u32_u24 v14, 640, v14
    v_add_u32 v14, v14, v13
    v_lshlrev_b32 v73, 1, v14
    s_waitcnt lgkmcnt(0)
    v_add_f32 v76, v76, v77
    v_add_f32 v78, v78, v79
    v_add_f32 v72, v76, v78
    v_cvt_pk_bf16_f32 v72, v72, v72
    v_lshlrev_b32 v72, 16, v72
    v_mul_f32 v72, 0xbfb8aa3b, v72
    v_exp_f32 v72, v72
    s_nop 0
    v_add_f32 v72, 1.0, v72
    v_rcp_f32 v72, v72
    s_nop 0
    v_cvt_pk_bf16_f32 v72, v72, v72
    v_lshlrev_b32 v72, 16, v72
    v_lshlrev_b32 v70, 16, v70
    v_lshlrev_b32 v71, 16, v71
L_e_pre_done:
    s_cmp_lt_u32 s53, 4
    s_cbranch_scc1 L_e_wait
L_e_act:
    v_subrev_u32 v15, 256, v0
    v_lshlrev_b32 v12, 4, v15
    v_mul_u32_u24 v13, 43691, v15
    v_lshrrev_b32 v13, 23, v13
    v_mul_u32_u24 v14, 64, v13
    v_add_u32 v14, v14, v12
    s_mov_b32 s45, 0
    s_mov_b32 s46, 360448
    buffer_load_dwordx4 v[80:83], v12, s[32:35], s46 offen sc0 sc1
    s_mov_b32 s46, 376832
    buffer_load_dwordx4 v[84:87], v12, s[32:35], s46 offen sc0 sc1
    s_sleep 10
L_pc_7:
    s_mov_b32 s46, 360448
    buffer_load_dwordx4 v[96:99], v12, s[32:35], s46 offen sc0 sc1
    s_mov_b32 s46, 376832
    buffer_load_dwordx4 v[100:103], v12, s[32:35], s46 offen sc0 sc1
    s_waitcnt vmcnt(2)
    v_max_u32 v15, v80, v81
    v_max3_u32 v15, v15, v82, v83
    v_max3_u32 v15, v15, v84, v85
    v_max3_u32 v15, v15, v86, v87
    v_cmp_eq_u32 vcc, -1, v15
    s_cbranch_vccz L_pc_7_a
    s_mov_b32 s46, 360448
    buffer_load_dwordx4 v[80:83], v12, s[32:35], s46 offen sc0 sc1
    s_mov_b32 s46, 376832
    buffer_load_dwordx4 v[84:87], v12, s[32:35], s46 offen sc0 sc1
    s_waitcnt vmcnt(2)
    v_max_u32 v15, v96, v97
    v_max3_u32 v15, v15, v98, v99
    v_max3_u32 v15, v15, v100, v101
    v_max3_u32 v15, v15, v102, v103
    v_cmp_eq_u32 vcc, -1, v15
    s_cbranch_vccz L_pc_7_b
    s_add_u32 s45, s45, 1
    s_cmp_lt_u32 s45, 0x20000
    s_cbranch_scc1 L_pc_7
L_pc_7_b:
    v_lshlrev_b32 v24, 16, v96
    v_and_b32 v25, 0xffff0000, v96
    v_lshlrev_b32 v26, 16, v100
    v_and_b32 v27, 0xffff0000, v100
    v_mul_f32 v24, v24, v26
    v_mul_f32 v25, v25, v27
    v_cvt_pk_bf16_f32 v32, v24, v25
    v_lshlrev_b32 v24, 16, v97
    v_and_b32 v25, 0xffff0000, v97
    v_lshlrev_b32 v26, 16, v101
    v_and_b32 v27, 0xffff0000, v101
    v_mul_f32 v24, v24, v26
    v_mul_f32 v25, v25, v27
    v_cvt_pk_bf16_f32 v33, v24, v25
    v_lshlrev_b32 v24, 16, v98
    v_and_b32 v25, 0xffff0000, v98
    v_lshlrev_b32 v26, 16, v102
    v_and_b32 v27, 0xffff0000, v102
    v_mul_f32 v24, v24, v26
    v_mul_f32 v25, v25, v27
    v_cvt_pk_bf16_f32 v34, v24, v25
    v_lshlrev_b32 v24, 16, v99
    v_and_b32 v25, 0xffff0000, v99
    v_lshlrev_b32 v26, 16, v103
    v_and_b32 v27, 0xffff0000, v103
    v_mul_f32 v24, v24, v26
    v_mul_f32 v25, v25, v27
    v_cvt_pk_bf16_f32 v35, v24, v25
    s_branch L_pc_7_e
L_pc_7_a:
    v_lshlrev_b32 v24, 16, v80
    v_and_b32 v25, 0xffff0000, v80
    v_lshlrev_b32 v26, 16, v84
    v_and_b32 v27, 0xffff0000, v84
    v_mul_f32 v24, v24, v26
    v_mul_f32 v25, v25, v27
    v_cvt_pk_bf16_f32 v32, v24, v25
    v_lshlrev_b32 v24, 16, v81
    v_and_b32 v25, 0xffff0000, v81
    v_lshlrev_b32 v26, 16, v85
    v_and_b32 v27, 0xffff0000, v85
    v_mul_f32 v24, v24, v26
    v_mul_f32 v25, v25, v27
    v_cvt_pk_bf16_f32 v33, v24, v25
    v_lshlrev_b32 v24, 16, v82
    v_and_b32 v25, 0xffff0000, v82
    v_lshlrev_b32 v26, 16, v86
    v_and_b32 v27, 0xffff0000, v86
    v_mul_f32 v24, v24, v26
    v_mul_f32 v25, v25, v27
    v_cvt_pk_bf16_f32 v34, v24, v25
    v_lshlrev_b32 v24, 16, v83
    v_and_b32 v25, 0xffff0000, v83
    v_lshlrev_b32 v26, 16, v87
    v_and_b32 v27, 0xffff0000, v87
    v_mul_f32 v24, v24, v26
    v_mul_f32 v25, v25, v27
    v_cvt_pk_bf16_f32 v35, v24, v25
L_pc_7_e:
    ds_write_b128 v14, v[32:35] offset:29952
L_e_wait:
    s_waitcnt lgkmcnt(0)
    s_barrier
    s_lshr_b32 s48, s53, 1
    s_mul_i32 s50, s48, 384
    s_add_u32 s50, s50, 29952
    v_add_u32 v12, s50, v8
    ds_read_b128 v[16:19], v12 offset:0
    ds_read_b128 v[20:23], v12 offset:64
    ds_read_b128 v[24:27], v12 offset:128
    ds_read_b128 v[28:31], v12 offset:192
    ds_read_b128 v[32:35], v12 offset:256
    ds_read_b128 v[36:39], v12 offset:320
    s_waitcnt lgkmcnt(5)
    v_mfma_f32_16x16x32_bf16 v[64:67], v[16:19], v[40:43], 0
    s_waitcnt lgkmcnt(4)
    v_mfma_f32_16x16x32_bf16 v[64:67], v[20:23], v[44:47], v[64:67]
    s_waitcnt lgkmcnt(3)
    v_mfma_f32_16x16x32_bf16 v[64:67], v[24:27], v[48:51], v[64:67]
    s_waitcnt lgkmcnt(2)
    v_mfma_f32_16x16x32_bf16 v[64:67], v[28:31], v[52:55], v[64:67]
    s_waitcnt lgkmcnt(1)
    v_mfma_f32_16x16x32_bf16 v[64:67], v[32:35], v[56:59], v[64:67]
    s_waitcnt lgkmcnt(0)
    v_mfma_f32_16x16x32_bf16 v[64:67], v[36:39], v[60:63], v[64:67]
    s_nop 15
    s_lshr_b32 s48, s53, 1
    s_and_b32 s49, s53, 1
    s_mul_i32 s48, s48, 512
    s_lshl_b32 s49, s49, 6
    s_add_u32 s48, s48, s49
    v_lshlrev_b32 v12, 2, v6
    v_add_u32 v12, s48, v12
    s_mov_b64 exec, 0xffff
    ds_write_b32 v12, v64 offset:13824
    ds_write_b32 v12, v65 offset:13952
    ds_write_b32 v12, v66 offset:14080
    ds_write_b32 v12, v67 offset:14208
    s_mov_b64 exec, -1
    s_waitcnt lgkmcnt(0)
    s_barrier
    s_cmp_ge_u32 s53, 2
    s_cbranch_scc1 L_done
    v_lshlrev_b32 v12, 2, v0
    ds_read_b32 v16, v12 offset:13824
    ds_read_b32 v17, v12 offset:14336
    ds_read_b32 v18, v12 offset:14848
    ds_read_b32 v19, v12 offset:15360
    ds_read_b32 v20, v12 offset:15872
    ds_read_b32 v21, v12 offset:16384
    ds_read_b32 v22, v12 offset:16896
    ds_read_b32 v23, v12 offset:17408
    s_waitcnt lgkmcnt(0)
    v_add_f32 v16, v16, v20
    v_add_f32 v17, v17, v21
    v_add_f32 v18, v18, v22
    v_add_f32 v19, v19, v23
    v_add_f32 v16, v16, v18
    v_add_f32 v17, v17, v19
    v_add_f32 v16, v16, v17
    v_cvt_pk_bf16_f32 v16, v16, v16
    v_lshlrev_b32 v16, 16, v16
    v_mul_f32 v16, v16, v72
    v_cvt_pk_bf16_f32 v16, v16, v16
    v_lshlrev_b32 v16, 16, v16
    v_add_f32 v16, v70, v16
    v_cvt_pk_bf16_f32 v16, v16, v16
    v_lshlrev_b32 v16, 16, v16
    v_add_f32 v16, v71, v16
    v_cvt_pk_bf16_f32 v16, v16, v16
    buffer_store_short v16, v73, s[76:79], 0 offen
    s_endpgm
L_tail_d:
    v_and_b32 v12, 15, v6
    v_min_u32 v12, 4, v12
    v_mul_u32_u24 v8, 1344, v12
    v_and_b32 v12, 3, v6
    v_lshlrev_b32 v9, 3, v12
    v_lshrrev_b32 v12, 4, v6
    v_lshl_add_u32 v8, v12, 4, v8
    v_mul_u32_u24 v12, 1024, v12
    v_add_u32 v9, v9, v12
    v_bfe_u32 v12, v6, 2, 2
    v_mul_u32_u24 v12, 128, v12
    v_add_u32 v9, v9, v12
    v_cmp_gt_u32 vcc, 320, v0
    s_and_saveexec_b64 s[100:101], vcc
    v_lshlrev_b32 v12, 2, v0
    v_mov_b32 v13, 0x3f803f80
    ds_write_b32 v12, v13 offset:24320
    s_mov_b64 exec, s[100:101]
    s_waitcnt vmcnt(0) lgkmcnt(0)
    s_barrier
    s_lshr_b32 s48, s53, 2
    s_and_b32 s49, s53, 3
    s_mul_i32 s50, s48, 20480
    s_lshl_b32 s49, s49, 5
    s_add_u32 s50, s50, s49
    s_add_u32 s50, s50, 42496
    v_add_u32 v13, s50, v9
    ds_read_b64_tr_b16 v[16:17], v13 offset:0
    ds_read_b64_tr_b16 v[18:19], v13 offset:512
    ds_read_b64_tr_b16 v[20:21], v13 offset:4096
    ds_read_b64_tr_b16 v[22:23], v13 offset:4608
    ds_read_b64_tr_b16 v[24:25], v13 offset:8192
    ds_read_b64_tr_b16 v[26:27], v13 offset:8704
    ds_read_b64_tr_b16 v[28:29], v13 offset:12288
    ds_read_b64_tr_b16 v[30:31], v13 offset:12800
    ds_read_b64_tr_b16 v[32:33], v13 offset:16384
    ds_read_b64_tr_b16 v[34:35], v13 offset:16896
    s_min_u32 s48, s53, 9
    s_lshl_b32 s48, s48, 8
    v_lshlrev_b32 v57, 2, v6
    v_add_u32 v57, s48, v57
    v_lshlrev_b32 v58, 1, v57
    buffer_load_dwordx2 v[48:49], v58, s[56:59], 0 offen
    v_lshrrev_b32 v60, 7, v57
    v_lshlrev_b32 v63, 3, v60
    v_mul_u32_u24 v60, 52, v60
    v_lshrrev_b32 v60, 8, v60
    v_mul_u32_u24 v62, 64, v60
    v_add_u32 v62, v62, v58
    v_lshlrev_b32 v59, 2, v57
    s_waitcnt vmcnt(0)
    v_and_b32 v51, 0xffff0000, v49
    v_lshlrev_b32 v50, 16, v49
    v_and_b32 v49, 0xffff0000, v48
    v_lshlrev_b32 v48, 16, v48
    s_cmp_lg_u32 s53, 0
    s_cbranch_scc1 L_d_gate_done
    s_lshl_b32 s44, s2, 7
    s_add_u32 s44, s44, 458752
    v_mov_b32 v122, 0
    s_mov_b32 s45, 0
    buffer_load_dword v123, v122, s[32:35], s44 offen sc0 sc1
L_gate_8:
    s_sleep 6
    buffer_load_dword v124, v122, s[32:35], s44 offen sc0 sc1
    s_waitcnt vmcnt(1)
    v_cmp_ne_u32 vcc, 1, v123
    s_cbranch_vccz L_gate_8_ok
    s_sleep 6
    buffer_load_dword v123, v122, s[32:35], s44 offen sc0 sc1
    s_waitcnt vmcnt(1)
    v_cmp_ne_u32 vcc, 1, v124
    s_add_u32 s45, s45, 1
    s_cbranch_vccz L_gate_8_ok
    s_cmp_lt_u32 s45, 0x20000
    s_cbranch_scc1 L_gate_8
L_gate_8_ok:
L_d_gate_done:
    s_barrier
    s_cmp_ge_u32 s53, 10
    s_cbranch_scc1 L_d10_skip
    s_mov_b32 s45, 0
    s_mov_b32 s44, 262144
    buffer_load_dwordx4 v[64:67], v59, s[32:35], s44 offen sc0 sc1
    s_add_u32 s44, s44, 10240
    buffer_load_dwordx4 v[68:71], v59, s[32:35], s44 offen sc0 sc1
    s_add_u32 s44, s44, 10240
    buffer_load_dwordx4 v[72:75], v59, s[32:35], s44 offen sc0 sc1
    s_add_u32 s44, s44, 10240
    buffer_load_dwordx4 v[76:79], v59, s[32:35], s44 offen sc0 sc1
    s_add_u32 s44, s44, 10240
    buffer_load_dwordx4 v[80:83], v59, s[32:35], s44 offen sc0 sc1
    s_add_u32 s44, s44, 10240
    buffer_load_dwordx4 v[84:87], v59, s[32:35], s44 offen sc0 sc1
    s_add_u32 s44, s44, 10240
    buffer_load_dwordx4 v[88:91], v59, s[32:35], s44 offen sc0 sc1
    s_add_u32 s44, s44, 10240
    buffer_load_dwordx4 v[92:95], v59, s[32:35], s44 offen sc0 sc1
    s_sleep 10
L_pc_9:
    s_mov_b32 s44, 262144
    buffer_load_dwordx4 v[96:99], v59, s[32:35], s44 offen sc0 sc1
    s_add_u32 s44, s44, 10240
    buffer_load_dwordx4 v[100:103], v59, s[32:35], s44 offen sc0 sc1
    s_add_u32 s44, s44, 10240
    buffer_load_dwordx4 v[104:107], v59, s[32:35], s44 offen sc0 sc1
    s_add_u32 s44, s44, 10240
    buffer_load_dwordx4 v[108:111], v59, s[32:35], s44 offen sc0 sc1
    s_add_u32 s44, s44, 10240
    buffer_load_dwordx4 v[112:115], v59, s[32:35], s44 offen sc0 sc1
    s_add_u32 s44, s44, 10240
    buffer_load_dwordx4 v[116:119], v59, s[32:35], s44 offen sc0 sc1
    s_add_u32 s44, s44, 10240
    buffer_load_dwordx4 v[120:123], v59, s[32:35], s44 offen sc0 sc1
    s_add_u32 s44, s44, 10240
    buffer_load_dwordx4 v[124:127], v59, s[32:35], s44 offen sc0 sc1
    s_waitcnt vmcnt(8)
    v_max_u32 v60, v64, v65
    v_max3_u32 v60, v60, v66, v67
    v_max3_u32 v60, v60, v68, v69
    v_max3_u32 v60, v60, v70, v71
    v_max3_u32 v60, v60, v72, v73
    v_max3_u32 v60, v60, v74, v75
    v_max3_u32 v60, v60, v76, v77
    v_max3_u32 v60, v60, v78, v79
    v_max3_u32 v60, v60, v80, v81
    v_max3_u32 v60, v60, v82, v83
    v_max3_u32 v60, v60, v84, v85
    v_max3_u32 v60, v60, v86, v87
    v_max3_u32 v60, v60, v88, v89
    v_max3_u32 v60, v60, v90, v91
    v_max3_u32 v60, v60, v92, v93
    v_max3_u32 v60, v60, v94, v95
    v_cmp_eq_u32 vcc, -1, v60
    s_cbranch_vccz L_pc_9_a
    s_mov_b32 s44, 262144
    buffer_load_dwordx4 v[64:67], v59, s[32:35], s44 offen sc0 sc1
    s_add_u32 s44, s44, 10240
    buffer_load_dwordx4 v[68:71], v59, s[32:35], s44 offen sc0 sc1
    s_add_u32 s44, s44, 10240
    buffer_load_dwordx4 v[72:75], v59, s[32:35], s44 offen sc0 sc1
    s_add_u32 s44, s44, 10240
    buffer_load_dwordx4 v[76:79], v59, s[32:35], s44 offen sc0 sc1
    s_add_u32 s44, s44, 10240
    buffer_load_dwordx4 v[80:83], v59, s[32:35], s44 offen sc0 sc1
    s_add_u32 s44, s44, 10240
    buffer_load_dwordx4 v[84:87], v59, s[32:35], s44 offen sc0 sc1
    s_add_u32 s44, s44, 10240
    buffer_load_dwordx4 v[88:91], v59, s[32:35], s44 offen sc0 sc1
    s_add_u32 s44, s44, 10240
    buffer_load_dwordx4 v[92:95], v59, s[32:35], s44 offen sc0 sc1
    s_waitcnt vmcnt(8)
    v_max_u32 v60, v96, v97
    v_max3_u32 v60, v60, v98, v99
    v_max3_u32 v60, v60, v100, v101
    v_max3_u32 v60, v60, v102, v103
    v_max3_u32 v60, v60, v104, v105
    v_max3_u32 v60, v60, v106, v107
    v_max3_u32 v60, v60, v108, v109
    v_max3_u32 v60, v60, v110, v111
    v_max3_u32 v60, v60, v112, v113
    v_max3_u32 v60, v60, v114, v115
    v_max3_u32 v60, v60, v116, v117
    v_max3_u32 v60, v60, v118, v119
    v_max3_u32 v60, v60, v120, v121
    v_max3_u32 v60, v60, v122, v123
    v_max3_u32 v60, v60, v124, v125
    v_max3_u32 v60, v60, v126, v127
    v_cmp_eq_u32 vcc, -1, v60
    s_cbranch_vccz L_pc_9_b
    s_add_u32 s45, s45, 1
    s_cmp_lt_u32 s45, 0x20000
    s_cbranch_scc1 L_pc_9
L_pc_9_b:
    v_add_f32 v96, v96, v112
    v_add_f32 v100, v100, v116
    v_add_f32 v104, v104, v120
    v_add_f32 v108, v108, v124
    v_add_f32 v97, v97, v113
    v_add_f32 v101, v101, v117
    v_add_f32 v105, v105, v121
    v_add_f32 v109, v109, v125
    v_add_f32 v98, v98, v114
    v_add_f32 v102, v102, v118
    v_add_f32 v106, v106, v122
    v_add_f32 v110, v110, v126
    v_add_f32 v99, v99, v115
    v_add_f32 v103, v103, v119
    v_add_f32 v107, v107, v123
    v_add_f32 v111, v111, v127
    v_add_f32 v96, v96, v100
    v_add_f32 v104, v104, v108
    v_add_f32 v97, v97, v101
    v_add_f32 v105, v105, v109
    v_add_f32 v98, v98, v102
    v_add_f32 v106, v106, v110
    v_add_f32 v99, v99, v103
    v_add_f32 v107, v107, v111
    v_add_f32 v52, v96, v104
    v_add_f32 v53, v97, v105
    v_add_f32 v54, v98, v106
    v_add_f32 v55, v99, v107
    s_branch L_pc_9_e
L_pc_9_a:
    v_add_f32 v64, v64, v80
    v_add_f32 v68, v68, v84
    v_add_f32 v72, v72, v88
    v_add_f32 v76, v76, v92
    v_add_f32 v65, v65, v81
    v_add_f32 v69, v69, v85
    v_add_f32 v73, v73, v89
    v_add_f32 v77, v77, v93
    v_add_f32 v66, v66, v82
    v_add_f32 v70, v70, v86
    v_add_f32 v74, v74, v90
    v_add_f32 v78, v78, v94
    v_add_f32 v67, v67, v83
    v_add_f32 v71, v71, v87
    v_add_f32 v75, v75, v91
    v_add_f32 v79, v79, v95
    v_add_f32 v64, v64, v68
    v_add_f32 v72, v72, v76
    v_add_f32 v65, v65, v69
    v_add_f32 v73, v73, v77
    v_add_f32 v66, v66, v70
    v_add_f32 v74, v74, v78
    v_add_f32 v67, v67, v71
    v_add_f32 v75, v75, v79
    v_add_f32 v52, v64, v72
    v_add_f32 v53, v65, v73
    v_add_f32 v54, v66, v74
    v_add_f32 v55, v67, v75
L_pc_9_e:
    v_cvt_pk_bf16_f32 v52, v52, v52
    v_lshlrev_b32 v52, 16, v52
    v_cvt_pk_bf16_f32 v53, v53, v53
    v_lshlrev_b32 v53, 16, v53
    v_cvt_pk_bf16_f32 v54, v54, v54
    v_lshlrev_b32 v54, 16, v54
    v_cvt_pk_bf16_f32 v55, v55, v55
    v_lshlrev_b32 v55, 16, v55
    v_add_f32 v52, v52, v48
    v_add_f32 v53, v53, v49
    v_add_f32 v54, v54, v50
    v_add_f32 v55, v55, v51
    v_cvt_pk_bf16_f32 v60, v52, v53
    v_cvt_pk_bf16_f32 v61, v54, v55
    ds_write_b64 v62, v[60:61] offset:18944
    s_mov_b32 vcc_lo, 0
    s_mov_b32 vcc_hi, -1
    v_lshlrev_b32 v52, 16, v60
    v_and_b32 v53, 0xffff0000, v60
    v_lshlrev_b32 v54, 16, v61
    v_and_b32 v55, 0xffff0000, v61
    v_add_f32 v58, v52, v53
    v_add_f32 v59, v54, v55
    v_add_f32 v58, v58, v59
    s_nop 1
    v_add_f32_dpp v58, v58, v58 quad_perm:[1,0,3,2] row_mask:0xf bank_mask:0xf
    s_nop 1
    v_add_f32_dpp v58, v58, v58 quad_perm:[2,3,0,1] row_mask:0xf bank_mask:0xf
    s_nop 1
    v_add_f32_dpp v58, v58, v58 row_half_mirror row_mask:0xf bank_mask:0xf
    s_nop 1
    v_add_f32_dpp v58, v58, v58 row_mirror row_mask:0xf bank_mask:0xf
    s_nop 1
    v_add_f32_dpp v58, v58, v58 row_bcast:15 row_mask:0xa bank_mask:0xf
    s_nop 1
    v_readlane_b32 s44, v58, 16
    v_readlane_b32 s45, v58, 48
    s_nop 1
    v_mov_b32 v58, s44
    v_mov_b32 v60, s45
    v_cndmask_b32 v58, v58, v60, vcc
    v_mul_f32 v58, 0x3c000000, v58
    v_sub_f32 v60, v52, v58
    v_mul_f32 v59, v60, v60
    v_sub_f32 v60, v53, v58
    v_fmac_f32 v59, v60, v60
    v_sub_f32 v60, v54, v58
    v_fmac_f32 v59, v60, v60
    v_sub_f32 v60, v55, v58
    v_fmac_f32 v59, v60, v60
    s_nop 1
    v_add_f32_dpp v59, v59, v59 quad_perm:[1,0,3,2] row_mask:0xf bank_mask:0xf
    s_nop 1
    v_add_f32_dpp v59, v59, v59 quad_perm:[2,3,0,1] row_mask:0xf bank_mask:0xf
    s_nop 1
    v_add_f32_dpp v59, v59, v59 row_half_mirror row_mask:0xf bank_mask:0xf
    s_nop 1
    v_add_f32_dpp v59, v59, v59 row_mirror row_mask:0xf bank_mask:0xf
    s_nop 1
    v_add_f32_dpp v59, v59, v59 row_bcast:15 row_mask:0xa bank_mask:0xf
    s_nop 1
    v_readlane_b32 s44, v59, 16
    v_readlane_b32 s45, v59, 48
    s_nop 1
    v_mov_b32 v59, s44
    v_mov_b32 v60, s45
    v_cndmask_b32 v59, v59, v60, vcc
    ds_write_b64 v63, v[58:59] offset:29696
L_d10_skip:
    s_waitcnt lgkmcnt(0)
    s_barrier
    s_lshr_b32 s48, s53, 2
    s_mul_i32 s50, s48, 320
    s_add_u32 s50, s50, 18944
    v_add_u32 v12, s50, v8
    s_cmp_ge_u32 s53, 4
    s_cbranch_scc1 L_d_h1
    s_mul_i32 s49, s53, 40
    v_mov_b32 v60, s49
    ds_read_b64 v[2:3], v60 offset:29696
    ds_read_b64 v[4:5], v60 offset:29704
    ds_read_b64 v[10:11], v60 offset:29712
    ds_read_b64 v[14:15], v60 offset:29720
    ds_read_b64 v[62:63], v60 offset:29728
L_d_h1:
    ds_read_b128 v[36:39], v12 offset:0
    ds_read_b128 v[40:43], v12 offset:64
    ds_read_b128 v[44:47], v12 offset:128
    ds_read_b128 v[48:51], v12 offset:192
    ds_read_b128 v[52:55], v12 offset:256
    s_cmp_ge_u32 s53, 4
    s_cbranch_scc1 L_d_h2
    s_waitcnt lgkmcnt(5)
    v_add_f32 v1, v2, v4
    v_add_f32 v12, v10, v14
    v_add_f32 v1, v1, v12
    v_add_f32 v1, v1, v62
    v_mul_f32 v60, 0x3e4ccccd, v1
    v_add_f32 v12, v3, v5
    v_add_f32 v13, v11, v15
    v_add_f32 v12, v12, v13
    v_add_f32 v12, v12, v63
    v_sub_f32 v2, v2, v60
    v_sub_f32 v4, v4, v60
    v_sub_f32 v10, v10, v60
    v_sub_f32 v14, v14, v60
    v_sub_f32 v62, v62, v60
    v_mul_f32 v13, v2, v2
    v_fmac_f32 v13, v4, v4
    v_fmac_f32 v13, v10, v10
    v_fmac_f32 v13, v14, v14
    v_fmac_f32 v13, v62, v62
    v_mov_b32 v1, 0x43000000
    v_fmac_f32 v12, v13, v1
    v_mul_f32 v61, 0x3acccccd, v12
    v_cvt_pk_bf16_f32 v60, v60, v60
    v_lshlrev_b32 v60, 16, v60
    v_cvt_pk_bf16_f32 v61, v61, v61
    v_lshlrev_b32 v61, 16, v61
    v_add_f32 v61, 0x3727c5ac, v61
    v_cvt_pk_bf16_f32 v61, v61, v61
    v_lshlrev_b32 v61, 16, v61
    v_sqrt_f32 v61, v61
    s_nop 0
    v_cvt_pk_bf16_f32 v61, v61, v61
    v_lshlrev_b32 v61, 16, v61
    v_rcp_f32 v61, v61
L_d_h2:
    s_waitcnt lgkmcnt(4)
    v_mfma_f32_16x16x32_bf16 v[56:59], v[36:39], v[16:19], 0
    s_waitcnt lgkmcnt(3)
    v_mfma_f32_16x16x32_bf16 v[56:59], v[40:43], v[20:23], v[56:59]
    s_waitcnt lgkmcnt(2)
    v_mfma_f32_16x16x32_bf16 v[56:59], v[44:47], v[24:27], v[56:59]
    s_waitcnt lgkmcnt(1)
    v_mfma_f32_16x16x32_bf16 v[56:59], v[48:51], v[28:31], v[56:59]
    s_waitcnt lgkmcnt(0)
    v_mfma_f32_16x16x32_bf16 v[56:59], v[52:55], v[32:35], v[56:59]
    s_nop 15
    s_lshr_b32 s48, s53, 2
    s_and_b32 s49, s53, 3
    s_mul_i32 s48, s48, 1280
    s_lshl_b32 s49, s49, 6
    s_add_u32 s48, s48, s49
    v_lshlrev_b32 v12, 2, v6
    v_add_u32 v12, s48, v12
    s_mov_b64 exec, 0xffff
    ds_write_b32 v12, v56 offset:13824
    ds_write_b32 v12, v57 offset:14080
    ds_write_b32 v12, v58 offset:14336
    ds_write_b32 v12, v59 offset:14592
    s_mov_b64 exec, 0xffff0000
    ds_write_b32 v12, v56 offset:14784
    s_mov_b64 exec, -1
    s_waitcnt lgkmcnt(0)
    s_barrier
    s_cmp_ge_u32 s53, 4
    s_cbranch_scc1 L_done
    v_lshlrev_b32 v12, 2, v0
    v_lshlrev_b32 v13, 2, v6
    ds_read_b32 v16, v12 offset:13824
    ds_read_b32 v17, v12 offset:15104
    ds_read_b32 v18, v12 offset:16384
    ds_read_b32 v19, v12 offset:17664
    ds_read_b32 v20, v13 offset:14848
    ds_read_b32 v21, v13 offset:16128
    ds_read_b32 v22, v13 offset:17408
    ds_read_b32 v23, v13 offset:18688
    s_waitcnt lgkmcnt(0)
    v_add_f32 v16, v16, v17
    v_add_f32 v20, v20, v21
    v_add_f32 v18, v18, v19
    v_add_f32 v22, v22, v23
    v_add_f32 v16, v16, v18
    v_add_f32 v20, v20, v22
    v_fma_f32 v16, -v60, v20, v16
    v_mul_f32 v16, v16, v61
    s_cmp_lg_u32 s54, 0
    s_cbranch_scc1 L_d_nosilu
    v_cvt_pk_bf16_f32 v16, v16, v16
    v_lshlrev_b32 v16, 16, v16
    v_mul_f32 v18, 0xbfb8aa3b, v16
    v_exp_f32 v18, v18
    s_nop 0
    v_add_f32 v18, 1.0, v18
    v_rcp_f32 v18, v18
    s_nop 0
    v_mul_f32 v16, v16, v18
L_d_nosilu:
    s_nop 1
    v_mov_b32_dpp v17, v16 quad_perm:[1,0,3,2] row_mask:0xf bank_mask:0xf
    v_cvt_pk_bf16_f32 v16, v16, v17
    v_mul_u32_u24 v12, 3072, v7
    v_lshl_add_u32 v12, v6, 1, v12
    s_mul_i32 s48, s54, 16384
    s_lshl_b32 s49, s55, 7
    s_add_u32 s48, s48, s49
    s_add_u32 s48, s48, 360448
    s_mov_b32 exec_lo, 0x55555555
    s_mov_b32 exec_hi, 0x55555555
    buffer_store_dword v16, v12, s[32:35], s48 offen sc0 sc1
    s_mov_b64 exec, -1
L_done:
    s_endpgm
.section .rodata,"a"
.p2align 6
.amdhsa_kernel sequential_preLN__mha_block_cached__moe_arch_mod__decode_kernel
  .amdhsa_next_free_vgpr 128
  .amdhsa_next_free_sgpr 102
  .amdhsa_accum_offset 128
  .amdhsa_group_segment_fixed_size 0
  .amdhsa_kernarg_size 104
  .amdhsa_user_sgpr_count 2
  .amdhsa_user_sgpr_kernarg_segment_ptr 1
  .amdhsa_system_sgpr_workgroup_id_x 1
.end_amdhsa_kernel
```

```asm
; @launch grid=(256,1,1) block=(1024,1,1) lds=140800
.amdgcn_target "amdgcn-amd-amdhsa--gfx950"
.text
.globl sequential_preLN__mha_block_cached__moe_arch_mod__decode_kernel
.p2align 8
.type sequential_preLN__mha_block_cached__moe_arch_mod__decode_kernel,@function
sequential_preLN__mha_block_cached__moe_arch_mod__decode_kernel:
    s_cmp_ge_u32 s2, 256
    s_cbranch_scc1 L_done
    s_load_dwordx2 s[4:5], s[0:1], 0
    s_load_dwordx4 s[8:11], s[0:1], 8
    s_load_dwordx4 s[12:15], s[0:1], 24
    s_load_dwordx4 s[80:83], s[0:1], 48
    s_load_dwordx4 s[84:87], s[0:1], 64
    s_load_dwordx4 s[88:91], s[0:1], 80
    s_load_dwordx2 s[6:7], s[0:1], 96
    s_and_b32 s42, s2, 7
    s_lshr_b32 s43, s2, 3
    s_and_b32 s44, s43, 3
    s_lshl_b32 s45, s42, 2
    s_add_u32 s45, s45, s44
    s_lshr_b32 s44, s43, 2
    s_lshr_b32 s46, s44, 1
    s_and_b32 s47, s44, 1
    s_lshl_b32 s40, s46, 5
    s_add_u32 s40, s40, s45
    s_lshl_b32 s40, s40, 1
    s_add_u32 s40, s40, s47
    s_mul_i32 s41, s40, 1572864
    s_lshr_b32 s99, s45, 3
    s_mov_b32 s96, 1572864
    v_and_b32 v6, 63, v0
    v_lshrrev_b32 v2, 6, v0
    v_lshrrev_b32 v3, 3, v6
    v_and_b32 v4, 7, v6
    v_readfirstlane_b32 s53, v2
    v_lshlrev_b32 v4, 4, v4
    v_mul_u32_u24 v5, 384, v3
    v_add_u32 v1, v5, v4
    v_mul_u32_u24 v5, 40, v2
    v_add_u32 v5, v5, v3
    v_mul_u32_u24 v7, 12288, v5
    v_add_u32 v7, v7, v4
    v_lshlrev_b32 v8, 1, v5
    v_lshlrev_b32 v5, 2, v6
    s_waitcnt lgkmcnt(0)
    s_mov_b32 s56, s4
    s_and_b32 s57, s5, 0xffff
    s_mov_b32 s58, 0x1400
    s_mov_b32 s59, 0x00020000
    s_mul_i32 s48, s46, 1280
    s_add_u32 s4, s4, s48
    s_addc_u32 s5, s5, 0
    s_mov_b32 s28, s4
    s_and_b32 s29, s5, 0xffff
    s_mov_b32 s30, 0x500
    s_mov_b32 s31, 0x00020000
    s_mul_i32 s48, s45, 384
    s_add_u32 s12, s12, s48
    s_addc_u32 s13, s13, 0
    s_sub_u32 s49, 7864320, s48
    s_mov_b32 s24, s12
    s_and_b32 s25, s13, 0xffff
    s_mov_b32 s26, s49
    s_mov_b32 s27, 0x00020000
    s_add_u32 s8, s8, s41
    s_addc_u32 s9, s9, 0
    s_mov_b32 s16, s8
    s_and_b32 s17, s9, 0xffff
    s_mov_b32 s18, s96
    s_mov_b32 s19, 0x00020000
    s_mov_b32 s99, s41
    v_mov_b32 v3, 12928
    v_mov_b32 v4, 16
    ds_write_b32 v3, v4
    s_mul_i32 s41, s53, 24576
    buffer_load_dword v46, v5, s[28:31], 0 offen offset:0
    buffer_load_dword v47, v5, s[28:31], 0 offen offset:256
    buffer_load_dword v48, v5, s[28:31], 0 offen offset:512
    buffer_load_dword v49, v5, s[28:31], 0 offen offset:768
    buffer_load_dword v50, v5, s[28:31], 0 offen offset:1024
    buffer_load_ushort v51, v8, s[28:31], 0 offen offset:0
    buffer_load_ushort v52, v8, s[28:31], 0 offen offset:16
    buffer_load_ushort v53, v8, s[28:31], 0 offen offset:32
    buffer_load_ushort v126, v8, s[28:31], 0 offen offset:48
    buffer_load_ushort v127, v8, s[28:31], 0 offen offset:64
    s_mov_b32 s48, 0
    buffer_load_dwordx4 v[102:105], v7, s[24:27], s48 offen offset:0 nt
    buffer_load_dwordx4 v[106:109], v7, s[24:27], s48 offen offset:128 nt
    buffer_load_dwordx4 v[110:113], v7, s[24:27], s48 offen offset:256 nt
    s_mov_b32 s48, 98304
    buffer_load_dwordx4 v[114:117], v7, s[24:27], s48 offen offset:0 nt
    buffer_load_dwordx4 v[118:121], v7, s[24:27], s48 offen offset:128 nt
    buffer_load_dwordx4 v[122:125], v7, s[24:27], s48 offen offset:256 nt
    s_add_u32 s48, s41, 0
    buffer_load_dwordx4 v[78:81], v1, s[16:19], s48 offen offset:0 nt
    buffer_load_dwordx4 v[82:85], v1, s[16:19], s48 offen offset:128 nt
    buffer_load_dwordx4 v[86:89], v1, s[16:19], s48 offen offset:256 nt
    s_mov_b32 s48, 196608
    buffer_load_dwordx4 v[10:13], v7, s[24:27], s48 offen offset:0 nt
    buffer_load_dwordx4 v[14:17], v7, s[24:27], s48 offen offset:128 nt
    buffer_load_dwordx4 v[18:21], v7, s[24:27], s48 offen offset:256 nt
    s_add_u32 s48, s41, 3072
    buffer_load_dwordx4 v[90:93], v1, s[16:19], s48 offen offset:0 nt
    buffer_load_dwordx4 v[94:97], v1, s[16:19], s48 offen offset:128 nt
    buffer_load_dwordx4 v[98:101], v1, s[16:19], s48 offen offset:256 nt
    s_mov_b32 s48, 294912
    buffer_load_dwordx4 v[22:25], v7, s[24:27], s48 offen offset:0 nt
    buffer_load_dwordx4 v[26:29], v7, s[24:27], s48 offen offset:128 nt
    buffer_load_dwordx4 v[30:33], v7, s[24:27], s48 offen offset:256 nt
    s_mov_b32 s48, 393216
    buffer_load_dwordx4 v[34:37], v7, s[24:27], s48 offen offset:0 nt
    buffer_load_dwordx4 v[38:41], v7, s[24:27], s48 offen offset:128 nt
    buffer_load_dwordx4 v[42:45], v7, s[24:27], s48 offen offset:256 nt
    s_add_u32 s10, s10, s99
    s_addc_u32 s11, s11, 0
    s_mov_b32 s20, s10
    s_and_b32 s21, s11, 0xffff
    s_mov_b32 s22, s96
    s_mov_b32 s23, 0x00020000
    s_mov_b32 s32, s6
    s_and_b32 s33, s7, 0xffff
    s_mov_b32 s34, 0x200000
    s_mov_b32 s35, 0x00020000
    s_mov_b32 s36, s90
    s_and_b32 s37, s91, 0xffff
    s_mov_b32 s38, 0x100
    s_mov_b32 s39, 0x00020000
    s_mov_b32 s60, s14
    s_and_b32 s61, s15, 0xffff
    s_mov_b32 s62, 0x780000
    s_mov_b32 s63, 0x00020000
    s_mov_b32 s64, s82
    s_and_b32 s65, s83, 0xffff
    s_mov_b32 s66, 0x1e0000
    s_mov_b32 s67, 0x00020000
    s_mov_b32 s92, s84
    s_and_b32 s93, s85, 0xffff
    s_mov_b32 s94, 0x1e0000
    s_mov_b32 s95, 0x00020000
    s_mov_b32 s68, s86
    s_and_b32 s69, s87, 0xffff
    s_mov_b32 s70, 0x1e0000
    s_mov_b32 s71, 0x00020000
    s_mov_b32 s72, s80
    s_and_b32 s73, s81, 0xffff
    s_mov_b32 s74, 0x500
    s_mov_b32 s75, 0x00020000
    s_mov_b32 s76, s88
    s_and_b32 s77, s89, 0xffff
    s_mov_b32 s78, 0x1400
    s_mov_b32 s79, 0x00020000
    s_mul_i32 s48, s2, 6554
    s_lshr_b32 s54, s48, 16
    s_mul_i32 s48, s54, 10
    s_sub_u32 s55, s2, s48
    s_mov_b32 s98, 0
    s_cmp_lt_u32 s2, 80
    s_cbranch_scc1 L_role_1
    s_mov_b32 s98, 1
    s_sub_u32 s55, s2, 80
    s_cmp_ge_u32 s55, 24
    s_cselect_b32 s54, 1, 0
    s_mul_i32 s48, s54, 24
    s_sub_u32 s55, s55, s48
    s_cmp_lt_u32 s2, 128
    s_cbranch_scc1 L_role_1
    s_mov_b32 s98, 2
    s_sub_u32 s55, s2, 128
    s_cmp_lt_u32 s2, 148
    s_cbranch_scc1 L_role_1
    s_mov_b32 s98, 3
L_role_1:
    v_mov_b32 v2, -1
    v_lshlrev_b32 v3, 2, v0
    v_cmp_gt_u32 vcc, 384, v0
    s_and_saveexec_b64 s[100:101], vcc
    s_cbranch_execz L_clr1
    s_mul_i32 s48, s40, 1536
    s_add_u32 s48, s48, 1048576
    buffer_store_dword v2, v3, s[32:35], s48 offen sc0 sc1
    v_cmp_eq_u32 vcc, 0, v0
    s_and_b64 exec, exec, vcc
    s_cbranch_execz L_clr1
    s_lshl_b32 s48, s2, 7
    s_add_u32 s48, s48, 458752
    buffer_store_dword v2, v3, s[32:35], s48 offen sc0 sc1
    buffer_store_dword v2, v3, s[32:35], s48 offen offset:4 sc0 sc1
L_clr1:
    s_mov_b64 exec, s[100:101]
    s_cmp_ge_u32 s98, 2
    s_cbranch_scc1 L_clr3
    s_cmp_eq_u32 s98, 1
    s_cbranch_scc1 L_clr_d
    v_cmp_gt_u32 vcc, 256, v0
    s_and_saveexec_b64 s[100:101], vcc
    s_cbranch_execz L_clr2
    v_lshrrev_b32 v3, 6, v0
    v_mul_u32_u24 v3, 2560, v3
    v_and_b32 v4, 63, v0
    v_lshl_add_u32 v3, v4, 2, v3
    s_mul_i32 s48, s54, 10240
    s_lshl_b32 s49, s55, 8
    s_add_u32 s48, s48, s49
    s_add_u32 s48, s48, 262144
    buffer_store_dword v2, v3, s[32:35], s48 offen sc0 sc1
    v_cmp_eq_u32 vcc, 0, v0
    s_and_b64 exec, exec, vcc
    s_cbranch_execz L_clr2
    s_lshl_b32 s48, s2, 2
    s_add_u32 s48, s48, 454656
    buffer_store_dword v2, v3, s[32:35], s48 offen sc0 sc1
    s_branch L_clr2
L_clr_d:
    v_cmp_gt_u32 vcc, 128, v0
    s_and_saveexec_b64 s[100:101], vcc
    s_cbranch_execz L_clr2
    v_lshrrev_b32 v3, 5, v0
    v_mul_u32_u24 v3, 3072, v3
    v_and_b32 v4, 31, v0
    v_lshl_add_u32 v3, v4, 2, v3
    s_mul_i32 s48, s54, 16384
    s_lshl_b32 s49, s55, 7
    s_add_u32 s48, s48, s49
    s_add_u32 s48, s48, 360448
    buffer_store_dword v2, v3, s[32:35], s48 offen sc0 sc1
L_clr2:
    s_mov_b64 exec, s[100:101]
L_clr3:
    s_waitcnt vmcnt(26)
    v_lshlrev_b32 v54, 16, v46
    v_and_b32 v55, 0xffff0000, v46
    v_lshlrev_b32 v56, 16, v47
    v_and_b32 v57, 0xffff0000, v47
    v_lshlrev_b32 v58, 16, v48
    v_and_b32 v59, 0xffff0000, v48
    v_lshlrev_b32 v60, 16, v49
    v_and_b32 v61, 0xffff0000, v49
    v_lshlrev_b32 v62, 16, v50
    v_and_b32 v63, 0xffff0000, v50
    v_add_f32 v2, v54, v55
    v_add_f32 v2, v2, v56
    v_add_f32 v2, v2, v57
    v_add_f32 v2, v2, v58
    v_add_f32 v2, v2, v59
    v_add_f32 v2, v2, v60
    v_add_f32 v2, v2, v61
    v_add_f32 v2, v2, v62
    v_add_f32 v2, v2, v63
    s_nop 1
    v_add_f32_dpp v2, v2, v2 quad_perm:[1,0,3,2] row_mask:0xf bank_mask:0xf
    s_nop 1
    v_add_f32_dpp v2, v2, v2 quad_perm:[2,3,0,1] row_mask:0xf bank_mask:0xf
    s_nop 1
    v_add_f32_dpp v2, v2, v2 row_half_mirror row_mask:0xf bank_mask:0xf
    s_nop 1
    v_add_f32_dpp v2, v2, v2 row_mirror row_mask:0xf bank_mask:0xf
    s_nop 1
    v_readlane_b32 s48, v2, 0
    v_readlane_b32 s49, v2, 16
    v_readlane_b32 s50, v2, 32
    v_readlane_b32 s51, v2, 48
    s_nop 1
    v_mov_b32 v2, s48
    v_add_f32 v2, s49, v2
    v_add_f32 v2, s50, v2
    v_add_f32 v2, s51, v2
    v_mul_f32 v2, 0x3acccccd, v2
    v_sub_f32 v4, v54, v2
    v_mul_f32 v3, v4, v4
    v_sub_f32 v4, v55, v2
    v_fmac_f32 v3, v4, v4
    v_sub_f32 v4, v56, v2
    v_fmac_f32 v3, v4, v4
    v_sub_f32 v4, v57, v2
    v_fmac_f32 v3, v4, v4
    v_sub_f32 v4, v58, v2
    v_fmac_f32 v3, v4, v4
    v_sub_f32 v4, v59, v2
    v_fmac_f32 v3, v4, v4
    v_sub_f32 v4, v60, v2
    v_fmac_f32 v3, v4, v4
    v_sub_f32 v4, v61, v2
    v_fmac_f32 v3, v4, v4
    v_sub_f32 v4, v62, v2
    v_fmac_f32 v3, v4, v4
    v_sub_f32 v4, v63, v2
    v_fmac_f32 v3, v4, v4
    s_nop 1
    v_add_f32_dpp v3, v3, v3 quad_perm:[1,0,3,2] row_mask:0xf bank_mask:0xf
    s_nop 1
    v_add_f32_dpp v3, v3, v3 quad_perm:[2,3,0,1] row_mask:0xf bank_mask:0xf
    s_nop 1
    v_add_f32_dpp v3, v3, v3 row_half_mirror row_mask:0xf bank_mask:0xf
    s_nop 1
    v_add_f32_dpp v3, v3, v3 row_mirror row_mask:0xf bank_mask:0xf
    s_nop 1
    v_readlane_b32 s48, v3, 0
    v_readlane_b32 s49, v3, 16
    v_readlane_b32 s50, v3, 32
    v_readlane_b32 s51, v3, 48
    s_nop 1
    v_mov_b32 v3, s48
    v_add_f32 v3, s49, v3
    v_add_f32 v3, s50, v3
    v_add_f32 v3, s51, v3
    v_mul_f32 v3, 0x3acccccd, v3
    v_cvt_pk_bf16_f32 v2, v2, v2
    v_lshlrev_b32 v2, 16, v2
    v_cvt_pk_bf16_f32 v3, v3, v3
    v_lshlrev_b32 v3, 16, v3
    v_add_f32 v3, 0x3727c5ac, v3
    v_cvt_pk_bf16_f32 v3, v3, v3
    v_lshlrev_b32 v3, 16, v3
    v_sqrt_f32 v3, v3
    s_nop 0
    v_cvt_pk_bf16_f32 v3, v3, v3
    v_lshlrev_b32 v3, 16, v3
    v_rcp_f32 v3, v3
    s_waitcnt vmcnt(21)
    v_lshlrev_b32 v51, 16, v51
    v_sub_f32 v51, v51, v2
    v_cvt_pk_bf16_f32 v51, v51, v51
    v_lshlrev_b32 v51, 16, v51
    v_mul_f32 v51, v51, v3
    v_cvt_pk_bf16_f32 v51, v51, v51
    v_lshlrev_b32 v51, 16, v51
    v_lshlrev_b32 v52, 16, v52
    v_sub_f32 v52, v52, v2
    v_cvt_pk_bf16_f32 v52, v52, v52
    v_lshlrev_b32 v52, 16, v52
    v_mul_f32 v52, v52, v3
    v_cvt_pk_bf16_f32 v52, v52, v52
    v_lshlrev_b32 v52, 16, v52
    v_lshlrev_b32 v53, 16, v53
    v_sub_f32 v53, v53, v2
    v_cvt_pk_bf16_f32 v53, v53, v53
    v_lshlrev_b32 v53, 16, v53
    v_mul_f32 v53, v53, v3
    v_cvt_pk_bf16_f32 v53, v53, v53
    v_lshlrev_b32 v53, 16, v53
    v_lshlrev_b32 v126, 16, v126
    v_sub_f32 v126, v126, v2
    v_cvt_pk_bf16_f32 v126, v126, v126
    v_lshlrev_b32 v126, 16, v126
    v_mul_f32 v126, v126, v3
    v_cvt_pk_bf16_f32 v126, v126, v126
    v_lshlrev_b32 v126, 16, v126
    v_lshlrev_b32 v127, 16, v127
    v_sub_f32 v127, v127, v2
    v_cvt_pk_bf16_f32 v127, v127, v127
    v_lshlrev_b32 v127, 16, v127
    v_mul_f32 v127, v127, v3
    v_cvt_pk_bf16_f32 v127, v127, v127
    v_lshlrev_b32 v127, 16, v127
    s_waitcnt vmcnt(18)
    v_lshlrev_b32 v2, 16, v102
    v_and_b32 v3, 0xffff0000, v102
    v_mul_f32 v54, v51, v2
    v_mul_f32 v55, v51, v3
    v_lshlrev_b32 v2, 16, v103
    v_and_b32 v3, 0xffff0000, v103
    v_mul_f32 v56, v51, v2
    v_mul_f32 v57, v51, v3
    v_lshlrev_b32 v2, 16, v104
    v_and_b32 v3, 0xffff0000, v104
    v_mul_f32 v58, v51, v2
    v_mul_f32 v59, v51, v3
    v_lshlrev_b32 v2, 16, v105
    v_and_b32 v3, 0xffff0000, v105
    v_mul_f32 v60, v51, v2
    v_mul_f32 v61, v51, v3
    v_lshlrev_b32 v2, 16, v106
    v_and_b32 v3, 0xffff0000, v106
    v_mul_f32 v62, v51, v2
    v_mul_f32 v63, v51, v3
    v_lshlrev_b32 v2, 16, v107
    v_and_b32 v3, 0xffff0000, v107
    v_mul_f32 v64, v51, v2
    v_mul_f32 v65, v51, v3
    v_lshlrev_b32 v2, 16, v108
    v_and_b32 v3, 0xffff0000, v108
    v_mul_f32 v66, v51, v2
    v_mul_f32 v67, v51, v3
    v_lshlrev_b32 v2, 16, v109
    v_and_b32 v3, 0xffff0000, v109
    v_mul_f32 v68, v51, v2
    v_mul_f32 v69, v51, v3
    v_lshlrev_b32 v2, 16, v110
    v_and_b32 v3, 0xffff0000, v110
    v_mul_f32 v70, v51, v2
    v_mul_f32 v71, v51, v3
    v_lshlrev_b32 v2, 16, v111
    v_and_b32 v3, 0xffff0000, v111
    v_mul_f32 v72, v51, v2
    v_mul_f32 v73, v51, v3
    v_lshlrev_b32 v2, 16, v112
    v_and_b32 v3, 0xffff0000, v112
    v_mul_f32 v74, v51, v2
    v_mul_f32 v75, v51, v3
    v_lshlrev_b32 v2, 16, v113
    v_and_b32 v3, 0xffff0000, v113
    v_mul_f32 v76, v51, v2
    v_mul_f32 v77, v51, v3
    s_add_u32 s48, s41, 6144
    buffer_load_dwordx4 v[102:105], v1, s[16:19], s48 offen offset:0 nt
    buffer_load_dwordx4 v[106:109], v1, s[16:19], s48 offen offset:128 nt
    buffer_load_dwordx4 v[110:113], v1, s[16:19], s48 offen offset:256 nt
    s_waitcnt vmcnt(18)
    v_lshlrev_b32 v2, 16, v114
    v_and_b32 v3, 0xffff0000, v114
    v_fmac_f32 v54, v52, v2
    v_fmac_f32 v55, v52, v3
    v_lshlrev_b32 v2, 16, v115
    v_and_b32 v3, 0xffff0000, v115
    v_fmac_f32 v56, v52, v2
    v_fmac_f32 v57, v52, v3
    v_lshlrev_b32 v2, 16, v116
    v_and_b32 v3, 0xffff0000, v116
    v_fmac_f32 v58, v52, v2
    v_fmac_f32 v59, v52, v3
    v_lshlrev_b32 v2, 16, v117
    v_and_b32 v3, 0xffff0000, v117
    v_fmac_f32 v60, v52, v2
    v_fmac_f32 v61, v52, v3
    v_lshlrev_b32 v2, 16, v118
    v_and_b32 v3, 0xffff0000, v118
    v_fmac_f32 v62, v52, v2
    v_fmac_f32 v63, v52, v3
    v_lshlrev_b32 v2, 16, v119
    v_and_b32 v3, 0xffff0000, v119
    v_fmac_f32 v64, v52, v2
    v_fmac_f32 v65, v52, v3
    v_lshlrev_b32 v2, 16, v120
    v_and_b32 v3, 0xffff0000, v120
    v_fmac_f32 v66, v52, v2
    v_fmac_f32 v67, v52, v3
    v_lshlrev_b32 v2, 16, v121
    v_and_b32 v3, 0xffff0000, v121
    v_fmac_f32 v68, v52, v2
    v_fmac_f32 v69, v52, v3
    v_lshlrev_b32 v2, 16, v122
    v_and_b32 v3, 0xffff0000, v122
    v_fmac_f32 v70, v52, v2
    v_fmac_f32 v71, v52, v3
    v_lshlrev_b32 v2, 16, v123
    v_and_b32 v3, 0xffff0000, v123
    v_fmac_f32 v72, v52, v2
    v_fmac_f32 v73, v52, v3
    v_lshlrev_b32 v2, 16, v124
    v_and_b32 v3, 0xffff0000, v124
    v_fmac_f32 v74, v52, v2
    v_fmac_f32 v75, v52, v3
    v_lshlrev_b32 v2, 16, v125
    v_and_b32 v3, 0xffff0000, v125
    v_fmac_f32 v76, v52, v2
    v_fmac_f32 v77, v52, v3
    s_add_u32 s48, s41, 9216
    buffer_load_dwordx4 v[114:117], v1, s[16:19], s48 offen offset:0 nt
    buffer_load_dwordx4 v[118:121], v1, s[16:19], s48 offen offset:128 nt
    buffer_load_dwordx4 v[122:125], v1, s[16:19], s48 offen offset:256 nt
    s_waitcnt vmcnt(15)
    v_lshlrev_b32 v2, 16, v10
    v_and_b32 v3, 0xffff0000, v10
    v_fmac_f32 v54, v53, v2
    v_fmac_f32 v55, v53, v3
    v_lshlrev_b32 v2, 16, v11
    v_and_b32 v3, 0xffff0000, v11
    v_fmac_f32 v56, v53, v2
    v_fmac_f32 v57, v53, v3
    v_lshlrev_b32 v2, 16, v12
    v_and_b32 v3, 0xffff0000, v12
    v_fmac_f32 v58, v53, v2
    v_fmac_f32 v59, v53, v3
    v_lshlrev_b32 v2, 16, v13
    v_and_b32 v3, 0xffff0000, v13
    v_fmac_f32 v60, v53, v2
    v_fmac_f32 v61, v53, v3
    v_lshlrev_b32 v2, 16, v14
    v_and_b32 v3, 0xffff0000, v14
    v_fmac_f32 v62, v53, v2
    v_fmac_f32 v63, v53, v3
    v_lshlrev_b32 v2, 16, v15
    v_and_b32 v3, 0xffff0000, v15
    v_fmac_f32 v64, v53, v2
    v_fmac_f32 v65, v53, v3
    v_lshlrev_b32 v2, 16, v16
    v_and_b32 v3, 0xffff0000, v16
    v_fmac_f32 v66, v53, v2
    v_fmac_f32 v67, v53, v3
    v_lshlrev_b32 v2, 16, v17
    v_and_b32 v3, 0xffff0000, v17
    v_fmac_f32 v68, v53, v2
    v_fmac_f32 v69, v53, v3
    v_lshlrev_b32 v2, 16, v18
    v_and_b32 v3, 0xffff0000, v18
    v_fmac_f32 v70, v53, v2
    v_fmac_f32 v71, v53, v3
    v_lshlrev_b32 v2, 16, v19
    v_and_b32 v3, 0xffff0000, v19
    v_fmac_f32 v72, v53, v2
    v_fmac_f32 v73, v53, v3
    v_lshlrev_b32 v2, 16, v20
    v_and_b32 v3, 0xffff0000, v20
    v_fmac_f32 v74, v53, v2
    v_fmac_f32 v75, v53, v3
    v_lshlrev_b32 v2, 16, v21
    v_and_b32 v3, 0xffff0000, v21
    v_fmac_f32 v76, v53, v2
    v_fmac_f32 v77, v53, v3
    s_waitcnt vmcnt(9)
    v_lshlrev_b32 v2, 16, v22
    v_and_b32 v3, 0xffff0000, v22
    v_fmac_f32 v54, v126, v2
    v_fmac_f32 v55, v126, v3
    v_lshlrev_b32 v2, 16, v23
    v_and_b32 v3, 0xffff0000, v23
    v_fmac_f32 v56, v126, v2
    v_fmac_f32 v57, v126, v3
    v_lshlrev_b32 v2, 16, v24
    v_and_b32 v3, 0xffff0000, v24
    v_fmac_f32 v58, v126, v2
    v_fmac_f32 v59, v126, v3
    v_lshlrev_b32 v2, 16, v25
    v_and_b32 v3, 0xffff0000, v25
    v_fmac_f32 v60, v126, v2
    v_fmac_f32 v61, v126, v3
    v_lshlrev_b32 v2, 16, v26
    v_and_b32 v3, 0xffff0000, v26
    v_fmac_f32 v62, v126, v2
    v_fmac_f32 v63, v126, v3
    v_lshlrev_b32 v2, 16, v27
    v_and_b32 v3, 0xffff0000, v27
    v_fmac_f32 v64, v126, v2
    v_fmac_f32 v65, v126, v3
    v_lshlrev_b32 v2, 16, v28
    v_and_b32 v3, 0xffff0000, v28
    v_fmac_f32 v66, v126, v2
    v_fmac_f32 v67, v126, v3
    v_lshlrev_b32 v2, 16, v29
    v_and_b32 v3, 0xffff0000, v29
    v_fmac_f32 v68, v126, v2
    v_fmac_f32 v69, v126, v3
    v_lshlrev_b32 v2, 16, v30
    v_and_b32 v3, 0xffff0000, v30
    v_fmac_f32 v70, v126, v2
    v_fmac_f32 v71, v126, v3
    v_lshlrev_b32 v2, 16, v31
    v_and_b32 v3, 0xffff0000, v31
    v_fmac_f32 v72, v126, v2
    v_fmac_f32 v73, v126, v3
    v_lshlrev_b32 v2, 16, v32
    v_and_b32 v3, 0xffff0000, v32
    v_fmac_f32 v74, v126, v2
    v_fmac_f32 v75, v126, v3
    v_lshlrev_b32 v2, 16, v33
    v_and_b32 v3, 0xffff0000, v33
    v_fmac_f32 v76, v126, v2
    v_fmac_f32 v77, v126, v3
    s_waitcnt vmcnt(6)
    v_lshlrev_b32 v2, 16, v34
    v_and_b32 v3, 0xffff0000, v34
    v_fmac_f32 v54, v127, v2
    v_fmac_f32 v55, v127, v3
    v_lshlrev_b32 v2, 16, v35
    v_and_b32 v3, 0xffff0000, v35
    v_fmac_f32 v56, v127, v2
    v_fmac_f32 v57, v127, v3
    v_lshlrev_b32 v2, 16, v36
    v_and_b32 v3, 0xffff0000, v36
    v_fmac_f32 v58, v127, v2
    v_fmac_f32 v59, v127, v3
    v_lshlrev_b32 v2, 16, v37
    v_and_b32 v3, 0xffff0000, v37
    v_fmac_f32 v60, v127, v2
    v_fmac_f32 v61, v127, v3
    v_lshlrev_b32 v2, 16, v38
    v_and_b32 v3, 0xffff0000, v38
    v_fmac_f32 v62, v127, v2
    v_fmac_f32 v63, v127, v3
    v_lshlrev_b32 v2, 16, v39
    v_and_b32 v3, 0xffff0000, v39
    v_fmac_f32 v64, v127, v2
    v_fmac_f32 v65, v127, v3
    v_lshlrev_b32 v2, 16, v40
    v_and_b32 v3, 0xffff0000, v40
    v_fmac_f32 v66, v127, v2
    v_fmac_f32 v67, v127, v3
    v_lshlrev_b32 v2, 16, v41
    v_and_b32 v3, 0xffff0000, v41
    v_fmac_f32 v68, v127, v2
    v_fmac_f32 v69, v127, v3
    v_lshlrev_b32 v2, 16, v42
    v_and_b32 v3, 0xffff0000, v42
    v_fmac_f32 v70, v127, v2
    v_fmac_f32 v71, v127, v3
    v_lshlrev_b32 v2, 16, v43
    v_and_b32 v3, 0xffff0000, v43
    v_fmac_f32 v72, v127, v2
    v_fmac_f32 v73, v127, v3
    v_lshlrev_b32 v2, 16, v44
    v_and_b32 v3, 0xffff0000, v44
    v_fmac_f32 v74, v127, v2
    v_fmac_f32 v75, v127, v3
    v_lshlrev_b32 v2, 16, v45
    v_and_b32 v3, 0xffff0000, v45
    v_fmac_f32 v76, v127, v2
    v_fmac_f32 v77, v127, v3
    s_nop 1
    v_permlane32_swap_b32 v54, v58
    v_permlane32_swap_b32 v55, v59
    v_permlane32_swap_b32 v56, v60
    v_permlane32_swap_b32 v57, v61
    v_permlane32_swap_b32 v62, v66
    v_permlane32_swap_b32 v63, v67
    v_permlane32_swap_b32 v64, v68
    v_permlane32_swap_b32 v65, v69
    v_permlane32_swap_b32 v70, v74
    v_permlane32_swap_b32 v71, v75
    v_permlane32_swap_b32 v72, v76
    v_permlane32_swap_b32 v73, v77
    v_add_f32 v54, v54, v58
    v_add_f32 v55, v55, v59
    v_add_f32 v56, v56, v60
    v_add_f32 v57, v57, v61
    v_add_f32 v62, v62, v66
    v_add_f32 v63, v63, v67
    v_add_f32 v64, v64, v68
    v_add_f32 v65, v65, v69
    v_add_f32 v70, v70, v74
    v_add_f32 v71, v71, v75
    v_add_f32 v72, v72, v76
    v_add_f32 v73, v73, v77
    s_nop 1
    v_permlane16_swap_b32 v54, v56
    v_permlane16_swap_b32 v55, v57
    v_permlane16_swap_b32 v62, v64
    v_permlane16_swap_b32 v63, v65
    v_permlane16_swap_b32 v70, v72
    v_permlane16_swap_b32 v71, v73
    v_add_f32 v54, v54, v56
    v_add_f32 v55, v55, v57
    v_add_f32 v62, v62, v64
    v_add_f32 v63, v63, v65
    v_add_f32 v70, v70, v72
    v_add_f32 v71, v71, v73
    s_nop 1
    v_add_f32_dpp v54, v54, v54 row_ror:8 row_mask:0xf bank_mask:0xf
    v_add_f32_dpp v55, v55, v55 row_ror:8 row_mask:0xf bank_mask:0xf
    v_add_f32_dpp v62, v62, v62 row_ror:8 row_mask:0xf bank_mask:0xf
    v_add_f32_dpp v63, v63, v63 row_ror:8 row_mask:0xf bank_mask:0xf
    v_add_f32_dpp v70, v70, v70 row_ror:8 row_mask:0xf bank_mask:0xf
    v_add_f32_dpp v71, v71, v71 row_ror:8 row_mask:0xf bank_mask:0xf
    v_lshrrev_b32 v2, 6, v0
    v_mul_u32_u24 v9, 768, v2
    v_and_b32 v2, 7, v6
    v_lshlrev_b32 v2, 5, v2
    v_add_u32 v9, v9, v2
    v_lshrrev_b32 v2, 5, v6
    v_lshlrev_b32 v2, 4, v2
    v_add_u32 v9, v9, v2
    v_bfe_u32 v2, v6, 4, 1
    v_lshlrev_b32 v2, 3, v2
    v_add_u32 v9, v9, v2
    ds_write_b64 v9, v[54:55] offset:0
    ds_write_b64 v9, v[62:63] offset:256
    ds_write_b64 v9, v[70:71] offset:512
    s_waitcnt lgkmcnt(0)
    s_barrier
    v_cmp_gt_u32 vcc, 192, v0
    s_and_saveexec_b64 s[100:101], vcc
    s_cbranch_execz L_q1
    v_lshlrev_b32 v2, 2, v0
    ds_read_b32 v54, v2 offset:0
    ds_read_b32 v55, v2 offset:768
    ds_read_b32 v56, v2 offset:1536
    ds_read_b32 v57, v2 offset:2304
    ds_read_b32 v58, v2 offset:3072
    ds_read_b32 v59, v2 offset:3840
    ds_read_b32 v60, v2 offset:4608
    ds_read_b32 v61, v2 offset:5376
    ds_read_b32 v62, v2 offset:6144
    ds_read_b32 v63, v2 offset:6912
    ds_read_b32 v64, v2 offset:7680
    ds_read_b32 v65, v2 offset:8448
    ds_read_b32 v66, v2 offset:9216
    ds_read_b32 v67, v2 offset:9984
    ds_read_b32 v68, v2 offset:10752
    ds_read_b32 v69, v2 offset:11520
    s_waitcnt lgkmcnt(0)
    v_add_f32 v54, v54, v55
    v_add_f32 v54, v54, v56
    v_add_f32 v54, v54, v57
    v_add_f32 v54, v54, v58
    v_add_f32 v54, v54, v59
    v_add_f32 v54, v54, v60
    v_add_f32 v54, v54, v61
    v_add_f32 v54, v54, v62
    v_add_f32 v54, v54, v63
    v_add_f32 v54, v54, v64
    v_add_f32 v54, v54, v65
    v_add_f32 v54, v54, v66
    v_add_f32 v54, v54, v67
    v_add_f32 v54, v54, v68
    v_add_f32 v54, v54, v69
    v_cvt_pk_bf16_f32 v54, v54, v54
    v_lshlrev_b32 v2, 1, v0
    ds_write_b16 v2, v54 offset:12288
    v_cmp_eq_u32 vcc, 0, v0
    s_and_b64 exec, exec, vcc
    s_cbranch_execz L_q2
    v_mov_b32 v3, 1
    v_mov_b32 v2, 4
    buffer_atomic_add v3, v2, s[36:39], 0 offen sc1
L_q2:
    s_waitcnt lgkmcnt(0)
L_q1:
    s_mov_b64 exec, s[100:101]
    s_barrier
    v_and_b32 v2, 7, v6
    v_lshlrev_b32 v2, 4, v2
    ds_read_b128 v[10:13], v2 offset:12288
    ds_read_b128 v[14:17], v2 offset:12416
    ds_read_b128 v[18:21], v2 offset:12544
    s_waitcnt lgkmcnt(0)
    v_mov_b32 v30, 0xff7fffff
    v_mov_b32 v31, 0
    v_mov_b32 v54, 0
    v_mov_b32 v55, 0
    v_mov_b32 v56, 0
    v_mov_b32 v57, 0
    v_mov_b32 v58, 0
    v_mov_b32 v59, 0
    v_mov_b32 v60, 0
    v_mov_b32 v61, 0
    v_mov_b32 v62, 0
    v_mov_b32 v63, 0
    v_mov_b32 v64, 0
    v_mov_b32 v65, 0
    v_mov_b32 v66, 0
    v_mov_b32 v67, 0
    v_mov_b32 v68, 0
    v_mov_b32 v69, 0
    v_mov_b32 v70, 0
    v_mov_b32 v71, 0
    v_mov_b32 v72, 0
    v_mov_b32 v73, 0
    v_mov_b32 v74, 0
    v_mov_b32 v75, 0
    v_mov_b32 v76, 0
    v_mov_b32 v77, 0
    v_mov_b32 v33, 12928
    v_mov_b32 v34, 1
    s_mov_b32 s52, 0x3fb8aa3b
L_loop:
    s_mov_b64 exec, 1
    ds_add_rtn_u32 v32, v33, v34
    s_mov_b64 exec, -1
    s_waitcnt vmcnt(9)
    v_dot2_f32_bf16 v2, v78, v10, 0
    v_dot2_f32_bf16 v3, v82, v14, 0
    v_dot2_f32_bf16 v4, v86, v18, 0
    v_dot2_f32_bf16 v2, v79, v11, v2
    v_dot2_f32_bf16 v3, v83, v15, v3
    v_dot2_f32_bf16 v4, v87, v19, v4
    v_dot2_f32_bf16 v2, v80, v12, v2
    v_dot2_f32_bf16 v3, v84, v16, v3
    v_dot2_f32_bf16 v4, v88, v20, v4
    v_dot2_f32_bf16 v2, v81, v13, v2
    v_dot2_f32_bf16 v3, v85, v17, v3
    v_dot2_f32_bf16 v4, v89, v21, v4
    s_add_u32 s48, s41, 12288
    buffer_load_dwordx4 v[78:81], v1, s[16:19], s48 offen offset:0 nt
    buffer_load_dwordx4 v[82:85], v1, s[16:19], s48 offen offset:128 nt
    buffer_load_dwordx4 v[86:89], v1, s[16:19], s48 offen offset:256 nt
    v_add_f32 v2, v2, v3
    v_add_f32 v2, v2, v4
    s_nop 1
    v_add_f32_dpp v2, v2, v2 quad_perm:[1,0,3,2] row_mask:0xf bank_mask:0xf
    s_nop 1
    v_add_f32_dpp v2, v2, v2 quad_perm:[2,3,0,1] row_mask:0xf bank_mask:0xf
    s_nop 1
    v_add_f32_dpp v2, v2, v2 row_half_mirror row_mask:0xf bank_mask:0xf
    v_cvt_pk_bf16_f32 v2, v2, v2
    v_lshlrev_b32 v2, 16, v2
    v_mul_f32 v2, 0x3d93cd3a, v2
    v_cvt_pk_bf16_f32 v2, v2, v2
    v_lshlrev_b32 v22, 16, v2
    s_waitcnt vmcnt(9)
    v_dot2_f32_bf16 v2, v90, v10, 0
    v_dot2_f32_bf16 v3, v94, v14, 0
    v_dot2_f32_bf16 v4, v98, v18, 0
    v_dot2_f32_bf16 v2, v91, v11, v2
    v_dot2_f32_bf16 v3, v95, v15, v3
    v_dot2_f32_bf16 v4, v99, v19, v4
    v_dot2_f32_bf16 v2, v92, v12, v2
    v_dot2_f32_bf16 v3, v96, v16, v3
    v_dot2_f32_bf16 v4, v100, v20, v4
    v_dot2_f32_bf16 v2, v93, v13, v2
    v_dot2_f32_bf16 v3, v97, v17, v3
    v_dot2_f32_bf16 v4, v101, v21, v4
    s_add_u32 s48, s41, 15360
    buffer_load_dwordx4 v[90:93], v1, s[16:19], s48 offen offset:0 nt
    buffer_load_dwordx4 v[94:97], v1, s[16:19], s48 offen offset:128 nt
    buffer_load_dwordx4 v[98:101], v1, s[16:19], s48 offen offset:256 nt
    v_add_f32 v2, v2, v3
    v_add_f32 v2, v2, v4
    s_nop 1
    v_add_f32_dpp v2, v2, v2 quad_perm:[1,0,3,2] row_mask:0xf bank_mask:0xf
    s_nop 1
    v_add_f32_dpp v2, v2, v2 quad_perm:[2,3,0,1] row_mask:0xf bank_mask:0xf
    s_nop 1
    v_add_f32_dpp v2, v2, v2 row_half_mirror row_mask:0xf bank_mask:0xf
    v_cvt_pk_bf16_f32 v2, v2, v2
    v_lshlrev_b32 v2, 16, v2
    v_mul_f32 v2, 0x3d93cd3a, v2
    v_cvt_pk_bf16_f32 v2, v2, v2
    v_lshlrev_b32 v23, 16, v2
    s_waitcnt vmcnt(9)
    v_dot2_f32_bf16 v2, v102, v10, 0
    v_dot2_f32_bf16 v3, v106, v14, 0
    v_dot2_f32_bf16 v4, v110, v18, 0
    v_dot2_f32_bf16 v2, v103, v11, v2
    v_dot2_f32_bf16 v3, v107, v15, v3
    v_dot2_f32_bf16 v4, v111, v19, v4
    v_dot2_f32_bf16 v2, v104, v12, v2
    v_dot2_f32_bf16 v3, v108, v16, v3
    v_dot2_f32_bf16 v4, v112, v20, v4
    v_dot2_f32_bf16 v2, v105, v13, v2
    v_dot2_f32_bf16 v3, v109, v17, v3
    v_dot2_f32_bf16 v4, v113, v21, v4
    s_add_u32 s48, s41, 18432
    buffer_load_dwordx4 v[102:105], v1, s[16:19], s48 offen offset:0 nt
    buffer_load_dwordx4 v[106:109], v1, s[16:19], s48 offen offset:128 nt
    buffer_load_dwordx4 v[110:113], v1, s[16:19], s48 offen offset:256 nt
    v_add_f32 v2, v2, v3
    v_add_f32 v2, v2, v4
    s_nop 1
    v_add_f32_dpp v2, v2, v2 quad_perm:[1,0,3,2] row_mask:0xf bank_mask:0xf
    s_nop 1
    v_add_f32_dpp v2, v2, v2 quad_perm:[2,3,0,1] row_mask:0xf bank_mask:0xf
    s_nop 1
    v_add_f32_dpp v2, v2, v2 row_half_mirror row_mask:0xf bank_mask:0xf
    v_cvt_pk_bf16_f32 v2, v2, v2
    v_lshlrev_b32 v2, 16, v2
    v_mul_f32 v2, 0x3d93cd3a, v2
    v_cvt_pk_bf16_f32 v2, v2, v2
    v_lshlrev_b32 v24, 16, v2
    s_waitcnt lgkmcnt(0)
    v_readfirstlane_b32 s49, v32
    s_mul_i32 s47, s49, 24576
    s_waitcnt vmcnt(9)
    v_dot2_f32_bf16 v2, v114, v10, 0
    v_dot2_f32_bf16 v3, v118, v14, 0
    v_dot2_f32_bf16 v4, v122, v18, 0
    v_dot2_f32_bf16 v2, v115, v11, v2
    v_dot2_f32_bf16 v3, v119, v15, v3
    v_dot2_f32_bf16 v4, v123, v19, v4
    v_dot2_f32_bf16 v2, v116, v12, v2
    v_dot2_f32_bf16 v3, v120, v16, v3
    v_dot2_f32_bf16 v4, v124, v20, v4
    v_dot2_f32_bf16 v2, v117, v13, v2
    v_dot2_f32_bf16 v3, v121, v17, v3
    v_dot2_f32_bf16 v4, v125, v21, v4
    s_add_u32 s48, s41, 21504
    buffer_load_dwordx4 v[114:117], v1, s[16:19], s48 offen offset:0 nt
    buffer_load_dwordx4 v[118:121], v1, s[16:19], s48 offen offset:128 nt
    buffer_load_dwordx4 v[122:125], v1, s[16:19], s48 offen offset:256 nt
    v_add_f32 v2, v2, v3
    v_add_f32 v2, v2, v4
    s_nop 1
    v_add_f32_dpp v2, v2, v2 quad_perm:[1,0,3,2] row_mask:0xf bank_mask:0xf
    s_nop 1
    v_add_f32_dpp v2, v2, v2 quad_perm:[2,3,0,1] row_mask:0xf bank_mask:0xf
    s_nop 1
    v_add_f32_dpp v2, v2, v2 row_half_mirror row_mask:0xf bank_mask:0xf
    v_cvt_pk_bf16_f32 v2, v2, v2
    v_lshlrev_b32 v2, 16, v2
    v_mul_f32 v2, 0x3d93cd3a, v2
    v_cvt_pk_bf16_f32 v2, v2, v2
    v_lshlrev_b32 v25, 16, v2
    s_waitcnt vmcnt(9)
    v_dot2_f32_bf16 v2, v78, v10, 0
    v_dot2_f32_bf16 v3, v82, v14, 0
    v_dot2_f32_bf16 v4, v86, v18, 0
    v_dot2_f32_bf16 v2, v79, v11, v2
    v_dot2_f32_bf16 v3, v83, v15, v3
    v_dot2_f32_bf16 v4, v87, v19, v4
    v_dot2_f32_bf16 v2, v80, v12, v2
    v_dot2_f32_bf16 v3, v84, v16, v3
    v_dot2_f32_bf16 v4, v88, v20, v4
    v_dot2_f32_bf16 v2, v81, v13, v2
    v_dot2_f32_bf16 v3, v85, v17, v3
    v_dot2_f32_bf16 v4, v89, v21, v4
    s_add_u32 s48, s41, 0
    buffer_load_dwordx4 v[78:81], v1, s[20:23], s48 offen offset:0 nt
    buffer_load_dwordx4 v[82:85], v1, s[20:23], s48 offen offset:128 nt
    buffer_load_dwordx4 v[86:89], v1, s[20:23], s48 offen offset:256 nt
    v_add_f32 v2, v2, v3
    v_add_f32 v2, v2, v4
    s_nop 1
    v_add_f32_dpp v2, v2, v2 quad_perm:[1,0,3,2] row_mask:0xf bank_mask:0xf
    s_nop 1
    v_add_f32_dpp v2, v2, v2 quad_perm:[2,3,0,1] row_mask:0xf bank_mask:0xf
    s_nop 1
    v_add_f32_dpp v2, v2, v2 row_half_mirror row_mask:0xf bank_mask:0xf
    v_cvt_pk_bf16_f32 v2, v2, v2
    v_lshlrev_b32 v2, 16, v2
    v_mul_f32 v2, 0x3d93cd3a, v2
    v_cvt_pk_bf16_f32 v2, v2, v2
    v_lshlrev_b32 v26, 16, v2
    s_waitcnt vmcnt(9)
    v_dot2_f32_bf16 v2, v90, v10, 0
    v_dot2_f32_bf16 v3, v94, v14, 0
    v_dot2_f32_bf16 v4, v98, v18, 0
    v_dot2_f32_bf16 v2, v91, v11, v2
    v_dot2_f32_bf16 v3, v95, v15, v3
    v_dot2_f32_bf16 v4, v99, v19, v4
    v_dot2_f32_bf16 v2, v92, v12, v2
    v_dot2_f32_bf16 v3, v96, v16, v3
    v_dot2_f32_bf16 v4, v100, v20, v4
    v_dot2_f32_bf16 v2, v93, v13, v2
    v_dot2_f32_bf16 v3, v97, v17, v3
    v_dot2_f32_bf16 v4, v101, v21, v4
    s_add_u32 s48, s41, 3072
    buffer_load_dwordx4 v[90:93], v1, s[20:23], s48 offen offset:0 nt
    buffer_load_dwordx4 v[94:97], v1, s[20:23], s48 offen offset:128 nt
    buffer_load_dwordx4 v[98:101], v1, s[20:23], s48 offen offset:256 nt
    v_add_f32 v2, v2, v3
    v_add_f32 v2, v2, v4
    s_nop 1
    v_add_f32_dpp v2, v2, v2 quad_perm:[1,0,3,2] row_mask:0xf bank_mask:0xf
    s_nop 1
    v_add_f32_dpp v2, v2, v2 quad_perm:[2,3,0,1] row_mask:0xf bank_mask:0xf
    s_nop 1
    v_add_f32_dpp v2, v2, v2 row_half_mirror row_mask:0xf bank_mask:0xf
    v_cvt_pk_bf16_f32 v2, v2, v2
    v_lshlrev_b32 v2, 16, v2
    v_mul_f32 v2, 0x3d93cd3a, v2
    v_cvt_pk_bf16_f32 v2, v2, v2
    v_lshlrev_b32 v27, 16, v2
    s_waitcnt vmcnt(9)
    v_dot2_f32_bf16 v2, v102, v10, 0
    v_dot2_f32_bf16 v3, v106, v14, 0
    v_dot2_f32_bf16 v4, v110, v18, 0
    v_dot2_f32_bf16 v2, v103, v11, v2
    v_dot2_f32_bf16 v3, v107, v15, v3
    v_dot2_f32_bf16 v4, v111, v19, v4
    v_dot2_f32_bf16 v2, v104, v12, v2
    v_dot2_f32_bf16 v3, v108, v16, v3
    v_dot2_f32_bf16 v4, v112, v20, v4
    v_dot2_f32_bf16 v2, v105, v13, v2
    v_dot2_f32_bf16 v3, v109, v17, v3
    v_dot2_f32_bf16 v4, v113, v21, v4
    s_add_u32 s48, s41, 6144
    buffer_load_dwordx4 v[102:105], v1, s[20:23], s48 offen offset:0 nt
    buffer_load_dwordx4 v[106:109], v1, s[20:23], s48 offen offset:128 nt
    buffer_load_dwordx4 v[110:113], v1, s[20:23], s48 offen offset:256 nt
    v_add_f32 v2, v2, v3
    v_add_f32 v2, v2, v4
    s_nop 1
    v_add_f32_dpp v2, v2, v2 quad_perm:[1,0,3,2] row_mask:0xf bank_mask:0xf
    s_nop 1
    v_add_f32_dpp v2, v2, v2 quad_perm:[2,3,0,1] row_mask:0xf bank_mask:0xf
    s_nop 1
    v_add_f32_dpp v2, v2, v2 row_half_mirror row_mask:0xf bank_mask:0xf
    v_cvt_pk_bf16_f32 v2, v2, v2
    v_lshlrev_b32 v2, 16, v2
    v_mul_f32 v2, 0x3d93cd3a, v2
    v_cvt_pk_bf16_f32 v2, v2, v2
    v_lshlrev_b32 v28, 16, v2
    s_waitcnt vmcnt(9)
    v_dot2_f32_bf16 v2, v114, v10, 0
    v_dot2_f32_bf16 v3, v118, v14, 0
    v_dot2_f32_bf16 v4, v122, v18, 0
    v_dot2_f32_bf16 v2, v115, v11, v2
    v_dot2_f32_bf16 v3, v119, v15, v3
    v_dot2_f32_bf16 v4, v123, v19, v4
    v_dot2_f32_bf16 v2, v116, v12, v2
    v_dot2_f32_bf16 v3, v120, v16, v3
    v_dot2_f32_bf16 v4, v124, v20, v4
    v_dot2_f32_bf16 v2, v117, v13, v2
    v_dot2_f32_bf16 v3, v121, v17, v3
    v_dot2_f32_bf16 v4, v125, v21, v4
    s_add_u32 s48, s41, 9216
    buffer_load_dwordx4 v[114:117], v1, s[20:23], s48 offen offset:0 nt
    buffer_load_dwordx4 v[118:121], v1, s[20:23], s48 offen offset:128 nt
    buffer_load_dwordx4 v[122:125], v1, s[20:23], s48 offen offset:256 nt
    v_add_f32 v2, v2, v3
    v_add_f32 v2, v2, v4
    s_nop 1
    v_add_f32_dpp v2, v2, v2 quad_perm:[1,0,3,2] row_mask:0xf bank_mask:0xf
    s_nop 1
    v_add_f32_dpp v2, v2, v2 quad_perm:[2,3,0,1] row_mask:0xf bank_mask:0xf
    s_nop 1
    v_add_f32_dpp v2, v2, v2 row_half_mirror row_mask:0xf bank_mask:0xf
    v_cvt_pk_bf16_f32 v2, v2, v2
    v_lshlrev_b32 v2, 16, v2
    v_mul_f32 v2, 0x3d93cd3a, v2
    v_cvt_pk_bf16_f32 v2, v2, v2
    v_lshlrev_b32 v29, 16, v2
    v_max3_f32 v2, v22, v23, v24
    v_max3_f32 v2, v2, v25, v26
    v_max3_f32 v2, v2, v27, v28
    v_max_f32 v2, v2, v29
    s_nop 1
    v_max_f32_dpp v2, v2, v2 row_ror:8 row_mask:0xf bank_mask:0xf
    s_nop 1
    v_readlane_b32 s48, v2, 0
    v_readlane_b32 s49, v2, 16
    v_readlane_b32 s50, v2, 32
    v_readlane_b32 s51, v2, 48
    s_nop 1
    v_mov_b32 v2, s48
    v_max_f32 v2, s49, v2
    v_max_f32 v2, s50, v2
    v_max_f32 v2, s51, v2
    v_max_f32 v2, v2, v30
    v_sub_f32 v3, v30, v2
    v_mul_f32 v3, s52, v3
    v_exp_f32 v3, v3
    v_mov_b32 v30, v2
    v_mul_f32 v4, s52, v2
    v_fma_f32 v22, v22, s52, -v4
    v_exp_f32 v22, v22
    v_fma_f32 v23, v23, s52, -v4
    v_exp_f32 v23, v23
    v_fma_f32 v24, v24, s52, -v4
    v_exp_f32 v24, v24
    v_fma_f32 v25, v25, s52, -v4
    v_exp_f32 v25, v25
    v_fma_f32 v26, v26, s52, -v4
    v_exp_f32 v26, v26
    v_fma_f32 v27, v27, s52, -v4
    v_exp_f32 v27, v27
    v_fma_f32 v28, v28, s52, -v4
    v_exp_f32 v28, v28
    v_fma_f32 v29, v29, s52, -v4
    v_exp_f32 v29, v29
    v_mul_f32 v31, v31, v3
    v_mul_f32 v54, v54, v3
    v_mul_f32 v55, v55, v3
    v_mul_f32 v56, v56, v3
    v_mul_f32 v57, v57, v3
    v_mul_f32 v58, v58, v3
    v_mul_f32 v59, v59, v3
    v_mul_f32 v60, v60, v3
    v_mul_f32 v61, v61, v3
    v_mul_f32 v62, v62, v3
    v_mul_f32 v63, v63, v3
    v_mul_f32 v64, v64, v3
    v_mul_f32 v65, v65, v3
    v_mul_f32 v66, v66, v3
    v_mul_f32 v67, v67, v3
    v_mul_f32 v68, v68, v3
    v_mul_f32 v69, v69, v3
    v_mul_f32 v70, v70, v3
    v_mul_f32 v71, v71, v3
    v_mul_f32 v72, v72, v3
    v_mul_f32 v73, v73, v3
    v_mul_f32 v74, v74, v3
    v_mul_f32 v75, v75, v3
    v_mul_f32 v76, v76, v3
    v_mul_f32 v77, v77, v3
    v_add_f32 v31, v31, v22
    v_add_f32 v31, v31, v23
    v_add_f32 v31, v31, v24
    v_add_f32 v31, v31, v25
    v_add_f32 v31, v31, v26
    v_add_f32 v31, v31, v27
    v_add_f32 v31, v31, v28
    v_add_f32 v31, v31, v29
    s_waitcnt vmcnt(9)
    v_lshlrev_b32 v4, 16, v78
    v_and_b32 v5, 0xffff0000, v78
    v_fmac_f32 v54, v22, v4
    v_fmac_f32 v55, v22, v5
    v_lshlrev_b32 v4, 16, v79
    v_and_b32 v5, 0xffff0000, v79
    v_fmac_f32 v56, v22, v4
    v_fmac_f32 v57, v22, v5
    v_lshlrev_b32 v4, 16, v80
    v_and_b32 v5, 0xffff0000, v80
    v_fmac_f32 v58, v22, v4
    v_fmac_f32 v59, v22, v5
    v_lshlrev_b32 v4, 16, v81
    v_and_b32 v5, 0xffff0000, v81
    v_fmac_f32 v60, v22, v4
    v_fmac_f32 v61, v22, v5
    v_lshlrev_b32 v4, 16, v82
    v_and_b32 v5, 0xffff0000, v82
    v_fmac_f32 v62, v22, v4
    v_fmac_f32 v63, v22, v5
    v_lshlrev_b32 v4, 16, v83
    v_and_b32 v5, 0xffff0000, v83
    v_fmac_f32 v64, v22, v4
    v_fmac_f32 v65, v22, v5
    v_lshlrev_b32 v4, 16, v84
    v_and_b32 v5, 0xffff0000, v84
    v_fmac_f32 v66, v22, v4
    v_fmac_f32 v67, v22, v5
    v_lshlrev_b32 v4, 16, v85
    v_and_b32 v5, 0xffff0000, v85
    v_fmac_f32 v68, v22, v4
    v_fmac_f32 v69, v22, v5
    v_lshlrev_b32 v4, 16, v86
    v_and_b32 v5, 0xffff0000, v86
    v_fmac_f32 v70, v22, v4
    v_fmac_f32 v71, v22, v5
    v_lshlrev_b32 v4, 16, v87
    v_and_b32 v5, 0xffff0000, v87
    v_fmac_f32 v72, v22, v4
    v_fmac_f32 v73, v22, v5
    v_lshlrev_b32 v4, 16, v88
    v_and_b32 v5, 0xffff0000, v88
    v_fmac_f32 v74, v22, v4
    v_fmac_f32 v75, v22, v5
    v_lshlrev_b32 v4, 16, v89
    v_and_b32 v5, 0xffff0000, v89
    v_fmac_f32 v76, v22, v4
    v_fmac_f32 v77, v22, v5
    s_add_u32 s48, s41, 12288
    buffer_load_dwordx4 v[78:81], v1, s[20:23], s48 offen offset:0 nt
    buffer_load_dwordx4 v[82:85], v1, s[20:23], s48 offen offset:128 nt
    buffer_load_dwordx4 v[86:89], v1, s[20:23], s48 offen offset:256 nt
    s_waitcnt vmcnt(9)
    v_lshlrev_b32 v4, 16, v90
    v_and_b32 v5, 0xffff0000, v90
    v_fmac_f32 v54, v23, v4
    v_fmac_f32 v55, v23, v5
    v_lshlrev_b32 v4, 16, v91
    v_and_b32 v5, 0xffff0000, v91
    v_fmac_f32 v56, v23, v4
    v_fmac_f32 v57, v23, v5
    v_lshlrev_b32 v4, 16, v92
    v_and_b32 v5, 0xffff0000, v92
    v_fmac_f32 v58, v23, v4
    v_fmac_f32 v59, v23, v5
    v_lshlrev_b32 v4, 16, v93
    v_and_b32 v5, 0xffff0000, v93
    v_fmac_f32 v60, v23, v4
    v_fmac_f32 v61, v23, v5
    v_lshlrev_b32 v4, 16, v94
    v_and_b32 v5, 0xffff0000, v94
    v_fmac_f32 v62, v23, v4
    v_fmac_f32 v63, v23, v5
    v_lshlrev_b32 v4, 16, v95
    v_and_b32 v5, 0xffff0000, v95
    v_fmac_f32 v64, v23, v4
    v_fmac_f32 v65, v23, v5
    v_lshlrev_b32 v4, 16, v96
    v_and_b32 v5, 0xffff0000, v96
    v_fmac_f32 v66, v23, v4
    v_fmac_f32 v67, v23, v5
    v_lshlrev_b32 v4, 16, v97
    v_and_b32 v5, 0xffff0000, v97
    v_fmac_f32 v68, v23, v4
    v_fmac_f32 v69, v23, v5
    v_lshlrev_b32 v4, 16, v98
    v_and_b32 v5, 0xffff0000, v98
    v_fmac_f32 v70, v23, v4
    v_fmac_f32 v71, v23, v5
    v_lshlrev_b32 v4, 16, v99
    v_and_b32 v5, 0xffff0000, v99
    v_fmac_f32 v72, v23, v4
    v_fmac_f32 v73, v23, v5
    v_lshlrev_b32 v4, 16, v100
    v_and_b32 v5, 0xffff0000, v100
    v_fmac_f32 v74, v23, v4
    v_fmac_f32 v75, v23, v5
    v_lshlrev_b32 v4, 16, v101
    v_and_b32 v5, 0xffff0000, v101
    v_fmac_f32 v76, v23, v4
    v_fmac_f32 v77, v23, v5
    s_add_u32 s48, s41, 15360
    buffer_load_dwordx4 v[90:93], v1, s[20:23], s48 offen offset:0 nt
    buffer_load_dwordx4 v[94:97], v1, s[20:23], s48 offen offset:128 nt
    buffer_load_dwordx4 v[98:101], v1, s[20:23], s48 offen offset:256 nt
    s_waitcnt vmcnt(9)
    v_lshlrev_b32 v4, 16, v102
    v_and_b32 v5, 0xffff0000, v102
    v_fmac_f32 v54, v24, v4
    v_fmac_f32 v55, v24, v5
    v_lshlrev_b32 v4, 16, v103
    v_and_b32 v5, 0xffff0000, v103
    v_fmac_f32 v56, v24, v4
    v_fmac_f32 v57, v24, v5
    v_lshlrev_b32 v4, 16, v104
    v_and_b32 v5, 0xffff0000, v104
    v_fmac_f32 v58, v24, v4
    v_fmac_f32 v59, v24, v5
    v_lshlrev_b32 v4, 16, v105
    v_and_b32 v5, 0xffff0000, v105
    v_fmac_f32 v60, v24, v4
    v_fmac_f32 v61, v24, v5
    v_lshlrev_b32 v4, 16, v106
    v_and_b32 v5, 0xffff0000, v106
    v_fmac_f32 v62, v24, v4
    v_fmac_f32 v63, v24, v5
    v_lshlrev_b32 v4, 16, v107
    v_and_b32 v5, 0xffff0000, v107
    v_fmac_f32 v64, v24, v4
    v_fmac_f32 v65, v24, v5
    v_lshlrev_b32 v4, 16, v108
    v_and_b32 v5, 0xffff0000, v108
    v_fmac_f32 v66, v24, v4
    v_fmac_f32 v67, v24, v5
    v_lshlrev_b32 v4, 16, v109
    v_and_b32 v5, 0xffff0000, v109
    v_fmac_f32 v68, v24, v4
    v_fmac_f32 v69, v24, v5
    v_lshlrev_b32 v4, 16, v110
    v_and_b32 v5, 0xffff0000, v110
    v_fmac_f32 v70, v24, v4
    v_fmac_f32 v71, v24, v5
    v_lshlrev_b32 v4, 16, v111
    v_and_b32 v5, 0xffff0000, v111
    v_fmac_f32 v72, v24, v4
    v_fmac_f32 v73, v24, v5
    v_lshlrev_b32 v4, 16, v112
    v_and_b32 v5, 0xffff0000, v112
    v_fmac_f32 v74, v24, v4
    v_fmac_f32 v75, v24, v5
    v_lshlrev_b32 v4, 16, v113
    v_and_b32 v5, 0xffff0000, v113
    v_fmac_f32 v76, v24, v4
    v_fmac_f32 v77, v24, v5
    s_add_u32 s48, s41, 18432
    buffer_load_dwordx4 v[102:105], v1, s[20:23], s48 offen offset:0 nt
    buffer_load_dwordx4 v[106:109], v1, s[20:23], s48 offen offset:128 nt
    buffer_load_dwordx4 v[110:113], v1, s[20:23], s48 offen offset:256 nt
    s_waitcnt vmcnt(9)
    v_lshlrev_b32 v4, 16, v114
    v_and_b32 v5, 0xffff0000, v114
    v_fmac_f32 v54, v25, v4
    v_fmac_f32 v55, v25, v5
    v_lshlrev_b32 v4, 16, v115
    v_and_b32 v5, 0xffff0000, v115
    v_fmac_f32 v56, v25, v4
    v_fmac_f32 v57, v25, v5
    v_lshlrev_b32 v4, 16, v116
    v_and_b32 v5, 0xffff0000, v116
    v_fmac_f32 v58, v25, v4
    v_fmac_f32 v59, v25, v5
    v_lshlrev_b32 v4, 16, v117
    v_and_b32 v5, 0xffff0000, v117
    v_fmac_f32 v60, v25, v4
    v_fmac_f32 v61, v25, v5
    v_lshlrev_b32 v4, 16, v118
    v_and_b32 v5, 0xffff0000, v118
    v_fmac_f32 v62, v25, v4
    v_fmac_f32 v63, v25, v5
    v_lshlrev_b32 v4, 16, v119
    v_and_b32 v5, 0xffff0000, v119
    v_fmac_f32 v64, v25, v4
    v_fmac_f32 v65, v25, v5
    v_lshlrev_b32 v4, 16, v120
    v_and_b32 v5, 0xffff0000, v120
    v_fmac_f32 v66, v25, v4
    v_fmac_f32 v67, v25, v5
    v_lshlrev_b32 v4, 16, v121
    v_and_b32 v5, 0xffff0000, v121
    v_fmac_f32 v68, v25, v4
    v_fmac_f32 v69, v25, v5
    v_lshlrev_b32 v4, 16, v122
    v_and_b32 v5, 0xffff0000, v122
    v_fmac_f32 v70, v25, v4
    v_fmac_f32 v71, v25, v5
    v_lshlrev_b32 v4, 16, v123
    v_and_b32 v5, 0xffff0000, v123
    v_fmac_f32 v72, v25, v4
    v_fmac_f32 v73, v25, v5
    v_lshlrev_b32 v4, 16, v124
    v_and_b32 v5, 0xffff0000, v124
    v_fmac_f32 v74, v25, v4
    v_fmac_f32 v75, v25, v5
    v_lshlrev_b32 v4, 16, v125
    v_and_b32 v5, 0xffff0000, v125
    v_fmac_f32 v76, v25, v4
    v_fmac_f32 v77, v25, v5
    s_add_u32 s48, s41, 21504
    buffer_load_dwordx4 v[114:117], v1, s[20:23], s48 offen offset:0 nt
    buffer_load_dwordx4 v[118:121], v1, s[20:23], s48 offen offset:128 nt
    buffer_load_dwordx4 v[122:125], v1, s[20:23], s48 offen offset:256 nt
    s_waitcnt vmcnt(9)
    v_lshlrev_b32 v4, 16, v78
    v_and_b32 v5, 0xffff0000, v78
    v_fmac_f32 v54, v26, v4
    v_fmac_f32 v55, v26, v5
    v_lshlrev_b32 v4, 16, v79
    v_and_b32 v5, 0xffff0000, v79
    v_fmac_f32 v56, v26, v4
    v_fmac_f32 v57, v26, v5
    v_lshlrev_b32 v4, 16, v80
    v_and_b32 v5, 0xffff0000, v80
    v_fmac_f32 v58, v26, v4
    v_fmac_f32 v59, v26, v5
    v_lshlrev_b32 v4, 16, v81
    v_and_b32 v5, 0xffff0000, v81
    v_fmac_f32 v60, v26, v4
    v_fmac_f32 v61, v26, v5
    v_lshlrev_b32 v4, 16, v82
    v_and_b32 v5, 0xffff0000, v82
    v_fmac_f32 v62, v26, v4
    v_fmac_f32 v63, v26, v5
    v_lshlrev_b32 v4, 16, v83
    v_and_b32 v5, 0xffff0000, v83
    v_fmac_f32 v64, v26, v4
    v_fmac_f32 v65, v26, v5
    v_lshlrev_b32 v4, 16, v84
    v_and_b32 v5, 0xffff0000, v84
    v_fmac_f32 v66, v26, v4
    v_fmac_f32 v67, v26, v5
    v_lshlrev_b32 v4, 16, v85
    v_and_b32 v5, 0xffff0000, v85
    v_fmac_f32 v68, v26, v4
    v_fmac_f32 v69, v26, v5
    v_lshlrev_b32 v4, 16, v86
    v_and_b32 v5, 0xffff0000, v86
    v_fmac_f32 v70, v26, v4
    v_fmac_f32 v71, v26, v5
    v_lshlrev_b32 v4, 16, v87
    v_and_b32 v5, 0xffff0000, v87
    v_fmac_f32 v72, v26, v4
    v_fmac_f32 v73, v26, v5
    v_lshlrev_b32 v4, 16, v88
    v_and_b32 v5, 0xffff0000, v88
    v_fmac_f32 v74, v26, v4
    v_fmac_f32 v75, v26, v5
    v_lshlrev_b32 v4, 16, v89
    v_and_b32 v5, 0xffff0000, v89
    v_fmac_f32 v76, v26, v4
    v_fmac_f32 v77, v26, v5
    s_add_u32 s48, s47, 0
    buffer_load_dwordx4 v[78:81], v1, s[16:19], s48 offen offset:0 nt
    buffer_load_dwordx4 v[82:85], v1, s[16:19], s48 offen offset:128 nt
    buffer_load_dwordx4 v[86:89], v1, s[16:19], s48 offen offset:256 nt
    s_waitcnt vmcnt(9)
    v_lshlrev_b32 v4, 16, v90
    v_and_b32 v5, 0xffff0000, v90
    v_fmac_f32 v54, v27, v4
    v_fmac_f32 v55, v27, v5
    v_lshlrev_b32 v4, 16, v91
    v_and_b32 v5, 0xffff0000, v91
    v_fmac_f32 v56, v27, v4
    v_fmac_f32 v57, v27, v5
    v_lshlrev_b32 v4, 16, v92
    v_and_b32 v5, 0xffff0000, v92
    v_fmac_f32 v58, v27, v4
    v_fmac_f32 v59, v27, v5
    v_lshlrev_b32 v4, 16, v93
    v_and_b32 v5, 0xffff0000, v93
    v_fmac_f32 v60, v27, v4
    v_fmac_f32 v61, v27, v5
    v_lshlrev_b32 v4, 16, v94
    v_and_b32 v5, 0xffff0000, v94
    v_fmac_f32 v62, v27, v4
    v_fmac_f32 v63, v27, v5
    v_lshlrev_b32 v4, 16, v95
    v_and_b32 v5, 0xffff0000, v95
    v_fmac_f32 v64, v27, v4
    v_fmac_f32 v65, v27, v5
    v_lshlrev_b32 v4, 16, v96
    v_and_b32 v5, 0xffff0000, v96
    v_fmac_f32 v66, v27, v4
    v_fmac_f32 v67, v27, v5
    v_lshlrev_b32 v4, 16, v97
    v_and_b32 v5, 0xffff0000, v97
    v_fmac_f32 v68, v27, v4
    v_fmac_f32 v69, v27, v5
    v_lshlrev_b32 v4, 16, v98
    v_and_b32 v5, 0xffff0000, v98
    v_fmac_f32 v70, v27, v4
    v_fmac_f32 v71, v27, v5
    v_lshlrev_b32 v4, 16, v99
    v_and_b32 v5, 0xffff0000, v99
    v_fmac_f32 v72, v27, v4
    v_fmac_f32 v73, v27, v5
    v_lshlrev_b32 v4, 16, v100
    v_and_b32 v5, 0xffff0000, v100
    v_fmac_f32 v74, v27, v4
    v_fmac_f32 v75, v27, v5
    v_lshlrev_b32 v4, 16, v101
    v_and_b32 v5, 0xffff0000, v101
    v_fmac_f32 v76, v27, v4
    v_fmac_f32 v77, v27, v5
    s_add_u32 s48, s47, 3072
    buffer_load_dwordx4 v[90:93], v1, s[16:19], s48 offen offset:0 nt
    buffer_load_dwordx4 v[94:97], v1, s[16:19], s48 offen offset:128 nt
    buffer_load_dwordx4 v[98:101], v1, s[16:19], s48 offen offset:256 nt
    s_waitcnt vmcnt(9)
    v_lshlrev_b32 v4, 16, v102
    v_and_b32 v5, 0xffff0000, v102
    v_fmac_f32 v54, v28, v4
    v_fmac_f32 v55, v28, v5
    v_lshlrev_b32 v4, 16, v103
    v_and_b32 v5, 0xffff0000, v103
    v_fmac_f32 v56, v28, v4
    v_fmac_f32 v57, v28, v5
    v_lshlrev_b32 v4, 16, v104
    v_and_b32 v5, 0xffff0000, v104
    v_fmac_f32 v58, v28, v4
    v_fmac_f32 v59, v28, v5
    v_lshlrev_b32 v4, 16, v105
    v_and_b32 v5, 0xffff0000, v105
    v_fmac_f32 v60, v28, v4
    v_fmac_f32 v61, v28, v5
    v_lshlrev_b32 v4, 16, v106
    v_and_b32 v5, 0xffff0000, v106
    v_fmac_f32 v62, v28, v4
    v_fmac_f32 v63, v28, v5
    v_lshlrev_b32 v4, 16, v107
    v_and_b32 v5, 0xffff0000, v107
    v_fmac_f32 v64, v28, v4
    v_fmac_f32 v65, v28, v5
    v_lshlrev_b32 v4, 16, v108
    v_and_b32 v5, 0xffff0000, v108
    v_fmac_f32 v66, v28, v4
    v_fmac_f32 v67, v28, v5
    v_lshlrev_b32 v4, 16, v109
    v_and_b32 v5, 0xffff0000, v109
    v_fmac_f32 v68, v28, v4
    v_fmac_f32 v69, v28, v5
    v_lshlrev_b32 v4, 16, v110
    v_and_b32 v5, 0xffff0000, v110
    v_fmac_f32 v70, v28, v4
    v_fmac_f32 v71, v28, v5
    v_lshlrev_b32 v4, 16, v111
    v_and_b32 v5, 0xffff0000, v111
    v_fmac_f32 v72, v28, v4
    v_fmac_f32 v73, v28, v5
    v_lshlrev_b32 v4, 16, v112
    v_and_b32 v5, 0xffff0000, v112
    v_fmac_f32 v74, v28, v4
    v_fmac_f32 v75, v28, v5
    v_lshlrev_b32 v4, 16, v113
    v_and_b32 v5, 0xffff0000, v113
    v_fmac_f32 v76, v28, v4
    v_fmac_f32 v77, v28, v5
    s_add_u32 s48, s47, 6144
    buffer_load_dwordx4 v[102:105], v1, s[16:19], s48 offen offset:0 nt
    buffer_load_dwordx4 v[106:109], v1, s[16:19], s48 offen offset:128 nt
    buffer_load_dwordx4 v[110:113], v1, s[16:19], s48 offen offset:256 nt
    s_waitcnt vmcnt(9)
    v_lshlrev_b32 v4, 16, v114
    v_and_b32 v5, 0xffff0000, v114
    v_fmac_f32 v54, v29, v4
    v_fmac_f32 v55, v29, v5
    v_lshlrev_b32 v4, 16, v115
    v_and_b32 v5, 0xffff0000, v115
    v_fmac_f32 v56, v29, v4
    v_fmac_f32 v57, v29, v5
    v_lshlrev_b32 v4, 16, v116
    v_and_b32 v5, 0xffff0000, v116
    v_fmac_f32 v58, v29, v4
    v_fmac_f32 v59, v29, v5
    v_lshlrev_b32 v4, 16, v117
    v_and_b32 v5, 0xffff0000, v117
    v_fmac_f32 v60, v29, v4
    v_fmac_f32 v61, v29, v5
    v_lshlrev_b32 v4, 16, v118
    v_and_b32 v5, 0xffff0000, v118
    v_fmac_f32 v62, v29, v4
    v_fmac_f32 v63, v29, v5
    v_lshlrev_b32 v4, 16, v119
    v_and_b32 v5, 0xffff0000, v119
    v_fmac_f32 v64, v29, v4
    v_fmac_f32 v65, v29, v5
    v_lshlrev_b32 v4, 16, v120
    v_and_b32 v5, 0xffff0000, v120
    v_fmac_f32 v66, v29, v4
    v_fmac_f32 v67, v29, v5
    v_lshlrev_b32 v4, 16, v121
    v_and_b32 v5, 0xffff0000, v121
    v_fmac_f32 v68, v29, v4
    v_fmac_f32 v69, v29, v5
    v_lshlrev_b32 v4, 16, v122
    v_and_b32 v5, 0xffff0000, v122
    v_fmac_f32 v70, v29, v4
    v_fmac_f32 v71, v29, v5
    v_lshlrev_b32 v4, 16, v123
    v_and_b32 v5, 0xffff0000, v123
    v_fmac_f32 v72, v29, v4
    v_fmac_f32 v73, v29, v5
    v_lshlrev_b32 v4, 16, v124
    v_and_b32 v5, 0xffff0000, v124
    v_fmac_f32 v74, v29, v4
    v_fmac_f32 v75, v29, v5
    v_lshlrev_b32 v4, 16, v125
    v_and_b32 v5, 0xffff0000, v125
    v_fmac_f32 v76, v29, v4
    v_fmac_f32 v77, v29, v5
    s_add_u32 s48, s47, 9216
    buffer_load_dwordx4 v[114:117], v1, s[16:19], s48 offen offset:0 nt
    buffer_load_dwordx4 v[118:121], v1, s[16:19], s48 offen offset:128 nt
    buffer_load_dwordx4 v[122:125], v1, s[16:19], s48 offen offset:256 nt
    s_mov_b32 s41, s47
    s_cmp_lt_u32 s41, s96
    s_cbranch_scc1 L_loop
L_pool_end:
    v_mov_b32 v2, v30
    v_mov_b32 v3, v31
    s_nop 1
    v_add_f32_dpp v3, v3, v3 quad_perm:[1,0,3,2] row_mask:0xf bank_mask:0xf
    s_nop 1
    v_add_f32_dpp v3, v3, v3 quad_perm:[2,3,0,1] row_mask:0xf bank_mask:0xf
    s_nop 1
    v_add_f32_dpp v3, v3, v3 row_half_mirror row_mask:0xf bank_mask:0xf
    s_nop 1
    v_add_f32_dpp v3, v3, v3 row_mirror row_mask:0xf bank_mask:0xf
    s_nop 1
    v_readlane_b32 s48, v3, 0
    v_readlane_b32 s49, v3, 16
    v_readlane_b32 s50, v3, 32
    v_readlane_b32 s51, v3, 48
    s_nop 1
    v_mov_b32 v3, s48
    v_add_f32 v3, s49, v3
    v_add_f32 v3, s50, v3
    v_add_f32 v3, s51, v3
    v_mul_f32 v3, 0.125, v3
    s_nop 1
    v_permlane32_swap_b32 v54, v58
    v_permlane32_swap_b32 v55, v59
    v_permlane32_swap_b32 v56, v60
    v_permlane32_swap_b32 v57, v61
    v_permlane32_swap_b32 v62, v66
    v_permlane32_swap_b32 v63, v67
    v_permlane32_swap_b32 v64, v68
    v_permlane32_swap_b32 v65, v69
    v_permlane32_swap_b32 v70, v74
    v_permlane32_swap_b32 v71, v75
    v_permlane32_swap_b32 v72, v76
    v_permlane32_swap_b32 v73, v77
    v_add_f32 v54, v54, v58
    v_add_f32 v55, v55, v59
    v_add_f32 v56, v56, v60
    v_add_f32 v57, v57, v61
    v_add_f32 v62, v62, v66
    v_add_f32 v63, v63, v67
    v_add_f32 v64, v64, v68
    v_add_f32 v65, v65, v69
    v_add_f32 v70, v70, v74
    v_add_f32 v71, v71, v75
    v_add_f32 v72, v72, v76
    v_add_f32 v73, v73, v77
    s_nop 1
    v_permlane16_swap_b32 v54, v56
    v_permlane16_swap_b32 v55, v57
    v_permlane16_swap_b32 v62, v64
    v_permlane16_swap_b32 v63, v65
    v_permlane16_swap_b32 v70, v72
    v_permlane16_swap_b32 v71, v73
    v_add_f32 v54, v54, v56
    v_add_f32 v55, v55, v57
    v_add_f32 v62, v62, v64
    v_add_f32 v63, v63, v65
    v_add_f32 v70, v70, v72
    v_add_f32 v71, v71, v73
    s_nop 1
    v_add_f32_dpp v54, v54, v54 row_ror:8 row_mask:0xf bank_mask:0xf
    v_add_f32_dpp v55, v55, v55 row_ror:8 row_mask:0xf bank_mask:0xf
    v_add_f32_dpp v62, v62, v62 row_ror:8 row_mask:0xf bank_mask:0xf
    v_add_f32_dpp v63, v63, v63 row_ror:8 row_mask:0xf bank_mask:0xf
    v_add_f32_dpp v70, v70, v70 row_ror:8 row_mask:0xf bank_mask:0xf
    v_add_f32_dpp v71, v71, v71 row_ror:8 row_mask:0xf bank_mask:0xf
    ds_write_b64 v9, v[54:55] offset:0
    ds_write_b64 v9, v[62:63] offset:256
    ds_write_b64 v9, v[70:71] offset:512
    v_lshrrev_b32 v4, 6, v0
    v_lshlrev_b32 v4, 3, v4
    ds_write_b64 v4, v[2:3] offset:12800
    s_waitcnt lgkmcnt(0)
    s_barrier
    s_cmp_lg_u32 s53, 3
    s_cbranch_scc1 L_noarr
    s_mov_b64 exec, 1
    v_mov_b32 v4, 0
    v_mov_b32 v5, 1
    buffer_atomic_add v5, v4, s[36:39], 0 offen sc0 sc1
    s_waitcnt vmcnt(0)
    v_mov_b32 v4, 12928
    ds_write_b32 v4, v5
    v_readfirstlane_b32 s48, v5
    s_waitcnt lgkmcnt(0)
    s_mov_b64 exec, -1
    v_lshlrev_b32 v4, 7, v6
    v_mov_b32 v5, 1
    s_cmp_lg_u32 s48, 247
    s_cbranch_scc1 L_e3
    s_mov_b32 s48, 458756
    buffer_store_dword v5, v4, s[32:35], s48 offen sc0 sc1
    s_mov_b32 s48, 466948
    buffer_store_dword v5, v4, s[32:35], s48 offen sc0 sc1
    s_mov_b32 s48, 475140
    buffer_store_dword v5, v4, s[32:35], s48 offen sc0 sc1
    s_mov_b32 s48, 483332
    buffer_store_dword v5, v4, s[32:35], s48 offen sc0 sc1
    s_branch L_e2
L_e3:
    s_cmp_lg_u32 s48, 255
    s_cbranch_scc1 L_e2
    s_mov_b32 s48, 458752
    buffer_store_dword v5, v4, s[32:35], s48 offen sc0 sc1
    s_mov_b32 s48, 466944
    buffer_store_dword v5, v4, s[32:35], s48 offen sc0 sc1
    s_mov_b32 s48, 475136
    buffer_store_dword v5, v4, s[32:35], s48 offen sc0 sc1
    s_mov_b32 s48, 483328
    buffer_store_dword v5, v4, s[32:35], s48 offen sc0 sc1
    s_branch L_e2
L_noarr:
    v_cmp_gt_u32 vcc, 192, v0
    s_and_saveexec_b64 s[100:101], vcc
    s_cbranch_execz L_e1
    v_lshlrev_b32 v2, 2, v0
    v_and_b32 v4, 15, v6
    v_lshlrev_b32 v4, 3, v4
    ds_read_b64 v[22:23], v4 offset:12800
    ds_read_b32 v54, v2 offset:0
    ds_read_b32 v55, v2 offset:768
    ds_read_b32 v56, v2 offset:1536
    ds_read_b32 v57, v2 offset:2304
    ds_read_b32 v58, v2 offset:3072
    ds_read_b32 v59, v2 offset:3840
    ds_read_b32 v60, v2 offset:4608
    ds_read_b32 v61, v2 offset:5376
    s_waitcnt lgkmcnt(8)
    ds_read_b32 v62, v2 offset:6144
    ds_read_b32 v63, v2 offset:6912
    ds_read_b32 v64, v2 offset:7680
    ds_read_b32 v65, v2 offset:8448
    ds_read_b32 v66, v2 offset:9216
    ds_read_b32 v67, v2 offset:9984
    ds_read_b32 v68, v2 offset:10752
    ds_read_b32 v69, v2 offset:11520
    v_mov_b32 v3, v22
    s_nop 1
    v_max_f32_dpp v3, v3, v3 quad_perm:[1,0,3,2] row_mask:0xf bank_mask:0xf
    s_nop 1
    v_max_f32_dpp v3, v3, v3 quad_perm:[2,3,0,1] row_mask:0xf bank_mask:0xf
    s_nop 1
    v_max_f32_dpp v3, v3, v3 row_half_mirror row_mask:0xf bank_mask:0xf
    s_nop 1
    v_max_f32_dpp v3, v3, v3 row_mirror row_mask:0xf bank_mask:0xf
    v_sub_f32 v24, v22, v3
    v_mul_f32 v24, 0x3fb8aa3b, v24
    v_exp_f32 v24, v24
    s_nop 0
    v_mul_f32 v5, v24, v23
    s_nop 1
    v_add_f32_dpp v5, v5, v5 quad_perm:[1,0,3,2] row_mask:0xf bank_mask:0xf
    s_nop 1
    v_add_f32_dpp v5, v5, v5 quad_perm:[2,3,0,1] row_mask:0xf bank_mask:0xf
    s_nop 1
    v_add_f32_dpp v5, v5, v5 row_half_mirror row_mask:0xf bank_mask:0xf
    s_nop 1
    v_add_f32_dpp v5, v5, v5 row_mirror row_mask:0xf bank_mask:0xf
    s_waitcnt lgkmcnt(0)
    v_mul_f32_dpp v4, v24, v54 row_newbcast:0 row_mask:0xf bank_mask:0xf
    v_mul_f32_dpp v25, v24, v55 row_newbcast:1 row_mask:0xf bank_mask:0xf
    v_fmac_f32_dpp v4, v24, v56 row_newbcast:2 row_mask:0xf bank_mask:0xf
    v_fmac_f32_dpp v25, v24, v57 row_newbcast:3 row_mask:0xf bank_mask:0xf
    v_fmac_f32_dpp v4, v24, v58 row_newbcast:4 row_mask:0xf bank_mask:0xf
    v_fmac_f32_dpp v25, v24, v59 row_newbcast:5 row_mask:0xf bank_mask:0xf
    v_fmac_f32_dpp v4, v24, v60 row_newbcast:6 row_mask:0xf bank_mask:0xf
    v_fmac_f32_dpp v25, v24, v61 row_newbcast:7 row_mask:0xf bank_mask:0xf
    v_fmac_f32_dpp v4, v24, v62 row_newbcast:8 row_mask:0xf bank_mask:0xf
    v_fmac_f32_dpp v25, v24, v63 row_newbcast:9 row_mask:0xf bank_mask:0xf
    v_fmac_f32_dpp v4, v24, v64 row_newbcast:10 row_mask:0xf bank_mask:0xf
    v_fmac_f32_dpp v25, v24, v65 row_newbcast:11 row_mask:0xf bank_mask:0xf
    v_fmac_f32_dpp v4, v24, v66 row_newbcast:12 row_mask:0xf bank_mask:0xf
    v_fmac_f32_dpp v25, v24, v67 row_newbcast:13 row_mask:0xf bank_mask:0xf
    v_fmac_f32_dpp v4, v24, v68 row_newbcast:14 row_mask:0xf bank_mask:0xf
    v_fmac_f32_dpp v25, v24, v69 row_newbcast:15 row_mask:0xf bank_mask:0xf
    v_add_f32 v4, v4, v25
    v_mov_b32 v12, v4
    v_mov_b32 v14, v3
    v_mov_b32 v15, v5
    v_mov_b32_dpp v13, v4 quad_perm:[1,0,3,2] row_mask:0xf bank_mask:0xf
    v_lshlrev_b32 v2, 3, v0
    s_mul_i32 s48, s40, 1536
    s_add_u32 s48, s48, 1048576
    s_mov_b32 exec_lo, 0x55555555
    s_mov_b32 exec_hi, 0x55555555
    buffer_store_dwordx4 v[12:15], v2, s[32:35], s48 offen sc0 sc1
L_e1:
    s_mov_b64 exec, s[100:101]
L_e2:
    s_waitcnt vmcnt(0)
    s_barrier
    v_mov_b32 v12, 12928
    ds_read_b32 v13, v12
    s_waitcnt lgkmcnt(0)
    v_readfirstlane_b32 s97, v13
    s_mul_i32 s48, s97, 6554
    s_lshr_b32 s54, s48, 16
    s_mul_i32 s48, s54, 10
    s_sub_u32 s55, s97, s48
    s_mov_b32 s98, 0
    s_cmp_lt_u32 s97, 80
    s_cbranch_scc1 L_role_2
    s_mov_b32 s98, 1
    s_sub_u32 s55, s97, 80
    s_cmp_ge_u32 s55, 24
    s_cselect_b32 s54, 1, 0
    s_mul_i32 s48, s54, 24
    s_sub_u32 s55, s55, s48
    s_cmp_lt_u32 s97, 128
    s_cbranch_scc1 L_role_2
    s_mov_b32 s98, 2
    s_sub_u32 s55, s97, 128
    s_cmp_lt_u32 s97, 148
    s_cbranch_scc1 L_role_2
    s_mov_b32 s98, 3
L_role_2:
    s_cmp_eq_u32 s54, 1
    s_cselect_b32 s64, s92, s64
    s_cselect_b32 s65, s93, s65
    s_cmp_eq_u32 s98, 3
    s_cbranch_scc1 L_dma_end
    s_cmp_eq_u32 s98, 2
    s_cbranch_scc1 L_dma_e
    v_lshrrev_b32 v126, 3, v6
    v_and_b32 v127, 7, v6
    v_lshlrev_b32 v127, 4, v127
    s_cmp_eq_u32 s98, 1
    s_cbranch_scc1 L_dma_d
    v_mul_u32_u24 v126, 1280, v126
    v_add_u32 v126, v126, v127
    s_mul_i32 s48, s54, 768
    s_mul_i32 s49, s53, 48
    s_add_u32 s48, s48, s49
    s_mul_i32 s48, s48, 1280
    s_lshl_b32 s50, s55, 7
    s_add_u32 s48, s48, s50
    s_lshl_b32 s50, s49, 7
    s_add_u32 s50, s50, 42496
    s_mov_b32 m0, s50
    s_nop 0
    buffer_load_dwordx4 v126, s[60:63], s48 offen nt lds
    s_add_u32 s48, s48, 10240
    s_add_u32 s50, s50, 1024
    s_mov_b32 m0, s50
    s_nop 0
    buffer_load_dwordx4 v126, s[60:63], s48 offen nt lds
    s_add_u32 s48, s48, 10240
    s_add_u32 s50, s50, 1024
    s_mov_b32 m0, s50
    s_nop 0
    buffer_load_dwordx4 v126, s[60:63], s48 offen nt lds
    s_add_u32 s48, s48, 10240
    s_add_u32 s50, s50, 1024
    s_mov_b32 m0, s50
    s_nop 0
    buffer_load_dwordx4 v126, s[60:63], s48 offen nt lds
    s_add_u32 s48, s48, 10240
    s_add_u32 s50, s50, 1024
    s_mov_b32 m0, s50
    s_nop 0
    buffer_load_dwordx4 v126, s[60:63], s48 offen nt lds
    s_add_u32 s48, s48, 10240
    s_add_u32 s50, s50, 1024
    s_mov_b32 m0, s50
    s_nop 0
    buffer_load_dwordx4 v126, s[60:63], s48 offen nt lds
    s_branch L_dma_end
L_dma_d:
    v_mul_u32_u24 v126, 3072, v126
    v_add_u32 v126, v126, v127
    s_mul_i32 s49, s53, 40
    s_mul_i32 s48, s49, 3072
    s_lshl_b32 s50, s55, 7
    s_add_u32 s48, s48, s50
    s_lshl_b32 s50, s49, 7
    s_add_u32 s50, s50, 42496
    s_mov_b32 m0, s50
    s_nop 0
    buffer_load_dwordx4 v126, s[64:67], s48 offen nt lds
    s_add_u32 s48, s48, 24576
    s_add_u32 s50, s50, 1024
    s_mov_b32 m0, s50
    s_nop 0
    buffer_load_dwordx4 v126, s[64:67], s48 offen nt lds
    s_add_u32 s48, s48, 24576
    s_add_u32 s50, s50, 1024
    s_mov_b32 m0, s50
    s_nop 0
    buffer_load_dwordx4 v126, s[64:67], s48 offen nt lds
    s_add_u32 s48, s48, 24576
    s_add_u32 s50, s50, 1024
    s_mov_b32 m0, s50
    s_nop 0
    buffer_load_dwordx4 v126, s[64:67], s48 offen nt lds
    s_add_u32 s48, s48, 24576
    s_add_u32 s50, s50, 1024
    s_mov_b32 m0, s50
    s_nop 0
    buffer_load_dwordx4 v126, s[64:67], s48 offen nt lds
    s_branch L_dma_end
L_dma_e:
    v_lshrrev_b32 v126, 2, v6
    v_and_b32 v127, 3, v6
    v_lshlrev_b32 v127, 4, v127
    v_mul_u32_u24 v126, 1280, v126
    v_add_u32 v126, v126, v127
    s_mul_i32 s49, s53, 96
    s_mul_i32 s48, s49, 1280
    s_lshl_b32 s50, s55, 6
    s_add_u32 s48, s48, s50
    s_lshl_b32 s50, s49, 6
    s_add_u32 s50, s50, 42496
    s_mov_b32 m0, s50
    s_nop 0
    buffer_load_dwordx4 v126, s[68:71], s48 offen nt lds
    s_add_u32 s48, s48, 20480
    s_add_u32 s50, s50, 1024
    s_mov_b32 m0, s50
    s_nop 0
    buffer_load_dwordx4 v126, s[68:71], s48 offen nt lds
    s_add_u32 s48, s48, 20480
    s_add_u32 s50, s50, 1024
    s_mov_b32 m0, s50
    s_nop 0
    buffer_load_dwordx4 v126, s[68:71], s48 offen nt lds
    s_add_u32 s48, s48, 20480
    s_add_u32 s50, s50, 1024
    s_mov_b32 m0, s50
    s_nop 0
    buffer_load_dwordx4 v126, s[68:71], s48 offen nt lds
    s_add_u32 s48, s48, 20480
    s_add_u32 s50, s50, 1024
    s_mov_b32 m0, s50
    s_nop 0
    buffer_load_dwordx4 v126, s[68:71], s48 offen nt lds
    s_add_u32 s48, s48, 20480
    s_add_u32 s50, s50, 1024
    s_mov_b32 m0, s50
    s_nop 0
    buffer_load_dwordx4 v126, s[68:71], s48 offen nt lds
L_dma_end:
    s_cmp_eq_u32 s98, 3
    s_cbranch_scc0 L_tail_go
    s_endpgm
L_tail_go:
    v_lshrrev_b32 v7, 6, v0
    s_cmp_eq_u32 s98, 0
    s_cbranch_scc1 L_tail_c
    s_cmp_eq_u32 s98, 1
    s_cbranch_scc1 L_tail_d
    s_cmp_lg_u32 s53, 0
    s_cbranch_scc1 L_gate_done
    s_lshl_b32 s44, s2, 7
    s_add_u32 s44, s44, 458752
    v_mov_b32 v122, 0
    s_mov_b32 s45, 0
    buffer_load_dword v123, v122, s[32:35], s44 offen sc0 sc1
L_gate_3:
    s_sleep 6
    buffer_load_dword v124, v122, s[32:35], s44 offen sc0 sc1
    s_waitcnt vmcnt(1)
    v_cmp_ne_u32 vcc, 1, v123
    s_cbranch_vccz L_gate_3_ok
    s_sleep 6
    buffer_load_dword v123, v122, s[32:35], s44 offen sc0 sc1
    s_waitcnt vmcnt(1)
    v_cmp_ne_u32 vcc, 1, v124
    s_add_u32 s45, s45, 1
    s_cbranch_vccz L_gate_3_ok
    s_cmp_lt_u32 s45, 0x20000
    s_cbranch_scc1 L_gate_3
L_gate_3_ok:
L_gate_done:
    s_cmp_eq_u32 s98, 1
    s_cbranch_scc1 L_tail_d
    s_branch L_tail_e
L_tail_c:
    v_mov_b32 v12, v0
    v_mul_u32_u24 v13, 43691, v12
    v_lshrrev_b32 v13, 24, v13
    v_mul_u32_u24 v14, 384, v13
    v_sub_u32 v12, v12, v14
    v_mul_u32_u24 v14, 43691, v12
    v_lshrrev_b32 v14, 22, v14
    v_mul_u32_u24 v40, 98304, v13
    v_mul_u32_u24 v15, 1536, v14
    v_add_u32 v40, v40, v15
    v_lshl_add_u32 v40, v12, 4, v40
    v_mul_u32_u24 v46, 3136, v13
    v_lshl_add_u32 v46, v12, 2, v46
    v_and_b32 v12, 511, v0
    v_add_u32 v12, 1024, v12
    v_mul_u32_u24 v13, 43691, v12
    v_lshrrev_b32 v13, 24, v13
    v_mul_u32_u24 v14, 384, v13
    v_sub_u32 v12, v12, v14
    v_mul_u32_u24 v14, 43691, v12
    v_lshrrev_b32 v14, 22, v14
    v_mul_u32_u24 v41, 98304, v13
    v_mul_u32_u24 v15, 1536, v14
    v_add_u32 v41, v41, v15
    v_lshl_add_u32 v41, v12, 4, v41
    v_mul_u32_u24 v47, 3136, v13
    v_lshl_add_u32 v47, v12, 2, v47
    v_and_b32 v12, 3, v6
    v_mul_u32_u24 v8, 3136, v12
    v_lshlrev_b32 v9, 3, v12
    v_lshrrev_b32 v12, 4, v6
    v_lshl_add_u32 v8, v12, 4, v8
    v_mul_u32_u24 v12, 1024, v12
    v_add_u32 v9, v9, v12
    v_bfe_u32 v12, v6, 2, 2
    v_mul_u32_u24 v12, 128, v12
    v_add_u32 v9, v9, v12
    s_mul_i32 s46, s54, 12288
    s_add_u32 s46, s46, 1048576
    s_cmp_lg_u32 s53, 0
    s_cbranch_scc1 L_c_f
    v_mov_b32 v12, 4
    s_mov_b32 s45, 0
L_c_clr:
    buffer_load_dword v13, v12, s[36:39], 0 offen sc0 sc1
    s_waitcnt vmcnt(0)
    v_cmp_gt_u32 vcc, 256, v13
    s_add_u32 s45, s45, 1
    s_cbranch_vccz L_c_clr_ok
    s_cmp_ge_u32 s45, 0x20000
    s_cbranch_scc1 L_c_clr_ok
    s_sleep 8
    s_branch L_c_clr
L_c_clr_ok:
    s_lshl_b32 s44, s2, 7
    s_add_u32 s44, s44, 458752
    v_mov_b32 v12, 0
    s_mov_b32 s45, 0
L_c_fl:
    buffer_load_dwordx2 v[14:15], v12, s[32:35], s44 offen sc0 sc1
    s_waitcnt vmcnt(0)
    v_min_u32 v14, v14, v15
    v_cmp_ne_u32 vcc, 1, v14
    s_add_u32 s45, s45, 1
    s_cbranch_vccz L_c_f
    s_cmp_ge_u32 s45, 0x20000
    s_cbranch_scc1 L_c_f
    s_sleep 6
    s_branch L_c_fl
L_c_f:
    s_waitcnt vmcnt(0)
    s_barrier
    s_lshr_b32 s48, s53, 2
    s_and_b32 s49, s53, 3
    s_mul_i32 s50, s48, 24576
    s_lshl_b32 s49, s49, 5
    s_add_u32 s50, s50, s49
    s_add_u32 s50, s50, 42496
    v_add_u32 v13, s50, v9
    ds_read_b64_tr_b16 v[80:81], v13 offset:0
    ds_read_b64_tr_b16 v[82:83], v13 offset:512
    ds_read_b64_tr_b16 v[84:85], v13 offset:4096
    ds_read_b64_tr_b16 v[86:87], v13 offset:4608
    ds_read_b64_tr_b16 v[88:89], v13 offset:8192
    ds_read_b64_tr_b16 v[90:91], v13 offset:8704
    ds_read_b64_tr_b16 v[92:93], v13 offset:12288
    ds_read_b64_tr_b16 v[94:95], v13 offset:12800
    ds_read_b64_tr_b16 v[112:113], v13 offset:16384
    ds_read_b64_tr_b16 v[114:115], v13 offset:16896
    ds_read_b64_tr_b16 v[116:117], v13 offset:20480
    ds_read_b64_tr_b16 v[118:119], v13 offset:20992
    s_cmp_ge_u32 s53, 8
    s_cbranch_scc1 L_c_one
    s_mov_b32 s45, 0
    buffer_load_dwordx4 v[64:67], v40, s[32:35], s46 offen offset:0 sc0 sc1
    buffer_load_dwordx4 v[68:71], v40, s[32:35], s46 offen offset:1536 sc0 sc1
    buffer_load_dwordx4 v[72:75], v41, s[32:35], s46 offen offset:0 sc0 sc1
    buffer_load_dwordx4 v[76:79], v41, s[32:35], s46 offen offset:1536 sc0 sc1
    s_sleep 10
L_pc_4:
    buffer_load_dwordx4 v[96:99], v40, s[32:35], s46 offen offset:0 sc0 sc1
    buffer_load_dwordx4 v[100:103], v40, s[32:35], s46 offen offset:1536 sc0 sc1
    buffer_load_dwordx4 v[104:107], v41, s[32:35], s46 offen offset:0 sc0 sc1
    buffer_load_dwordx4 v[108:111], v41, s[32:35], s46 offen offset:1536 sc0 sc1
    s_waitcnt vmcnt(4)
    v_max_u32 v14, v64, v65
    v_max3_u32 v14, v14, v66, v67
    v_max3_u32 v14, v14, v68, v69
    v_max3_u32 v14, v14, v70, v71
    v_max3_u32 v14, v14, v72, v73
    v_max3_u32 v14, v14, v74, v75
    v_max3_u32 v14, v14, v76, v77
    v_max3_u32 v14, v14, v78, v79
    v_cmp_eq_u32 vcc, -1, v14
    s_cbranch_vccz L_pc_4_a
    buffer_load_dwordx4 v[64:67], v40, s[32:35], s46 offen offset:0 sc0 sc1
    buffer_load_dwordx4 v[68:71], v40, s[32:35], s46 offen offset:1536 sc0 sc1
    buffer_load_dwordx4 v[72:75], v41, s[32:35], s46 offen offset:0 sc0 sc1
    buffer_load_dwordx4 v[76:79], v41, s[32:35], s46 offen offset:1536 sc0 sc1
    s_waitcnt vmcnt(4)
    v_max_u32 v14, v96, v97
    v_max3_u32 v14, v14, v98, v99
    v_max3_u32 v14, v14, v100, v101
    v_max3_u32 v14, v14, v102, v103
    v_max3_u32 v14, v14, v104, v105
    v_max3_u32 v14, v14, v106, v107
    v_max3_u32 v14, v14, v108, v109
    v_max3_u32 v14, v14, v110, v111
    v_cmp_eq_u32 vcc, -1, v14
    s_cbranch_vccz L_pc_4_b
    s_add_u32 s45, s45, 1
    s_cmp_lt_u32 s45, 0x20000
    s_cbranch_scc1 L_pc_4
L_pc_4_b:
    v_max_f32 v12, v98, v102
    v_sub_f32 v13, v98, v12
    v_sub_f32 v14, v102, v12
    v_mul_f32 v13, 0x3fb8aa3b, v13
    v_mul_f32 v14, 0x3fb8aa3b, v14
    v_exp_f32 v13, v13
    v_exp_f32 v14, v14
    s_nop 0
    v_mul_f32 v15, v13, v99
    v_fmac_f32 v15, v14, v103
    v_rcp_f32 v15, v15
    s_nop 0
    v_mul_f32 v13, v13, v15
    v_mul_f32 v14, v14, v15
    v_mul_f32 v12, v13, v96
    v_mul_f32 v15, v13, v97
    v_fmac_f32 v12, v14, v100
    v_fmac_f32 v15, v14, v101
    v_cvt_pk_bf16_f32 v12, v12, v15
    ds_write_b32 v46, v12 offset:29952
    v_max_f32 v12, v106, v110
    v_sub_f32 v13, v106, v12
    v_sub_f32 v14, v110, v12
    v_mul_f32 v13, 0x3fb8aa3b, v13
    v_mul_f32 v14, 0x3fb8aa3b, v14
    v_exp_f32 v13, v13
    v_exp_f32 v14, v14
    s_nop 0
    v_mul_f32 v15, v13, v107
    v_fmac_f32 v15, v14, v111
    v_rcp_f32 v15, v15
    s_nop 0
    v_mul_f32 v13, v13, v15
    v_mul_f32 v14, v14, v15
    v_mul_f32 v12, v13, v104
    v_mul_f32 v15, v13, v105
    v_fmac_f32 v12, v14, v108
    v_fmac_f32 v15, v14, v109
    v_cvt_pk_bf16_f32 v12, v12, v15
    ds_write_b32 v47, v12 offset:29952
    s_branch L_pc_4_e
L_pc_4_a:
    v_max_f32 v12, v66, v70
    v_sub_f32 v13, v66, v12
    v_sub_f32 v14, v70, v12
    v_mul_f32 v13, 0x3fb8aa3b, v13
    v_mul_f32 v14, 0x3fb8aa3b, v14
    v_exp_f32 v13, v13
    v_exp_f32 v14, v14
    s_nop 0
    v_mul_f32 v15, v13, v67
    v_fmac_f32 v15, v14, v71
    v_rcp_f32 v15, v15
    s_nop 0
    v_mul_f32 v13, v13, v15
    v_mul_f32 v14, v14, v15
    v_mul_f32 v12, v13, v64
    v_mul_f32 v15, v13, v65
    v_fmac_f32 v12, v14, v68
    v_fmac_f32 v15, v14, v69
    v_cvt_pk_bf16_f32 v12, v12, v15
    ds_write_b32 v46, v12 offset:29952
    v_max_f32 v12, v74, v78
    v_sub_f32 v13, v74, v12
    v_sub_f32 v14, v78, v12
    v_mul_f32 v13, 0x3fb8aa3b, v13
    v_mul_f32 v14, 0x3fb8aa3b, v14
    v_exp_f32 v13, v13
    v_exp_f32 v14, v14
    s_nop 0
    v_mul_f32 v15, v13, v75
    v_fmac_f32 v15, v14, v79
    v_rcp_f32 v15, v15
    s_nop 0
    v_mul_f32 v13, v13, v15
    v_mul_f32 v14, v14, v15
    v_mul_f32 v12, v13, v72
    v_mul_f32 v15, v13, v73
    v_fmac_f32 v12, v14, v76
    v_fmac_f32 v15, v14, v77
    v_cvt_pk_bf16_f32 v12, v12, v15
    ds_write_b32 v47, v12 offset:29952
L_pc_4_e:
    s_branch L_c_items_done
L_c_one:
    s_mov_b32 s45, 0
    buffer_load_dwordx4 v[64:67], v40, s[32:35], s46 offen offset:0 sc0 sc1
    buffer_load_dwordx4 v[68:71], v40, s[32:35], s46 offen offset:1536 sc0 sc1
    s_sleep 10
L_pc_5:
    buffer_load_dwordx4 v[96:99], v40, s[32:35], s46 offen offset:0 sc0 sc1
    buffer_load_dwordx4 v[100:103], v40, s[32:35], s46 offen offset:1536 sc0 sc1
    s_waitcnt vmcnt(2)
    v_max_u32 v14, v64, v65
    v_max3_u32 v14, v14, v66, v67
    v_max3_u32 v14, v14, v68, v69
    v_max3_u32 v14, v14, v70, v71
    v_cmp_eq_u32 vcc, -1, v14
    s_cbranch_vccz L_pc_5_a
    buffer_load_dwordx4 v[64:67], v40, s[32:35], s46 offen offset:0 sc0 sc1
    buffer_load_dwordx4 v[68:71], v40, s[32:35], s46 offen offset:1536 sc0 sc1
    s_waitcnt vmcnt(2)
    v_max_u32 v14, v96, v97
    v_max3_u32 v14, v14, v98, v99
    v_max3_u32 v14, v14, v100, v101
    v_max3_u32 v14, v14, v102, v103
    v_cmp_eq_u32 vcc, -1, v14
    s_cbranch_vccz L_pc_5_b
    s_add_u32 s45, s45, 1
    s_cmp_lt_u32 s45, 0x20000
    s_cbranch_scc1 L_pc_5
L_pc_5_b:
    v_max_f32 v12, v98, v102
    v_sub_f32 v13, v98, v12
    v_sub_f32 v14, v102, v12
    v_mul_f32 v13, 0x3fb8aa3b, v13
    v_mul_f32 v14, 0x3fb8aa3b, v14
    v_exp_f32 v13, v13
    v_exp_f32 v14, v14
    s_nop 0
    v_mul_f32 v15, v13, v99
    v_fmac_f32 v15, v14, v103
    v_rcp_f32 v15, v15
    s_nop 0
    v_mul_f32 v13, v13, v15
    v_mul_f32 v14, v14, v15
    v_mul_f32 v12, v13, v96
    v_mul_f32 v15, v13, v97
    v_fmac_f32 v12, v14, v100
    v_fmac_f32 v15, v14, v101
    v_cvt_pk_bf16_f32 v12, v12, v15
    ds_write_b32 v46, v12 offset:29952
    s_branch L_pc_5_e
L_pc_5_a:
    v_max_f32 v12, v66, v70
    v_sub_f32 v13, v66, v12
    v_sub_f32 v14, v70, v12
    v_mul_f32 v13, 0x3fb8aa3b, v13
    v_mul_f32 v14, 0x3fb8aa3b, v14
    v_exp_f32 v13, v13
    v_exp_f32 v14, v14
    s_nop 0
    v_mul_f32 v15, v13, v67
    v_fmac_f32 v15, v14, v71
    v_rcp_f32 v15, v15
    s_nop 0
    v_mul_f32 v13, v13, v15
    v_mul_f32 v14, v14, v15
    v_mul_f32 v12, v13, v64
    v_mul_f32 v15, v13, v65
    v_fmac_f32 v12, v14, v68
    v_fmac_f32 v15, v14, v69
    v_cvt_pk_bf16_f32 v12, v12, v15
    ds_write_b32 v46, v12 offset:29952
L_pc_5_e:
L_c_items_done:
    s_waitcnt lgkmcnt(0)
    s_barrier
    s_lshr_b32 s48, s53, 2
    s_mul_i32 s50, s48, 384
    s_add_u32 s50, s50, 29952
    v_add_u32 v12, s50, v8
    ds_read_b128 v[16:19], v12 offset:0
    ds_read_b128 v[20:23], v12 offset:64
    ds_read_b128 v[24:27], v12 offset:128
    ds_read_b128 v[28:31], v12 offset:192
    ds_read_b128 v[32:35], v12 offset:256
    ds_read_b128 v[36:39], v12 offset:320
    s_waitcnt lgkmcnt(5)
    v_mfma_f32_16x16x32_bf16 v[48:51], v[16:19], v[80:83], 0
    s_waitcnt lgkmcnt(4)
    v_mfma_f32_16x16x32_bf16 v[48:51], v[20:23], v[84:87], v[48:51]
    s_waitcnt lgkmcnt(3)
    v_mfma_f32_16x16x32_bf16 v[48:51], v[24:27], v[88:91], v[48:51]
    s_waitcnt lgkmcnt(2)
    v_mfma_f32_16x16x32_bf16 v[48:51], v[28:31], v[92:95], v[48:51]
    s_waitcnt lgkmcnt(1)
    v_mfma_f32_16x16x32_bf16 v[48:51], v[32:35], v[112:115], v[48:51]
    s_waitcnt lgkmcnt(0)
    v_mfma_f32_16x16x32_bf16 v[48:51], v[36:39], v[116:119], v[48:51]
    s_nop 15
    s_lshr_b32 s48, s53, 2
    s_and_b32 s49, s53, 3
    s_mul_i32 s48, s48, 1024
    s_lshl_b32 s49, s49, 6
    s_add_u32 s48, s48, s49
    v_lshlrev_b32 v12, 2, v6
    v_add_u32 v12, s48, v12
    s_mov_b64 exec, 0xffff
    ds_write_b32 v12, v48 offset:13824
    ds_write_b32 v12, v49 offset:14080
    ds_write_b32 v12, v50 offset:14336
    ds_write_b32 v12, v51 offset:14592
    s_mov_b64 exec, -1
    s_waitcnt lgkmcnt(0)
    s_barrier
    s_cmp_ge_u32 s53, 4
    s_cbranch_scc1 L_c_pub_done
    v_lshlrev_b32 v12, 2, v0
    ds_read_b32 v16, v12 offset:13824
    ds_read_b32 v17, v12 offset:14848
    ds_read_b32 v18, v12 offset:15872
    ds_read_b32 v19, v12 offset:16896
    s_waitcnt lgkmcnt(0)
    v_add_f32 v16, v16, v17
    v_add_f32 v18, v18, v19
    v_add_f32 v16, v16, v18
    v_mul_u32_u24 v12, 2560, v7
    v_lshl_add_u32 v12, v6, 2, v12
    s_mul_i32 s48, s54, 10240
    s_lshl_b32 s49, s55, 8
    s_add_u32 s48, s48, s49
    s_add_u32 s48, s48, 262144
    buffer_store_dword v16, v12, s[32:35], s48 offen sc0 sc1
L_c_pub_done:
    s_endpgm
L_tail_e:
    v_and_b32 v12, 3, v6
    v_mul_u32_u24 v8, 3136, v12
    v_lshlrev_b32 v9, 3, v12
    v_lshrrev_b32 v12, 4, v6
    v_lshl_add_u32 v8, v12, 4, v8
    v_mul_u32_u24 v12, 512, v12
    v_add_u32 v9, v9, v12
    v_bfe_u32 v12, v6, 2, 2
    v_mul_u32_u24 v12, 64, v12
    v_add_u32 v9, v9, v12
    s_barrier
    v_min_u32 v57, 39, v6
    s_lshr_b32 s48, s53, 2
    s_mul_i32 s48, s48, 40
    v_add_u32 v57, s48, v57
    v_cmp_gt_u32 vcc, 40, v6
    s_nop 1
    v_cndmask_b32_e64 v56, 0, 1.0, vcc
    s_and_b32 s49, s53, 3
    s_mul_i32 s50, s49, 1280
    v_lshlrev_b32 v58, 3, v57
    buffer_load_dwordx2 v[48:49], v58, s[56:59], s50 offen
    buffer_load_dwordx2 v[50:51], v58, s[72:75], 0 offen
    s_mul_i32 s51, s49, 1344
    v_add_u32 v62, s51, v58
    v_lshlrev_b32 v59, 4, v57
    s_mul_i32 s50, s49, 2560
    s_add_u32 s50, s50, 262144
    s_mov_b32 s45, 0
    s_mov_b32 s44, s50
    buffer_load_dwordx4 v[64:67], v59, s[32:35], s44 offen sc0 sc1
    s_add_u32 s44, s44, 10240
    buffer_load_dwordx4 v[68:71], v59, s[32:35], s44 offen sc0 sc1
    s_add_u32 s44, s44, 10240
    buffer_load_dwordx4 v[72:75], v59, s[32:35], s44 offen sc0 sc1
    s_add_u32 s44, s44, 10240
    buffer_load_dwordx4 v[76:79], v59, s[32:35], s44 offen sc0 sc1
    s_add_u32 s44, s44, 10240
    buffer_load_dwordx4 v[80:83], v59, s[32:35], s44 offen sc0 sc1
    s_add_u32 s44, s44, 10240
    buffer_load_dwordx4 v[84:87], v59, s[32:35], s44 offen sc0 sc1
    s_add_u32 s44, s44, 10240
    buffer_load_dwordx4 v[88:91], v59, s[32:35], s44 offen sc0 sc1
    s_add_u32 s44, s44, 10240
    buffer_load_dwordx4 v[92:95], v59, s[32:35], s44 offen sc0 sc1
    s_sleep 10
L_pl_6:
    s_mov_b32 s44, s50
    buffer_load_dwordx4 v[96:99], v59, s[32:35], s44 offen sc0 sc1
    s_add_u32 s44, s44, 10240
    buffer_load_dwordx4 v[100:103], v59, s[32:35], s44 offen sc0 sc1
    s_add_u32 s44, s44, 10240
    buffer_load_dwordx4 v[104:107], v59, s[32:35], s44 offen sc0 sc1
    s_add_u32 s44, s44, 10240
    buffer_load_dwordx4 v[108:111], v59, s[32:35], s44 offen sc0 sc1
    s_add_u32 s44, s44, 10240
    buffer_load_dwordx4 v[112:115], v59, s[32:35], s44 offen sc0 sc1
    s_add_u32 s44, s44, 10240
    buffer_load_dwordx4 v[116:119], v59, s[32:35], s44 offen sc0 sc1
    s_add_u32 s44, s44, 10240
    buffer_load_dwordx4 v[120:123], v59, s[32:35], s44 offen sc0 sc1
    s_add_u32 s44, s44, 10240
    buffer_load_dwordx4 v[124:127], v59, s[32:35], s44 offen sc0 sc1
    s_waitcnt vmcnt(8)
    v_max_u32 v60, v64, v65
    v_max3_u32 v60, v60, v66, v67
    v_max3_u32 v60, v60, v68, v69
    v_max3_u32 v60, v60, v70, v71
    v_max3_u32 v60, v60, v72, v73
    v_max3_u32 v60, v60, v74, v75
    v_max3_u32 v60, v60, v76, v77
    v_max3_u32 v60, v60, v78, v79
    v_max3_u32 v60, v60, v80, v81
    v_max3_u32 v60, v60, v82, v83
    v_max3_u32 v60, v60, v84, v85
    v_max3_u32 v60, v60, v86, v87
    v_max3_u32 v60, v60, v88, v89
    v_max3_u32 v60, v60, v90, v91
    v_max3_u32 v60, v60, v92, v93
    v_max3_u32 v60, v60, v94, v95
    v_cmp_eq_u32 vcc, -1, v60
    s_cbranch_vccz L_pl_6_a
    s_mov_b32 s44, s50
    buffer_load_dwordx4 v[64:67], v59, s[32:35], s44 offen sc0 sc1
    s_add_u32 s44, s44, 10240
    buffer_load_dwordx4 v[68:71], v59, s[32:35], s44 offen sc0 sc1
    s_add_u32 s44, s44, 10240
    buffer_load_dwordx4 v[72:75], v59, s[32:35], s44 offen sc0 sc1
    s_add_u32 s44, s44, 10240
    buffer_load_dwordx4 v[76:79], v59, s[32:35], s44 offen sc0 sc1
    s_add_u32 s44, s44, 10240
    buffer_load_dwordx4 v[80:83], v59, s[32:35], s44 offen sc0 sc1
    s_add_u32 s44, s44, 10240
    buffer_load_dwordx4 v[84:87], v59, s[32:35], s44 offen sc0 sc1
    s_add_u32 s44, s44, 10240
    buffer_load_dwordx4 v[88:91], v59, s[32:35], s44 offen sc0 sc1
    s_add_u32 s44, s44, 10240
    buffer_load_dwordx4 v[92:95], v59, s[32:35], s44 offen sc0 sc1
    s_waitcnt vmcnt(8)
    v_max_u32 v60, v96, v97
    v_max3_u32 v60, v60, v98, v99
    v_max3_u32 v60, v60, v100, v101
    v_max3_u32 v60, v60, v102, v103
    v_max3_u32 v60, v60, v104, v105
    v_max3_u32 v60, v60, v106, v107
    v_max3_u32 v60, v60, v108, v109
    v_max3_u32 v60, v60, v110, v111
    v_max3_u32 v60, v60, v112, v113
    v_max3_u32 v60, v60, v114, v115
    v_max3_u32 v60, v60, v116, v117
    v_max3_u32 v60, v60, v118, v119
    v_max3_u32 v60, v60, v120, v121
    v_max3_u32 v60, v60, v122, v123
    v_max3_u32 v60, v60, v124, v125
    v_max3_u32 v60, v60, v126, v127
    v_cmp_eq_u32 vcc, -1, v60
    s_cbranch_vccz L_pl_6_b
    s_add_u32 s45, s45, 1
    s_cmp_lt_u32 s45, 0x20000
    s_cbranch_scc1 L_pl_6
L_pl_6_b:
    v_mov_b32 v16, v96
    v_mov_b32 v17, v97
    v_mov_b32 v18, v98
    v_mov_b32 v19, v99
    v_mov_b32 v20, v100
    v_mov_b32 v21, v101
    v_mov_b32 v22, v102
    v_mov_b32 v23, v103
    v_mov_b32 v24, v104
    v_mov_b32 v25, v105
    v_mov_b32 v26, v106
    v_mov_b32 v27, v107
    v_mov_b32 v28, v108
    v_mov_b32 v29, v109
    v_mov_b32 v30, v110
    v_mov_b32 v31, v111
    v_mov_b32 v32, v112
    v_mov_b32 v33, v113
    v_mov_b32 v34, v114
    v_mov_b32 v35, v115
    v_mov_b32 v36, v116
    v_mov_b32 v37, v117
    v_mov_b32 v38, v118
    v_mov_b32 v39, v119
    v_mov_b32 v40, v120
    v_mov_b32 v41, v121
    v_mov_b32 v42, v122
    v_mov_b32 v43, v123
    v_mov_b32 v44, v124
    v_mov_b32 v45, v125
    v_mov_b32 v46, v126
    v_mov_b32 v47, v127
    s_branch L_pl_6_e
L_pl_6_a:
    v_mov_b32 v16, v64
    v_mov_b32 v17, v65
    v_mov_b32 v18, v66
    v_mov_b32 v19, v67
    v_mov_b32 v20, v68
    v_mov_b32 v21, v69
    v_mov_b32 v22, v70
    v_mov_b32 v23, v71
    v_mov_b32 v24, v72
    v_mov_b32 v25, v73
    v_mov_b32 v26, v74
    v_mov_b32 v27, v75
    v_mov_b32 v28, v76
    v_mov_b32 v29, v77
    v_mov_b32 v30, v78
    v_mov_b32 v31, v79
    v_mov_b32 v32, v80
    v_mov_b32 v33, v81
    v_mov_b32 v34, v82
    v_mov_b32 v35, v83
    v_mov_b32 v36, v84
    v_mov_b32 v37, v85
    v_mov_b32 v38, v86
    v_mov_b32 v39, v87
    v_mov_b32 v40, v88
    v_mov_b32 v41, v89
    v_mov_b32 v42, v90
    v_mov_b32 v43, v91
    v_mov_b32 v44, v92
    v_mov_b32 v45, v93
    v_mov_b32 v46, v94
    v_mov_b32 v47, v95
L_pl_6_e:
    v_add_f32 v16, v16, v32
    v_add_f32 v20, v20, v36
    v_add_f32 v24, v24, v40
    v_add_f32 v28, v28, v44
    v_add_f32 v52, v16, v20
    v_add_f32 v60, v24, v28
    v_add_f32 v52, v52, v60
    v_cvt_pk_bf16_f32 v52, v52, v52
    v_lshlrev_b32 v52, 16, v52
    v_add_f32 v17, v17, v33
    v_add_f32 v21, v21, v37
    v_add_f32 v25, v25, v41
    v_add_f32 v29, v29, v45
    v_add_f32 v53, v17, v21
    v_add_f32 v60, v25, v29
    v_add_f32 v53, v53, v60
    v_cvt_pk_bf16_f32 v53, v53, v53
    v_lshlrev_b32 v53, 16, v53
    v_add_f32 v18, v18, v34
    v_add_f32 v22, v22, v38
    v_add_f32 v26, v26, v42
    v_add_f32 v30, v30, v46
    v_add_f32 v54, v18, v22
    v_add_f32 v60, v26, v30
    v_add_f32 v54, v54, v60
    v_cvt_pk_bf16_f32 v54, v54, v54
    v_lshlrev_b32 v54, 16, v54
    v_add_f32 v19, v19, v35
    v_add_f32 v23, v23, v39
    v_add_f32 v27, v27, v43
    v_add_f32 v31, v31, v47
    v_add_f32 v55, v19, v23
    v_add_f32 v60, v27, v31
    v_add_f32 v55, v55, v60
    v_cvt_pk_bf16_f32 v55, v55, v55
    v_lshlrev_b32 v55, 16, v55
    v_lshlrev_b32 v58, 16, v48
    v_and_b32 v59, 0xffff0000, v48
    v_lshlrev_b32 v60, 16, v49
    v_and_b32 v61, 0xffff0000, v49
    v_add_f32 v52, v52, v58
    v_cvt_pk_bf16_f32 v52, v52, v52
    v_lshlrev_b32 v52, 16, v52
    v_add_f32 v53, v53, v59
    v_cvt_pk_bf16_f32 v53, v53, v53
    v_lshlrev_b32 v53, 16, v53
    v_add_f32 v54, v54, v60
    v_cvt_pk_bf16_f32 v54, v54, v54
    v_lshlrev_b32 v54, 16, v54
    v_add_f32 v55, v55, v61
    v_cvt_pk_bf16_f32 v55, v55, v55
    v_lshlrev_b32 v55, 16, v55
    v_add_f32 v58, v52, v53
    v_add_f32 v59, v54, v55
    v_add_f32 v58, v58, v59
    v_mul_f32 v58, v58, v56
    s_nop 1
    v_add_f32_dpp v58, v58, v58 quad_perm:[1,0,3,2] row_mask:0xf bank_mask:0xf
    s_nop 1
    v_add_f32_dpp v58, v58, v58 quad_perm:[2,3,0,1] row_mask:0xf bank_mask:0xf
    s_nop 1
    v_add_f32_dpp v58, v58, v58 row_half_mirror row_mask:0xf bank_mask:0xf
    s_nop 1
    v_add_f32_dpp v58, v58, v58 row_mirror row_mask:0xf bank_mask:0xf
    s_nop 1
    v_readlane_b32 s48, v58, 0
    v_readlane_b32 s49, v58, 16
    v_readlane_b32 s50, v58, 32
    v_readlane_b32 s51, v58, 48
    s_nop 1
    v_mov_b32 v58, s48
    v_add_f32 v58, s49, v58
    v_add_f32 v58, s50, v58
    v_add_f32 v58, s51, v58
    v_mul_f32 v58, 0x3bcccccd, v58
    v_sub_f32 v60, v52, v58
    v_mul_f32 v59, v60, v60
    v_sub_f32 v60, v53, v58
    v_fmac_f32 v59, v60, v60
    v_sub_f32 v60, v54, v58
    v_fmac_f32 v59, v60, v60
    v_sub_f32 v60, v55, v58
    v_fmac_f32 v59, v60, v60
    v_mul_f32 v59, v59, v56
    s_nop 1
    v_add_f32_dpp v59, v59, v59 quad_perm:[1,0,3,2] row_mask:0xf bank_mask:0xf
    s_nop 1
    v_add_f32_dpp v59, v59, v59 quad_perm:[2,3,0,1] row_mask:0xf bank_mask:0xf
    s_nop 1
    v_add_f32_dpp v59, v59, v59 row_half_mirror row_mask:0xf bank_mask:0xf
    s_nop 1
    v_add_f32_dpp v59, v59, v59 row_mirror row_mask:0xf bank_mask:0xf
    s_nop 1
    v_readlane_b32 s48, v59, 0
    v_readlane_b32 s49, v59, 16
    v_readlane_b32 s50, v59, 32
    v_readlane_b32 s51, v59, 48
    s_nop 1
    v_mov_b32 v59, s48
    v_add_f32 v59, s49, v59
    v_add_f32 v59, s50, v59
    v_add_f32 v59, s51, v59
    s_lshl_b32 s49, s53, 5
    s_and_b32 s49, s49, 96
    s_and_b32 s50, s53, 12
    s_lshl_b32 s50, s50, 1
    s_add_u32 s50, s50, s49
    v_mov_b32 v60, s50
    v_mov_b32 v61, s49
    ds_write_b64 v60, v[58:59] offset:29696
    s_waitcnt lgkmcnt(0)
    s_barrier
    ds_read_b128 v[16:19], v61 offset:29696
    ds_read_b128 v[20:23], v61 offset:29712
    s_waitcnt lgkmcnt(0)
    v_add_f32 v24, v16, v18
    v_add_f32 v25, v20, v22
    v_add_f32 v24, v24, v25
    v_mul_f32 v24, 0.25, v24
    v_add_f32 v25, v17, v19
    v_add_f32 v26, v21, v23
    v_add_f32 v25, v25, v26
    v_sub_f32 v16, v16, v24
    v_sub_f32 v18, v18, v24
    v_sub_f32 v20, v20, v24
    v_sub_f32 v22, v22, v24
    v_mul_f32 v26, v16, v16
    v_fmac_f32 v26, v18, v18
    v_fmac_f32 v26, v20, v20
    v_fmac_f32 v26, v22, v22
    v_mov_b32 v27, 0x43200000
    v_fmac_f32 v25, v26, v27
    v_mul_f32 v25, 0x3acccccd, v25
    v_cvt_pk_bf16_f32 v24, v24, v24
    v_lshlrev_b32 v24, 16, v24
    v_cvt_pk_bf16_f32 v25, v25, v25
    v_lshlrev_b32 v25, 16, v25
    v_add_f32 v25, 0x3727c5ac, v25
    v_cvt_pk_bf16_f32 v25, v25, v25
    v_lshlrev_b32 v25, 16, v25
    v_sqrt_f32 v25, v25
    s_nop 0
    v_cvt_pk_bf16_f32 v25, v25, v25
    v_lshlrev_b32 v25, 16, v25
    v_rcp_f32 v25, v25
    s_nop 0
    v_sub_f32 v28, v52, v24
    v_cvt_pk_bf16_f32 v28, v28, v28
    v_lshlrev_b32 v28, 16, v28
    v_mul_f32 v28, v28, v25
    v_cvt_pk_bf16_f32 v28, v28, v28
    v_lshlrev_b32 v28, 16, v28
    v_sub_f32 v29, v53, v24
    v_cvt_pk_bf16_f32 v29, v29, v29
    v_lshlrev_b32 v29, 16, v29
    v_mul_f32 v29, v29, v25
    v_cvt_pk_bf16_f32 v29, v29, v29
    v_lshlrev_b32 v29, 16, v29
    v_sub_f32 v30, v54, v24
    v_cvt_pk_bf16_f32 v30, v30, v30
    v_lshlrev_b32 v30, 16, v30
    v_mul_f32 v30, v30, v25
    v_cvt_pk_bf16_f32 v30, v30, v30
    v_lshlrev_b32 v30, 16, v30
    v_sub_f32 v31, v55, v24
    v_cvt_pk_bf16_f32 v31, v31, v31
    v_lshlrev_b32 v31, 16, v31
    v_mul_f32 v31, v31, v25
    v_cvt_pk_bf16_f32 v31, v31, v31
    v_lshlrev_b32 v31, 16, v31
    v_cvt_pk_bf16_f32 v32, v28, v29
    v_cvt_pk_bf16_f32 v33, v30, v31
    v_cvt_pk_bf16_f32 v34, v52, v53
    v_cvt_pk_bf16_f32 v35, v54, v55
    v_lshlrev_b32 v58, 16, v50
    v_and_b32 v59, 0xffff0000, v50
    v_mul_f32 v36, v28, v58
    v_fmac_f32 v36, v29, v59
    v_lshlrev_b32 v58, 16, v51
    v_and_b32 v59, 0xffff0000, v51
    v_fmac_f32 v36, v30, v58
    v_fmac_f32 v36, v31, v59
    v_mul_f32 v36, v36, v56
    s_nop 1
    v_add_f32_dpp v36, v36, v36 quad_perm:[1,0,3,2] row_mask:0xf bank_mask:0xf
    s_nop 1
    v_add_f32_dpp v36, v36, v36 quad_perm:[2,3,0,1] row_mask:0xf bank_mask:0xf
    s_nop 1
    v_add_f32_dpp v36, v36, v36 row_half_mirror row_mask:0xf bank_mask:0xf
    s_nop 1
    v_add_f32_dpp v36, v36, v36 row_mirror row_mask:0xf bank_mask:0xf
    s_nop 1
    v_readlane_b32 s48, v36, 0
    v_readlane_b32 s49, v36, 16
    v_readlane_b32 s50, v36, 32
    v_readlane_b32 s51, v36, 48
    s_nop 1
    v_mov_b32 v36, s48
    v_add_f32 v36, s49, v36
    v_add_f32 v36, s50, v36
    v_add_f32 v36, s51, v36
    v_lshrrev_b32 v60, 1, v60
    ds_write_b32 v60, v36 offset:29824
    s_mov_b32 exec_lo, -1
    s_mov_b32 exec_hi, 0xff
    ds_write_b64 v62, v[32:33] offset:18944
    ds_write_b64 v62, v[34:35] offset:24320
    s_mov_b64 exec, -1
    s_waitcnt vmcnt(0)
    s_lshr_b32 s48, s53, 1
    s_and_b32 s49, s53, 1
    s_mul_i32 s50, s48, 12288
    s_lshl_b32 s49, s49, 5
    s_add_u32 s50, s50, s49
    s_add_u32 s50, s50, 42496
    v_add_u32 v13, s50, v9
    ds_read_b64_tr_b16 v[40:41], v13 offset:0
    ds_read_b64_tr_b16 v[42:43], v13 offset:256
    ds_read_b64_tr_b16 v[44:45], v13 offset:2048
    ds_read_b64_tr_b16 v[46:47], v13 offset:2304
    ds_read_b64_tr_b16 v[48:49], v13 offset:4096
    ds_read_b64_tr_b16 v[50:51], v13 offset:4352
    ds_read_b64_tr_b16 v[52:53], v13 offset:6144
    ds_read_b64_tr_b16 v[54:55], v13 offset:6400
    ds_read_b64_tr_b16 v[56:57], v13 offset:8192
    ds_read_b64_tr_b16 v[58:59], v13 offset:8448
    ds_read_b64_tr_b16 v[60:61], v13 offset:10240
    ds_read_b64_tr_b16 v[62:63], v13 offset:10496
    s_waitcnt lgkmcnt(0)
    s_barrier
    s_cmp_ge_u32 s53, 2
    s_cbranch_scc1 L_e_pre_done
    v_and_b32 v13, 31, v0
    s_lshl_b32 s48, s55, 5
    v_add_u32 v13, s48, v13
    v_lshrrev_b32 v14, 5, v0
    v_mul_u32_u24 v15, 1344, v14
    v_lshl_add_u32 v15, v13, 1, v15
    v_lshlrev_b32 v12, 4, v14
    ds_read_u16 v70, v15 offset:18944
    ds_read_u16 v71, v15 offset:24320
    ds_read_b128 v[76:79], v12 offset:29824
    v_mul_u32_u24 v14, 640, v14
    v_add_u32 v14, v14, v13
    v_lshlrev_b32 v73, 1, v14
    s_waitcnt lgkmcnt(0)
    v_add_f32 v76, v76, v77
    v_add_f32 v78, v78, v79
    v_add_f32 v72, v76, v78
    v_cvt_pk_bf16_f32 v72, v72, v72
    v_lshlrev_b32 v72, 16, v72
    v_mul_f32 v72, 0xbfb8aa3b, v72
    v_exp_f32 v72, v72
    s_nop 0
    v_add_f32 v72, 1.0, v72
    v_rcp_f32 v72, v72
    s_nop 0
    v_cvt_pk_bf16_f32 v72, v72, v72
    v_lshlrev_b32 v72, 16, v72
    v_lshlrev_b32 v70, 16, v70
    v_lshlrev_b32 v71, 16, v71
L_e_pre_done:
    s_cmp_lt_u32 s53, 4
    s_cbranch_scc1 L_e_wait
L_e_act:
    v_subrev_u32 v15, 256, v0
    v_lshlrev_b32 v12, 4, v15
    v_mul_u32_u24 v13, 43691, v15
    v_lshrrev_b32 v13, 23, v13
    v_mul_u32_u24 v14, 64, v13
    v_add_u32 v14, v14, v12
    s_mov_b32 s45, 0
    s_mov_b32 s46, 360448
    buffer_load_dwordx4 v[80:83], v12, s[32:35], s46 offen sc0 sc1
    s_mov_b32 s46, 376832
    buffer_load_dwordx4 v[84:87], v12, s[32:35], s46 offen sc0 sc1
    s_sleep 10
L_pc_7:
    s_mov_b32 s46, 360448
    buffer_load_dwordx4 v[96:99], v12, s[32:35], s46 offen sc0 sc1
    s_mov_b32 s46, 376832
    buffer_load_dwordx4 v[100:103], v12, s[32:35], s46 offen sc0 sc1
    s_waitcnt vmcnt(2)
    v_max_u32 v15, v80, v81
    v_max3_u32 v15, v15, v82, v83
    v_max3_u32 v15, v15, v84, v85
    v_max3_u32 v15, v15, v86, v87
    v_cmp_eq_u32 vcc, -1, v15
    s_cbranch_vccz L_pc_7_a
    s_mov_b32 s46, 360448
    buffer_load_dwordx4 v[80:83], v12, s[32:35], s46 offen sc0 sc1
    s_mov_b32 s46, 376832
    buffer_load_dwordx4 v[84:87], v12, s[32:35], s46 offen sc0 sc1
    s_waitcnt vmcnt(2)
    v_max_u32 v15, v96, v97
    v_max3_u32 v15, v15, v98, v99
    v_max3_u32 v15, v15, v100, v101
    v_max3_u32 v15, v15, v102, v103
    v_cmp_eq_u32 vcc, -1, v15
    s_cbranch_vccz L_pc_7_b
    s_add_u32 s45, s45, 1
    s_cmp_lt_u32 s45, 0x20000
    s_cbranch_scc1 L_pc_7
L_pc_7_b:
    v_lshlrev_b32 v24, 16, v96
    v_and_b32 v25, 0xffff0000, v96
    v_lshlrev_b32 v26, 16, v100
    v_and_b32 v27, 0xffff0000, v100
    v_mul_f32 v24, v24, v26
    v_mul_f32 v25, v25, v27
    v_cvt_pk_bf16_f32 v32, v24, v25
    v_lshlrev_b32 v24, 16, v97
    v_and_b32 v25, 0xffff0000, v97
    v_lshlrev_b32 v26, 16, v101
    v_and_b32 v27, 0xffff0000, v101
    v_mul_f32 v24, v24, v26
    v_mul_f32 v25, v25, v27
    v_cvt_pk_bf16_f32 v33, v24, v25
    v_lshlrev_b32 v24, 16, v98
    v_and_b32 v25, 0xffff0000, v98
    v_lshlrev_b32 v26, 16, v102
    v_and_b32 v27, 0xffff0000, v102
    v_mul_f32 v24, v24, v26
    v_mul_f32 v25, v25, v27
    v_cvt_pk_bf16_f32 v34, v24, v25
    v_lshlrev_b32 v24, 16, v99
    v_and_b32 v25, 0xffff0000, v99
    v_lshlrev_b32 v26, 16, v103
    v_and_b32 v27, 0xffff0000, v103
    v_mul_f32 v24, v24, v26
    v_mul_f32 v25, v25, v27
    v_cvt_pk_bf16_f32 v35, v24, v25
    s_branch L_pc_7_e
L_pc_7_a:
    v_lshlrev_b32 v24, 16, v80
    v_and_b32 v25, 0xffff0000, v80
    v_lshlrev_b32 v26, 16, v84
    v_and_b32 v27, 0xffff0000, v84
    v_mul_f32 v24, v24, v26
    v_mul_f32 v25, v25, v27
    v_cvt_pk_bf16_f32 v32, v24, v25
    v_lshlrev_b32 v24, 16, v81
    v_and_b32 v25, 0xffff0000, v81
    v_lshlrev_b32 v26, 16, v85
    v_and_b32 v27, 0xffff0000, v85
    v_mul_f32 v24, v24, v26
    v_mul_f32 v25, v25, v27
    v_cvt_pk_bf16_f32 v33, v24, v25
    v_lshlrev_b32 v24, 16, v82
    v_and_b32 v25, 0xffff0000, v82
    v_lshlrev_b32 v26, 16, v86
    v_and_b32 v27, 0xffff0000, v86
    v_mul_f32 v24, v24, v26
    v_mul_f32 v25, v25, v27
    v_cvt_pk_bf16_f32 v34, v24, v25
    v_lshlrev_b32 v24, 16, v83
    v_and_b32 v25, 0xffff0000, v83
    v_lshlrev_b32 v26, 16, v87
    v_and_b32 v27, 0xffff0000, v87
    v_mul_f32 v24, v24, v26
    v_mul_f32 v25, v25, v27
    v_cvt_pk_bf16_f32 v35, v24, v25
L_pc_7_e:
    ds_write_b128 v14, v[32:35] offset:29952
L_e_wait:
    s_waitcnt lgkmcnt(0)
    s_barrier
    s_lshr_b32 s48, s53, 1
    s_mul_i32 s50, s48, 384
    s_add_u32 s50, s50, 29952
    v_add_u32 v12, s50, v8
    ds_read_b128 v[16:19], v12 offset:0
    ds_read_b128 v[20:23], v12 offset:64
    ds_read_b128 v[24:27], v12 offset:128
    ds_read_b128 v[28:31], v12 offset:192
    ds_read_b128 v[32:35], v12 offset:256
    ds_read_b128 v[36:39], v12 offset:320
    s_waitcnt lgkmcnt(5)
    v_mfma_f32_16x16x32_bf16 v[64:67], v[16:19], v[40:43], 0
    s_waitcnt lgkmcnt(4)
    v_mfma_f32_16x16x32_bf16 v[64:67], v[20:23], v[44:47], v[64:67]
    s_waitcnt lgkmcnt(3)
    v_mfma_f32_16x16x32_bf16 v[64:67], v[24:27], v[48:51], v[64:67]
    s_waitcnt lgkmcnt(2)
    v_mfma_f32_16x16x32_bf16 v[64:67], v[28:31], v[52:55], v[64:67]
    s_waitcnt lgkmcnt(1)
    v_mfma_f32_16x16x32_bf16 v[64:67], v[32:35], v[56:59], v[64:67]
    s_waitcnt lgkmcnt(0)
    v_mfma_f32_16x16x32_bf16 v[64:67], v[36:39], v[60:63], v[64:67]
    s_nop 15
    s_lshr_b32 s48, s53, 1
    s_and_b32 s49, s53, 1
    s_mul_i32 s48, s48, 512
    s_lshl_b32 s49, s49, 6
    s_add_u32 s48, s48, s49
    v_lshlrev_b32 v12, 2, v6
    v_add_u32 v12, s48, v12
    s_mov_b64 exec, 0xffff
    ds_write_b32 v12, v64 offset:13824
    ds_write_b32 v12, v65 offset:13952
    ds_write_b32 v12, v66 offset:14080
    ds_write_b32 v12, v67 offset:14208
    s_mov_b64 exec, -1
    s_waitcnt lgkmcnt(0)
    s_barrier
    s_cmp_ge_u32 s53, 2
    s_cbranch_scc1 L_done
    v_lshlrev_b32 v12, 2, v0
    ds_read_b32 v16, v12 offset:13824
    ds_read_b32 v17, v12 offset:14336
    ds_read_b32 v18, v12 offset:14848
    ds_read_b32 v19, v12 offset:15360
    ds_read_b32 v20, v12 offset:15872
    ds_read_b32 v21, v12 offset:16384
    ds_read_b32 v22, v12 offset:16896
    ds_read_b32 v23, v12 offset:17408
    s_waitcnt lgkmcnt(0)
    v_add_f32 v16, v16, v20
    v_add_f32 v17, v17, v21
    v_add_f32 v18, v18, v22
    v_add_f32 v19, v19, v23
    v_add_f32 v16, v16, v18
    v_add_f32 v17, v17, v19
    v_add_f32 v16, v16, v17
    v_cvt_pk_bf16_f32 v16, v16, v16
    v_lshlrev_b32 v16, 16, v16
    v_mul_f32 v16, v16, v72
    v_cvt_pk_bf16_f32 v16, v16, v16
    v_lshlrev_b32 v16, 16, v16
    v_add_f32 v16, v70, v16
    v_cvt_pk_bf16_f32 v16, v16, v16
    v_lshlrev_b32 v16, 16, v16
    v_add_f32 v16, v71, v16
    v_cvt_pk_bf16_f32 v16, v16, v16
    buffer_store_short v16, v73, s[76:79], 0 offen
    s_endpgm
L_tail_d:
    v_and_b32 v12, 15, v6
    v_min_u32 v12, 4, v12
    v_mul_u32_u24 v8, 1344, v12
    v_and_b32 v12, 3, v6
    v_lshlrev_b32 v9, 3, v12
    v_lshrrev_b32 v12, 4, v6
    v_lshl_add_u32 v8, v12, 4, v8
    v_mul_u32_u24 v12, 1024, v12
    v_add_u32 v9, v9, v12
    v_bfe_u32 v12, v6, 2, 2
    v_mul_u32_u24 v12, 128, v12
    v_add_u32 v9, v9, v12
    v_cmp_gt_u32 vcc, 320, v0
    s_and_saveexec_b64 s[100:101], vcc
    v_lshlrev_b32 v12, 2, v0
    v_mov_b32 v13, 0x3f803f80
    ds_write_b32 v12, v13 offset:24320
    s_mov_b64 exec, s[100:101]
    s_waitcnt vmcnt(0) lgkmcnt(0)
    s_barrier
    s_lshr_b32 s48, s53, 2
    s_and_b32 s49, s53, 3
    s_mul_i32 s50, s48, 20480
    s_lshl_b32 s49, s49, 5
    s_add_u32 s50, s50, s49
    s_add_u32 s50, s50, 42496
    v_add_u32 v13, s50, v9
    ds_read_b64_tr_b16 v[16:17], v13 offset:0
    ds_read_b64_tr_b16 v[18:19], v13 offset:512
    ds_read_b64_tr_b16 v[20:21], v13 offset:4096
    ds_read_b64_tr_b16 v[22:23], v13 offset:4608
    ds_read_b64_tr_b16 v[24:25], v13 offset:8192
    ds_read_b64_tr_b16 v[26:27], v13 offset:8704
    ds_read_b64_tr_b16 v[28:29], v13 offset:12288
    ds_read_b64_tr_b16 v[30:31], v13 offset:12800
    ds_read_b64_tr_b16 v[32:33], v13 offset:16384
    ds_read_b64_tr_b16 v[34:35], v13 offset:16896
    s_min_u32 s48, s53, 9
    s_lshl_b32 s48, s48, 8
    v_lshlrev_b32 v57, 2, v6
    v_add_u32 v57, s48, v57
    v_lshlrev_b32 v58, 1, v57
    buffer_load_dwordx2 v[48:49], v58, s[56:59], 0 offen
    v_lshrrev_b32 v60, 7, v57
    v_lshlrev_b32 v63, 3, v60
    v_mul_u32_u24 v60, 52, v60
    v_lshrrev_b32 v60, 8, v60
    v_mul_u32_u24 v62, 64, v60
    v_add_u32 v62, v62, v58
    v_lshlrev_b32 v59, 2, v57
    s_waitcnt vmcnt(0)
    v_and_b32 v51, 0xffff0000, v49
    v_lshlrev_b32 v50, 16, v49
    v_and_b32 v49, 0xffff0000, v48
    v_lshlrev_b32 v48, 16, v48
    s_cmp_lg_u32 s53, 0
    s_cbranch_scc1 L_d_gate_done
    s_lshl_b32 s44, s2, 7
    s_add_u32 s44, s44, 458752
    v_mov_b32 v122, 0
    s_mov_b32 s45, 0
    buffer_load_dword v123, v122, s[32:35], s44 offen sc0 sc1
L_gate_8:
    s_sleep 6
    buffer_load_dword v124, v122, s[32:35], s44 offen sc0 sc1
    s_waitcnt vmcnt(1)
    v_cmp_ne_u32 vcc, 1, v123
    s_cbranch_vccz L_gate_8_ok
    s_sleep 6
    buffer_load_dword v123, v122, s[32:35], s44 offen sc0 sc1
    s_waitcnt vmcnt(1)
    v_cmp_ne_u32 vcc, 1, v124
    s_add_u32 s45, s45, 1
    s_cbranch_vccz L_gate_8_ok
    s_cmp_lt_u32 s45, 0x20000
    s_cbranch_scc1 L_gate_8
L_gate_8_ok:
L_d_gate_done:
    s_barrier
    s_cmp_ge_u32 s53, 10
    s_cbranch_scc1 L_d10_skip
    s_mov_b32 s45, 0
    s_mov_b32 s44, 262144
    buffer_load_dwordx4 v[64:67], v59, s[32:35], s44 offen sc0 sc1
    s_add_u32 s44, s44, 10240
    buffer_load_dwordx4 v[68:71], v59, s[32:35], s44 offen sc0 sc1
    s_add_u32 s44, s44, 10240
    buffer_load_dwordx4 v[72:75], v59, s[32:35], s44 offen sc0 sc1
    s_add_u32 s44, s44, 10240
    buffer_load_dwordx4 v[76:79], v59, s[32:35], s44 offen sc0 sc1
    s_add_u32 s44, s44, 10240
    buffer_load_dwordx4 v[80:83], v59, s[32:35], s44 offen sc0 sc1
    s_add_u32 s44, s44, 10240
    buffer_load_dwordx4 v[84:87], v59, s[32:35], s44 offen sc0 sc1
    s_add_u32 s44, s44, 10240
    buffer_load_dwordx4 v[88:91], v59, s[32:35], s44 offen sc0 sc1
    s_add_u32 s44, s44, 10240
    buffer_load_dwordx4 v[92:95], v59, s[32:35], s44 offen sc0 sc1
    s_sleep 10
L_pc_9:
    s_mov_b32 s44, 262144
    buffer_load_dwordx4 v[96:99], v59, s[32:35], s44 offen sc0 sc1
    s_add_u32 s44, s44, 10240
    buffer_load_dwordx4 v[100:103], v59, s[32:35], s44 offen sc0 sc1
    s_add_u32 s44, s44, 10240
    buffer_load_dwordx4 v[104:107], v59, s[32:35], s44 offen sc0 sc1
    s_add_u32 s44, s44, 10240
    buffer_load_dwordx4 v[108:111], v59, s[32:35], s44 offen sc0 sc1
    s_add_u32 s44, s44, 10240
    buffer_load_dwordx4 v[112:115], v59, s[32:35], s44 offen sc0 sc1
    s_add_u32 s44, s44, 10240
    buffer_load_dwordx4 v[116:119], v59, s[32:35], s44 offen sc0 sc1
    s_add_u32 s44, s44, 10240
    buffer_load_dwordx4 v[120:123], v59, s[32:35], s44 offen sc0 sc1
    s_add_u32 s44, s44, 10240
    buffer_load_dwordx4 v[124:127], v59, s[32:35], s44 offen sc0 sc1
    s_waitcnt vmcnt(8)
    v_max_u32 v60, v64, v65
    v_max3_u32 v60, v60, v66, v67
    v_max3_u32 v60, v60, v68, v69
    v_max3_u32 v60, v60, v70, v71
    v_max3_u32 v60, v60, v72, v73
    v_max3_u32 v60, v60, v74, v75
    v_max3_u32 v60, v60, v76, v77
    v_max3_u32 v60, v60, v78, v79
    v_max3_u32 v60, v60, v80, v81
    v_max3_u32 v60, v60, v82, v83
    v_max3_u32 v60, v60, v84, v85
    v_max3_u32 v60, v60, v86, v87
    v_max3_u32 v60, v60, v88, v89
    v_max3_u32 v60, v60, v90, v91
    v_max3_u32 v60, v60, v92, v93
    v_max3_u32 v60, v60, v94, v95
    v_cmp_eq_u32 vcc, -1, v60
    s_cbranch_vccz L_pc_9_a
    s_mov_b32 s44, 262144
    buffer_load_dwordx4 v[64:67], v59, s[32:35], s44 offen sc0 sc1
    s_add_u32 s44, s44, 10240
    buffer_load_dwordx4 v[68:71], v59, s[32:35], s44 offen sc0 sc1
    s_add_u32 s44, s44, 10240
    buffer_load_dwordx4 v[72:75], v59, s[32:35], s44 offen sc0 sc1
    s_add_u32 s44, s44, 10240
    buffer_load_dwordx4 v[76:79], v59, s[32:35], s44 offen sc0 sc1
    s_add_u32 s44, s44, 10240
    buffer_load_dwordx4 v[80:83], v59, s[32:35], s44 offen sc0 sc1
    s_add_u32 s44, s44, 10240
    buffer_load_dwordx4 v[84:87], v59, s[32:35], s44 offen sc0 sc1
    s_add_u32 s44, s44, 10240
    buffer_load_dwordx4 v[88:91], v59, s[32:35], s44 offen sc0 sc1
    s_add_u32 s44, s44, 10240
    buffer_load_dwordx4 v[92:95], v59, s[32:35], s44 offen sc0 sc1
    s_waitcnt vmcnt(8)
    v_max_u32 v60, v96, v97
    v_max3_u32 v60, v60, v98, v99
    v_max3_u32 v60, v60, v100, v101
    v_max3_u32 v60, v60, v102, v103
    v_max3_u32 v60, v60, v104, v105
    v_max3_u32 v60, v60, v106, v107
    v_max3_u32 v60, v60, v108, v109
    v_max3_u32 v60, v60, v110, v111
    v_max3_u32 v60, v60, v112, v113
    v_max3_u32 v60, v60, v114, v115
    v_max3_u32 v60, v60, v116, v117
    v_max3_u32 v60, v60, v118, v119
    v_max3_u32 v60, v60, v120, v121
    v_max3_u32 v60, v60, v122, v123
    v_max3_u32 v60, v60, v124, v125
    v_max3_u32 v60, v60, v126, v127
    v_cmp_eq_u32 vcc, -1, v60
    s_cbranch_vccz L_pc_9_b
    s_add_u32 s45, s45, 1
    s_cmp_lt_u32 s45, 0x20000
    s_cbranch_scc1 L_pc_9
L_pc_9_b:
    v_add_f32 v96, v96, v112
    v_add_f32 v100, v100, v116
    v_add_f32 v104, v104, v120
    v_add_f32 v108, v108, v124
    v_add_f32 v97, v97, v113
    v_add_f32 v101, v101, v117
    v_add_f32 v105, v105, v121
    v_add_f32 v109, v109, v125
    v_add_f32 v98, v98, v114
    v_add_f32 v102, v102, v118
    v_add_f32 v106, v106, v122
    v_add_f32 v110, v110, v126
    v_add_f32 v99, v99, v115
    v_add_f32 v103, v103, v119
    v_add_f32 v107, v107, v123
    v_add_f32 v111, v111, v127
    v_add_f32 v96, v96, v100
    v_add_f32 v104, v104, v108
    v_add_f32 v97, v97, v101
    v_add_f32 v105, v105, v109
    v_add_f32 v98, v98, v102
    v_add_f32 v106, v106, v110
    v_add_f32 v99, v99, v103
    v_add_f32 v107, v107, v111
    v_add_f32 v52, v96, v104
    v_add_f32 v53, v97, v105
    v_add_f32 v54, v98, v106
    v_add_f32 v55, v99, v107
    s_branch L_pc_9_e
L_pc_9_a:
    v_add_f32 v64, v64, v80
    v_add_f32 v68, v68, v84
    v_add_f32 v72, v72, v88
    v_add_f32 v76, v76, v92
    v_add_f32 v65, v65, v81
    v_add_f32 v69, v69, v85
    v_add_f32 v73, v73, v89
    v_add_f32 v77, v77, v93
    v_add_f32 v66, v66, v82
    v_add_f32 v70, v70, v86
    v_add_f32 v74, v74, v90
    v_add_f32 v78, v78, v94
    v_add_f32 v67, v67, v83
    v_add_f32 v71, v71, v87
    v_add_f32 v75, v75, v91
    v_add_f32 v79, v79, v95
    v_add_f32 v64, v64, v68
    v_add_f32 v72, v72, v76
    v_add_f32 v65, v65, v69
    v_add_f32 v73, v73, v77
    v_add_f32 v66, v66, v70
    v_add_f32 v74, v74, v78
    v_add_f32 v67, v67, v71
    v_add_f32 v75, v75, v79
    v_add_f32 v52, v64, v72
    v_add_f32 v53, v65, v73
    v_add_f32 v54, v66, v74
    v_add_f32 v55, v67, v75
L_pc_9_e:
    v_cvt_pk_bf16_f32 v52, v52, v52
    v_lshlrev_b32 v52, 16, v52
    v_cvt_pk_bf16_f32 v53, v53, v53
    v_lshlrev_b32 v53, 16, v53
    v_cvt_pk_bf16_f32 v54, v54, v54
    v_lshlrev_b32 v54, 16, v54
    v_cvt_pk_bf16_f32 v55, v55, v55
    v_lshlrev_b32 v55, 16, v55
    v_add_f32 v52, v52, v48
    v_add_f32 v53, v53, v49
    v_add_f32 v54, v54, v50
    v_add_f32 v55, v55, v51
    v_cvt_pk_bf16_f32 v60, v52, v53
    v_cvt_pk_bf16_f32 v61, v54, v55
    ds_write_b64 v62, v[60:61] offset:18944
    s_mov_b32 vcc_lo, 0
    s_mov_b32 vcc_hi, -1
    v_lshlrev_b32 v52, 16, v60
    v_and_b32 v53, 0xffff0000, v60
    v_lshlrev_b32 v54, 16, v61
    v_and_b32 v55, 0xffff0000, v61
    v_add_f32 v58, v52, v53
    v_add_f32 v59, v54, v55
    v_add_f32 v58, v58, v59
    s_nop 1
    v_add_f32_dpp v58, v58, v58 quad_perm:[1,0,3,2] row_mask:0xf bank_mask:0xf
    s_nop 1
    v_add_f32_dpp v58, v58, v58 quad_perm:[2,3,0,1] row_mask:0xf bank_mask:0xf
    s_nop 1
    v_add_f32_dpp v58, v58, v58 row_half_mirror row_mask:0xf bank_mask:0xf
    s_nop 1
    v_add_f32_dpp v58, v58, v58 row_mirror row_mask:0xf bank_mask:0xf
    s_nop 1
    v_add_f32_dpp v58, v58, v58 row_bcast:15 row_mask:0xa bank_mask:0xf
    s_nop 1
    v_readlane_b32 s44, v58, 16
    v_readlane_b32 s45, v58, 48
    s_nop 1
    v_mov_b32 v58, s44
    v_mov_b32 v60, s45
    v_cndmask_b32 v58, v58, v60, vcc
    v_mul_f32 v58, 0x3c000000, v58
    v_sub_f32 v60, v52, v58
    v_mul_f32 v59, v60, v60
    v_sub_f32 v60, v53, v58
    v_fmac_f32 v59, v60, v60
    v_sub_f32 v60, v54, v58
    v_fmac_f32 v59, v60, v60
    v_sub_f32 v60, v55, v58
    v_fmac_f32 v59, v60, v60
    s_nop 1
    v_add_f32_dpp v59, v59, v59 quad_perm:[1,0,3,2] row_mask:0xf bank_mask:0xf
    s_nop 1
    v_add_f32_dpp v59, v59, v59 quad_perm:[2,3,0,1] row_mask:0xf bank_mask:0xf
    s_nop 1
    v_add_f32_dpp v59, v59, v59 row_half_mirror row_mask:0xf bank_mask:0xf
    s_nop 1
    v_add_f32_dpp v59, v59, v59 row_mirror row_mask:0xf bank_mask:0xf
    s_nop 1
    v_add_f32_dpp v59, v59, v59 row_bcast:15 row_mask:0xa bank_mask:0xf
    s_nop 1
    v_readlane_b32 s44, v59, 16
    v_readlane_b32 s45, v59, 48
    s_nop 1
    v_mov_b32 v59, s44
    v_mov_b32 v60, s45
    v_cndmask_b32 v59, v59, v60, vcc
    ds_write_b64 v63, v[58:59] offset:29696
L_d10_skip:
    s_waitcnt lgkmcnt(0)
    s_barrier
    s_lshr_b32 s48, s53, 2
    s_mul_i32 s50, s48, 320
    s_add_u32 s50, s50, 18944
    v_add_u32 v12, s50, v8
    s_cmp_ge_u32 s53, 4
    s_cbranch_scc1 L_d_h1
    s_mul_i32 s49, s53, 40
    v_mov_b32 v60, s49
    ds_read_b64 v[2:3], v60 offset:29696
    ds_read_b64 v[4:5], v60 offset:29704
    ds_read_b64 v[10:11], v60 offset:29712
    ds_read_b64 v[14:15], v60 offset:29720
    ds_read_b64 v[62:63], v60 offset:29728
L_d_h1:
    ds_read_b128 v[36:39], v12 offset:0
    ds_read_b128 v[40:43], v12 offset:64
    ds_read_b128 v[44:47], v12 offset:128
    ds_read_b128 v[48:51], v12 offset:192
    ds_read_b128 v[52:55], v12 offset:256
    s_cmp_ge_u32 s53, 4
    s_cbranch_scc1 L_d_h2
    s_waitcnt lgkmcnt(5)
    v_add_f32 v1, v2, v4
    v_add_f32 v12, v10, v14
    v_add_f32 v1, v1, v12
    v_add_f32 v1, v1, v62
    v_mul_f32 v60, 0x3e4ccccd, v1
    v_add_f32 v12, v3, v5
    v_add_f32 v13, v11, v15
    v_add_f32 v12, v12, v13
    v_add_f32 v12, v12, v63
    v_sub_f32 v2, v2, v60
    v_sub_f32 v4, v4, v60
    v_sub_f32 v10, v10, v60
    v_sub_f32 v14, v14, v60
    v_sub_f32 v62, v62, v60
    v_mul_f32 v13, v2, v2
    v_fmac_f32 v13, v4, v4
    v_fmac_f32 v13, v10, v10
    v_fmac_f32 v13, v14, v14
    v_fmac_f32 v13, v62, v62
    v_mov_b32 v1, 0x43000000
    v_fmac_f32 v12, v13, v1
    v_mul_f32 v61, 0x3acccccd, v12
    v_cvt_pk_bf16_f32 v60, v60, v60
    v_lshlrev_b32 v60, 16, v60
    v_cvt_pk_bf16_f32 v61, v61, v61
    v_lshlrev_b32 v61, 16, v61
    v_add_f32 v61, 0x3727c5ac, v61
    v_cvt_pk_bf16_f32 v61, v61, v61
    v_lshlrev_b32 v61, 16, v61
    v_sqrt_f32 v61, v61
    s_nop 0
    v_cvt_pk_bf16_f32 v61, v61, v61
    v_lshlrev_b32 v61, 16, v61
    v_rcp_f32 v61, v61
L_d_h2:
    s_waitcnt lgkmcnt(4)
    v_mfma_f32_16x16x32_bf16 v[56:59], v[36:39], v[16:19], 0
    s_waitcnt lgkmcnt(3)
    v_mfma_f32_16x16x32_bf16 v[56:59], v[40:43], v[20:23], v[56:59]
    s_waitcnt lgkmcnt(2)
    v_mfma_f32_16x16x32_bf16 v[56:59], v[44:47], v[24:27], v[56:59]
    s_waitcnt lgkmcnt(1)
    v_mfma_f32_16x16x32_bf16 v[56:59], v[48:51], v[28:31], v[56:59]
    s_waitcnt lgkmcnt(0)
    v_mfma_f32_16x16x32_bf16 v[56:59], v[52:55], v[32:35], v[56:59]
    s_nop 15
    s_lshr_b32 s48, s53, 2
    s_and_b32 s49, s53, 3
    s_mul_i32 s48, s48, 1280
    s_lshl_b32 s49, s49, 6
    s_add_u32 s48, s48, s49
    v_lshlrev_b32 v12, 2, v6
    v_add_u32 v12, s48, v12
    s_mov_b64 exec, 0xffff
    ds_write_b32 v12, v56 offset:13824
    ds_write_b32 v12, v57 offset:14080
    ds_write_b32 v12, v58 offset:14336
    ds_write_b32 v12, v59 offset:14592
    s_mov_b64 exec, 0xffff0000
    ds_write_b32 v12, v56 offset:14784
    s_mov_b64 exec, -1
    s_waitcnt lgkmcnt(0)
    s_barrier
    s_cmp_ge_u32 s53, 4
    s_cbranch_scc1 L_done
    v_lshlrev_b32 v12, 2, v0
    v_lshlrev_b32 v13, 2, v6
    ds_read_b32 v16, v12 offset:13824
    ds_read_b32 v17, v12 offset:15104
    ds_read_b32 v18, v12 offset:16384
    ds_read_b32 v19, v12 offset:17664
    ds_read_b32 v20, v13 offset:14848
    ds_read_b32 v21, v13 offset:16128
    ds_read_b32 v22, v13 offset:17408
    ds_read_b32 v23, v13 offset:18688
    s_waitcnt lgkmcnt(0)
    v_add_f32 v16, v16, v17
    v_add_f32 v20, v20, v21
    v_add_f32 v18, v18, v19
    v_add_f32 v22, v22, v23
    v_add_f32 v16, v16, v18
    v_add_f32 v20, v20, v22
    v_fma_f32 v16, -v60, v20, v16
    v_mul_f32 v16, v16, v61
    s_cmp_lg_u32 s54, 0
    s_cbranch_scc1 L_d_nosilu
    v_cvt_pk_bf16_f32 v16, v16, v16
    v_lshlrev_b32 v16, 16, v16
    v_mul_f32 v18, 0xbfb8aa3b, v16
    v_exp_f32 v18, v18
    s_nop 0
    v_add_f32 v18, 1.0, v18
    v_rcp_f32 v18, v18
    s_nop 0
    v_mul_f32 v16, v16, v18
L_d_nosilu:
    s_nop 1
    v_mov_b32_dpp v17, v16 quad_perm:[1,0,3,2] row_mask:0xf bank_mask:0xf
    v_cvt_pk_bf16_f32 v16, v16, v17
    v_mul_u32_u24 v12, 3072, v7
    v_lshl_add_u32 v12, v6, 1, v12
    s_mul_i32 s48, s54, 16384
    s_lshl_b32 s49, s55, 7
    s_add_u32 s48, s48, s49
    s_add_u32 s48, s48, 360448
    s_mov_b32 exec_lo, 0x55555555
    s_mov_b32 exec_hi, 0x55555555
    buffer_store_dword v16, v12, s[32:35], s48 offen sc0 sc1
    s_mov_b64 exec, -1
L_done:
    s_endpgm
.section .rodata,"a"
.p2align 6
.amdhsa_kernel sequential_preLN__mha_block_cached__moe_arch_mod__decode_kernel
  .amdhsa_next_free_vgpr 128
  .amdhsa_next_free_sgpr 102
  .amdhsa_accum_offset 128
  .amdhsa_group_segment_fixed_size 0
  .amdhsa_kernarg_size 104
  .amdhsa_user_sgpr_count 2
  .amdhsa_user_sgpr_kernarg_segment_ptr 1
  .amdhsa_system_sgpr_workgroup_id_x 1
.end_amdhsa_kernel
```

```asm
; @launch grid=(256,1,1) block=(1024,1,1) lds=140800
.amdgcn_target "amdgcn-amd-amdhsa--gfx950"
.text
.globl sequential_preLN__mha_block_cached__moe_arch_mod__decode_kernel
.p2align 8
.type sequential_preLN__mha_block_cached__moe_arch_mod__decode_kernel,@function
sequential_preLN__mha_block_cached__moe_arch_mod__decode_kernel:
    s_cmp_ge_u32 s2, 256
    s_cbranch_scc1 L_done
    s_load_dwordx2 s[4:5], s[0:1], 0
    s_load_dwordx4 s[8:11], s[0:1], 8
    s_load_dwordx4 s[12:15], s[0:1], 24
    s_load_dwordx4 s[80:83], s[0:1], 48
    s_load_dwordx4 s[84:87], s[0:1], 64
    s_load_dwordx4 s[88:91], s[0:1], 80
    s_load_dwordx2 s[6:7], s[0:1], 96
    s_and_b32 s42, s2, 7
    s_lshr_b32 s43, s2, 3
    s_and_b32 s44, s43, 3
    s_lshl_b32 s45, s42, 2
    s_add_u32 s45, s45, s44
    s_lshr_b32 s44, s43, 2
    s_lshr_b32 s46, s44, 1
    s_and_b32 s47, s44, 1
    s_lshl_b32 s40, s46, 5
    s_add_u32 s40, s40, s45
    s_lshl_b32 s40, s40, 1
    s_add_u32 s40, s40, s47
    s_mul_i32 s41, s40, 1572864
    s_lshr_b32 s99, s45, 3
    s_mov_b32 s96, 1572864
    v_and_b32 v6, 63, v0
    v_lshrrev_b32 v2, 6, v0
    v_lshrrev_b32 v3, 3, v6
    v_and_b32 v4, 7, v6
    v_readfirstlane_b32 s53, v2
    v_lshlrev_b32 v4, 4, v4
    v_mul_u32_u24 v5, 384, v3
    v_add_u32 v1, v5, v4
    v_mul_u32_u24 v5, 40, v2
    v_add_u32 v5, v5, v3
    v_mul_u32_u24 v7, 12288, v5
    v_add_u32 v7, v7, v4
    v_lshlrev_b32 v8, 1, v5
    v_lshlrev_b32 v5, 2, v6
    s_waitcnt lgkmcnt(0)
    s_mov_b32 s56, s4
    s_and_b32 s57, s5, 0xffff
    s_mov_b32 s58, 0x1400
    s_mov_b32 s59, 0x00020000
    s_mul_i32 s48, s46, 1280
    s_add_u32 s4, s4, s48
    s_addc_u32 s5, s5, 0
    s_mov_b32 s28, s4
    s_and_b32 s29, s5, 0xffff
    s_mov_b32 s30, 0x500
    s_mov_b32 s31, 0x00020000
    s_mul_i32 s48, s45, 384
    s_add_u32 s12, s12, s48
    s_addc_u32 s13, s13, 0
    s_sub_u32 s49, 7864320, s48
    s_mov_b32 s24, s12
    s_and_b32 s25, s13, 0xffff
    s_mov_b32 s26, s49
    s_mov_b32 s27, 0x00020000
    s_add_u32 s8, s8, s41
    s_addc_u32 s9, s9, 0
    s_mov_b32 s16, s8
    s_and_b32 s17, s9, 0xffff
    s_mov_b32 s18, s96
    s_mov_b32 s19, 0x00020000
    s_mov_b32 s99, s41
    v_mov_b32 v3, 12928
    v_mov_b32 v4, 16
    ds_write_b32 v3, v4
    s_mul_i32 s41, s53, 24576
    buffer_load_dword v46, v5, s[28:31], 0 offen offset:0
    buffer_load_dword v47, v5, s[28:31], 0 offen offset:256
    buffer_load_dword v48, v5, s[28:31], 0 offen offset:512
    buffer_load_dword v49, v5, s[28:31], 0 offen offset:768
    buffer_load_dword v50, v5, s[28:31], 0 offen offset:1024
    buffer_load_ushort v51, v8, s[28:31], 0 offen offset:0
    buffer_load_ushort v52, v8, s[28:31], 0 offen offset:16
    buffer_load_ushort v53, v8, s[28:31], 0 offen offset:32
    buffer_load_ushort v126, v8, s[28:31], 0 offen offset:48
    buffer_load_ushort v127, v8, s[28:31], 0 offen offset:64
    s_mov_b32 s48, 0
    buffer_load_dwordx4 v[102:105], v7, s[24:27], s48 offen offset:0 nt
    buffer_load_dwordx4 v[106:109], v7, s[24:27], s48 offen offset:128 nt
    buffer_load_dwordx4 v[110:113], v7, s[24:27], s48 offen offset:256 nt
    s_mov_b32 s48, 98304
    buffer_load_dwordx4 v[114:117], v7, s[24:27], s48 offen offset:0 nt
    buffer_load_dwordx4 v[118:121], v7, s[24:27], s48 offen offset:128 nt
    buffer_load_dwordx4 v[122:125], v7, s[24:27], s48 offen offset:256 nt
    s_add_u32 s48, s41, 0
    buffer_load_dwordx4 v[78:81], v1, s[16:19], s48 offen offset:0 nt
    buffer_load_dwordx4 v[82:85], v1, s[16:19], s48 offen offset:128 nt
    buffer_load_dwordx4 v[86:89], v1, s[16:19], s48 offen offset:256 nt
    s_mov_b32 s48, 196608
    buffer_load_dwordx4 v[10:13], v7, s[24:27], s48 offen offset:0 nt
    buffer_load_dwordx4 v[14:17], v7, s[24:27], s48 offen offset:128 nt
    buffer_load_dwordx4 v[18:21], v7, s[24:27], s48 offen offset:256 nt
    s_add_u32 s48, s41, 3072
    buffer_load_dwordx4 v[90:93], v1, s[16:19], s48 offen offset:0 nt
    buffer_load_dwordx4 v[94:97], v1, s[16:19], s48 offen offset:128 nt
    buffer_load_dwordx4 v[98:101], v1, s[16:19], s48 offen offset:256 nt
    s_mov_b32 s48, 294912
    buffer_load_dwordx4 v[22:25], v7, s[24:27], s48 offen offset:0 nt
    buffer_load_dwordx4 v[26:29], v7, s[24:27], s48 offen offset:128 nt
    buffer_load_dwordx4 v[30:33], v7, s[24:27], s48 offen offset:256 nt
    s_mov_b32 s48, 393216
    buffer_load_dwordx4 v[34:37], v7, s[24:27], s48 offen offset:0 nt
    buffer_load_dwordx4 v[38:41], v7, s[24:27], s48 offen offset:128 nt
    buffer_load_dwordx4 v[42:45], v7, s[24:27], s48 offen offset:256 nt
    s_add_u32 s10, s10, s99
    s_addc_u32 s11, s11, 0
    s_mov_b32 s20, s10
    s_and_b32 s21, s11, 0xffff
    s_mov_b32 s22, s96
    s_mov_b32 s23, 0x00020000
    s_mov_b32 s32, s6
    s_and_b32 s33, s7, 0xffff
    s_mov_b32 s34, 0x200000
    s_mov_b32 s35, 0x00020000
    s_mov_b32 s36, s90
    s_and_b32 s37, s91, 0xffff
    s_mov_b32 s38, 0x100
    s_mov_b32 s39, 0x00020000
    s_mov_b32 s60, s14
    s_and_b32 s61, s15, 0xffff
    s_mov_b32 s62, 0x780000
    s_mov_b32 s63, 0x00020000
    s_mov_b32 s64, s82
    s_and_b32 s65, s83, 0xffff
    s_mov_b32 s66, 0x1e0000
    s_mov_b32 s67, 0x00020000
    s_mov_b32 s92, s84
    s_and_b32 s93, s85, 0xffff
    s_mov_b32 s94, 0x1e0000
    s_mov_b32 s95, 0x00020000
    s_mov_b32 s68, s86
    s_and_b32 s69, s87, 0xffff
    s_mov_b32 s70, 0x1e0000
    s_mov_b32 s71, 0x00020000
    s_mov_b32 s72, s80
    s_and_b32 s73, s81, 0xffff
    s_mov_b32 s74, 0x500
    s_mov_b32 s75, 0x00020000
    s_mov_b32 s76, s88
    s_and_b32 s77, s89, 0xffff
    s_mov_b32 s78, 0x1400
    s_mov_b32 s79, 0x00020000
    s_mul_i32 s48, s2, 6554
    s_lshr_b32 s54, s48, 16
    s_mul_i32 s48, s54, 10
    s_sub_u32 s55, s2, s48
    s_mov_b32 s98, 0
    s_cmp_lt_u32 s2, 80
    s_cbranch_scc1 L_role_1
    s_mov_b32 s98, 1
    s_sub_u32 s55, s2, 80
    s_cmp_ge_u32 s55, 24
    s_cselect_b32 s54, 1, 0
    s_mul_i32 s48, s54, 24
    s_sub_u32 s55, s55, s48
    s_cmp_lt_u32 s2, 128
    s_cbranch_scc1 L_role_1
    s_mov_b32 s98, 2
    s_sub_u32 s55, s2, 128
    s_cmp_lt_u32 s2, 148
    s_cbranch_scc1 L_role_1
    s_mov_b32 s98, 3
L_role_1:
    v_mov_b32 v2, -1
    v_lshlrev_b32 v3, 2, v0
    v_cmp_gt_u32 vcc, 384, v0
    s_and_saveexec_b64 s[100:101], vcc
    s_cbranch_execz L_clr1
    s_mul_i32 s48, s40, 1536
    s_add_u32 s48, s48, 1048576
    buffer_store_dword v2, v3, s[32:35], s48 offen sc0 sc1
    v_cmp_eq_u32 vcc, 0, v0
    s_and_b64 exec, exec, vcc
    s_cbranch_execz L_clr1
    s_lshl_b32 s48, s2, 7
    s_add_u32 s48, s48, 458752
    buffer_store_dword v2, v3, s[32:35], s48 offen sc0 sc1
    buffer_store_dword v2, v3, s[32:35], s48 offen offset:4 sc0 sc1
L_clr1:
    s_mov_b64 exec, s[100:101]
    s_cmp_ge_u32 s98, 2
    s_cbranch_scc1 L_clr3
    s_cmp_eq_u32 s98, 1
    s_cbranch_scc1 L_clr_d
    v_cmp_gt_u32 vcc, 256, v0
    s_and_saveexec_b64 s[100:101], vcc
    s_cbranch_execz L_clr2
    v_lshrrev_b32 v3, 6, v0
    v_mul_u32_u24 v3, 2560, v3
    v_and_b32 v4, 63, v0
    v_lshl_add_u32 v3, v4, 2, v3
    s_mul_i32 s48, s54, 10240
    s_lshl_b32 s49, s55, 8
    s_add_u32 s48, s48, s49
    s_add_u32 s48, s48, 262144
    buffer_store_dword v2, v3, s[32:35], s48 offen sc0 sc1
    v_cmp_eq_u32 vcc, 0, v0
    s_and_b64 exec, exec, vcc
    s_cbranch_execz L_clr2
    s_lshl_b32 s48, s2, 2
    s_add_u32 s48, s48, 454656
    buffer_store_dword v2, v3, s[32:35], s48 offen sc0 sc1
    s_branch L_clr2
L_clr_d:
    v_cmp_gt_u32 vcc, 128, v0
    s_and_saveexec_b64 s[100:101], vcc
    s_cbranch_execz L_clr2
    v_lshrrev_b32 v3, 5, v0
    v_mul_u32_u24 v3, 3072, v3
    v_and_b32 v4, 31, v0
    v_lshl_add_u32 v3, v4, 2, v3
    s_mul_i32 s48, s54, 16384
    s_lshl_b32 s49, s55, 7
    s_add_u32 s48, s48, s49
    s_add_u32 s48, s48, 360448
    buffer_store_dword v2, v3, s[32:35], s48 offen sc0 sc1
L_clr2:
    s_mov_b64 exec, s[100:101]
L_clr3:
    s_waitcnt vmcnt(26)
    v_lshlrev_b32 v54, 16, v46
    v_and_b32 v55, 0xffff0000, v46
    v_lshlrev_b32 v56, 16, v47
    v_and_b32 v57, 0xffff0000, v47
    v_lshlrev_b32 v58, 16, v48
    v_and_b32 v59, 0xffff0000, v48
    v_lshlrev_b32 v60, 16, v49
    v_and_b32 v61, 0xffff0000, v49
    v_lshlrev_b32 v62, 16, v50
    v_and_b32 v63, 0xffff0000, v50
    v_add_f32 v2, v54, v55
    v_add_f32 v2, v2, v56
    v_add_f32 v2, v2, v57
    v_add_f32 v2, v2, v58
    v_add_f32 v2, v2, v59
    v_add_f32 v2, v2, v60
    v_add_f32 v2, v2, v61
    v_add_f32 v2, v2, v62
    v_add_f32 v2, v2, v63
    s_nop 1
    v_add_f32_dpp v2, v2, v2 quad_perm:[1,0,3,2] row_mask:0xf bank_mask:0xf
    s_nop 1
    v_add_f32_dpp v2, v2, v2 quad_perm:[2,3,0,1] row_mask:0xf bank_mask:0xf
    s_nop 1
    v_add_f32_dpp v2, v2, v2 row_half_mirror row_mask:0xf bank_mask:0xf
    s_nop 1
    v_add_f32_dpp v2, v2, v2 row_mirror row_mask:0xf bank_mask:0xf
    s_nop 1
    v_readlane_b32 s48, v2, 0
    v_readlane_b32 s49, v2, 16
    v_readlane_b32 s50, v2, 32
    v_readlane_b32 s51, v2, 48
    s_nop 1
    v_mov_b32 v2, s48
    v_add_f32 v2, s49, v2
    v_add_f32 v2, s50, v2
    v_add_f32 v2, s51, v2
    v_mul_f32 v2, 0x3acccccd, v2
    v_sub_f32 v4, v54, v2
    v_mul_f32 v3, v4, v4
    v_sub_f32 v4, v55, v2
    v_fmac_f32 v3, v4, v4
    v_sub_f32 v4, v56, v2
    v_fmac_f32 v3, v4, v4
    v_sub_f32 v4, v57, v2
    v_fmac_f32 v3, v4, v4
    v_sub_f32 v4, v58, v2
    v_fmac_f32 v3, v4, v4
    v_sub_f32 v4, v59, v2
    v_fmac_f32 v3, v4, v4
    v_sub_f32 v4, v60, v2
    v_fmac_f32 v3, v4, v4
    v_sub_f32 v4, v61, v2
    v_fmac_f32 v3, v4, v4
    v_sub_f32 v4, v62, v2
    v_fmac_f32 v3, v4, v4
    v_sub_f32 v4, v63, v2
    v_fmac_f32 v3, v4, v4
    s_nop 1
    v_add_f32_dpp v3, v3, v3 quad_perm:[1,0,3,2] row_mask:0xf bank_mask:0xf
    s_nop 1
    v_add_f32_dpp v3, v3, v3 quad_perm:[2,3,0,1] row_mask:0xf bank_mask:0xf
    s_nop 1
    v_add_f32_dpp v3, v3, v3 row_half_mirror row_mask:0xf bank_mask:0xf
    s_nop 1
    v_add_f32_dpp v3, v3, v3 row_mirror row_mask:0xf bank_mask:0xf
    s_nop 1
    v_readlane_b32 s48, v3, 0
    v_readlane_b32 s49, v3, 16
    v_readlane_b32 s50, v3, 32
    v_readlane_b32 s51, v3, 48
    s_nop 1
    v_mov_b32 v3, s48
    v_add_f32 v3, s49, v3
    v_add_f32 v3, s50, v3
    v_add_f32 v3, s51, v3
    v_mul_f32 v3, 0x3acccccd, v3
    v_cvt_pk_bf16_f32 v2, v2, v2
    v_lshlrev_b32 v2, 16, v2
    v_cvt_pk_bf16_f32 v3, v3, v3
    v_lshlrev_b32 v3, 16, v3
    v_add_f32 v3, 0x3727c5ac, v3
    v_cvt_pk_bf16_f32 v3, v3, v3
    v_lshlrev_b32 v3, 16, v3
    v_sqrt_f32 v3, v3
    s_nop 0
    v_cvt_pk_bf16_f32 v3, v3, v3
    v_lshlrev_b32 v3, 16, v3
    v_rcp_f32 v3, v3
    s_waitcnt vmcnt(21)
    v_lshlrev_b32 v51, 16, v51
    v_sub_f32 v51, v51, v2
    v_cvt_pk_bf16_f32 v51, v51, v51
    v_lshlrev_b32 v51, 16, v51
    v_mul_f32 v51, v51, v3
    v_cvt_pk_bf16_f32 v51, v51, v51
    v_lshlrev_b32 v51, 16, v51
    v_lshlrev_b32 v52, 16, v52
    v_sub_f32 v52, v52, v2
    v_cvt_pk_bf16_f32 v52, v52, v52
    v_lshlrev_b32 v52, 16, v52
    v_mul_f32 v52, v52, v3
    v_cvt_pk_bf16_f32 v52, v52, v52
    v_lshlrev_b32 v52, 16, v52
    v_lshlrev_b32 v53, 16, v53
    v_sub_f32 v53, v53, v2
    v_cvt_pk_bf16_f32 v53, v53, v53
    v_lshlrev_b32 v53, 16, v53
    v_mul_f32 v53, v53, v3
    v_cvt_pk_bf16_f32 v53, v53, v53
    v_lshlrev_b32 v53, 16, v53
    v_lshlrev_b32 v126, 16, v126
    v_sub_f32 v126, v126, v2
    v_cvt_pk_bf16_f32 v126, v126, v126
    v_lshlrev_b32 v126, 16, v126
    v_mul_f32 v126, v126, v3
    v_cvt_pk_bf16_f32 v126, v126, v126
    v_lshlrev_b32 v126, 16, v126
    v_lshlrev_b32 v127, 16, v127
    v_sub_f32 v127, v127, v2
    v_cvt_pk_bf16_f32 v127, v127, v127
    v_lshlrev_b32 v127, 16, v127
    v_mul_f32 v127, v127, v3
    v_cvt_pk_bf16_f32 v127, v127, v127
    v_lshlrev_b32 v127, 16, v127
    s_waitcnt vmcnt(18)
    v_lshlrev_b32 v2, 16, v102
    v_and_b32 v3, 0xffff0000, v102
    v_mul_f32 v54, v51, v2
    v_mul_f32 v55, v51, v3
    v_lshlrev_b32 v2, 16, v103
    v_and_b32 v3, 0xffff0000, v103
    v_mul_f32 v56, v51, v2
    v_mul_f32 v57, v51, v3
    v_lshlrev_b32 v2, 16, v104
    v_and_b32 v3, 0xffff0000, v104
    v_mul_f32 v58, v51, v2
    v_mul_f32 v59, v51, v3
    v_lshlrev_b32 v2, 16, v105
    v_and_b32 v3, 0xffff0000, v105
    v_mul_f32 v60, v51, v2
    v_mul_f32 v61, v51, v3
    v_lshlrev_b32 v2, 16, v106
    v_and_b32 v3, 0xffff0000, v106
    v_mul_f32 v62, v51, v2
    v_mul_f32 v63, v51, v3
    v_lshlrev_b32 v2, 16, v107
    v_and_b32 v3, 0xffff0000, v107
    v_mul_f32 v64, v51, v2
    v_mul_f32 v65, v51, v3
    v_lshlrev_b32 v2, 16, v108
    v_and_b32 v3, 0xffff0000, v108
    v_mul_f32 v66, v51, v2
    v_mul_f32 v67, v51, v3
    v_lshlrev_b32 v2, 16, v109
    v_and_b32 v3, 0xffff0000, v109
    v_mul_f32 v68, v51, v2
    v_mul_f32 v69, v51, v3
    v_lshlrev_b32 v2, 16, v110
    v_and_b32 v3, 0xffff0000, v110
    v_mul_f32 v70, v51, v2
    v_mul_f32 v71, v51, v3
    v_lshlrev_b32 v2, 16, v111
    v_and_b32 v3, 0xffff0000, v111
    v_mul_f32 v72, v51, v2
    v_mul_f32 v73, v51, v3
    v_lshlrev_b32 v2, 16, v112
    v_and_b32 v3, 0xffff0000, v112
    v_mul_f32 v74, v51, v2
    v_mul_f32 v75, v51, v3
    v_lshlrev_b32 v2, 16, v113
    v_and_b32 v3, 0xffff0000, v113
    v_mul_f32 v76, v51, v2
    v_mul_f32 v77, v51, v3
    s_add_u32 s48, s41, 6144
    buffer_load_dwordx4 v[102:105], v1, s[16:19], s48 offen offset:0 nt
    buffer_load_dwordx4 v[106:109], v1, s[16:19], s48 offen offset:128 nt
    buffer_load_dwordx4 v[110:113], v1, s[16:19], s48 offen offset:256 nt
    s_waitcnt vmcnt(18)
    v_lshlrev_b32 v2, 16, v114
    v_and_b32 v3, 0xffff0000, v114
    v_fmac_f32 v54, v52, v2
    v_fmac_f32 v55, v52, v3
    v_lshlrev_b32 v2, 16, v115
    v_and_b32 v3, 0xffff0000, v115
    v_fmac_f32 v56, v52, v2
    v_fmac_f32 v57, v52, v3
    v_lshlrev_b32 v2, 16, v116
    v_and_b32 v3, 0xffff0000, v116
    v_fmac_f32 v58, v52, v2
    v_fmac_f32 v59, v52, v3
    v_lshlrev_b32 v2, 16, v117
    v_and_b32 v3, 0xffff0000, v117
    v_fmac_f32 v60, v52, v2
    v_fmac_f32 v61, v52, v3
    v_lshlrev_b32 v2, 16, v118
    v_and_b32 v3, 0xffff0000, v118
    v_fmac_f32 v62, v52, v2
    v_fmac_f32 v63, v52, v3
    v_lshlrev_b32 v2, 16, v119
    v_and_b32 v3, 0xffff0000, v119
    v_fmac_f32 v64, v52, v2
    v_fmac_f32 v65, v52, v3
    v_lshlrev_b32 v2, 16, v120
    v_and_b32 v3, 0xffff0000, v120
    v_fmac_f32 v66, v52, v2
    v_fmac_f32 v67, v52, v3
    v_lshlrev_b32 v2, 16, v121
    v_and_b32 v3, 0xffff0000, v121
    v_fmac_f32 v68, v52, v2
    v_fmac_f32 v69, v52, v3
    v_lshlrev_b32 v2, 16, v122
    v_and_b32 v3, 0xffff0000, v122
    v_fmac_f32 v70, v52, v2
    v_fmac_f32 v71, v52, v3
    v_lshlrev_b32 v2, 16, v123
    v_and_b32 v3, 0xffff0000, v123
    v_fmac_f32 v72, v52, v2
    v_fmac_f32 v73, v52, v3
    v_lshlrev_b32 v2, 16, v124
    v_and_b32 v3, 0xffff0000, v124
    v_fmac_f32 v74, v52, v2
    v_fmac_f32 v75, v52, v3
    v_lshlrev_b32 v2, 16, v125
    v_and_b32 v3, 0xffff0000, v125
    v_fmac_f32 v76, v52, v2
    v_fmac_f32 v77, v52, v3
    s_add_u32 s48, s41, 9216
    buffer_load_dwordx4 v[114:117], v1, s[16:19], s48 offen offset:0 nt
    buffer_load_dwordx4 v[118:121], v1, s[16:19], s48 offen offset:128 nt
    buffer_load_dwordx4 v[122:125], v1, s[16:19], s48 offen offset:256 nt
    s_waitcnt vmcnt(15)
    v_lshlrev_b32 v2, 16, v10
    v_and_b32 v3, 0xffff0000, v10
    v_fmac_f32 v54, v53, v2
    v_fmac_f32 v55, v53, v3
    v_lshlrev_b32 v2, 16, v11
    v_and_b32 v3, 0xffff0000, v11
    v_fmac_f32 v56, v53, v2
    v_fmac_f32 v57, v53, v3
    v_lshlrev_b32 v2, 16, v12
    v_and_b32 v3, 0xffff0000, v12
    v_fmac_f32 v58, v53, v2
    v_fmac_f32 v59, v53, v3
    v_lshlrev_b32 v2, 16, v13
    v_and_b32 v3, 0xffff0000, v13
    v_fmac_f32 v60, v53, v2
    v_fmac_f32 v61, v53, v3
    v_lshlrev_b32 v2, 16, v14
    v_and_b32 v3, 0xffff0000, v14
    v_fmac_f32 v62, v53, v2
    v_fmac_f32 v63, v53, v3
    v_lshlrev_b32 v2, 16, v15
    v_and_b32 v3, 0xffff0000, v15
    v_fmac_f32 v64, v53, v2
    v_fmac_f32 v65, v53, v3
    v_lshlrev_b32 v2, 16, v16
    v_and_b32 v3, 0xffff0000, v16
    v_fmac_f32 v66, v53, v2
    v_fmac_f32 v67, v53, v3
    v_lshlrev_b32 v2, 16, v17
    v_and_b32 v3, 0xffff0000, v17
    v_fmac_f32 v68, v53, v2
    v_fmac_f32 v69, v53, v3
    v_lshlrev_b32 v2, 16, v18
    v_and_b32 v3, 0xffff0000, v18
    v_fmac_f32 v70, v53, v2
    v_fmac_f32 v71, v53, v3
    v_lshlrev_b32 v2, 16, v19
    v_and_b32 v3, 0xffff0000, v19
    v_fmac_f32 v72, v53, v2
    v_fmac_f32 v73, v53, v3
    v_lshlrev_b32 v2, 16, v20
    v_and_b32 v3, 0xffff0000, v20
    v_fmac_f32 v74, v53, v2
    v_fmac_f32 v75, v53, v3
    v_lshlrev_b32 v2, 16, v21
    v_and_b32 v3, 0xffff0000, v21
    v_fmac_f32 v76, v53, v2
    v_fmac_f32 v77, v53, v3
    s_waitcnt vmcnt(9)
    v_lshlrev_b32 v2, 16, v22
    v_and_b32 v3, 0xffff0000, v22
    v_fmac_f32 v54, v126, v2
    v_fmac_f32 v55, v126, v3
    v_lshlrev_b32 v2, 16, v23
    v_and_b32 v3, 0xffff0000, v23
    v_fmac_f32 v56, v126, v2
    v_fmac_f32 v57, v126, v3
    v_lshlrev_b32 v2, 16, v24
    v_and_b32 v3, 0xffff0000, v24
    v_fmac_f32 v58, v126, v2
    v_fmac_f32 v59, v126, v3
    v_lshlrev_b32 v2, 16, v25
    v_and_b32 v3, 0xffff0000, v25
    v_fmac_f32 v60, v126, v2
    v_fmac_f32 v61, v126, v3
    v_lshlrev_b32 v2, 16, v26
    v_and_b32 v3, 0xffff0000, v26
    v_fmac_f32 v62, v126, v2
    v_fmac_f32 v63, v126, v3
    v_lshlrev_b32 v2, 16, v27
    v_and_b32 v3, 0xffff0000, v27
    v_fmac_f32 v64, v126, v2
    v_fmac_f32 v65, v126, v3
    v_lshlrev_b32 v2, 16, v28
    v_and_b32 v3, 0xffff0000, v28
    v_fmac_f32 v66, v126, v2
    v_fmac_f32 v67, v126, v3
    v_lshlrev_b32 v2, 16, v29
    v_and_b32 v3, 0xffff0000, v29
    v_fmac_f32 v68, v126, v2
    v_fmac_f32 v69, v126, v3
    v_lshlrev_b32 v2, 16, v30
    v_and_b32 v3, 0xffff0000, v30
    v_fmac_f32 v70, v126, v2
    v_fmac_f32 v71, v126, v3
    v_lshlrev_b32 v2, 16, v31
    v_and_b32 v3, 0xffff0000, v31
    v_fmac_f32 v72, v126, v2
    v_fmac_f32 v73, v126, v3
    v_lshlrev_b32 v2, 16, v32
    v_and_b32 v3, 0xffff0000, v32
    v_fmac_f32 v74, v126, v2
    v_fmac_f32 v75, v126, v3
    v_lshlrev_b32 v2, 16, v33
    v_and_b32 v3, 0xffff0000, v33
    v_fmac_f32 v76, v126, v2
    v_fmac_f32 v77, v126, v3
    s_waitcnt vmcnt(6)
    v_lshlrev_b32 v2, 16, v34
    v_and_b32 v3, 0xffff0000, v34
    v_fmac_f32 v54, v127, v2
    v_fmac_f32 v55, v127, v3
    v_lshlrev_b32 v2, 16, v35
    v_and_b32 v3, 0xffff0000, v35
    v_fmac_f32 v56, v127, v2
    v_fmac_f32 v57, v127, v3
    v_lshlrev_b32 v2, 16, v36
    v_and_b32 v3, 0xffff0000, v36
    v_fmac_f32 v58, v127, v2
    v_fmac_f32 v59, v127, v3
    v_lshlrev_b32 v2, 16, v37
    v_and_b32 v3, 0xffff0000, v37
    v_fmac_f32 v60, v127, v2
    v_fmac_f32 v61, v127, v3
    v_lshlrev_b32 v2, 16, v38
    v_and_b32 v3, 0xffff0000, v38
    v_fmac_f32 v62, v127, v2
    v_fmac_f32 v63, v127, v3
    v_lshlrev_b32 v2, 16, v39
    v_and_b32 v3, 0xffff0000, v39
    v_fmac_f32 v64, v127, v2
    v_fmac_f32 v65, v127, v3
    v_lshlrev_b32 v2, 16, v40
    v_and_b32 v3, 0xffff0000, v40
    v_fmac_f32 v66, v127, v2
    v_fmac_f32 v67, v127, v3
    v_lshlrev_b32 v2, 16, v41
    v_and_b32 v3, 0xffff0000, v41
    v_fmac_f32 v68, v127, v2
    v_fmac_f32 v69, v127, v3
    v_lshlrev_b32 v2, 16, v42
    v_and_b32 v3, 0xffff0000, v42
    v_fmac_f32 v70, v127, v2
    v_fmac_f32 v71, v127, v3
    v_lshlrev_b32 v2, 16, v43
    v_and_b32 v3, 0xffff0000, v43
    v_fmac_f32 v72, v127, v2
    v_fmac_f32 v73, v127, v3
    v_lshlrev_b32 v2, 16, v44
    v_and_b32 v3, 0xffff0000, v44
    v_fmac_f32 v74, v127, v2
    v_fmac_f32 v75, v127, v3
    v_lshlrev_b32 v2, 16, v45
    v_and_b32 v3, 0xffff0000, v45
    v_fmac_f32 v76, v127, v2
    v_fmac_f32 v77, v127, v3
    s_nop 1
    v_permlane32_swap_b32 v54, v58
    v_permlane32_swap_b32 v55, v59
    v_permlane32_swap_b32 v56, v60
    v_permlane32_swap_b32 v57, v61
    v_permlane32_swap_b32 v62, v66
    v_permlane32_swap_b32 v63, v67
    v_permlane32_swap_b32 v64, v68
    v_permlane32_swap_b32 v65, v69
    v_permlane32_swap_b32 v70, v74
    v_permlane32_swap_b32 v71, v75
    v_permlane32_swap_b32 v72, v76
    v_permlane32_swap_b32 v73, v77
    v_add_f32 v54, v54, v58
    v_add_f32 v55, v55, v59
    v_add_f32 v56, v56, v60
    v_add_f32 v57, v57, v61
    v_add_f32 v62, v62, v66
    v_add_f32 v63, v63, v67
    v_add_f32 v64, v64, v68
    v_add_f32 v65, v65, v69
    v_add_f32 v70, v70, v74
    v_add_f32 v71, v71, v75
    v_add_f32 v72, v72, v76
    v_add_f32 v73, v73, v77
    s_nop 1
    v_permlane16_swap_b32 v54, v56
    v_permlane16_swap_b32 v55, v57
    v_permlane16_swap_b32 v62, v64
    v_permlane16_swap_b32 v63, v65
    v_permlane16_swap_b32 v70, v72
    v_permlane16_swap_b32 v71, v73
    v_add_f32 v54, v54, v56
    v_add_f32 v55, v55, v57
    v_add_f32 v62, v62, v64
    v_add_f32 v63, v63, v65
    v_add_f32 v70, v70, v72
    v_add_f32 v71, v71, v73
    s_nop 1
    v_add_f32_dpp v54, v54, v54 row_ror:8 row_mask:0xf bank_mask:0xf
    v_add_f32_dpp v55, v55, v55 row_ror:8 row_mask:0xf bank_mask:0xf
    v_add_f32_dpp v62, v62, v62 row_ror:8 row_mask:0xf bank_mask:0xf
    v_add_f32_dpp v63, v63, v63 row_ror:8 row_mask:0xf bank_mask:0xf
    v_add_f32_dpp v70, v70, v70 row_ror:8 row_mask:0xf bank_mask:0xf
    v_add_f32_dpp v71, v71, v71 row_ror:8 row_mask:0xf bank_mask:0xf
    v_lshrrev_b32 v2, 6, v0
    v_mul_u32_u24 v9, 768, v2
    v_and_b32 v2, 7, v6
    v_lshlrev_b32 v2, 5, v2
    v_add_u32 v9, v9, v2
    v_lshrrev_b32 v2, 5, v6
    v_lshlrev_b32 v2, 4, v2
    v_add_u32 v9, v9, v2
    v_bfe_u32 v2, v6, 4, 1
    v_lshlrev_b32 v2, 3, v2
    v_add_u32 v9, v9, v2
    ds_write_b64 v9, v[54:55] offset:0
    ds_write_b64 v9, v[62:63] offset:256
    ds_write_b64 v9, v[70:71] offset:512
    s_waitcnt lgkmcnt(0)
    s_barrier
    v_cmp_gt_u32 vcc, 192, v0
    s_and_saveexec_b64 s[100:101], vcc
    s_cbranch_execz L_q1
    v_lshlrev_b32 v2, 2, v0
    ds_read_b32 v54, v2 offset:0
    ds_read_b32 v55, v2 offset:768
    ds_read_b32 v56, v2 offset:1536
    ds_read_b32 v57, v2 offset:2304
    ds_read_b32 v58, v2 offset:3072
    ds_read_b32 v59, v2 offset:3840
    ds_read_b32 v60, v2 offset:4608
    ds_read_b32 v61, v2 offset:5376
    ds_read_b32 v62, v2 offset:6144
    ds_read_b32 v63, v2 offset:6912
    ds_read_b32 v64, v2 offset:7680
    ds_read_b32 v65, v2 offset:8448
    ds_read_b32 v66, v2 offset:9216
    ds_read_b32 v67, v2 offset:9984
    ds_read_b32 v68, v2 offset:10752
    ds_read_b32 v69, v2 offset:11520
    s_waitcnt lgkmcnt(0)
    v_add_f32 v54, v54, v55
    v_add_f32 v54, v54, v56
    v_add_f32 v54, v54, v57
    v_add_f32 v54, v54, v58
    v_add_f32 v54, v54, v59
    v_add_f32 v54, v54, v60
    v_add_f32 v54, v54, v61
    v_add_f32 v54, v54, v62
    v_add_f32 v54, v54, v63
    v_add_f32 v54, v54, v64
    v_add_f32 v54, v54, v65
    v_add_f32 v54, v54, v66
    v_add_f32 v54, v54, v67
    v_add_f32 v54, v54, v68
    v_add_f32 v54, v54, v69
    v_cvt_pk_bf16_f32 v54, v54, v54
    v_lshlrev_b32 v2, 1, v0
    ds_write_b16 v2, v54 offset:12288
    v_cmp_eq_u32 vcc, 0, v0
    s_and_b64 exec, exec, vcc
    s_cbranch_execz L_q2
    v_mov_b32 v3, 1
    v_mov_b32 v2, 4
    buffer_atomic_add v3, v2, s[36:39], 0 offen sc1
L_q2:
    s_waitcnt lgkmcnt(0)
L_q1:
    s_mov_b64 exec, s[100:101]
    s_barrier
    v_and_b32 v2, 7, v6
    v_lshlrev_b32 v2, 4, v2
    ds_read_b128 v[10:13], v2 offset:12288
    ds_read_b128 v[14:17], v2 offset:12416
    ds_read_b128 v[18:21], v2 offset:12544
    s_waitcnt lgkmcnt(0)
    v_mov_b32 v30, 0xff7fffff
    v_mov_b32 v31, 0
    v_mov_b32 v54, 0
    v_mov_b32 v55, 0
    v_mov_b32 v56, 0
    v_mov_b32 v57, 0
    v_mov_b32 v58, 0
    v_mov_b32 v59, 0
    v_mov_b32 v60, 0
    v_mov_b32 v61, 0
    v_mov_b32 v62, 0
    v_mov_b32 v63, 0
    v_mov_b32 v64, 0
    v_mov_b32 v65, 0
    v_mov_b32 v66, 0
    v_mov_b32 v67, 0
    v_mov_b32 v68, 0
    v_mov_b32 v69, 0
    v_mov_b32 v70, 0
    v_mov_b32 v71, 0
    v_mov_b32 v72, 0
    v_mov_b32 v73, 0
    v_mov_b32 v74, 0
    v_mov_b32 v75, 0
    v_mov_b32 v76, 0
    v_mov_b32 v77, 0
    v_mov_b32 v33, 12928
    v_mov_b32 v34, 1
    s_mov_b32 s52, 0x3fb8aa3b
L_loop:
    s_mov_b64 exec, 1
    ds_add_rtn_u32 v32, v33, v34
    s_mov_b64 exec, -1
    s_waitcnt vmcnt(9)
    v_dot2_f32_bf16 v2, v78, v10, 0
    v_dot2_f32_bf16 v3, v82, v14, 0
    v_dot2_f32_bf16 v4, v86, v18, 0
    v_dot2_f32_bf16 v2, v79, v11, v2
    v_dot2_f32_bf16 v3, v83, v15, v3
    v_dot2_f32_bf16 v4, v87, v19, v4
    v_dot2_f32_bf16 v2, v80, v12, v2
    v_dot2_f32_bf16 v3, v84, v16, v3
    v_dot2_f32_bf16 v4, v88, v20, v4
    v_dot2_f32_bf16 v2, v81, v13, v2
    v_dot2_f32_bf16 v3, v85, v17, v3
    v_dot2_f32_bf16 v4, v89, v21, v4
    s_add_u32 s48, s41, 12288
    buffer_load_dwordx4 v[78:81], v1, s[16:19], s48 offen offset:0 nt
    buffer_load_dwordx4 v[82:85], v1, s[16:19], s48 offen offset:128 nt
    buffer_load_dwordx4 v[86:89], v1, s[16:19], s48 offen offset:256 nt
    v_add_f32 v2, v2, v3
    v_add_f32 v2, v2, v4
    s_nop 1
    v_add_f32_dpp v2, v2, v2 quad_perm:[1,0,3,2] row_mask:0xf bank_mask:0xf
    s_nop 1
    v_add_f32_dpp v2, v2, v2 quad_perm:[2,3,0,1] row_mask:0xf bank_mask:0xf
    s_nop 1
    v_add_f32_dpp v2, v2, v2 row_half_mirror row_mask:0xf bank_mask:0xf
    v_cvt_pk_bf16_f32 v2, v2, v2
    v_lshlrev_b32 v2, 16, v2
    v_mul_f32 v2, 0x3d93cd3a, v2
    v_cvt_pk_bf16_f32 v2, v2, v2
    v_lshlrev_b32 v22, 16, v2
    s_waitcnt vmcnt(9)
    v_dot2_f32_bf16 v2, v90, v10, 0
    v_dot2_f32_bf16 v3, v94, v14, 0
    v_dot2_f32_bf16 v4, v98, v18, 0
    v_dot2_f32_bf16 v2, v91, v11, v2
    v_dot2_f32_bf16 v3, v95, v15, v3
    v_dot2_f32_bf16 v4, v99, v19, v4
    v_dot2_f32_bf16 v2, v92, v12, v2
    v_dot2_f32_bf16 v3, v96, v16, v3
    v_dot2_f32_bf16 v4, v100, v20, v4
    v_dot2_f32_bf16 v2, v93, v13, v2
    v_dot2_f32_bf16 v3, v97, v17, v3
    v_dot2_f32_bf16 v4, v101, v21, v4
    s_add_u32 s48, s41, 15360
    buffer_load_dwordx4 v[90:93], v1, s[16:19], s48 offen offset:0 nt
    buffer_load_dwordx4 v[94:97], v1, s[16:19], s48 offen offset:128 nt
    buffer_load_dwordx4 v[98:101], v1, s[16:19], s48 offen offset:256 nt
    v_add_f32 v2, v2, v3
    v_add_f32 v2, v2, v4
    s_nop 1
    v_add_f32_dpp v2, v2, v2 quad_perm:[1,0,3,2] row_mask:0xf bank_mask:0xf
    s_nop 1
    v_add_f32_dpp v2, v2, v2 quad_perm:[2,3,0,1] row_mask:0xf bank_mask:0xf
    s_nop 1
    v_add_f32_dpp v2, v2, v2 row_half_mirror row_mask:0xf bank_mask:0xf
    v_cvt_pk_bf16_f32 v2, v2, v2
    v_lshlrev_b32 v2, 16, v2
    v_mul_f32 v2, 0x3d93cd3a, v2
    v_cvt_pk_bf16_f32 v2, v2, v2
    v_lshlrev_b32 v23, 16, v2
    s_waitcnt vmcnt(9)
    v_dot2_f32_bf16 v2, v102, v10, 0
    v_dot2_f32_bf16 v3, v106, v14, 0
    v_dot2_f32_bf16 v4, v110, v18, 0
    v_dot2_f32_bf16 v2, v103, v11, v2
    v_dot2_f32_bf16 v3, v107, v15, v3
    v_dot2_f32_bf16 v4, v111, v19, v4
    v_dot2_f32_bf16 v2, v104, v12, v2
    v_dot2_f32_bf16 v3, v108, v16, v3
    v_dot2_f32_bf16 v4, v112, v20, v4
    v_dot2_f32_bf16 v2, v105, v13, v2
    v_dot2_f32_bf16 v3, v109, v17, v3
    v_dot2_f32_bf16 v4, v113, v21, v4
    s_add_u32 s48, s41, 18432
    buffer_load_dwordx4 v[102:105], v1, s[16:19], s48 offen offset:0 nt
    buffer_load_dwordx4 v[106:109], v1, s[16:19], s48 offen offset:128 nt
    buffer_load_dwordx4 v[110:113], v1, s[16:19], s48 offen offset:256 nt
    v_add_f32 v2, v2, v3
    v_add_f32 v2, v2, v4
    s_nop 1
    v_add_f32_dpp v2, v2, v2 quad_perm:[1,0,3,2] row_mask:0xf bank_mask:0xf
    s_nop 1
    v_add_f32_dpp v2, v2, v2 quad_perm:[2,3,0,1] row_mask:0xf bank_mask:0xf
    s_nop 1
    v_add_f32_dpp v2, v2, v2 row_half_mirror row_mask:0xf bank_mask:0xf
    v_cvt_pk_bf16_f32 v2, v2, v2
    v_lshlrev_b32 v2, 16, v2
    v_mul_f32 v2, 0x3d93cd3a, v2
    v_cvt_pk_bf16_f32 v2, v2, v2
    v_lshlrev_b32 v24, 16, v2
    s_waitcnt lgkmcnt(0)
    v_readfirstlane_b32 s49, v32
    s_mul_i32 s47, s49, 24576
    s_waitcnt vmcnt(9)
    v_dot2_f32_bf16 v2, v114, v10, 0
    v_dot2_f32_bf16 v3, v118, v14, 0
    v_dot2_f32_bf16 v4, v122, v18, 0
    v_dot2_f32_bf16 v2, v115, v11, v2
    v_dot2_f32_bf16 v3, v119, v15, v3
    v_dot2_f32_bf16 v4, v123, v19, v4
    v_dot2_f32_bf16 v2, v116, v12, v2
    v_dot2_f32_bf16 v3, v120, v16, v3
    v_dot2_f32_bf16 v4, v124, v20, v4
    v_dot2_f32_bf16 v2, v117, v13, v2
    v_dot2_f32_bf16 v3, v121, v17, v3
    v_dot2_f32_bf16 v4, v125, v21, v4
    s_add_u32 s48, s41, 21504
    buffer_load_dwordx4 v[114:117], v1, s[16:19], s48 offen offset:0 nt
    buffer_load_dwordx4 v[118:121], v1, s[16:19], s48 offen offset:128 nt
    buffer_load_dwordx4 v[122:125], v1, s[16:19], s48 offen offset:256 nt
    v_add_f32 v2, v2, v3
    v_add_f32 v2, v2, v4
    s_nop 1
    v_add_f32_dpp v2, v2, v2 quad_perm:[1,0,3,2] row_mask:0xf bank_mask:0xf
    s_nop 1
    v_add_f32_dpp v2, v2, v2 quad_perm:[2,3,0,1] row_mask:0xf bank_mask:0xf
    s_nop 1
    v_add_f32_dpp v2, v2, v2 row_half_mirror row_mask:0xf bank_mask:0xf
    v_cvt_pk_bf16_f32 v2, v2, v2
    v_lshlrev_b32 v2, 16, v2
    v_mul_f32 v2, 0x3d93cd3a, v2
    v_cvt_pk_bf16_f32 v2, v2, v2
    v_lshlrev_b32 v25, 16, v2
    s_waitcnt vmcnt(9)
    v_dot2_f32_bf16 v2, v78, v10, 0
    v_dot2_f32_bf16 v3, v82, v14, 0
    v_dot2_f32_bf16 v4, v86, v18, 0
    v_dot2_f32_bf16 v2, v79, v11, v2
    v_dot2_f32_bf16 v3, v83, v15, v3
    v_dot2_f32_bf16 v4, v87, v19, v4
    v_dot2_f32_bf16 v2, v80, v12, v2
    v_dot2_f32_bf16 v3, v84, v16, v3
    v_dot2_f32_bf16 v4, v88, v20, v4
    v_dot2_f32_bf16 v2, v81, v13, v2
    v_dot2_f32_bf16 v3, v85, v17, v3
    v_dot2_f32_bf16 v4, v89, v21, v4
    s_add_u32 s48, s41, 0
    buffer_load_dwordx4 v[78:81], v1, s[20:23], s48 offen offset:0 nt
    buffer_load_dwordx4 v[82:85], v1, s[20:23], s48 offen offset:128 nt
    buffer_load_dwordx4 v[86:89], v1, s[20:23], s48 offen offset:256 nt
    v_add_f32 v2, v2, v3
    v_add_f32 v2, v2, v4
    s_nop 1
    v_add_f32_dpp v2, v2, v2 quad_perm:[1,0,3,2] row_mask:0xf bank_mask:0xf
    s_nop 1
    v_add_f32_dpp v2, v2, v2 quad_perm:[2,3,0,1] row_mask:0xf bank_mask:0xf
    s_nop 1
    v_add_f32_dpp v2, v2, v2 row_half_mirror row_mask:0xf bank_mask:0xf
    v_cvt_pk_bf16_f32 v2, v2, v2
    v_lshlrev_b32 v2, 16, v2
    v_mul_f32 v2, 0x3d93cd3a, v2
    v_cvt_pk_bf16_f32 v2, v2, v2
    v_lshlrev_b32 v26, 16, v2
    s_waitcnt vmcnt(9)
    v_dot2_f32_bf16 v2, v90, v10, 0
    v_dot2_f32_bf16 v3, v94, v14, 0
    v_dot2_f32_bf16 v4, v98, v18, 0
    v_dot2_f32_bf16 v2, v91, v11, v2
    v_dot2_f32_bf16 v3, v95, v15, v3
    v_dot2_f32_bf16 v4, v99, v19, v4
    v_dot2_f32_bf16 v2, v92, v12, v2
    v_dot2_f32_bf16 v3, v96, v16, v3
    v_dot2_f32_bf16 v4, v100, v20, v4
    v_dot2_f32_bf16 v2, v93, v13, v2
    v_dot2_f32_bf16 v3, v97, v17, v3
    v_dot2_f32_bf16 v4, v101, v21, v4
    s_add_u32 s48, s41, 3072
    buffer_load_dwordx4 v[90:93], v1, s[20:23], s48 offen offset:0 nt
    buffer_load_dwordx4 v[94:97], v1, s[20:23], s48 offen offset:128 nt
    buffer_load_dwordx4 v[98:101], v1, s[20:23], s48 offen offset:256 nt
    v_add_f32 v2, v2, v3
    v_add_f32 v2, v2, v4
    s_nop 1
    v_add_f32_dpp v2, v2, v2 quad_perm:[1,0,3,2] row_mask:0xf bank_mask:0xf
    s_nop 1
    v_add_f32_dpp v2, v2, v2 quad_perm:[2,3,0,1] row_mask:0xf bank_mask:0xf
    s_nop 1
    v_add_f32_dpp v2, v2, v2 row_half_mirror row_mask:0xf bank_mask:0xf
    v_cvt_pk_bf16_f32 v2, v2, v2
    v_lshlrev_b32 v2, 16, v2
    v_mul_f32 v2, 0x3d93cd3a, v2
    v_cvt_pk_bf16_f32 v2, v2, v2
    v_lshlrev_b32 v27, 16, v2
    s_waitcnt vmcnt(9)
    v_dot2_f32_bf16 v2, v102, v10, 0
    v_dot2_f32_bf16 v3, v106, v14, 0
    v_dot2_f32_bf16 v4, v110, v18, 0
    v_dot2_f32_bf16 v2, v103, v11, v2
    v_dot2_f32_bf16 v3, v107, v15, v3
    v_dot2_f32_bf16 v4, v111, v19, v4
    v_dot2_f32_bf16 v2, v104, v12, v2
    v_dot2_f32_bf16 v3, v108, v16, v3
    v_dot2_f32_bf16 v4, v112, v20, v4
    v_dot2_f32_bf16 v2, v105, v13, v2
    v_dot2_f32_bf16 v3, v109, v17, v3
    v_dot2_f32_bf16 v4, v113, v21, v4
    s_add_u32 s48, s41, 6144
    buffer_load_dwordx4 v[102:105], v1, s[20:23], s48 offen offset:0 nt
    buffer_load_dwordx4 v[106:109], v1, s[20:23], s48 offen offset:128 nt
    buffer_load_dwordx4 v[110:113], v1, s[20:23], s48 offen offset:256 nt
    v_add_f32 v2, v2, v3
    v_add_f32 v2, v2, v4
    s_nop 1
    v_add_f32_dpp v2, v2, v2 quad_perm:[1,0,3,2] row_mask:0xf bank_mask:0xf
    s_nop 1
    v_add_f32_dpp v2, v2, v2 quad_perm:[2,3,0,1] row_mask:0xf bank_mask:0xf
    s_nop 1
    v_add_f32_dpp v2, v2, v2 row_half_mirror row_mask:0xf bank_mask:0xf
    v_cvt_pk_bf16_f32 v2, v2, v2
    v_lshlrev_b32 v2, 16, v2
    v_mul_f32 v2, 0x3d93cd3a, v2
    v_cvt_pk_bf16_f32 v2, v2, v2
    v_lshlrev_b32 v28, 16, v2
    s_waitcnt vmcnt(9)
    v_dot2_f32_bf16 v2, v114, v10, 0
    v_dot2_f32_bf16 v3, v118, v14, 0
    v_dot2_f32_bf16 v4, v122, v18, 0
    v_dot2_f32_bf16 v2, v115, v11, v2
    v_dot2_f32_bf16 v3, v119, v15, v3
    v_dot2_f32_bf16 v4, v123, v19, v4
    v_dot2_f32_bf16 v2, v116, v12, v2
    v_dot2_f32_bf16 v3, v120, v16, v3
    v_dot2_f32_bf16 v4, v124, v20, v4
    v_dot2_f32_bf16 v2, v117, v13, v2
    v_dot2_f32_bf16 v3, v121, v17, v3
    v_dot2_f32_bf16 v4, v125, v21, v4
    s_add_u32 s48, s41, 9216
    buffer_load_dwordx4 v[114:117], v1, s[20:23], s48 offen offset:0 nt
    buffer_load_dwordx4 v[118:121], v1, s[20:23], s48 offen offset:128 nt
    buffer_load_dwordx4 v[122:125], v1, s[20:23], s48 offen offset:256 nt
    v_add_f32 v2, v2, v3
    v_add_f32 v2, v2, v4
    s_nop 1
    v_add_f32_dpp v2, v2, v2 quad_perm:[1,0,3,2] row_mask:0xf bank_mask:0xf
    s_nop 1
    v_add_f32_dpp v2, v2, v2 quad_perm:[2,3,0,1] row_mask:0xf bank_mask:0xf
    s_nop 1
    v_add_f32_dpp v2, v2, v2 row_half_mirror row_mask:0xf bank_mask:0xf
    v_cvt_pk_bf16_f32 v2, v2, v2
    v_lshlrev_b32 v2, 16, v2
    v_mul_f32 v2, 0x3d93cd3a, v2
    v_cvt_pk_bf16_f32 v2, v2, v2
    v_lshlrev_b32 v29, 16, v2
    v_max3_f32 v2, v22, v23, v24
    v_max3_f32 v2, v2, v25, v26
    v_max3_f32 v2, v2, v27, v28
    v_max_f32 v2, v2, v29
    s_nop 1
    v_max_f32_dpp v2, v2, v2 row_ror:8 row_mask:0xf bank_mask:0xf
    s_nop 1
    v_readlane_b32 s48, v2, 0
    v_readlane_b32 s49, v2, 16
    v_readlane_b32 s50, v2, 32
    v_readlane_b32 s51, v2, 48
    s_nop 1
    v_mov_b32 v2, s48
    v_max_f32 v2, s49, v2
    v_max_f32 v2, s50, v2
    v_max_f32 v2, s51, v2
    v_max_f32 v2, v2, v30
    v_sub_f32 v3, v30, v2
    v_mul_f32 v3, s52, v3
    v_exp_f32 v3, v3
    v_mov_b32 v30, v2
    v_mul_f32 v4, s52, v2
    v_fma_f32 v22, v22, s52, -v4
    v_exp_f32 v22, v22
    v_fma_f32 v23, v23, s52, -v4
    v_exp_f32 v23, v23
    v_fma_f32 v24, v24, s52, -v4
    v_exp_f32 v24, v24
    v_fma_f32 v25, v25, s52, -v4
    v_exp_f32 v25, v25
    v_fma_f32 v26, v26, s52, -v4
    v_exp_f32 v26, v26
    v_fma_f32 v27, v27, s52, -v4
    v_exp_f32 v27, v27
    v_fma_f32 v28, v28, s52, -v4
    v_exp_f32 v28, v28
    v_fma_f32 v29, v29, s52, -v4
    v_exp_f32 v29, v29
    v_mul_f32 v31, v31, v3
    v_mul_f32 v54, v54, v3
    v_mul_f32 v55, v55, v3
    v_mul_f32 v56, v56, v3
    v_mul_f32 v57, v57, v3
    v_mul_f32 v58, v58, v3
    v_mul_f32 v59, v59, v3
    v_mul_f32 v60, v60, v3
    v_mul_f32 v61, v61, v3
    v_mul_f32 v62, v62, v3
    v_mul_f32 v63, v63, v3
    v_mul_f32 v64, v64, v3
    v_mul_f32 v65, v65, v3
    v_mul_f32 v66, v66, v3
    v_mul_f32 v67, v67, v3
    v_mul_f32 v68, v68, v3
    v_mul_f32 v69, v69, v3
    v_mul_f32 v70, v70, v3
    v_mul_f32 v71, v71, v3
    v_mul_f32 v72, v72, v3
    v_mul_f32 v73, v73, v3
    v_mul_f32 v74, v74, v3
    v_mul_f32 v75, v75, v3
    v_mul_f32 v76, v76, v3
    v_mul_f32 v77, v77, v3
    v_add_f32 v31, v31, v22
    v_add_f32 v31, v31, v23
    v_add_f32 v31, v31, v24
    v_add_f32 v31, v31, v25
    v_add_f32 v31, v31, v26
    v_add_f32 v31, v31, v27
    v_add_f32 v31, v31, v28
    v_add_f32 v31, v31, v29
    s_waitcnt vmcnt(9)
    v_lshlrev_b32 v4, 16, v78
    v_and_b32 v5, 0xffff0000, v78
    v_fmac_f32 v54, v22, v4
    v_fmac_f32 v55, v22, v5
    v_lshlrev_b32 v4, 16, v79
    v_and_b32 v5, 0xffff0000, v79
    v_fmac_f32 v56, v22, v4
    v_fmac_f32 v57, v22, v5
    v_lshlrev_b32 v4, 16, v80
    v_and_b32 v5, 0xffff0000, v80
    v_fmac_f32 v58, v22, v4
    v_fmac_f32 v59, v22, v5
    v_lshlrev_b32 v4, 16, v81
    v_and_b32 v5, 0xffff0000, v81
    v_fmac_f32 v60, v22, v4
    v_fmac_f32 v61, v22, v5
    v_lshlrev_b32 v4, 16, v82
    v_and_b32 v5, 0xffff0000, v82
    v_fmac_f32 v62, v22, v4
    v_fmac_f32 v63, v22, v5
    v_lshlrev_b32 v4, 16, v83
    v_and_b32 v5, 0xffff0000, v83
    v_fmac_f32 v64, v22, v4
    v_fmac_f32 v65, v22, v5
    v_lshlrev_b32 v4, 16, v84
    v_and_b32 v5, 0xffff0000, v84
    v_fmac_f32 v66, v22, v4
    v_fmac_f32 v67, v22, v5
    v_lshlrev_b32 v4, 16, v85
    v_and_b32 v5, 0xffff0000, v85
    v_fmac_f32 v68, v22, v4
    v_fmac_f32 v69, v22, v5
    v_lshlrev_b32 v4, 16, v86
    v_and_b32 v5, 0xffff0000, v86
    v_fmac_f32 v70, v22, v4
    v_fmac_f32 v71, v22, v5
    v_lshlrev_b32 v4, 16, v87
    v_and_b32 v5, 0xffff0000, v87
    v_fmac_f32 v72, v22, v4
    v_fmac_f32 v73, v22, v5
    v_lshlrev_b32 v4, 16, v88
    v_and_b32 v5, 0xffff0000, v88
    v_fmac_f32 v74, v22, v4
    v_fmac_f32 v75, v22, v5
    v_lshlrev_b32 v4, 16, v89
    v_and_b32 v5, 0xffff0000, v89
    v_fmac_f32 v76, v22, v4
    v_fmac_f32 v77, v22, v5
    s_add_u32 s48, s41, 12288
    buffer_load_dwordx4 v[78:81], v1, s[20:23], s48 offen offset:0 nt
    buffer_load_dwordx4 v[82:85], v1, s[20:23], s48 offen offset:128 nt
    buffer_load_dwordx4 v[86:89], v1, s[20:23], s48 offen offset:256 nt
    s_waitcnt vmcnt(9)
    v_lshlrev_b32 v4, 16, v90
    v_and_b32 v5, 0xffff0000, v90
    v_fmac_f32 v54, v23, v4
    v_fmac_f32 v55, v23, v5
    v_lshlrev_b32 v4, 16, v91
    v_and_b32 v5, 0xffff0000, v91
    v_fmac_f32 v56, v23, v4
    v_fmac_f32 v57, v23, v5
    v_lshlrev_b32 v4, 16, v92
    v_and_b32 v5, 0xffff0000, v92
    v_fmac_f32 v58, v23, v4
    v_fmac_f32 v59, v23, v5
    v_lshlrev_b32 v4, 16, v93
    v_and_b32 v5, 0xffff0000, v93
    v_fmac_f32 v60, v23, v4
    v_fmac_f32 v61, v23, v5
    v_lshlrev_b32 v4, 16, v94
    v_and_b32 v5, 0xffff0000, v94
    v_fmac_f32 v62, v23, v4
    v_fmac_f32 v63, v23, v5
    v_lshlrev_b32 v4, 16, v95
    v_and_b32 v5, 0xffff0000, v95
    v_fmac_f32 v64, v23, v4
    v_fmac_f32 v65, v23, v5
    v_lshlrev_b32 v4, 16, v96
    v_and_b32 v5, 0xffff0000, v96
    v_fmac_f32 v66, v23, v4
    v_fmac_f32 v67, v23, v5
    v_lshlrev_b32 v4, 16, v97
    v_and_b32 v5, 0xffff0000, v97
    v_fmac_f32 v68, v23, v4
    v_fmac_f32 v69, v23, v5
    v_lshlrev_b32 v4, 16, v98
    v_and_b32 v5, 0xffff0000, v98
    v_fmac_f32 v70, v23, v4
    v_fmac_f32 v71, v23, v5
    v_lshlrev_b32 v4, 16, v99
    v_and_b32 v5, 0xffff0000, v99
    v_fmac_f32 v72, v23, v4
    v_fmac_f32 v73, v23, v5
    v_lshlrev_b32 v4, 16, v100
    v_and_b32 v5, 0xffff0000, v100
    v_fmac_f32 v74, v23, v4
    v_fmac_f32 v75, v23, v5
    v_lshlrev_b32 v4, 16, v101
    v_and_b32 v5, 0xffff0000, v101
    v_fmac_f32 v76, v23, v4
    v_fmac_f32 v77, v23, v5
    s_add_u32 s48, s41, 15360
    buffer_load_dwordx4 v[90:93], v1, s[20:23], s48 offen offset:0 nt
    buffer_load_dwordx4 v[94:97], v1, s[20:23], s48 offen offset:128 nt
    buffer_load_dwordx4 v[98:101], v1, s[20:23], s48 offen offset:256 nt
    s_waitcnt vmcnt(9)
    v_lshlrev_b32 v4, 16, v102
    v_and_b32 v5, 0xffff0000, v102
    v_fmac_f32 v54, v24, v4
    v_fmac_f32 v55, v24, v5
    v_lshlrev_b32 v4, 16, v103
    v_and_b32 v5, 0xffff0000, v103
    v_fmac_f32 v56, v24, v4
    v_fmac_f32 v57, v24, v5
    v_lshlrev_b32 v4, 16, v104
    v_and_b32 v5, 0xffff0000, v104
    v_fmac_f32 v58, v24, v4
    v_fmac_f32 v59, v24, v5
    v_lshlrev_b32 v4, 16, v105
    v_and_b32 v5, 0xffff0000, v105
    v_fmac_f32 v60, v24, v4
    v_fmac_f32 v61, v24, v5
    v_lshlrev_b32 v4, 16, v106
    v_and_b32 v5, 0xffff0000, v106
    v_fmac_f32 v62, v24, v4
    v_fmac_f32 v63, v24, v5
    v_lshlrev_b32 v4, 16, v107
    v_and_b32 v5, 0xffff0000, v107
    v_fmac_f32 v64, v24, v4
    v_fmac_f32 v65, v24, v5
    v_lshlrev_b32 v4, 16, v108
    v_and_b32 v5, 0xffff0000, v108
    v_fmac_f32 v66, v24, v4
    v_fmac_f32 v67, v24, v5
    v_lshlrev_b32 v4, 16, v109
    v_and_b32 v5, 0xffff0000, v109
    v_fmac_f32 v68, v24, v4
    v_fmac_f32 v69, v24, v5
    v_lshlrev_b32 v4, 16, v110
    v_and_b32 v5, 0xffff0000, v110
    v_fmac_f32 v70, v24, v4
    v_fmac_f32 v71, v24, v5
    v_lshlrev_b32 v4, 16, v111
    v_and_b32 v5, 0xffff0000, v111
    v_fmac_f32 v72, v24, v4
    v_fmac_f32 v73, v24, v5
    v_lshlrev_b32 v4, 16, v112
    v_and_b32 v5, 0xffff0000, v112
    v_fmac_f32 v74, v24, v4
    v_fmac_f32 v75, v24, v5
    v_lshlrev_b32 v4, 16, v113
    v_and_b32 v5, 0xffff0000, v113
    v_fmac_f32 v76, v24, v4
    v_fmac_f32 v77, v24, v5
    s_add_u32 s48, s41, 18432
    buffer_load_dwordx4 v[102:105], v1, s[20:23], s48 offen offset:0 nt
    buffer_load_dwordx4 v[106:109], v1, s[20:23], s48 offen offset:128 nt
    buffer_load_dwordx4 v[110:113], v1, s[20:23], s48 offen offset:256 nt
    s_waitcnt vmcnt(9)
    v_lshlrev_b32 v4, 16, v114
    v_and_b32 v5, 0xffff0000, v114
    v_fmac_f32 v54, v25, v4
    v_fmac_f32 v55, v25, v5
    v_lshlrev_b32 v4, 16, v115
    v_and_b32 v5, 0xffff0000, v115
    v_fmac_f32 v56, v25, v4
    v_fmac_f32 v57, v25, v5
    v_lshlrev_b32 v4, 16, v116
    v_and_b32 v5, 0xffff0000, v116
    v_fmac_f32 v58, v25, v4
    v_fmac_f32 v59, v25, v5
    v_lshlrev_b32 v4, 16, v117
    v_and_b32 v5, 0xffff0000, v117
    v_fmac_f32 v60, v25, v4
    v_fmac_f32 v61, v25, v5
    v_lshlrev_b32 v4, 16, v118
    v_and_b32 v5, 0xffff0000, v118
    v_fmac_f32 v62, v25, v4
    v_fmac_f32 v63, v25, v5
    v_lshlrev_b32 v4, 16, v119
    v_and_b32 v5, 0xffff0000, v119
    v_fmac_f32 v64, v25, v4
    v_fmac_f32 v65, v25, v5
    v_lshlrev_b32 v4, 16, v120
    v_and_b32 v5, 0xffff0000, v120
    v_fmac_f32 v66, v25, v4
    v_fmac_f32 v67, v25, v5
    v_lshlrev_b32 v4, 16, v121
    v_and_b32 v5, 0xffff0000, v121
    v_fmac_f32 v68, v25, v4
    v_fmac_f32 v69, v25, v5
    v_lshlrev_b32 v4, 16, v122
    v_and_b32 v5, 0xffff0000, v122
    v_fmac_f32 v70, v25, v4
    v_fmac_f32 v71, v25, v5
    v_lshlrev_b32 v4, 16, v123
    v_and_b32 v5, 0xffff0000, v123
    v_fmac_f32 v72, v25, v4
    v_fmac_f32 v73, v25, v5
    v_lshlrev_b32 v4, 16, v124
    v_and_b32 v5, 0xffff0000, v124
    v_fmac_f32 v74, v25, v4
    v_fmac_f32 v75, v25, v5
    v_lshlrev_b32 v4, 16, v125
    v_and_b32 v5, 0xffff0000, v125
    v_fmac_f32 v76, v25, v4
    v_fmac_f32 v77, v25, v5
    s_add_u32 s48, s41, 21504
    buffer_load_dwordx4 v[114:117], v1, s[20:23], s48 offen offset:0 nt
    buffer_load_dwordx4 v[118:121], v1, s[20:23], s48 offen offset:128 nt
    buffer_load_dwordx4 v[122:125], v1, s[20:23], s48 offen offset:256 nt
    s_waitcnt vmcnt(9)
    v_lshlrev_b32 v4, 16, v78
    v_and_b32 v5, 0xffff0000, v78
    v_fmac_f32 v54, v26, v4
    v_fmac_f32 v55, v26, v5
    v_lshlrev_b32 v4, 16, v79
    v_and_b32 v5, 0xffff0000, v79
    v_fmac_f32 v56, v26, v4
    v_fmac_f32 v57, v26, v5
    v_lshlrev_b32 v4, 16, v80
    v_and_b32 v5, 0xffff0000, v80
    v_fmac_f32 v58, v26, v4
    v_fmac_f32 v59, v26, v5
    v_lshlrev_b32 v4, 16, v81
    v_and_b32 v5, 0xffff0000, v81
    v_fmac_f32 v60, v26, v4
    v_fmac_f32 v61, v26, v5
    v_lshlrev_b32 v4, 16, v82
    v_and_b32 v5, 0xffff0000, v82
    v_fmac_f32 v62, v26, v4
    v_fmac_f32 v63, v26, v5
    v_lshlrev_b32 v4, 16, v83
    v_and_b32 v5, 0xffff0000, v83
    v_fmac_f32 v64, v26, v4
    v_fmac_f32 v65, v26, v5
    v_lshlrev_b32 v4, 16, v84
    v_and_b32 v5, 0xffff0000, v84
    v_fmac_f32 v66, v26, v4
    v_fmac_f32 v67, v26, v5
    v_lshlrev_b32 v4, 16, v85
    v_and_b32 v5, 0xffff0000, v85
    v_fmac_f32 v68, v26, v4
    v_fmac_f32 v69, v26, v5
    v_lshlrev_b32 v4, 16, v86
    v_and_b32 v5, 0xffff0000, v86
    v_fmac_f32 v70, v26, v4
    v_fmac_f32 v71, v26, v5
    v_lshlrev_b32 v4, 16, v87
    v_and_b32 v5, 0xffff0000, v87
    v_fmac_f32 v72, v26, v4
    v_fmac_f32 v73, v26, v5
    v_lshlrev_b32 v4, 16, v88
    v_and_b32 v5, 0xffff0000, v88
    v_fmac_f32 v74, v26, v4
    v_fmac_f32 v75, v26, v5
    v_lshlrev_b32 v4, 16, v89
    v_and_b32 v5, 0xffff0000, v89
    v_fmac_f32 v76, v26, v4
    v_fmac_f32 v77, v26, v5
    s_add_u32 s48, s47, 0
    buffer_load_dwordx4 v[78:81], v1, s[16:19], s48 offen offset:0 nt
    buffer_load_dwordx4 v[82:85], v1, s[16:19], s48 offen offset:128 nt
    buffer_load_dwordx4 v[86:89], v1, s[16:19], s48 offen offset:256 nt
    s_waitcnt vmcnt(9)
    v_lshlrev_b32 v4, 16, v90
    v_and_b32 v5, 0xffff0000, v90
    v_fmac_f32 v54, v27, v4
    v_fmac_f32 v55, v27, v5
    v_lshlrev_b32 v4, 16, v91
    v_and_b32 v5, 0xffff0000, v91
    v_fmac_f32 v56, v27, v4
    v_fmac_f32 v57, v27, v5
    v_lshlrev_b32 v4, 16, v92
    v_and_b32 v5, 0xffff0000, v92
    v_fmac_f32 v58, v27, v4
    v_fmac_f32 v59, v27, v5
    v_lshlrev_b32 v4, 16, v93
    v_and_b32 v5, 0xffff0000, v93
    v_fmac_f32 v60, v27, v4
    v_fmac_f32 v61, v27, v5
    v_lshlrev_b32 v4, 16, v94
    v_and_b32 v5, 0xffff0000, v94
    v_fmac_f32 v62, v27, v4
    v_fmac_f32 v63, v27, v5
    v_lshlrev_b32 v4, 16, v95
    v_and_b32 v5, 0xffff0000, v95
    v_fmac_f32 v64, v27, v4
    v_fmac_f32 v65, v27, v5
    v_lshlrev_b32 v4, 16, v96
    v_and_b32 v5, 0xffff0000, v96
    v_fmac_f32 v66, v27, v4
    v_fmac_f32 v67, v27, v5
    v_lshlrev_b32 v4, 16, v97
    v_and_b32 v5, 0xffff0000, v97
    v_fmac_f32 v68, v27, v4
    v_fmac_f32 v69, v27, v5
    v_lshlrev_b32 v4, 16, v98
    v_and_b32 v5, 0xffff0000, v98
    v_fmac_f32 v70, v27, v4
    v_fmac_f32 v71, v27, v5
    v_lshlrev_b32 v4, 16, v99
    v_and_b32 v5, 0xffff0000, v99
    v_fmac_f32 v72, v27, v4
    v_fmac_f32 v73, v27, v5
    v_lshlrev_b32 v4, 16, v100
    v_and_b32 v5, 0xffff0000, v100
    v_fmac_f32 v74, v27, v4
    v_fmac_f32 v75, v27, v5
    v_lshlrev_b32 v4, 16, v101
    v_and_b32 v5, 0xffff0000, v101
    v_fmac_f32 v76, v27, v4
    v_fmac_f32 v77, v27, v5
    s_add_u32 s48, s47, 3072
    buffer_load_dwordx4 v[90:93], v1, s[16:19], s48 offen offset:0 nt
    buffer_load_dwordx4 v[94:97], v1, s[16:19], s48 offen offset:128 nt
    buffer_load_dwordx4 v[98:101], v1, s[16:19], s48 offen offset:256 nt
    s_waitcnt vmcnt(9)
    v_lshlrev_b32 v4, 16, v102
    v_and_b32 v5, 0xffff0000, v102
    v_fmac_f32 v54, v28, v4
    v_fmac_f32 v55, v28, v5
    v_lshlrev_b32 v4, 16, v103
    v_and_b32 v5, 0xffff0000, v103
    v_fmac_f32 v56, v28, v4
    v_fmac_f32 v57, v28, v5
    v_lshlrev_b32 v4, 16, v104
    v_and_b32 v5, 0xffff0000, v104
    v_fmac_f32 v58, v28, v4
    v_fmac_f32 v59, v28, v5
    v_lshlrev_b32 v4, 16, v105
    v_and_b32 v5, 0xffff0000, v105
    v_fmac_f32 v60, v28, v4
    v_fmac_f32 v61, v28, v5
    v_lshlrev_b32 v4, 16, v106
    v_and_b32 v5, 0xffff0000, v106
    v_fmac_f32 v62, v28, v4
    v_fmac_f32 v63, v28, v5
    v_lshlrev_b32 v4, 16, v107
    v_and_b32 v5, 0xffff0000, v107
    v_fmac_f32 v64, v28, v4
    v_fmac_f32 v65, v28, v5
    v_lshlrev_b32 v4, 16, v108
    v_and_b32 v5, 0xffff0000, v108
    v_fmac_f32 v66, v28, v4
    v_fmac_f32 v67, v28, v5
    v_lshlrev_b32 v4, 16, v109
    v_and_b32 v5, 0xffff0000, v109
    v_fmac_f32 v68, v28, v4
    v_fmac_f32 v69, v28, v5
    v_lshlrev_b32 v4, 16, v110
    v_and_b32 v5, 0xffff0000, v110
    v_fmac_f32 v70, v28, v4
    v_fmac_f32 v71, v28, v5
    v_lshlrev_b32 v4, 16, v111
    v_and_b32 v5, 0xffff0000, v111
    v_fmac_f32 v72, v28, v4
    v_fmac_f32 v73, v28, v5
    v_lshlrev_b32 v4, 16, v112
    v_and_b32 v5, 0xffff0000, v112
    v_fmac_f32 v74, v28, v4
    v_fmac_f32 v75, v28, v5
    v_lshlrev_b32 v4, 16, v113
    v_and_b32 v5, 0xffff0000, v113
    v_fmac_f32 v76, v28, v4
    v_fmac_f32 v77, v28, v5
    s_add_u32 s48, s47, 6144
    buffer_load_dwordx4 v[102:105], v1, s[16:19], s48 offen offset:0 nt
    buffer_load_dwordx4 v[106:109], v1, s[16:19], s48 offen offset:128 nt
    buffer_load_dwordx4 v[110:113], v1, s[16:19], s48 offen offset:256 nt
    s_waitcnt vmcnt(9)
    v_lshlrev_b32 v4, 16, v114
    v_and_b32 v5, 0xffff0000, v114
    v_fmac_f32 v54, v29, v4
    v_fmac_f32 v55, v29, v5
    v_lshlrev_b32 v4, 16, v115
    v_and_b32 v5, 0xffff0000, v115
    v_fmac_f32 v56, v29, v4
    v_fmac_f32 v57, v29, v5
    v_lshlrev_b32 v4, 16, v116
    v_and_b32 v5, 0xffff0000, v116
    v_fmac_f32 v58, v29, v4
    v_fmac_f32 v59, v29, v5
    v_lshlrev_b32 v4, 16, v117
    v_and_b32 v5, 0xffff0000, v117
    v_fmac_f32 v60, v29, v4
    v_fmac_f32 v61, v29, v5
    v_lshlrev_b32 v4, 16, v118
    v_and_b32 v5, 0xffff0000, v118
    v_fmac_f32 v62, v29, v4
    v_fmac_f32 v63, v29, v5
    v_lshlrev_b32 v4, 16, v119
    v_and_b32 v5, 0xffff0000, v119
    v_fmac_f32 v64, v29, v4
    v_fmac_f32 v65, v29, v5
    v_lshlrev_b32 v4, 16, v120
    v_and_b32 v5, 0xffff0000, v120
    v_fmac_f32 v66, v29, v4
    v_fmac_f32 v67, v29, v5
    v_lshlrev_b32 v4, 16, v121
    v_and_b32 v5, 0xffff0000, v121
    v_fmac_f32 v68, v29, v4
    v_fmac_f32 v69, v29, v5
    v_lshlrev_b32 v4, 16, v122
    v_and_b32 v5, 0xffff0000, v122
    v_fmac_f32 v70, v29, v4
    v_fmac_f32 v71, v29, v5
    v_lshlrev_b32 v4, 16, v123
    v_and_b32 v5, 0xffff0000, v123
    v_fmac_f32 v72, v29, v4
    v_fmac_f32 v73, v29, v5
    v_lshlrev_b32 v4, 16, v124
    v_and_b32 v5, 0xffff0000, v124
    v_fmac_f32 v74, v29, v4
    v_fmac_f32 v75, v29, v5
    v_lshlrev_b32 v4, 16, v125
    v_and_b32 v5, 0xffff0000, v125
    v_fmac_f32 v76, v29, v4
    v_fmac_f32 v77, v29, v5
    s_add_u32 s48, s47, 9216
    buffer_load_dwordx4 v[114:117], v1, s[16:19], s48 offen offset:0 nt
    buffer_load_dwordx4 v[118:121], v1, s[16:19], s48 offen offset:128 nt
    buffer_load_dwordx4 v[122:125], v1, s[16:19], s48 offen offset:256 nt
    s_mov_b32 s41, s47
    s_cmp_lt_u32 s41, s96
    s_cbranch_scc1 L_loop
L_pool_end:
    v_mov_b32 v2, v30
    v_mov_b32 v3, v31
    s_nop 1
    v_add_f32_dpp v3, v3, v3 quad_perm:[1,0,3,2] row_mask:0xf bank_mask:0xf
    s_nop 1
    v_add_f32_dpp v3, v3, v3 quad_perm:[2,3,0,1] row_mask:0xf bank_mask:0xf
    s_nop 1
    v_add_f32_dpp v3, v3, v3 row_half_mirror row_mask:0xf bank_mask:0xf
    s_nop 1
    v_add_f32_dpp v3, v3, v3 row_mirror row_mask:0xf bank_mask:0xf
    s_nop 1
    v_readlane_b32 s48, v3, 0
    v_readlane_b32 s49, v3, 16
    v_readlane_b32 s50, v3, 32
    v_readlane_b32 s51, v3, 48
    s_nop 1
    v_mov_b32 v3, s48
    v_add_f32 v3, s49, v3
    v_add_f32 v3, s50, v3
    v_add_f32 v3, s51, v3
    v_mul_f32 v3, 0.125, v3
    s_nop 1
    v_permlane32_swap_b32 v54, v58
    v_permlane32_swap_b32 v55, v59
    v_permlane32_swap_b32 v56, v60
    v_permlane32_swap_b32 v57, v61
    v_permlane32_swap_b32 v62, v66
    v_permlane32_swap_b32 v63, v67
    v_permlane32_swap_b32 v64, v68
    v_permlane32_swap_b32 v65, v69
    v_permlane32_swap_b32 v70, v74
    v_permlane32_swap_b32 v71, v75
    v_permlane32_swap_b32 v72, v76
    v_permlane32_swap_b32 v73, v77
    v_add_f32 v54, v54, v58
    v_add_f32 v55, v55, v59
    v_add_f32 v56, v56, v60
    v_add_f32 v57, v57, v61
    v_add_f32 v62, v62, v66
    v_add_f32 v63, v63, v67
    v_add_f32 v64, v64, v68
    v_add_f32 v65, v65, v69
    v_add_f32 v70, v70, v74
    v_add_f32 v71, v71, v75
    v_add_f32 v72, v72, v76
    v_add_f32 v73, v73, v77
    s_nop 1
    v_permlane16_swap_b32 v54, v56
    v_permlane16_swap_b32 v55, v57
    v_permlane16_swap_b32 v62, v64
    v_permlane16_swap_b32 v63, v65
    v_permlane16_swap_b32 v70, v72
    v_permlane16_swap_b32 v71, v73
    v_add_f32 v54, v54, v56
    v_add_f32 v55, v55, v57
    v_add_f32 v62, v62, v64
    v_add_f32 v63, v63, v65
    v_add_f32 v70, v70, v72
    v_add_f32 v71, v71, v73
    s_nop 1
    v_add_f32_dpp v54, v54, v54 row_ror:8 row_mask:0xf bank_mask:0xf
    v_add_f32_dpp v55, v55, v55 row_ror:8 row_mask:0xf bank_mask:0xf
    v_add_f32_dpp v62, v62, v62 row_ror:8 row_mask:0xf bank_mask:0xf
    v_add_f32_dpp v63, v63, v63 row_ror:8 row_mask:0xf bank_mask:0xf
    v_add_f32_dpp v70, v70, v70 row_ror:8 row_mask:0xf bank_mask:0xf
    v_add_f32_dpp v71, v71, v71 row_ror:8 row_mask:0xf bank_mask:0xf
    ds_write_b64 v9, v[54:55] offset:0
    ds_write_b64 v9, v[62:63] offset:256
    ds_write_b64 v9, v[70:71] offset:512
    v_lshrrev_b32 v4, 6, v0
    v_lshlrev_b32 v4, 3, v4
    ds_write_b64 v4, v[2:3] offset:12800
    s_waitcnt lgkmcnt(0)
    s_barrier
    s_cmp_lg_u32 s53, 3
    s_cbranch_scc1 L_noarr
    s_mov_b64 exec, 1
    v_mov_b32 v4, 0
    v_mov_b32 v5, 1
    buffer_atomic_add v5, v4, s[36:39], 0 offen sc0 sc1
    s_waitcnt vmcnt(0)
    v_mov_b32 v4, 12928
    ds_write_b32 v4, v5
    v_readfirstlane_b32 s48, v5
    s_waitcnt lgkmcnt(0)
    s_mov_b64 exec, -1
    v_lshlrev_b32 v4, 7, v6
    v_mov_b32 v5, 1
    s_cmp_lg_u32 s48, 223
    s_cbranch_scc1 L_e3
    s_mov_b32 s48, 458756
    buffer_store_dword v5, v4, s[32:35], s48 offen sc0 sc1
    s_mov_b32 s48, 466948
    buffer_store_dword v5, v4, s[32:35], s48 offen sc0 sc1
    s_mov_b32 s48, 475140
    buffer_store_dword v5, v4, s[32:35], s48 offen sc0 sc1
    s_mov_b32 s48, 483332
    buffer_store_dword v5, v4, s[32:35], s48 offen sc0 sc1
    s_branch L_e2
L_e3:
    s_cmp_lg_u32 s48, 255
    s_cbranch_scc1 L_e2
    s_mov_b32 s48, 458752
    buffer_store_dword v5, v4, s[32:35], s48 offen sc0 sc1
    s_mov_b32 s48, 466944
    buffer_store_dword v5, v4, s[32:35], s48 offen sc0 sc1
    s_mov_b32 s48, 475136
    buffer_store_dword v5, v4, s[32:35], s48 offen sc0 sc1
    s_mov_b32 s48, 483328
    buffer_store_dword v5, v4, s[32:35], s48 offen sc0 sc1
    s_branch L_e2
L_noarr:
    v_cmp_gt_u32 vcc, 192, v0
    s_and_saveexec_b64 s[100:101], vcc
    s_cbranch_execz L_e1
    v_lshlrev_b32 v2, 2, v0
    v_and_b32 v4, 15, v6
    v_lshlrev_b32 v4, 3, v4
    ds_read_b64 v[22:23], v4 offset:12800
    ds_read_b32 v54, v2 offset:0
    ds_read_b32 v55, v2 offset:768
    ds_read_b32 v56, v2 offset:1536
    ds_read_b32 v57, v2 offset:2304
    ds_read_b32 v58, v2 offset:3072
    ds_read_b32 v59, v2 offset:3840
    ds_read_b32 v60, v2 offset:4608
    ds_read_b32 v61, v2 offset:5376
    s_waitcnt lgkmcnt(8)
    ds_read_b32 v62, v2 offset:6144
    ds_read_b32 v63, v2 offset:6912
    ds_read_b32 v64, v2 offset:7680
    ds_read_b32 v65, v2 offset:8448
    ds_read_b32 v66, v2 offset:9216
    ds_read_b32 v67, v2 offset:9984
    ds_read_b32 v68, v2 offset:10752
    ds_read_b32 v69, v2 offset:11520
    v_mov_b32 v3, v22
    s_nop 1
    v_max_f32_dpp v3, v3, v3 quad_perm:[1,0,3,2] row_mask:0xf bank_mask:0xf
    s_nop 1
    v_max_f32_dpp v3, v3, v3 quad_perm:[2,3,0,1] row_mask:0xf bank_mask:0xf
    s_nop 1
    v_max_f32_dpp v3, v3, v3 row_half_mirror row_mask:0xf bank_mask:0xf
    s_nop 1
    v_max_f32_dpp v3, v3, v3 row_mirror row_mask:0xf bank_mask:0xf
    v_sub_f32 v24, v22, v3
    v_mul_f32 v24, 0x3fb8aa3b, v24
    v_exp_f32 v24, v24
    s_nop 0
    v_mul_f32 v5, v24, v23
    s_nop 1
    v_add_f32_dpp v5, v5, v5 quad_perm:[1,0,3,2] row_mask:0xf bank_mask:0xf
    s_nop 1
    v_add_f32_dpp v5, v5, v5 quad_perm:[2,3,0,1] row_mask:0xf bank_mask:0xf
    s_nop 1
    v_add_f32_dpp v5, v5, v5 row_half_mirror row_mask:0xf bank_mask:0xf
    s_nop 1
    v_add_f32_dpp v5, v5, v5 row_mirror row_mask:0xf bank_mask:0xf
    s_waitcnt lgkmcnt(0)
    v_mul_f32_dpp v4, v24, v54 row_newbcast:0 row_mask:0xf bank_mask:0xf
    v_mul_f32_dpp v25, v24, v55 row_newbcast:1 row_mask:0xf bank_mask:0xf
    v_fmac_f32_dpp v4, v24, v56 row_newbcast:2 row_mask:0xf bank_mask:0xf
    v_fmac_f32_dpp v25, v24, v57 row_newbcast:3 row_mask:0xf bank_mask:0xf
    v_fmac_f32_dpp v4, v24, v58 row_newbcast:4 row_mask:0xf bank_mask:0xf
    v_fmac_f32_dpp v25, v24, v59 row_newbcast:5 row_mask:0xf bank_mask:0xf
    v_fmac_f32_dpp v4, v24, v60 row_newbcast:6 row_mask:0xf bank_mask:0xf
    v_fmac_f32_dpp v25, v24, v61 row_newbcast:7 row_mask:0xf bank_mask:0xf
    v_fmac_f32_dpp v4, v24, v62 row_newbcast:8 row_mask:0xf bank_mask:0xf
    v_fmac_f32_dpp v25, v24, v63 row_newbcast:9 row_mask:0xf bank_mask:0xf
    v_fmac_f32_dpp v4, v24, v64 row_newbcast:10 row_mask:0xf bank_mask:0xf
    v_fmac_f32_dpp v25, v24, v65 row_newbcast:11 row_mask:0xf bank_mask:0xf
    v_fmac_f32_dpp v4, v24, v66 row_newbcast:12 row_mask:0xf bank_mask:0xf
    v_fmac_f32_dpp v25, v24, v67 row_newbcast:13 row_mask:0xf bank_mask:0xf
    v_fmac_f32_dpp v4, v24, v68 row_newbcast:14 row_mask:0xf bank_mask:0xf
    v_fmac_f32_dpp v25, v24, v69 row_newbcast:15 row_mask:0xf bank_mask:0xf
    v_add_f32 v4, v4, v25
    v_mov_b32 v12, v4
    v_mov_b32 v14, v3
    v_mov_b32 v15, v5
    v_mov_b32_dpp v13, v4 quad_perm:[1,0,3,2] row_mask:0xf bank_mask:0xf
    v_lshlrev_b32 v2, 3, v0
    s_mul_i32 s48, s40, 1536
    s_add_u32 s48, s48, 1048576
    s_mov_b32 exec_lo, 0x55555555
    s_mov_b32 exec_hi, 0x55555555
    buffer_store_dwordx4 v[12:15], v2, s[32:35], s48 offen sc0 sc1
L_e1:
    s_mov_b64 exec, s[100:101]
L_e2:
    s_waitcnt vmcnt(0)
    s_barrier
    v_mov_b32 v12, 12928
    ds_read_b32 v13, v12
    s_waitcnt lgkmcnt(0)
    v_readfirstlane_b32 s97, v13
    s_mul_i32 s48, s97, 6554
    s_lshr_b32 s54, s48, 16
    s_mul_i32 s48, s54, 10
    s_sub_u32 s55, s97, s48
    s_mov_b32 s98, 0
    s_cmp_lt_u32 s97, 80
    s_cbranch_scc1 L_role_2
    s_mov_b32 s98, 1
    s_sub_u32 s55, s97, 80
    s_cmp_ge_u32 s55, 24
    s_cselect_b32 s54, 1, 0
    s_mul_i32 s48, s54, 24
    s_sub_u32 s55, s55, s48
    s_cmp_lt_u32 s97, 128
    s_cbranch_scc1 L_role_2
    s_mov_b32 s98, 2
    s_sub_u32 s55, s97, 128
    s_cmp_lt_u32 s97, 148
    s_cbranch_scc1 L_role_2
    s_mov_b32 s98, 3
L_role_2:
    s_cmp_eq_u32 s54, 1
    s_cselect_b32 s64, s92, s64
    s_cselect_b32 s65, s93, s65
    s_cmp_eq_u32 s98, 3
    s_cbranch_scc1 L_dma_end
    s_cmp_eq_u32 s98, 2
    s_cbranch_scc1 L_dma_e
    v_lshrrev_b32 v126, 3, v6
    v_and_b32 v127, 7, v6
    v_lshlrev_b32 v127, 4, v127
    s_cmp_eq_u32 s98, 1
    s_cbranch_scc1 L_dma_d
    v_mul_u32_u24 v126, 1280, v126
    v_add_u32 v126, v126, v127
    s_mul_i32 s48, s54, 768
    s_mul_i32 s49, s53, 48
    s_add_u32 s48, s48, s49
    s_mul_i32 s48, s48, 1280
    s_lshl_b32 s50, s55, 7
    s_add_u32 s48, s48, s50
    s_lshl_b32 s50, s49, 7
    s_add_u32 s50, s50, 42496
    s_mov_b32 m0, s50
    s_nop 0
    buffer_load_dwordx4 v126, s[60:63], s48 offen nt lds
    s_add_u32 s48, s48, 10240
    s_add_u32 s50, s50, 1024
    s_mov_b32 m0, s50
    s_nop 0
    buffer_load_dwordx4 v126, s[60:63], s48 offen nt lds
    s_add_u32 s48, s48, 10240
    s_add_u32 s50, s50, 1024
    s_mov_b32 m0, s50
    s_nop 0
    buffer_load_dwordx4 v126, s[60:63], s48 offen nt lds
    s_add_u32 s48, s48, 10240
    s_add_u32 s50, s50, 1024
    s_mov_b32 m0, s50
    s_nop 0
    buffer_load_dwordx4 v126, s[60:63], s48 offen nt lds
    s_add_u32 s48, s48, 10240
    s_add_u32 s50, s50, 1024
    s_mov_b32 m0, s50
    s_nop 0
    buffer_load_dwordx4 v126, s[60:63], s48 offen nt lds
    s_add_u32 s48, s48, 10240
    s_add_u32 s50, s50, 1024
    s_mov_b32 m0, s50
    s_nop 0
    buffer_load_dwordx4 v126, s[60:63], s48 offen nt lds
    s_branch L_dma_end
L_dma_d:
    v_mul_u32_u24 v126, 3072, v126
    v_add_u32 v126, v126, v127
    s_mul_i32 s49, s53, 40
    s_mul_i32 s48, s49, 3072
    s_lshl_b32 s50, s55, 7
    s_add_u32 s48, s48, s50
    s_lshl_b32 s50, s49, 7
    s_add_u32 s50, s50, 42496
    s_mov_b32 m0, s50
    s_nop 0
    buffer_load_dwordx4 v126, s[64:67], s48 offen nt lds
    s_add_u32 s48, s48, 24576
    s_add_u32 s50, s50, 1024
    s_mov_b32 m0, s50
    s_nop 0
    buffer_load_dwordx4 v126, s[64:67], s48 offen nt lds
    s_add_u32 s48, s48, 24576
    s_add_u32 s50, s50, 1024
    s_mov_b32 m0, s50
    s_nop 0
    buffer_load_dwordx4 v126, s[64:67], s48 offen nt lds
    s_add_u32 s48, s48, 24576
    s_add_u32 s50, s50, 1024
    s_mov_b32 m0, s50
    s_nop 0
    buffer_load_dwordx4 v126, s[64:67], s48 offen nt lds
    s_add_u32 s48, s48, 24576
    s_add_u32 s50, s50, 1024
    s_mov_b32 m0, s50
    s_nop 0
    buffer_load_dwordx4 v126, s[64:67], s48 offen nt lds
    s_branch L_dma_end
L_dma_e:
    v_lshrrev_b32 v126, 2, v6
    v_and_b32 v127, 3, v6
    v_lshlrev_b32 v127, 4, v127
    v_mul_u32_u24 v126, 1280, v126
    v_add_u32 v126, v126, v127
    s_mul_i32 s49, s53, 96
    s_mul_i32 s48, s49, 1280
    s_lshl_b32 s50, s55, 6
    s_add_u32 s48, s48, s50
    s_lshl_b32 s50, s49, 6
    s_add_u32 s50, s50, 42496
    s_mov_b32 m0, s50
    s_nop 0
    buffer_load_dwordx4 v126, s[68:71], s48 offen nt lds
    s_add_u32 s48, s48, 20480
    s_add_u32 s50, s50, 1024
    s_mov_b32 m0, s50
    s_nop 0
    buffer_load_dwordx4 v126, s[68:71], s48 offen nt lds
    s_add_u32 s48, s48, 20480
    s_add_u32 s50, s50, 1024
    s_mov_b32 m0, s50
    s_nop 0
    buffer_load_dwordx4 v126, s[68:71], s48 offen nt lds
    s_add_u32 s48, s48, 20480
    s_add_u32 s50, s50, 1024
    s_mov_b32 m0, s50
    s_nop 0
    buffer_load_dwordx4 v126, s[68:71], s48 offen nt lds
    s_add_u32 s48, s48, 20480
    s_add_u32 s50, s50, 1024
    s_mov_b32 m0, s50
    s_nop 0
    buffer_load_dwordx4 v126, s[68:71], s48 offen nt lds
    s_add_u32 s48, s48, 20480
    s_add_u32 s50, s50, 1024
    s_mov_b32 m0, s50
    s_nop 0
    buffer_load_dwordx4 v126, s[68:71], s48 offen nt lds
L_dma_end:
    s_cmp_eq_u32 s98, 3
    s_cbranch_scc0 L_tail_go
    s_endpgm
L_tail_go:
    v_lshrrev_b32 v7, 6, v0
    s_cmp_eq_u32 s98, 0
    s_cbranch_scc1 L_tail_c
    s_cmp_eq_u32 s98, 1
    s_cbranch_scc1 L_tail_d
    s_cmp_lg_u32 s53, 0
    s_cbranch_scc1 L_gate_done
    s_lshl_b32 s44, s2, 7
    s_add_u32 s44, s44, 458752
    v_mov_b32 v122, 0
    s_mov_b32 s45, 0
    buffer_load_dword v123, v122, s[32:35], s44 offen sc0 sc1
L_gate_3:
    s_sleep 6
    buffer_load_dword v124, v122, s[32:35], s44 offen sc0 sc1
    s_waitcnt vmcnt(1)
    v_cmp_ne_u32 vcc, 1, v123
    s_cbranch_vccz L_gate_3_ok
    s_sleep 6
    buffer_load_dword v123, v122, s[32:35], s44 offen sc0 sc1
    s_waitcnt vmcnt(1)
    v_cmp_ne_u32 vcc, 1, v124
    s_add_u32 s45, s45, 1
    s_cbranch_vccz L_gate_3_ok
    s_cmp_lt_u32 s45, 0x20000
    s_cbranch_scc1 L_gate_3
L_gate_3_ok:
L_gate_done:
    s_cmp_eq_u32 s98, 1
    s_cbranch_scc1 L_tail_d
    s_branch L_tail_e
L_tail_c:
    v_mov_b32 v12, v0
    v_mul_u32_u24 v13, 43691, v12
    v_lshrrev_b32 v13, 24, v13
    v_mul_u32_u24 v14, 384, v13
    v_sub_u32 v12, v12, v14
    v_mul_u32_u24 v14, 43691, v12
    v_lshrrev_b32 v14, 22, v14
    v_mul_u32_u24 v40, 98304, v13
    v_mul_u32_u24 v15, 1536, v14
    v_add_u32 v40, v40, v15
    v_lshl_add_u32 v40, v12, 4, v40
    v_mul_u32_u24 v46, 3136, v13
    v_lshl_add_u32 v46, v12, 2, v46
    v_and_b32 v12, 511, v0
    v_add_u32 v12, 1024, v12
    v_mul_u32_u24 v13, 43691, v12
    v_lshrrev_b32 v13, 24, v13
    v_mul_u32_u24 v14, 384, v13
    v_sub_u32 v12, v12, v14
    v_mul_u32_u24 v14, 43691, v12
    v_lshrrev_b32 v14, 22, v14
    v_mul_u32_u24 v41, 98304, v13
    v_mul_u32_u24 v15, 1536, v14
    v_add_u32 v41, v41, v15
    v_lshl_add_u32 v41, v12, 4, v41
    v_mul_u32_u24 v47, 3136, v13
    v_lshl_add_u32 v47, v12, 2, v47
    v_and_b32 v12, 3, v6
    v_mul_u32_u24 v8, 3136, v12
    v_lshlrev_b32 v9, 3, v12
    v_lshrrev_b32 v12, 4, v6
    v_lshl_add_u32 v8, v12, 4, v8
    v_mul_u32_u24 v12, 1024, v12
    v_add_u32 v9, v9, v12
    v_bfe_u32 v12, v6, 2, 2
    v_mul_u32_u24 v12, 128, v12
    v_add_u32 v9, v9, v12
    s_mul_i32 s46, s54, 12288
    s_add_u32 s46, s46, 1048576
    s_cmp_lg_u32 s53, 0
    s_cbranch_scc1 L_c_f
    v_mov_b32 v12, 4
    s_mov_b32 s45, 0
L_c_clr:
    buffer_load_dword v13, v12, s[36:39], 0 offen sc0 sc1
    s_waitcnt vmcnt(0)
    v_cmp_gt_u32 vcc, 256, v13
    s_add_u32 s45, s45, 1
    s_cbranch_vccz L_c_clr_ok
    s_cmp_ge_u32 s45, 0x20000
    s_cbranch_scc1 L_c_clr_ok
    s_sleep 8
    s_branch L_c_clr
L_c_clr_ok:
    s_lshl_b32 s44, s2, 7
    s_add_u32 s44, s44, 458752
    v_mov_b32 v12, 0
    s_mov_b32 s45, 0
L_c_fl:
    buffer_load_dwordx2 v[14:15], v12, s[32:35], s44 offen sc0 sc1
    s_waitcnt vmcnt(0)
    v_min_u32 v14, v14, v15
    v_cmp_ne_u32 vcc, 1, v14
    s_add_u32 s45, s45, 1
    s_cbranch_vccz L_c_f
    s_cmp_ge_u32 s45, 0x20000
    s_cbranch_scc1 L_c_f
    s_sleep 6
    s_branch L_c_fl
L_c_f:
    s_waitcnt vmcnt(0)
    s_barrier
    s_lshr_b32 s48, s53, 2
    s_and_b32 s49, s53, 3
    s_mul_i32 s50, s48, 24576
    s_lshl_b32 s49, s49, 5
    s_add_u32 s50, s50, s49
    s_add_u32 s50, s50, 42496
    v_add_u32 v13, s50, v9
    ds_read_b64_tr_b16 v[80:81], v13 offset:0
    ds_read_b64_tr_b16 v[82:83], v13 offset:512
    ds_read_b64_tr_b16 v[84:85], v13 offset:4096
    ds_read_b64_tr_b16 v[86:87], v13 offset:4608
    ds_read_b64_tr_b16 v[88:89], v13 offset:8192
    ds_read_b64_tr_b16 v[90:91], v13 offset:8704
    ds_read_b64_tr_b16 v[92:93], v13 offset:12288
    ds_read_b64_tr_b16 v[94:95], v13 offset:12800
    ds_read_b64_tr_b16 v[112:113], v13 offset:16384
    ds_read_b64_tr_b16 v[114:115], v13 offset:16896
    ds_read_b64_tr_b16 v[116:117], v13 offset:20480
    ds_read_b64_tr_b16 v[118:119], v13 offset:20992
    s_cmp_ge_u32 s53, 8
    s_cbranch_scc1 L_c_one
    s_mov_b32 s47, 0xf
    s_mov_b32 s45, 0
L_ps_4:
    s_bitcmp1_b32 s47, 0
    s_cbranch_scc0 L_ps_4_i0
    buffer_load_dwordx4 v[64:67], v40, s[32:35], s46 offen offset:0 sc0 sc1
L_ps_4_i0:
    s_bitcmp1_b32 s47, 1
    s_cbranch_scc0 L_ps_4_i1
    buffer_load_dwordx4 v[68:71], v40, s[32:35], s46 offen offset:1536 sc0 sc1
L_ps_4_i1:
    s_bitcmp1_b32 s47, 2
    s_cbranch_scc0 L_ps_4_i2
    buffer_load_dwordx4 v[72:75], v41, s[32:35], s46 offen offset:0 sc0 sc1
L_ps_4_i2:
    s_bitcmp1_b32 s47, 3
    s_cbranch_scc0 L_ps_4_i3
    buffer_load_dwordx4 v[76:79], v41, s[32:35], s46 offen offset:1536 sc0 sc1
L_ps_4_i3:
    s_waitcnt vmcnt(0)
    s_bitcmp1_b32 s47, 0
    s_cbranch_scc0 L_ps_4_c0
    v_max_u32 v14, v64, v65
    v_max3_u32 v14, v14, v66, v67
    v_cmp_eq_u32 vcc, -1, v14
    s_cbranch_vccnz L_ps_4_c0
    s_bitset0_b32 s47, 0
L_ps_4_c0:
    s_bitcmp1_b32 s47, 1
    s_cbranch_scc0 L_ps_4_c1
    v_max_u32 v14, v68, v69
    v_max3_u32 v14, v14, v70, v71
    v_cmp_eq_u32 vcc, -1, v14
    s_cbranch_vccnz L_ps_4_c1
    s_bitset0_b32 s47, 1
L_ps_4_c1:
    s_bitcmp1_b32 s47, 2
    s_cbranch_scc0 L_ps_4_c2
    v_max_u32 v14, v72, v73
    v_max3_u32 v14, v14, v74, v75
    v_cmp_eq_u32 vcc, -1, v14
    s_cbranch_vccnz L_ps_4_c2
    s_bitset0_b32 s47, 2
L_ps_4_c2:
    s_bitcmp1_b32 s47, 3
    s_cbranch_scc0 L_ps_4_c3
    v_max_u32 v14, v76, v77
    v_max3_u32 v14, v14, v78, v79
    v_cmp_eq_u32 vcc, -1, v14
    s_cbranch_vccnz L_ps_4_c3
    s_bitset0_b32 s47, 3
L_ps_4_c3:
    s_cmp_eq_u32 s47, 0
    s_cbranch_scc1 L_ps_4_ok
    s_add_u32 s45, s45, 1
    s_cmp_lt_u32 s45, 0x20000
    s_cbranch_scc1 L_ps_4
L_ps_4_ok:
    v_max_f32 v12, v66, v70
    v_sub_f32 v13, v66, v12
    v_sub_f32 v14, v70, v12
    v_mul_f32 v13, 0x3fb8aa3b, v13
    v_mul_f32 v14, 0x3fb8aa3b, v14
    v_exp_f32 v13, v13
    v_exp_f32 v14, v14
    s_nop 0
    v_mul_f32 v15, v13, v67
    v_fmac_f32 v15, v14, v71
    v_rcp_f32 v15, v15
    s_nop 0
    v_mul_f32 v13, v13, v15
    v_mul_f32 v14, v14, v15
    v_mul_f32 v12, v13, v64
    v_mul_f32 v15, v13, v65
    v_fmac_f32 v12, v14, v68
    v_fmac_f32 v15, v14, v69
    v_cvt_pk_bf16_f32 v12, v12, v15
    ds_write_b32 v46, v12 offset:29952
    v_max_f32 v12, v74, v78
    v_sub_f32 v13, v74, v12
    v_sub_f32 v14, v78, v12
    v_mul_f32 v13, 0x3fb8aa3b, v13
    v_mul_f32 v14, 0x3fb8aa3b, v14
    v_exp_f32 v13, v13
    v_exp_f32 v14, v14
    s_nop 0
    v_mul_f32 v15, v13, v75
    v_fmac_f32 v15, v14, v79
    v_rcp_f32 v15, v15
    s_nop 0
    v_mul_f32 v13, v13, v15
    v_mul_f32 v14, v14, v15
    v_mul_f32 v12, v13, v72
    v_mul_f32 v15, v13, v73
    v_fmac_f32 v12, v14, v76
    v_fmac_f32 v15, v14, v77
    v_cvt_pk_bf16_f32 v12, v12, v15
    ds_write_b32 v47, v12 offset:29952
    s_branch L_c_items_done
L_c_one:
    s_mov_b32 s47, 0x3
    s_mov_b32 s45, 0
L_ps_5:
    s_bitcmp1_b32 s47, 0
    s_cbranch_scc0 L_ps_5_i0
    buffer_load_dwordx4 v[64:67], v40, s[32:35], s46 offen offset:0 sc0 sc1
L_ps_5_i0:
    s_bitcmp1_b32 s47, 1
    s_cbranch_scc0 L_ps_5_i1
    buffer_load_dwordx4 v[68:71], v40, s[32:35], s46 offen offset:1536 sc0 sc1
L_ps_5_i1:
    s_waitcnt vmcnt(0)
    s_bitcmp1_b32 s47, 0
    s_cbranch_scc0 L_ps_5_c0
    v_max_u32 v14, v64, v65
    v_max3_u32 v14, v14, v66, v67
    v_cmp_eq_u32 vcc, -1, v14
    s_cbranch_vccnz L_ps_5_c0
    s_bitset0_b32 s47, 0
L_ps_5_c0:
    s_bitcmp1_b32 s47, 1
    s_cbranch_scc0 L_ps_5_c1
    v_max_u32 v14, v68, v69
    v_max3_u32 v14, v14, v70, v71
    v_cmp_eq_u32 vcc, -1, v14
    s_cbranch_vccnz L_ps_5_c1
    s_bitset0_b32 s47, 1
L_ps_5_c1:
    s_cmp_eq_u32 s47, 0
    s_cbranch_scc1 L_ps_5_ok
    s_add_u32 s45, s45, 1
    s_cmp_lt_u32 s45, 0x20000
    s_cbranch_scc1 L_ps_5
L_ps_5_ok:
    v_max_f32 v12, v66, v70
    v_sub_f32 v13, v66, v12
    v_sub_f32 v14, v70, v12
    v_mul_f32 v13, 0x3fb8aa3b, v13
    v_mul_f32 v14, 0x3fb8aa3b, v14
    v_exp_f32 v13, v13
    v_exp_f32 v14, v14
    s_nop 0
    v_mul_f32 v15, v13, v67
    v_fmac_f32 v15, v14, v71
    v_rcp_f32 v15, v15
    s_nop 0
    v_mul_f32 v13, v13, v15
    v_mul_f32 v14, v14, v15
    v_mul_f32 v12, v13, v64
    v_mul_f32 v15, v13, v65
    v_fmac_f32 v12, v14, v68
    v_fmac_f32 v15, v14, v69
    v_cvt_pk_bf16_f32 v12, v12, v15
    ds_write_b32 v46, v12 offset:29952
L_c_items_done:
    s_waitcnt lgkmcnt(0)
    s_barrier
    s_lshr_b32 s48, s53, 2
    s_mul_i32 s50, s48, 384
    s_add_u32 s50, s50, 29952
    v_add_u32 v12, s50, v8
    ds_read_b128 v[16:19], v12 offset:0
    ds_read_b128 v[20:23], v12 offset:64
    ds_read_b128 v[24:27], v12 offset:128
    ds_read_b128 v[28:31], v12 offset:192
    ds_read_b128 v[32:35], v12 offset:256
    ds_read_b128 v[36:39], v12 offset:320
    s_waitcnt lgkmcnt(5)
    v_mfma_f32_16x16x32_bf16 v[48:51], v[16:19], v[80:83], 0
    s_waitcnt lgkmcnt(4)
    v_mfma_f32_16x16x32_bf16 v[48:51], v[20:23], v[84:87], v[48:51]
    s_waitcnt lgkmcnt(3)
    v_mfma_f32_16x16x32_bf16 v[48:51], v[24:27], v[88:91], v[48:51]
    s_waitcnt lgkmcnt(2)
    v_mfma_f32_16x16x32_bf16 v[48:51], v[28:31], v[92:95], v[48:51]
    s_waitcnt lgkmcnt(1)
    v_mfma_f32_16x16x32_bf16 v[48:51], v[32:35], v[112:115], v[48:51]
    s_waitcnt lgkmcnt(0)
    v_mfma_f32_16x16x32_bf16 v[48:51], v[36:39], v[116:119], v[48:51]
    s_nop 15
    s_lshr_b32 s48, s53, 2
    s_and_b32 s49, s53, 3
    s_mul_i32 s48, s48, 1024
    s_lshl_b32 s49, s49, 6
    s_add_u32 s48, s48, s49
    v_lshlrev_b32 v12, 2, v6
    v_add_u32 v12, s48, v12
    s_mov_b64 exec, 0xffff
    ds_write_b32 v12, v48 offset:13824
    ds_write_b32 v12, v49 offset:14080
    ds_write_b32 v12, v50 offset:14336
    ds_write_b32 v12, v51 offset:14592
    s_mov_b64 exec, -1
    s_waitcnt lgkmcnt(0)
    s_barrier
    s_cmp_ge_u32 s53, 4
    s_cbranch_scc1 L_c_pub_done
    v_lshlrev_b32 v12, 2, v0
    ds_read_b32 v16, v12 offset:13824
    ds_read_b32 v17, v12 offset:14848
    ds_read_b32 v18, v12 offset:15872
    ds_read_b32 v19, v12 offset:16896
    s_waitcnt lgkmcnt(0)
    v_add_f32 v16, v16, v17
    v_add_f32 v18, v18, v19
    v_add_f32 v16, v16, v18
    v_mul_u32_u24 v12, 2560, v7
    v_lshl_add_u32 v12, v6, 2, v12
    s_mul_i32 s48, s54, 10240
    s_lshl_b32 s49, s55, 8
    s_add_u32 s48, s48, s49
    s_add_u32 s48, s48, 262144
    buffer_store_dword v16, v12, s[32:35], s48 offen sc0 sc1
L_c_pub_done:
    s_endpgm
L_tail_e:
    v_and_b32 v12, 3, v6
    v_mul_u32_u24 v8, 3136, v12
    v_lshlrev_b32 v9, 3, v12
    v_lshrrev_b32 v12, 4, v6
    v_lshl_add_u32 v8, v12, 4, v8
    v_mul_u32_u24 v12, 512, v12
    v_add_u32 v9, v9, v12
    v_bfe_u32 v12, v6, 2, 2
    v_mul_u32_u24 v12, 64, v12
    v_add_u32 v9, v9, v12
    s_barrier
    v_min_u32 v57, 39, v6
    s_lshr_b32 s48, s53, 2
    s_mul_i32 s48, s48, 40
    v_add_u32 v57, s48, v57
    v_cmp_gt_u32 vcc, 40, v6
    s_nop 1
    v_cndmask_b32_e64 v56, 0, 1.0, vcc
    s_and_b32 s49, s53, 3
    s_mul_i32 s50, s49, 1280
    v_lshlrev_b32 v58, 3, v57
    buffer_load_dwordx2 v[48:49], v58, s[56:59], s50 offen
    buffer_load_dwordx2 v[50:51], v58, s[72:75], 0 offen
    s_mul_i32 s51, s49, 1344
    v_add_u32 v62, s51, v58
    v_lshlrev_b32 v59, 4, v57
    s_mul_i32 s50, s49, 2560
    s_add_u32 s50, s50, 262144
    s_mov_b32 s45, 0
    s_mov_b32 s44, s50
    buffer_load_dwordx4 v[64:67], v59, s[32:35], s44 offen sc0 sc1
    s_add_u32 s44, s44, 10240
    buffer_load_dwordx4 v[68:71], v59, s[32:35], s44 offen sc0 sc1
    s_add_u32 s44, s44, 10240
    buffer_load_dwordx4 v[72:75], v59, s[32:35], s44 offen sc0 sc1
    s_add_u32 s44, s44, 10240
    buffer_load_dwordx4 v[76:79], v59, s[32:35], s44 offen sc0 sc1
    s_add_u32 s44, s44, 10240
    buffer_load_dwordx4 v[80:83], v59, s[32:35], s44 offen sc0 sc1
    s_add_u32 s44, s44, 10240
    buffer_load_dwordx4 v[84:87], v59, s[32:35], s44 offen sc0 sc1
    s_add_u32 s44, s44, 10240
    buffer_load_dwordx4 v[88:91], v59, s[32:35], s44 offen sc0 sc1
    s_add_u32 s44, s44, 10240
    buffer_load_dwordx4 v[92:95], v59, s[32:35], s44 offen sc0 sc1
    s_sleep 10
L_pl_6:
    s_mov_b32 s44, s50
    buffer_load_dwordx4 v[96:99], v59, s[32:35], s44 offen sc0 sc1
    s_add_u32 s44, s44, 10240
    buffer_load_dwordx4 v[100:103], v59, s[32:35], s44 offen sc0 sc1
    s_add_u32 s44, s44, 10240
    buffer_load_dwordx4 v[104:107], v59, s[32:35], s44 offen sc0 sc1
    s_add_u32 s44, s44, 10240
    buffer_load_dwordx4 v[108:111], v59, s[32:35], s44 offen sc0 sc1
    s_add_u32 s44, s44, 10240
    buffer_load_dwordx4 v[112:115], v59, s[32:35], s44 offen sc0 sc1
    s_add_u32 s44, s44, 10240
    buffer_load_dwordx4 v[116:119], v59, s[32:35], s44 offen sc0 sc1
    s_add_u32 s44, s44, 10240
    buffer_load_dwordx4 v[120:123], v59, s[32:35], s44 offen sc0 sc1
    s_add_u32 s44, s44, 10240
    buffer_load_dwordx4 v[124:127], v59, s[32:35], s44 offen sc0 sc1
    s_waitcnt vmcnt(8)
    v_max_u32 v60, v64, v65
    v_max3_u32 v60, v60, v66, v67
    v_max3_u32 v60, v60, v68, v69
    v_max3_u32 v60, v60, v70, v71
    v_max3_u32 v60, v60, v72, v73
    v_max3_u32 v60, v60, v74, v75
    v_max3_u32 v60, v60, v76, v77
    v_max3_u32 v60, v60, v78, v79
    v_max3_u32 v60, v60, v80, v81
    v_max3_u32 v60, v60, v82, v83
    v_max3_u32 v60, v60, v84, v85
    v_max3_u32 v60, v60, v86, v87
    v_max3_u32 v60, v60, v88, v89
    v_max3_u32 v60, v60, v90, v91
    v_max3_u32 v60, v60, v92, v93
    v_max3_u32 v60, v60, v94, v95
    v_cmp_eq_u32 vcc, -1, v60
    s_cbranch_vccz L_pl_6_a
    s_mov_b32 s44, s50
    buffer_load_dwordx4 v[64:67], v59, s[32:35], s44 offen sc0 sc1
    s_add_u32 s44, s44, 10240
    buffer_load_dwordx4 v[68:71], v59, s[32:35], s44 offen sc0 sc1
    s_add_u32 s44, s44, 10240
    buffer_load_dwordx4 v[72:75], v59, s[32:35], s44 offen sc0 sc1
    s_add_u32 s44, s44, 10240
    buffer_load_dwordx4 v[76:79], v59, s[32:35], s44 offen sc0 sc1
    s_add_u32 s44, s44, 10240
    buffer_load_dwordx4 v[80:83], v59, s[32:35], s44 offen sc0 sc1
    s_add_u32 s44, s44, 10240
    buffer_load_dwordx4 v[84:87], v59, s[32:35], s44 offen sc0 sc1
    s_add_u32 s44, s44, 10240
    buffer_load_dwordx4 v[88:91], v59, s[32:35], s44 offen sc0 sc1
    s_add_u32 s44, s44, 10240
    buffer_load_dwordx4 v[92:95], v59, s[32:35], s44 offen sc0 sc1
    s_waitcnt vmcnt(8)
    v_max_u32 v60, v96, v97
    v_max3_u32 v60, v60, v98, v99
    v_max3_u32 v60, v60, v100, v101
    v_max3_u32 v60, v60, v102, v103
    v_max3_u32 v60, v60, v104, v105
    v_max3_u32 v60, v60, v106, v107
    v_max3_u32 v60, v60, v108, v109
    v_max3_u32 v60, v60, v110, v111
    v_max3_u32 v60, v60, v112, v113
    v_max3_u32 v60, v60, v114, v115
    v_max3_u32 v60, v60, v116, v117
    v_max3_u32 v60, v60, v118, v119
    v_max3_u32 v60, v60, v120, v121
    v_max3_u32 v60, v60, v122, v123
    v_max3_u32 v60, v60, v124, v125
    v_max3_u32 v60, v60, v126, v127
    v_cmp_eq_u32 vcc, -1, v60
    s_cbranch_vccz L_pl_6_b
    s_add_u32 s45, s45, 1
    s_cmp_lt_u32 s45, 0x20000
    s_cbranch_scc1 L_pl_6
L_pl_6_b:
    v_mov_b32 v16, v96
    v_mov_b32 v17, v97
    v_mov_b32 v18, v98
    v_mov_b32 v19, v99
    v_mov_b32 v20, v100
    v_mov_b32 v21, v101
    v_mov_b32 v22, v102
    v_mov_b32 v23, v103
    v_mov_b32 v24, v104
    v_mov_b32 v25, v105
    v_mov_b32 v26, v106
    v_mov_b32 v27, v107
    v_mov_b32 v28, v108
    v_mov_b32 v29, v109
    v_mov_b32 v30, v110
    v_mov_b32 v31, v111
    v_mov_b32 v32, v112
    v_mov_b32 v33, v113
    v_mov_b32 v34, v114
    v_mov_b32 v35, v115
    v_mov_b32 v36, v116
    v_mov_b32 v37, v117
    v_mov_b32 v38, v118
    v_mov_b32 v39, v119
    v_mov_b32 v40, v120
    v_mov_b32 v41, v121
    v_mov_b32 v42, v122
    v_mov_b32 v43, v123
    v_mov_b32 v44, v124
    v_mov_b32 v45, v125
    v_mov_b32 v46, v126
    v_mov_b32 v47, v127
    s_branch L_pl_6_e
L_pl_6_a:
    v_mov_b32 v16, v64
    v_mov_b32 v17, v65
    v_mov_b32 v18, v66
    v_mov_b32 v19, v67
    v_mov_b32 v20, v68
    v_mov_b32 v21, v69
    v_mov_b32 v22, v70
    v_mov_b32 v23, v71
    v_mov_b32 v24, v72
    v_mov_b32 v25, v73
    v_mov_b32 v26, v74
    v_mov_b32 v27, v75
    v_mov_b32 v28, v76
    v_mov_b32 v29, v77
    v_mov_b32 v30, v78
    v_mov_b32 v31, v79
    v_mov_b32 v32, v80
    v_mov_b32 v33, v81
    v_mov_b32 v34, v82
    v_mov_b32 v35, v83
    v_mov_b32 v36, v84
    v_mov_b32 v37, v85
    v_mov_b32 v38, v86
    v_mov_b32 v39, v87
    v_mov_b32 v40, v88
    v_mov_b32 v41, v89
    v_mov_b32 v42, v90
    v_mov_b32 v43, v91
    v_mov_b32 v44, v92
    v_mov_b32 v45, v93
    v_mov_b32 v46, v94
    v_mov_b32 v47, v95
L_pl_6_e:
    v_add_f32 v16, v16, v32
    v_add_f32 v20, v20, v36
    v_add_f32 v24, v24, v40
    v_add_f32 v28, v28, v44
    v_add_f32 v52, v16, v20
    v_add_f32 v60, v24, v28
    v_add_f32 v52, v52, v60
    v_cvt_pk_bf16_f32 v52, v52, v52
    v_lshlrev_b32 v52, 16, v52
    v_add_f32 v17, v17, v33
    v_add_f32 v21, v21, v37
    v_add_f32 v25, v25, v41
    v_add_f32 v29, v29, v45
    v_add_f32 v53, v17, v21
    v_add_f32 v60, v25, v29
    v_add_f32 v53, v53, v60
    v_cvt_pk_bf16_f32 v53, v53, v53
    v_lshlrev_b32 v53, 16, v53
    v_add_f32 v18, v18, v34
    v_add_f32 v22, v22, v38
    v_add_f32 v26, v26, v42
    v_add_f32 v30, v30, v46
    v_add_f32 v54, v18, v22
    v_add_f32 v60, v26, v30
    v_add_f32 v54, v54, v60
    v_cvt_pk_bf16_f32 v54, v54, v54
    v_lshlrev_b32 v54, 16, v54
    v_add_f32 v19, v19, v35
    v_add_f32 v23, v23, v39
    v_add_f32 v27, v27, v43
    v_add_f32 v31, v31, v47
    v_add_f32 v55, v19, v23
    v_add_f32 v60, v27, v31
    v_add_f32 v55, v55, v60
    v_cvt_pk_bf16_f32 v55, v55, v55
    v_lshlrev_b32 v55, 16, v55
    v_lshlrev_b32 v58, 16, v48
    v_and_b32 v59, 0xffff0000, v48
    v_lshlrev_b32 v60, 16, v49
    v_and_b32 v61, 0xffff0000, v49
    v_add_f32 v52, v52, v58
    v_cvt_pk_bf16_f32 v52, v52, v52
    v_lshlrev_b32 v52, 16, v52
    v_add_f32 v53, v53, v59
    v_cvt_pk_bf16_f32 v53, v53, v53
    v_lshlrev_b32 v53, 16, v53
    v_add_f32 v54, v54, v60
    v_cvt_pk_bf16_f32 v54, v54, v54
    v_lshlrev_b32 v54, 16, v54
    v_add_f32 v55, v55, v61
    v_cvt_pk_bf16_f32 v55, v55, v55
    v_lshlrev_b32 v55, 16, v55
    v_add_f32 v58, v52, v53
    v_add_f32 v59, v54, v55
    v_add_f32 v58, v58, v59
    v_mul_f32 v58, v58, v56
    s_nop 1
    v_add_f32_dpp v58, v58, v58 quad_perm:[1,0,3,2] row_mask:0xf bank_mask:0xf
    s_nop 1
    v_add_f32_dpp v58, v58, v58 quad_perm:[2,3,0,1] row_mask:0xf bank_mask:0xf
    s_nop 1
    v_add_f32_dpp v58, v58, v58 row_half_mirror row_mask:0xf bank_mask:0xf
    s_nop 1
    v_add_f32_dpp v58, v58, v58 row_mirror row_mask:0xf bank_mask:0xf
    s_nop 1
    v_readlane_b32 s48, v58, 0
    v_readlane_b32 s49, v58, 16
    v_readlane_b32 s50, v58, 32
    v_readlane_b32 s51, v58, 48
    s_nop 1
    v_mov_b32 v58, s48
    v_add_f32 v58, s49, v58
    v_add_f32 v58, s50, v58
    v_add_f32 v58, s51, v58
    v_mul_f32 v58, 0x3bcccccd, v58
    v_sub_f32 v60, v52, v58
    v_mul_f32 v59, v60, v60
    v_sub_f32 v60, v53, v58
    v_fmac_f32 v59, v60, v60
    v_sub_f32 v60, v54, v58
    v_fmac_f32 v59, v60, v60
    v_sub_f32 v60, v55, v58
    v_fmac_f32 v59, v60, v60
    v_mul_f32 v59, v59, v56
    s_nop 1
    v_add_f32_dpp v59, v59, v59 quad_perm:[1,0,3,2] row_mask:0xf bank_mask:0xf
    s_nop 1
    v_add_f32_dpp v59, v59, v59 quad_perm:[2,3,0,1] row_mask:0xf bank_mask:0xf
    s_nop 1
    v_add_f32_dpp v59, v59, v59 row_half_mirror row_mask:0xf bank_mask:0xf
    s_nop 1
    v_add_f32_dpp v59, v59, v59 row_mirror row_mask:0xf bank_mask:0xf
    s_nop 1
    v_readlane_b32 s48, v59, 0
    v_readlane_b32 s49, v59, 16
    v_readlane_b32 s50, v59, 32
    v_readlane_b32 s51, v59, 48
    s_nop 1
    v_mov_b32 v59, s48
    v_add_f32 v59, s49, v59
    v_add_f32 v59, s50, v59
    v_add_f32 v59, s51, v59
    s_lshl_b32 s49, s53, 5
    s_and_b32 s49, s49, 96
    s_and_b32 s50, s53, 12
    s_lshl_b32 s50, s50, 1
    s_add_u32 s50, s50, s49
    v_mov_b32 v60, s50
    v_mov_b32 v61, s49
    ds_write_b64 v60, v[58:59] offset:29696
    s_waitcnt lgkmcnt(0)
    s_barrier
    ds_read_b128 v[16:19], v61 offset:29696
    ds_read_b128 v[20:23], v61 offset:29712
    s_waitcnt lgkmcnt(0)
    v_add_f32 v24, v16, v18
    v_add_f32 v25, v20, v22
    v_add_f32 v24, v24, v25
    v_mul_f32 v24, 0.25, v24
    v_add_f32 v25, v17, v19
    v_add_f32 v26, v21, v23
    v_add_f32 v25, v25, v26
    v_sub_f32 v16, v16, v24
    v_sub_f32 v18, v18, v24
    v_sub_f32 v20, v20, v24
    v_sub_f32 v22, v22, v24
    v_mul_f32 v26, v16, v16
    v_fmac_f32 v26, v18, v18
    v_fmac_f32 v26, v20, v20
    v_fmac_f32 v26, v22, v22
    v_mov_b32 v27, 0x43200000
    v_fmac_f32 v25, v26, v27
    v_mul_f32 v25, 0x3acccccd, v25
    v_cvt_pk_bf16_f32 v24, v24, v24
    v_lshlrev_b32 v24, 16, v24
    v_cvt_pk_bf16_f32 v25, v25, v25
    v_lshlrev_b32 v25, 16, v25
    v_add_f32 v25, 0x3727c5ac, v25
    v_cvt_pk_bf16_f32 v25, v25, v25
    v_lshlrev_b32 v25, 16, v25
    v_sqrt_f32 v25, v25
    s_nop 0
    v_cvt_pk_bf16_f32 v25, v25, v25
    v_lshlrev_b32 v25, 16, v25
    v_rcp_f32 v25, v25
    s_nop 0
    v_sub_f32 v28, v52, v24
    v_cvt_pk_bf16_f32 v28, v28, v28
    v_lshlrev_b32 v28, 16, v28
    v_mul_f32 v28, v28, v25
    v_cvt_pk_bf16_f32 v28, v28, v28
    v_lshlrev_b32 v28, 16, v28
    v_sub_f32 v29, v53, v24
    v_cvt_pk_bf16_f32 v29, v29, v29
    v_lshlrev_b32 v29, 16, v29
    v_mul_f32 v29, v29, v25
    v_cvt_pk_bf16_f32 v29, v29, v29
    v_lshlrev_b32 v29, 16, v29
    v_sub_f32 v30, v54, v24
    v_cvt_pk_bf16_f32 v30, v30, v30
    v_lshlrev_b32 v30, 16, v30
    v_mul_f32 v30, v30, v25
    v_cvt_pk_bf16_f32 v30, v30, v30
    v_lshlrev_b32 v30, 16, v30
    v_sub_f32 v31, v55, v24
    v_cvt_pk_bf16_f32 v31, v31, v31
    v_lshlrev_b32 v31, 16, v31
    v_mul_f32 v31, v31, v25
    v_cvt_pk_bf16_f32 v31, v31, v31
    v_lshlrev_b32 v31, 16, v31
    v_cvt_pk_bf16_f32 v32, v28, v29
    v_cvt_pk_bf16_f32 v33, v30, v31
    v_cvt_pk_bf16_f32 v34, v52, v53
    v_cvt_pk_bf16_f32 v35, v54, v55
    v_lshlrev_b32 v58, 16, v50
    v_and_b32 v59, 0xffff0000, v50
    v_mul_f32 v36, v28, v58
    v_fmac_f32 v36, v29, v59
    v_lshlrev_b32 v58, 16, v51
    v_and_b32 v59, 0xffff0000, v51
    v_fmac_f32 v36, v30, v58
    v_fmac_f32 v36, v31, v59
    v_mul_f32 v36, v36, v56
    s_nop 1
    v_add_f32_dpp v36, v36, v36 quad_perm:[1,0,3,2] row_mask:0xf bank_mask:0xf
    s_nop 1
    v_add_f32_dpp v36, v36, v36 quad_perm:[2,3,0,1] row_mask:0xf bank_mask:0xf
    s_nop 1
    v_add_f32_dpp v36, v36, v36 row_half_mirror row_mask:0xf bank_mask:0xf
    s_nop 1
    v_add_f32_dpp v36, v36, v36 row_mirror row_mask:0xf bank_mask:0xf
    s_nop 1
    v_readlane_b32 s48, v36, 0
    v_readlane_b32 s49, v36, 16
    v_readlane_b32 s50, v36, 32
    v_readlane_b32 s51, v36, 48
    s_nop 1
    v_mov_b32 v36, s48
    v_add_f32 v36, s49, v36
    v_add_f32 v36, s50, v36
    v_add_f32 v36, s51, v36
    v_lshrrev_b32 v60, 1, v60
    ds_write_b32 v60, v36 offset:29824
    s_mov_b32 exec_lo, -1
    s_mov_b32 exec_hi, 0xff
    ds_write_b64 v62, v[32:33] offset:18944
    ds_write_b64 v62, v[34:35] offset:24320
    s_mov_b64 exec, -1
    s_waitcnt vmcnt(0)
    s_lshr_b32 s48, s53, 1
    s_and_b32 s49, s53, 1
    s_mul_i32 s50, s48, 12288
    s_lshl_b32 s49, s49, 5
    s_add_u32 s50, s50, s49
    s_add_u32 s50, s50, 42496
    v_add_u32 v13, s50, v9
    ds_read_b64_tr_b16 v[40:41], v13 offset:0
    ds_read_b64_tr_b16 v[42:43], v13 offset:256
    ds_read_b64_tr_b16 v[44:45], v13 offset:2048
    ds_read_b64_tr_b16 v[46:47], v13 offset:2304
    ds_read_b64_tr_b16 v[48:49], v13 offset:4096
    ds_read_b64_tr_b16 v[50:51], v13 offset:4352
    ds_read_b64_tr_b16 v[52:53], v13 offset:6144
    ds_read_b64_tr_b16 v[54:55], v13 offset:6400
    ds_read_b64_tr_b16 v[56:57], v13 offset:8192
    ds_read_b64_tr_b16 v[58:59], v13 offset:8448
    ds_read_b64_tr_b16 v[60:61], v13 offset:10240
    ds_read_b64_tr_b16 v[62:63], v13 offset:10496
    s_waitcnt lgkmcnt(0)
    s_barrier
    s_cmp_ge_u32 s53, 2
    s_cbranch_scc1 L_e_pre_done
    v_and_b32 v13, 31, v0
    s_lshl_b32 s48, s55, 5
    v_add_u32 v13, s48, v13
    v_lshrrev_b32 v14, 5, v0
    v_mul_u32_u24 v15, 1344, v14
    v_lshl_add_u32 v15, v13, 1, v15
    v_lshlrev_b32 v12, 4, v14
    ds_read_u16 v70, v15 offset:18944
    ds_read_u16 v71, v15 offset:24320
    ds_read_b128 v[76:79], v12 offset:29824
    v_mul_u32_u24 v14, 640, v14
    v_add_u32 v14, v14, v13
    v_lshlrev_b32 v73, 1, v14
    s_waitcnt lgkmcnt(0)
    v_add_f32 v76, v76, v77
    v_add_f32 v78, v78, v79
    v_add_f32 v72, v76, v78
    v_cvt_pk_bf16_f32 v72, v72, v72
    v_lshlrev_b32 v72, 16, v72
    v_mul_f32 v72, 0xbfb8aa3b, v72
    v_exp_f32 v72, v72
    s_nop 0
    v_add_f32 v72, 1.0, v72
    v_rcp_f32 v72, v72
    s_nop 0
    v_cvt_pk_bf16_f32 v72, v72, v72
    v_lshlrev_b32 v72, 16, v72
    v_lshlrev_b32 v70, 16, v70
    v_lshlrev_b32 v71, 16, v71
L_e_pre_done:
    s_cmp_lt_u32 s53, 4
    s_cbranch_scc1 L_e_wait
L_e_act:
    v_subrev_u32 v15, 256, v0
    v_lshlrev_b32 v12, 4, v15
    v_mul_u32_u24 v13, 43691, v15
    v_lshrrev_b32 v13, 23, v13
    v_mul_u32_u24 v14, 64, v13
    v_add_u32 v14, v14, v12
    s_mov_b32 s45, 0
    s_mov_b32 s46, 360448
    buffer_load_dwordx4 v[80:83], v12, s[32:35], s46 offen sc0 sc1
    s_mov_b32 s46, 376832
    buffer_load_dwordx4 v[84:87], v12, s[32:35], s46 offen sc0 sc1
    s_sleep 10
L_pc_7:
    s_mov_b32 s46, 360448
    buffer_load_dwordx4 v[96:99], v12, s[32:35], s46 offen sc0 sc1
    s_mov_b32 s46, 376832
    buffer_load_dwordx4 v[100:103], v12, s[32:35], s46 offen sc0 sc1
    s_waitcnt vmcnt(2)
    v_max_u32 v15, v80, v81
    v_max3_u32 v15, v15, v82, v83
    v_max3_u32 v15, v15, v84, v85
    v_max3_u32 v15, v15, v86, v87
    v_cmp_eq_u32 vcc, -1, v15
    s_cbranch_vccz L_pc_7_a
    s_mov_b32 s46, 360448
    buffer_load_dwordx4 v[80:83], v12, s[32:35], s46 offen sc0 sc1
    s_mov_b32 s46, 376832
    buffer_load_dwordx4 v[84:87], v12, s[32:35], s46 offen sc0 sc1
    s_waitcnt vmcnt(2)
    v_max_u32 v15, v96, v97
    v_max3_u32 v15, v15, v98, v99
    v_max3_u32 v15, v15, v100, v101
    v_max3_u32 v15, v15, v102, v103
    v_cmp_eq_u32 vcc, -1, v15
    s_cbranch_vccz L_pc_7_b
    s_add_u32 s45, s45, 1
    s_cmp_lt_u32 s45, 0x20000
    s_cbranch_scc1 L_pc_7
L_pc_7_b:
    v_lshlrev_b32 v24, 16, v96
    v_and_b32 v25, 0xffff0000, v96
    v_lshlrev_b32 v26, 16, v100
    v_and_b32 v27, 0xffff0000, v100
    v_mul_f32 v24, v24, v26
    v_mul_f32 v25, v25, v27
    v_cvt_pk_bf16_f32 v32, v24, v25
    v_lshlrev_b32 v24, 16, v97
    v_and_b32 v25, 0xffff0000, v97
    v_lshlrev_b32 v26, 16, v101
    v_and_b32 v27, 0xffff0000, v101
    v_mul_f32 v24, v24, v26
    v_mul_f32 v25, v25, v27
    v_cvt_pk_bf16_f32 v33, v24, v25
    v_lshlrev_b32 v24, 16, v98
    v_and_b32 v25, 0xffff0000, v98
    v_lshlrev_b32 v26, 16, v102
    v_and_b32 v27, 0xffff0000, v102
    v_mul_f32 v24, v24, v26
    v_mul_f32 v25, v25, v27
    v_cvt_pk_bf16_f32 v34, v24, v25
    v_lshlrev_b32 v24, 16, v99
    v_and_b32 v25, 0xffff0000, v99
    v_lshlrev_b32 v26, 16, v103
    v_and_b32 v27, 0xffff0000, v103
    v_mul_f32 v24, v24, v26
    v_mul_f32 v25, v25, v27
    v_cvt_pk_bf16_f32 v35, v24, v25
    s_branch L_pc_7_e
L_pc_7_a:
    v_lshlrev_b32 v24, 16, v80
    v_and_b32 v25, 0xffff0000, v80
    v_lshlrev_b32 v26, 16, v84
    v_and_b32 v27, 0xffff0000, v84
    v_mul_f32 v24, v24, v26
    v_mul_f32 v25, v25, v27
    v_cvt_pk_bf16_f32 v32, v24, v25
    v_lshlrev_b32 v24, 16, v81
    v_and_b32 v25, 0xffff0000, v81
    v_lshlrev_b32 v26, 16, v85
    v_and_b32 v27, 0xffff0000, v85
    v_mul_f32 v24, v24, v26
    v_mul_f32 v25, v25, v27
    v_cvt_pk_bf16_f32 v33, v24, v25
    v_lshlrev_b32 v24, 16, v82
    v_and_b32 v25, 0xffff0000, v82
    v_lshlrev_b32 v26, 16, v86
    v_and_b32 v27, 0xffff0000, v86
    v_mul_f32 v24, v24, v26
    v_mul_f32 v25, v25, v27
    v_cvt_pk_bf16_f32 v34, v24, v25
    v_lshlrev_b32 v24, 16, v83
    v_and_b32 v25, 0xffff0000, v83
    v_lshlrev_b32 v26, 16, v87
    v_and_b32 v27, 0xffff0000, v87
    v_mul_f32 v24, v24, v26
    v_mul_f32 v25, v25, v27
    v_cvt_pk_bf16_f32 v35, v24, v25
L_pc_7_e:
    ds_write_b128 v14, v[32:35] offset:29952
L_e_wait:
    s_waitcnt lgkmcnt(0)
    s_barrier
    s_lshr_b32 s48, s53, 1
    s_mul_i32 s50, s48, 384
    s_add_u32 s50, s50, 29952
    v_add_u32 v12, s50, v8
    ds_read_b128 v[16:19], v12 offset:0
    ds_read_b128 v[20:23], v12 offset:64
    ds_read_b128 v[24:27], v12 offset:128
    ds_read_b128 v[28:31], v12 offset:192
    ds_read_b128 v[32:35], v12 offset:256
    ds_read_b128 v[36:39], v12 offset:320
    s_waitcnt lgkmcnt(5)
    v_mfma_f32_16x16x32_bf16 v[64:67], v[16:19], v[40:43], 0
    s_waitcnt lgkmcnt(4)
    v_mfma_f32_16x16x32_bf16 v[64:67], v[20:23], v[44:47], v[64:67]
    s_waitcnt lgkmcnt(3)
    v_mfma_f32_16x16x32_bf16 v[64:67], v[24:27], v[48:51], v[64:67]
    s_waitcnt lgkmcnt(2)
    v_mfma_f32_16x16x32_bf16 v[64:67], v[28:31], v[52:55], v[64:67]
    s_waitcnt lgkmcnt(1)
    v_mfma_f32_16x16x32_bf16 v[64:67], v[32:35], v[56:59], v[64:67]
    s_waitcnt lgkmcnt(0)
    v_mfma_f32_16x16x32_bf16 v[64:67], v[36:39], v[60:63], v[64:67]
    s_nop 15
    s_lshr_b32 s48, s53, 1
    s_and_b32 s49, s53, 1
    s_mul_i32 s48, s48, 512
    s_lshl_b32 s49, s49, 6
    s_add_u32 s48, s48, s49
    v_lshlrev_b32 v12, 2, v6
    v_add_u32 v12, s48, v12
    s_mov_b64 exec, 0xffff
    ds_write_b32 v12, v64 offset:13824
    ds_write_b32 v12, v65 offset:13952
    ds_write_b32 v12, v66 offset:14080
    ds_write_b32 v12, v67 offset:14208
    s_mov_b64 exec, -1
    s_waitcnt lgkmcnt(0)
    s_barrier
    s_cmp_ge_u32 s53, 2
    s_cbranch_scc1 L_done
    v_lshlrev_b32 v12, 2, v0
    ds_read_b32 v16, v12 offset:13824
    ds_read_b32 v17, v12 offset:14336
    ds_read_b32 v18, v12 offset:14848
    ds_read_b32 v19, v12 offset:15360
    ds_read_b32 v20, v12 offset:15872
    ds_read_b32 v21, v12 offset:16384
    ds_read_b32 v22, v12 offset:16896
    ds_read_b32 v23, v12 offset:17408
    s_waitcnt lgkmcnt(0)
    v_add_f32 v16, v16, v20
    v_add_f32 v17, v17, v21
    v_add_f32 v18, v18, v22
    v_add_f32 v19, v19, v23
    v_add_f32 v16, v16, v18
    v_add_f32 v17, v17, v19
    v_add_f32 v16, v16, v17
    v_cvt_pk_bf16_f32 v16, v16, v16
    v_lshlrev_b32 v16, 16, v16
    v_mul_f32 v16, v16, v72
    v_cvt_pk_bf16_f32 v16, v16, v16
    v_lshlrev_b32 v16, 16, v16
    v_add_f32 v16, v70, v16
    v_cvt_pk_bf16_f32 v16, v16, v16
    v_lshlrev_b32 v16, 16, v16
    v_add_f32 v16, v71, v16
    v_cvt_pk_bf16_f32 v16, v16, v16
    buffer_store_short v16, v73, s[76:79], 0 offen
    s_endpgm
L_tail_d:
    v_and_b32 v12, 15, v6
    v_min_u32 v12, 4, v12
    v_mul_u32_u24 v8, 1344, v12
    v_and_b32 v12, 3, v6
    v_lshlrev_b32 v9, 3, v12
    v_lshrrev_b32 v12, 4, v6
    v_lshl_add_u32 v8, v12, 4, v8
    v_mul_u32_u24 v12, 1024, v12
    v_add_u32 v9, v9, v12
    v_bfe_u32 v12, v6, 2, 2
    v_mul_u32_u24 v12, 128, v12
    v_add_u32 v9, v9, v12
    v_cmp_gt_u32 vcc, 320, v0
    s_and_saveexec_b64 s[100:101], vcc
    v_lshlrev_b32 v12, 2, v0
    v_mov_b32 v13, 0x3f803f80
    ds_write_b32 v12, v13 offset:24320
    s_mov_b64 exec, s[100:101]
    s_waitcnt vmcnt(0) lgkmcnt(0)
    s_barrier
    s_lshr_b32 s48, s53, 2
    s_and_b32 s49, s53, 3
    s_mul_i32 s50, s48, 20480
    s_lshl_b32 s49, s49, 5
    s_add_u32 s50, s50, s49
    s_add_u32 s50, s50, 42496
    v_add_u32 v13, s50, v9
    ds_read_b64_tr_b16 v[16:17], v13 offset:0
    ds_read_b64_tr_b16 v[18:19], v13 offset:512
    ds_read_b64_tr_b16 v[20:21], v13 offset:4096
    ds_read_b64_tr_b16 v[22:23], v13 offset:4608
    ds_read_b64_tr_b16 v[24:25], v13 offset:8192
    ds_read_b64_tr_b16 v[26:27], v13 offset:8704
    ds_read_b64_tr_b16 v[28:29], v13 offset:12288
    ds_read_b64_tr_b16 v[30:31], v13 offset:12800
    ds_read_b64_tr_b16 v[32:33], v13 offset:16384
    ds_read_b64_tr_b16 v[34:35], v13 offset:16896
    s_min_u32 s48, s53, 9
    s_lshl_b32 s48, s48, 8
    v_lshlrev_b32 v57, 2, v6
    v_add_u32 v57, s48, v57
    v_lshlrev_b32 v58, 1, v57
    buffer_load_dwordx2 v[48:49], v58, s[56:59], 0 offen
    v_lshrrev_b32 v60, 7, v57
    v_lshlrev_b32 v63, 3, v60
    v_mul_u32_u24 v60, 52, v60
    v_lshrrev_b32 v60, 8, v60
    v_mul_u32_u24 v62, 64, v60
    v_add_u32 v62, v62, v58
    v_lshlrev_b32 v59, 2, v57
    s_waitcnt vmcnt(0)
    v_and_b32 v51, 0xffff0000, v49
    v_lshlrev_b32 v50, 16, v49
    v_and_b32 v49, 0xffff0000, v48
    v_lshlrev_b32 v48, 16, v48
    s_cmp_lg_u32 s53, 0
    s_cbranch_scc1 L_d_gate_done
    s_lshl_b32 s44, s2, 7
    s_add_u32 s44, s44, 458752
    v_mov_b32 v122, 0
    s_mov_b32 s45, 0
    buffer_load_dword v123, v122, s[32:35], s44 offen sc0 sc1
L_gate_8:
    s_sleep 6
    buffer_load_dword v124, v122, s[32:35], s44 offen sc0 sc1
    s_waitcnt vmcnt(1)
    v_cmp_ne_u32 vcc, 1, v123
    s_cbranch_vccz L_gate_8_ok
    s_sleep 6
    buffer_load_dword v123, v122, s[32:35], s44 offen sc0 sc1
    s_waitcnt vmcnt(1)
    v_cmp_ne_u32 vcc, 1, v124
    s_add_u32 s45, s45, 1
    s_cbranch_vccz L_gate_8_ok
    s_cmp_lt_u32 s45, 0x20000
    s_cbranch_scc1 L_gate_8
L_gate_8_ok:
L_d_gate_done:
    s_barrier
    s_cmp_ge_u32 s53, 10
    s_cbranch_scc1 L_d10_skip
    s_mov_b32 s45, 0
    s_mov_b32 s44, 262144
    buffer_load_dwordx4 v[64:67], v59, s[32:35], s44 offen sc0 sc1
    s_add_u32 s44, s44, 10240
    buffer_load_dwordx4 v[68:71], v59, s[32:35], s44 offen sc0 sc1
    s_add_u32 s44, s44, 10240
    buffer_load_dwordx4 v[72:75], v59, s[32:35], s44 offen sc0 sc1
    s_add_u32 s44, s44, 10240
    buffer_load_dwordx4 v[76:79], v59, s[32:35], s44 offen sc0 sc1
    s_add_u32 s44, s44, 10240
    buffer_load_dwordx4 v[80:83], v59, s[32:35], s44 offen sc0 sc1
    s_add_u32 s44, s44, 10240
    buffer_load_dwordx4 v[84:87], v59, s[32:35], s44 offen sc0 sc1
    s_add_u32 s44, s44, 10240
    buffer_load_dwordx4 v[88:91], v59, s[32:35], s44 offen sc0 sc1
    s_add_u32 s44, s44, 10240
    buffer_load_dwordx4 v[92:95], v59, s[32:35], s44 offen sc0 sc1
    s_sleep 10
L_pc_9:
    s_mov_b32 s44, 262144
    buffer_load_dwordx4 v[96:99], v59, s[32:35], s44 offen sc0 sc1
    s_add_u32 s44, s44, 10240
    buffer_load_dwordx4 v[100:103], v59, s[32:35], s44 offen sc0 sc1
    s_add_u32 s44, s44, 10240
    buffer_load_dwordx4 v[104:107], v59, s[32:35], s44 offen sc0 sc1
    s_add_u32 s44, s44, 10240
    buffer_load_dwordx4 v[108:111], v59, s[32:35], s44 offen sc0 sc1
    s_add_u32 s44, s44, 10240
    buffer_load_dwordx4 v[112:115], v59, s[32:35], s44 offen sc0 sc1
    s_add_u32 s44, s44, 10240
    buffer_load_dwordx4 v[116:119], v59, s[32:35], s44 offen sc0 sc1
    s_add_u32 s44, s44, 10240
    buffer_load_dwordx4 v[120:123], v59, s[32:35], s44 offen sc0 sc1
    s_add_u32 s44, s44, 10240
    buffer_load_dwordx4 v[124:127], v59, s[32:35], s44 offen sc0 sc1
    s_waitcnt vmcnt(8)
    v_max_u32 v60, v64, v65
    v_max3_u32 v60, v60, v66, v67
    v_max3_u32 v60, v60, v68, v69
    v_max3_u32 v60, v60, v70, v71
    v_max3_u32 v60, v60, v72, v73
    v_max3_u32 v60, v60, v74, v75
    v_max3_u32 v60, v60, v76, v77
    v_max3_u32 v60, v60, v78, v79
    v_max3_u32 v60, v60, v80, v81
    v_max3_u32 v60, v60, v82, v83
    v_max3_u32 v60, v60, v84, v85
    v_max3_u32 v60, v60, v86, v87
    v_max3_u32 v60, v60, v88, v89
    v_max3_u32 v60, v60, v90, v91
    v_max3_u32 v60, v60, v92, v93
    v_max3_u32 v60, v60, v94, v95
    v_cmp_eq_u32 vcc, -1, v60
    s_cbranch_vccz L_pc_9_a
    s_mov_b32 s44, 262144
    buffer_load_dwordx4 v[64:67], v59, s[32:35], s44 offen sc0 sc1
    s_add_u32 s44, s44, 10240
    buffer_load_dwordx4 v[68:71], v59, s[32:35], s44 offen sc0 sc1
    s_add_u32 s44, s44, 10240
    buffer_load_dwordx4 v[72:75], v59, s[32:35], s44 offen sc0 sc1
    s_add_u32 s44, s44, 10240
    buffer_load_dwordx4 v[76:79], v59, s[32:35], s44 offen sc0 sc1
    s_add_u32 s44, s44, 10240
    buffer_load_dwordx4 v[80:83], v59, s[32:35], s44 offen sc0 sc1
    s_add_u32 s44, s44, 10240
    buffer_load_dwordx4 v[84:87], v59, s[32:35], s44 offen sc0 sc1
    s_add_u32 s44, s44, 10240
    buffer_load_dwordx4 v[88:91], v59, s[32:35], s44 offen sc0 sc1
    s_add_u32 s44, s44, 10240
    buffer_load_dwordx4 v[92:95], v59, s[32:35], s44 offen sc0 sc1
    s_waitcnt vmcnt(8)
    v_max_u32 v60, v96, v97
    v_max3_u32 v60, v60, v98, v99
    v_max3_u32 v60, v60, v100, v101
    v_max3_u32 v60, v60, v102, v103
    v_max3_u32 v60, v60, v104, v105
    v_max3_u32 v60, v60, v106, v107
    v_max3_u32 v60, v60, v108, v109
    v_max3_u32 v60, v60, v110, v111
    v_max3_u32 v60, v60, v112, v113
    v_max3_u32 v60, v60, v114, v115
    v_max3_u32 v60, v60, v116, v117
    v_max3_u32 v60, v60, v118, v119
    v_max3_u32 v60, v60, v120, v121
    v_max3_u32 v60, v60, v122, v123
    v_max3_u32 v60, v60, v124, v125
    v_max3_u32 v60, v60, v126, v127
    v_cmp_eq_u32 vcc, -1, v60
    s_cbranch_vccz L_pc_9_b
    s_add_u32 s45, s45, 1
    s_cmp_lt_u32 s45, 0x20000
    s_cbranch_scc1 L_pc_9
L_pc_9_b:
    v_add_f32 v96, v96, v112
    v_add_f32 v100, v100, v116
    v_add_f32 v104, v104, v120
    v_add_f32 v108, v108, v124
    v_add_f32 v97, v97, v113
    v_add_f32 v101, v101, v117
    v_add_f32 v105, v105, v121
    v_add_f32 v109, v109, v125
    v_add_f32 v98, v98, v114
    v_add_f32 v102, v102, v118
    v_add_f32 v106, v106, v122
    v_add_f32 v110, v110, v126
    v_add_f32 v99, v99, v115
    v_add_f32 v103, v103, v119
    v_add_f32 v107, v107, v123
    v_add_f32 v111, v111, v127
    v_add_f32 v96, v96, v100
    v_add_f32 v104, v104, v108
    v_add_f32 v97, v97, v101
    v_add_f32 v105, v105, v109
    v_add_f32 v98, v98, v102
    v_add_f32 v106, v106, v110
    v_add_f32 v99, v99, v103
    v_add_f32 v107, v107, v111
    v_add_f32 v52, v96, v104
    v_add_f32 v53, v97, v105
    v_add_f32 v54, v98, v106
    v_add_f32 v55, v99, v107
    s_branch L_pc_9_e
L_pc_9_a:
    v_add_f32 v64, v64, v80
    v_add_f32 v68, v68, v84
    v_add_f32 v72, v72, v88
    v_add_f32 v76, v76, v92
    v_add_f32 v65, v65, v81
    v_add_f32 v69, v69, v85
    v_add_f32 v73, v73, v89
    v_add_f32 v77, v77, v93
    v_add_f32 v66, v66, v82
    v_add_f32 v70, v70, v86
    v_add_f32 v74, v74, v90
    v_add_f32 v78, v78, v94
    v_add_f32 v67, v67, v83
    v_add_f32 v71, v71, v87
    v_add_f32 v75, v75, v91
    v_add_f32 v79, v79, v95
    v_add_f32 v64, v64, v68
    v_add_f32 v72, v72, v76
    v_add_f32 v65, v65, v69
    v_add_f32 v73, v73, v77
    v_add_f32 v66, v66, v70
    v_add_f32 v74, v74, v78
    v_add_f32 v67, v67, v71
    v_add_f32 v75, v75, v79
    v_add_f32 v52, v64, v72
    v_add_f32 v53, v65, v73
    v_add_f32 v54, v66, v74
    v_add_f32 v55, v67, v75
L_pc_9_e:
    v_cvt_pk_bf16_f32 v52, v52, v52
    v_lshlrev_b32 v52, 16, v52
    v_cvt_pk_bf16_f32 v53, v53, v53
    v_lshlrev_b32 v53, 16, v53
    v_cvt_pk_bf16_f32 v54, v54, v54
    v_lshlrev_b32 v54, 16, v54
    v_cvt_pk_bf16_f32 v55, v55, v55
    v_lshlrev_b32 v55, 16, v55
    v_add_f32 v52, v52, v48
    v_add_f32 v53, v53, v49
    v_add_f32 v54, v54, v50
    v_add_f32 v55, v55, v51
    v_cvt_pk_bf16_f32 v60, v52, v53
    v_cvt_pk_bf16_f32 v61, v54, v55
    ds_write_b64 v62, v[60:61] offset:18944
    s_mov_b32 vcc_lo, 0
    s_mov_b32 vcc_hi, -1
    v_lshlrev_b32 v52, 16, v60
    v_and_b32 v53, 0xffff0000, v60
    v_lshlrev_b32 v54, 16, v61
    v_and_b32 v55, 0xffff0000, v61
    v_add_f32 v58, v52, v53
    v_add_f32 v59, v54, v55
    v_add_f32 v58, v58, v59
    s_nop 1
    v_add_f32_dpp v58, v58, v58 quad_perm:[1,0,3,2] row_mask:0xf bank_mask:0xf
    s_nop 1
    v_add_f32_dpp v58, v58, v58 quad_perm:[2,3,0,1] row_mask:0xf bank_mask:0xf
    s_nop 1
    v_add_f32_dpp v58, v58, v58 row_half_mirror row_mask:0xf bank_mask:0xf
    s_nop 1
    v_add_f32_dpp v58, v58, v58 row_mirror row_mask:0xf bank_mask:0xf
    s_nop 1
    v_add_f32_dpp v58, v58, v58 row_bcast:15 row_mask:0xa bank_mask:0xf
    s_nop 1
    v_readlane_b32 s44, v58, 16
    v_readlane_b32 s45, v58, 48
    s_nop 1
    v_mov_b32 v58, s44
    v_mov_b32 v60, s45
    v_cndmask_b32 v58, v58, v60, vcc
    v_mul_f32 v58, 0x3c000000, v58
    v_sub_f32 v60, v52, v58
    v_mul_f32 v59, v60, v60
    v_sub_f32 v60, v53, v58
    v_fmac_f32 v59, v60, v60
    v_sub_f32 v60, v54, v58
    v_fmac_f32 v59, v60, v60
    v_sub_f32 v60, v55, v58
    v_fmac_f32 v59, v60, v60
    s_nop 1
    v_add_f32_dpp v59, v59, v59 quad_perm:[1,0,3,2] row_mask:0xf bank_mask:0xf
    s_nop 1
    v_add_f32_dpp v59, v59, v59 quad_perm:[2,3,0,1] row_mask:0xf bank_mask:0xf
    s_nop 1
    v_add_f32_dpp v59, v59, v59 row_half_mirror row_mask:0xf bank_mask:0xf
    s_nop 1
    v_add_f32_dpp v59, v59, v59 row_mirror row_mask:0xf bank_mask:0xf
    s_nop 1
    v_add_f32_dpp v59, v59, v59 row_bcast:15 row_mask:0xa bank_mask:0xf
    s_nop 1
    v_readlane_b32 s44, v59, 16
    v_readlane_b32 s45, v59, 48
    s_nop 1
    v_mov_b32 v59, s44
    v_mov_b32 v60, s45
    v_cndmask_b32 v59, v59, v60, vcc
    ds_write_b64 v63, v[58:59] offset:29696
L_d10_skip:
    s_waitcnt lgkmcnt(0)
    s_barrier
    s_lshr_b32 s48, s53, 2
    s_mul_i32 s50, s48, 320
    s_add_u32 s50, s50, 18944
    v_add_u32 v12, s50, v8
    s_cmp_ge_u32 s53, 4
    s_cbranch_scc1 L_d_h1
    s_mul_i32 s49, s53, 40
    v_mov_b32 v60, s49
    ds_read_b64 v[2:3], v60 offset:29696
    ds_read_b64 v[4:5], v60 offset:29704
    ds_read_b64 v[10:11], v60 offset:29712
    ds_read_b64 v[14:15], v60 offset:29720
    ds_read_b64 v[62:63], v60 offset:29728
L_d_h1:
    ds_read_b128 v[36:39], v12 offset:0
    ds_read_b128 v[40:43], v12 offset:64
    ds_read_b128 v[44:47], v12 offset:128
    ds_read_b128 v[48:51], v12 offset:192
    ds_read_b128 v[52:55], v12 offset:256
    s_cmp_ge_u32 s53, 4
    s_cbranch_scc1 L_d_h2
    s_waitcnt lgkmcnt(5)
    v_add_f32 v1, v2, v4
    v_add_f32 v12, v10, v14
    v_add_f32 v1, v1, v12
    v_add_f32 v1, v1, v62
    v_mul_f32 v60, 0x3e4ccccd, v1
    v_add_f32 v12, v3, v5
    v_add_f32 v13, v11, v15
    v_add_f32 v12, v12, v13
    v_add_f32 v12, v12, v63
    v_sub_f32 v2, v2, v60
    v_sub_f32 v4, v4, v60
    v_sub_f32 v10, v10, v60
    v_sub_f32 v14, v14, v60
    v_sub_f32 v62, v62, v60
    v_mul_f32 v13, v2, v2
    v_fmac_f32 v13, v4, v4
    v_fmac_f32 v13, v10, v10
    v_fmac_f32 v13, v14, v14
    v_fmac_f32 v13, v62, v62
    v_mov_b32 v1, 0x43000000
    v_fmac_f32 v12, v13, v1
    v_mul_f32 v61, 0x3acccccd, v12
    v_cvt_pk_bf16_f32 v60, v60, v60
    v_lshlrev_b32 v60, 16, v60
    v_cvt_pk_bf16_f32 v61, v61, v61
    v_lshlrev_b32 v61, 16, v61
    v_add_f32 v61, 0x3727c5ac, v61
    v_cvt_pk_bf16_f32 v61, v61, v61
    v_lshlrev_b32 v61, 16, v61
    v_sqrt_f32 v61, v61
    s_nop 0
    v_cvt_pk_bf16_f32 v61, v61, v61
    v_lshlrev_b32 v61, 16, v61
    v_rcp_f32 v61, v61
L_d_h2:
    s_waitcnt lgkmcnt(4)
    v_mfma_f32_16x16x32_bf16 v[56:59], v[36:39], v[16:19], 0
    s_waitcnt lgkmcnt(3)
    v_mfma_f32_16x16x32_bf16 v[56:59], v[40:43], v[20:23], v[56:59]
    s_waitcnt lgkmcnt(2)
    v_mfma_f32_16x16x32_bf16 v[56:59], v[44:47], v[24:27], v[56:59]
    s_waitcnt lgkmcnt(1)
    v_mfma_f32_16x16x32_bf16 v[56:59], v[48:51], v[28:31], v[56:59]
    s_waitcnt lgkmcnt(0)
    v_mfma_f32_16x16x32_bf16 v[56:59], v[52:55], v[32:35], v[56:59]
    s_nop 15
    s_lshr_b32 s48, s53, 2
    s_and_b32 s49, s53, 3
    s_mul_i32 s48, s48, 1280
    s_lshl_b32 s49, s49, 6
    s_add_u32 s48, s48, s49
    v_lshlrev_b32 v12, 2, v6
    v_add_u32 v12, s48, v12
    s_mov_b64 exec, 0xffff
    ds_write_b32 v12, v56 offset:13824
    ds_write_b32 v12, v57 offset:14080
    ds_write_b32 v12, v58 offset:14336
    ds_write_b32 v12, v59 offset:14592
    s_mov_b64 exec, 0xffff0000
    ds_write_b32 v12, v56 offset:14784
    s_mov_b64 exec, -1
    s_waitcnt lgkmcnt(0)
    s_barrier
    s_cmp_ge_u32 s53, 4
    s_cbranch_scc1 L_done
    v_lshlrev_b32 v12, 2, v0
    v_lshlrev_b32 v13, 2, v6
    ds_read_b32 v16, v12 offset:13824
    ds_read_b32 v17, v12 offset:15104
    ds_read_b32 v18, v12 offset:16384
    ds_read_b32 v19, v12 offset:17664
    ds_read_b32 v20, v13 offset:14848
    ds_read_b32 v21, v13 offset:16128
    ds_read_b32 v22, v13 offset:17408
    ds_read_b32 v23, v13 offset:18688
    s_waitcnt lgkmcnt(0)
    v_add_f32 v16, v16, v17
    v_add_f32 v20, v20, v21
    v_add_f32 v18, v18, v19
    v_add_f32 v22, v22, v23
    v_add_f32 v16, v16, v18
    v_add_f32 v20, v20, v22
    v_fma_f32 v16, -v60, v20, v16
    v_mul_f32 v16, v16, v61
    s_cmp_lg_u32 s54, 0
    s_cbranch_scc1 L_d_nosilu
    v_cvt_pk_bf16_f32 v16, v16, v16
    v_lshlrev_b32 v16, 16, v16
    v_mul_f32 v18, 0xbfb8aa3b, v16
    v_exp_f32 v18, v18
    s_nop 0
    v_add_f32 v18, 1.0, v18
    v_rcp_f32 v18, v18
    s_nop 0
    v_mul_f32 v16, v16, v18
L_d_nosilu:
    s_nop 1
    v_mov_b32_dpp v17, v16 quad_perm:[1,0,3,2] row_mask:0xf bank_mask:0xf
    v_cvt_pk_bf16_f32 v16, v16, v17
    v_mul_u32_u24 v12, 3072, v7
    v_lshl_add_u32 v12, v6, 1, v12
    s_mul_i32 s48, s54, 16384
    s_lshl_b32 s49, s55, 7
    s_add_u32 s48, s48, s49
    s_add_u32 s48, s48, 360448
    s_mov_b32 exec_lo, 0x55555555
    s_mov_b32 exec_hi, 0x55555555
    buffer_store_dword v16, v12, s[32:35], s48 offen sc0 sc1
    s_mov_b64 exec, -1
L_done:
    s_endpgm
.section .rodata,"a"
.p2align 6
.amdhsa_kernel sequential_preLN__mha_block_cached__moe_arch_mod__decode_kernel
  .amdhsa_next_free_vgpr 128
  .amdhsa_next_free_sgpr 102
  .amdhsa_accum_offset 128
  .amdhsa_group_segment_fixed_size 0
  .amdhsa_kernarg_size 104
  .amdhsa_user_sgpr_count 2
  .amdhsa_user_sgpr_kernarg_segment_ptr 1
  .amdhsa_system_sgpr_workgroup_id_x 1
.end_amdhsa_kernel
```

```asm
; @launch grid=(256,1,1) block=(1024,1,1) lds=140800
.amdgcn_target "amdgcn-amd-amdhsa--gfx950"
.text
.globl sequential_preLN__mha_block_cached__moe_arch_mod__decode_kernel
.p2align 8
.type sequential_preLN__mha_block_cached__moe_arch_mod__decode_kernel,@function
sequential_preLN__mha_block_cached__moe_arch_mod__decode_kernel:
    s_cmp_ge_u32 s2, 256
    s_cbranch_scc1 L_done
    s_load_dwordx2 s[4:5], s[0:1], 0
    s_load_dwordx4 s[8:11], s[0:1], 8
    s_load_dwordx4 s[12:15], s[0:1], 24
    s_load_dwordx4 s[80:83], s[0:1], 48
    s_load_dwordx4 s[84:87], s[0:1], 64
    s_load_dwordx4 s[88:91], s[0:1], 80
    s_load_dwordx2 s[6:7], s[0:1], 96
    s_and_b32 s42, s2, 7
    s_lshr_b32 s43, s2, 3
    s_and_b32 s44, s43, 3
    s_lshl_b32 s45, s42, 2
    s_add_u32 s45, s45, s44
    s_lshr_b32 s44, s43, 2
    s_lshr_b32 s46, s44, 1
    s_and_b32 s47, s44, 1
    s_lshl_b32 s40, s46, 5
    s_add_u32 s40, s40, s45
    s_lshl_b32 s40, s40, 1
    s_add_u32 s40, s40, s47
    s_mul_i32 s41, s40, 1572864
    s_lshr_b32 s99, s45, 3
    s_mov_b32 s96, 1572864
    v_and_b32 v6, 63, v0
    v_lshrrev_b32 v2, 6, v0
    v_lshrrev_b32 v3, 3, v6
    v_and_b32 v4, 7, v6
    v_readfirstlane_b32 s53, v2
    v_lshlrev_b32 v4, 4, v4
    v_mul_u32_u24 v5, 384, v3
    v_add_u32 v1, v5, v4
    v_mul_u32_u24 v5, 40, v2
    v_add_u32 v5, v5, v3
    v_mul_u32_u24 v7, 12288, v5
    v_add_u32 v7, v7, v4
    v_lshlrev_b32 v8, 1, v5
    v_lshlrev_b32 v5, 2, v6
    s_waitcnt lgkmcnt(0)
    s_mov_b32 s56, s4
    s_and_b32 s57, s5, 0xffff
    s_mov_b32 s58, 0x1400
    s_mov_b32 s59, 0x00020000
    s_mul_i32 s48, s46, 1280
    s_add_u32 s4, s4, s48
    s_addc_u32 s5, s5, 0
    s_mov_b32 s28, s4
    s_and_b32 s29, s5, 0xffff
    s_mov_b32 s30, 0x500
    s_mov_b32 s31, 0x00020000
    s_mul_i32 s48, s45, 384
    s_add_u32 s12, s12, s48
    s_addc_u32 s13, s13, 0
    s_sub_u32 s49, 7864320, s48
    s_mov_b32 s24, s12
    s_and_b32 s25, s13, 0xffff
    s_mov_b32 s26, s49
    s_mov_b32 s27, 0x00020000
    s_add_u32 s8, s8, s41
    s_addc_u32 s9, s9, 0
    s_mov_b32 s16, s8
    s_and_b32 s17, s9, 0xffff
    s_mov_b32 s18, s96
    s_mov_b32 s19, 0x00020000
    s_mov_b32 s99, s41
    v_mov_b32 v3, 12928
    v_mov_b32 v4, 16
    ds_write_b32 v3, v4
    s_mul_i32 s41, s53, 24576
    buffer_load_dword v46, v5, s[28:31], 0 offen offset:0
    buffer_load_dword v47, v5, s[28:31], 0 offen offset:256
    buffer_load_dword v48, v5, s[28:31], 0 offen offset:512
    buffer_load_dword v49, v5, s[28:31], 0 offen offset:768
    buffer_load_dword v50, v5, s[28:31], 0 offen offset:1024
    buffer_load_ushort v51, v8, s[28:31], 0 offen offset:0
    buffer_load_ushort v52, v8, s[28:31], 0 offen offset:16
    buffer_load_ushort v53, v8, s[28:31], 0 offen offset:32
    buffer_load_ushort v126, v8, s[28:31], 0 offen offset:48
    buffer_load_ushort v127, v8, s[28:31], 0 offen offset:64
    s_mov_b32 s48, 0
    buffer_load_dwordx4 v[102:105], v7, s[24:27], s48 offen offset:0 nt
    buffer_load_dwordx4 v[106:109], v7, s[24:27], s48 offen offset:128 nt
    buffer_load_dwordx4 v[110:113], v7, s[24:27], s48 offen offset:256 nt
    s_mov_b32 s48, 98304
    buffer_load_dwordx4 v[114:117], v7, s[24:27], s48 offen offset:0 nt
    buffer_load_dwordx4 v[118:121], v7, s[24:27], s48 offen offset:128 nt
    buffer_load_dwordx4 v[122:125], v7, s[24:27], s48 offen offset:256 nt
    s_add_u32 s48, s41, 0
    buffer_load_dwordx4 v[78:81], v1, s[16:19], s48 offen offset:0 nt
    buffer_load_dwordx4 v[82:85], v1, s[16:19], s48 offen offset:128 nt
    buffer_load_dwordx4 v[86:89], v1, s[16:19], s48 offen offset:256 nt
    s_mov_b32 s48, 196608
    buffer_load_dwordx4 v[10:13], v7, s[24:27], s48 offen offset:0 nt
    buffer_load_dwordx4 v[14:17], v7, s[24:27], s48 offen offset:128 nt
    buffer_load_dwordx4 v[18:21], v7, s[24:27], s48 offen offset:256 nt
    s_add_u32 s48, s41, 3072
    buffer_load_dwordx4 v[90:93], v1, s[16:19], s48 offen offset:0 nt
    buffer_load_dwordx4 v[94:97], v1, s[16:19], s48 offen offset:128 nt
    buffer_load_dwordx4 v[98:101], v1, s[16:19], s48 offen offset:256 nt
    s_mov_b32 s48, 294912
    buffer_load_dwordx4 v[22:25], v7, s[24:27], s48 offen offset:0 nt
    buffer_load_dwordx4 v[26:29], v7, s[24:27], s48 offen offset:128 nt
    buffer_load_dwordx4 v[30:33], v7, s[24:27], s48 offen offset:256 nt
    s_mov_b32 s48, 393216
    buffer_load_dwordx4 v[34:37], v7, s[24:27], s48 offen offset:0 nt
    buffer_load_dwordx4 v[38:41], v7, s[24:27], s48 offen offset:128 nt
    buffer_load_dwordx4 v[42:45], v7, s[24:27], s48 offen offset:256 nt
    s_add_u32 s10, s10, s99
    s_addc_u32 s11, s11, 0
    s_mov_b32 s20, s10
    s_and_b32 s21, s11, 0xffff
    s_mov_b32 s22, s96
    s_mov_b32 s23, 0x00020000
    s_mov_b32 s32, s6
    s_and_b32 s33, s7, 0xffff
    s_mov_b32 s34, 0x200000
    s_mov_b32 s35, 0x00020000
    s_mov_b32 s36, s90
    s_and_b32 s37, s91, 0xffff
    s_mov_b32 s38, 0x100
    s_mov_b32 s39, 0x00020000
    s_mov_b32 s60, s14
    s_and_b32 s61, s15, 0xffff
    s_mov_b32 s62, 0x780000
    s_mov_b32 s63, 0x00020000
    s_mov_b32 s64, s82
    s_and_b32 s65, s83, 0xffff
    s_mov_b32 s66, 0x1e0000
    s_mov_b32 s67, 0x00020000
    s_mov_b32 s92, s84
    s_and_b32 s93, s85, 0xffff
    s_mov_b32 s94, 0x1e0000
    s_mov_b32 s95, 0x00020000
    s_mov_b32 s68, s86
    s_and_b32 s69, s87, 0xffff
    s_mov_b32 s70, 0x1e0000
    s_mov_b32 s71, 0x00020000
    s_mov_b32 s72, s80
    s_and_b32 s73, s81, 0xffff
    s_mov_b32 s74, 0x500
    s_mov_b32 s75, 0x00020000
    s_mov_b32 s76, s88
    s_and_b32 s77, s89, 0xffff
    s_mov_b32 s78, 0x1400
    s_mov_b32 s79, 0x00020000
    s_mul_i32 s48, s2, 6554
    s_lshr_b32 s54, s48, 16
    s_mul_i32 s48, s54, 10
    s_sub_u32 s55, s2, s48
    s_mov_b32 s98, 0
    s_cmp_lt_u32 s2, 80
    s_cbranch_scc1 L_role_1
    s_mov_b32 s98, 1
    s_sub_u32 s55, s2, 80
    s_cmp_ge_u32 s55, 24
    s_cselect_b32 s54, 1, 0
    s_mul_i32 s48, s54, 24
    s_sub_u32 s55, s55, s48
    s_cmp_lt_u32 s2, 128
    s_cbranch_scc1 L_role_1
    s_mov_b32 s98, 2
    s_sub_u32 s55, s2, 128
    s_cmp_lt_u32 s2, 148
    s_cbranch_scc1 L_role_1
    s_mov_b32 s98, 3
L_role_1:
    v_mov_b32 v2, -1
    v_lshlrev_b32 v3, 2, v0
    v_cmp_gt_u32 vcc, 384, v0
    s_and_saveexec_b64 s[100:101], vcc
    s_cbranch_execz L_clr1
    s_mul_i32 s48, s40, 1536
    s_add_u32 s48, s48, 1048576
    buffer_store_dword v2, v3, s[32:35], s48 offen sc0 sc1
    v_cmp_eq_u32 vcc, 0, v0
    s_and_b64 exec, exec, vcc
    s_cbranch_execz L_clr1
    s_lshl_b32 s48, s2, 7
    s_add_u32 s48, s48, 458752
    buffer_store_dword v2, v3, s[32:35], s48 offen sc0 sc1
    buffer_store_dword v2, v3, s[32:35], s48 offen offset:4 sc0 sc1
L_clr1:
    s_mov_b64 exec, s[100:101]
    s_cmp_ge_u32 s98, 2
    s_cbranch_scc1 L_clr3
    s_cmp_eq_u32 s98, 1
    s_cbranch_scc1 L_clr_d
    v_cmp_gt_u32 vcc, 256, v0
    s_and_saveexec_b64 s[100:101], vcc
    s_cbranch_execz L_clr2
    v_lshrrev_b32 v3, 6, v0
    v_mul_u32_u24 v3, 2560, v3
    v_and_b32 v4, 63, v0
    v_lshl_add_u32 v3, v4, 2, v3
    s_mul_i32 s48, s54, 10240
    s_lshl_b32 s49, s55, 8
    s_add_u32 s48, s48, s49
    s_add_u32 s48, s48, 262144
    buffer_store_dword v2, v3, s[32:35], s48 offen sc0 sc1
    v_cmp_eq_u32 vcc, 0, v0
    s_and_b64 exec, exec, vcc
    s_cbranch_execz L_clr2
    s_lshl_b32 s48, s2, 2
    s_add_u32 s48, s48, 454656
    buffer_store_dword v2, v3, s[32:35], s48 offen sc0 sc1
    s_branch L_clr2
L_clr_d:
    v_cmp_gt_u32 vcc, 128, v0
    s_and_saveexec_b64 s[100:101], vcc
    s_cbranch_execz L_clr2
    v_lshrrev_b32 v3, 5, v0
    v_mul_u32_u24 v3, 3072, v3
    v_and_b32 v4, 31, v0
    v_lshl_add_u32 v3, v4, 2, v3
    s_mul_i32 s48, s54, 16384
    s_lshl_b32 s49, s55, 7
    s_add_u32 s48, s48, s49
    s_add_u32 s48, s48, 360448
    buffer_store_dword v2, v3, s[32:35], s48 offen sc0 sc1
L_clr2:
    s_mov_b64 exec, s[100:101]
L_clr3:
    s_waitcnt vmcnt(26)
    v_lshlrev_b32 v54, 16, v46
    v_and_b32 v55, 0xffff0000, v46
    v_lshlrev_b32 v56, 16, v47
    v_and_b32 v57, 0xffff0000, v47
    v_lshlrev_b32 v58, 16, v48
    v_and_b32 v59, 0xffff0000, v48
    v_lshlrev_b32 v60, 16, v49
    v_and_b32 v61, 0xffff0000, v49
    v_lshlrev_b32 v62, 16, v50
    v_and_b32 v63, 0xffff0000, v50
    v_add_f32 v2, v54, v55
    v_add_f32 v2, v2, v56
    v_add_f32 v2, v2, v57
    v_add_f32 v2, v2, v58
    v_add_f32 v2, v2, v59
    v_add_f32 v2, v2, v60
    v_add_f32 v2, v2, v61
    v_add_f32 v2, v2, v62
    v_add_f32 v2, v2, v63
    s_nop 1
    v_add_f32_dpp v2, v2, v2 quad_perm:[1,0,3,2] row_mask:0xf bank_mask:0xf
    s_nop 1
    v_add_f32_dpp v2, v2, v2 quad_perm:[2,3,0,1] row_mask:0xf bank_mask:0xf
    s_nop 1
    v_add_f32_dpp v2, v2, v2 row_half_mirror row_mask:0xf bank_mask:0xf
    s_nop 1
    v_add_f32_dpp v2, v2, v2 row_mirror row_mask:0xf bank_mask:0xf
    s_nop 1
    v_readlane_b32 s48, v2, 0
    v_readlane_b32 s49, v2, 16
    v_readlane_b32 s50, v2, 32
    v_readlane_b32 s51, v2, 48
    s_nop 1
    v_mov_b32 v2, s48
    v_add_f32 v2, s49, v2
    v_add_f32 v2, s50, v2
    v_add_f32 v2, s51, v2
    v_mul_f32 v2, 0x3acccccd, v2
    v_sub_f32 v4, v54, v2
    v_mul_f32 v3, v4, v4
    v_sub_f32 v4, v55, v2
    v_fmac_f32 v3, v4, v4
    v_sub_f32 v4, v56, v2
    v_fmac_f32 v3, v4, v4
    v_sub_f32 v4, v57, v2
    v_fmac_f32 v3, v4, v4
    v_sub_f32 v4, v58, v2
    v_fmac_f32 v3, v4, v4
    v_sub_f32 v4, v59, v2
    v_fmac_f32 v3, v4, v4
    v_sub_f32 v4, v60, v2
    v_fmac_f32 v3, v4, v4
    v_sub_f32 v4, v61, v2
    v_fmac_f32 v3, v4, v4
    v_sub_f32 v4, v62, v2
    v_fmac_f32 v3, v4, v4
    v_sub_f32 v4, v63, v2
    v_fmac_f32 v3, v4, v4
    s_nop 1
    v_add_f32_dpp v3, v3, v3 quad_perm:[1,0,3,2] row_mask:0xf bank_mask:0xf
    s_nop 1
    v_add_f32_dpp v3, v3, v3 quad_perm:[2,3,0,1] row_mask:0xf bank_mask:0xf
    s_nop 1
    v_add_f32_dpp v3, v3, v3 row_half_mirror row_mask:0xf bank_mask:0xf
    s_nop 1
    v_add_f32_dpp v3, v3, v3 row_mirror row_mask:0xf bank_mask:0xf
    s_nop 1
    v_readlane_b32 s48, v3, 0
    v_readlane_b32 s49, v3, 16
    v_readlane_b32 s50, v3, 32
    v_readlane_b32 s51, v3, 48
    s_nop 1
    v_mov_b32 v3, s48
    v_add_f32 v3, s49, v3
    v_add_f32 v3, s50, v3
    v_add_f32 v3, s51, v3
    v_mul_f32 v3, 0x3acccccd, v3
    v_cvt_pk_bf16_f32 v2, v2, v2
    v_lshlrev_b32 v2, 16, v2
    v_cvt_pk_bf16_f32 v3, v3, v3
    v_lshlrev_b32 v3, 16, v3
    v_add_f32 v3, 0x3727c5ac, v3
    v_cvt_pk_bf16_f32 v3, v3, v3
    v_lshlrev_b32 v3, 16, v3
    v_sqrt_f32 v3, v3
    s_nop 0
    v_cvt_pk_bf16_f32 v3, v3, v3
    v_lshlrev_b32 v3, 16, v3
    v_rcp_f32 v3, v3
    s_waitcnt vmcnt(21)
    v_lshlrev_b32 v51, 16, v51
    v_sub_f32 v51, v51, v2
    v_cvt_pk_bf16_f32 v51, v51, v51
    v_lshlrev_b32 v51, 16, v51
    v_mul_f32 v51, v51, v3
    v_cvt_pk_bf16_f32 v51, v51, v51
    v_lshlrev_b32 v51, 16, v51
    v_lshlrev_b32 v52, 16, v52
    v_sub_f32 v52, v52, v2
    v_cvt_pk_bf16_f32 v52, v52, v52
    v_lshlrev_b32 v52, 16, v52
    v_mul_f32 v52, v52, v3
    v_cvt_pk_bf16_f32 v52, v52, v52
    v_lshlrev_b32 v52, 16, v52
    v_lshlrev_b32 v53, 16, v53
    v_sub_f32 v53, v53, v2
    v_cvt_pk_bf16_f32 v53, v53, v53
    v_lshlrev_b32 v53, 16, v53
    v_mul_f32 v53, v53, v3
    v_cvt_pk_bf16_f32 v53, v53, v53
    v_lshlrev_b32 v53, 16, v53
    v_lshlrev_b32 v126, 16, v126
    v_sub_f32 v126, v126, v2
    v_cvt_pk_bf16_f32 v126, v126, v126
    v_lshlrev_b32 v126, 16, v126
    v_mul_f32 v126, v126, v3
    v_cvt_pk_bf16_f32 v126, v126, v126
    v_lshlrev_b32 v126, 16, v126
    v_lshlrev_b32 v127, 16, v127
    v_sub_f32 v127, v127, v2
    v_cvt_pk_bf16_f32 v127, v127, v127
    v_lshlrev_b32 v127, 16, v127
    v_mul_f32 v127, v127, v3
    v_cvt_pk_bf16_f32 v127, v127, v127
    v_lshlrev_b32 v127, 16, v127
    s_waitcnt vmcnt(18)
    v_lshlrev_b32 v2, 16, v102
    v_and_b32 v3, 0xffff0000, v102
    v_mul_f32 v54, v51, v2
    v_mul_f32 v55, v51, v3
    v_lshlrev_b32 v2, 16, v103
    v_and_b32 v3, 0xffff0000, v103
    v_mul_f32 v56, v51, v2
    v_mul_f32 v57, v51, v3
    v_lshlrev_b32 v2, 16, v104
    v_and_b32 v3, 0xffff0000, v104
    v_mul_f32 v58, v51, v2
    v_mul_f32 v59, v51, v3
    v_lshlrev_b32 v2, 16, v105
    v_and_b32 v3, 0xffff0000, v105
    v_mul_f32 v60, v51, v2
    v_mul_f32 v61, v51, v3
    v_lshlrev_b32 v2, 16, v106
    v_and_b32 v3, 0xffff0000, v106
    v_mul_f32 v62, v51, v2
    v_mul_f32 v63, v51, v3
    v_lshlrev_b32 v2, 16, v107
    v_and_b32 v3, 0xffff0000, v107
    v_mul_f32 v64, v51, v2
    v_mul_f32 v65, v51, v3
    v_lshlrev_b32 v2, 16, v108
    v_and_b32 v3, 0xffff0000, v108
    v_mul_f32 v66, v51, v2
    v_mul_f32 v67, v51, v3
    v_lshlrev_b32 v2, 16, v109
    v_and_b32 v3, 0xffff0000, v109
    v_mul_f32 v68, v51, v2
    v_mul_f32 v69, v51, v3
    v_lshlrev_b32 v2, 16, v110
    v_and_b32 v3, 0xffff0000, v110
    v_mul_f32 v70, v51, v2
    v_mul_f32 v71, v51, v3
    v_lshlrev_b32 v2, 16, v111
    v_and_b32 v3, 0xffff0000, v111
    v_mul_f32 v72, v51, v2
    v_mul_f32 v73, v51, v3
    v_lshlrev_b32 v2, 16, v112
    v_and_b32 v3, 0xffff0000, v112
    v_mul_f32 v74, v51, v2
    v_mul_f32 v75, v51, v3
    v_lshlrev_b32 v2, 16, v113
    v_and_b32 v3, 0xffff0000, v113
    v_mul_f32 v76, v51, v2
    v_mul_f32 v77, v51, v3
    s_add_u32 s48, s41, 6144
    buffer_load_dwordx4 v[102:105], v1, s[16:19], s48 offen offset:0 nt
    buffer_load_dwordx4 v[106:109], v1, s[16:19], s48 offen offset:128 nt
    buffer_load_dwordx4 v[110:113], v1, s[16:19], s48 offen offset:256 nt
    s_waitcnt vmcnt(18)
    v_lshlrev_b32 v2, 16, v114
    v_and_b32 v3, 0xffff0000, v114
    v_fmac_f32 v54, v52, v2
    v_fmac_f32 v55, v52, v3
    v_lshlrev_b32 v2, 16, v115
    v_and_b32 v3, 0xffff0000, v115
    v_fmac_f32 v56, v52, v2
    v_fmac_f32 v57, v52, v3
    v_lshlrev_b32 v2, 16, v116
    v_and_b32 v3, 0xffff0000, v116
    v_fmac_f32 v58, v52, v2
    v_fmac_f32 v59, v52, v3
    v_lshlrev_b32 v2, 16, v117
    v_and_b32 v3, 0xffff0000, v117
    v_fmac_f32 v60, v52, v2
    v_fmac_f32 v61, v52, v3
    v_lshlrev_b32 v2, 16, v118
    v_and_b32 v3, 0xffff0000, v118
    v_fmac_f32 v62, v52, v2
    v_fmac_f32 v63, v52, v3
    v_lshlrev_b32 v2, 16, v119
    v_and_b32 v3, 0xffff0000, v119
    v_fmac_f32 v64, v52, v2
    v_fmac_f32 v65, v52, v3
    v_lshlrev_b32 v2, 16, v120
    v_and_b32 v3, 0xffff0000, v120
    v_fmac_f32 v66, v52, v2
    v_fmac_f32 v67, v52, v3
    v_lshlrev_b32 v2, 16, v121
    v_and_b32 v3, 0xffff0000, v121
    v_fmac_f32 v68, v52, v2
    v_fmac_f32 v69, v52, v3
    v_lshlrev_b32 v2, 16, v122
    v_and_b32 v3, 0xffff0000, v122
    v_fmac_f32 v70, v52, v2
    v_fmac_f32 v71, v52, v3
    v_lshlrev_b32 v2, 16, v123
    v_and_b32 v3, 0xffff0000, v123
    v_fmac_f32 v72, v52, v2
    v_fmac_f32 v73, v52, v3
    v_lshlrev_b32 v2, 16, v124
    v_and_b32 v3, 0xffff0000, v124
    v_fmac_f32 v74, v52, v2
    v_fmac_f32 v75, v52, v3
    v_lshlrev_b32 v2, 16, v125
    v_and_b32 v3, 0xffff0000, v125
    v_fmac_f32 v76, v52, v2
    v_fmac_f32 v77, v52, v3
    s_add_u32 s48, s41, 9216
    buffer_load_dwordx4 v[114:117], v1, s[16:19], s48 offen offset:0 nt
    buffer_load_dwordx4 v[118:121], v1, s[16:19], s48 offen offset:128 nt
    buffer_load_dwordx4 v[122:125], v1, s[16:19], s48 offen offset:256 nt
    s_waitcnt vmcnt(15)
    v_lshlrev_b32 v2, 16, v10
    v_and_b32 v3, 0xffff0000, v10
    v_fmac_f32 v54, v53, v2
    v_fmac_f32 v55, v53, v3
    v_lshlrev_b32 v2, 16, v11
    v_and_b32 v3, 0xffff0000, v11
    v_fmac_f32 v56, v53, v2
    v_fmac_f32 v57, v53, v3
    v_lshlrev_b32 v2, 16, v12
    v_and_b32 v3, 0xffff0000, v12
    v_fmac_f32 v58, v53, v2
    v_fmac_f32 v59, v53, v3
    v_lshlrev_b32 v2, 16, v13
    v_and_b32 v3, 0xffff0000, v13
    v_fmac_f32 v60, v53, v2
    v_fmac_f32 v61, v53, v3
    v_lshlrev_b32 v2, 16, v14
    v_and_b32 v3, 0xffff0000, v14
    v_fmac_f32 v62, v53, v2
    v_fmac_f32 v63, v53, v3
    v_lshlrev_b32 v2, 16, v15
    v_and_b32 v3, 0xffff0000, v15
    v_fmac_f32 v64, v53, v2
    v_fmac_f32 v65, v53, v3
    v_lshlrev_b32 v2, 16, v16
    v_and_b32 v3, 0xffff0000, v16
    v_fmac_f32 v66, v53, v2
    v_fmac_f32 v67, v53, v3
    v_lshlrev_b32 v2, 16, v17
    v_and_b32 v3, 0xffff0000, v17
    v_fmac_f32 v68, v53, v2
    v_fmac_f32 v69, v53, v3
    v_lshlrev_b32 v2, 16, v18
    v_and_b32 v3, 0xffff0000, v18
    v_fmac_f32 v70, v53, v2
    v_fmac_f32 v71, v53, v3
    v_lshlrev_b32 v2, 16, v19
    v_and_b32 v3, 0xffff0000, v19
    v_fmac_f32 v72, v53, v2
    v_fmac_f32 v73, v53, v3
    v_lshlrev_b32 v2, 16, v20
    v_and_b32 v3, 0xffff0000, v20
    v_fmac_f32 v74, v53, v2
    v_fmac_f32 v75, v53, v3
    v_lshlrev_b32 v2, 16, v21
    v_and_b32 v3, 0xffff0000, v21
    v_fmac_f32 v76, v53, v2
    v_fmac_f32 v77, v53, v3
    s_waitcnt vmcnt(9)
    v_lshlrev_b32 v2, 16, v22
    v_and_b32 v3, 0xffff0000, v22
    v_fmac_f32 v54, v126, v2
    v_fmac_f32 v55, v126, v3
    v_lshlrev_b32 v2, 16, v23
    v_and_b32 v3, 0xffff0000, v23
    v_fmac_f32 v56, v126, v2
    v_fmac_f32 v57, v126, v3
    v_lshlrev_b32 v2, 16, v24
    v_and_b32 v3, 0xffff0000, v24
    v_fmac_f32 v58, v126, v2
    v_fmac_f32 v59, v126, v3
    v_lshlrev_b32 v2, 16, v25
    v_and_b32 v3, 0xffff0000, v25
    v_fmac_f32 v60, v126, v2
    v_fmac_f32 v61, v126, v3
    v_lshlrev_b32 v2, 16, v26
    v_and_b32 v3, 0xffff0000, v26
    v_fmac_f32 v62, v126, v2
    v_fmac_f32 v63, v126, v3
    v_lshlrev_b32 v2, 16, v27
    v_and_b32 v3, 0xffff0000, v27
    v_fmac_f32 v64, v126, v2
    v_fmac_f32 v65, v126, v3
    v_lshlrev_b32 v2, 16, v28
    v_and_b32 v3, 0xffff0000, v28
    v_fmac_f32 v66, v126, v2
    v_fmac_f32 v67, v126, v3
    v_lshlrev_b32 v2, 16, v29
    v_and_b32 v3, 0xffff0000, v29
    v_fmac_f32 v68, v126, v2
    v_fmac_f32 v69, v126, v3
    v_lshlrev_b32 v2, 16, v30
    v_and_b32 v3, 0xffff0000, v30
    v_fmac_f32 v70, v126, v2
    v_fmac_f32 v71, v126, v3
    v_lshlrev_b32 v2, 16, v31
    v_and_b32 v3, 0xffff0000, v31
    v_fmac_f32 v72, v126, v2
    v_fmac_f32 v73, v126, v3
    v_lshlrev_b32 v2, 16, v32
    v_and_b32 v3, 0xffff0000, v32
    v_fmac_f32 v74, v126, v2
    v_fmac_f32 v75, v126, v3
    v_lshlrev_b32 v2, 16, v33
    v_and_b32 v3, 0xffff0000, v33
    v_fmac_f32 v76, v126, v2
    v_fmac_f32 v77, v126, v3
    s_waitcnt vmcnt(6)
    v_lshlrev_b32 v2, 16, v34
    v_and_b32 v3, 0xffff0000, v34
    v_fmac_f32 v54, v127, v2
    v_fmac_f32 v55, v127, v3
    v_lshlrev_b32 v2, 16, v35
    v_and_b32 v3, 0xffff0000, v35
    v_fmac_f32 v56, v127, v2
    v_fmac_f32 v57, v127, v3
    v_lshlrev_b32 v2, 16, v36
    v_and_b32 v3, 0xffff0000, v36
    v_fmac_f32 v58, v127, v2
    v_fmac_f32 v59, v127, v3
    v_lshlrev_b32 v2, 16, v37
    v_and_b32 v3, 0xffff0000, v37
    v_fmac_f32 v60, v127, v2
    v_fmac_f32 v61, v127, v3
    v_lshlrev_b32 v2, 16, v38
    v_and_b32 v3, 0xffff0000, v38
    v_fmac_f32 v62, v127, v2
    v_fmac_f32 v63, v127, v3
    v_lshlrev_b32 v2, 16, v39
    v_and_b32 v3, 0xffff0000, v39
    v_fmac_f32 v64, v127, v2
    v_fmac_f32 v65, v127, v3
    v_lshlrev_b32 v2, 16, v40
    v_and_b32 v3, 0xffff0000, v40
    v_fmac_f32 v66, v127, v2
    v_fmac_f32 v67, v127, v3
    v_lshlrev_b32 v2, 16, v41
    v_and_b32 v3, 0xffff0000, v41
    v_fmac_f32 v68, v127, v2
    v_fmac_f32 v69, v127, v3
    v_lshlrev_b32 v2, 16, v42
    v_and_b32 v3, 0xffff0000, v42
    v_fmac_f32 v70, v127, v2
    v_fmac_f32 v71, v127, v3
    v_lshlrev_b32 v2, 16, v43
    v_and_b32 v3, 0xffff0000, v43
    v_fmac_f32 v72, v127, v2
    v_fmac_f32 v73, v127, v3
    v_lshlrev_b32 v2, 16, v44
    v_and_b32 v3, 0xffff0000, v44
    v_fmac_f32 v74, v127, v2
    v_fmac_f32 v75, v127, v3
    v_lshlrev_b32 v2, 16, v45
    v_and_b32 v3, 0xffff0000, v45
    v_fmac_f32 v76, v127, v2
    v_fmac_f32 v77, v127, v3
    s_nop 1
    v_permlane32_swap_b32 v54, v58
    v_permlane32_swap_b32 v55, v59
    v_permlane32_swap_b32 v56, v60
    v_permlane32_swap_b32 v57, v61
    v_permlane32_swap_b32 v62, v66
    v_permlane32_swap_b32 v63, v67
    v_permlane32_swap_b32 v64, v68
    v_permlane32_swap_b32 v65, v69
    v_permlane32_swap_b32 v70, v74
    v_permlane32_swap_b32 v71, v75
    v_permlane32_swap_b32 v72, v76
    v_permlane32_swap_b32 v73, v77
    v_add_f32 v54, v54, v58
    v_add_f32 v55, v55, v59
    v_add_f32 v56, v56, v60
    v_add_f32 v57, v57, v61
    v_add_f32 v62, v62, v66
    v_add_f32 v63, v63, v67
    v_add_f32 v64, v64, v68
    v_add_f32 v65, v65, v69
    v_add_f32 v70, v70, v74
    v_add_f32 v71, v71, v75
    v_add_f32 v72, v72, v76
    v_add_f32 v73, v73, v77
    s_nop 1
    v_permlane16_swap_b32 v54, v56
    v_permlane16_swap_b32 v55, v57
    v_permlane16_swap_b32 v62, v64
    v_permlane16_swap_b32 v63, v65
    v_permlane16_swap_b32 v70, v72
    v_permlane16_swap_b32 v71, v73
    v_add_f32 v54, v54, v56
    v_add_f32 v55, v55, v57
    v_add_f32 v62, v62, v64
    v_add_f32 v63, v63, v65
    v_add_f32 v70, v70, v72
    v_add_f32 v71, v71, v73
    s_nop 1
    v_add_f32_dpp v54, v54, v54 row_ror:8 row_mask:0xf bank_mask:0xf
    v_add_f32_dpp v55, v55, v55 row_ror:8 row_mask:0xf bank_mask:0xf
    v_add_f32_dpp v62, v62, v62 row_ror:8 row_mask:0xf bank_mask:0xf
    v_add_f32_dpp v63, v63, v63 row_ror:8 row_mask:0xf bank_mask:0xf
    v_add_f32_dpp v70, v70, v70 row_ror:8 row_mask:0xf bank_mask:0xf
    v_add_f32_dpp v71, v71, v71 row_ror:8 row_mask:0xf bank_mask:0xf
    v_lshrrev_b32 v2, 6, v0
    v_mul_u32_u24 v9, 768, v2
    v_and_b32 v2, 7, v6
    v_lshlrev_b32 v2, 5, v2
    v_add_u32 v9, v9, v2
    v_lshrrev_b32 v2, 5, v6
    v_lshlrev_b32 v2, 4, v2
    v_add_u32 v9, v9, v2
    v_bfe_u32 v2, v6, 4, 1
    v_lshlrev_b32 v2, 3, v2
    v_add_u32 v9, v9, v2
    ds_write_b64 v9, v[54:55] offset:0
    ds_write_b64 v9, v[62:63] offset:256
    ds_write_b64 v9, v[70:71] offset:512
    s_waitcnt lgkmcnt(0)
    s_barrier
    v_cmp_gt_u32 vcc, 192, v0
    s_and_saveexec_b64 s[100:101], vcc
    s_cbranch_execz L_q1
    v_lshlrev_b32 v2, 2, v0
    ds_read_b32 v54, v2 offset:0
    ds_read_b32 v55, v2 offset:768
    ds_read_b32 v56, v2 offset:1536
    ds_read_b32 v57, v2 offset:2304
    ds_read_b32 v58, v2 offset:3072
    ds_read_b32 v59, v2 offset:3840
    ds_read_b32 v60, v2 offset:4608
    ds_read_b32 v61, v2 offset:5376
    ds_read_b32 v62, v2 offset:6144
    ds_read_b32 v63, v2 offset:6912
    ds_read_b32 v64, v2 offset:7680
    ds_read_b32 v65, v2 offset:8448
    ds_read_b32 v66, v2 offset:9216
    ds_read_b32 v67, v2 offset:9984
    ds_read_b32 v68, v2 offset:10752
    ds_read_b32 v69, v2 offset:11520
    s_waitcnt lgkmcnt(0)
    v_add_f32 v54, v54, v55
    v_add_f32 v54, v54, v56
    v_add_f32 v54, v54, v57
    v_add_f32 v54, v54, v58
    v_add_f32 v54, v54, v59
    v_add_f32 v54, v54, v60
    v_add_f32 v54, v54, v61
    v_add_f32 v54, v54, v62
    v_add_f32 v54, v54, v63
    v_add_f32 v54, v54, v64
    v_add_f32 v54, v54, v65
    v_add_f32 v54, v54, v66
    v_add_f32 v54, v54, v67
    v_add_f32 v54, v54, v68
    v_add_f32 v54, v54, v69
    v_cvt_pk_bf16_f32 v54, v54, v54
    v_lshlrev_b32 v2, 1, v0
    ds_write_b16 v2, v54 offset:12288
    v_cmp_eq_u32 vcc, 0, v0
    s_and_b64 exec, exec, vcc
    s_cbranch_execz L_q2
    v_mov_b32 v3, 1
    v_mov_b32 v2, 4
    buffer_atomic_add v3, v2, s[36:39], 0 offen sc1
L_q2:
    s_waitcnt lgkmcnt(0)
L_q1:
    s_mov_b64 exec, s[100:101]
    s_barrier
    v_and_b32 v2, 7, v6
    v_lshlrev_b32 v2, 4, v2
    ds_read_b128 v[10:13], v2 offset:12288
    ds_read_b128 v[14:17], v2 offset:12416
    ds_read_b128 v[18:21], v2 offset:12544
    s_waitcnt lgkmcnt(0)
    v_mov_b32 v30, 0xff7fffff
    v_mov_b32 v31, 0
    v_mov_b32 v54, 0
    v_mov_b32 v55, 0
    v_mov_b32 v56, 0
    v_mov_b32 v57, 0
    v_mov_b32 v58, 0
    v_mov_b32 v59, 0
    v_mov_b32 v60, 0
    v_mov_b32 v61, 0
    v_mov_b32 v62, 0
    v_mov_b32 v63, 0
    v_mov_b32 v64, 0
    v_mov_b32 v65, 0
    v_mov_b32 v66, 0
    v_mov_b32 v67, 0
    v_mov_b32 v68, 0
    v_mov_b32 v69, 0
    v_mov_b32 v70, 0
    v_mov_b32 v71, 0
    v_mov_b32 v72, 0
    v_mov_b32 v73, 0
    v_mov_b32 v74, 0
    v_mov_b32 v75, 0
    v_mov_b32 v76, 0
    v_mov_b32 v77, 0
    v_mov_b32 v33, 12928
    v_mov_b32 v34, 1
    s_mov_b32 s52, 0x3fb8aa3b
L_loop:
    s_mov_b64 exec, 1
    ds_add_rtn_u32 v32, v33, v34
    s_mov_b64 exec, -1
    s_waitcnt vmcnt(9)
    v_dot2_f32_bf16 v2, v78, v10, 0
    v_dot2_f32_bf16 v3, v82, v14, 0
    v_dot2_f32_bf16 v4, v86, v18, 0
    v_dot2_f32_bf16 v2, v79, v11, v2
    v_dot2_f32_bf16 v3, v83, v15, v3
    v_dot2_f32_bf16 v4, v87, v19, v4
    v_dot2_f32_bf16 v2, v80, v12, v2
    v_dot2_f32_bf16 v3, v84, v16, v3
    v_dot2_f32_bf16 v4, v88, v20, v4
    v_dot2_f32_bf16 v2, v81, v13, v2
    v_dot2_f32_bf16 v3, v85, v17, v3
    v_dot2_f32_bf16 v4, v89, v21, v4
    s_add_u32 s48, s41, 12288
    buffer_load_dwordx4 v[78:81], v1, s[16:19], s48 offen offset:0 nt
    buffer_load_dwordx4 v[82:85], v1, s[16:19], s48 offen offset:128 nt
    buffer_load_dwordx4 v[86:89], v1, s[16:19], s48 offen offset:256 nt
    v_add_f32 v2, v2, v3
    v_add_f32 v2, v2, v4
    s_nop 1
    v_add_f32_dpp v2, v2, v2 quad_perm:[1,0,3,2] row_mask:0xf bank_mask:0xf
    s_nop 1
    v_add_f32_dpp v2, v2, v2 quad_perm:[2,3,0,1] row_mask:0xf bank_mask:0xf
    s_nop 1
    v_add_f32_dpp v2, v2, v2 row_half_mirror row_mask:0xf bank_mask:0xf
    v_cvt_pk_bf16_f32 v2, v2, v2
    v_lshlrev_b32 v2, 16, v2
    v_mul_f32 v2, 0x3d93cd3a, v2
    v_cvt_pk_bf16_f32 v2, v2, v2
    v_lshlrev_b32 v22, 16, v2
    s_waitcnt vmcnt(9)
    v_dot2_f32_bf16 v2, v90, v10, 0
    v_dot2_f32_bf16 v3, v94, v14, 0
    v_dot2_f32_bf16 v4, v98, v18, 0
    v_dot2_f32_bf16 v2, v91, v11, v2
    v_dot2_f32_bf16 v3, v95, v15, v3
    v_dot2_f32_bf16 v4, v99, v19, v4
    v_dot2_f32_bf16 v2, v92, v12, v2
    v_dot2_f32_bf16 v3, v96, v16, v3
    v_dot2_f32_bf16 v4, v100, v20, v4
    v_dot2_f32_bf16 v2, v93, v13, v2
    v_dot2_f32_bf16 v3, v97, v17, v3
    v_dot2_f32_bf16 v4, v101, v21, v4
    s_add_u32 s48, s41, 15360
    buffer_load_dwordx4 v[90:93], v1, s[16:19], s48 offen offset:0 nt
    buffer_load_dwordx4 v[94:97], v1, s[16:19], s48 offen offset:128 nt
    buffer_load_dwordx4 v[98:101], v1, s[16:19], s48 offen offset:256 nt
    v_add_f32 v2, v2, v3
    v_add_f32 v2, v2, v4
    s_nop 1
    v_add_f32_dpp v2, v2, v2 quad_perm:[1,0,3,2] row_mask:0xf bank_mask:0xf
    s_nop 1
    v_add_f32_dpp v2, v2, v2 quad_perm:[2,3,0,1] row_mask:0xf bank_mask:0xf
    s_nop 1
    v_add_f32_dpp v2, v2, v2 row_half_mirror row_mask:0xf bank_mask:0xf
    v_cvt_pk_bf16_f32 v2, v2, v2
    v_lshlrev_b32 v2, 16, v2
    v_mul_f32 v2, 0x3d93cd3a, v2
    v_cvt_pk_bf16_f32 v2, v2, v2
    v_lshlrev_b32 v23, 16, v2
    s_waitcnt vmcnt(9)
    v_dot2_f32_bf16 v2, v102, v10, 0
    v_dot2_f32_bf16 v3, v106, v14, 0
    v_dot2_f32_bf16 v4, v110, v18, 0
    v_dot2_f32_bf16 v2, v103, v11, v2
    v_dot2_f32_bf16 v3, v107, v15, v3
    v_dot2_f32_bf16 v4, v111, v19, v4
    v_dot2_f32_bf16 v2, v104, v12, v2
    v_dot2_f32_bf16 v3, v108, v16, v3
    v_dot2_f32_bf16 v4, v112, v20, v4
    v_dot2_f32_bf16 v2, v105, v13, v2
    v_dot2_f32_bf16 v3, v109, v17, v3
    v_dot2_f32_bf16 v4, v113, v21, v4
    s_add_u32 s48, s41, 18432
    buffer_load_dwordx4 v[102:105], v1, s[16:19], s48 offen offset:0 nt
    buffer_load_dwordx4 v[106:109], v1, s[16:19], s48 offen offset:128 nt
    buffer_load_dwordx4 v[110:113], v1, s[16:19], s48 offen offset:256 nt
    v_add_f32 v2, v2, v3
    v_add_f32 v2, v2, v4
    s_nop 1
    v_add_f32_dpp v2, v2, v2 quad_perm:[1,0,3,2] row_mask:0xf bank_mask:0xf
    s_nop 1
    v_add_f32_dpp v2, v2, v2 quad_perm:[2,3,0,1] row_mask:0xf bank_mask:0xf
    s_nop 1
    v_add_f32_dpp v2, v2, v2 row_half_mirror row_mask:0xf bank_mask:0xf
    v_cvt_pk_bf16_f32 v2, v2, v2
    v_lshlrev_b32 v2, 16, v2
    v_mul_f32 v2, 0x3d93cd3a, v2
    v_cvt_pk_bf16_f32 v2, v2, v2
    v_lshlrev_b32 v24, 16, v2
    s_waitcnt lgkmcnt(0)
    v_readfirstlane_b32 s49, v32
    s_mul_i32 s47, s49, 24576
    s_waitcnt vmcnt(9)
    v_dot2_f32_bf16 v2, v114, v10, 0
    v_dot2_f32_bf16 v3, v118, v14, 0
    v_dot2_f32_bf16 v4, v122, v18, 0
    v_dot2_f32_bf16 v2, v115, v11, v2
    v_dot2_f32_bf16 v3, v119, v15, v3
    v_dot2_f32_bf16 v4, v123, v19, v4
    v_dot2_f32_bf16 v2, v116, v12, v2
    v_dot2_f32_bf16 v3, v120, v16, v3
    v_dot2_f32_bf16 v4, v124, v20, v4
    v_dot2_f32_bf16 v2, v117, v13, v2
    v_dot2_f32_bf16 v3, v121, v17, v3
    v_dot2_f32_bf16 v4, v125, v21, v4
    s_add_u32 s48, s41, 21504
    buffer_load_dwordx4 v[114:117], v1, s[16:19], s48 offen offset:0 nt
    buffer_load_dwordx4 v[118:121], v1, s[16:19], s48 offen offset:128 nt
    buffer_load_dwordx4 v[122:125], v1, s[16:19], s48 offen offset:256 nt
    v_add_f32 v2, v2, v3
    v_add_f32 v2, v2, v4
    s_nop 1
    v_add_f32_dpp v2, v2, v2 quad_perm:[1,0,3,2] row_mask:0xf bank_mask:0xf
    s_nop 1
    v_add_f32_dpp v2, v2, v2 quad_perm:[2,3,0,1] row_mask:0xf bank_mask:0xf
    s_nop 1
    v_add_f32_dpp v2, v2, v2 row_half_mirror row_mask:0xf bank_mask:0xf
    v_cvt_pk_bf16_f32 v2, v2, v2
    v_lshlrev_b32 v2, 16, v2
    v_mul_f32 v2, 0x3d93cd3a, v2
    v_cvt_pk_bf16_f32 v2, v2, v2
    v_lshlrev_b32 v25, 16, v2
    s_waitcnt vmcnt(9)
    v_dot2_f32_bf16 v2, v78, v10, 0
    v_dot2_f32_bf16 v3, v82, v14, 0
    v_dot2_f32_bf16 v4, v86, v18, 0
    v_dot2_f32_bf16 v2, v79, v11, v2
    v_dot2_f32_bf16 v3, v83, v15, v3
    v_dot2_f32_bf16 v4, v87, v19, v4
    v_dot2_f32_bf16 v2, v80, v12, v2
    v_dot2_f32_bf16 v3, v84, v16, v3
    v_dot2_f32_bf16 v4, v88, v20, v4
    v_dot2_f32_bf16 v2, v81, v13, v2
    v_dot2_f32_bf16 v3, v85, v17, v3
    v_dot2_f32_bf16 v4, v89, v21, v4
    s_add_u32 s48, s41, 0
    buffer_load_dwordx4 v[78:81], v1, s[20:23], s48 offen offset:0 nt
    buffer_load_dwordx4 v[82:85], v1, s[20:23], s48 offen offset:128 nt
    buffer_load_dwordx4 v[86:89], v1, s[20:23], s48 offen offset:256 nt
    v_add_f32 v2, v2, v3
    v_add_f32 v2, v2, v4
    s_nop 1
    v_add_f32_dpp v2, v2, v2 quad_perm:[1,0,3,2] row_mask:0xf bank_mask:0xf
    s_nop 1
    v_add_f32_dpp v2, v2, v2 quad_perm:[2,3,0,1] row_mask:0xf bank_mask:0xf
    s_nop 1
    v_add_f32_dpp v2, v2, v2 row_half_mirror row_mask:0xf bank_mask:0xf
    v_cvt_pk_bf16_f32 v2, v2, v2
    v_lshlrev_b32 v2, 16, v2
    v_mul_f32 v2, 0x3d93cd3a, v2
    v_cvt_pk_bf16_f32 v2, v2, v2
    v_lshlrev_b32 v26, 16, v2
    s_waitcnt vmcnt(9)
    v_dot2_f32_bf16 v2, v90, v10, 0
    v_dot2_f32_bf16 v3, v94, v14, 0
    v_dot2_f32_bf16 v4, v98, v18, 0
    v_dot2_f32_bf16 v2, v91, v11, v2
    v_dot2_f32_bf16 v3, v95, v15, v3
    v_dot2_f32_bf16 v4, v99, v19, v4
    v_dot2_f32_bf16 v2, v92, v12, v2
    v_dot2_f32_bf16 v3, v96, v16, v3
    v_dot2_f32_bf16 v4, v100, v20, v4
    v_dot2_f32_bf16 v2, v93, v13, v2
    v_dot2_f32_bf16 v3, v97, v17, v3
    v_dot2_f32_bf16 v4, v101, v21, v4
    s_add_u32 s48, s41, 3072
    buffer_load_dwordx4 v[90:93], v1, s[20:23], s48 offen offset:0 nt
    buffer_load_dwordx4 v[94:97], v1, s[20:23], s48 offen offset:128 nt
    buffer_load_dwordx4 v[98:101], v1, s[20:23], s48 offen offset:256 nt
    v_add_f32 v2, v2, v3
    v_add_f32 v2, v2, v4
    s_nop 1
    v_add_f32_dpp v2, v2, v2 quad_perm:[1,0,3,2] row_mask:0xf bank_mask:0xf
    s_nop 1
    v_add_f32_dpp v2, v2, v2 quad_perm:[2,3,0,1] row_mask:0xf bank_mask:0xf
    s_nop 1
    v_add_f32_dpp v2, v2, v2 row_half_mirror row_mask:0xf bank_mask:0xf
    v_cvt_pk_bf16_f32 v2, v2, v2
    v_lshlrev_b32 v2, 16, v2
    v_mul_f32 v2, 0x3d93cd3a, v2
    v_cvt_pk_bf16_f32 v2, v2, v2
    v_lshlrev_b32 v27, 16, v2
    s_waitcnt vmcnt(9)
    v_dot2_f32_bf16 v2, v102, v10, 0
    v_dot2_f32_bf16 v3, v106, v14, 0
    v_dot2_f32_bf16 v4, v110, v18, 0
    v_dot2_f32_bf16 v2, v103, v11, v2
    v_dot2_f32_bf16 v3, v107, v15, v3
    v_dot2_f32_bf16 v4, v111, v19, v4
    v_dot2_f32_bf16 v2, v104, v12, v2
    v_dot2_f32_bf16 v3, v108, v16, v3
    v_dot2_f32_bf16 v4, v112, v20, v4
    v_dot2_f32_bf16 v2, v105, v13, v2
    v_dot2_f32_bf16 v3, v109, v17, v3
    v_dot2_f32_bf16 v4, v113, v21, v4
    s_add_u32 s48, s41, 6144
    buffer_load_dwordx4 v[102:105], v1, s[20:23], s48 offen offset:0 nt
    buffer_load_dwordx4 v[106:109], v1, s[20:23], s48 offen offset:128 nt
    buffer_load_dwordx4 v[110:113], v1, s[20:23], s48 offen offset:256 nt
    v_add_f32 v2, v2, v3
    v_add_f32 v2, v2, v4
    s_nop 1
    v_add_f32_dpp v2, v2, v2 quad_perm:[1,0,3,2] row_mask:0xf bank_mask:0xf
    s_nop 1
    v_add_f32_dpp v2, v2, v2 quad_perm:[2,3,0,1] row_mask:0xf bank_mask:0xf
    s_nop 1
    v_add_f32_dpp v2, v2, v2 row_half_mirror row_mask:0xf bank_mask:0xf
    v_cvt_pk_bf16_f32 v2, v2, v2
    v_lshlrev_b32 v2, 16, v2
    v_mul_f32 v2, 0x3d93cd3a, v2
    v_cvt_pk_bf16_f32 v2, v2, v2
    v_lshlrev_b32 v28, 16, v2
    s_waitcnt vmcnt(9)
    v_dot2_f32_bf16 v2, v114, v10, 0
    v_dot2_f32_bf16 v3, v118, v14, 0
    v_dot2_f32_bf16 v4, v122, v18, 0
    v_dot2_f32_bf16 v2, v115, v11, v2
    v_dot2_f32_bf16 v3, v119, v15, v3
    v_dot2_f32_bf16 v4, v123, v19, v4
    v_dot2_f32_bf16 v2, v116, v12, v2
    v_dot2_f32_bf16 v3, v120, v16, v3
    v_dot2_f32_bf16 v4, v124, v20, v4
    v_dot2_f32_bf16 v2, v117, v13, v2
    v_dot2_f32_bf16 v3, v121, v17, v3
    v_dot2_f32_bf16 v4, v125, v21, v4
    s_add_u32 s48, s41, 9216
    buffer_load_dwordx4 v[114:117], v1, s[20:23], s48 offen offset:0 nt
    buffer_load_dwordx4 v[118:121], v1, s[20:23], s48 offen offset:128 nt
    buffer_load_dwordx4 v[122:125], v1, s[20:23], s48 offen offset:256 nt
    v_add_f32 v2, v2, v3
    v_add_f32 v2, v2, v4
    s_nop 1
    v_add_f32_dpp v2, v2, v2 quad_perm:[1,0,3,2] row_mask:0xf bank_mask:0xf
    s_nop 1
    v_add_f32_dpp v2, v2, v2 quad_perm:[2,3,0,1] row_mask:0xf bank_mask:0xf
    s_nop 1
    v_add_f32_dpp v2, v2, v2 row_half_mirror row_mask:0xf bank_mask:0xf
    v_cvt_pk_bf16_f32 v2, v2, v2
    v_lshlrev_b32 v2, 16, v2
    v_mul_f32 v2, 0x3d93cd3a, v2
    v_cvt_pk_bf16_f32 v2, v2, v2
    v_lshlrev_b32 v29, 16, v2
    v_max3_f32 v2, v22, v23, v24
    v_max3_f32 v2, v2, v25, v26
    v_max3_f32 v2, v2, v27, v28
    v_max_f32 v2, v2, v29
    s_nop 1
    v_max_f32_dpp v2, v2, v2 row_ror:8 row_mask:0xf bank_mask:0xf
    s_nop 1
    v_readlane_b32 s48, v2, 0
    v_readlane_b32 s49, v2, 16
    v_readlane_b32 s50, v2, 32
    v_readlane_b32 s51, v2, 48
    s_nop 1
    v_mov_b32 v2, s48
    v_max_f32 v2, s49, v2
    v_max_f32 v2, s50, v2
    v_max_f32 v2, s51, v2
    v_max_f32 v2, v2, v30
    v_sub_f32 v3, v30, v2
    v_mul_f32 v3, s52, v3
    v_exp_f32 v3, v3
    v_mov_b32 v30, v2
    v_mul_f32 v4, s52, v2
    v_fma_f32 v22, v22, s52, -v4
    v_exp_f32 v22, v22
    v_fma_f32 v23, v23, s52, -v4
    v_exp_f32 v23, v23
    v_fma_f32 v24, v24, s52, -v4
    v_exp_f32 v24, v24
    v_fma_f32 v25, v25, s52, -v4
    v_exp_f32 v25, v25
    v_fma_f32 v26, v26, s52, -v4
    v_exp_f32 v26, v26
    v_fma_f32 v27, v27, s52, -v4
    v_exp_f32 v27, v27
    v_fma_f32 v28, v28, s52, -v4
    v_exp_f32 v28, v28
    v_fma_f32 v29, v29, s52, -v4
    v_exp_f32 v29, v29
    v_mul_f32 v31, v31, v3
    v_mul_f32 v54, v54, v3
    v_mul_f32 v55, v55, v3
    v_mul_f32 v56, v56, v3
    v_mul_f32 v57, v57, v3
    v_mul_f32 v58, v58, v3
    v_mul_f32 v59, v59, v3
    v_mul_f32 v60, v60, v3
    v_mul_f32 v61, v61, v3
    v_mul_f32 v62, v62, v3
    v_mul_f32 v63, v63, v3
    v_mul_f32 v64, v64, v3
    v_mul_f32 v65, v65, v3
    v_mul_f32 v66, v66, v3
    v_mul_f32 v67, v67, v3
    v_mul_f32 v68, v68, v3
    v_mul_f32 v69, v69, v3
    v_mul_f32 v70, v70, v3
    v_mul_f32 v71, v71, v3
    v_mul_f32 v72, v72, v3
    v_mul_f32 v73, v73, v3
    v_mul_f32 v74, v74, v3
    v_mul_f32 v75, v75, v3
    v_mul_f32 v76, v76, v3
    v_mul_f32 v77, v77, v3
    v_add_f32 v31, v31, v22
    v_add_f32 v31, v31, v23
    v_add_f32 v31, v31, v24
    v_add_f32 v31, v31, v25
    v_add_f32 v31, v31, v26
    v_add_f32 v31, v31, v27
    v_add_f32 v31, v31, v28
    v_add_f32 v31, v31, v29
    s_waitcnt vmcnt(9)
    v_lshlrev_b32 v4, 16, v78
    v_and_b32 v5, 0xffff0000, v78
    v_fmac_f32 v54, v22, v4
    v_fmac_f32 v55, v22, v5
    v_lshlrev_b32 v4, 16, v79
    v_and_b32 v5, 0xffff0000, v79
    v_fmac_f32 v56, v22, v4
    v_fmac_f32 v57, v22, v5
    v_lshlrev_b32 v4, 16, v80
    v_and_b32 v5, 0xffff0000, v80
    v_fmac_f32 v58, v22, v4
    v_fmac_f32 v59, v22, v5
    v_lshlrev_b32 v4, 16, v81
    v_and_b32 v5, 0xffff0000, v81
    v_fmac_f32 v60, v22, v4
    v_fmac_f32 v61, v22, v5
    v_lshlrev_b32 v4, 16, v82
    v_and_b32 v5, 0xffff0000, v82
    v_fmac_f32 v62, v22, v4
    v_fmac_f32 v63, v22, v5
    v_lshlrev_b32 v4, 16, v83
    v_and_b32 v5, 0xffff0000, v83
    v_fmac_f32 v64, v22, v4
    v_fmac_f32 v65, v22, v5
    v_lshlrev_b32 v4, 16, v84
    v_and_b32 v5, 0xffff0000, v84
    v_fmac_f32 v66, v22, v4
    v_fmac_f32 v67, v22, v5
    v_lshlrev_b32 v4, 16, v85
    v_and_b32 v5, 0xffff0000, v85
    v_fmac_f32 v68, v22, v4
    v_fmac_f32 v69, v22, v5
    v_lshlrev_b32 v4, 16, v86
    v_and_b32 v5, 0xffff0000, v86
    v_fmac_f32 v70, v22, v4
    v_fmac_f32 v71, v22, v5
    v_lshlrev_b32 v4, 16, v87
    v_and_b32 v5, 0xffff0000, v87
    v_fmac_f32 v72, v22, v4
    v_fmac_f32 v73, v22, v5
    v_lshlrev_b32 v4, 16, v88
    v_and_b32 v5, 0xffff0000, v88
    v_fmac_f32 v74, v22, v4
    v_fmac_f32 v75, v22, v5
    v_lshlrev_b32 v4, 16, v89
    v_and_b32 v5, 0xffff0000, v89
    v_fmac_f32 v76, v22, v4
    v_fmac_f32 v77, v22, v5
    s_add_u32 s48, s41, 12288
    buffer_load_dwordx4 v[78:81], v1, s[20:23], s48 offen offset:0 nt
    buffer_load_dwordx4 v[82:85], v1, s[20:23], s48 offen offset:128 nt
    buffer_load_dwordx4 v[86:89], v1, s[20:23], s48 offen offset:256 nt
    s_waitcnt vmcnt(9)
    v_lshlrev_b32 v4, 16, v90
    v_and_b32 v5, 0xffff0000, v90
    v_fmac_f32 v54, v23, v4
    v_fmac_f32 v55, v23, v5
    v_lshlrev_b32 v4, 16, v91
    v_and_b32 v5, 0xffff0000, v91
    v_fmac_f32 v56, v23, v4
    v_fmac_f32 v57, v23, v5
    v_lshlrev_b32 v4, 16, v92
    v_and_b32 v5, 0xffff0000, v92
    v_fmac_f32 v58, v23, v4
    v_fmac_f32 v59, v23, v5
    v_lshlrev_b32 v4, 16, v93
    v_and_b32 v5, 0xffff0000, v93
    v_fmac_f32 v60, v23, v4
    v_fmac_f32 v61, v23, v5
    v_lshlrev_b32 v4, 16, v94
    v_and_b32 v5, 0xffff0000, v94
    v_fmac_f32 v62, v23, v4
    v_fmac_f32 v63, v23, v5
    v_lshlrev_b32 v4, 16, v95
    v_and_b32 v5, 0xffff0000, v95
    v_fmac_f32 v64, v23, v4
    v_fmac_f32 v65, v23, v5
    v_lshlrev_b32 v4, 16, v96
    v_and_b32 v5, 0xffff0000, v96
    v_fmac_f32 v66, v23, v4
    v_fmac_f32 v67, v23, v5
    v_lshlrev_b32 v4, 16, v97
    v_and_b32 v5, 0xffff0000, v97
    v_fmac_f32 v68, v23, v4
    v_fmac_f32 v69, v23, v5
    v_lshlrev_b32 v4, 16, v98
    v_and_b32 v5, 0xffff0000, v98
    v_fmac_f32 v70, v23, v4
    v_fmac_f32 v71, v23, v5
    v_lshlrev_b32 v4, 16, v99
    v_and_b32 v5, 0xffff0000, v99
    v_fmac_f32 v72, v23, v4
    v_fmac_f32 v73, v23, v5
    v_lshlrev_b32 v4, 16, v100
    v_and_b32 v5, 0xffff0000, v100
    v_fmac_f32 v74, v23, v4
    v_fmac_f32 v75, v23, v5
    v_lshlrev_b32 v4, 16, v101
    v_and_b32 v5, 0xffff0000, v101
    v_fmac_f32 v76, v23, v4
    v_fmac_f32 v77, v23, v5
    s_add_u32 s48, s41, 15360
    buffer_load_dwordx4 v[90:93], v1, s[20:23], s48 offen offset:0 nt
    buffer_load_dwordx4 v[94:97], v1, s[20:23], s48 offen offset:128 nt
    buffer_load_dwordx4 v[98:101], v1, s[20:23], s48 offen offset:256 nt
    s_waitcnt vmcnt(9)
    v_lshlrev_b32 v4, 16, v102
    v_and_b32 v5, 0xffff0000, v102
    v_fmac_f32 v54, v24, v4
    v_fmac_f32 v55, v24, v5
    v_lshlrev_b32 v4, 16, v103
    v_and_b32 v5, 0xffff0000, v103
    v_fmac_f32 v56, v24, v4
    v_fmac_f32 v57, v24, v5
    v_lshlrev_b32 v4, 16, v104
    v_and_b32 v5, 0xffff0000, v104
    v_fmac_f32 v58, v24, v4
    v_fmac_f32 v59, v24, v5
    v_lshlrev_b32 v4, 16, v105
    v_and_b32 v5, 0xffff0000, v105
    v_fmac_f32 v60, v24, v4
    v_fmac_f32 v61, v24, v5
    v_lshlrev_b32 v4, 16, v106
    v_and_b32 v5, 0xffff0000, v106
    v_fmac_f32 v62, v24, v4
    v_fmac_f32 v63, v24, v5
    v_lshlrev_b32 v4, 16, v107
    v_and_b32 v5, 0xffff0000, v107
    v_fmac_f32 v64, v24, v4
    v_fmac_f32 v65, v24, v5
    v_lshlrev_b32 v4, 16, v108
    v_and_b32 v5, 0xffff0000, v108
    v_fmac_f32 v66, v24, v4
    v_fmac_f32 v67, v24, v5
    v_lshlrev_b32 v4, 16, v109
    v_and_b32 v5, 0xffff0000, v109
    v_fmac_f32 v68, v24, v4
    v_fmac_f32 v69, v24, v5
    v_lshlrev_b32 v4, 16, v110
    v_and_b32 v5, 0xffff0000, v110
    v_fmac_f32 v70, v24, v4
    v_fmac_f32 v71, v24, v5
    v_lshlrev_b32 v4, 16, v111
    v_and_b32 v5, 0xffff0000, v111
    v_fmac_f32 v72, v24, v4
    v_fmac_f32 v73, v24, v5
    v_lshlrev_b32 v4, 16, v112
    v_and_b32 v5, 0xffff0000, v112
    v_fmac_f32 v74, v24, v4
    v_fmac_f32 v75, v24, v5
    v_lshlrev_b32 v4, 16, v113
    v_and_b32 v5, 0xffff0000, v113
    v_fmac_f32 v76, v24, v4
    v_fmac_f32 v77, v24, v5
    s_add_u32 s48, s41, 18432
    buffer_load_dwordx4 v[102:105], v1, s[20:23], s48 offen offset:0 nt
    buffer_load_dwordx4 v[106:109], v1, s[20:23], s48 offen offset:128 nt
    buffer_load_dwordx4 v[110:113], v1, s[20:23], s48 offen offset:256 nt
    s_waitcnt vmcnt(9)
    v_lshlrev_b32 v4, 16, v114
    v_and_b32 v5, 0xffff0000, v114
    v_fmac_f32 v54, v25, v4
    v_fmac_f32 v55, v25, v5
    v_lshlrev_b32 v4, 16, v115
    v_and_b32 v5, 0xffff0000, v115
    v_fmac_f32 v56, v25, v4
    v_fmac_f32 v57, v25, v5
    v_lshlrev_b32 v4, 16, v116
    v_and_b32 v5, 0xffff0000, v116
    v_fmac_f32 v58, v25, v4
    v_fmac_f32 v59, v25, v5
    v_lshlrev_b32 v4, 16, v117
    v_and_b32 v5, 0xffff0000, v117
    v_fmac_f32 v60, v25, v4
    v_fmac_f32 v61, v25, v5
    v_lshlrev_b32 v4, 16, v118
    v_and_b32 v5, 0xffff0000, v118
    v_fmac_f32 v62, v25, v4
    v_fmac_f32 v63, v25, v5
    v_lshlrev_b32 v4, 16, v119
    v_and_b32 v5, 0xffff0000, v119
    v_fmac_f32 v64, v25, v4
    v_fmac_f32 v65, v25, v5
    v_lshlrev_b32 v4, 16, v120
    v_and_b32 v5, 0xffff0000, v120
    v_fmac_f32 v66, v25, v4
    v_fmac_f32 v67, v25, v5
    v_lshlrev_b32 v4, 16, v121
    v_and_b32 v5, 0xffff0000, v121
    v_fmac_f32 v68, v25, v4
    v_fmac_f32 v69, v25, v5
    v_lshlrev_b32 v4, 16, v122
    v_and_b32 v5, 0xffff0000, v122
    v_fmac_f32 v70, v25, v4
    v_fmac_f32 v71, v25, v5
    v_lshlrev_b32 v4, 16, v123
    v_and_b32 v5, 0xffff0000, v123
    v_fmac_f32 v72, v25, v4
    v_fmac_f32 v73, v25, v5
    v_lshlrev_b32 v4, 16, v124
    v_and_b32 v5, 0xffff0000, v124
    v_fmac_f32 v74, v25, v4
    v_fmac_f32 v75, v25, v5
    v_lshlrev_b32 v4, 16, v125
    v_and_b32 v5, 0xffff0000, v125
    v_fmac_f32 v76, v25, v4
    v_fmac_f32 v77, v25, v5
    s_add_u32 s48, s41, 21504
    buffer_load_dwordx4 v[114:117], v1, s[20:23], s48 offen offset:0 nt
    buffer_load_dwordx4 v[118:121], v1, s[20:23], s48 offen offset:128 nt
    buffer_load_dwordx4 v[122:125], v1, s[20:23], s48 offen offset:256 nt
    s_waitcnt vmcnt(9)
    v_lshlrev_b32 v4, 16, v78
    v_and_b32 v5, 0xffff0000, v78
    v_fmac_f32 v54, v26, v4
    v_fmac_f32 v55, v26, v5
    v_lshlrev_b32 v4, 16, v79
    v_and_b32 v5, 0xffff0000, v79
    v_fmac_f32 v56, v26, v4
    v_fmac_f32 v57, v26, v5
    v_lshlrev_b32 v4, 16, v80
    v_and_b32 v5, 0xffff0000, v80
    v_fmac_f32 v58, v26, v4
    v_fmac_f32 v59, v26, v5
    v_lshlrev_b32 v4, 16, v81
    v_and_b32 v5, 0xffff0000, v81
    v_fmac_f32 v60, v26, v4
    v_fmac_f32 v61, v26, v5
    v_lshlrev_b32 v4, 16, v82
    v_and_b32 v5, 0xffff0000, v82
    v_fmac_f32 v62, v26, v4
    v_fmac_f32 v63, v26, v5
    v_lshlrev_b32 v4, 16, v83
    v_and_b32 v5, 0xffff0000, v83
    v_fmac_f32 v64, v26, v4
    v_fmac_f32 v65, v26, v5
    v_lshlrev_b32 v4, 16, v84
    v_and_b32 v5, 0xffff0000, v84
    v_fmac_f32 v66, v26, v4
    v_fmac_f32 v67, v26, v5
    v_lshlrev_b32 v4, 16, v85
    v_and_b32 v5, 0xffff0000, v85
    v_fmac_f32 v68, v26, v4
    v_fmac_f32 v69, v26, v5
    v_lshlrev_b32 v4, 16, v86
    v_and_b32 v5, 0xffff0000, v86
    v_fmac_f32 v70, v26, v4
    v_fmac_f32 v71, v26, v5
    v_lshlrev_b32 v4, 16, v87
    v_and_b32 v5, 0xffff0000, v87
    v_fmac_f32 v72, v26, v4
    v_fmac_f32 v73, v26, v5
    v_lshlrev_b32 v4, 16, v88
    v_and_b32 v5, 0xffff0000, v88
    v_fmac_f32 v74, v26, v4
    v_fmac_f32 v75, v26, v5
    v_lshlrev_b32 v4, 16, v89
    v_and_b32 v5, 0xffff0000, v89
    v_fmac_f32 v76, v26, v4
    v_fmac_f32 v77, v26, v5
    s_add_u32 s48, s47, 0
    buffer_load_dwordx4 v[78:81], v1, s[16:19], s48 offen offset:0 nt
    buffer_load_dwordx4 v[82:85], v1, s[16:19], s48 offen offset:128 nt
    buffer_load_dwordx4 v[86:89], v1, s[16:19], s48 offen offset:256 nt
    s_waitcnt vmcnt(9)
    v_lshlrev_b32 v4, 16, v90
    v_and_b32 v5, 0xffff0000, v90
    v_fmac_f32 v54, v27, v4
    v_fmac_f32 v55, v27, v5
    v_lshlrev_b32 v4, 16, v91
    v_and_b32 v5, 0xffff0000, v91
    v_fmac_f32 v56, v27, v4
    v_fmac_f32 v57, v27, v5
    v_lshlrev_b32 v4, 16, v92
    v_and_b32 v5, 0xffff0000, v92
    v_fmac_f32 v58, v27, v4
    v_fmac_f32 v59, v27, v5
    v_lshlrev_b32 v4, 16, v93
    v_and_b32 v5, 0xffff0000, v93
    v_fmac_f32 v60, v27, v4
    v_fmac_f32 v61, v27, v5
    v_lshlrev_b32 v4, 16, v94
    v_and_b32 v5, 0xffff0000, v94
    v_fmac_f32 v62, v27, v4
    v_fmac_f32 v63, v27, v5
    v_lshlrev_b32 v4, 16, v95
    v_and_b32 v5, 0xffff0000, v95
    v_fmac_f32 v64, v27, v4
    v_fmac_f32 v65, v27, v5
    v_lshlrev_b32 v4, 16, v96
    v_and_b32 v5, 0xffff0000, v96
    v_fmac_f32 v66, v27, v4
    v_fmac_f32 v67, v27, v5
    v_lshlrev_b32 v4, 16, v97
    v_and_b32 v5, 0xffff0000, v97
    v_fmac_f32 v68, v27, v4
    v_fmac_f32 v69, v27, v5
    v_lshlrev_b32 v4, 16, v98
    v_and_b32 v5, 0xffff0000, v98
    v_fmac_f32 v70, v27, v4
    v_fmac_f32 v71, v27, v5
    v_lshlrev_b32 v4, 16, v99
    v_and_b32 v5, 0xffff0000, v99
    v_fmac_f32 v72, v27, v4
    v_fmac_f32 v73, v27, v5
    v_lshlrev_b32 v4, 16, v100
    v_and_b32 v5, 0xffff0000, v100
    v_fmac_f32 v74, v27, v4
    v_fmac_f32 v75, v27, v5
    v_lshlrev_b32 v4, 16, v101
    v_and_b32 v5, 0xffff0000, v101
    v_fmac_f32 v76, v27, v4
    v_fmac_f32 v77, v27, v5
    s_add_u32 s48, s47, 3072
    buffer_load_dwordx4 v[90:93], v1, s[16:19], s48 offen offset:0 nt
    buffer_load_dwordx4 v[94:97], v1, s[16:19], s48 offen offset:128 nt
    buffer_load_dwordx4 v[98:101], v1, s[16:19], s48 offen offset:256 nt
    s_waitcnt vmcnt(9)
    v_lshlrev_b32 v4, 16, v102
    v_and_b32 v5, 0xffff0000, v102
    v_fmac_f32 v54, v28, v4
    v_fmac_f32 v55, v28, v5
    v_lshlrev_b32 v4, 16, v103
    v_and_b32 v5, 0xffff0000, v103
    v_fmac_f32 v56, v28, v4
    v_fmac_f32 v57, v28, v5
    v_lshlrev_b32 v4, 16, v104
    v_and_b32 v5, 0xffff0000, v104
    v_fmac_f32 v58, v28, v4
    v_fmac_f32 v59, v28, v5
    v_lshlrev_b32 v4, 16, v105
    v_and_b32 v5, 0xffff0000, v105
    v_fmac_f32 v60, v28, v4
    v_fmac_f32 v61, v28, v5
    v_lshlrev_b32 v4, 16, v106
    v_and_b32 v5, 0xffff0000, v106
    v_fmac_f32 v62, v28, v4
    v_fmac_f32 v63, v28, v5
    v_lshlrev_b32 v4, 16, v107
    v_and_b32 v5, 0xffff0000, v107
    v_fmac_f32 v64, v28, v4
    v_fmac_f32 v65, v28, v5
    v_lshlrev_b32 v4, 16, v108
    v_and_b32 v5, 0xffff0000, v108
    v_fmac_f32 v66, v28, v4
    v_fmac_f32 v67, v28, v5
    v_lshlrev_b32 v4, 16, v109
    v_and_b32 v5, 0xffff0000, v109
    v_fmac_f32 v68, v28, v4
    v_fmac_f32 v69, v28, v5
    v_lshlrev_b32 v4, 16, v110
    v_and_b32 v5, 0xffff0000, v110
    v_fmac_f32 v70, v28, v4
    v_fmac_f32 v71, v28, v5
    v_lshlrev_b32 v4, 16, v111
    v_and_b32 v5, 0xffff0000, v111
    v_fmac_f32 v72, v28, v4
    v_fmac_f32 v73, v28, v5
    v_lshlrev_b32 v4, 16, v112
    v_and_b32 v5, 0xffff0000, v112
    v_fmac_f32 v74, v28, v4
    v_fmac_f32 v75, v28, v5
    v_lshlrev_b32 v4, 16, v113
    v_and_b32 v5, 0xffff0000, v113
    v_fmac_f32 v76, v28, v4
    v_fmac_f32 v77, v28, v5
    s_add_u32 s48, s47, 6144
    buffer_load_dwordx4 v[102:105], v1, s[16:19], s48 offen offset:0 nt
    buffer_load_dwordx4 v[106:109], v1, s[16:19], s48 offen offset:128 nt
    buffer_load_dwordx4 v[110:113], v1, s[16:19], s48 offen offset:256 nt
    s_waitcnt vmcnt(9)
    v_lshlrev_b32 v4, 16, v114
    v_and_b32 v5, 0xffff0000, v114
    v_fmac_f32 v54, v29, v4
    v_fmac_f32 v55, v29, v5
    v_lshlrev_b32 v4, 16, v115
    v_and_b32 v5, 0xffff0000, v115
    v_fmac_f32 v56, v29, v4
    v_fmac_f32 v57, v29, v5
    v_lshlrev_b32 v4, 16, v116
    v_and_b32 v5, 0xffff0000, v116
    v_fmac_f32 v58, v29, v4
    v_fmac_f32 v59, v29, v5
    v_lshlrev_b32 v4, 16, v117
    v_and_b32 v5, 0xffff0000, v117
    v_fmac_f32 v60, v29, v4
    v_fmac_f32 v61, v29, v5
    v_lshlrev_b32 v4, 16, v118
    v_and_b32 v5, 0xffff0000, v118
    v_fmac_f32 v62, v29, v4
    v_fmac_f32 v63, v29, v5
    v_lshlrev_b32 v4, 16, v119
    v_and_b32 v5, 0xffff0000, v119
    v_fmac_f32 v64, v29, v4
    v_fmac_f32 v65, v29, v5
    v_lshlrev_b32 v4, 16, v120
    v_and_b32 v5, 0xffff0000, v120
    v_fmac_f32 v66, v29, v4
    v_fmac_f32 v67, v29, v5
    v_lshlrev_b32 v4, 16, v121
    v_and_b32 v5, 0xffff0000, v121
    v_fmac_f32 v68, v29, v4
    v_fmac_f32 v69, v29, v5
    v_lshlrev_b32 v4, 16, v122
    v_and_b32 v5, 0xffff0000, v122
    v_fmac_f32 v70, v29, v4
    v_fmac_f32 v71, v29, v5
    v_lshlrev_b32 v4, 16, v123
    v_and_b32 v5, 0xffff0000, v123
    v_fmac_f32 v72, v29, v4
    v_fmac_f32 v73, v29, v5
    v_lshlrev_b32 v4, 16, v124
    v_and_b32 v5, 0xffff0000, v124
    v_fmac_f32 v74, v29, v4
    v_fmac_f32 v75, v29, v5
    v_lshlrev_b32 v4, 16, v125
    v_and_b32 v5, 0xffff0000, v125
    v_fmac_f32 v76, v29, v4
    v_fmac_f32 v77, v29, v5
    s_add_u32 s48, s47, 9216
    buffer_load_dwordx4 v[114:117], v1, s[16:19], s48 offen offset:0 nt
    buffer_load_dwordx4 v[118:121], v1, s[16:19], s48 offen offset:128 nt
    buffer_load_dwordx4 v[122:125], v1, s[16:19], s48 offen offset:256 nt
    s_mov_b32 s41, s47
    s_cmp_lt_u32 s41, s96
    s_cbranch_scc1 L_loop
L_pool_end:
    v_mov_b32 v2, v30
    v_mov_b32 v3, v31
    s_nop 1
    v_add_f32_dpp v3, v3, v3 quad_perm:[1,0,3,2] row_mask:0xf bank_mask:0xf
    s_nop 1
    v_add_f32_dpp v3, v3, v3 quad_perm:[2,3,0,1] row_mask:0xf bank_mask:0xf
    s_nop 1
    v_add_f32_dpp v3, v3, v3 row_half_mirror row_mask:0xf bank_mask:0xf
    s_nop 1
    v_add_f32_dpp v3, v3, v3 row_mirror row_mask:0xf bank_mask:0xf
    s_nop 1
    v_readlane_b32 s48, v3, 0
    v_readlane_b32 s49, v3, 16
    v_readlane_b32 s50, v3, 32
    v_readlane_b32 s51, v3, 48
    s_nop 1
    v_mov_b32 v3, s48
    v_add_f32 v3, s49, v3
    v_add_f32 v3, s50, v3
    v_add_f32 v3, s51, v3
    v_mul_f32 v3, 0.125, v3
    s_nop 1
    v_permlane32_swap_b32 v54, v58
    v_permlane32_swap_b32 v55, v59
    v_permlane32_swap_b32 v56, v60
    v_permlane32_swap_b32 v57, v61
    v_permlane32_swap_b32 v62, v66
    v_permlane32_swap_b32 v63, v67
    v_permlane32_swap_b32 v64, v68
    v_permlane32_swap_b32 v65, v69
    v_permlane32_swap_b32 v70, v74
    v_permlane32_swap_b32 v71, v75
    v_permlane32_swap_b32 v72, v76
    v_permlane32_swap_b32 v73, v77
    v_add_f32 v54, v54, v58
    v_add_f32 v55, v55, v59
    v_add_f32 v56, v56, v60
    v_add_f32 v57, v57, v61
    v_add_f32 v62, v62, v66
    v_add_f32 v63, v63, v67
    v_add_f32 v64, v64, v68
    v_add_f32 v65, v65, v69
    v_add_f32 v70, v70, v74
    v_add_f32 v71, v71, v75
    v_add_f32 v72, v72, v76
    v_add_f32 v73, v73, v77
    s_nop 1
    v_permlane16_swap_b32 v54, v56
    v_permlane16_swap_b32 v55, v57
    v_permlane16_swap_b32 v62, v64
    v_permlane16_swap_b32 v63, v65
    v_permlane16_swap_b32 v70, v72
    v_permlane16_swap_b32 v71, v73
    v_add_f32 v54, v54, v56
    v_add_f32 v55, v55, v57
    v_add_f32 v62, v62, v64
    v_add_f32 v63, v63, v65
    v_add_f32 v70, v70, v72
    v_add_f32 v71, v71, v73
    s_nop 1
    v_add_f32_dpp v54, v54, v54 row_ror:8 row_mask:0xf bank_mask:0xf
    v_add_f32_dpp v55, v55, v55 row_ror:8 row_mask:0xf bank_mask:0xf
    v_add_f32_dpp v62, v62, v62 row_ror:8 row_mask:0xf bank_mask:0xf
    v_add_f32_dpp v63, v63, v63 row_ror:8 row_mask:0xf bank_mask:0xf
    v_add_f32_dpp v70, v70, v70 row_ror:8 row_mask:0xf bank_mask:0xf
    v_add_f32_dpp v71, v71, v71 row_ror:8 row_mask:0xf bank_mask:0xf
    ds_write_b64 v9, v[54:55] offset:0
    ds_write_b64 v9, v[62:63] offset:256
    ds_write_b64 v9, v[70:71] offset:512
    v_lshrrev_b32 v4, 6, v0
    v_lshlrev_b32 v4, 3, v4
    ds_write_b64 v4, v[2:3] offset:12800
    s_waitcnt lgkmcnt(0)
    s_barrier
    s_cmp_lg_u32 s53, 3
    s_cbranch_scc1 L_noarr
    s_mov_b64 exec, 1
    v_mov_b32 v4, 0
    v_mov_b32 v5, 1
    buffer_atomic_add v5, v4, s[36:39], 0 offen sc0 sc1
    s_waitcnt vmcnt(0)
    v_mov_b32 v4, 12928
    ds_write_b32 v4, v5
    v_readfirstlane_b32 s48, v5
    s_waitcnt lgkmcnt(0)
    s_mov_b64 exec, -1
    v_lshlrev_b32 v4, 7, v6
    v_mov_b32 v5, 1
    s_cmp_lg_u32 s48, 223
    s_cbranch_scc1 L_e3
    s_mov_b32 s48, 458756
    buffer_store_dword v5, v4, s[32:35], s48 offen sc0 sc1
    s_mov_b32 s48, 466948
    buffer_store_dword v5, v4, s[32:35], s48 offen sc0 sc1
    s_mov_b32 s48, 475140
    buffer_store_dword v5, v4, s[32:35], s48 offen sc0 sc1
    s_mov_b32 s48, 483332
    buffer_store_dword v5, v4, s[32:35], s48 offen sc0 sc1
    s_branch L_e2
L_e3:
    s_cmp_lg_u32 s48, 255
    s_cbranch_scc1 L_e2
    s_mov_b32 s48, 458752
    buffer_store_dword v5, v4, s[32:35], s48 offen sc0 sc1
    s_mov_b32 s48, 466944
    buffer_store_dword v5, v4, s[32:35], s48 offen sc0 sc1
    s_mov_b32 s48, 475136
    buffer_store_dword v5, v4, s[32:35], s48 offen sc0 sc1
    s_mov_b32 s48, 483328
    buffer_store_dword v5, v4, s[32:35], s48 offen sc0 sc1
    s_branch L_e2
L_noarr:
    v_cmp_gt_u32 vcc, 192, v0
    s_and_saveexec_b64 s[100:101], vcc
    s_cbranch_execz L_e1
    v_lshlrev_b32 v2, 2, v0
    v_and_b32 v4, 15, v6
    v_lshlrev_b32 v4, 3, v4
    ds_read_b64 v[22:23], v4 offset:12800
    ds_read_b32 v54, v2 offset:0
    ds_read_b32 v55, v2 offset:768
    ds_read_b32 v56, v2 offset:1536
    ds_read_b32 v57, v2 offset:2304
    ds_read_b32 v58, v2 offset:3072
    ds_read_b32 v59, v2 offset:3840
    ds_read_b32 v60, v2 offset:4608
    ds_read_b32 v61, v2 offset:5376
    s_waitcnt lgkmcnt(8)
    ds_read_b32 v62, v2 offset:6144
    ds_read_b32 v63, v2 offset:6912
    ds_read_b32 v64, v2 offset:7680
    ds_read_b32 v65, v2 offset:8448
    ds_read_b32 v66, v2 offset:9216
    ds_read_b32 v67, v2 offset:9984
    ds_read_b32 v68, v2 offset:10752
    ds_read_b32 v69, v2 offset:11520
    v_mov_b32 v3, v22
    s_nop 1
    v_max_f32_dpp v3, v3, v3 quad_perm:[1,0,3,2] row_mask:0xf bank_mask:0xf
    s_nop 1
    v_max_f32_dpp v3, v3, v3 quad_perm:[2,3,0,1] row_mask:0xf bank_mask:0xf
    s_nop 1
    v_max_f32_dpp v3, v3, v3 row_half_mirror row_mask:0xf bank_mask:0xf
    s_nop 1
    v_max_f32_dpp v3, v3, v3 row_mirror row_mask:0xf bank_mask:0xf
    v_sub_f32 v24, v22, v3
    v_mul_f32 v24, 0x3fb8aa3b, v24
    v_exp_f32 v24, v24
    s_nop 0
    v_mul_f32 v5, v24, v23
    s_nop 1
    v_add_f32_dpp v5, v5, v5 quad_perm:[1,0,3,2] row_mask:0xf bank_mask:0xf
    s_nop 1
    v_add_f32_dpp v5, v5, v5 quad_perm:[2,3,0,1] row_mask:0xf bank_mask:0xf
    s_nop 1
    v_add_f32_dpp v5, v5, v5 row_half_mirror row_mask:0xf bank_mask:0xf
    s_nop 1
    v_add_f32_dpp v5, v5, v5 row_mirror row_mask:0xf bank_mask:0xf
    s_waitcnt lgkmcnt(0)
    v_mul_f32_dpp v4, v24, v54 row_newbcast:0 row_mask:0xf bank_mask:0xf
    v_mul_f32_dpp v25, v24, v55 row_newbcast:1 row_mask:0xf bank_mask:0xf
    v_fmac_f32_dpp v4, v24, v56 row_newbcast:2 row_mask:0xf bank_mask:0xf
    v_fmac_f32_dpp v25, v24, v57 row_newbcast:3 row_mask:0xf bank_mask:0xf
    v_fmac_f32_dpp v4, v24, v58 row_newbcast:4 row_mask:0xf bank_mask:0xf
    v_fmac_f32_dpp v25, v24, v59 row_newbcast:5 row_mask:0xf bank_mask:0xf
    v_fmac_f32_dpp v4, v24, v60 row_newbcast:6 row_mask:0xf bank_mask:0xf
    v_fmac_f32_dpp v25, v24, v61 row_newbcast:7 row_mask:0xf bank_mask:0xf
    v_fmac_f32_dpp v4, v24, v62 row_newbcast:8 row_mask:0xf bank_mask:0xf
    v_fmac_f32_dpp v25, v24, v63 row_newbcast:9 row_mask:0xf bank_mask:0xf
    v_fmac_f32_dpp v4, v24, v64 row_newbcast:10 row_mask:0xf bank_mask:0xf
    v_fmac_f32_dpp v25, v24, v65 row_newbcast:11 row_mask:0xf bank_mask:0xf
    v_fmac_f32_dpp v4, v24, v66 row_newbcast:12 row_mask:0xf bank_mask:0xf
    v_fmac_f32_dpp v25, v24, v67 row_newbcast:13 row_mask:0xf bank_mask:0xf
    v_fmac_f32_dpp v4, v24, v68 row_newbcast:14 row_mask:0xf bank_mask:0xf
    v_fmac_f32_dpp v25, v24, v69 row_newbcast:15 row_mask:0xf bank_mask:0xf
    v_add_f32 v4, v4, v25
    v_mov_b32 v12, v4
    v_mov_b32 v14, v3
    v_mov_b32 v15, v5
    v_mov_b32_dpp v13, v4 quad_perm:[1,0,3,2] row_mask:0xf bank_mask:0xf
    v_lshlrev_b32 v2, 3, v0
    s_mul_i32 s48, s40, 1536
    s_add_u32 s48, s48, 1048576
    s_mov_b32 exec_lo, 0x55555555
    s_mov_b32 exec_hi, 0x55555555
    buffer_store_dwordx4 v[12:15], v2, s[32:35], s48 offen sc0 sc1
L_e1:
    s_mov_b64 exec, s[100:101]
L_e2:
    s_waitcnt vmcnt(0)
    s_barrier
    v_mov_b32 v12, 12928
    ds_read_b32 v13, v12
    s_waitcnt lgkmcnt(0)
    v_readfirstlane_b32 s97, v13
    s_mul_i32 s48, s97, 6554
    s_lshr_b32 s54, s48, 16
    s_mul_i32 s48, s54, 10
    s_sub_u32 s55, s97, s48
    s_mov_b32 s98, 0
    s_cmp_lt_u32 s97, 80
    s_cbranch_scc1 L_role_2
    s_mov_b32 s98, 1
    s_sub_u32 s55, s97, 80
    s_cmp_ge_u32 s55, 24
    s_cselect_b32 s54, 1, 0
    s_mul_i32 s48, s54, 24
    s_sub_u32 s55, s55, s48
    s_cmp_lt_u32 s97, 128
    s_cbranch_scc1 L_role_2
    s_mov_b32 s98, 2
    s_sub_u32 s55, s97, 128
    s_cmp_lt_u32 s97, 148
    s_cbranch_scc1 L_role_2
    s_mov_b32 s98, 3
L_role_2:
    s_cmp_eq_u32 s54, 1
    s_cselect_b32 s64, s92, s64
    s_cselect_b32 s65, s93, s65
    s_cmp_eq_u32 s98, 3
    s_cbranch_scc1 L_dma_end
    s_cmp_eq_u32 s98, 2
    s_cbranch_scc1 L_dma_e
    v_lshrrev_b32 v126, 3, v6
    v_and_b32 v127, 7, v6
    v_lshlrev_b32 v127, 4, v127
    s_cmp_eq_u32 s98, 1
    s_cbranch_scc1 L_dma_d
    v_mul_u32_u24 v126, 1280, v126
    v_add_u32 v126, v126, v127
    s_mul_i32 s48, s54, 768
    s_mul_i32 s49, s53, 48
    s_add_u32 s48, s48, s49
    s_mul_i32 s48, s48, 1280
    s_lshl_b32 s50, s55, 7
    s_add_u32 s48, s48, s50
    s_lshl_b32 s50, s49, 7
    s_add_u32 s50, s50, 42496
    s_mov_b32 m0, s50
    s_nop 0
    buffer_load_dwordx4 v126, s[60:63], s48 offen nt lds
    s_add_u32 s48, s48, 10240
    s_add_u32 s50, s50, 1024
    s_mov_b32 m0, s50
    s_nop 0
    buffer_load_dwordx4 v126, s[60:63], s48 offen nt lds
    s_add_u32 s48, s48, 10240
    s_add_u32 s50, s50, 1024
    s_mov_b32 m0, s50
    s_nop 0
    buffer_load_dwordx4 v126, s[60:63], s48 offen nt lds
    s_add_u32 s48, s48, 10240
    s_add_u32 s50, s50, 1024
    s_mov_b32 m0, s50
    s_nop 0
    buffer_load_dwordx4 v126, s[60:63], s48 offen nt lds
    s_add_u32 s48, s48, 10240
    s_add_u32 s50, s50, 1024
    s_mov_b32 m0, s50
    s_nop 0
    buffer_load_dwordx4 v126, s[60:63], s48 offen nt lds
    s_add_u32 s48, s48, 10240
    s_add_u32 s50, s50, 1024
    s_mov_b32 m0, s50
    s_nop 0
    buffer_load_dwordx4 v126, s[60:63], s48 offen nt lds
    s_branch L_dma_end
L_dma_d:
    v_mul_u32_u24 v126, 3072, v126
    v_add_u32 v126, v126, v127
    s_mul_i32 s49, s53, 40
    s_mul_i32 s48, s49, 3072
    s_lshl_b32 s50, s55, 7
    s_add_u32 s48, s48, s50
    s_lshl_b32 s50, s49, 7
    s_add_u32 s50, s50, 42496
    s_mov_b32 m0, s50
    s_nop 0
    buffer_load_dwordx4 v126, s[64:67], s48 offen nt lds
    s_add_u32 s48, s48, 24576
    s_add_u32 s50, s50, 1024
    s_mov_b32 m0, s50
    s_nop 0
    buffer_load_dwordx4 v126, s[64:67], s48 offen nt lds
    s_add_u32 s48, s48, 24576
    s_add_u32 s50, s50, 1024
    s_mov_b32 m0, s50
    s_nop 0
    buffer_load_dwordx4 v126, s[64:67], s48 offen nt lds
    s_add_u32 s48, s48, 24576
    s_add_u32 s50, s50, 1024
    s_mov_b32 m0, s50
    s_nop 0
    buffer_load_dwordx4 v126, s[64:67], s48 offen nt lds
    s_add_u32 s48, s48, 24576
    s_add_u32 s50, s50, 1024
    s_mov_b32 m0, s50
    s_nop 0
    buffer_load_dwordx4 v126, s[64:67], s48 offen nt lds
    s_branch L_dma_end
L_dma_e:
    v_lshrrev_b32 v126, 2, v6
    v_and_b32 v127, 3, v6
    v_lshlrev_b32 v127, 4, v127
    v_mul_u32_u24 v126, 1280, v126
    v_add_u32 v126, v126, v127
    s_mul_i32 s49, s53, 96
    s_mul_i32 s48, s49, 1280
    s_lshl_b32 s50, s55, 6
    s_add_u32 s48, s48, s50
    s_lshl_b32 s50, s49, 6
    s_add_u32 s50, s50, 42496
    s_mov_b32 m0, s50
    s_nop 0
    buffer_load_dwordx4 v126, s[68:71], s48 offen nt lds
    s_add_u32 s48, s48, 20480
    s_add_u32 s50, s50, 1024
    s_mov_b32 m0, s50
    s_nop 0
    buffer_load_dwordx4 v126, s[68:71], s48 offen nt lds
    s_add_u32 s48, s48, 20480
    s_add_u32 s50, s50, 1024
    s_mov_b32 m0, s50
    s_nop 0
    buffer_load_dwordx4 v126, s[68:71], s48 offen nt lds
    s_add_u32 s48, s48, 20480
    s_add_u32 s50, s50, 1024
    s_mov_b32 m0, s50
    s_nop 0
    buffer_load_dwordx4 v126, s[68:71], s48 offen nt lds
    s_add_u32 s48, s48, 20480
    s_add_u32 s50, s50, 1024
    s_mov_b32 m0, s50
    s_nop 0
    buffer_load_dwordx4 v126, s[68:71], s48 offen nt lds
    s_add_u32 s48, s48, 20480
    s_add_u32 s50, s50, 1024
    s_mov_b32 m0, s50
    s_nop 0
    buffer_load_dwordx4 v126, s[68:71], s48 offen nt lds
L_dma_end:
    s_cmp_eq_u32 s98, 3
    s_cbranch_scc0 L_tail_go
    s_endpgm
L_tail_go:
    v_lshrrev_b32 v7, 6, v0
    s_cmp_eq_u32 s98, 0
    s_cbranch_scc1 L_tail_c
    s_cmp_eq_u32 s98, 1
    s_cbranch_scc1 L_tail_d
    s_cmp_lg_u32 s53, 0
    s_cbranch_scc1 L_gate_done
    s_lshl_b32 s44, s2, 7
    s_add_u32 s44, s44, 458752
    v_mov_b32 v122, 0
    s_mov_b32 s45, 0
    buffer_load_dword v123, v122, s[32:35], s44 offen sc0 sc1
L_gate_3:
    s_sleep 6
    buffer_load_dword v124, v122, s[32:35], s44 offen sc0 sc1
    s_waitcnt vmcnt(1)
    v_cmp_ne_u32 vcc, 1, v123
    s_cbranch_vccz L_gate_3_ok
    s_sleep 6
    buffer_load_dword v123, v122, s[32:35], s44 offen sc0 sc1
    s_waitcnt vmcnt(1)
    v_cmp_ne_u32 vcc, 1, v124
    s_add_u32 s45, s45, 1
    s_cbranch_vccz L_gate_3_ok
    s_cmp_lt_u32 s45, 0x20000
    s_cbranch_scc1 L_gate_3
L_gate_3_ok:
L_gate_done:
    s_cmp_eq_u32 s98, 1
    s_cbranch_scc1 L_tail_d
    s_branch L_tail_e
L_tail_c:
    v_mov_b32 v12, v0
    v_mul_u32_u24 v13, 43691, v12
    v_lshrrev_b32 v13, 24, v13
    v_mul_u32_u24 v14, 384, v13
    v_sub_u32 v12, v12, v14
    v_mul_u32_u24 v14, 43691, v12
    v_lshrrev_b32 v14, 22, v14
    v_mul_u32_u24 v40, 98304, v13
    v_mul_u32_u24 v15, 1536, v14
    v_add_u32 v40, v40, v15
    v_lshl_add_u32 v40, v12, 4, v40
    v_mul_u32_u24 v46, 3136, v13
    v_lshl_add_u32 v46, v12, 2, v46
    v_and_b32 v12, 511, v0
    v_add_u32 v12, 1024, v12
    v_mul_u32_u24 v13, 43691, v12
    v_lshrrev_b32 v13, 24, v13
    v_mul_u32_u24 v14, 384, v13
    v_sub_u32 v12, v12, v14
    v_mul_u32_u24 v14, 43691, v12
    v_lshrrev_b32 v14, 22, v14
    v_mul_u32_u24 v41, 98304, v13
    v_mul_u32_u24 v15, 1536, v14
    v_add_u32 v41, v41, v15
    v_lshl_add_u32 v41, v12, 4, v41
    v_mul_u32_u24 v47, 3136, v13
    v_lshl_add_u32 v47, v12, 2, v47
    v_and_b32 v12, 3, v6
    v_mul_u32_u24 v8, 3136, v12
    v_lshlrev_b32 v9, 3, v12
    v_lshrrev_b32 v12, 4, v6
    v_lshl_add_u32 v8, v12, 4, v8
    v_mul_u32_u24 v12, 1024, v12
    v_add_u32 v9, v9, v12
    v_bfe_u32 v12, v6, 2, 2
    v_mul_u32_u24 v12, 128, v12
    v_add_u32 v9, v9, v12
    s_mul_i32 s46, s54, 12288
    s_add_u32 s46, s46, 1048576
    s_cmp_lg_u32 s53, 0
    s_cbranch_scc1 L_c_f
    v_mov_b32 v12, 4
    s_mov_b32 s45, 0
L_c_clr:
    buffer_load_dword v13, v12, s[36:39], 0 offen sc0 sc1
    s_waitcnt vmcnt(0)
    v_cmp_gt_u32 vcc, 256, v13
    s_add_u32 s45, s45, 1
    s_cbranch_vccz L_c_clr_ok
    s_cmp_ge_u32 s45, 0x20000
    s_cbranch_scc1 L_c_clr_ok
    s_sleep 8
    s_branch L_c_clr
L_c_clr_ok:
    s_lshl_b32 s44, s2, 7
    s_add_u32 s44, s44, 458752
    v_mov_b32 v12, 0
    s_mov_b32 s45, 0
L_c_fl:
    buffer_load_dwordx2 v[14:15], v12, s[32:35], s44 offen sc0 sc1
    s_waitcnt vmcnt(0)
    v_min_u32 v14, v14, v15
    v_cmp_ne_u32 vcc, 1, v14
    s_add_u32 s45, s45, 1
    s_cbranch_vccz L_c_f
    s_cmp_ge_u32 s45, 0x20000
    s_cbranch_scc1 L_c_f
    s_sleep 6
    s_branch L_c_fl
L_c_f:
    s_waitcnt vmcnt(0)
    s_barrier
    s_lshr_b32 s48, s53, 2
    s_and_b32 s49, s53, 3
    s_mul_i32 s50, s48, 24576
    s_lshl_b32 s49, s49, 5
    s_add_u32 s50, s50, s49
    s_add_u32 s50, s50, 42496
    v_add_u32 v13, s50, v9
    ds_read_b64_tr_b16 v[80:81], v13 offset:0
    ds_read_b64_tr_b16 v[82:83], v13 offset:512
    ds_read_b64_tr_b16 v[84:85], v13 offset:4096
    ds_read_b64_tr_b16 v[86:87], v13 offset:4608
    ds_read_b64_tr_b16 v[88:89], v13 offset:8192
    ds_read_b64_tr_b16 v[90:91], v13 offset:8704
    ds_read_b64_tr_b16 v[92:93], v13 offset:12288
    ds_read_b64_tr_b16 v[94:95], v13 offset:12800
    ds_read_b64_tr_b16 v[112:113], v13 offset:16384
    ds_read_b64_tr_b16 v[114:115], v13 offset:16896
    ds_read_b64_tr_b16 v[116:117], v13 offset:20480
    ds_read_b64_tr_b16 v[118:119], v13 offset:20992
    s_cmp_ge_u32 s53, 8
    s_cbranch_scc1 L_c_one
    s_mov_b32 s47, 0xf
    s_mov_b32 s45, 0
L_ps_4:
    s_bitcmp1_b32 s47, 0
    s_cbranch_scc0 L_ps_4_i0
    buffer_load_dwordx4 v[64:67], v40, s[32:35], s46 offen offset:0 sc0 sc1
L_ps_4_i0:
    s_bitcmp1_b32 s47, 1
    s_cbranch_scc0 L_ps_4_i1
    buffer_load_dwordx4 v[68:71], v40, s[32:35], s46 offen offset:1536 sc0 sc1
L_ps_4_i1:
    s_bitcmp1_b32 s47, 2
    s_cbranch_scc0 L_ps_4_i2
    buffer_load_dwordx4 v[72:75], v41, s[32:35], s46 offen offset:0 sc0 sc1
L_ps_4_i2:
    s_bitcmp1_b32 s47, 3
    s_cbranch_scc0 L_ps_4_i3
    buffer_load_dwordx4 v[76:79], v41, s[32:35], s46 offen offset:1536 sc0 sc1
L_ps_4_i3:
    s_waitcnt vmcnt(0)
    s_bitcmp1_b32 s47, 0
    s_cbranch_scc0 L_ps_4_c0
    v_max_u32 v14, v64, v65
    v_max3_u32 v14, v14, v66, v67
    v_cmp_eq_u32 vcc, -1, v14
    s_cbranch_vccnz L_ps_4_c0
    s_bitset0_b32 s47, 0
L_ps_4_c0:
    s_bitcmp1_b32 s47, 1
    s_cbranch_scc0 L_ps_4_c1
    v_max_u32 v14, v68, v69
    v_max3_u32 v14, v14, v70, v71
    v_cmp_eq_u32 vcc, -1, v14
    s_cbranch_vccnz L_ps_4_c1
    s_bitset0_b32 s47, 1
L_ps_4_c1:
    s_bitcmp1_b32 s47, 2
    s_cbranch_scc0 L_ps_4_c2
    v_max_u32 v14, v72, v73
    v_max3_u32 v14, v14, v74, v75
    v_cmp_eq_u32 vcc, -1, v14
    s_cbranch_vccnz L_ps_4_c2
    s_bitset0_b32 s47, 2
L_ps_4_c2:
    s_bitcmp1_b32 s47, 3
    s_cbranch_scc0 L_ps_4_c3
    v_max_u32 v14, v76, v77
    v_max3_u32 v14, v14, v78, v79
    v_cmp_eq_u32 vcc, -1, v14
    s_cbranch_vccnz L_ps_4_c3
    s_bitset0_b32 s47, 3
L_ps_4_c3:
    s_cmp_eq_u32 s47, 0
    s_cbranch_scc1 L_ps_4_ok
    s_add_u32 s45, s45, 1
    s_cmp_lt_u32 s45, 0x20000
    s_cbranch_scc1 L_ps_4
L_ps_4_ok:
    v_max_f32 v12, v66, v70
    v_sub_f32 v13, v66, v12
    v_sub_f32 v14, v70, v12
    v_mul_f32 v13, 0x3fb8aa3b, v13
    v_mul_f32 v14, 0x3fb8aa3b, v14
    v_exp_f32 v13, v13
    v_exp_f32 v14, v14
    s_nop 0
    v_mul_f32 v15, v13, v67
    v_fmac_f32 v15, v14, v71
    v_rcp_f32 v15, v15
    s_nop 0
    v_mul_f32 v13, v13, v15
    v_mul_f32 v14, v14, v15
    v_mul_f32 v12, v13, v64
    v_mul_f32 v15, v13, v65
    v_fmac_f32 v12, v14, v68
    v_fmac_f32 v15, v14, v69
    v_cvt_pk_bf16_f32 v12, v12, v15
    ds_write_b32 v46, v12 offset:29952
    v_max_f32 v12, v74, v78
    v_sub_f32 v13, v74, v12
    v_sub_f32 v14, v78, v12
    v_mul_f32 v13, 0x3fb8aa3b, v13
    v_mul_f32 v14, 0x3fb8aa3b, v14
    v_exp_f32 v13, v13
    v_exp_f32 v14, v14
    s_nop 0
    v_mul_f32 v15, v13, v75
    v_fmac_f32 v15, v14, v79
    v_rcp_f32 v15, v15
    s_nop 0
    v_mul_f32 v13, v13, v15
    v_mul_f32 v14, v14, v15
    v_mul_f32 v12, v13, v72
    v_mul_f32 v15, v13, v73
    v_fmac_f32 v12, v14, v76
    v_fmac_f32 v15, v14, v77
    v_cvt_pk_bf16_f32 v12, v12, v15
    ds_write_b32 v47, v12 offset:29952
    s_branch L_c_items_done
L_c_one:
    s_mov_b32 s47, 0x3
    s_mov_b32 s45, 0
L_ps_5:
    s_bitcmp1_b32 s47, 0
    s_cbranch_scc0 L_ps_5_i0
    buffer_load_dwordx4 v[64:67], v40, s[32:35], s46 offen offset:0 sc0 sc1
L_ps_5_i0:
    s_bitcmp1_b32 s47, 1
    s_cbranch_scc0 L_ps_5_i1
    buffer_load_dwordx4 v[68:71], v40, s[32:35], s46 offen offset:1536 sc0 sc1
L_ps_5_i1:
    s_waitcnt vmcnt(0)
    s_bitcmp1_b32 s47, 0
    s_cbranch_scc0 L_ps_5_c0
    v_max_u32 v14, v64, v65
    v_max3_u32 v14, v14, v66, v67
    v_cmp_eq_u32 vcc, -1, v14
    s_cbranch_vccnz L_ps_5_c0
    s_bitset0_b32 s47, 0
L_ps_5_c0:
    s_bitcmp1_b32 s47, 1
    s_cbranch_scc0 L_ps_5_c1
    v_max_u32 v14, v68, v69
    v_max3_u32 v14, v14, v70, v71
    v_cmp_eq_u32 vcc, -1, v14
    s_cbranch_vccnz L_ps_5_c1
    s_bitset0_b32 s47, 1
L_ps_5_c1:
    s_cmp_eq_u32 s47, 0
    s_cbranch_scc1 L_ps_5_ok
    s_add_u32 s45, s45, 1
    s_cmp_lt_u32 s45, 0x20000
    s_cbranch_scc1 L_ps_5
L_ps_5_ok:
    v_max_f32 v12, v66, v70
    v_sub_f32 v13, v66, v12
    v_sub_f32 v14, v70, v12
    v_mul_f32 v13, 0x3fb8aa3b, v13
    v_mul_f32 v14, 0x3fb8aa3b, v14
    v_exp_f32 v13, v13
    v_exp_f32 v14, v14
    s_nop 0
    v_mul_f32 v15, v13, v67
    v_fmac_f32 v15, v14, v71
    v_rcp_f32 v15, v15
    s_nop 0
    v_mul_f32 v13, v13, v15
    v_mul_f32 v14, v14, v15
    v_mul_f32 v12, v13, v64
    v_mul_f32 v15, v13, v65
    v_fmac_f32 v12, v14, v68
    v_fmac_f32 v15, v14, v69
    v_cvt_pk_bf16_f32 v12, v12, v15
    ds_write_b32 v46, v12 offset:29952
L_c_items_done:
    s_waitcnt lgkmcnt(0)
    s_barrier
    s_lshr_b32 s48, s53, 2
    s_mul_i32 s50, s48, 384
    s_add_u32 s50, s50, 29952
    v_add_u32 v12, s50, v8
    ds_read_b128 v[16:19], v12 offset:0
    ds_read_b128 v[20:23], v12 offset:64
    ds_read_b128 v[24:27], v12 offset:128
    ds_read_b128 v[28:31], v12 offset:192
    ds_read_b128 v[32:35], v12 offset:256
    ds_read_b128 v[36:39], v12 offset:320
    s_waitcnt lgkmcnt(5)
    v_mfma_f32_16x16x32_bf16 v[48:51], v[16:19], v[80:83], 0
    s_waitcnt lgkmcnt(4)
    v_mfma_f32_16x16x32_bf16 v[48:51], v[20:23], v[84:87], v[48:51]
    s_waitcnt lgkmcnt(3)
    v_mfma_f32_16x16x32_bf16 v[48:51], v[24:27], v[88:91], v[48:51]
    s_waitcnt lgkmcnt(2)
    v_mfma_f32_16x16x32_bf16 v[48:51], v[28:31], v[92:95], v[48:51]
    s_waitcnt lgkmcnt(1)
    v_mfma_f32_16x16x32_bf16 v[48:51], v[32:35], v[112:115], v[48:51]
    s_waitcnt lgkmcnt(0)
    v_mfma_f32_16x16x32_bf16 v[48:51], v[36:39], v[116:119], v[48:51]
    s_nop 15
    s_lshr_b32 s48, s53, 2
    s_and_b32 s49, s53, 3
    s_mul_i32 s48, s48, 1024
    s_lshl_b32 s49, s49, 6
    s_add_u32 s48, s48, s49
    v_lshlrev_b32 v12, 2, v6
    v_add_u32 v12, s48, v12
    s_mov_b64 exec, 0xffff
    ds_write_b32 v12, v48 offset:13824
    ds_write_b32 v12, v49 offset:14080
    ds_write_b32 v12, v50 offset:14336
    ds_write_b32 v12, v51 offset:14592
    s_mov_b64 exec, -1
    s_waitcnt lgkmcnt(0)
    s_barrier
    s_cmp_ge_u32 s53, 4
    s_cbranch_scc1 L_c_pub_done
    v_lshlrev_b32 v12, 2, v0
    ds_read_b32 v16, v12 offset:13824
    ds_read_b32 v17, v12 offset:14848
    ds_read_b32 v18, v12 offset:15872
    ds_read_b32 v19, v12 offset:16896
    s_waitcnt lgkmcnt(0)
    v_add_f32 v16, v16, v17
    v_add_f32 v18, v18, v19
    v_add_f32 v16, v16, v18
    v_mul_u32_u24 v12, 2560, v7
    v_lshl_add_u32 v12, v6, 2, v12
    s_mul_i32 s48, s54, 10240
    s_lshl_b32 s49, s55, 8
    s_add_u32 s48, s48, s49
    s_add_u32 s48, s48, 262144
    buffer_store_dword v16, v12, s[32:35], s48 offen sc0 sc1
L_c_pub_done:
    s_endpgm
L_tail_e:
    v_and_b32 v12, 3, v6
    v_mul_u32_u24 v8, 3136, v12
    v_lshlrev_b32 v9, 3, v12
    v_lshrrev_b32 v12, 4, v6
    v_lshl_add_u32 v8, v12, 4, v8
    v_mul_u32_u24 v12, 512, v12
    v_add_u32 v9, v9, v12
    v_bfe_u32 v12, v6, 2, 2
    v_mul_u32_u24 v12, 64, v12
    v_add_u32 v9, v9, v12
    s_barrier
    v_min_u32 v57, 39, v6
    s_lshr_b32 s48, s53, 2
    s_mul_i32 s48, s48, 40
    v_add_u32 v57, s48, v57
    v_cmp_gt_u32 vcc, 40, v6
    s_nop 1
    v_cndmask_b32_e64 v56, 0, 1.0, vcc
    s_and_b32 s49, s53, 3
    s_mul_i32 s50, s49, 1280
    v_lshlrev_b32 v58, 3, v57
    buffer_load_dwordx2 v[48:49], v58, s[56:59], s50 offen
    buffer_load_dwordx2 v[50:51], v58, s[72:75], 0 offen
    s_mul_i32 s51, s49, 1344
    v_add_u32 v62, s51, v58
    v_lshlrev_b32 v59, 4, v57
    s_mul_i32 s50, s49, 2560
    s_add_u32 s50, s50, 262144
    s_mov_b32 s46, s50
    s_mov_b32 s47, 0xff
    s_mov_b32 s45, 0
    v_mov_b32 v52, 0
    v_mov_b32 v53, 0
    v_mov_b32 v54, 0
    v_mov_b32 v55, 0
L_pp_6:
    s_bitcmp1_b32 s47, 0
    s_cbranch_scc0 L_pp_6_i0
    s_add_u32 s44, s46, 0
    buffer_load_dwordx4 v[64:67], v59, s[32:35], s44 offen sc0 sc1
L_pp_6_i0:
    s_bitcmp1_b32 s47, 1
    s_cbranch_scc0 L_pp_6_i1
    s_add_u32 s44, s46, 10240
    buffer_load_dwordx4 v[68:71], v59, s[32:35], s44 offen sc0 sc1
L_pp_6_i1:
    s_bitcmp1_b32 s47, 2
    s_cbranch_scc0 L_pp_6_i2
    s_add_u32 s44, s46, 20480
    buffer_load_dwordx4 v[72:75], v59, s[32:35], s44 offen sc0 sc1
L_pp_6_i2:
    s_bitcmp1_b32 s47, 3
    s_cbranch_scc0 L_pp_6_i3
    s_add_u32 s44, s46, 30720
    buffer_load_dwordx4 v[76:79], v59, s[32:35], s44 offen sc0 sc1
L_pp_6_i3:
    s_bitcmp1_b32 s47, 4
    s_cbranch_scc0 L_pp_6_i4
    s_add_u32 s44, s46, 40960
    buffer_load_dwordx4 v[80:83], v59, s[32:35], s44 offen sc0 sc1
L_pp_6_i4:
    s_bitcmp1_b32 s47, 5
    s_cbranch_scc0 L_pp_6_i5
    s_add_u32 s44, s46, 51200
    buffer_load_dwordx4 v[84:87], v59, s[32:35], s44 offen sc0 sc1
L_pp_6_i5:
    s_bitcmp1_b32 s47, 6
    s_cbranch_scc0 L_pp_6_i6
    s_add_u32 s44, s46, 61440
    buffer_load_dwordx4 v[88:91], v59, s[32:35], s44 offen sc0 sc1
L_pp_6_i6:
    s_bitcmp1_b32 s47, 7
    s_cbranch_scc0 L_pp_6_i7
    s_add_u32 s44, s46, 71680
    buffer_load_dwordx4 v[92:95], v59, s[32:35], s44 offen sc0 sc1
L_pp_6_i7:
    s_waitcnt vmcnt(0)
    s_bitcmp1_b32 s47, 0
    s_cbranch_scc0 L_pp_6_c0
    v_max_u32 v60, v64, v65
    v_max3_u32 v60, v60, v66, v67
    v_cmp_eq_u32 vcc, -1, v60
    s_cbranch_vccnz L_pp_6_c0
    v_add_f32 v52, v52, v64
    v_add_f32 v53, v53, v65
    v_add_f32 v54, v54, v66
    v_add_f32 v55, v55, v67
    s_bitset0_b32 s47, 0
L_pp_6_c0:
    s_bitcmp1_b32 s47, 1
    s_cbranch_scc0 L_pp_6_c1
    v_max_u32 v60, v68, v69
    v_max3_u32 v60, v60, v70, v71
    v_cmp_eq_u32 vcc, -1, v60
    s_cbranch_vccnz L_pp_6_c1
    v_add_f32 v52, v52, v68
    v_add_f32 v53, v53, v69
    v_add_f32 v54, v54, v70
    v_add_f32 v55, v55, v71
    s_bitset0_b32 s47, 1
L_pp_6_c1:
    s_bitcmp1_b32 s47, 2
    s_cbranch_scc0 L_pp_6_c2
    v_max_u32 v60, v72, v73
    v_max3_u32 v60, v60, v74, v75
    v_cmp_eq_u32 vcc, -1, v60
    s_cbranch_vccnz L_pp_6_c2
    v_add_f32 v52, v52, v72
    v_add_f32 v53, v53, v73
    v_add_f32 v54, v54, v74
    v_add_f32 v55, v55, v75
    s_bitset0_b32 s47, 2
L_pp_6_c2:
    s_bitcmp1_b32 s47, 3
    s_cbranch_scc0 L_pp_6_c3
    v_max_u32 v60, v76, v77
    v_max3_u32 v60, v60, v78, v79
    v_cmp_eq_u32 vcc, -1, v60
    s_cbranch_vccnz L_pp_6_c3
    v_add_f32 v52, v52, v76
    v_add_f32 v53, v53, v77
    v_add_f32 v54, v54, v78
    v_add_f32 v55, v55, v79
    s_bitset0_b32 s47, 3
L_pp_6_c3:
    s_bitcmp1_b32 s47, 4
    s_cbranch_scc0 L_pp_6_c4
    v_max_u32 v60, v80, v81
    v_max3_u32 v60, v60, v82, v83
    v_cmp_eq_u32 vcc, -1, v60
    s_cbranch_vccnz L_pp_6_c4
    v_add_f32 v52, v52, v80
    v_add_f32 v53, v53, v81
    v_add_f32 v54, v54, v82
    v_add_f32 v55, v55, v83
    s_bitset0_b32 s47, 4
L_pp_6_c4:
    s_bitcmp1_b32 s47, 5
    s_cbranch_scc0 L_pp_6_c5
    v_max_u32 v60, v84, v85
    v_max3_u32 v60, v60, v86, v87
    v_cmp_eq_u32 vcc, -1, v60
    s_cbranch_vccnz L_pp_6_c5
    v_add_f32 v52, v52, v84
    v_add_f32 v53, v53, v85
    v_add_f32 v54, v54, v86
    v_add_f32 v55, v55, v87
    s_bitset0_b32 s47, 5
L_pp_6_c5:
    s_bitcmp1_b32 s47, 6
    s_cbranch_scc0 L_pp_6_c6
    v_max_u32 v60, v88, v89
    v_max3_u32 v60, v60, v90, v91
    v_cmp_eq_u32 vcc, -1, v60
    s_cbranch_vccnz L_pp_6_c6
    v_add_f32 v52, v52, v88
    v_add_f32 v53, v53, v89
    v_add_f32 v54, v54, v90
    v_add_f32 v55, v55, v91
    s_bitset0_b32 s47, 6
L_pp_6_c6:
    s_bitcmp1_b32 s47, 7
    s_cbranch_scc0 L_pp_6_c7
    v_max_u32 v60, v92, v93
    v_max3_u32 v60, v60, v94, v95
    v_cmp_eq_u32 vcc, -1, v60
    s_cbranch_vccnz L_pp_6_c7
    v_add_f32 v52, v52, v92
    v_add_f32 v53, v53, v93
    v_add_f32 v54, v54, v94
    v_add_f32 v55, v55, v95
    s_bitset0_b32 s47, 7
L_pp_6_c7:
    s_cmp_eq_u32 s47, 0
    s_cbranch_scc1 L_pp_6_ok
    s_add_u32 s45, s45, 1
    s_cmp_ge_u32 s45, 0x20000
    s_cbranch_scc1 L_pp_6_ok
    s_sleep 1
    s_branch L_pp_6
L_pp_6_ok:
    v_cvt_pk_bf16_f32 v52, v52, v52
    v_lshlrev_b32 v52, 16, v52
    v_cvt_pk_bf16_f32 v53, v53, v53
    v_lshlrev_b32 v53, 16, v53
    v_cvt_pk_bf16_f32 v54, v54, v54
    v_lshlrev_b32 v54, 16, v54
    v_cvt_pk_bf16_f32 v55, v55, v55
    v_lshlrev_b32 v55, 16, v55
    v_lshlrev_b32 v58, 16, v48
    v_and_b32 v59, 0xffff0000, v48
    v_lshlrev_b32 v60, 16, v49
    v_and_b32 v61, 0xffff0000, v49
    v_add_f32 v52, v52, v58
    v_cvt_pk_bf16_f32 v52, v52, v52
    v_lshlrev_b32 v52, 16, v52
    v_add_f32 v53, v53, v59
    v_cvt_pk_bf16_f32 v53, v53, v53
    v_lshlrev_b32 v53, 16, v53
    v_add_f32 v54, v54, v60
    v_cvt_pk_bf16_f32 v54, v54, v54
    v_lshlrev_b32 v54, 16, v54
    v_add_f32 v55, v55, v61
    v_cvt_pk_bf16_f32 v55, v55, v55
    v_lshlrev_b32 v55, 16, v55
    v_add_f32 v58, v52, v53
    v_add_f32 v59, v54, v55
    v_add_f32 v58, v58, v59
    v_mul_f32 v58, v58, v56
    s_nop 1
    v_add_f32_dpp v58, v58, v58 quad_perm:[1,0,3,2] row_mask:0xf bank_mask:0xf
    s_nop 1
    v_add_f32_dpp v58, v58, v58 quad_perm:[2,3,0,1] row_mask:0xf bank_mask:0xf
    s_nop 1
    v_add_f32_dpp v58, v58, v58 row_half_mirror row_mask:0xf bank_mask:0xf
    s_nop 1
    v_add_f32_dpp v58, v58, v58 row_mirror row_mask:0xf bank_mask:0xf
    s_nop 1
    v_readlane_b32 s48, v58, 0
    v_readlane_b32 s49, v58, 16
    v_readlane_b32 s50, v58, 32
    v_readlane_b32 s51, v58, 48
    s_nop 1
    v_mov_b32 v58, s48
    v_add_f32 v58, s49, v58
    v_add_f32 v58, s50, v58
    v_add_f32 v58, s51, v58
    v_mul_f32 v58, 0x3bcccccd, v58
    v_sub_f32 v60, v52, v58
    v_mul_f32 v59, v60, v60
    v_sub_f32 v60, v53, v58
    v_fmac_f32 v59, v60, v60
    v_sub_f32 v60, v54, v58
    v_fmac_f32 v59, v60, v60
    v_sub_f32 v60, v55, v58
    v_fmac_f32 v59, v60, v60
    v_mul_f32 v59, v59, v56
    s_nop 1
    v_add_f32_dpp v59, v59, v59 quad_perm:[1,0,3,2] row_mask:0xf bank_mask:0xf
    s_nop 1
    v_add_f32_dpp v59, v59, v59 quad_perm:[2,3,0,1] row_mask:0xf bank_mask:0xf
    s_nop 1
    v_add_f32_dpp v59, v59, v59 row_half_mirror row_mask:0xf bank_mask:0xf
    s_nop 1
    v_add_f32_dpp v59, v59, v59 row_mirror row_mask:0xf bank_mask:0xf
    s_nop 1
    v_readlane_b32 s48, v59, 0
    v_readlane_b32 s49, v59, 16
    v_readlane_b32 s50, v59, 32
    v_readlane_b32 s51, v59, 48
    s_nop 1
    v_mov_b32 v59, s48
    v_add_f32 v59, s49, v59
    v_add_f32 v59, s50, v59
    v_add_f32 v59, s51, v59
    s_lshl_b32 s49, s53, 5
    s_and_b32 s49, s49, 96
    s_and_b32 s50, s53, 12
    s_lshl_b32 s50, s50, 1
    s_add_u32 s50, s50, s49
    v_mov_b32 v60, s50
    v_mov_b32 v61, s49
    ds_write_b64 v60, v[58:59] offset:29696
    s_waitcnt lgkmcnt(0)
    s_barrier
    ds_read_b128 v[16:19], v61 offset:29696
    ds_read_b128 v[20:23], v61 offset:29712
    s_waitcnt lgkmcnt(0)
    v_add_f32 v24, v16, v18
    v_add_f32 v25, v20, v22
    v_add_f32 v24, v24, v25
    v_mul_f32 v24, 0.25, v24
    v_add_f32 v25, v17, v19
    v_add_f32 v26, v21, v23
    v_add_f32 v25, v25, v26
    v_sub_f32 v16, v16, v24
    v_sub_f32 v18, v18, v24
    v_sub_f32 v20, v20, v24
    v_sub_f32 v22, v22, v24
    v_mul_f32 v26, v16, v16
    v_fmac_f32 v26, v18, v18
    v_fmac_f32 v26, v20, v20
    v_fmac_f32 v26, v22, v22
    v_mov_b32 v27, 0x43200000
    v_fmac_f32 v25, v26, v27
    v_mul_f32 v25, 0x3acccccd, v25
    v_cvt_pk_bf16_f32 v24, v24, v24
    v_lshlrev_b32 v24, 16, v24
    v_cvt_pk_bf16_f32 v25, v25, v25
    v_lshlrev_b32 v25, 16, v25
    v_add_f32 v25, 0x3727c5ac, v25
    v_cvt_pk_bf16_f32 v25, v25, v25
    v_lshlrev_b32 v25, 16, v25
    v_sqrt_f32 v25, v25
    s_nop 0
    v_cvt_pk_bf16_f32 v25, v25, v25
    v_lshlrev_b32 v25, 16, v25
    v_rcp_f32 v25, v25
    s_nop 0
    v_sub_f32 v28, v52, v24
    v_cvt_pk_bf16_f32 v28, v28, v28
    v_lshlrev_b32 v28, 16, v28
    v_mul_f32 v28, v28, v25
    v_cvt_pk_bf16_f32 v28, v28, v28
    v_lshlrev_b32 v28, 16, v28
    v_sub_f32 v29, v53, v24
    v_cvt_pk_bf16_f32 v29, v29, v29
    v_lshlrev_b32 v29, 16, v29
    v_mul_f32 v29, v29, v25
    v_cvt_pk_bf16_f32 v29, v29, v29
    v_lshlrev_b32 v29, 16, v29
    v_sub_f32 v30, v54, v24
    v_cvt_pk_bf16_f32 v30, v30, v30
    v_lshlrev_b32 v30, 16, v30
    v_mul_f32 v30, v30, v25
    v_cvt_pk_bf16_f32 v30, v30, v30
    v_lshlrev_b32 v30, 16, v30
    v_sub_f32 v31, v55, v24
    v_cvt_pk_bf16_f32 v31, v31, v31
    v_lshlrev_b32 v31, 16, v31
    v_mul_f32 v31, v31, v25
    v_cvt_pk_bf16_f32 v31, v31, v31
    v_lshlrev_b32 v31, 16, v31
    v_cvt_pk_bf16_f32 v32, v28, v29
    v_cvt_pk_bf16_f32 v33, v30, v31
    v_cvt_pk_bf16_f32 v34, v52, v53
    v_cvt_pk_bf16_f32 v35, v54, v55
    v_lshlrev_b32 v58, 16, v50
    v_and_b32 v59, 0xffff0000, v50
    v_mul_f32 v36, v28, v58
    v_fmac_f32 v36, v29, v59
    v_lshlrev_b32 v58, 16, v51
    v_and_b32 v59, 0xffff0000, v51
    v_fmac_f32 v36, v30, v58
    v_fmac_f32 v36, v31, v59
    v_mul_f32 v36, v36, v56
    s_nop 1
    v_add_f32_dpp v36, v36, v36 quad_perm:[1,0,3,2] row_mask:0xf bank_mask:0xf
    s_nop 1
    v_add_f32_dpp v36, v36, v36 quad_perm:[2,3,0,1] row_mask:0xf bank_mask:0xf
    s_nop 1
    v_add_f32_dpp v36, v36, v36 row_half_mirror row_mask:0xf bank_mask:0xf
    s_nop 1
    v_add_f32_dpp v36, v36, v36 row_mirror row_mask:0xf bank_mask:0xf
    s_nop 1
    v_readlane_b32 s48, v36, 0
    v_readlane_b32 s49, v36, 16
    v_readlane_b32 s50, v36, 32
    v_readlane_b32 s51, v36, 48
    s_nop 1
    v_mov_b32 v36, s48
    v_add_f32 v36, s49, v36
    v_add_f32 v36, s50, v36
    v_add_f32 v36, s51, v36
    v_lshrrev_b32 v60, 1, v60
    ds_write_b32 v60, v36 offset:29824
    s_mov_b32 exec_lo, -1
    s_mov_b32 exec_hi, 0xff
    ds_write_b64 v62, v[32:33] offset:18944
    ds_write_b64 v62, v[34:35] offset:24320
    s_mov_b64 exec, -1
    s_waitcnt vmcnt(0)
    s_lshr_b32 s48, s53, 1
    s_and_b32 s49, s53, 1
    s_mul_i32 s50, s48, 12288
    s_lshl_b32 s49, s49, 5
    s_add_u32 s50, s50, s49
    s_add_u32 s50, s50, 42496
    v_add_u32 v13, s50, v9
    ds_read_b64_tr_b16 v[40:41], v13 offset:0
    ds_read_b64_tr_b16 v[42:43], v13 offset:256
    ds_read_b64_tr_b16 v[44:45], v13 offset:2048
    ds_read_b64_tr_b16 v[46:47], v13 offset:2304
    ds_read_b64_tr_b16 v[48:49], v13 offset:4096
    ds_read_b64_tr_b16 v[50:51], v13 offset:4352
    ds_read_b64_tr_b16 v[52:53], v13 offset:6144
    ds_read_b64_tr_b16 v[54:55], v13 offset:6400
    ds_read_b64_tr_b16 v[56:57], v13 offset:8192
    ds_read_b64_tr_b16 v[58:59], v13 offset:8448
    ds_read_b64_tr_b16 v[60:61], v13 offset:10240
    ds_read_b64_tr_b16 v[62:63], v13 offset:10496
    s_waitcnt lgkmcnt(0)
    s_barrier
    s_cmp_ge_u32 s53, 2
    s_cbranch_scc1 L_e_pre_done
    v_and_b32 v13, 31, v0
    s_lshl_b32 s48, s55, 5
    v_add_u32 v13, s48, v13
    v_lshrrev_b32 v14, 5, v0
    v_mul_u32_u24 v15, 1344, v14
    v_lshl_add_u32 v15, v13, 1, v15
    v_lshlrev_b32 v12, 4, v14
    ds_read_u16 v70, v15 offset:18944
    ds_read_u16 v71, v15 offset:24320
    ds_read_b128 v[76:79], v12 offset:29824
    v_mul_u32_u24 v14, 640, v14
    v_add_u32 v14, v14, v13
    v_lshlrev_b32 v73, 1, v14
    s_waitcnt lgkmcnt(0)
    v_add_f32 v76, v76, v77
    v_add_f32 v78, v78, v79
    v_add_f32 v72, v76, v78
    v_cvt_pk_bf16_f32 v72, v72, v72
    v_lshlrev_b32 v72, 16, v72
    v_mul_f32 v72, 0xbfb8aa3b, v72
    v_exp_f32 v72, v72
    s_nop 0
    v_add_f32 v72, 1.0, v72
    v_rcp_f32 v72, v72
    s_nop 0
    v_cvt_pk_bf16_f32 v72, v72, v72
    v_lshlrev_b32 v72, 16, v72
    v_lshlrev_b32 v70, 16, v70
    v_lshlrev_b32 v71, 16, v71
L_e_pre_done:
    s_cmp_lt_u32 s53, 4
    s_cbranch_scc1 L_e_wait
L_e_act:
    v_subrev_u32 v15, 256, v0
    v_lshlrev_b32 v12, 4, v15
    v_mul_u32_u24 v13, 43691, v15
    v_lshrrev_b32 v13, 23, v13
    v_mul_u32_u24 v14, 64, v13
    v_add_u32 v14, v14, v12
    s_mov_b32 s45, 0
    s_mov_b32 s46, 360448
    buffer_load_dwordx4 v[80:83], v12, s[32:35], s46 offen sc0 sc1
    s_mov_b32 s46, 376832
    buffer_load_dwordx4 v[84:87], v12, s[32:35], s46 offen sc0 sc1
    s_sleep 10
L_pc_7:
    s_mov_b32 s46, 360448
    buffer_load_dwordx4 v[96:99], v12, s[32:35], s46 offen sc0 sc1
    s_mov_b32 s46, 376832
    buffer_load_dwordx4 v[100:103], v12, s[32:35], s46 offen sc0 sc1
    s_waitcnt vmcnt(2)
    v_max_u32 v15, v80, v81
    v_max3_u32 v15, v15, v82, v83
    v_max3_u32 v15, v15, v84, v85
    v_max3_u32 v15, v15, v86, v87
    v_cmp_eq_u32 vcc, -1, v15
    s_cbranch_vccz L_pc_7_a
    s_mov_b32 s46, 360448
    buffer_load_dwordx4 v[80:83], v12, s[32:35], s46 offen sc0 sc1
    s_mov_b32 s46, 376832
    buffer_load_dwordx4 v[84:87], v12, s[32:35], s46 offen sc0 sc1
    s_waitcnt vmcnt(2)
    v_max_u32 v15, v96, v97
    v_max3_u32 v15, v15, v98, v99
    v_max3_u32 v15, v15, v100, v101
    v_max3_u32 v15, v15, v102, v103
    v_cmp_eq_u32 vcc, -1, v15
    s_cbranch_vccz L_pc_7_b
    s_add_u32 s45, s45, 1
    s_cmp_lt_u32 s45, 0x20000
    s_cbranch_scc1 L_pc_7
L_pc_7_b:
    v_lshlrev_b32 v24, 16, v96
    v_and_b32 v25, 0xffff0000, v96
    v_lshlrev_b32 v26, 16, v100
    v_and_b32 v27, 0xffff0000, v100
    v_mul_f32 v24, v24, v26
    v_mul_f32 v25, v25, v27
    v_cvt_pk_bf16_f32 v32, v24, v25
    v_lshlrev_b32 v24, 16, v97
    v_and_b32 v25, 0xffff0000, v97
    v_lshlrev_b32 v26, 16, v101
    v_and_b32 v27, 0xffff0000, v101
    v_mul_f32 v24, v24, v26
    v_mul_f32 v25, v25, v27
    v_cvt_pk_bf16_f32 v33, v24, v25
    v_lshlrev_b32 v24, 16, v98
    v_and_b32 v25, 0xffff0000, v98
    v_lshlrev_b32 v26, 16, v102
    v_and_b32 v27, 0xffff0000, v102
    v_mul_f32 v24, v24, v26
    v_mul_f32 v25, v25, v27
    v_cvt_pk_bf16_f32 v34, v24, v25
    v_lshlrev_b32 v24, 16, v99
    v_and_b32 v25, 0xffff0000, v99
    v_lshlrev_b32 v26, 16, v103
    v_and_b32 v27, 0xffff0000, v103
    v_mul_f32 v24, v24, v26
    v_mul_f32 v25, v25, v27
    v_cvt_pk_bf16_f32 v35, v24, v25
    s_branch L_pc_7_e
L_pc_7_a:
    v_lshlrev_b32 v24, 16, v80
    v_and_b32 v25, 0xffff0000, v80
    v_lshlrev_b32 v26, 16, v84
    v_and_b32 v27, 0xffff0000, v84
    v_mul_f32 v24, v24, v26
    v_mul_f32 v25, v25, v27
    v_cvt_pk_bf16_f32 v32, v24, v25
    v_lshlrev_b32 v24, 16, v81
    v_and_b32 v25, 0xffff0000, v81
    v_lshlrev_b32 v26, 16, v85
    v_and_b32 v27, 0xffff0000, v85
    v_mul_f32 v24, v24, v26
    v_mul_f32 v25, v25, v27
    v_cvt_pk_bf16_f32 v33, v24, v25
    v_lshlrev_b32 v24, 16, v82
    v_and_b32 v25, 0xffff0000, v82
    v_lshlrev_b32 v26, 16, v86
    v_and_b32 v27, 0xffff0000, v86
    v_mul_f32 v24, v24, v26
    v_mul_f32 v25, v25, v27
    v_cvt_pk_bf16_f32 v34, v24, v25
    v_lshlrev_b32 v24, 16, v83
    v_and_b32 v25, 0xffff0000, v83
    v_lshlrev_b32 v26, 16, v87
    v_and_b32 v27, 0xffff0000, v87
    v_mul_f32 v24, v24, v26
    v_mul_f32 v25, v25, v27
    v_cvt_pk_bf16_f32 v35, v24, v25
L_pc_7_e:
    ds_write_b128 v14, v[32:35] offset:29952
L_e_wait:
    s_waitcnt lgkmcnt(0)
    s_barrier
    s_lshr_b32 s48, s53, 1
    s_mul_i32 s50, s48, 384
    s_add_u32 s50, s50, 29952
    v_add_u32 v12, s50, v8
    ds_read_b128 v[16:19], v12 offset:0
    ds_read_b128 v[20:23], v12 offset:64
    ds_read_b128 v[24:27], v12 offset:128
    ds_read_b128 v[28:31], v12 offset:192
    ds_read_b128 v[32:35], v12 offset:256
    ds_read_b128 v[36:39], v12 offset:320
    s_waitcnt lgkmcnt(5)
    v_mfma_f32_16x16x32_bf16 v[64:67], v[16:19], v[40:43], 0
    s_waitcnt lgkmcnt(4)
    v_mfma_f32_16x16x32_bf16 v[64:67], v[20:23], v[44:47], v[64:67]
    s_waitcnt lgkmcnt(3)
    v_mfma_f32_16x16x32_bf16 v[64:67], v[24:27], v[48:51], v[64:67]
    s_waitcnt lgkmcnt(2)
    v_mfma_f32_16x16x32_bf16 v[64:67], v[28:31], v[52:55], v[64:67]
    s_waitcnt lgkmcnt(1)
    v_mfma_f32_16x16x32_bf16 v[64:67], v[32:35], v[56:59], v[64:67]
    s_waitcnt lgkmcnt(0)
    v_mfma_f32_16x16x32_bf16 v[64:67], v[36:39], v[60:63], v[64:67]
    s_nop 15
    s_lshr_b32 s48, s53, 1
    s_and_b32 s49, s53, 1
    s_mul_i32 s48, s48, 512
    s_lshl_b32 s49, s49, 6
    s_add_u32 s48, s48, s49
    v_lshlrev_b32 v12, 2, v6
    v_add_u32 v12, s48, v12
    s_mov_b64 exec, 0xffff
    ds_write_b32 v12, v64 offset:13824
    ds_write_b32 v12, v65 offset:13952
    ds_write_b32 v12, v66 offset:14080
    ds_write_b32 v12, v67 offset:14208
    s_mov_b64 exec, -1
    s_waitcnt lgkmcnt(0)
    s_barrier
    s_cmp_ge_u32 s53, 2
    s_cbranch_scc1 L_done
    v_lshlrev_b32 v12, 2, v0
    ds_read_b32 v16, v12 offset:13824
    ds_read_b32 v17, v12 offset:14336
    ds_read_b32 v18, v12 offset:14848
    ds_read_b32 v19, v12 offset:15360
    ds_read_b32 v20, v12 offset:15872
    ds_read_b32 v21, v12 offset:16384
    ds_read_b32 v22, v12 offset:16896
    ds_read_b32 v23, v12 offset:17408
    s_waitcnt lgkmcnt(0)
    v_add_f32 v16, v16, v20
    v_add_f32 v17, v17, v21
    v_add_f32 v18, v18, v22
    v_add_f32 v19, v19, v23
    v_add_f32 v16, v16, v18
    v_add_f32 v17, v17, v19
    v_add_f32 v16, v16, v17
    v_cvt_pk_bf16_f32 v16, v16, v16
    v_lshlrev_b32 v16, 16, v16
    v_mul_f32 v16, v16, v72
    v_cvt_pk_bf16_f32 v16, v16, v16
    v_lshlrev_b32 v16, 16, v16
    v_add_f32 v16, v70, v16
    v_cvt_pk_bf16_f32 v16, v16, v16
    v_lshlrev_b32 v16, 16, v16
    v_add_f32 v16, v71, v16
    v_cvt_pk_bf16_f32 v16, v16, v16
    buffer_store_short v16, v73, s[76:79], 0 offen
    s_endpgm
L_tail_d:
    v_and_b32 v12, 15, v6
    v_min_u32 v12, 4, v12
    v_mul_u32_u24 v8, 1344, v12
    v_and_b32 v12, 3, v6
    v_lshlrev_b32 v9, 3, v12
    v_lshrrev_b32 v12, 4, v6
    v_lshl_add_u32 v8, v12, 4, v8
    v_mul_u32_u24 v12, 1024, v12
    v_add_u32 v9, v9, v12
    v_bfe_u32 v12, v6, 2, 2
    v_mul_u32_u24 v12, 128, v12
    v_add_u32 v9, v9, v12
    v_cmp_gt_u32 vcc, 320, v0
    s_and_saveexec_b64 s[100:101], vcc
    v_lshlrev_b32 v12, 2, v0
    v_mov_b32 v13, 0x3f803f80
    ds_write_b32 v12, v13 offset:24320
    s_mov_b64 exec, s[100:101]
    s_waitcnt vmcnt(0) lgkmcnt(0)
    s_barrier
    s_lshr_b32 s48, s53, 2
    s_and_b32 s49, s53, 3
    s_mul_i32 s50, s48, 20480
    s_lshl_b32 s49, s49, 5
    s_add_u32 s50, s50, s49
    s_add_u32 s50, s50, 42496
    v_add_u32 v13, s50, v9
    ds_read_b64_tr_b16 v[16:17], v13 offset:0
    ds_read_b64_tr_b16 v[18:19], v13 offset:512
    ds_read_b64_tr_b16 v[20:21], v13 offset:4096
    ds_read_b64_tr_b16 v[22:23], v13 offset:4608
    ds_read_b64_tr_b16 v[24:25], v13 offset:8192
    ds_read_b64_tr_b16 v[26:27], v13 offset:8704
    ds_read_b64_tr_b16 v[28:29], v13 offset:12288
    ds_read_b64_tr_b16 v[30:31], v13 offset:12800
    ds_read_b64_tr_b16 v[32:33], v13 offset:16384
    ds_read_b64_tr_b16 v[34:35], v13 offset:16896
    s_min_u32 s48, s53, 9
    s_lshl_b32 s48, s48, 8
    v_lshlrev_b32 v57, 2, v6
    v_add_u32 v57, s48, v57
    v_lshlrev_b32 v58, 1, v57
    buffer_load_dwordx2 v[48:49], v58, s[56:59], 0 offen
    v_lshrrev_b32 v60, 7, v57
    v_lshlrev_b32 v63, 3, v60
    v_mul_u32_u24 v60, 52, v60
    v_lshrrev_b32 v60, 8, v60
    v_mul_u32_u24 v62, 64, v60
    v_add_u32 v62, v62, v58
    v_lshlrev_b32 v59, 2, v57
    s_waitcnt vmcnt(0)
    v_and_b32 v51, 0xffff0000, v49
    v_lshlrev_b32 v50, 16, v49
    v_and_b32 v49, 0xffff0000, v48
    v_lshlrev_b32 v48, 16, v48
    s_cmp_lg_u32 s53, 0
    s_cbranch_scc1 L_d_gate_done
    s_lshl_b32 s44, s2, 7
    s_add_u32 s44, s44, 458752
    v_mov_b32 v122, 0
    s_mov_b32 s45, 0
    buffer_load_dword v123, v122, s[32:35], s44 offen sc0 sc1
L_gate_8:
    s_sleep 6
    buffer_load_dword v124, v122, s[32:35], s44 offen sc0 sc1
    s_waitcnt vmcnt(1)
    v_cmp_ne_u32 vcc, 1, v123
    s_cbranch_vccz L_gate_8_ok
    s_sleep 6
    buffer_load_dword v123, v122, s[32:35], s44 offen sc0 sc1
    s_waitcnt vmcnt(1)
    v_cmp_ne_u32 vcc, 1, v124
    s_add_u32 s45, s45, 1
    s_cbranch_vccz L_gate_8_ok
    s_cmp_lt_u32 s45, 0x20000
    s_cbranch_scc1 L_gate_8
L_gate_8_ok:
L_d_gate_done:
    s_barrier
    s_cmp_ge_u32 s53, 10
    s_cbranch_scc1 L_d10_skip
    s_mov_b32 s47, 0xff
    s_mov_b32 s45, 0
    v_mov_b32 v52, 0
    v_mov_b32 v53, 0
    v_mov_b32 v54, 0
    v_mov_b32 v55, 0
L_pp_9:
    s_bitcmp1_b32 s47, 0
    s_cbranch_scc0 L_pp_9_i0
    s_mov_b32 s44, 262144
    buffer_load_dwordx4 v[64:67], v59, s[32:35], s44 offen sc0 sc1
L_pp_9_i0:
    s_bitcmp1_b32 s47, 1
    s_cbranch_scc0 L_pp_9_i1
    s_mov_b32 s44, 272384
    buffer_load_dwordx4 v[68:71], v59, s[32:35], s44 offen sc0 sc1
L_pp_9_i1:
    s_bitcmp1_b32 s47, 2
    s_cbranch_scc0 L_pp_9_i2
    s_mov_b32 s44, 282624
    buffer_load_dwordx4 v[72:75], v59, s[32:35], s44 offen sc0 sc1
L_pp_9_i2:
    s_bitcmp1_b32 s47, 3
    s_cbranch_scc0 L_pp_9_i3
    s_mov_b32 s44, 292864
    buffer_load_dwordx4 v[76:79], v59, s[32:35], s44 offen sc0 sc1
L_pp_9_i3:
    s_bitcmp1_b32 s47, 4
    s_cbranch_scc0 L_pp_9_i4
    s_mov_b32 s44, 303104
    buffer_load_dwordx4 v[80:83], v59, s[32:35], s44 offen sc0 sc1
L_pp_9_i4:
    s_bitcmp1_b32 s47, 5
    s_cbranch_scc0 L_pp_9_i5
    s_mov_b32 s44, 313344
    buffer_load_dwordx4 v[84:87], v59, s[32:35], s44 offen sc0 sc1
L_pp_9_i5:
    s_bitcmp1_b32 s47, 6
    s_cbranch_scc0 L_pp_9_i6
    s_mov_b32 s44, 323584
    buffer_load_dwordx4 v[88:91], v59, s[32:35], s44 offen sc0 sc1
L_pp_9_i6:
    s_bitcmp1_b32 s47, 7
    s_cbranch_scc0 L_pp_9_i7
    s_mov_b32 s44, 333824
    buffer_load_dwordx4 v[92:95], v59, s[32:35], s44 offen sc0 sc1
L_pp_9_i7:
    s_waitcnt vmcnt(0)
    s_bitcmp1_b32 s47, 0
    s_cbranch_scc0 L_pp_9_c0
    v_max_u32 v60, v64, v65
    v_max3_u32 v60, v60, v66, v67
    v_cmp_eq_u32 vcc, -1, v60
    s_cbranch_vccnz L_pp_9_c0
    v_add_f32 v52, v52, v64
    v_add_f32 v53, v53, v65
    v_add_f32 v54, v54, v66
    v_add_f32 v55, v55, v67
    s_bitset0_b32 s47, 0
L_pp_9_c0:
    s_bitcmp1_b32 s47, 1
    s_cbranch_scc0 L_pp_9_c1
    v_max_u32 v60, v68, v69
    v_max3_u32 v60, v60, v70, v71
    v_cmp_eq_u32 vcc, -1, v60
    s_cbranch_vccnz L_pp_9_c1
    v_add_f32 v52, v52, v68
    v_add_f32 v53, v53, v69
    v_add_f32 v54, v54, v70
    v_add_f32 v55, v55, v71
    s_bitset0_b32 s47, 1
L_pp_9_c1:
    s_bitcmp1_b32 s47, 2
    s_cbranch_scc0 L_pp_9_c2
    v_max_u32 v60, v72, v73
    v_max3_u32 v60, v60, v74, v75
    v_cmp_eq_u32 vcc, -1, v60
    s_cbranch_vccnz L_pp_9_c2
    v_add_f32 v52, v52, v72
    v_add_f32 v53, v53, v73
    v_add_f32 v54, v54, v74
    v_add_f32 v55, v55, v75
    s_bitset0_b32 s47, 2
L_pp_9_c2:
    s_bitcmp1_b32 s47, 3
    s_cbranch_scc0 L_pp_9_c3
    v_max_u32 v60, v76, v77
    v_max3_u32 v60, v60, v78, v79
    v_cmp_eq_u32 vcc, -1, v60
    s_cbranch_vccnz L_pp_9_c3
    v_add_f32 v52, v52, v76
    v_add_f32 v53, v53, v77
    v_add_f32 v54, v54, v78
    v_add_f32 v55, v55, v79
    s_bitset0_b32 s47, 3
L_pp_9_c3:
    s_bitcmp1_b32 s47, 4
    s_cbranch_scc0 L_pp_9_c4
    v_max_u32 v60, v80, v81
    v_max3_u32 v60, v60, v82, v83
    v_cmp_eq_u32 vcc, -1, v60
    s_cbranch_vccnz L_pp_9_c4
    v_add_f32 v52, v52, v80
    v_add_f32 v53, v53, v81
    v_add_f32 v54, v54, v82
    v_add_f32 v55, v55, v83
    s_bitset0_b32 s47, 4
L_pp_9_c4:
    s_bitcmp1_b32 s47, 5
    s_cbranch_scc0 L_pp_9_c5
    v_max_u32 v60, v84, v85
    v_max3_u32 v60, v60, v86, v87
    v_cmp_eq_u32 vcc, -1, v60
    s_cbranch_vccnz L_pp_9_c5
    v_add_f32 v52, v52, v84
    v_add_f32 v53, v53, v85
    v_add_f32 v54, v54, v86
    v_add_f32 v55, v55, v87
    s_bitset0_b32 s47, 5
L_pp_9_c5:
    s_bitcmp1_b32 s47, 6
    s_cbranch_scc0 L_pp_9_c6
    v_max_u32 v60, v88, v89
    v_max3_u32 v60, v60, v90, v91
    v_cmp_eq_u32 vcc, -1, v60
    s_cbranch_vccnz L_pp_9_c6
    v_add_f32 v52, v52, v88
    v_add_f32 v53, v53, v89
    v_add_f32 v54, v54, v90
    v_add_f32 v55, v55, v91
    s_bitset0_b32 s47, 6
L_pp_9_c6:
    s_bitcmp1_b32 s47, 7
    s_cbranch_scc0 L_pp_9_c7
    v_max_u32 v60, v92, v93
    v_max3_u32 v60, v60, v94, v95
    v_cmp_eq_u32 vcc, -1, v60
    s_cbranch_vccnz L_pp_9_c7
    v_add_f32 v52, v52, v92
    v_add_f32 v53, v53, v93
    v_add_f32 v54, v54, v94
    v_add_f32 v55, v55, v95
    s_bitset0_b32 s47, 7
L_pp_9_c7:
    s_cmp_eq_u32 s47, 0
    s_cbranch_scc1 L_pp_9_ok
    s_add_u32 s45, s45, 1
    s_cmp_ge_u32 s45, 0x20000
    s_cbranch_scc1 L_pp_9_ok
    s_sleep 1
    s_branch L_pp_9
L_pp_9_ok:
    v_cvt_pk_bf16_f32 v52, v52, v52
    v_lshlrev_b32 v52, 16, v52
    v_cvt_pk_bf16_f32 v53, v53, v53
    v_lshlrev_b32 v53, 16, v53
    v_cvt_pk_bf16_f32 v54, v54, v54
    v_lshlrev_b32 v54, 16, v54
    v_cvt_pk_bf16_f32 v55, v55, v55
    v_lshlrev_b32 v55, 16, v55
    v_add_f32 v52, v52, v48
    v_add_f32 v53, v53, v49
    v_add_f32 v54, v54, v50
    v_add_f32 v55, v55, v51
    v_cvt_pk_bf16_f32 v60, v52, v53
    v_cvt_pk_bf16_f32 v61, v54, v55
    ds_write_b64 v62, v[60:61] offset:18944
    s_mov_b32 vcc_lo, 0
    s_mov_b32 vcc_hi, -1
    v_lshlrev_b32 v52, 16, v60
    v_and_b32 v53, 0xffff0000, v60
    v_lshlrev_b32 v54, 16, v61
    v_and_b32 v55, 0xffff0000, v61
    v_add_f32 v58, v52, v53
    v_add_f32 v59, v54, v55
    v_add_f32 v58, v58, v59
    s_nop 1
    v_add_f32_dpp v58, v58, v58 quad_perm:[1,0,3,2] row_mask:0xf bank_mask:0xf
    s_nop 1
    v_add_f32_dpp v58, v58, v58 quad_perm:[2,3,0,1] row_mask:0xf bank_mask:0xf
    s_nop 1
    v_add_f32_dpp v58, v58, v58 row_half_mirror row_mask:0xf bank_mask:0xf
    s_nop 1
    v_add_f32_dpp v58, v58, v58 row_mirror row_mask:0xf bank_mask:0xf
    s_nop 1
    v_add_f32_dpp v58, v58, v58 row_bcast:15 row_mask:0xa bank_mask:0xf
    s_nop 1
    v_readlane_b32 s44, v58, 16
    v_readlane_b32 s45, v58, 48
    s_nop 1
    v_mov_b32 v58, s44
    v_mov_b32 v60, s45
    v_cndmask_b32 v58, v58, v60, vcc
    v_mul_f32 v58, 0x3c000000, v58
    v_sub_f32 v60, v52, v58
    v_mul_f32 v59, v60, v60
    v_sub_f32 v60, v53, v58
    v_fmac_f32 v59, v60, v60
    v_sub_f32 v60, v54, v58
    v_fmac_f32 v59, v60, v60
    v_sub_f32 v60, v55, v58
    v_fmac_f32 v59, v60, v60
    s_nop 1
    v_add_f32_dpp v59, v59, v59 quad_perm:[1,0,3,2] row_mask:0xf bank_mask:0xf
    s_nop 1
    v_add_f32_dpp v59, v59, v59 quad_perm:[2,3,0,1] row_mask:0xf bank_mask:0xf
    s_nop 1
    v_add_f32_dpp v59, v59, v59 row_half_mirror row_mask:0xf bank_mask:0xf
    s_nop 1
    v_add_f32_dpp v59, v59, v59 row_mirror row_mask:0xf bank_mask:0xf
    s_nop 1
    v_add_f32_dpp v59, v59, v59 row_bcast:15 row_mask:0xa bank_mask:0xf
    s_nop 1
    v_readlane_b32 s44, v59, 16
    v_readlane_b32 s45, v59, 48
    s_nop 1
    v_mov_b32 v59, s44
    v_mov_b32 v60, s45
    v_cndmask_b32 v59, v59, v60, vcc
    ds_write_b64 v63, v[58:59] offset:29696
L_d10_skip:
    s_waitcnt lgkmcnt(0)
    s_barrier
    s_lshr_b32 s48, s53, 2
    s_mul_i32 s50, s48, 320
    s_add_u32 s50, s50, 18944
    v_add_u32 v12, s50, v8
    s_cmp_ge_u32 s53, 4
    s_cbranch_scc1 L_d_h1
    s_mul_i32 s49, s53, 40
    v_mov_b32 v60, s49
    ds_read_b64 v[2:3], v60 offset:29696
    ds_read_b64 v[4:5], v60 offset:29704
    ds_read_b64 v[10:11], v60 offset:29712
    ds_read_b64 v[14:15], v60 offset:29720
    ds_read_b64 v[62:63], v60 offset:29728
L_d_h1:
    ds_read_b128 v[36:39], v12 offset:0
    ds_read_b128 v[40:43], v12 offset:64
    ds_read_b128 v[44:47], v12 offset:128
    ds_read_b128 v[48:51], v12 offset:192
    ds_read_b128 v[52:55], v12 offset:256
    s_cmp_ge_u32 s53, 4
    s_cbranch_scc1 L_d_h2
    s_waitcnt lgkmcnt(5)
    v_add_f32 v1, v2, v4
    v_add_f32 v12, v10, v14
    v_add_f32 v1, v1, v12
    v_add_f32 v1, v1, v62
    v_mul_f32 v60, 0x3e4ccccd, v1
    v_add_f32 v12, v3, v5
    v_add_f32 v13, v11, v15
    v_add_f32 v12, v12, v13
    v_add_f32 v12, v12, v63
    v_sub_f32 v2, v2, v60
    v_sub_f32 v4, v4, v60
    v_sub_f32 v10, v10, v60
    v_sub_f32 v14, v14, v60
    v_sub_f32 v62, v62, v60
    v_mul_f32 v13, v2, v2
    v_fmac_f32 v13, v4, v4
    v_fmac_f32 v13, v10, v10
    v_fmac_f32 v13, v14, v14
    v_fmac_f32 v13, v62, v62
    v_mov_b32 v1, 0x43000000
    v_fmac_f32 v12, v13, v1
    v_mul_f32 v61, 0x3acccccd, v12
    v_cvt_pk_bf16_f32 v60, v60, v60
    v_lshlrev_b32 v60, 16, v60
    v_cvt_pk_bf16_f32 v61, v61, v61
    v_lshlrev_b32 v61, 16, v61
    v_add_f32 v61, 0x3727c5ac, v61
    v_cvt_pk_bf16_f32 v61, v61, v61
    v_lshlrev_b32 v61, 16, v61
    v_sqrt_f32 v61, v61
    s_nop 0
    v_cvt_pk_bf16_f32 v61, v61, v61
    v_lshlrev_b32 v61, 16, v61
    v_rcp_f32 v61, v61
L_d_h2:
    s_waitcnt lgkmcnt(4)
    v_mfma_f32_16x16x32_bf16 v[56:59], v[36:39], v[16:19], 0
    s_waitcnt lgkmcnt(3)
    v_mfma_f32_16x16x32_bf16 v[56:59], v[40:43], v[20:23], v[56:59]
    s_waitcnt lgkmcnt(2)
    v_mfma_f32_16x16x32_bf16 v[56:59], v[44:47], v[24:27], v[56:59]
    s_waitcnt lgkmcnt(1)
    v_mfma_f32_16x16x32_bf16 v[56:59], v[48:51], v[28:31], v[56:59]
    s_waitcnt lgkmcnt(0)
    v_mfma_f32_16x16x32_bf16 v[56:59], v[52:55], v[32:35], v[56:59]
    s_nop 15
    s_lshr_b32 s48, s53, 2
    s_and_b32 s49, s53, 3
    s_mul_i32 s48, s48, 1280
    s_lshl_b32 s49, s49, 6
    s_add_u32 s48, s48, s49
    v_lshlrev_b32 v12, 2, v6
    v_add_u32 v12, s48, v12
    s_mov_b64 exec, 0xffff
    ds_write_b32 v12, v56 offset:13824
    ds_write_b32 v12, v57 offset:14080
    ds_write_b32 v12, v58 offset:14336
    ds_write_b32 v12, v59 offset:14592
    s_mov_b64 exec, 0xffff0000
    ds_write_b32 v12, v56 offset:14784
    s_mov_b64 exec, -1
    s_waitcnt lgkmcnt(0)
    s_barrier
    s_cmp_ge_u32 s53, 4
    s_cbranch_scc1 L_done
    v_lshlrev_b32 v12, 2, v0
    v_lshlrev_b32 v13, 2, v6
    ds_read_b32 v16, v12 offset:13824
    ds_read_b32 v17, v12 offset:15104
    ds_read_b32 v18, v12 offset:16384
    ds_read_b32 v19, v12 offset:17664
    ds_read_b32 v20, v13 offset:14848
    ds_read_b32 v21, v13 offset:16128
    ds_read_b32 v22, v13 offset:17408
    ds_read_b32 v23, v13 offset:18688
    s_waitcnt lgkmcnt(0)
    v_add_f32 v16, v16, v17
    v_add_f32 v20, v20, v21
    v_add_f32 v18, v18, v19
    v_add_f32 v22, v22, v23
    v_add_f32 v16, v16, v18
    v_add_f32 v20, v20, v22
    v_fma_f32 v16, -v60, v20, v16
    v_mul_f32 v16, v16, v61
    s_cmp_lg_u32 s54, 0
    s_cbranch_scc1 L_d_nosilu
    v_cvt_pk_bf16_f32 v16, v16, v16
    v_lshlrev_b32 v16, 16, v16
    v_mul_f32 v18, 0xbfb8aa3b, v16
    v_exp_f32 v18, v18
    s_nop 0
    v_add_f32 v18, 1.0, v18
    v_rcp_f32 v18, v18
    s_nop 0
    v_mul_f32 v16, v16, v18
L_d_nosilu:
    s_nop 1
    v_mov_b32_dpp v17, v16 quad_perm:[1,0,3,2] row_mask:0xf bank_mask:0xf
    v_cvt_pk_bf16_f32 v16, v16, v17
    v_mul_u32_u24 v12, 3072, v7
    v_lshl_add_u32 v12, v6, 1, v12
    s_mul_i32 s48, s54, 16384
    s_lshl_b32 s49, s55, 7
    s_add_u32 s48, s48, s49
    s_add_u32 s48, s48, 360448
    s_mov_b32 exec_lo, 0x55555555
    s_mov_b32 exec_hi, 0x55555555
    buffer_store_dword v16, v12, s[32:35], s48 offen sc0 sc1
    s_mov_b64 exec, -1
L_done:
    s_endpgm
.section .rodata,"a"
.p2align 6
.amdhsa_kernel sequential_preLN__mha_block_cached__moe_arch_mod__decode_kernel
  .amdhsa_next_free_vgpr 128
  .amdhsa_next_free_sgpr 102
  .amdhsa_accum_offset 128
  .amdhsa_group_segment_fixed_size 0
  .amdhsa_kernarg_size 104
  .amdhsa_user_sgpr_count 2
  .amdhsa_user_sgpr_kernarg_segment_ptr 1
  .amdhsa_system_sgpr_workgroup_id_x 1
.end_amdhsa_kernel
```
